```python
import torch

def _softmax(x, axis=-1):
    return torch.softmax(x, dim=axis)
def _gelu(x):
    return torch.nn.functional.gelu(x, approximate="tanh")
def _silu(x):
    return torch.nn.functional.silu(x)
def _sigmoid(x):
    return torch.sigmoid(x)
def _layernorm(x, axis=-1, eps=1e-5):
    m = x.mean(dim=axis, keepdim=True)
    v = x.var(dim=axis, keepdim=True, unbiased=False)
    return (x - m) / torch.sqrt(v + eps)
def _scatter_add(tgt, idx, src, axis=0):
    return tgt.clone().index_add_(axis, idx, src)
def _segment_sum(src, seg, n):
    out = torch.zeros((n,) + src.shape[1:], dtype=src.dtype)
    return out.index_add_(0, seg, src)
def _pad(x, pw):
    flat = tuple(v for pair in reversed(pw) for v in pair)
    return torch.nn.functional.pad(x, flat)

kernel_name = 'recurrent_scan__compressed_kv_cla__dense_activation_silu__prompt'

def setup_inputs():

    _w = (lambda a: (lambda t: t.to(torch.bfloat16) if t.is_floating_point() else t)(torch.as_tensor(a)))
    def _A_setup():
        B, H, Sq, Sk, D, M = 1, 32, 2048, 2048, 128, 640
        Dc = 4 * D
        return {
            "x": _w((lambda *s: torch.randn(*s, dtype=torch.bfloat16) * 0.05)(B, Sq, M)),
            "c_kv": _w((lambda *s: torch.randn(*s, dtype=torch.bfloat16) * 0.8)(B, Sk, Dc)),
            "w_q": _w((lambda *s: torch.randn(*s, dtype=torch.bfloat16) * 1.6)(M, H, D) * (M ** -0.5)),
            "w_uk": _w((lambda *s: torch.randn(*s, dtype=torch.bfloat16) * 1.6)(Dc, H, D) * (Dc ** -0.5)),
            "w_uv": _w((lambda *s: torch.randn(*s, dtype=torch.bfloat16) * 0.8)(Dc, H, D) * (Dc ** -0.5)),
            "w_o": _w((lambda *s: torch.randn(*s, dtype=torch.bfloat16) * 0.8)(H, D, M) * ((H * D) ** -0.5)),
        }
    _A_in = _A_setup()

    def _B_setup():
        B, S, D, F = 1, 2048, 640, 1728
        return {
            "x": _w((lambda *s: torch.randn(*s, dtype=torch.bfloat16) * 0.05)(B, S, D)),
            "w1": _w((lambda *s: torch.randn(*s, dtype=torch.bfloat16) * 0.8)(D, F) * (D ** -0.5)),
            "w2": _w((lambda *s: torch.randn(*s, dtype=torch.bfloat16) * 0.2)(F, D) * (F ** -0.5)),
        }
    _B_in = _B_setup()

    return {
        "A_x": _A_in["x"],
        "A_c_kv": _A_in["c_kv"],
        "A_w_q": _A_in["w_q"],
        "A_w_uk": _A_in["w_uk"],
        "A_w_uv": _A_in["w_uv"],
        "A_w_o": _A_in["w_o"],
        "B_x": _B_in["x"],
        "B_w1": _B_in["w1"],
        "B_w2": _B_in["w2"],
    }

def reference(A_x, A_c_kv, A_w_q, A_w_uk, A_w_uv, A_w_o, B_x, B_w1, B_w2):
    def _A_ref(x, c_kv, w_q, w_uk, w_uv, w_o):
        B, Sq, M = x.shape[0], x.shape[1], x.shape[2]
        Sk = c_kv.shape[1]
        H, D = w_q.shape[1], w_q.shape[2]
        q = torch.einsum("bqm,mhd->bhqd", x, w_q)
        k = torch.einsum("bkc,chd->bhkd", c_kv, w_uk)
        v = torch.einsum("bkc,chd->bhkd", c_kv, w_uv)
        scores = torch.einsum("bhqd,bhkd->bhqk", q, k) * (D ** -0.5)
        off = Sk - Sq
        qi = torch.arange(Sq)[:, None]
        kj = torch.arange(Sk)[None, :]
        cmask = kj <= (qi + off)
        scores = torch.where(cmask[None, None], scores, -1e9)
        p = _softmax(scores, axis=-1)
        ctx = torch.einsum("bhqk,bhkd->bhqd", p, v)
        return torch.einsum("bhqd,hdm->bqm", ctx, w_o)

    def _B_ref(x, w1, w2):
        h = torch.einsum("bsd,df->bsf", x, w1)
        h = _silu(h)
        out = torch.einsum("bsf,fd->bsd", h, w2)
        return out

    x = A_x
    xn = _layernorm(x, axis=-1)
    s = _A_ref(xn, A_c_kv, A_w_q, A_w_uk, A_w_uv, A_w_o)
    g = _silu(_B_ref(xn, B_w1, B_w2))
    return x + s * g
```

```asm
; @launch grid=(256,1,1) block=(256,1,1) lds=163840
.amdgcn_target "amdgcn-amd-amdhsa--gfx950"
.text
.globl recurrent_scan__compressed_kv_cla__dense_activation_silu__prompt_kernel
.p2align 8
.type recurrent_scan__compressed_kv_cla__dense_activation_silu__prompt_kernel,@function
recurrent_scan__compressed_kv_cla__dense_activation_silu__prompt_kernel:

s_cmp_ge_u32 s2, 256
s_cbranch_scc1 L_end
s_load_dwordx2 s[12:13], s[0:1], 8
s_load_dwordx2 s[20:21], s[0:1], 24
s_load_dwordx2 s[24:25], s[0:1], 32
v_lshrrev_b32 v1, 6, v0
s_mov_b32 s6, 97517568
s_mov_b32 s7, 0x20000
s_mov_b32 s10, 2621440
s_mov_b32 s11, 0x20000
s_mov_b32 s14, 2097152
s_mov_b32 s15, 0x20000
s_mov_b32 s18, 5242880
s_mov_b32 s19, 0x20000
s_mov_b32 s22, 4194304
s_mov_b32 s23, 0x20000
s_mov_b32 s26, 4194304
s_mov_b32 s27, 0x20000
s_mov_b32 s30, 5242880
s_mov_b32 s31, 0x20000
s_mov_b32 s34, 2211840
s_mov_b32 s35, 0x20000
s_mov_b32 s38, 2211840
s_mov_b32 s39, 0x20000
s_mov_b32 s42, 2621440
s_mov_b32 s43, 0x20000
s_mov_b32 s46, 256
s_mov_b32 s47, 0x20000
v_readfirstlane_b32 s48, v1
v_and_b32 v0, 63, v0
v_lshlrev_b32 v1, 4, v0
s_and_b32 s49, s2, 7
s_lshl_b32 s49, s49, 2
s_lshr_b32 s3, s2, 3
s_add_u32 s3, s3, 0
s_and_b32 s3, s3, 3
s_add_u32 s49, s49, s3
s_lshr_b32 s50, s2, 5
s_sub_u32 s64, 15, s50
s_lshl_b32 s51, 1, s49
s_sub_u32 s52, s51, 1
s_and_b32 s52, s52, 538976290
s_bcnt1_i32_b32 s52, s52
s_sub_u32 s92, s49, s52
s_bitcmp1_b32 538976290, s49
s_cselect_b32 s92, 31, s92
s_and_b32 s54, s48, 1
s_lshr_b32 s55, s48, 1
s_lshl_b32 s100, s3, 0
s_lshl_b32 s51, s50, 0
s_xor_b32 s100, s100, s51
s_and_b32 s100, s100, 1
s_add_u32 s101, s2, 1
s_and_b32 s101, s101, 1
s_getpc_b64 s[96:97]
L_pc:
s_lshr_b32 s95, s2, 3
s_lshl_b32 s95, s95, 2
s_add_u32 s95, s95, s48
s_lshl_b32 s95, s95, 10
v_add_u32 v252, s95, v1
v_min_u32 v252, L_code_end-L_pc-4, v252
v_mov_b32 v253, s97
v_add_co_u32 v252, vcc, s96, v252
s_nop 1
v_addc_co_u32 v253, vcc, 0, v253, vcc
global_load_dword v255, v[252:253], off

v_and_b32 v60, 15, v0
v_lshrrev_b32 v61, 4, v0
v_lshrrev_b32 v62, 3, v0
s_lshl_b32 s51, s50, 8
s_lshl_b32 s52, s48, 6
s_add_u32 s51, s51, s52
v_add_u32 v62, s51, v62
v_lshlrev_b32 v62, 10, v62
v_and_b32 v63, 7, v0
v_xor_b32 v63, v63, v61
v_lshl_add_u32 v8, v63, 4, v62
v_xor_b32 v9, 64, v8
v_add_u32 v9, 7168, v9
v_add_u32 v10, 14336, v8
v_add_u32 v11, 14336, v9
s_lshl_b32 s51, s48, 4
v_add_u32 v62, s51, v61
v_lshlrev_b32 v62, 13, v62
s_lshl_b32 s53, s49, 8
v_add_u32 v62, s53, v62
v_lshlrev_b32 v63, 1, v61
v_xor_b32 v63, v63, v60
v_lshl_add_u32 v12, v63, 4, v62
v_add_u32 v13, 31744, v12
v_xor_b32 v14, 128, v12
v_add_u32 v14, 63488, v14
v_add_u32 v15, 31744, v14
s_lshl_b32 s56, s48, 13
s_lshl_b32 s57, s48, 12
s_add_u32 s57, s57, 65536
v_mov_b32 v69, 2146435072
s_waitcnt lgkmcnt(0)
s_add_u32 m0, s56, 0
s_mov_b32 s58, 0
buffer_load_dwordx4 v8, s[12:15], s58 offen offset:0 lds
buffer_load_dwordx4 v9, s[12:15], s58 offen offset:1024 lds
buffer_load_dwordx4 v10, s[12:15], s58 offen offset:2048 lds
buffer_load_dwordx4 v11, s[12:15], s58 offen offset:3072 lds
s_add_u32 m0, s56, 4096
s_add_u32 s58, s58, 32768
buffer_load_dwordx4 v8, s[12:15], s58 offen offset:0 lds
buffer_load_dwordx4 v9, s[12:15], s58 offen offset:1024 lds
buffer_load_dwordx4 v10, s[12:15], s58 offen offset:2048 lds
buffer_load_dwordx4 v11, s[12:15], s58 offen offset:3072 lds
s_add_u32 m0, s57, 0
s_mov_b32 s59, 0
buffer_load_dwordx4 v12, s[20:23], s59 offen offset:0 lds
buffer_load_dwordx4 v13, s[20:23], s59 offen offset:1024 lds
buffer_load_dwordx4 v14, s[20:23], s59 offen offset:2048 lds
buffer_load_dwordx4 v15, s[20:23], s59 offen offset:3072 lds
s_load_dwordx2 s[8:9], s[0:1], 0
s_load_dwordx2 s[4:5], s[0:1], 88
s_load_dwordx2 s[16:17], s[0:1], 16
s_load_dwordx2 s[32:33], s[0:1], 56
s_load_dwordx2 s[36:37], s[0:1], 64
s_load_dwordx2 s[28:29], s[0:1], 40
s_load_dwordx2 s[40:41], s[0:1], 72
s_load_dwordx2 s[44:45], s[0:1], 80
v_lshrrev_b32 v62, 1, v60
v_xor_b32 v62, v62, v61
v_lshlrev_b32 v62, 4, v62
v_lshl_add_u32 v2, v60, 7, v62
s_lshl_b32 s51, s55, 14
v_add_u32 v2, s51, v2
v_xor_b32 v3, 64, v2
v_lshrrev_b32 v62, 2, v60
v_and_b32 v63, 1, v61
v_lshl_or_b32 v63, v63, 2, v62
v_lshl_add_u32 v62, v61, 3, v62
v_lshlrev_b32 v62, 8, v62
v_and_b32 v70, 3, v60
v_lshl_add_u32 v62, v70, 3, v62
v_add_u32 v62, 65536, v62
s_lshl_b32 s51, s54, 2
v_xor_b32 v63, s51, v63
v_lshl_add_u32 v4, v63, 5, v62
v_xor_b32 v5, 32, v4
v_xor_b32 v6, 64, v4
v_xor_b32 v7, 96, v4
v_lshlrev_b32 v36, 2, v0
v_cmp_gt_u32 vcc, 16, v0
s_lshl_b32 s51, s50, 7
s_lshl_b32 s52, s64, 7
s_sub_u32 s52, s52, 64
v_mov_b32 v62, s51
v_mov_b32 v63, s52
s_add_u32 m0, s57, 16384
s_mov_b32 s59, 0
buffer_load_dwordx4 v12, s[24:27], s59 offen offset:0 lds
v_cndmask_b32 v37, v63, v62, vcc
v_add_u32 v37, v37, v36
v_add_u32 v37, 70799360, v37
s_lshl_b32 s61, s2, 2
s_add_u32 s62, s61, s48
s_lshl_b32 s62, s62, 10
s_add_u32 s62, s62, 70778880
s_cmp_lt_u32 s2, 8
s_cselect_b32 s62, s62, 2146435072
s_cselect_b32 s61, s61, 2146435072
v_mov_b32 v72, 0
v_mov_b32 v73, 0
buffer_load_dwordx4 v13, s[24:27], s59 offen offset:1024 lds
v_mov_b32 v74, 0
v_mov_b32 v75, 0
s_lshr_b32 s87, s2, 4
s_lshl_b32 s87, s87, 7
s_and_b32 s51, s2, 15
s_lshl_b32 s51, s51, 2
s_add_u32 s87, s87, s51
s_add_u32 s87, s87, 70799360
v_and_b32 v64, 7, v0
v_lshrrev_b32 v65, 3, v0
s_lshl_b32 s51, s2, 3
v_add_u32 v66, s51, v64
s_movk_i32 s52, 1280
v_mul_lo_u32 v66, v66, s52
s_mul_i32 s53, s48, 20
v_add_u32 v67, s53, v65
v_lshl_add_u32 v252, v67, 4, v66
v_cmp_gt_u32 vcc, 4, v65
v_add_u32 v253, 256, v252
v_lshlrev_b32 v254, 4, v64
v_lshl_add_u32 v254, v67, 8, v254
v_add_u32 v42, 4096, v254
v_cndmask_b32 v253, v69, v253, vcc
v_cndmask_b32 v42, v69, v42, vcc
s_lshr_b32 s60, s2, 1
s_mul_i32 s60, s60, 20480
s_and_b32 s52, s2, 1
s_lshl_b32 s52, s52, 7
s_add_u32 s60, s60, s52
s_cmp_eq_u32 s48, 0
s_cselect_b32 s61, s61, 2146435072
s_cselect_b32 s87, s87, 2146435072
s_lshl_b32 s51, s50, 2
s_add_u32 s51, s51, s48
s_mul_i32 s51, s51, 5
v_lshrrev_b32 v62, 1, v0
buffer_load_dwordx4 v14, s[24:27], s59 offen offset:2048 lds
v_add_u32 v62, s51, v62
v_lshlrev_b32 v62, 13, v62
v_and_b32 v63, 1, v0
v_lshlrev_b32 v63, 7, v63
s_lshl_b32 s52, s49, 8
v_add3_u32 v34, v62, v63, s52
v_cmp_gt_u32 vcc, 10, v0
v_add_u32 v63, s51, v0
s_movk_i32 s53, 3456
v_mul_lo_u32 v63, v63, s53
v_cndmask_b32 v34, v69, v34, vcc
v_cmp_gt_u32 vcc, 5, v0
s_lshl_b32 s52, s92, 7
v_add_u32 v35, s52, v63
v_cndmask_b32 v35, v69, v35, vcc
s_waitcnt lgkmcnt(0)
buffer_store_dwordx4 v[72:75], v1, s[4:7], s62 offen sc1
s_cmp_eq_u32 s54, 0
s_cselect_b32 s51, s50, s64
s_lshl_b32 s51, s51, 3
s_add_u32 s52, s51, s55
s_mul_i32 s52, s52, 20480
v_add_u32 v16, s52, v1
v_add_u32 v18, 81920, v16
s_sub_u32 s52, s51, s55
s_add_u32 s52, s52, 3
s_mul_i32 s52, s52, 20480
v_add_u32 v17, s52, v1
v_add_u32 v19, 81920, v17
s_lshl_b32 s51, s48, 4
v_lshrrev_b32 v62, 3, v0
v_add_u32 v62, s51, v62
s_movk_i32 s52, 3456
v_mul_lo_u32 v62, v62, s52
s_lshl_b32 s52, s92, 7
v_add_u32 v62, s52, v62
buffer_load_dwordx4 v15, s[24:27], s59 offen offset:3072 lds
v_and_b32 v63, 1, v61
v_lshlrev_b32 v63, 1, v63
v_and_b32 v70, 7, v0
v_xor_b32 v63, v63, v70
v_lshl_add_u32 v20, v63, 4, v62
v_xor_b32 v63, 4, v63
v_lshl_add_u32 v21, v63, 4, v62
v_add_u32 v21, 26624, v21
v_lshrrev_b32 v62, 2, v60
v_and_b32 v63, 1, v61
v_lshl_or_b32 v63, v63, 2, v62
v_lshl_add_u32 v62, v61, 3, v62
s_add_u32 m0, s56, 32768
s_xor_b32 s58, s100, 2
s_cmp_eq_u32 s101, 0
s_cselect_b32 s58, 1, s58
s_lshl_b32 s58, s58, 7
buffer_load_dwordx4 v8, s[12:15], s58 offen offset:0 lds
v_and_b32 v70, 3, v60
v_lshlrev_b32 v70, 3, v70
v_lshl_add_u32 v71, v62, 8, v70
v_lshl_add_u32 v22, v63, 5, v71
v_xor_b32 v23, 32, v22
v_xor_b32 v24, 64, v22
v_xor_b32 v25, 96, v22
v_xor_b32 v26, 128, v22
v_xor_b32 v27, 160, v22
v_xor_b32 v28, 192, v22
v_xor_b32 v29, 224, v22
v_lshl_add_u32 v71, v62, 7, v70
buffer_load_dwordx4 v9, s[12:15], s58 offen offset:1024 lds
v_lshrrev_b32 v63, 3, v60
v_and_b32 v62, 1, v61
v_lshl_or_b32 v63, v62, 1, v63
v_lshl_add_u32 v30, v63, 5, v71
v_add_u32 v30, 16384, v30
v_xor_b32 v31, 32, v30
v_xor_b32 v32, 64, v30
v_xor_b32 v33, 96, v30
s_lshr_b32 s51, s50, 2
s_lshl_b32 s94, s49, 0
s_xor_b32 s94, s94, s51
s_and_b32 s94, s94, 3
s_and_b32 s93, s50, 3
s_lshl_b32 s65, s48, 12
s_lshl_b32 s66, s48, 11
s_cmp_lt_u32 s92, 27
s_cselect_b32 s67, 0, 2146435072
v_mov_b32 v38, 2146435072
v_writelane_b32 v38, 0, 0
v_mov_b32 v39, 1
s_lshl_b32 s51, s49, 19
s_add_u32 s51, s51, s56
v_add_u32 v40, s51, v1
v_add_u32 v41, 4096, v40
buffer_load_dwordx4 v10, s[12:15], s58 offen offset:2048 lds
buffer_load_dwordx4 v11, s[12:15], s58 offen offset:3072 lds
s_add_u32 m0, s56, 36864
s_add_u32 s58, s58, 32768
buffer_load_dwordx4 v8, s[12:15], s58 offen offset:0 lds
buffer_load_dwordx4 v9, s[12:15], s58 offen offset:1024 lds
buffer_load_dwordx4 v10, s[12:15], s58 offen offset:2048 lds
buffer_load_dwordx4 v11, s[12:15], s58 offen offset:3072 lds

s_waitcnt vmcnt(13)
s_barrier
ds_read_b64_tr_b16 a[128:129], v4 offset:0
ds_read_b64_tr_b16 a[130:131], v4 offset:1024
ds_read_b64_tr_b16 a[132:133], v4 offset:8192
ds_read_b64_tr_b16 a[134:135], v4 offset:9216
ds_read_b128 a[0:3], v2 offset:0
ds_read_b128 a[4:7], v3 offset:0
ds_read_b128 a[8:11], v2 offset:2048
ds_read_b128 a[12:15], v3 offset:2048
ds_read_b128 a[16:19], v2 offset:4096
ds_read_b128 a[20:23], v3 offset:4096
ds_read_b128 a[24:27], v2 offset:6144
ds_read_b128 a[28:31], v3 offset:6144
ds_read_b128 a[32:35], v2 offset:8192
ds_read_b128 a[36:39], v3 offset:8192
ds_read_b128 a[40:43], v2 offset:10240
ds_read_b128 a[44:47], v3 offset:10240
ds_read_b128 a[48:51], v2 offset:12288
ds_read_b128 a[52:55], v3 offset:12288
ds_read_b128 a[56:59], v2 offset:14336
ds_read_b128 a[60:63], v3 offset:14336
s_waitcnt lgkmcnt(15)
v_mfma_f32_16x16x32_bf16 v[44:47], a[128:131], a[0:3], 0
s_waitcnt lgkmcnt(13)
ds_read_b64_tr_b16 a[136:137], v5 offset:0
ds_read_b64_tr_b16 a[138:139], v5 offset:1024
v_mfma_f32_16x16x32_bf16 v[44:47], a[132:135], a[4:7], v[44:47]
s_waitcnt lgkmcnt(13)
s_add_u32 m0, s57, 32768
ds_read_b64_tr_b16 a[140:141], v5 offset:8192
ds_read_b64_tr_b16 a[142:143], v5 offset:9216
v_mfma_f32_16x16x32_bf16 v[48:51], a[132:135], a[12:15], 0
s_xor_b32 s59, s100, 2
s_cmp_eq_u32 s101, 0
s_cselect_b32 s59, 1, s59
v_mfma_f32_16x16x32_bf16 v[48:51], a[128:131], a[8:11], v[48:51]
s_lshl_b32 s59, s59, 19
buffer_load_dwordx4 v12, s[20:23], s59 offen offset:0 lds
v_mfma_f32_16x16x32_bf16 v[52:55], a[128:131], a[16:19], 0
s_waitcnt lgkmcnt(14)
v_mfma_f32_16x16x32_bf16 v[52:55], a[132:135], a[20:23], v[52:55]
s_waitcnt lgkmcnt(12)
buffer_load_dwordx4 v13, s[20:23], s59 offen offset:1024 lds
v_mfma_f32_16x16x32_bf16 v[56:59], a[132:135], a[28:31], 0
v_mfma_f32_16x16x32_bf16 v[56:59], a[128:131], a[24:27], v[56:59]
s_waitcnt lgkmcnt(7)
v_mfma_f32_16x16x32_bf16 v[60:63], a[128:131], a[32:35], 0
v_mfma_f32_16x16x32_bf16 v[60:63], a[132:135], a[36:39], v[60:63]
buffer_load_dwordx4 v14, s[20:23], s59 offen offset:2048 lds
v_mfma_f32_16x16x32_bf16 v[64:67], a[132:135], a[44:47], 0
v_mfma_f32_16x16x32_bf16 v[64:67], a[128:131], a[40:43], v[64:67]
v_mfma_f32_16x16x32_bf16 v[68:71], a[128:131], a[48:51], 0
s_waitcnt lgkmcnt(0)
v_mfma_f32_16x16x32_bf16 v[68:71], a[132:135], a[52:55], v[68:71]
buffer_load_dwordx4 v15, s[20:23], s59 offen offset:3072 lds
v_mfma_f32_16x16x32_bf16 v[72:75], a[132:135], a[60:63], 0
v_mfma_f32_16x16x32_bf16 v[72:75], a[128:131], a[56:59], v[72:75]
v_mfma_f32_16x16x32_bf16 a[172:175], a[136:139], a[56:59], 0
ds_read_b64_tr_b16 a[128:129], v6 offset:0
ds_read_b64_tr_b16 a[130:131], v6 offset:1024
v_mfma_f32_16x16x32_bf16 a[172:175], a[140:143], a[60:63], a[172:175]
s_add_u32 m0, s57, 49152
ds_read_b64_tr_b16 a[132:133], v6 offset:8192
ds_read_b64_tr_b16 a[134:135], v6 offset:9216
v_mfma_f32_16x16x32_bf16 a[168:171], a[140:143], a[52:55], 0
s_xor_b32 s59, s100, 2
s_cmp_eq_u32 s101, 0
s_cselect_b32 s59, 1, s59
v_mfma_f32_16x16x32_bf16 a[168:171], a[136:139], a[48:51], a[168:171]
s_lshl_b32 s59, s59, 19
buffer_load_dwordx4 v12, s[24:27], s59 offen offset:0 lds
v_mfma_f32_16x16x32_bf16 a[164:167], a[136:139], a[40:43], 0
v_mfma_f32_16x16x32_bf16 a[164:167], a[140:143], a[44:47], a[164:167]
buffer_load_dwordx4 v13, s[24:27], s59 offen offset:1024 lds
v_mfma_f32_16x16x32_bf16 a[160:163], a[140:143], a[36:39], 0
v_mfma_f32_16x16x32_bf16 a[160:163], a[136:139], a[32:35], a[160:163]
v_mfma_f32_16x16x32_bf16 a[156:159], a[136:139], a[24:27], 0
v_mfma_f32_16x16x32_bf16 a[156:159], a[140:143], a[28:31], a[156:159]
buffer_load_dwordx4 v14, s[24:27], s59 offen offset:2048 lds
v_mfma_f32_16x16x32_bf16 a[152:155], a[140:143], a[20:23], 0
v_mfma_f32_16x16x32_bf16 a[152:155], a[136:139], a[16:19], a[152:155]
v_mfma_f32_16x16x32_bf16 a[148:151], a[136:139], a[8:11], 0
v_mfma_f32_16x16x32_bf16 a[148:151], a[140:143], a[12:15], a[148:151]
buffer_load_dwordx4 v15, s[24:27], s59 offen offset:3072 lds
v_mfma_f32_16x16x32_bf16 a[144:147], a[140:143], a[4:7], 0
v_mfma_f32_16x16x32_bf16 a[144:147], a[136:139], a[0:3], a[144:147]
s_waitcnt lgkmcnt(0)
v_mfma_f32_16x16x32_bf16 v[76:79], a[128:131], a[0:3], 0
ds_read_b64_tr_b16 a[136:137], v7 offset:0
ds_read_b64_tr_b16 a[138:139], v7 offset:1024
v_mfma_f32_16x16x32_bf16 v[76:79], a[132:135], a[4:7], v[76:79]
ds_read_b64_tr_b16 a[140:141], v7 offset:8192
ds_read_b64_tr_b16 a[142:143], v7 offset:9216
v_mfma_f32_16x16x32_bf16 v[80:83], a[132:135], a[12:15], 0
v_mfma_f32_16x16x32_bf16 v[80:83], a[128:131], a[8:11], v[80:83]
v_mfma_f32_16x16x32_bf16 v[84:87], a[128:131], a[16:19], 0
v_mfma_f32_16x16x32_bf16 v[84:87], a[132:135], a[20:23], v[84:87]
v_mfma_f32_16x16x32_bf16 v[88:91], a[132:135], a[28:31], 0
v_mfma_f32_16x16x32_bf16 v[88:91], a[128:131], a[24:27], v[88:91]
v_mfma_f32_16x16x32_bf16 v[92:95], a[128:131], a[32:35], 0
v_mfma_f32_16x16x32_bf16 v[92:95], a[132:135], a[36:39], v[92:95]
v_mfma_f32_16x16x32_bf16 v[96:99], a[132:135], a[44:47], 0
v_mfma_f32_16x16x32_bf16 v[96:99], a[128:131], a[40:43], v[96:99]
v_mfma_f32_16x16x32_bf16 v[100:103], a[128:131], a[48:51], 0
v_mfma_f32_16x16x32_bf16 v[100:103], a[132:135], a[52:55], v[100:103]
v_mfma_f32_16x16x32_bf16 v[104:107], a[132:135], a[60:63], 0
v_mfma_f32_16x16x32_bf16 v[104:107], a[128:131], a[56:59], v[104:107]
s_waitcnt lgkmcnt(0)
v_mfma_f32_16x16x32_bf16 a[228:231], a[136:139], a[56:59], 0
s_waitcnt vmcnt(16) lgkmcnt(0)
s_barrier
ds_read_b64_tr_b16 a[128:129], v4 offset:16384
v_mfma_f32_16x16x32_bf16 a[228:231], a[140:143], a[60:63], a[228:231]
ds_read_b64_tr_b16 a[130:131], v4 offset:17408
ds_read_b64_tr_b16 a[132:133], v4 offset:24576
v_mfma_f32_16x16x32_bf16 a[224:227], a[140:143], a[52:55], 0
ds_read_b64_tr_b16 a[134:135], v4 offset:25600
v_mfma_f32_16x16x32_bf16 a[224:227], a[136:139], a[48:51], a[224:227]
buffer_store_dword v39, v38, s[44:47], s61 offen sc1
v_mfma_f32_16x16x32_bf16 a[220:223], a[136:139], a[40:43], 0
v_mfma_f32_16x16x32_bf16 a[220:223], a[140:143], a[44:47], a[220:223]
v_mfma_f32_16x16x32_bf16 a[216:219], a[140:143], a[36:39], 0
v_mfma_f32_16x16x32_bf16 a[216:219], a[136:139], a[32:35], a[216:219]
v_mfma_f32_16x16x32_bf16 a[188:191], a[136:139], a[24:27], 0
s_add_u32 m0, s56, 0
s_add_u32 s58, s101, 2
s_and_b32 s58, s58, 7
v_mfma_f32_16x16x32_bf16 a[188:191], a[140:143], a[28:31], a[188:191]
s_xor_b32 s58, s58, s100
s_lshl_b32 s58, s58, 7
v_mfma_f32_16x16x32_bf16 a[184:187], a[140:143], a[20:23], 0
buffer_load_dwordx4 v8, s[12:15], s58 offen offset:0 lds
v_mfma_f32_16x16x32_bf16 a[184:187], a[136:139], a[16:19], a[184:187]
v_mfma_f32_16x16x32_bf16 a[180:183], a[136:139], a[8:11], 0
v_mfma_f32_16x16x32_bf16 a[180:183], a[140:143], a[12:15], a[180:183]
buffer_load_dwordx4 v9, s[12:15], s58 offen offset:1024 lds
v_mfma_f32_16x16x32_bf16 a[176:179], a[140:143], a[4:7], 0
v_mfma_f32_16x16x32_bf16 a[176:179], a[136:139], a[0:3], a[176:179]
s_waitcnt lgkmcnt(0)
v_mfma_f32_16x16x32_bf16 v[108:111], a[0:3], a[128:131], 0
ds_read_b64_tr_b16 a[136:137], v5 offset:16384
ds_read_b64_tr_b16 a[138:139], v5 offset:17408
v_mfma_f32_16x16x32_bf16 v[108:111], a[4:7], a[132:135], v[108:111]
ds_read_b64_tr_b16 a[140:141], v5 offset:24576
ds_read_b64_tr_b16 a[142:143], v5 offset:25600
v_mfma_f32_16x16x32_bf16 v[116:119], a[12:15], a[132:135], 0
buffer_load_dwordx4 v10, s[12:15], s58 offen offset:2048 lds
v_mfma_f32_16x16x32_bf16 v[116:119], a[8:11], a[128:131], v[116:119]
v_mfma_f32_16x16x32_bf16 a[232:235], a[16:19], a[128:131], 0
v_mfma_f32_16x16x32_bf16 a[232:235], a[20:23], a[132:135], a[232:235]
v_mfma_f32_16x16x32_bf16 a[240:243], a[28:31], a[132:135], 0
v_mfma_f32_16x16x32_bf16 a[240:243], a[24:27], a[128:131], a[240:243]
buffer_load_dwordx4 v11, s[12:15], s58 offen offset:3072 lds
v_mfma_f32_16x16x32_bf16 v[112:115], a[32:35], a[128:131], 0
v_mfma_f32_16x16x32_bf16 v[112:115], a[36:39], a[132:135], v[112:115]
v_mfma_f32_16x16x32_bf16 v[120:123], a[44:47], a[132:135], 0
v_mfma_f32_16x16x32_bf16 v[120:123], a[40:43], a[128:131], v[120:123]
v_mfma_f32_16x16x32_bf16 a[236:239], a[48:51], a[128:131], 0
s_add_u32 m0, s56, 4096
s_add_u32 s58, s58, 32768
v_mfma_f32_16x16x32_bf16 a[236:239], a[52:55], a[132:135], a[236:239]
buffer_load_dwordx4 v8, s[12:15], s58 offen offset:0 lds
v_mfma_f32_16x16x32_bf16 a[244:247], a[60:63], a[132:135], 0
v_mfma_f32_16x16x32_bf16 a[244:247], a[56:59], a[128:131], a[244:247]
s_waitcnt lgkmcnt(0)
v_mfma_f32_16x16x32_bf16 v[176:179], a[56:59], a[136:139], 0
ds_read_b64_tr_b16 a[128:129], v6 offset:16384
ds_read_b64_tr_b16 a[130:131], v6 offset:17408
v_mfma_f32_16x16x32_bf16 v[176:179], a[60:63], a[140:143], v[176:179]
ds_read_b64_tr_b16 a[132:133], v6 offset:24576
ds_read_b64_tr_b16 a[134:135], v6 offset:25600
v_mfma_f32_16x16x32_bf16 a[252:255], a[52:55], a[140:143], 0
buffer_load_dwordx4 v9, s[12:15], s58 offen offset:1024 lds
v_mfma_f32_16x16x32_bf16 a[252:255], a[48:51], a[136:139], a[252:255]
v_mfma_f32_16x16x32_bf16 v[136:139], a[40:43], a[136:139], 0
v_mfma_f32_16x16x32_bf16 v[136:139], a[44:47], a[140:143], v[136:139]
v_mfma_f32_16x16x32_bf16 v[128:131], a[36:39], a[140:143], 0
buffer_load_dwordx4 v10, s[12:15], s58 offen offset:2048 lds
v_mfma_f32_16x16x32_bf16 v[128:131], a[32:35], a[136:139], v[128:131]
v_mfma_f32_16x16x32_bf16 v[172:175], a[24:27], a[136:139], 0
v_mfma_f32_16x16x32_bf16 v[172:175], a[28:31], a[140:143], v[172:175]
v_mfma_f32_16x16x32_bf16 a[248:251], a[20:23], a[140:143], 0
v_mfma_f32_16x16x32_bf16 a[248:251], a[16:19], a[136:139], a[248:251]
buffer_load_dwordx4 v11, s[12:15], s58 offen offset:3072 lds
v_mfma_f32_16x16x32_bf16 v[132:135], a[8:11], a[136:139], 0
v_mfma_f32_16x16x32_bf16 v[132:135], a[12:15], a[140:143], v[132:135]
v_mfma_f32_16x16x32_bf16 v[124:127], a[4:7], a[140:143], 0
v_mfma_f32_16x16x32_bf16 v[124:127], a[0:3], a[136:139], v[124:127]
s_waitcnt lgkmcnt(0)
v_mfma_f32_16x16x32_bf16 v[140:143], a[0:3], a[128:131], 0
s_add_u32 m0, s57, 0
ds_read_b64_tr_b16 a[136:137], v7 offset:16384
ds_read_b64_tr_b16 a[138:139], v7 offset:17408
v_mfma_f32_16x16x32_bf16 v[140:143], a[4:7], a[132:135], v[140:143]
s_add_u32 s59, s101, 2
ds_read_b64_tr_b16 a[140:141], v7 offset:24576
ds_read_b64_tr_b16 a[142:143], v7 offset:25600
v_mfma_f32_16x16x32_bf16 v[148:151], a[12:15], a[132:135], 0
s_and_b32 s59, s59, 7
s_xor_b32 s59, s59, s100
s_lshl_b32 s59, s59, 19
v_mfma_f32_16x16x32_bf16 v[148:151], a[8:11], a[128:131], v[148:151]
buffer_load_dwordx4 v12, s[20:23], s59 offen offset:0 lds
v_mfma_f32_16x16x32_bf16 v[180:183], a[16:19], a[128:131], 0
v_mfma_f32_16x16x32_bf16 v[180:183], a[20:23], a[132:135], v[180:183]
buffer_load_dwordx4 v13, s[20:23], s59 offen offset:1024 lds
v_mfma_f32_16x16x32_bf16 v[188:191], a[28:31], a[132:135], 0
v_mfma_f32_16x16x32_bf16 v[188:191], a[24:27], a[128:131], v[188:191]
v_mfma_f32_16x16x32_bf16 v[144:147], a[32:35], a[128:131], 0
v_mfma_f32_16x16x32_bf16 v[144:147], a[36:39], a[132:135], v[144:147]
v_mfma_f32_16x16x32_bf16 v[152:155], a[44:47], a[132:135], 0
buffer_load_dwordx4 v14, s[20:23], s59 offen offset:2048 lds
v_mfma_f32_16x16x32_bf16 v[152:155], a[40:43], a[128:131], v[152:155]
v_mfma_f32_16x16x32_bf16 v[184:187], a[48:51], a[128:131], 0
v_mfma_f32_16x16x32_bf16 v[184:187], a[52:55], a[132:135], v[184:187]
v_mfma_f32_16x16x32_bf16 v[192:195], a[60:63], a[132:135], 0
v_mfma_f32_16x16x32_bf16 v[192:195], a[56:59], a[128:131], v[192:195]
s_waitcnt lgkmcnt(0)
buffer_load_dwordx4 v15, s[20:23], s59 offen offset:3072 lds
v_mfma_f32_16x16x32_bf16 v[208:211], a[56:59], a[136:139], 0
s_waitcnt vmcnt(17) lgkmcnt(0)
s_barrier
ds_read_b64_tr_b16 a[128:129], v4 offset:32768
v_mfma_f32_16x16x32_bf16 v[208:211], a[60:63], a[140:143], v[208:211]
ds_read_b64_tr_b16 a[130:131], v4 offset:33792
ds_read_b64_tr_b16 a[132:133], v4 offset:40960
v_mfma_f32_16x16x32_bf16 v[200:203], a[52:55], a[140:143], 0
ds_read_b64_tr_b16 a[134:135], v4 offset:41984
ds_read_b128 a[64:67], v2 offset:32768
v_mfma_f32_16x16x32_bf16 v[200:203], a[48:51], a[136:139], v[200:203]
ds_read_b128 a[68:71], v3 offset:32768
ds_read_b128 a[72:75], v2 offset:34816
v_mfma_f32_16x16x32_bf16 v[168:171], a[40:43], a[136:139], 0
ds_read_b128 a[76:79], v3 offset:34816
ds_read_b128 a[80:83], v2 offset:36864
v_mfma_f32_16x16x32_bf16 v[168:171], a[44:47], a[140:143], v[168:171]
ds_read_b128 a[84:87], v3 offset:36864
ds_read_b128 a[88:91], v2 offset:38912
v_mfma_f32_16x16x32_bf16 v[160:163], a[36:39], a[140:143], 0
buffer_load_dwordx4 v[212:215], v252, s[8:11], 0 offen
v_mfma_f32_16x16x32_bf16 v[160:163], a[32:35], a[136:139], v[160:163]
ds_read_b128 a[92:95], v3 offset:38912
ds_read_b128 a[96:99], v2 offset:40960
v_mfma_f32_16x16x32_bf16 v[204:207], a[24:27], a[136:139], 0
ds_read_b128 a[100:103], v3 offset:40960
ds_read_b128 a[104:107], v2 offset:43008
v_mfma_f32_16x16x32_bf16 v[204:207], a[28:31], a[140:143], v[204:207]
ds_read_b128 a[108:111], v3 offset:43008
ds_read_b128 a[112:115], v2 offset:45056
v_mfma_f32_16x16x32_bf16 v[196:199], a[20:23], a[140:143], 0
buffer_load_dwordx4 v[216:219], v252, s[8:11], 0 offen offset:128
v_mfma_f32_16x16x32_bf16 v[196:199], a[16:19], a[136:139], v[196:199]
ds_read_b128 a[116:119], v3 offset:45056
ds_read_b128 a[120:123], v2 offset:47104
v_mfma_f32_16x16x32_bf16 v[164:167], a[8:11], a[136:139], 0
ds_read_b128 a[124:127], v3 offset:47104
v_mfma_f32_16x16x32_bf16 v[164:167], a[12:15], a[140:143], v[164:167]
v_mfma_f32_16x16x32_bf16 v[156:159], a[4:7], a[140:143], 0
buffer_load_dwordx4 v[220:223], v253, s[8:11], 0 offen
v_mfma_f32_16x16x32_bf16 v[156:159], a[0:3], a[136:139], v[156:159]
s_waitcnt lgkmcnt(9)
v_mfma_f32_16x16x32_bf16 v[44:47], a[128:131], a[64:67], v[44:47]
ds_read_b64_tr_b16 a[136:137], v5 offset:32768
ds_read_b64_tr_b16 a[138:139], v5 offset:33792
v_mfma_f32_16x16x32_bf16 v[44:47], a[132:135], a[68:71], v[44:47]
ds_read_b64_tr_b16 a[140:141], v5 offset:40960
ds_read_b64_tr_b16 a[142:143], v5 offset:41984
v_mfma_f32_16x16x32_bf16 v[48:51], a[132:135], a[76:79], v[48:51]
v_mfma_f32_16x16x32_bf16 v[48:51], a[128:131], a[72:75], v[48:51]
s_add_u32 m0, s57, 16384
s_add_u32 s59, s101, 2
s_and_b32 s59, s59, 7
v_mfma_f32_16x16x32_bf16 v[52:55], a[128:131], a[80:83], v[52:55]
s_xor_b32 s59, s59, s100
s_lshl_b32 s59, s59, 19
v_mfma_f32_16x16x32_bf16 v[52:55], a[132:135], a[84:87], v[52:55]
s_waitcnt lgkmcnt(4)
buffer_load_dwordx4 v12, s[24:27], s59 offen offset:0 lds
v_mfma_f32_16x16x32_bf16 v[56:59], a[132:135], a[92:95], v[56:59]
v_mfma_f32_16x16x32_bf16 v[56:59], a[128:131], a[88:91], v[56:59]
v_mfma_f32_16x16x32_bf16 v[60:63], a[128:131], a[96:99], v[60:63]
buffer_load_dwordx4 v13, s[24:27], s59 offen offset:1024 lds
v_mfma_f32_16x16x32_bf16 v[60:63], a[132:135], a[100:103], v[60:63]
v_mfma_f32_16x16x32_bf16 v[64:67], a[132:135], a[108:111], v[64:67]
v_mfma_f32_16x16x32_bf16 v[64:67], a[128:131], a[104:107], v[64:67]
v_mfma_f32_16x16x32_bf16 v[68:71], a[128:131], a[112:115], v[68:71]
v_mfma_f32_16x16x32_bf16 v[68:71], a[132:135], a[116:119], v[68:71]
buffer_load_dwordx4 v14, s[24:27], s59 offen offset:2048 lds
v_mfma_f32_16x16x32_bf16 v[72:75], a[132:135], a[124:127], v[72:75]
v_mfma_f32_16x16x32_bf16 v[72:75], a[128:131], a[120:123], v[72:75]
s_waitcnt lgkmcnt(0)
v_mfma_f32_16x16x32_bf16 a[172:175], a[136:139], a[120:123], a[172:175]
ds_read_b64_tr_b16 a[128:129], v6 offset:32768
ds_read_b64_tr_b16 a[130:131], v6 offset:33792
v_mfma_f32_16x16x32_bf16 a[172:175], a[140:143], a[124:127], a[172:175]
ds_read_b64_tr_b16 a[132:133], v6 offset:40960
ds_read_b64_tr_b16 a[134:135], v6 offset:41984
v_mfma_f32_16x16x32_bf16 a[168:171], a[140:143], a[116:119], a[168:171]
buffer_load_dwordx4 v15, s[24:27], s59 offen offset:3072 lds
v_mfma_f32_16x16x32_bf16 a[168:171], a[136:139], a[112:115], a[168:171]
v_mfma_f32_16x16x32_bf16 a[164:167], a[136:139], a[104:107], a[164:167]
v_mfma_f32_16x16x32_bf16 a[164:167], a[140:143], a[108:111], a[164:167]
v_mfma_f32_16x16x32_bf16 a[160:163], a[140:143], a[100:103], a[160:163]
v_mfma_f32_16x16x32_bf16 a[160:163], a[136:139], a[96:99], a[160:163]
v_mfma_f32_16x16x32_bf16 a[156:159], a[136:139], a[88:91], a[156:159]
v_mfma_f32_16x16x32_bf16 a[156:159], a[140:143], a[92:95], a[156:159]
v_mfma_f32_16x16x32_bf16 a[152:155], a[140:143], a[84:87], a[152:155]
v_mfma_f32_16x16x32_bf16 a[152:155], a[136:139], a[80:83], a[152:155]
v_mfma_f32_16x16x32_bf16 a[148:151], a[136:139], a[72:75], a[148:151]
v_mfma_f32_16x16x32_bf16 a[148:151], a[140:143], a[76:79], a[148:151]
v_mfma_f32_16x16x32_bf16 a[144:147], a[140:143], a[68:71], a[144:147]
v_mfma_f32_16x16x32_bf16 a[144:147], a[136:139], a[64:67], a[144:147]
s_waitcnt lgkmcnt(0)
v_mfma_f32_16x16x32_bf16 v[76:79], a[128:131], a[64:67], v[76:79]
ds_read_b64_tr_b16 a[136:137], v7 offset:32768
ds_read_b64_tr_b16 a[138:139], v7 offset:33792
v_mfma_f32_16x16x32_bf16 v[76:79], a[132:135], a[68:71], v[76:79]
ds_read_b64_tr_b16 a[140:141], v7 offset:40960
ds_read_b64_tr_b16 a[142:143], v7 offset:41984
v_mfma_f32_16x16x32_bf16 v[80:83], a[132:135], a[76:79], v[80:83]
v_mfma_f32_16x16x32_bf16 v[80:83], a[128:131], a[72:75], v[80:83]
v_mfma_f32_16x16x32_bf16 v[84:87], a[128:131], a[80:83], v[84:87]
v_mfma_f32_16x16x32_bf16 v[84:87], a[132:135], a[84:87], v[84:87]
v_mfma_f32_16x16x32_bf16 v[88:91], a[132:135], a[92:95], v[88:91]
v_mfma_f32_16x16x32_bf16 v[88:91], a[128:131], a[88:91], v[88:91]
v_mfma_f32_16x16x32_bf16 v[92:95], a[128:131], a[96:99], v[92:95]
v_mfma_f32_16x16x32_bf16 v[92:95], a[132:135], a[100:103], v[92:95]
v_mfma_f32_16x16x32_bf16 v[96:99], a[132:135], a[108:111], v[96:99]
v_mfma_f32_16x16x32_bf16 v[96:99], a[128:131], a[104:107], v[96:99]
v_mfma_f32_16x16x32_bf16 v[100:103], a[128:131], a[112:115], v[100:103]
v_mfma_f32_16x16x32_bf16 v[100:103], a[132:135], a[116:119], v[100:103]
v_mfma_f32_16x16x32_bf16 v[104:107], a[132:135], a[124:127], v[104:107]
v_mfma_f32_16x16x32_bf16 v[104:107], a[128:131], a[120:123], v[104:107]
s_waitcnt lgkmcnt(0)
v_mfma_f32_16x16x32_bf16 a[228:231], a[136:139], a[120:123], a[228:231]
s_waitcnt vmcnt(11) lgkmcnt(0)
s_barrier
ds_read_b64_tr_b16 a[128:129], v4 offset:49152
v_mfma_f32_16x16x32_bf16 a[228:231], a[140:143], a[124:127], a[228:231]
ds_read_b64_tr_b16 a[130:131], v4 offset:50176
ds_read_b64_tr_b16 a[132:133], v4 offset:57344
v_mfma_f32_16x16x32_bf16 a[224:227], a[140:143], a[116:119], a[224:227]
ds_read_b64_tr_b16 a[134:135], v4 offset:58368
s_waitcnt vmcnt(6)
v_lshlrev_b32 v224, 16, v212
v_mfma_f32_16x16x32_bf16 a[224:227], a[136:139], a[112:115], a[224:227]
s_add_u32 m0, s56, 32768
s_add_u32 s58, s101, 3
s_and_b32 s58, s58, 7
v_mfma_f32_16x16x32_bf16 a[220:223], a[136:139], a[104:107], a[220:223]
s_xor_b32 s58, s58, s100
s_lshl_b32 s58, s58, 7
ds_read_b128 a[0:3], v2 offset:0
v_mfma_f32_16x16x32_bf16 a[220:223], a[140:143], a[108:111], a[220:223]
buffer_load_dwordx4 v8, s[12:15], s58 offen offset:0 lds
v_mfma_f32_16x16x32_bf16 a[216:219], a[140:143], a[100:103], a[216:219]
v_and_b32 v225, 0xffff0000, v212
v_lshlrev_b32 v226, 16, v213
v_mfma_f32_16x16x32_bf16 a[216:219], a[136:139], a[96:99], a[216:219]
ds_read_b128 a[4:7], v3 offset:0
v_and_b32 v227, 0xffff0000, v213
v_mfma_f32_16x16x32_bf16 a[188:191], a[136:139], a[88:91], a[188:191]
buffer_load_dwordx4 v9, s[12:15], s58 offen offset:1024 lds
v_mfma_f32_16x16x32_bf16 a[188:191], a[140:143], a[92:95], a[188:191]
v_lshlrev_b32 v228, 16, v214
v_and_b32 v229, 0xffff0000, v214
v_mfma_f32_16x16x32_bf16 a[184:187], a[140:143], a[84:87], a[184:187]
ds_read_b128 a[8:11], v2 offset:2048
v_lshlrev_b32 v230, 16, v215
v_mfma_f32_16x16x32_bf16 a[184:187], a[136:139], a[80:83], a[184:187]
v_and_b32 v231, 0xffff0000, v215
s_waitcnt vmcnt(7)
v_lshlrev_b32 v232, 16, v216
v_mfma_f32_16x16x32_bf16 a[180:183], a[136:139], a[72:75], a[180:183]
v_and_b32 v233, 0xffff0000, v216
v_lshlrev_b32 v234, 16, v217
v_mfma_f32_16x16x32_bf16 a[180:183], a[140:143], a[76:79], a[180:183]
ds_read_b128 a[12:15], v3 offset:2048
v_and_b32 v235, 0xffff0000, v217
v_mfma_f32_16x16x32_bf16 a[176:179], a[140:143], a[68:71], a[176:179]
buffer_load_dwordx4 v10, s[12:15], s58 offen offset:2048 lds
v_mfma_f32_16x16x32_bf16 a[176:179], a[136:139], a[64:67], a[176:179]
s_waitcnt lgkmcnt(3)
v_lshlrev_b32 v236, 16, v218
v_and_b32 v237, 0xffff0000, v218
v_mfma_f32_16x16x32_bf16 v[108:111], a[64:67], a[128:131], v[108:111]
ds_read_b64_tr_b16 a[136:137], v5 offset:49152
ds_read_b64_tr_b16 a[138:139], v5 offset:50176
v_mfma_f32_16x16x32_bf16 v[108:111], a[68:71], a[132:135], v[108:111]
ds_read_b64_tr_b16 a[140:141], v5 offset:57344
ds_read_b64_tr_b16 a[142:143], v5 offset:58368
v_mfma_f32_16x16x32_bf16 v[116:119], a[76:79], a[132:135], v[116:119]
ds_read_b128 a[16:19], v2 offset:4096
v_lshlrev_b32 v238, 16, v219
v_mfma_f32_16x16x32_bf16 v[116:119], a[72:75], a[128:131], v[116:119]
ds_read_b128 a[20:23], v3 offset:4096
v_and_b32 v239, 0xffff0000, v219
v_mfma_f32_16x16x32_bf16 a[232:235], a[80:83], a[128:131], a[232:235]
buffer_load_dwordx4 v11, s[12:15], s58 offen offset:3072 lds
v_mfma_f32_16x16x32_bf16 a[232:235], a[84:87], a[132:135], a[232:235]
s_waitcnt vmcnt(8)
v_lshlrev_b32 v240, 16, v220
v_and_b32 v241, 0xffff0000, v220
v_mfma_f32_16x16x32_bf16 a[240:243], a[92:95], a[132:135], a[240:243]
ds_read_b128 a[24:27], v2 offset:6144
v_lshlrev_b32 v242, 16, v221
v_mfma_f32_16x16x32_bf16 a[240:243], a[88:91], a[128:131], a[240:243]
s_add_u32 m0, s56, 36864
s_add_u32 s58, s58, 32768
v_and_b32 v243, 0xffff0000, v221
v_mfma_f32_16x16x32_bf16 v[112:115], a[96:99], a[128:131], v[112:115]
buffer_load_dwordx4 v8, s[12:15], s58 offen offset:0 lds
v_mfma_f32_16x16x32_bf16 v[112:115], a[100:103], a[132:135], v[112:115]
ds_read_b128 a[28:31], v3 offset:6144
v_lshlrev_b32 v244, 16, v222
v_mfma_f32_16x16x32_bf16 v[120:123], a[108:111], a[132:135], v[120:123]
v_and_b32 v245, 0xffff0000, v222
v_lshlrev_b32 v246, 16, v223
v_mfma_f32_16x16x32_bf16 v[120:123], a[104:107], a[128:131], v[120:123]
v_and_b32 v247, 0xffff0000, v223
v_add_f32 v248, v224, v225
v_mfma_f32_16x16x32_bf16 a[236:239], a[112:115], a[128:131], a[236:239]
ds_read_b128 a[32:35], v2 offset:8192
v_mul_f32 v249, v224, v224
v_mfma_f32_16x16x32_bf16 a[236:239], a[116:119], a[132:135], a[236:239]
buffer_load_dwordx4 v9, s[12:15], s58 offen offset:1024 lds
v_mfma_f32_16x16x32_bf16 a[244:247], a[124:127], a[132:135], a[244:247]
v_add_f32 v250, v226, v227
v_mul_f32 v251, v225, v225
v_mfma_f32_16x16x32_bf16 a[244:247], a[120:123], a[128:131], a[244:247]
s_waitcnt lgkmcnt(2)
ds_read_b128 a[36:39], v3 offset:8192
v_fmac_f32 v249, v226, v226
v_mfma_f32_16x16x32_bf16 v[176:179], a[120:123], a[136:139], v[176:179]
ds_read_b64_tr_b16 a[128:129], v6 offset:49152
ds_read_b64_tr_b16 a[130:131], v6 offset:50176
v_mfma_f32_16x16x32_bf16 v[176:179], a[124:127], a[140:143], v[176:179]
ds_read_b64_tr_b16 a[132:133], v6 offset:57344
ds_read_b64_tr_b16 a[134:135], v6 offset:58368
v_mfma_f32_16x16x32_bf16 a[252:255], a[116:119], a[140:143], a[252:255]
ds_read_b128 a[40:43], v2 offset:10240
v_fmac_f32 v251, v227, v227
v_mfma_f32_16x16x32_bf16 a[252:255], a[112:115], a[136:139], a[252:255]
buffer_load_dwordx4 v10, s[12:15], s58 offen offset:2048 lds
v_mfma_f32_16x16x32_bf16 v[136:139], a[104:107], a[136:139], v[136:139]
v_add_f32 v248, v248, v228
v_fmac_f32 v249, v228, v228
v_mfma_f32_16x16x32_bf16 v[136:139], a[108:111], a[140:143], v[136:139]
ds_read_b128 a[44:47], v3 offset:10240
v_add_f32 v250, v250, v229
v_mfma_f32_16x16x32_bf16 v[128:131], a[100:103], a[140:143], v[128:131]
buffer_load_dwordx4 v11, s[12:15], s58 offen offset:3072 lds
v_mfma_f32_16x16x32_bf16 v[128:131], a[96:99], a[136:139], v[128:131]
v_fmac_f32 v251, v229, v229
v_add_f32 v248, v248, v230
v_mfma_f32_16x16x32_bf16 v[172:175], a[88:91], a[136:139], v[172:175]
ds_read_b128 a[48:51], v2 offset:12288
v_fmac_f32 v249, v230, v230
v_mfma_f32_16x16x32_bf16 v[172:175], a[92:95], a[140:143], v[172:175]
v_add_f32 v250, v250, v231
v_fmac_f32 v251, v231, v231
v_mfma_f32_16x16x32_bf16 a[248:251], a[84:87], a[140:143], a[248:251]
v_add_f32 v248, v248, v232
v_fmac_f32 v249, v232, v232
v_mfma_f32_16x16x32_bf16 a[248:251], a[80:83], a[136:139], a[248:251]
s_add_u32 m0, s57, 32768
s_add_u32 s59, s101, 3
ds_read_b128 a[52:55], v3 offset:12288
v_mfma_f32_16x16x32_bf16 v[132:135], a[72:75], a[136:139], v[132:135]
s_and_b32 s59, s59, 7
s_xor_b32 s59, s59, s100
s_lshl_b32 s59, s59, 19
v_mfma_f32_16x16x32_bf16 v[132:135], a[76:79], a[140:143], v[132:135]
buffer_load_dwordx4 v12, s[20:23], s59 offen offset:0 lds
v_mfma_f32_16x16x32_bf16 v[124:127], a[68:71], a[140:143], v[124:127]
ds_read_b128 a[56:59], v2 offset:14336
v_add_f32 v250, v250, v233
v_mfma_f32_16x16x32_bf16 v[124:127], a[64:67], a[136:139], v[124:127]
s_waitcnt lgkmcnt(3)
v_fmac_f32 v251, v233, v233
v_add_f32 v248, v248, v234
v_mfma_f32_16x16x32_bf16 v[140:143], a[64:67], a[128:131], v[140:143]
ds_read_b64_tr_b16 a[136:137], v7 offset:49152
ds_read_b64_tr_b16 a[138:139], v7 offset:50176
v_mfma_f32_16x16x32_bf16 v[140:143], a[68:71], a[132:135], v[140:143]
ds_read_b64_tr_b16 a[140:141], v7 offset:57344
ds_read_b64_tr_b16 a[142:143], v7 offset:58368
v_mfma_f32_16x16x32_bf16 v[148:151], a[76:79], a[132:135], v[148:151]
ds_read_b128 a[60:63], v3 offset:14336
v_fmac_f32 v249, v234, v234
v_mfma_f32_16x16x32_bf16 v[148:151], a[72:75], a[128:131], v[148:151]
buffer_load_dwordx4 v13, s[20:23], s59 offen offset:1024 lds
v_mfma_f32_16x16x32_bf16 v[180:183], a[80:83], a[128:131], v[180:183]
v_add_f32 v250, v250, v235
v_fmac_f32 v251, v235, v235
v_mfma_f32_16x16x32_bf16 v[180:183], a[84:87], a[132:135], v[180:183]
buffer_load_dwordx4 v14, s[20:23], s59 offen offset:2048 lds
v_mfma_f32_16x16x32_bf16 v[188:191], a[92:95], a[132:135], v[188:191]
v_add_f32 v248, v248, v236
v_fmac_f32 v249, v236, v236
v_mfma_f32_16x16x32_bf16 v[188:191], a[88:91], a[128:131], v[188:191]
v_add_f32 v250, v250, v237
v_fmac_f32 v251, v237, v237
v_mfma_f32_16x16x32_bf16 v[144:147], a[96:99], a[128:131], v[144:147]
v_add_f32 v248, v248, v238
v_fmac_f32 v249, v238, v238
v_mfma_f32_16x16x32_bf16 v[144:147], a[100:103], a[132:135], v[144:147]
v_add_f32 v250, v250, v239
v_fmac_f32 v251, v239, v239
v_mfma_f32_16x16x32_bf16 v[152:155], a[108:111], a[132:135], v[152:155]
buffer_load_dwordx4 v15, s[20:23], s59 offen offset:3072 lds
v_mfma_f32_16x16x32_bf16 v[152:155], a[104:107], a[128:131], v[152:155]
v_add_f32 v248, v248, v240
v_fmac_f32 v249, v240, v240
v_mfma_f32_16x16x32_bf16 v[184:187], a[112:115], a[128:131], v[184:187]
v_add_f32 v250, v250, v241
v_fmac_f32 v251, v241, v241
v_mfma_f32_16x16x32_bf16 v[184:187], a[116:119], a[132:135], v[184:187]
v_add_f32 v248, v248, v242
v_fmac_f32 v249, v242, v242
v_mfma_f32_16x16x32_bf16 v[192:195], a[124:127], a[132:135], v[192:195]
v_add_f32 v250, v250, v243
v_fmac_f32 v251, v243, v243
v_mfma_f32_16x16x32_bf16 v[192:195], a[120:123], a[128:131], v[192:195]
s_waitcnt lgkmcnt(0)
v_add_f32 v248, v248, v244
v_fmac_f32 v249, v244, v244
v_mfma_f32_16x16x32_bf16 v[208:211], a[120:123], a[136:139], v[208:211]
s_waitcnt vmcnt(63) lgkmcnt(0)
s_barrier
ds_read_b64_tr_b16 a[128:129], v4 offset:0
v_mfma_f32_16x16x32_bf16 v[208:211], a[124:127], a[140:143], v[208:211]
ds_read_b64_tr_b16 a[130:131], v4 offset:1024
ds_read_b64_tr_b16 a[132:133], v4 offset:8192
v_mfma_f32_16x16x32_bf16 v[200:203], a[116:119], a[140:143], v[200:203]
ds_read_b64_tr_b16 a[134:135], v4 offset:9216
v_add_f32 v250, v250, v245
v_mfma_f32_16x16x32_bf16 v[200:203], a[112:115], a[136:139], v[200:203]
s_add_u32 m0, s57, 49152
s_add_u32 s59, s101, 3
s_and_b32 s59, s59, 7
v_mfma_f32_16x16x32_bf16 v[168:171], a[104:107], a[136:139], v[168:171]
s_xor_b32 s59, s59, s100
s_lshl_b32 s59, s59, 19
v_fmac_f32 v251, v245, v245
v_mfma_f32_16x16x32_bf16 v[168:171], a[108:111], a[140:143], v[168:171]
buffer_load_dwordx4 v12, s[24:27], s59 offen offset:0 lds
v_mfma_f32_16x16x32_bf16 v[160:163], a[100:103], a[140:143], v[160:163]
v_add_f32 v248, v248, v246
v_fmac_f32 v249, v246, v246
v_mfma_f32_16x16x32_bf16 v[160:163], a[96:99], a[136:139], v[160:163]
v_add_f32 v250, v250, v247
v_fmac_f32 v251, v247, v247
v_mfma_f32_16x16x32_bf16 v[204:207], a[88:91], a[136:139], v[204:207]
buffer_load_dwordx4 v13, s[24:27], s59 offen offset:1024 lds
v_mfma_f32_16x16x32_bf16 v[204:207], a[92:95], a[140:143], v[204:207]
s_lshl_b32 s51, s48, 6
v_add_f32 v248, v248, v250
v_add_f32 v249, v249, v251
v_mfma_f32_16x16x32_bf16 v[196:199], a[84:87], a[140:143], v[196:199]
s_add_u32 s51, s51, 131072
v_and_b32 v212, 7, v0
v_lshlrev_b32 v212, 3, v212
v_mfma_f32_16x16x32_bf16 v[196:199], a[80:83], a[136:139], v[196:199]
v_add_f32_dpp v248, v248, v248 row_ror:8 row_mask:0xf bank_mask:0xf
v_add_f32_dpp v249, v249, v249 row_ror:8 row_mask:0xf bank_mask:0xf
v_mfma_f32_16x16x32_bf16 v[164:167], a[72:75], a[136:139], v[164:167]
v_mov_b32 v250, v248
v_mov_b32 v251, v249
v_mfma_f32_16x16x32_bf16 v[164:167], a[76:79], a[140:143], v[164:167]
buffer_load_dwordx4 v14, s[24:27], s59 offen offset:2048 lds
v_mfma_f32_16x16x32_bf16 v[156:159], a[68:71], a[140:143], v[156:159]
v_add_u32 v213, s51, v212
v_add_u32 v212, 131072, v212
v_mfma_f32_16x16x32_bf16 v[156:159], a[64:67], a[136:139], v[156:159]
v_permlane16_swap_b32 v248, v250
v_permlane16_swap_b32 v249, v251
s_waitcnt lgkmcnt(0)
v_mfma_f32_16x16x32_bf16 v[44:47], a[128:131], a[0:3], v[44:47]
ds_read_b64_tr_b16 a[136:137], v5 offset:0
ds_read_b64_tr_b16 a[138:139], v5 offset:1024
v_mfma_f32_16x16x32_bf16 v[44:47], a[132:135], a[4:7], v[44:47]
ds_read_b64_tr_b16 a[140:141], v5 offset:8192
ds_read_b64_tr_b16 a[142:143], v5 offset:9216
v_mfma_f32_16x16x32_bf16 v[48:51], a[132:135], a[12:15], v[48:51]
buffer_load_dwordx4 v15, s[24:27], s59 offen offset:3072 lds
v_mfma_f32_16x16x32_bf16 v[48:51], a[128:131], a[8:11], v[48:51]
v_add_f32 v248, v248, v250
v_add_f32 v249, v249, v251
v_mfma_f32_16x16x32_bf16 v[52:55], a[128:131], a[16:19], v[52:55]
v_mov_b32 v250, v248
v_mov_b32 v251, v249
v_mfma_f32_16x16x32_bf16 v[52:55], a[132:135], a[20:23], v[52:55]
s_nop 1
v_permlane32_swap_b32 v248, v250
v_mfma_f32_16x16x32_bf16 v[56:59], a[132:135], a[28:31], v[56:59]
v_permlane32_swap_b32 v249, v251
v_add_f32 v248, v248, v250
v_mfma_f32_16x16x32_bf16 v[56:59], a[128:131], a[24:27], v[56:59]
s_add_u32 m0, s56, 0
s_add_u32 s58, s101, 4
s_and_b32 s58, s58, 7
v_mfma_f32_16x16x32_bf16 v[60:63], a[128:131], a[32:35], v[60:63]
s_xor_b32 s58, s58, s100
s_lshl_b32 s58, s58, 7
v_add_f32 v249, v249, v251
v_mfma_f32_16x16x32_bf16 v[60:63], a[132:135], a[36:39], v[60:63]
buffer_load_dwordx4 v8, s[12:15], s58 offen offset:0 lds
v_mfma_f32_16x16x32_bf16 v[64:67], a[132:135], a[44:47], v[64:67]
ds_write_b64 v213, v[248:249]
v_mfma_f32_16x16x32_bf16 v[64:67], a[128:131], a[40:43], v[64:67]
v_mfma_f32_16x16x32_bf16 v[68:71], a[128:131], a[48:51], v[68:71]
buffer_load_dwordx4 v9, s[12:15], s58 offen offset:1024 lds
v_mfma_f32_16x16x32_bf16 v[68:71], a[132:135], a[52:55], v[68:71]
v_mfma_f32_16x16x32_bf16 v[72:75], a[132:135], a[60:63], v[72:75]
v_mfma_f32_16x16x32_bf16 v[72:75], a[128:131], a[56:59], v[72:75]
s_waitcnt lgkmcnt(1)
v_mfma_f32_16x16x32_bf16 a[172:175], a[136:139], a[56:59], a[172:175]
ds_read_b64_tr_b16 a[128:129], v6 offset:0
ds_read_b64_tr_b16 a[130:131], v6 offset:1024
v_mfma_f32_16x16x32_bf16 a[172:175], a[140:143], a[60:63], a[172:175]
ds_read_b64_tr_b16 a[132:133], v6 offset:8192
ds_read_b64_tr_b16 a[134:135], v6 offset:9216
v_mfma_f32_16x16x32_bf16 a[168:171], a[140:143], a[52:55], a[168:171]
buffer_load_dwordx4 v10, s[12:15], s58 offen offset:2048 lds
v_mfma_f32_16x16x32_bf16 a[168:171], a[136:139], a[48:51], a[168:171]
v_mfma_f32_16x16x32_bf16 a[164:167], a[136:139], a[40:43], a[164:167]
v_mfma_f32_16x16x32_bf16 a[164:167], a[140:143], a[44:47], a[164:167]
v_mfma_f32_16x16x32_bf16 a[160:163], a[140:143], a[36:39], a[160:163]
buffer_load_dwordx4 v11, s[12:15], s58 offen offset:3072 lds
v_mfma_f32_16x16x32_bf16 a[160:163], a[136:139], a[32:35], a[160:163]
v_mfma_f32_16x16x32_bf16 a[156:159], a[136:139], a[24:27], a[156:159]
v_mfma_f32_16x16x32_bf16 a[156:159], a[140:143], a[28:31], a[156:159]
v_mfma_f32_16x16x32_bf16 a[152:155], a[140:143], a[20:23], a[152:155]
v_mfma_f32_16x16x32_bf16 a[152:155], a[136:139], a[16:19], a[152:155]
s_add_u32 m0, s56, 4096
s_add_u32 s58, s58, 32768
v_mfma_f32_16x16x32_bf16 a[148:151], a[136:139], a[8:11], a[148:151]
buffer_load_dwordx4 v8, s[12:15], s58 offen offset:0 lds
v_mfma_f32_16x16x32_bf16 a[148:151], a[140:143], a[12:15], a[148:151]
v_mfma_f32_16x16x32_bf16 a[144:147], a[140:143], a[4:7], a[144:147]
v_mfma_f32_16x16x32_bf16 a[144:147], a[136:139], a[0:3], a[144:147]
s_waitcnt lgkmcnt(0)
v_mfma_f32_16x16x32_bf16 v[76:79], a[128:131], a[0:3], v[76:79]
ds_read_b64_tr_b16 a[136:137], v7 offset:0
ds_read_b64_tr_b16 a[138:139], v7 offset:1024
v_mfma_f32_16x16x32_bf16 v[76:79], a[132:135], a[4:7], v[76:79]
ds_read_b64_tr_b16 a[140:141], v7 offset:8192
ds_read_b64_tr_b16 a[142:143], v7 offset:9216
v_mfma_f32_16x16x32_bf16 v[80:83], a[132:135], a[12:15], v[80:83]
buffer_load_dwordx4 v9, s[12:15], s58 offen offset:1024 lds
v_mfma_f32_16x16x32_bf16 v[80:83], a[128:131], a[8:11], v[80:83]
v_mfma_f32_16x16x32_bf16 v[84:87], a[128:131], a[16:19], v[84:87]
v_mfma_f32_16x16x32_bf16 v[84:87], a[132:135], a[20:23], v[84:87]
buffer_load_dwordx4 v10, s[12:15], s58 offen offset:2048 lds
v_mfma_f32_16x16x32_bf16 v[88:91], a[132:135], a[28:31], v[88:91]
v_mfma_f32_16x16x32_bf16 v[88:91], a[128:131], a[24:27], v[88:91]
v_mfma_f32_16x16x32_bf16 v[92:95], a[128:131], a[32:35], v[92:95]
v_mfma_f32_16x16x32_bf16 v[92:95], a[132:135], a[36:39], v[92:95]
v_mfma_f32_16x16x32_bf16 v[96:99], a[132:135], a[44:47], v[96:99]
buffer_load_dwordx4 v11, s[12:15], s58 offen offset:3072 lds
v_mfma_f32_16x16x32_bf16 v[96:99], a[128:131], a[40:43], v[96:99]
v_mfma_f32_16x16x32_bf16 v[100:103], a[128:131], a[48:51], v[100:103]
v_mfma_f32_16x16x32_bf16 v[100:103], a[132:135], a[52:55], v[100:103]
v_mfma_f32_16x16x32_bf16 v[104:107], a[132:135], a[60:63], v[104:107]
v_mfma_f32_16x16x32_bf16 v[104:107], a[128:131], a[56:59], v[104:107]
s_waitcnt lgkmcnt(0)
s_mov_b32 s88, 0
buffer_load_dword v255, v34, s[16:19], s88 offen
v_mfma_f32_16x16x32_bf16 a[228:231], a[136:139], a[56:59], a[228:231]
s_waitcnt vmcnt(17) lgkmcnt(0)
s_barrier
ds_read_b64_tr_b16 a[128:129], v4 offset:16384
v_mfma_f32_16x16x32_bf16 a[228:231], a[140:143], a[60:63], a[228:231]
ds_read_b64_tr_b16 a[130:131], v4 offset:17408
ds_read_b64_tr_b16 a[132:133], v4 offset:24576
v_mfma_f32_16x16x32_bf16 a[224:227], a[140:143], a[52:55], a[224:227]
ds_read_b64_tr_b16 a[134:135], v4 offset:25600
ds_read_b64 v[214:215], v212 offset:0
v_mfma_f32_16x16x32_bf16 a[224:227], a[136:139], a[48:51], a[224:227]
ds_read_b64 v[216:217], v212 offset:64
ds_read_b64 v[218:219], v212 offset:128
v_mfma_f32_16x16x32_bf16 a[220:223], a[136:139], a[40:43], a[220:223]
s_add_u32 s88, s67, 0
ds_read_b128 a[64:67], v2 offset:32768
ds_read_b64 v[220:221], v212 offset:192
v_mfma_f32_16x16x32_bf16 a[220:223], a[140:143], a[44:47], a[220:223]
buffer_load_dword v255, v35, s[32:35], s88 offen
v_mfma_f32_16x16x32_bf16 a[216:219], a[140:143], a[36:39], a[216:219]
s_waitcnt lgkmcnt(3)
v_add_f32 v214, v214, v216
v_add_f32 v215, v215, v217
v_mfma_f32_16x16x32_bf16 a[216:219], a[136:139], a[32:35], a[216:219]
ds_read_b128 a[68:71], v3 offset:32768
s_waitcnt lgkmcnt(1)
v_add_f32 v218, v218, v220
v_mfma_f32_16x16x32_bf16 a[188:191], a[136:139], a[24:27], a[188:191]
v_add_f32 v219, v219, v221
v_add_f32 v248, v214, v218
v_mfma_f32_16x16x32_bf16 a[188:191], a[140:143], a[28:31], a[188:191]
s_add_u32 m0, s57, 0
s_add_u32 s59, s101, 4
s_and_b32 s59, s59, 7
v_mfma_f32_16x16x32_bf16 a[184:187], a[140:143], a[20:23], a[184:187]
s_xor_b32 s59, s59, s100
s_lshl_b32 s59, s59, 19
ds_read_b128 a[72:75], v2 offset:34816
v_mfma_f32_16x16x32_bf16 a[184:187], a[136:139], a[16:19], a[184:187]
buffer_load_dwordx4 v12, s[20:23], s59 offen offset:0 lds
v_mfma_f32_16x16x32_bf16 a[180:183], a[136:139], a[8:11], a[180:183]
v_add_f32 v249, v215, v219
v_mul_f32 v248, 0x3acccccd, v248
v_mfma_f32_16x16x32_bf16 a[180:183], a[140:143], a[12:15], a[180:183]
ds_read_b128 a[76:79], v3 offset:34816
v_mul_f32 v249, 0x3acccccd, v249
v_mfma_f32_16x16x32_bf16 a[176:179], a[140:143], a[4:7], a[176:179]
buffer_load_dwordx4 v13, s[20:23], s59 offen offset:1024 lds
v_mfma_f32_16x16x32_bf16 a[176:179], a[136:139], a[0:3], a[176:179]
v_fma_f32 v249, -v248, v248, v249
v_max_f32 v249, 0, v249
v_mfma_f32_16x16x32_bf16 v[108:111], a[0:3], a[128:131], v[108:111]
ds_read_b64_tr_b16 a[136:137], v5 offset:16384
ds_read_b64_tr_b16 a[138:139], v5 offset:17408
v_mfma_f32_16x16x32_bf16 v[108:111], a[4:7], a[132:135], v[108:111]
ds_read_b64_tr_b16 a[140:141], v5 offset:24576
ds_read_b64_tr_b16 a[142:143], v5 offset:25600
v_mfma_f32_16x16x32_bf16 v[116:119], a[12:15], a[132:135], v[116:119]
ds_read_b128 a[80:83], v2 offset:36864
v_add_f32 v249, 0x3727c5ac, v249
v_mfma_f32_16x16x32_bf16 v[116:119], a[8:11], a[128:131], v[116:119]
ds_read_b128 a[84:87], v3 offset:36864
v_mfma_f32_16x16x32_bf16 a[232:235], a[16:19], a[128:131], a[232:235]
buffer_load_dwordx4 v14, s[20:23], s59 offen offset:2048 lds
v_mfma_f32_16x16x32_bf16 a[232:235], a[20:23], a[132:135], a[232:235]
v_rsq_f32 v249, v249
v_mfma_f32_16x16x32_bf16 a[240:243], a[28:31], a[132:135], a[240:243]
ds_read_b128 a[88:91], v2 offset:38912
v_mul_f32 v249, 0x3e0293ee, v249
v_mfma_f32_16x16x32_bf16 a[240:243], a[24:27], a[128:131], a[240:243]
v_mul_f32 v248, v248, v249
v_fma_f32 v224, v224, v249, -v248
v_mfma_f32_16x16x32_bf16 v[112:115], a[32:35], a[128:131], v[112:115]
buffer_load_dwordx4 v15, s[20:23], s59 offen offset:3072 lds
v_mfma_f32_16x16x32_bf16 v[112:115], a[36:39], a[132:135], v[112:115]
ds_read_b128 a[92:95], v3 offset:38912
v_fma_f32 v225, v225, v249, -v248
v_mfma_f32_16x16x32_bf16 v[120:123], a[44:47], a[132:135], v[120:123]
v_fma_f32 v226, v226, v249, -v248
v_fma_f32 v227, v227, v249, -v248
v_mfma_f32_16x16x32_bf16 v[120:123], a[40:43], a[128:131], v[120:123]
v_fma_f32 v228, v228, v249, -v248
v_fma_f32 v229, v229, v249, -v248
v_mfma_f32_16x16x32_bf16 a[236:239], a[48:51], a[128:131], a[236:239]
ds_read_b128 a[96:99], v2 offset:40960
v_fma_f32 v230, v230, v249, -v248
v_mfma_f32_16x16x32_bf16 a[236:239], a[52:55], a[132:135], a[236:239]
v_fma_f32 v231, v231, v249, -v248
v_cvt_pk_bf16_f32 v212, v224, v225
v_mfma_f32_16x16x32_bf16 a[244:247], a[60:63], a[132:135], a[244:247]
v_cvt_pk_bf16_f32 v213, v226, v227
v_cvt_pk_bf16_f32 v214, v228, v229
v_mfma_f32_16x16x32_bf16 a[244:247], a[56:59], a[128:131], a[244:247]
s_waitcnt lgkmcnt(3)
ds_read_b128 a[100:103], v3 offset:40960
v_cvt_pk_bf16_f32 v215, v230, v231
v_mfma_f32_16x16x32_bf16 v[176:179], a[56:59], a[136:139], v[176:179]
ds_read_b64_tr_b16 a[128:129], v6 offset:16384
ds_read_b64_tr_b16 a[130:131], v6 offset:17408
v_mfma_f32_16x16x32_bf16 v[176:179], a[60:63], a[140:143], v[176:179]
ds_read_b64_tr_b16 a[132:133], v6 offset:24576
ds_read_b64_tr_b16 a[134:135], v6 offset:25600
v_mfma_f32_16x16x32_bf16 a[252:255], a[52:55], a[140:143], a[252:255]
ds_read_b128 a[104:107], v2 offset:43008
v_fma_f32 v232, v232, v249, -v248
v_mfma_f32_16x16x32_bf16 a[252:255], a[48:51], a[136:139], a[252:255]
v_fma_f32 v233, v233, v249, -v248
v_fma_f32 v234, v234, v249, -v248
v_mfma_f32_16x16x32_bf16 v[136:139], a[40:43], a[136:139], v[136:139]
v_fma_f32 v235, v235, v249, -v248
v_fma_f32 v236, v236, v249, -v248
v_mfma_f32_16x16x32_bf16 v[136:139], a[44:47], a[140:143], v[136:139]
ds_read_b128 a[108:111], v3 offset:43008
v_fma_f32 v237, v237, v249, -v248
v_mfma_f32_16x16x32_bf16 v[128:131], a[36:39], a[140:143], v[128:131]
v_fma_f32 v238, v238, v249, -v248
v_fma_f32 v239, v239, v249, -v248
v_mfma_f32_16x16x32_bf16 v[128:131], a[32:35], a[136:139], v[128:131]
v_cvt_pk_bf16_f32 v216, v232, v233
v_cvt_pk_bf16_f32 v217, v234, v235
v_mfma_f32_16x16x32_bf16 v[172:175], a[24:27], a[136:139], v[172:175]
ds_read_b128 a[112:115], v2 offset:45056
v_cvt_pk_bf16_f32 v218, v236, v237
v_mfma_f32_16x16x32_bf16 v[172:175], a[28:31], a[140:143], v[172:175]
v_cvt_pk_bf16_f32 v219, v238, v239
v_fma_f32 v240, v240, v249, -v248
v_mfma_f32_16x16x32_bf16 a[248:251], a[20:23], a[140:143], a[248:251]
v_fma_f32 v241, v241, v249, -v248
v_fma_f32 v242, v242, v249, -v248
v_mfma_f32_16x16x32_bf16 a[248:251], a[16:19], a[136:139], a[248:251]
ds_read_b128 a[116:119], v3 offset:45056
v_fma_f32 v243, v243, v249, -v248
v_mfma_f32_16x16x32_bf16 v[132:135], a[8:11], a[136:139], v[132:135]
v_fma_f32 v244, v244, v249, -v248
v_fma_f32 v245, v245, v249, -v248
v_mfma_f32_16x16x32_bf16 v[132:135], a[12:15], a[140:143], v[132:135]
v_fma_f32 v246, v246, v249, -v248
v_fma_f32 v247, v247, v249, -v248
v_mfma_f32_16x16x32_bf16 v[124:127], a[4:7], a[140:143], v[124:127]
ds_read_b128 a[120:123], v2 offset:47104
v_cvt_pk_bf16_f32 v220, v240, v241
v_mfma_f32_16x16x32_bf16 v[124:127], a[0:3], a[136:139], v[124:127]
s_waitcnt lgkmcnt(3)
v_cvt_pk_bf16_f32 v221, v242, v243
v_cvt_pk_bf16_f32 v222, v244, v245
v_mfma_f32_16x16x32_bf16 v[140:143], a[0:3], a[128:131], v[140:143]
ds_read_b64_tr_b16 a[136:137], v7 offset:16384
ds_read_b64_tr_b16 a[138:139], v7 offset:17408
v_mfma_f32_16x16x32_bf16 v[140:143], a[4:7], a[132:135], v[140:143]
ds_read_b64_tr_b16 a[140:141], v7 offset:24576
ds_read_b64_tr_b16 a[142:143], v7 offset:25600
v_mfma_f32_16x16x32_bf16 v[148:151], a[12:15], a[132:135], v[148:151]
ds_read_b128 a[124:127], v3 offset:47104
v_cvt_pk_bf16_f32 v223, v246, v247
v_mfma_f32_16x16x32_bf16 v[148:151], a[8:11], a[128:131], v[148:151]
buffer_store_dwordx4 v[212:215], v254, s[4:7], s60 offen sc1
v_mfma_f32_16x16x32_bf16 v[180:183], a[16:19], a[128:131], v[180:183]
buffer_store_dwordx4 v[216:219], v254, s[4:7], s60 offen offset:2048 sc1
v_mfma_f32_16x16x32_bf16 v[180:183], a[20:23], a[132:135], v[180:183]
buffer_store_dwordx4 v[220:223], v42, s[4:7], s60 offen sc1
v_mfma_f32_16x16x32_bf16 v[188:191], a[28:31], a[132:135], v[188:191]
v_mfma_f32_16x16x32_bf16 v[188:191], a[24:27], a[128:131], v[188:191]
v_mfma_f32_16x16x32_bf16 v[144:147], a[32:35], a[128:131], v[144:147]
v_mfma_f32_16x16x32_bf16 v[144:147], a[36:39], a[132:135], v[144:147]
v_mfma_f32_16x16x32_bf16 v[152:155], a[44:47], a[132:135], v[152:155]
v_mfma_f32_16x16x32_bf16 v[152:155], a[40:43], a[128:131], v[152:155]
v_mfma_f32_16x16x32_bf16 v[184:187], a[48:51], a[128:131], v[184:187]
v_mfma_f32_16x16x32_bf16 v[184:187], a[52:55], a[132:135], v[184:187]
v_mfma_f32_16x16x32_bf16 v[192:195], a[60:63], a[132:135], v[192:195]
v_mfma_f32_16x16x32_bf16 v[192:195], a[56:59], a[128:131], v[192:195]
s_waitcnt lgkmcnt(0)
v_mfma_f32_16x16x32_bf16 v[208:211], a[56:59], a[136:139], v[208:211]
s_waitcnt vmcnt(21) lgkmcnt(0)
s_barrier
ds_read_b64_tr_b16 a[128:129], v4 offset:32768
v_mfma_f32_16x16x32_bf16 v[208:211], a[60:63], a[140:143], v[208:211]
ds_read_b64_tr_b16 a[130:131], v4 offset:33792
ds_read_b64_tr_b16 a[132:133], v4 offset:40960
v_mfma_f32_16x16x32_bf16 v[200:203], a[52:55], a[140:143], v[200:203]
ds_read_b64_tr_b16 a[134:135], v4 offset:41984
v_mfma_f32_16x16x32_bf16 v[200:203], a[48:51], a[136:139], v[200:203]
s_add_u32 m0, s57, 16384
s_add_u32 s59, s101, 4
s_and_b32 s59, s59, 7
v_mfma_f32_16x16x32_bf16 v[168:171], a[40:43], a[136:139], v[168:171]
s_xor_b32 s59, s59, s100
s_lshl_b32 s59, s59, 19
v_mfma_f32_16x16x32_bf16 v[168:171], a[44:47], a[140:143], v[168:171]
buffer_load_dwordx4 v12, s[24:27], s59 offen offset:0 lds
v_mfma_f32_16x16x32_bf16 v[160:163], a[36:39], a[140:143], v[160:163]
v_mfma_f32_16x16x32_bf16 v[160:163], a[32:35], a[136:139], v[160:163]
v_mfma_f32_16x16x32_bf16 v[204:207], a[24:27], a[136:139], v[204:207]
buffer_load_dwordx4 v13, s[24:27], s59 offen offset:1024 lds
v_mfma_f32_16x16x32_bf16 v[204:207], a[28:31], a[140:143], v[204:207]
v_mfma_f32_16x16x32_bf16 v[196:199], a[20:23], a[140:143], v[196:199]
v_mfma_f32_16x16x32_bf16 v[196:199], a[16:19], a[136:139], v[196:199]
v_mfma_f32_16x16x32_bf16 v[164:167], a[8:11], a[136:139], v[164:167]
v_mfma_f32_16x16x32_bf16 v[164:167], a[12:15], a[140:143], v[164:167]
buffer_load_dwordx4 v14, s[24:27], s59 offen offset:2048 lds
v_mfma_f32_16x16x32_bf16 v[156:159], a[4:7], a[140:143], v[156:159]
v_mfma_f32_16x16x32_bf16 v[156:159], a[0:3], a[136:139], v[156:159]
s_waitcnt lgkmcnt(0)
v_mfma_f32_16x16x32_bf16 v[44:47], a[128:131], a[64:67], v[44:47]
ds_read_b64_tr_b16 a[136:137], v5 offset:32768
ds_read_b64_tr_b16 a[138:139], v5 offset:33792
v_mfma_f32_16x16x32_bf16 v[44:47], a[132:135], a[68:71], v[44:47]
ds_read_b64_tr_b16 a[140:141], v5 offset:40960
ds_read_b64_tr_b16 a[142:143], v5 offset:41984
v_mfma_f32_16x16x32_bf16 v[48:51], a[132:135], a[76:79], v[48:51]
buffer_load_dwordx4 v15, s[24:27], s59 offen offset:3072 lds
v_mfma_f32_16x16x32_bf16 v[48:51], a[128:131], a[72:75], v[48:51]
v_mfma_f32_16x16x32_bf16 v[52:55], a[128:131], a[80:83], v[52:55]
v_mfma_f32_16x16x32_bf16 v[52:55], a[132:135], a[84:87], v[52:55]
v_mfma_f32_16x16x32_bf16 v[56:59], a[132:135], a[92:95], v[56:59]
v_mfma_f32_16x16x32_bf16 v[56:59], a[128:131], a[88:91], v[56:59]
s_add_u32 m0, s56, 32768
s_add_u32 s58, s101, 5
s_and_b32 s58, s58, 7
v_mfma_f32_16x16x32_bf16 v[60:63], a[128:131], a[96:99], v[60:63]
s_xor_b32 s58, s58, s100
s_lshl_b32 s58, s58, 7
v_mfma_f32_16x16x32_bf16 v[60:63], a[132:135], a[100:103], v[60:63]
buffer_load_dwordx4 v8, s[12:15], s58 offen offset:0 lds
v_mfma_f32_16x16x32_bf16 v[64:67], a[132:135], a[108:111], v[64:67]
v_mfma_f32_16x16x32_bf16 v[64:67], a[128:131], a[104:107], v[64:67]
v_mfma_f32_16x16x32_bf16 v[68:71], a[128:131], a[112:115], v[68:71]
buffer_load_dwordx4 v9, s[12:15], s58 offen offset:1024 lds
v_mfma_f32_16x16x32_bf16 v[68:71], a[132:135], a[116:119], v[68:71]
v_mfma_f32_16x16x32_bf16 v[72:75], a[132:135], a[124:127], v[72:75]
v_mfma_f32_16x16x32_bf16 v[72:75], a[128:131], a[120:123], v[72:75]
s_waitcnt lgkmcnt(0)
v_mfma_f32_16x16x32_bf16 a[172:175], a[136:139], a[120:123], a[172:175]
ds_read_b64_tr_b16 a[128:129], v6 offset:32768
ds_read_b64_tr_b16 a[130:131], v6 offset:33792
v_mfma_f32_16x16x32_bf16 a[172:175], a[140:143], a[124:127], a[172:175]
ds_read_b64_tr_b16 a[132:133], v6 offset:40960
ds_read_b64_tr_b16 a[134:135], v6 offset:41984
v_mfma_f32_16x16x32_bf16 a[168:171], a[140:143], a[116:119], a[168:171]
buffer_load_dwordx4 v10, s[12:15], s58 offen offset:2048 lds
v_mfma_f32_16x16x32_bf16 a[168:171], a[136:139], a[112:115], a[168:171]
v_mfma_f32_16x16x32_bf16 a[164:167], a[136:139], a[104:107], a[164:167]
v_mfma_f32_16x16x32_bf16 a[164:167], a[140:143], a[108:111], a[164:167]
v_mfma_f32_16x16x32_bf16 a[160:163], a[140:143], a[100:103], a[160:163]
buffer_load_dwordx4 v11, s[12:15], s58 offen offset:3072 lds
v_mfma_f32_16x16x32_bf16 a[160:163], a[136:139], a[96:99], a[160:163]
v_mfma_f32_16x16x32_bf16 a[156:159], a[136:139], a[88:91], a[156:159]
v_mfma_f32_16x16x32_bf16 a[156:159], a[140:143], a[92:95], a[156:159]
v_mfma_f32_16x16x32_bf16 a[152:155], a[140:143], a[84:87], a[152:155]
v_mfma_f32_16x16x32_bf16 a[152:155], a[136:139], a[80:83], a[152:155]
s_add_u32 m0, s56, 36864
s_add_u32 s58, s58, 32768
v_mfma_f32_16x16x32_bf16 a[148:151], a[136:139], a[72:75], a[148:151]
buffer_load_dwordx4 v8, s[12:15], s58 offen offset:0 lds
v_mfma_f32_16x16x32_bf16 a[148:151], a[140:143], a[76:79], a[148:151]
v_mfma_f32_16x16x32_bf16 a[144:147], a[140:143], a[68:71], a[144:147]
v_mfma_f32_16x16x32_bf16 a[144:147], a[136:139], a[64:67], a[144:147]
s_waitcnt lgkmcnt(0)
v_mfma_f32_16x16x32_bf16 v[76:79], a[128:131], a[64:67], v[76:79]
ds_read_b64_tr_b16 a[136:137], v7 offset:32768
ds_read_b64_tr_b16 a[138:139], v7 offset:33792
v_mfma_f32_16x16x32_bf16 v[76:79], a[132:135], a[68:71], v[76:79]
ds_read_b64_tr_b16 a[140:141], v7 offset:40960
ds_read_b64_tr_b16 a[142:143], v7 offset:41984
v_mfma_f32_16x16x32_bf16 v[80:83], a[132:135], a[76:79], v[80:83]
buffer_load_dwordx4 v9, s[12:15], s58 offen offset:1024 lds
v_mfma_f32_16x16x32_bf16 v[80:83], a[128:131], a[72:75], v[80:83]
v_mfma_f32_16x16x32_bf16 v[84:87], a[128:131], a[80:83], v[84:87]
v_mfma_f32_16x16x32_bf16 v[84:87], a[132:135], a[84:87], v[84:87]
buffer_load_dwordx4 v10, s[12:15], s58 offen offset:2048 lds
v_mfma_f32_16x16x32_bf16 v[88:91], a[132:135], a[92:95], v[88:91]
v_mfma_f32_16x16x32_bf16 v[88:91], a[128:131], a[88:91], v[88:91]
v_mfma_f32_16x16x32_bf16 v[92:95], a[128:131], a[96:99], v[92:95]
v_mfma_f32_16x16x32_bf16 v[92:95], a[132:135], a[100:103], v[92:95]
v_mfma_f32_16x16x32_bf16 v[96:99], a[132:135], a[108:111], v[96:99]
buffer_load_dwordx4 v11, s[12:15], s58 offen offset:3072 lds
v_mfma_f32_16x16x32_bf16 v[96:99], a[128:131], a[104:107], v[96:99]
v_mfma_f32_16x16x32_bf16 v[100:103], a[128:131], a[112:115], v[100:103]
v_mfma_f32_16x16x32_bf16 v[100:103], a[132:135], a[116:119], v[100:103]
v_mfma_f32_16x16x32_bf16 v[104:107], a[132:135], a[124:127], v[104:107]
v_mfma_f32_16x16x32_bf16 v[104:107], a[128:131], a[120:123], v[104:107]
s_waitcnt lgkmcnt(0)
buffer_load_dword v43, v36, s[44:47], 0 offen sc1
v_mfma_f32_16x16x32_bf16 a[228:231], a[136:139], a[120:123], a[228:231]
s_waitcnt vmcnt(22) lgkmcnt(0)
s_barrier
ds_read_b64_tr_b16 a[128:129], v4 offset:49152
v_mfma_f32_16x16x32_bf16 a[228:231], a[140:143], a[124:127], a[228:231]
ds_read_b64_tr_b16 a[130:131], v4 offset:50176
ds_read_b64_tr_b16 a[132:133], v4 offset:57344
v_mfma_f32_16x16x32_bf16 a[224:227], a[140:143], a[116:119], a[224:227]
ds_read_b64_tr_b16 a[134:135], v4 offset:58368
v_mfma_f32_16x16x32_bf16 a[224:227], a[136:139], a[112:115], a[224:227]
v_mfma_f32_16x16x32_bf16 a[220:223], a[136:139], a[104:107], a[220:223]
s_mov_b32 s88, 1310720
ds_read_b128 a[0:3], v2 offset:0
v_mfma_f32_16x16x32_bf16 a[220:223], a[140:143], a[108:111], a[220:223]
buffer_load_dword v255, v34, s[16:19], s88 offen
v_mfma_f32_16x16x32_bf16 a[216:219], a[140:143], a[100:103], a[216:219]
v_mfma_f32_16x16x32_bf16 a[216:219], a[136:139], a[96:99], a[216:219]
ds_read_b128 a[4:7], v3 offset:0
v_mfma_f32_16x16x32_bf16 a[188:191], a[136:139], a[88:91], a[188:191]
v_mfma_f32_16x16x32_bf16 a[188:191], a[140:143], a[92:95], a[188:191]
s_add_u32 s88, s67, 552960
buffer_load_dword v255, v35, s[32:35], s88 offen
v_mfma_f32_16x16x32_bf16 a[184:187], a[140:143], a[84:87], a[184:187]
ds_read_b128 a[8:11], v2 offset:2048
v_mfma_f32_16x16x32_bf16 a[184:187], a[136:139], a[80:83], a[184:187]
v_mfma_f32_16x16x32_bf16 a[180:183], a[136:139], a[72:75], a[180:183]
v_mfma_f32_16x16x32_bf16 a[180:183], a[140:143], a[76:79], a[180:183]
ds_read_b128 a[12:15], v3 offset:2048
v_mfma_f32_16x16x32_bf16 a[176:179], a[140:143], a[68:71], a[176:179]
s_add_u32 m0, s57, 32768
s_add_u32 s59, s101, 5
s_and_b32 s59, s59, 7
v_mfma_f32_16x16x32_bf16 a[176:179], a[136:139], a[64:67], a[176:179]
s_waitcnt lgkmcnt(3)
s_xor_b32 s59, s59, s100
s_lshl_b32 s59, s59, 19
v_mfma_f32_16x16x32_bf16 v[108:111], a[64:67], a[128:131], v[108:111]
ds_read_b64_tr_b16 a[136:137], v5 offset:49152
ds_read_b64_tr_b16 a[138:139], v5 offset:50176
v_mfma_f32_16x16x32_bf16 v[108:111], a[68:71], a[132:135], v[108:111]
ds_read_b64_tr_b16 a[140:141], v5 offset:57344
ds_read_b64_tr_b16 a[142:143], v5 offset:58368
v_mfma_f32_16x16x32_bf16 v[116:119], a[76:79], a[132:135], v[116:119]
ds_read_b128 a[16:19], v2 offset:4096
v_mfma_f32_16x16x32_bf16 v[116:119], a[72:75], a[128:131], v[116:119]
ds_read_b128 a[20:23], v3 offset:4096
v_mfma_f32_16x16x32_bf16 a[232:235], a[80:83], a[128:131], a[232:235]
buffer_load_dwordx4 v12, s[20:23], s59 offen offset:0 lds
v_mfma_f32_16x16x32_bf16 a[232:235], a[84:87], a[132:135], a[232:235]
buffer_load_dwordx4 v13, s[20:23], s59 offen offset:1024 lds
v_mfma_f32_16x16x32_bf16 a[240:243], a[92:95], a[132:135], a[240:243]
ds_read_b128 a[24:27], v2 offset:6144
v_mfma_f32_16x16x32_bf16 a[240:243], a[88:91], a[128:131], a[240:243]
v_mfma_f32_16x16x32_bf16 v[112:115], a[96:99], a[128:131], v[112:115]
buffer_load_dwordx4 v14, s[20:23], s59 offen offset:2048 lds
v_mfma_f32_16x16x32_bf16 v[112:115], a[100:103], a[132:135], v[112:115]
ds_read_b128 a[28:31], v3 offset:6144
v_mfma_f32_16x16x32_bf16 v[120:123], a[108:111], a[132:135], v[120:123]
v_mfma_f32_16x16x32_bf16 v[120:123], a[104:107], a[128:131], v[120:123]
v_mfma_f32_16x16x32_bf16 a[236:239], a[112:115], a[128:131], a[236:239]
ds_read_b128 a[32:35], v2 offset:8192
v_mfma_f32_16x16x32_bf16 a[236:239], a[116:119], a[132:135], a[236:239]
buffer_load_dwordx4 v15, s[20:23], s59 offen offset:3072 lds
v_mfma_f32_16x16x32_bf16 a[244:247], a[124:127], a[132:135], a[244:247]
v_mfma_f32_16x16x32_bf16 a[244:247], a[120:123], a[128:131], a[244:247]
s_waitcnt lgkmcnt(3)
ds_read_b128 a[36:39], v3 offset:8192
v_mfma_f32_16x16x32_bf16 v[176:179], a[120:123], a[136:139], v[176:179]
ds_read_b64_tr_b16 a[128:129], v6 offset:49152
ds_read_b64_tr_b16 a[130:131], v6 offset:50176
v_mfma_f32_16x16x32_bf16 v[176:179], a[124:127], a[140:143], v[176:179]
ds_read_b64_tr_b16 a[132:133], v6 offset:57344
ds_read_b64_tr_b16 a[134:135], v6 offset:58368
v_mfma_f32_16x16x32_bf16 a[252:255], a[116:119], a[140:143], a[252:255]
ds_read_b128 a[40:43], v2 offset:10240
v_mfma_f32_16x16x32_bf16 a[252:255], a[112:115], a[136:139], a[252:255]
v_mfma_f32_16x16x32_bf16 v[136:139], a[104:107], a[136:139], v[136:139]
v_mfma_f32_16x16x32_bf16 v[136:139], a[108:111], a[140:143], v[136:139]
ds_read_b128 a[44:47], v3 offset:10240
v_mfma_f32_16x16x32_bf16 v[128:131], a[100:103], a[140:143], v[128:131]
v_mfma_f32_16x16x32_bf16 v[128:131], a[96:99], a[136:139], v[128:131]
v_mfma_f32_16x16x32_bf16 v[172:175], a[88:91], a[136:139], v[172:175]
s_mov_b64 s[90:91], 0xff
ds_read_b128 a[48:51], v2 offset:12288
s_waitcnt vmcnt(6)
v_cmp_ne_u32 vcc, 1, v43
v_mfma_f32_16x16x32_bf16 v[172:175], a[92:95], a[140:143], v[172:175]
v_mfma_f32_16x16x32_bf16 a[248:251], a[84:87], a[140:143], a[248:251]
v_mfma_f32_16x16x32_bf16 a[248:251], a[80:83], a[136:139], a[248:251]
ds_read_b128 a[52:55], v3 offset:12288
v_mfma_f32_16x16x32_bf16 v[132:135], a[72:75], a[136:139], v[132:135]
v_mfma_f32_16x16x32_bf16 v[132:135], a[76:79], a[140:143], v[132:135]
v_mfma_f32_16x16x32_bf16 v[124:127], a[68:71], a[140:143], v[124:127]
ds_read_b128 a[56:59], v2 offset:14336
v_mfma_f32_16x16x32_bf16 v[124:127], a[64:67], a[136:139], v[124:127]
s_waitcnt lgkmcnt(3)
v_mfma_f32_16x16x32_bf16 v[140:143], a[64:67], a[128:131], v[140:143]
ds_read_b64_tr_b16 a[136:137], v7 offset:49152
ds_read_b64_tr_b16 a[138:139], v7 offset:50176
v_mfma_f32_16x16x32_bf16 v[140:143], a[68:71], a[132:135], v[140:143]
ds_read_b64_tr_b16 a[140:141], v7 offset:57344
ds_read_b64_tr_b16 a[142:143], v7 offset:58368
v_mfma_f32_16x16x32_bf16 v[148:151], a[76:79], a[132:135], v[148:151]
ds_read_b128 a[60:63], v3 offset:14336
v_mfma_f32_16x16x32_bf16 v[148:151], a[72:75], a[128:131], v[148:151]
v_mfma_f32_16x16x32_bf16 v[180:183], a[80:83], a[128:131], v[180:183]
v_mfma_f32_16x16x32_bf16 v[180:183], a[84:87], a[132:135], v[180:183]
v_mfma_f32_16x16x32_bf16 v[188:191], a[92:95], a[132:135], v[188:191]
s_and_b64 vcc, vcc, s[90:91]
v_mfma_f32_16x16x32_bf16 v[188:191], a[88:91], a[128:131], v[188:191]
v_mfma_f32_16x16x32_bf16 v[144:147], a[96:99], a[128:131], v[144:147]
v_mfma_f32_16x16x32_bf16 v[144:147], a[100:103], a[132:135], v[144:147]
v_mfma_f32_16x16x32_bf16 v[152:155], a[108:111], a[132:135], v[152:155]
s_cbranch_vccnz L_slow_z
L_slow_z_back:
v_mfma_f32_16x16x32_bf16 v[152:155], a[104:107], a[128:131], v[152:155]
v_mfma_f32_16x16x32_bf16 v[184:187], a[112:115], a[128:131], v[184:187]
v_mfma_f32_16x16x32_bf16 v[184:187], a[116:119], a[132:135], v[184:187]
v_mfma_f32_16x16x32_bf16 v[192:195], a[124:127], a[132:135], v[192:195]
v_mfma_f32_16x16x32_bf16 v[192:195], a[120:123], a[128:131], v[192:195]
s_waitcnt lgkmcnt(0)
v_mfma_f32_16x16x32_bf16 v[208:211], a[120:123], a[136:139], v[208:211]
s_waitcnt vmcnt(63) lgkmcnt(0)
s_barrier
ds_read_b64_tr_b16 a[128:129], v4 offset:0
v_mfma_f32_16x16x32_bf16 v[208:211], a[124:127], a[140:143], v[208:211]
ds_read_b64_tr_b16 a[130:131], v4 offset:1024
ds_read_b64_tr_b16 a[132:133], v4 offset:8192
v_mfma_f32_16x16x32_bf16 v[200:203], a[116:119], a[140:143], v[200:203]
ds_read_b64_tr_b16 a[134:135], v4 offset:9216
v_mfma_f32_16x16x32_bf16 v[200:203], a[112:115], a[136:139], v[200:203]
buffer_store_dword v39, v38, s[4:7], s87 offen sc1
v_mfma_f32_16x16x32_bf16 v[168:171], a[104:107], a[136:139], v[168:171]
v_mfma_f32_16x16x32_bf16 v[168:171], a[108:111], a[140:143], v[168:171]
v_mfma_f32_16x16x32_bf16 v[160:163], a[100:103], a[140:143], v[160:163]
v_mfma_f32_16x16x32_bf16 v[160:163], a[96:99], a[136:139], v[160:163]
v_mfma_f32_16x16x32_bf16 v[204:207], a[88:91], a[136:139], v[204:207]
s_add_u32 m0, s57, 49152
s_add_u32 s59, s101, 5
s_and_b32 s59, s59, 7
v_mfma_f32_16x16x32_bf16 v[204:207], a[92:95], a[140:143], v[204:207]
s_xor_b32 s59, s59, s100
s_lshl_b32 s59, s59, 19
v_mfma_f32_16x16x32_bf16 v[196:199], a[84:87], a[140:143], v[196:199]
buffer_load_dwordx4 v12, s[24:27], s59 offen offset:0 lds
v_mfma_f32_16x16x32_bf16 v[196:199], a[80:83], a[136:139], v[196:199]
v_mfma_f32_16x16x32_bf16 v[164:167], a[72:75], a[136:139], v[164:167]
v_mfma_f32_16x16x32_bf16 v[164:167], a[76:79], a[140:143], v[164:167]
buffer_load_dwordx4 v13, s[24:27], s59 offen offset:1024 lds
v_mfma_f32_16x16x32_bf16 v[156:159], a[68:71], a[140:143], v[156:159]
v_mfma_f32_16x16x32_bf16 v[156:159], a[64:67], a[136:139], v[156:159]
s_waitcnt lgkmcnt(0)
v_mfma_f32_16x16x32_bf16 v[44:47], a[128:131], a[0:3], v[44:47]
ds_read_b64_tr_b16 a[136:137], v5 offset:0
ds_read_b64_tr_b16 a[138:139], v5 offset:1024
v_mfma_f32_16x16x32_bf16 v[44:47], a[132:135], a[4:7], v[44:47]
ds_read_b64_tr_b16 a[140:141], v5 offset:8192
ds_read_b64_tr_b16 a[142:143], v5 offset:9216
v_mfma_f32_16x16x32_bf16 v[48:51], a[132:135], a[12:15], v[48:51]
buffer_load_dwordx4 v14, s[24:27], s59 offen offset:2048 lds
v_mfma_f32_16x16x32_bf16 v[48:51], a[128:131], a[8:11], v[48:51]
v_mfma_f32_16x16x32_bf16 v[52:55], a[128:131], a[16:19], v[52:55]
v_mfma_f32_16x16x32_bf16 v[52:55], a[132:135], a[20:23], v[52:55]
v_mfma_f32_16x16x32_bf16 v[56:59], a[132:135], a[28:31], v[56:59]
v_mfma_f32_16x16x32_bf16 v[56:59], a[128:131], a[24:27], v[56:59]
buffer_load_dwordx4 v15, s[24:27], s59 offen offset:3072 lds
v_mfma_f32_16x16x32_bf16 v[60:63], a[128:131], a[32:35], v[60:63]
v_mfma_f32_16x16x32_bf16 v[60:63], a[132:135], a[36:39], v[60:63]
v_mfma_f32_16x16x32_bf16 v[64:67], a[132:135], a[44:47], v[64:67]
v_mfma_f32_16x16x32_bf16 v[64:67], a[128:131], a[40:43], v[64:67]
v_mfma_f32_16x16x32_bf16 v[68:71], a[128:131], a[48:51], v[68:71]
s_add_u32 m0, s56, 0
s_add_u32 s58, s101, 6
s_and_b32 s58, s58, 7
v_mfma_f32_16x16x32_bf16 v[68:71], a[132:135], a[52:55], v[68:71]
s_xor_b32 s58, s58, s100
s_lshl_b32 s58, s58, 7
v_mfma_f32_16x16x32_bf16 v[72:75], a[132:135], a[60:63], v[72:75]
buffer_load_dwordx4 v8, s[12:15], s58 offen offset:0 lds
v_mfma_f32_16x16x32_bf16 v[72:75], a[128:131], a[56:59], v[72:75]
s_waitcnt lgkmcnt(0)
v_mfma_f32_16x16x32_bf16 a[172:175], a[136:139], a[56:59], a[172:175]
ds_read_b64_tr_b16 a[128:129], v6 offset:0
ds_read_b64_tr_b16 a[130:131], v6 offset:1024
v_mfma_f32_16x16x32_bf16 a[172:175], a[140:143], a[60:63], a[172:175]
ds_read_b64_tr_b16 a[132:133], v6 offset:8192
ds_read_b64_tr_b16 a[134:135], v6 offset:9216
v_mfma_f32_16x16x32_bf16 a[168:171], a[140:143], a[52:55], a[168:171]
buffer_load_dwordx4 v9, s[12:15], s58 offen offset:1024 lds
v_mfma_f32_16x16x32_bf16 a[168:171], a[136:139], a[48:51], a[168:171]
v_mfma_f32_16x16x32_bf16 a[164:167], a[136:139], a[40:43], a[164:167]
v_mfma_f32_16x16x32_bf16 a[164:167], a[140:143], a[44:47], a[164:167]
v_mfma_f32_16x16x32_bf16 a[160:163], a[140:143], a[36:39], a[160:163]
buffer_load_dwordx4 v10, s[12:15], s58 offen offset:2048 lds
v_mfma_f32_16x16x32_bf16 a[160:163], a[136:139], a[32:35], a[160:163]
v_mfma_f32_16x16x32_bf16 a[156:159], a[136:139], a[24:27], a[156:159]
v_mfma_f32_16x16x32_bf16 a[156:159], a[140:143], a[28:31], a[156:159]
v_mfma_f32_16x16x32_bf16 a[152:155], a[140:143], a[20:23], a[152:155]
v_mfma_f32_16x16x32_bf16 a[152:155], a[136:139], a[16:19], a[152:155]
buffer_load_dwordx4 v11, s[12:15], s58 offen offset:3072 lds
v_mfma_f32_16x16x32_bf16 a[148:151], a[136:139], a[8:11], a[148:151]
v_mfma_f32_16x16x32_bf16 a[148:151], a[140:143], a[12:15], a[148:151]
v_mfma_f32_16x16x32_bf16 a[144:147], a[140:143], a[4:7], a[144:147]
v_mfma_f32_16x16x32_bf16 a[144:147], a[136:139], a[0:3], a[144:147]
s_waitcnt lgkmcnt(0)
v_mfma_f32_16x16x32_bf16 v[76:79], a[128:131], a[0:3], v[76:79]
s_add_u32 m0, s56, 4096
ds_read_b64_tr_b16 a[136:137], v7 offset:0
ds_read_b64_tr_b16 a[138:139], v7 offset:1024
v_mfma_f32_16x16x32_bf16 v[76:79], a[132:135], a[4:7], v[76:79]
s_add_u32 s58, s58, 32768
ds_read_b64_tr_b16 a[140:141], v7 offset:8192
ds_read_b64_tr_b16 a[142:143], v7 offset:9216
v_mfma_f32_16x16x32_bf16 v[80:83], a[132:135], a[12:15], v[80:83]
buffer_load_dwordx4 v8, s[12:15], s58 offen offset:0 lds
v_mfma_f32_16x16x32_bf16 v[80:83], a[128:131], a[8:11], v[80:83]
v_mfma_f32_16x16x32_bf16 v[84:87], a[128:131], a[16:19], v[84:87]
v_mfma_f32_16x16x32_bf16 v[84:87], a[132:135], a[20:23], v[84:87]
buffer_load_dwordx4 v9, s[12:15], s58 offen offset:1024 lds
v_mfma_f32_16x16x32_bf16 v[88:91], a[132:135], a[28:31], v[88:91]
v_mfma_f32_16x16x32_bf16 v[88:91], a[128:131], a[24:27], v[88:91]
v_mfma_f32_16x16x32_bf16 v[92:95], a[128:131], a[32:35], v[92:95]
v_mfma_f32_16x16x32_bf16 v[92:95], a[132:135], a[36:39], v[92:95]
v_mfma_f32_16x16x32_bf16 v[96:99], a[132:135], a[44:47], v[96:99]
buffer_load_dwordx4 v10, s[12:15], s58 offen offset:2048 lds
v_mfma_f32_16x16x32_bf16 v[96:99], a[128:131], a[40:43], v[96:99]
v_mfma_f32_16x16x32_bf16 v[100:103], a[128:131], a[48:51], v[100:103]
v_mfma_f32_16x16x32_bf16 v[100:103], a[132:135], a[52:55], v[100:103]
v_mfma_f32_16x16x32_bf16 v[104:107], a[132:135], a[60:63], v[104:107]
v_mfma_f32_16x16x32_bf16 v[104:107], a[128:131], a[56:59], v[104:107]
s_waitcnt lgkmcnt(0)
buffer_load_dwordx4 v11, s[12:15], s58 offen offset:3072 lds
v_mfma_f32_16x16x32_bf16 a[228:231], a[136:139], a[56:59], a[228:231]
s_waitcnt vmcnt(63) lgkmcnt(0)
s_barrier
ds_read_b64_tr_b16 a[128:129], v4 offset:16384
v_mfma_f32_16x16x32_bf16 a[228:231], a[140:143], a[60:63], a[228:231]
ds_read_b64_tr_b16 a[130:131], v4 offset:17408
ds_read_b64_tr_b16 a[132:133], v4 offset:24576
v_mfma_f32_16x16x32_bf16 a[224:227], a[140:143], a[52:55], a[224:227]
ds_read_b64_tr_b16 a[134:135], v4 offset:25600
v_mfma_f32_16x16x32_bf16 a[224:227], a[136:139], a[48:51], a[224:227]
v_mfma_f32_16x16x32_bf16 a[220:223], a[136:139], a[40:43], a[220:223]
s_mov_b32 s88, 2621440
ds_read_b128 a[64:67], v2 offset:32768
v_mfma_f32_16x16x32_bf16 a[220:223], a[140:143], a[44:47], a[220:223]
buffer_load_dword v255, v34, s[16:19], s88 offen
v_mfma_f32_16x16x32_bf16 a[216:219], a[140:143], a[36:39], a[216:219]
v_mfma_f32_16x16x32_bf16 a[216:219], a[136:139], a[32:35], a[216:219]
ds_read_b128 a[68:71], v3 offset:32768
v_mfma_f32_16x16x32_bf16 a[188:191], a[136:139], a[24:27], a[188:191]
v_mfma_f32_16x16x32_bf16 a[188:191], a[140:143], a[28:31], a[188:191]
s_add_u32 s88, s67, 1105920
buffer_load_dword v255, v35, s[32:35], s88 offen
v_mfma_f32_16x16x32_bf16 a[184:187], a[140:143], a[20:23], a[184:187]
ds_read_b128 a[72:75], v2 offset:34816
v_mfma_f32_16x16x32_bf16 a[184:187], a[136:139], a[16:19], a[184:187]
v_mfma_f32_16x16x32_bf16 a[180:183], a[136:139], a[8:11], a[180:183]
v_mfma_f32_16x16x32_bf16 a[180:183], a[140:143], a[12:15], a[180:183]
ds_read_b128 a[76:79], v3 offset:34816
v_mfma_f32_16x16x32_bf16 a[176:179], a[140:143], a[4:7], a[176:179]
s_add_u32 m0, s57, 0
s_add_u32 s59, s101, 6
s_and_b32 s59, s59, 7
v_mfma_f32_16x16x32_bf16 a[176:179], a[136:139], a[0:3], a[176:179]
s_waitcnt lgkmcnt(3)
s_xor_b32 s59, s59, s100
s_lshl_b32 s59, s59, 19
v_mfma_f32_16x16x32_bf16 v[108:111], a[0:3], a[128:131], v[108:111]
ds_read_b64_tr_b16 a[136:137], v5 offset:16384
ds_read_b64_tr_b16 a[138:139], v5 offset:17408
v_mfma_f32_16x16x32_bf16 v[108:111], a[4:7], a[132:135], v[108:111]
ds_read_b64_tr_b16 a[140:141], v5 offset:24576
ds_read_b64_tr_b16 a[142:143], v5 offset:25600
v_mfma_f32_16x16x32_bf16 v[116:119], a[12:15], a[132:135], v[116:119]
ds_read_b128 a[80:83], v2 offset:36864
v_mfma_f32_16x16x32_bf16 v[116:119], a[8:11], a[128:131], v[116:119]
ds_read_b128 a[84:87], v3 offset:36864
v_mfma_f32_16x16x32_bf16 a[232:235], a[16:19], a[128:131], a[232:235]
buffer_load_dwordx4 v12, s[20:23], s59 offen offset:0 lds
v_mfma_f32_16x16x32_bf16 a[232:235], a[20:23], a[132:135], a[232:235]
buffer_load_dwordx4 v13, s[20:23], s59 offen offset:1024 lds
v_mfma_f32_16x16x32_bf16 a[240:243], a[28:31], a[132:135], a[240:243]
ds_read_b128 a[88:91], v2 offset:38912
v_mfma_f32_16x16x32_bf16 a[240:243], a[24:27], a[128:131], a[240:243]
v_mfma_f32_16x16x32_bf16 v[112:115], a[32:35], a[128:131], v[112:115]
buffer_load_dwordx4 v14, s[20:23], s59 offen offset:2048 lds
v_mfma_f32_16x16x32_bf16 v[112:115], a[36:39], a[132:135], v[112:115]
ds_read_b128 a[92:95], v3 offset:38912
v_mfma_f32_16x16x32_bf16 v[120:123], a[44:47], a[132:135], v[120:123]
v_mfma_f32_16x16x32_bf16 v[120:123], a[40:43], a[128:131], v[120:123]
v_mfma_f32_16x16x32_bf16 a[236:239], a[48:51], a[128:131], a[236:239]
ds_read_b128 a[96:99], v2 offset:40960
v_mfma_f32_16x16x32_bf16 a[236:239], a[52:55], a[132:135], a[236:239]
buffer_load_dwordx4 v15, s[20:23], s59 offen offset:3072 lds
v_mfma_f32_16x16x32_bf16 a[244:247], a[60:63], a[132:135], a[244:247]
v_mfma_f32_16x16x32_bf16 a[244:247], a[56:59], a[128:131], a[244:247]
s_waitcnt lgkmcnt(3)
ds_read_b128 a[100:103], v3 offset:40960
v_mfma_f32_16x16x32_bf16 v[176:179], a[56:59], a[136:139], v[176:179]
ds_read_b64_tr_b16 a[128:129], v6 offset:16384
ds_read_b64_tr_b16 a[130:131], v6 offset:17408
v_mfma_f32_16x16x32_bf16 v[176:179], a[60:63], a[140:143], v[176:179]
ds_read_b64_tr_b16 a[132:133], v6 offset:24576
ds_read_b64_tr_b16 a[134:135], v6 offset:25600
v_mfma_f32_16x16x32_bf16 a[252:255], a[52:55], a[140:143], a[252:255]
ds_read_b128 a[104:107], v2 offset:43008
v_mfma_f32_16x16x32_bf16 a[252:255], a[48:51], a[136:139], a[252:255]
v_mfma_f32_16x16x32_bf16 v[136:139], a[40:43], a[136:139], v[136:139]
v_mfma_f32_16x16x32_bf16 v[136:139], a[44:47], a[140:143], v[136:139]
ds_read_b128 a[108:111], v3 offset:43008
v_mfma_f32_16x16x32_bf16 v[128:131], a[36:39], a[140:143], v[128:131]
v_mfma_f32_16x16x32_bf16 v[128:131], a[32:35], a[136:139], v[128:131]
v_mfma_f32_16x16x32_bf16 v[172:175], a[24:27], a[136:139], v[172:175]
ds_read_b128 a[112:115], v2 offset:45056
v_mfma_f32_16x16x32_bf16 v[172:175], a[28:31], a[140:143], v[172:175]
v_mfma_f32_16x16x32_bf16 a[248:251], a[20:23], a[140:143], a[248:251]
v_mfma_f32_16x16x32_bf16 a[248:251], a[16:19], a[136:139], a[248:251]
ds_read_b128 a[116:119], v3 offset:45056
v_mfma_f32_16x16x32_bf16 v[132:135], a[8:11], a[136:139], v[132:135]
v_mfma_f32_16x16x32_bf16 v[132:135], a[12:15], a[140:143], v[132:135]
v_mfma_f32_16x16x32_bf16 v[124:127], a[4:7], a[140:143], v[124:127]
ds_read_b128 a[120:123], v2 offset:47104
v_mfma_f32_16x16x32_bf16 v[124:127], a[0:3], a[136:139], v[124:127]
s_waitcnt lgkmcnt(3)
v_mfma_f32_16x16x32_bf16 v[140:143], a[0:3], a[128:131], v[140:143]
ds_read_b64_tr_b16 a[136:137], v7 offset:16384
ds_read_b64_tr_b16 a[138:139], v7 offset:17408
v_mfma_f32_16x16x32_bf16 v[140:143], a[4:7], a[132:135], v[140:143]
ds_read_b64_tr_b16 a[140:141], v7 offset:24576
ds_read_b64_tr_b16 a[142:143], v7 offset:25600
v_mfma_f32_16x16x32_bf16 v[148:151], a[12:15], a[132:135], v[148:151]
ds_read_b128 a[124:127], v3 offset:47104
v_mfma_f32_16x16x32_bf16 v[148:151], a[8:11], a[128:131], v[148:151]
v_mfma_f32_16x16x32_bf16 v[180:183], a[16:19], a[128:131], v[180:183]
v_mfma_f32_16x16x32_bf16 v[180:183], a[20:23], a[132:135], v[180:183]
v_mfma_f32_16x16x32_bf16 v[188:191], a[28:31], a[132:135], v[188:191]
v_mfma_f32_16x16x32_bf16 v[188:191], a[24:27], a[128:131], v[188:191]
v_mfma_f32_16x16x32_bf16 v[144:147], a[32:35], a[128:131], v[144:147]
v_mfma_f32_16x16x32_bf16 v[144:147], a[36:39], a[132:135], v[144:147]
v_mfma_f32_16x16x32_bf16 v[152:155], a[44:47], a[132:135], v[152:155]
v_mfma_f32_16x16x32_bf16 v[152:155], a[40:43], a[128:131], v[152:155]
v_mfma_f32_16x16x32_bf16 v[184:187], a[48:51], a[128:131], v[184:187]
v_mfma_f32_16x16x32_bf16 v[184:187], a[52:55], a[132:135], v[184:187]
v_mfma_f32_16x16x32_bf16 v[192:195], a[60:63], a[132:135], v[192:195]
v_mfma_f32_16x16x32_bf16 v[192:195], a[56:59], a[128:131], v[192:195]
s_waitcnt lgkmcnt(0)
v_mfma_f32_16x16x32_bf16 v[208:211], a[56:59], a[136:139], v[208:211]
s_waitcnt vmcnt(19) lgkmcnt(0)
s_barrier
ds_read_b64_tr_b16 a[128:129], v4 offset:32768
v_mfma_f32_16x16x32_bf16 v[208:211], a[60:63], a[140:143], v[208:211]
ds_read_b64_tr_b16 a[130:131], v4 offset:33792
ds_read_b64_tr_b16 a[132:133], v4 offset:40960
v_mfma_f32_16x16x32_bf16 v[200:203], a[52:55], a[140:143], v[200:203]
ds_read_b64_tr_b16 a[134:135], v4 offset:41984
v_mfma_f32_16x16x32_bf16 v[200:203], a[48:51], a[136:139], v[200:203]
s_add_u32 m0, s57, 16384
s_add_u32 s59, s101, 6
s_and_b32 s59, s59, 7
v_mfma_f32_16x16x32_bf16 v[168:171], a[40:43], a[136:139], v[168:171]
s_xor_b32 s59, s59, s100
s_lshl_b32 s59, s59, 19
v_mfma_f32_16x16x32_bf16 v[168:171], a[44:47], a[140:143], v[168:171]
buffer_load_dwordx4 v12, s[24:27], s59 offen offset:0 lds
v_mfma_f32_16x16x32_bf16 v[160:163], a[36:39], a[140:143], v[160:163]
v_mfma_f32_16x16x32_bf16 v[160:163], a[32:35], a[136:139], v[160:163]
v_mfma_f32_16x16x32_bf16 v[204:207], a[24:27], a[136:139], v[204:207]
buffer_load_dwordx4 v13, s[24:27], s59 offen offset:1024 lds
v_mfma_f32_16x16x32_bf16 v[204:207], a[28:31], a[140:143], v[204:207]
v_mfma_f32_16x16x32_bf16 v[196:199], a[20:23], a[140:143], v[196:199]
v_mfma_f32_16x16x32_bf16 v[196:199], a[16:19], a[136:139], v[196:199]
v_mfma_f32_16x16x32_bf16 v[164:167], a[8:11], a[136:139], v[164:167]
v_mfma_f32_16x16x32_bf16 v[164:167], a[12:15], a[140:143], v[164:167]
buffer_load_dwordx4 v14, s[24:27], s59 offen offset:2048 lds
v_mfma_f32_16x16x32_bf16 v[156:159], a[4:7], a[140:143], v[156:159]
v_mfma_f32_16x16x32_bf16 v[156:159], a[0:3], a[136:139], v[156:159]
s_waitcnt lgkmcnt(0)
v_mfma_f32_16x16x32_bf16 v[44:47], a[128:131], a[64:67], v[44:47]
ds_read_b64_tr_b16 a[136:137], v5 offset:32768
ds_read_b64_tr_b16 a[138:139], v5 offset:33792
v_mfma_f32_16x16x32_bf16 v[44:47], a[132:135], a[68:71], v[44:47]
ds_read_b64_tr_b16 a[140:141], v5 offset:40960
ds_read_b64_tr_b16 a[142:143], v5 offset:41984
v_mfma_f32_16x16x32_bf16 v[48:51], a[132:135], a[76:79], v[48:51]
buffer_load_dwordx4 v15, s[24:27], s59 offen offset:3072 lds
v_mfma_f32_16x16x32_bf16 v[48:51], a[128:131], a[72:75], v[48:51]
v_mfma_f32_16x16x32_bf16 v[52:55], a[128:131], a[80:83], v[52:55]
v_mfma_f32_16x16x32_bf16 v[52:55], a[132:135], a[84:87], v[52:55]
v_mfma_f32_16x16x32_bf16 v[56:59], a[132:135], a[92:95], v[56:59]
v_mfma_f32_16x16x32_bf16 v[56:59], a[128:131], a[88:91], v[56:59]
s_add_u32 m0, s56, 32768
s_xor_b32 s58, s100, 7
s_cmp_eq_u32 s101, 0
v_mfma_f32_16x16x32_bf16 v[60:63], a[128:131], a[96:99], v[60:63]
s_cselect_b32 s58, s58, 1
s_lshl_b32 s58, s58, 7
v_mfma_f32_16x16x32_bf16 v[60:63], a[132:135], a[100:103], v[60:63]
buffer_load_dwordx4 v8, s[12:15], s58 offen offset:0 lds
v_mfma_f32_16x16x32_bf16 v[64:67], a[132:135], a[108:111], v[64:67]
v_mfma_f32_16x16x32_bf16 v[64:67], a[128:131], a[104:107], v[64:67]
v_mfma_f32_16x16x32_bf16 v[68:71], a[128:131], a[112:115], v[68:71]
buffer_load_dwordx4 v9, s[12:15], s58 offen offset:1024 lds
v_mfma_f32_16x16x32_bf16 v[68:71], a[132:135], a[116:119], v[68:71]
v_mfma_f32_16x16x32_bf16 v[72:75], a[132:135], a[124:127], v[72:75]
v_mfma_f32_16x16x32_bf16 v[72:75], a[128:131], a[120:123], v[72:75]
s_waitcnt lgkmcnt(0)
v_mfma_f32_16x16x32_bf16 a[172:175], a[136:139], a[120:123], a[172:175]
ds_read_b64_tr_b16 a[128:129], v6 offset:32768
ds_read_b64_tr_b16 a[130:131], v6 offset:33792
v_mfma_f32_16x16x32_bf16 a[172:175], a[140:143], a[124:127], a[172:175]
ds_read_b64_tr_b16 a[132:133], v6 offset:40960
ds_read_b64_tr_b16 a[134:135], v6 offset:41984
v_mfma_f32_16x16x32_bf16 a[168:171], a[140:143], a[116:119], a[168:171]
buffer_load_dwordx4 v10, s[12:15], s58 offen offset:2048 lds
v_mfma_f32_16x16x32_bf16 a[168:171], a[136:139], a[112:115], a[168:171]
v_mfma_f32_16x16x32_bf16 a[164:167], a[136:139], a[104:107], a[164:167]
v_mfma_f32_16x16x32_bf16 a[164:167], a[140:143], a[108:111], a[164:167]
v_mfma_f32_16x16x32_bf16 a[160:163], a[140:143], a[100:103], a[160:163]
buffer_load_dwordx4 v11, s[12:15], s58 offen offset:3072 lds
v_mfma_f32_16x16x32_bf16 a[160:163], a[136:139], a[96:99], a[160:163]
v_mfma_f32_16x16x32_bf16 a[156:159], a[136:139], a[88:91], a[156:159]
v_mfma_f32_16x16x32_bf16 a[156:159], a[140:143], a[92:95], a[156:159]
v_mfma_f32_16x16x32_bf16 a[152:155], a[140:143], a[84:87], a[152:155]
v_mfma_f32_16x16x32_bf16 a[152:155], a[136:139], a[80:83], a[152:155]
s_add_u32 m0, s56, 36864
s_add_u32 s58, s58, 32768
v_mfma_f32_16x16x32_bf16 a[148:151], a[136:139], a[72:75], a[148:151]
buffer_load_dwordx4 v8, s[12:15], s58 offen offset:0 lds
v_mfma_f32_16x16x32_bf16 a[148:151], a[140:143], a[76:79], a[148:151]
v_mfma_f32_16x16x32_bf16 a[144:147], a[140:143], a[68:71], a[144:147]
v_mfma_f32_16x16x32_bf16 a[144:147], a[136:139], a[64:67], a[144:147]
s_waitcnt lgkmcnt(0)
v_mfma_f32_16x16x32_bf16 v[76:79], a[128:131], a[64:67], v[76:79]
ds_read_b64_tr_b16 a[136:137], v7 offset:32768
ds_read_b64_tr_b16 a[138:139], v7 offset:33792
v_mfma_f32_16x16x32_bf16 v[76:79], a[132:135], a[68:71], v[76:79]
ds_read_b64_tr_b16 a[140:141], v7 offset:40960
ds_read_b64_tr_b16 a[142:143], v7 offset:41984
v_mfma_f32_16x16x32_bf16 v[80:83], a[132:135], a[76:79], v[80:83]
buffer_load_dwordx4 v9, s[12:15], s58 offen offset:1024 lds
v_mfma_f32_16x16x32_bf16 v[80:83], a[128:131], a[72:75], v[80:83]
v_mfma_f32_16x16x32_bf16 v[84:87], a[128:131], a[80:83], v[84:87]
v_mfma_f32_16x16x32_bf16 v[84:87], a[132:135], a[84:87], v[84:87]
buffer_load_dwordx4 v10, s[12:15], s58 offen offset:2048 lds
v_mfma_f32_16x16x32_bf16 v[88:91], a[132:135], a[92:95], v[88:91]
v_mfma_f32_16x16x32_bf16 v[88:91], a[128:131], a[88:91], v[88:91]
v_mfma_f32_16x16x32_bf16 v[92:95], a[128:131], a[96:99], v[92:95]
v_mfma_f32_16x16x32_bf16 v[92:95], a[132:135], a[100:103], v[92:95]
v_mfma_f32_16x16x32_bf16 v[96:99], a[132:135], a[108:111], v[96:99]
buffer_load_dwordx4 v11, s[12:15], s58 offen offset:3072 lds
v_mfma_f32_16x16x32_bf16 v[96:99], a[128:131], a[104:107], v[96:99]
v_mfma_f32_16x16x32_bf16 v[100:103], a[128:131], a[112:115], v[100:103]
v_mfma_f32_16x16x32_bf16 v[100:103], a[132:135], a[116:119], v[100:103]
v_mfma_f32_16x16x32_bf16 v[104:107], a[132:135], a[124:127], v[104:107]
v_mfma_f32_16x16x32_bf16 v[104:107], a[128:131], a[120:123], v[104:107]
s_waitcnt lgkmcnt(0)
s_mov_b32 s88, 3932160
buffer_load_dword v255, v34, s[16:19], s88 offen
v_mfma_f32_16x16x32_bf16 a[228:231], a[136:139], a[120:123], a[228:231]
s_waitcnt vmcnt(19) lgkmcnt(0)
s_barrier
ds_read_b64_tr_b16 a[128:129], v4 offset:49152
v_mfma_f32_16x16x32_bf16 a[228:231], a[140:143], a[124:127], a[228:231]
ds_read_b64_tr_b16 a[130:131], v4 offset:50176
ds_read_b64_tr_b16 a[132:133], v4 offset:57344
v_mfma_f32_16x16x32_bf16 a[224:227], a[140:143], a[116:119], a[224:227]
ds_read_b64_tr_b16 a[134:135], v4 offset:58368
v_mfma_f32_16x16x32_bf16 a[224:227], a[136:139], a[112:115], a[224:227]
v_mfma_f32_16x16x32_bf16 a[220:223], a[136:139], a[104:107], a[220:223]
s_add_u32 s88, s67, 1658880
ds_read_b128 a[0:3], v2 offset:0
v_mfma_f32_16x16x32_bf16 a[220:223], a[140:143], a[108:111], a[220:223]
buffer_load_dword v255, v35, s[32:35], s88 offen
v_mfma_f32_16x16x32_bf16 a[216:219], a[140:143], a[100:103], a[216:219]
v_mfma_f32_16x16x32_bf16 a[216:219], a[136:139], a[96:99], a[216:219]
ds_read_b128 a[4:7], v3 offset:0
v_mfma_f32_16x16x32_bf16 a[188:191], a[136:139], a[88:91], a[188:191]
v_mfma_f32_16x16x32_bf16 a[188:191], a[140:143], a[92:95], a[188:191]
s_add_u32 m0, s57, 32768
s_xor_b32 s59, s100, 7
s_cmp_eq_u32 s101, 0
v_mfma_f32_16x16x32_bf16 a[184:187], a[140:143], a[84:87], a[184:187]
s_cselect_b32 s59, s59, 1
s_lshl_b32 s59, s59, 19
ds_read_b128 a[8:11], v2 offset:2048
v_mfma_f32_16x16x32_bf16 a[184:187], a[136:139], a[80:83], a[184:187]
buffer_load_dwordx4 v12, s[20:23], s59 offen offset:0 lds
v_mfma_f32_16x16x32_bf16 a[180:183], a[136:139], a[72:75], a[180:183]
v_mfma_f32_16x16x32_bf16 a[180:183], a[140:143], a[76:79], a[180:183]
ds_read_b128 a[12:15], v3 offset:2048
v_mfma_f32_16x16x32_bf16 a[176:179], a[140:143], a[68:71], a[176:179]
buffer_load_dwordx4 v13, s[20:23], s59 offen offset:1024 lds
v_mfma_f32_16x16x32_bf16 a[176:179], a[136:139], a[64:67], a[176:179]
s_waitcnt lgkmcnt(3)
v_mfma_f32_16x16x32_bf16 v[108:111], a[64:67], a[128:131], v[108:111]
ds_read_b64_tr_b16 a[136:137], v5 offset:49152
ds_read_b64_tr_b16 a[138:139], v5 offset:50176
v_mfma_f32_16x16x32_bf16 v[108:111], a[68:71], a[132:135], v[108:111]
ds_read_b64_tr_b16 a[140:141], v5 offset:57344
ds_read_b64_tr_b16 a[142:143], v5 offset:58368
v_mfma_f32_16x16x32_bf16 v[116:119], a[76:79], a[132:135], v[116:119]
ds_read_b128 a[16:19], v2 offset:4096
v_mfma_f32_16x16x32_bf16 v[116:119], a[72:75], a[128:131], v[116:119]
ds_read_b128 a[20:23], v3 offset:4096
v_mfma_f32_16x16x32_bf16 a[232:235], a[80:83], a[128:131], a[232:235]
buffer_load_dwordx4 v14, s[20:23], s59 offen offset:2048 lds
v_mfma_f32_16x16x32_bf16 a[232:235], a[84:87], a[132:135], a[232:235]
v_mfma_f32_16x16x32_bf16 a[240:243], a[92:95], a[132:135], a[240:243]
ds_read_b128 a[24:27], v2 offset:6144
v_mfma_f32_16x16x32_bf16 a[240:243], a[88:91], a[128:131], a[240:243]
v_mfma_f32_16x16x32_bf16 v[112:115], a[96:99], a[128:131], v[112:115]
buffer_load_dwordx4 v15, s[20:23], s59 offen offset:3072 lds
v_mfma_f32_16x16x32_bf16 v[112:115], a[100:103], a[132:135], v[112:115]
ds_read_b128 a[28:31], v3 offset:6144
v_mfma_f32_16x16x32_bf16 v[120:123], a[108:111], a[132:135], v[120:123]
v_mfma_f32_16x16x32_bf16 v[120:123], a[104:107], a[128:131], v[120:123]
v_mfma_f32_16x16x32_bf16 a[236:239], a[112:115], a[128:131], a[236:239]
ds_read_b128 a[32:35], v2 offset:8192
v_mfma_f32_16x16x32_bf16 a[236:239], a[116:119], a[132:135], a[236:239]
v_mfma_f32_16x16x32_bf16 a[244:247], a[124:127], a[132:135], a[244:247]
v_mfma_f32_16x16x32_bf16 a[244:247], a[120:123], a[128:131], a[244:247]
s_waitcnt lgkmcnt(3)
ds_read_b128 a[36:39], v3 offset:8192
v_mfma_f32_16x16x32_bf16 v[176:179], a[120:123], a[136:139], v[176:179]
ds_read_b64_tr_b16 a[128:129], v6 offset:49152
ds_read_b64_tr_b16 a[130:131], v6 offset:50176
v_mfma_f32_16x16x32_bf16 v[176:179], a[124:127], a[140:143], v[176:179]
ds_read_b64_tr_b16 a[132:133], v6 offset:57344
ds_read_b64_tr_b16 a[134:135], v6 offset:58368
v_mfma_f32_16x16x32_bf16 a[252:255], a[116:119], a[140:143], a[252:255]
ds_read_b128 a[40:43], v2 offset:10240
v_mfma_f32_16x16x32_bf16 a[252:255], a[112:115], a[136:139], a[252:255]
v_mfma_f32_16x16x32_bf16 v[136:139], a[104:107], a[136:139], v[136:139]
v_mfma_f32_16x16x32_bf16 v[136:139], a[108:111], a[140:143], v[136:139]
ds_read_b128 a[44:47], v3 offset:10240
v_mfma_f32_16x16x32_bf16 v[128:131], a[100:103], a[140:143], v[128:131]
v_mfma_f32_16x16x32_bf16 v[128:131], a[96:99], a[136:139], v[128:131]
v_mfma_f32_16x16x32_bf16 v[172:175], a[88:91], a[136:139], v[172:175]
ds_read_b128 a[48:51], v2 offset:12288
v_mfma_f32_16x16x32_bf16 v[172:175], a[92:95], a[140:143], v[172:175]
v_mfma_f32_16x16x32_bf16 a[248:251], a[84:87], a[140:143], a[248:251]
v_mfma_f32_16x16x32_bf16 a[248:251], a[80:83], a[136:139], a[248:251]
ds_read_b128 a[52:55], v3 offset:12288
v_mfma_f32_16x16x32_bf16 v[132:135], a[72:75], a[136:139], v[132:135]
v_mfma_f32_16x16x32_bf16 v[132:135], a[76:79], a[140:143], v[132:135]
v_mfma_f32_16x16x32_bf16 v[124:127], a[68:71], a[140:143], v[124:127]
ds_read_b128 a[56:59], v2 offset:14336
v_mfma_f32_16x16x32_bf16 v[124:127], a[64:67], a[136:139], v[124:127]
s_waitcnt lgkmcnt(3)
v_mfma_f32_16x16x32_bf16 v[140:143], a[64:67], a[128:131], v[140:143]
ds_read_b64_tr_b16 a[136:137], v7 offset:49152
ds_read_b64_tr_b16 a[138:139], v7 offset:50176
v_mfma_f32_16x16x32_bf16 v[140:143], a[68:71], a[132:135], v[140:143]
ds_read_b64_tr_b16 a[140:141], v7 offset:57344
ds_read_b64_tr_b16 a[142:143], v7 offset:58368
v_mfma_f32_16x16x32_bf16 v[148:151], a[76:79], a[132:135], v[148:151]
ds_read_b128 a[60:63], v3 offset:14336
v_mfma_f32_16x16x32_bf16 v[148:151], a[72:75], a[128:131], v[148:151]
v_mfma_f32_16x16x32_bf16 v[180:183], a[80:83], a[128:131], v[180:183]
v_mfma_f32_16x16x32_bf16 v[180:183], a[84:87], a[132:135], v[180:183]
v_mfma_f32_16x16x32_bf16 v[188:191], a[92:95], a[132:135], v[188:191]
v_mfma_f32_16x16x32_bf16 v[188:191], a[88:91], a[128:131], v[188:191]
v_mfma_f32_16x16x32_bf16 v[144:147], a[96:99], a[128:131], v[144:147]
v_mfma_f32_16x16x32_bf16 v[144:147], a[100:103], a[132:135], v[144:147]
v_mfma_f32_16x16x32_bf16 v[152:155], a[108:111], a[132:135], v[152:155]
v_mfma_f32_16x16x32_bf16 v[152:155], a[104:107], a[128:131], v[152:155]
v_mfma_f32_16x16x32_bf16 v[184:187], a[112:115], a[128:131], v[184:187]
v_mfma_f32_16x16x32_bf16 v[184:187], a[116:119], a[132:135], v[184:187]
v_mfma_f32_16x16x32_bf16 v[192:195], a[124:127], a[132:135], v[192:195]
v_mfma_f32_16x16x32_bf16 v[192:195], a[120:123], a[128:131], v[192:195]
s_waitcnt lgkmcnt(0)
v_mfma_f32_16x16x32_bf16 v[208:211], a[120:123], a[136:139], v[208:211]
s_waitcnt vmcnt(18) lgkmcnt(0)
s_barrier
ds_read_b64_tr_b16 a[128:129], v4 offset:0
v_mfma_f32_16x16x32_bf16 v[208:211], a[124:127], a[140:143], v[208:211]
ds_read_b64_tr_b16 a[130:131], v4 offset:1024
ds_read_b64_tr_b16 a[132:133], v4 offset:8192
v_mfma_f32_16x16x32_bf16 v[200:203], a[116:119], a[140:143], v[200:203]
ds_read_b64_tr_b16 a[134:135], v4 offset:9216
v_mfma_f32_16x16x32_bf16 v[200:203], a[112:115], a[136:139], v[200:203]
s_add_u32 m0, s57, 49152
s_xor_b32 s59, s100, 7
s_cmp_eq_u32 s101, 0
v_mfma_f32_16x16x32_bf16 v[168:171], a[104:107], a[136:139], v[168:171]
s_cselect_b32 s59, s59, 1
s_lshl_b32 s59, s59, 19
v_mfma_f32_16x16x32_bf16 v[168:171], a[108:111], a[140:143], v[168:171]
buffer_load_dwordx4 v12, s[24:27], s59 offen offset:0 lds
v_mfma_f32_16x16x32_bf16 v[160:163], a[100:103], a[140:143], v[160:163]
v_mfma_f32_16x16x32_bf16 v[160:163], a[96:99], a[136:139], v[160:163]
v_mfma_f32_16x16x32_bf16 v[204:207], a[88:91], a[136:139], v[204:207]
buffer_load_dwordx4 v13, s[24:27], s59 offen offset:1024 lds
v_mfma_f32_16x16x32_bf16 v[204:207], a[92:95], a[140:143], v[204:207]
v_mfma_f32_16x16x32_bf16 v[196:199], a[84:87], a[140:143], v[196:199]
v_mfma_f32_16x16x32_bf16 v[196:199], a[80:83], a[136:139], v[196:199]
v_mfma_f32_16x16x32_bf16 v[164:167], a[72:75], a[136:139], v[164:167]
v_mfma_f32_16x16x32_bf16 v[164:167], a[76:79], a[140:143], v[164:167]
buffer_load_dwordx4 v14, s[24:27], s59 offen offset:2048 lds
v_mfma_f32_16x16x32_bf16 v[156:159], a[68:71], a[140:143], v[156:159]
v_mfma_f32_16x16x32_bf16 v[156:159], a[64:67], a[136:139], v[156:159]
s_waitcnt lgkmcnt(0)
v_mfma_f32_16x16x32_bf16 v[44:47], a[128:131], a[0:3], v[44:47]
ds_read_b64_tr_b16 a[136:137], v5 offset:0
ds_read_b64_tr_b16 a[138:139], v5 offset:1024
v_mfma_f32_16x16x32_bf16 v[44:47], a[132:135], a[4:7], v[44:47]
ds_read_b64_tr_b16 a[140:141], v5 offset:8192
ds_read_b64_tr_b16 a[142:143], v5 offset:9216
v_mfma_f32_16x16x32_bf16 v[48:51], a[132:135], a[12:15], v[48:51]
buffer_load_dwordx4 v15, s[24:27], s59 offen offset:3072 lds
v_mfma_f32_16x16x32_bf16 v[48:51], a[128:131], a[8:11], v[48:51]
v_mfma_f32_16x16x32_bf16 v[52:55], a[128:131], a[16:19], v[52:55]
v_mfma_f32_16x16x32_bf16 v[52:55], a[132:135], a[20:23], v[52:55]
v_mfma_f32_16x16x32_bf16 v[56:59], a[132:135], a[28:31], v[56:59]
v_mfma_f32_16x16x32_bf16 v[56:59], a[128:131], a[24:27], v[56:59]
s_add_u32 m0, s65, 0
s_add_u32 s3, s93, 0
s_and_b32 s3, s3, 7
v_mfma_f32_16x16x32_bf16 v[60:63], a[128:131], a[32:35], v[60:63]
s_xor_b32 s3, s3, s94
s_lshl_b32 s3, s3, 19
v_mfma_f32_16x16x32_bf16 v[60:63], a[132:135], a[36:39], v[60:63]
buffer_load_dwordx4 v12, s[16:19], s3 offen offset:0 lds
v_mfma_f32_16x16x32_bf16 v[64:67], a[132:135], a[44:47], v[64:67]
v_mfma_f32_16x16x32_bf16 v[64:67], a[128:131], a[40:43], v[64:67]
v_mfma_f32_16x16x32_bf16 v[68:71], a[128:131], a[48:51], v[68:71]
buffer_load_dwordx4 v13, s[16:19], s3 offen offset:1024 lds
v_mfma_f32_16x16x32_bf16 v[68:71], a[132:135], a[52:55], v[68:71]
v_mfma_f32_16x16x32_bf16 v[72:75], a[132:135], a[60:63], v[72:75]
v_mfma_f32_16x16x32_bf16 v[72:75], a[128:131], a[56:59], v[72:75]
s_waitcnt lgkmcnt(0)
v_mfma_f32_16x16x32_bf16 a[172:175], a[136:139], a[56:59], a[172:175]
ds_read_b64_tr_b16 a[128:129], v6 offset:0
ds_read_b64_tr_b16 a[130:131], v6 offset:1024
v_mfma_f32_16x16x32_bf16 a[172:175], a[140:143], a[60:63], a[172:175]
ds_read_b64_tr_b16 a[132:133], v6 offset:8192
ds_read_b64_tr_b16 a[134:135], v6 offset:9216
v_mfma_f32_16x16x32_bf16 a[168:171], a[140:143], a[52:55], a[168:171]
buffer_load_dwordx4 v14, s[16:19], s3 offen offset:2048 lds
v_mfma_f32_16x16x32_bf16 a[168:171], a[136:139], a[48:51], a[168:171]
v_mfma_f32_16x16x32_bf16 a[164:167], a[136:139], a[40:43], a[164:167]
v_mfma_f32_16x16x32_bf16 a[164:167], a[140:143], a[44:47], a[164:167]
v_mfma_f32_16x16x32_bf16 a[160:163], a[140:143], a[36:39], a[160:163]
buffer_load_dwordx4 v15, s[16:19], s3 offen offset:3072 lds
v_mfma_f32_16x16x32_bf16 a[160:163], a[136:139], a[32:35], a[160:163]
v_mfma_f32_16x16x32_bf16 a[156:159], a[136:139], a[24:27], a[156:159]
v_mfma_f32_16x16x32_bf16 a[156:159], a[140:143], a[28:31], a[156:159]
v_mfma_f32_16x16x32_bf16 a[152:155], a[140:143], a[20:23], a[152:155]
v_mfma_f32_16x16x32_bf16 a[152:155], a[136:139], a[16:19], a[152:155]
s_add_u32 m0, s66, 16384
s_add_u32 s3, s93, 0
s_and_b32 s3, s3, 7
v_mfma_f32_16x16x32_bf16 a[148:151], a[136:139], a[8:11], a[148:151]
s_xor_b32 s3, s3, s94
s_mul_i32 s3, s3, 221184
s_add_u32 s3, s3, s67
v_mfma_f32_16x16x32_bf16 a[148:151], a[140:143], a[12:15], a[148:151]
buffer_load_dwordx4 v20, s[32:35], s3 offen offset:0 lds
v_mfma_f32_16x16x32_bf16 a[144:147], a[140:143], a[4:7], a[144:147]
v_mfma_f32_16x16x32_bf16 a[144:147], a[136:139], a[0:3], a[144:147]
s_waitcnt lgkmcnt(0)
v_mfma_f32_16x16x32_bf16 v[76:79], a[128:131], a[0:3], v[76:79]
ds_read_b64_tr_b16 a[136:137], v7 offset:0
ds_read_b64_tr_b16 a[138:139], v7 offset:1024
v_mfma_f32_16x16x32_bf16 v[76:79], a[132:135], a[4:7], v[76:79]
ds_read_b64_tr_b16 a[140:141], v7 offset:8192
ds_read_b64_tr_b16 a[142:143], v7 offset:9216
v_mfma_f32_16x16x32_bf16 v[80:83], a[132:135], a[12:15], v[80:83]
buffer_load_dwordx4 v21, s[32:35], s3 offen offset:1024 lds
v_mfma_f32_16x16x32_bf16 v[80:83], a[128:131], a[8:11], v[80:83]
v_mfma_f32_16x16x32_bf16 v[84:87], a[128:131], a[16:19], v[84:87]
v_mfma_f32_16x16x32_bf16 v[84:87], a[132:135], a[20:23], v[84:87]
buffer_load_dword v43, v37, s[4:7], 0 offen sc1
v_mfma_f32_16x16x32_bf16 v[88:91], a[132:135], a[28:31], v[88:91]
v_mfma_f32_16x16x32_bf16 v[88:91], a[128:131], a[24:27], v[88:91]
v_mfma_f32_16x16x32_bf16 v[92:95], a[128:131], a[32:35], v[92:95]
v_mfma_f32_16x16x32_bf16 v[92:95], a[132:135], a[36:39], v[92:95]
v_mfma_f32_16x16x32_bf16 v[96:99], a[132:135], a[44:47], v[96:99]
v_mfma_f32_16x16x32_bf16 v[96:99], a[128:131], a[40:43], v[96:99]
v_mfma_f32_16x16x32_bf16 v[100:103], a[128:131], a[48:51], v[100:103]
v_mfma_f32_16x16x32_bf16 v[100:103], a[132:135], a[52:55], v[100:103]
v_mfma_f32_16x16x32_bf16 v[104:107], a[132:135], a[60:63], v[104:107]
v_mfma_f32_16x16x32_bf16 v[104:107], a[128:131], a[56:59], v[104:107]
s_waitcnt lgkmcnt(0)
v_mfma_f32_16x16x32_bf16 a[228:231], a[136:139], a[56:59], a[228:231]
s_waitcnt vmcnt(17) lgkmcnt(0)
s_barrier
ds_read_b64_tr_b16 a[128:129], v4 offset:16384
v_mfma_f32_16x16x32_bf16 a[228:231], a[140:143], a[60:63], a[228:231]
ds_read_b64_tr_b16 a[130:131], v4 offset:17408
ds_read_b64_tr_b16 a[132:133], v4 offset:24576
v_mfma_f32_16x16x32_bf16 a[224:227], a[140:143], a[52:55], a[224:227]
ds_read_b64_tr_b16 a[134:135], v4 offset:25600
v_mfma_f32_16x16x32_bf16 a[224:227], a[136:139], a[48:51], a[224:227]
v_mfma_f32_16x16x32_bf16 a[220:223], a[136:139], a[40:43], a[220:223]
ds_read_b128 a[64:67], v2 offset:32768
v_mfma_f32_16x16x32_bf16 a[220:223], a[140:143], a[44:47], a[220:223]
v_mfma_f32_16x16x32_bf16 a[216:219], a[140:143], a[36:39], a[216:219]
v_mfma_f32_16x16x32_bf16 a[216:219], a[136:139], a[32:35], a[216:219]
ds_read_b128 a[68:71], v3 offset:32768
v_mfma_f32_16x16x32_bf16 a[188:191], a[136:139], a[24:27], a[188:191]
v_mfma_f32_16x16x32_bf16 a[188:191], a[140:143], a[28:31], a[188:191]
v_mfma_f32_16x16x32_bf16 a[184:187], a[140:143], a[20:23], a[184:187]
ds_read_b128 a[72:75], v2 offset:34816
v_mfma_f32_16x16x32_bf16 a[184:187], a[136:139], a[16:19], a[184:187]
v_mfma_f32_16x16x32_bf16 a[180:183], a[136:139], a[8:11], a[180:183]
v_mfma_f32_16x16x32_bf16 a[180:183], a[140:143], a[12:15], a[180:183]
ds_read_b128 a[76:79], v3 offset:34816
v_mfma_f32_16x16x32_bf16 a[176:179], a[140:143], a[4:7], a[176:179]
v_mfma_f32_16x16x32_bf16 a[176:179], a[136:139], a[0:3], a[176:179]
s_waitcnt lgkmcnt(3)
v_mfma_f32_16x16x32_bf16 v[108:111], a[0:3], a[128:131], v[108:111]
ds_read_b64_tr_b16 a[136:137], v5 offset:16384
ds_read_b64_tr_b16 a[138:139], v5 offset:17408
v_mfma_f32_16x16x32_bf16 v[108:111], a[4:7], a[132:135], v[108:111]
ds_read_b64_tr_b16 a[140:141], v5 offset:24576
ds_read_b64_tr_b16 a[142:143], v5 offset:25600
v_mfma_f32_16x16x32_bf16 v[116:119], a[12:15], a[132:135], v[116:119]
ds_read_b128 a[80:83], v2 offset:36864
v_mfma_f32_16x16x32_bf16 v[116:119], a[8:11], a[128:131], v[116:119]
ds_read_b128 a[84:87], v3 offset:36864
v_mfma_f32_16x16x32_bf16 a[232:235], a[16:19], a[128:131], a[232:235]
v_mfma_f32_16x16x32_bf16 a[232:235], a[20:23], a[132:135], a[232:235]
v_mfma_f32_16x16x32_bf16 a[240:243], a[28:31], a[132:135], a[240:243]
ds_read_b128 a[88:91], v2 offset:38912
v_mfma_f32_16x16x32_bf16 a[240:243], a[24:27], a[128:131], a[240:243]
v_mfma_f32_16x16x32_bf16 v[112:115], a[32:35], a[128:131], v[112:115]
v_mfma_f32_16x16x32_bf16 v[112:115], a[36:39], a[132:135], v[112:115]
ds_read_b128 a[92:95], v3 offset:38912
v_mfma_f32_16x16x32_bf16 v[120:123], a[44:47], a[132:135], v[120:123]
v_mfma_f32_16x16x32_bf16 v[120:123], a[40:43], a[128:131], v[120:123]
v_mfma_f32_16x16x32_bf16 a[236:239], a[48:51], a[128:131], a[236:239]
ds_read_b128 a[96:99], v2 offset:40960
v_mfma_f32_16x16x32_bf16 a[236:239], a[52:55], a[132:135], a[236:239]
v_mfma_f32_16x16x32_bf16 a[244:247], a[60:63], a[132:135], a[244:247]
v_mfma_f32_16x16x32_bf16 a[244:247], a[56:59], a[128:131], a[244:247]
s_waitcnt lgkmcnt(3)
ds_read_b128 a[100:103], v3 offset:40960
v_mfma_f32_16x16x32_bf16 v[176:179], a[56:59], a[136:139], v[176:179]
ds_read_b64_tr_b16 a[128:129], v6 offset:16384
ds_read_b64_tr_b16 a[130:131], v6 offset:17408
v_mfma_f32_16x16x32_bf16 v[176:179], a[60:63], a[140:143], v[176:179]
ds_read_b64_tr_b16 a[132:133], v6 offset:24576
ds_read_b64_tr_b16 a[134:135], v6 offset:25600
v_mfma_f32_16x16x32_bf16 a[252:255], a[52:55], a[140:143], a[252:255]
ds_read_b128 a[104:107], v2 offset:43008
v_mfma_f32_16x16x32_bf16 a[252:255], a[48:51], a[136:139], a[252:255]
v_mfma_f32_16x16x32_bf16 v[136:139], a[40:43], a[136:139], v[136:139]
v_mfma_f32_16x16x32_bf16 v[136:139], a[44:47], a[140:143], v[136:139]
ds_read_b128 a[108:111], v3 offset:43008
v_mfma_f32_16x16x32_bf16 v[128:131], a[36:39], a[140:143], v[128:131]
v_mfma_f32_16x16x32_bf16 v[128:131], a[32:35], a[136:139], v[128:131]
v_mfma_f32_16x16x32_bf16 v[172:175], a[24:27], a[136:139], v[172:175]
s_mov_b32 s90, -1
ds_read_b128 a[112:115], v2 offset:45056
s_waitcnt vmcnt(0)
v_cmp_ne_u32 vcc, 1, v43
v_mfma_f32_16x16x32_bf16 v[172:175], a[28:31], a[140:143], v[172:175]
v_mfma_f32_16x16x32_bf16 a[248:251], a[20:23], a[140:143], a[248:251]
v_mfma_f32_16x16x32_bf16 a[248:251], a[16:19], a[136:139], a[248:251]
ds_read_b128 a[116:119], v3 offset:45056
v_mfma_f32_16x16x32_bf16 v[132:135], a[8:11], a[136:139], v[132:135]
v_mfma_f32_16x16x32_bf16 v[132:135], a[12:15], a[140:143], v[132:135]
v_mfma_f32_16x16x32_bf16 v[124:127], a[4:7], a[140:143], v[124:127]
ds_read_b128 a[120:123], v2 offset:47104
v_mfma_f32_16x16x32_bf16 v[124:127], a[0:3], a[136:139], v[124:127]
s_waitcnt lgkmcnt(3)
v_mfma_f32_16x16x32_bf16 v[140:143], a[0:3], a[128:131], v[140:143]
ds_read_b64_tr_b16 a[136:137], v7 offset:16384
ds_read_b64_tr_b16 a[138:139], v7 offset:17408
v_mfma_f32_16x16x32_bf16 v[140:143], a[4:7], a[132:135], v[140:143]
ds_read_b64_tr_b16 a[140:141], v7 offset:24576
ds_read_b64_tr_b16 a[142:143], v7 offset:25600
v_mfma_f32_16x16x32_bf16 v[148:151], a[12:15], a[132:135], v[148:151]
ds_read_b128 a[124:127], v3 offset:47104
v_mfma_f32_16x16x32_bf16 v[148:151], a[8:11], a[128:131], v[148:151]
v_mfma_f32_16x16x32_bf16 v[180:183], a[16:19], a[128:131], v[180:183]
v_mfma_f32_16x16x32_bf16 v[180:183], a[20:23], a[132:135], v[180:183]
v_mfma_f32_16x16x32_bf16 v[188:191], a[28:31], a[132:135], v[188:191]
s_and_b64 vcc, vcc, s[90:91]
v_mfma_f32_16x16x32_bf16 v[188:191], a[24:27], a[128:131], v[188:191]
v_mfma_f32_16x16x32_bf16 v[144:147], a[32:35], a[128:131], v[144:147]
v_mfma_f32_16x16x32_bf16 v[144:147], a[36:39], a[132:135], v[144:147]
v_mfma_f32_16x16x32_bf16 v[152:155], a[44:47], a[132:135], v[152:155]
s_cbranch_vccnz L_slow_xn
L_slow_xn_back:
v_mfma_f32_16x16x32_bf16 v[152:155], a[40:43], a[128:131], v[152:155]
v_mfma_f32_16x16x32_bf16 v[184:187], a[48:51], a[128:131], v[184:187]
v_mfma_f32_16x16x32_bf16 v[184:187], a[52:55], a[132:135], v[184:187]
v_mfma_f32_16x16x32_bf16 v[192:195], a[60:63], a[132:135], v[192:195]
v_mfma_f32_16x16x32_bf16 v[192:195], a[56:59], a[128:131], v[192:195]
s_waitcnt lgkmcnt(0)
s_lshl_b32 s51, s49, 19
s_lshl_b32 s52, s50, 16
s_add_u32 s51, s51, s52
v_mfma_f32_16x16x32_bf16 v[208:211], a[56:59], a[136:139], v[208:211]
s_waitcnt vmcnt(63) lgkmcnt(0)
s_barrier
ds_read_b64_tr_b16 a[128:129], v4 offset:32768
v_mfma_f32_16x16x32_bf16 v[208:211], a[60:63], a[140:143], v[208:211]
s_lshl_b32 s52, s55, 15
ds_read_b64_tr_b16 a[130:131], v4 offset:33792
ds_read_b64_tr_b16 a[132:133], v4 offset:40960
v_mfma_f32_16x16x32_bf16 v[200:203], a[52:55], a[140:143], v[200:203]
s_add_u32 s51, s51, s52
s_lshl_b32 s52, s54, 11
ds_read_b64_tr_b16 a[134:135], v4 offset:41984
v_mfma_f32_16x16x32_bf16 v[200:203], a[48:51], a[136:139], v[200:203]
s_add_u32 s60, s51, s52
s_add_u32 s60, s60, 4194304
s_lshl_b32 s52, s54, 13
v_mfma_f32_16x16x32_bf16 v[168:171], a[40:43], a[136:139], v[168:171]
s_add_u32 s61, s51, s52
s_add_u32 s61, s61, 20971520
s_add_u32 m0, s65, 24576
v_mfma_f32_16x16x32_bf16 v[168:171], a[44:47], a[140:143], v[168:171]
s_add_u32 s3, s93, 1
s_and_b32 s3, s3, 7
s_xor_b32 s3, s3, s94
v_mfma_f32_16x16x32_bf16 v[160:163], a[36:39], a[140:143], v[160:163]
s_lshl_b32 s3, s3, 19
buffer_load_dwordx4 v12, s[16:19], s3 offen offset:0 lds
v_mfma_f32_16x16x32_bf16 v[160:163], a[32:35], a[136:139], v[160:163]
buffer_load_dwordx4 v13, s[16:19], s3 offen offset:1024 lds
v_mfma_f32_16x16x32_bf16 v[204:207], a[24:27], a[136:139], v[204:207]
v_mfma_f32_16x16x32_bf16 v[204:207], a[28:31], a[140:143], v[204:207]
v_mfma_f32_16x16x32_bf16 v[196:199], a[20:23], a[140:143], v[196:199]
v_mfma_f32_16x16x32_bf16 v[196:199], a[16:19], a[136:139], v[196:199]
buffer_load_dwordx4 v14, s[16:19], s3 offen offset:2048 lds
v_mfma_f32_16x16x32_bf16 v[164:167], a[8:11], a[136:139], v[164:167]
v_mfma_f32_16x16x32_bf16 v[164:167], a[12:15], a[140:143], v[164:167]
v_mfma_f32_16x16x32_bf16 v[156:159], a[4:7], a[140:143], v[156:159]
v_mfma_f32_16x16x32_bf16 v[156:159], a[0:3], a[136:139], v[156:159]
s_waitcnt lgkmcnt(0)
buffer_load_dwordx4 v15, s[16:19], s3 offen offset:3072 lds
v_mfma_f32_16x16x32_bf16 v[44:47], a[128:131], a[64:67], v[44:47]
ds_read_b64_tr_b16 a[136:137], v5 offset:32768
ds_read_b64_tr_b16 a[138:139], v5 offset:33792
v_mfma_f32_16x16x32_bf16 v[44:47], a[132:135], a[68:71], v[44:47]
ds_read_b64_tr_b16 a[140:141], v5 offset:40960
ds_read_b64_tr_b16 a[142:143], v5 offset:41984
v_mfma_f32_16x16x32_bf16 v[48:51], a[132:135], a[76:79], v[48:51]
v_mfma_f32_16x16x32_bf16 v[48:51], a[128:131], a[72:75], v[48:51]
s_add_u32 m0, s66, 40960
s_add_u32 s3, s93, 1
s_and_b32 s3, s3, 7
v_mfma_f32_16x16x32_bf16 v[52:55], a[128:131], a[80:83], v[52:55]
s_xor_b32 s3, s3, s94
s_mul_i32 s3, s3, 221184
s_add_u32 s3, s3, s67
v_mfma_f32_16x16x32_bf16 v[52:55], a[132:135], a[84:87], v[52:55]
buffer_load_dwordx4 v20, s[32:35], s3 offen offset:0 lds
v_mfma_f32_16x16x32_bf16 v[56:59], a[132:135], a[92:95], v[56:59]
v_mfma_f32_16x16x32_bf16 v[56:59], a[128:131], a[88:91], v[56:59]
buffer_load_dwordx4 v21, s[32:35], s3 offen offset:1024 lds
v_mfma_f32_16x16x32_bf16 v[60:63], a[128:131], a[96:99], v[60:63]
v_mfma_f32_16x16x32_bf16 v[60:63], a[132:135], a[100:103], v[60:63]
v_mfma_f32_16x16x32_bf16 v[64:67], a[132:135], a[108:111], v[64:67]
v_mfma_f32_16x16x32_bf16 v[64:67], a[128:131], a[104:107], v[64:67]
s_add_u32 m0, s65, 49152
s_add_u32 s3, s93, 2
s_and_b32 s3, s3, 7
v_mfma_f32_16x16x32_bf16 v[68:71], a[128:131], a[112:115], v[68:71]
s_xor_b32 s3, s3, s94
s_lshl_b32 s3, s3, 19
v_mfma_f32_16x16x32_bf16 v[68:71], a[132:135], a[116:119], v[68:71]
buffer_load_dwordx4 v12, s[16:19], s3 offen offset:0 lds
v_mfma_f32_16x16x32_bf16 v[72:75], a[132:135], a[124:127], v[72:75]
v_mfma_f32_16x16x32_bf16 v[72:75], a[128:131], a[120:123], v[72:75]
s_waitcnt lgkmcnt(0)
buffer_load_dwordx4 v13, s[16:19], s3 offen offset:1024 lds
v_mfma_f32_16x16x32_bf16 a[144:147], a[136:139], a[64:67], a[144:147]
ds_read_b64_tr_b16 a[128:129], v6 offset:32768
ds_read_b64_tr_b16 a[130:131], v6 offset:33792
v_mfma_f32_16x16x32_bf16 a[144:147], a[140:143], a[68:71], a[144:147]
ds_read_b64_tr_b16 a[132:133], v6 offset:40960
ds_read_b64_tr_b16 a[134:135], v6 offset:41984
v_mfma_f32_16x16x32_bf16 a[148:151], a[140:143], a[76:79], a[148:151]
v_mfma_f32_16x16x32_bf16 a[148:151], a[136:139], a[72:75], a[148:151]
buffer_load_dwordx4 v14, s[16:19], s3 offen offset:2048 lds
v_mfma_f32_16x16x32_bf16 a[152:155], a[136:139], a[80:83], a[152:155]
v_mfma_f32_16x16x32_bf16 a[152:155], a[140:143], a[84:87], a[152:155]
v_mfma_f32_16x16x32_bf16 a[156:159], a[140:143], a[92:95], a[156:159]
v_mfma_f32_16x16x32_bf16 a[156:159], a[136:139], a[88:91], a[156:159]
buffer_load_dwordx4 v15, s[16:19], s3 offen offset:3072 lds
v_mfma_f32_16x16x32_bf16 a[160:163], a[136:139], a[96:99], a[160:163]
v_cvt_pk_bf16_f32 v44, v44, v45
v_cvt_pk_bf16_f32 v45, v46, v47
v_mfma_f32_16x16x32_bf16 a[160:163], a[140:143], a[100:103], a[160:163]
v_accvgpr_read_b32 v46, a144
v_accvgpr_read_b32 v47, a145
v_mfma_f32_16x16x32_bf16 a[164:167], a[140:143], a[108:111], a[164:167]
v_accvgpr_read_b32 v252, a146
v_accvgpr_read_b32 v253, a147
v_mfma_f32_16x16x32_bf16 a[164:167], a[136:139], a[104:107], a[164:167]
s_add_u32 m0, s66, 65536
s_add_u32 s3, s93, 2
s_and_b32 s3, s3, 7
v_mfma_f32_16x16x32_bf16 a[168:171], a[136:139], a[112:115], a[168:171]
s_xor_b32 s3, s3, s94
s_mul_i32 s3, s3, 221184
s_add_u32 s3, s3, s67
v_mfma_f32_16x16x32_bf16 a[168:171], a[140:143], a[116:119], a[168:171]
buffer_load_dwordx4 v20, s[32:35], s3 offen offset:0 lds
v_mfma_f32_16x16x32_bf16 a[172:175], a[140:143], a[124:127], a[172:175]
v_cvt_pk_bf16_f32 v46, v46, v47
v_cvt_pk_bf16_f32 v47, v252, v253
v_mfma_f32_16x16x32_bf16 a[172:175], a[136:139], a[120:123], a[172:175]
s_waitcnt lgkmcnt(0)
buffer_load_dwordx4 v21, s[32:35], s3 offen offset:1024 lds
v_mfma_f32_16x16x32_bf16 v[76:79], a[128:131], a[64:67], v[76:79]
ds_read_b64_tr_b16 a[136:137], v7 offset:32768
ds_read_b64_tr_b16 a[138:139], v7 offset:33792
v_mfma_f32_16x16x32_bf16 v[76:79], a[132:135], a[68:71], v[76:79]
ds_read_b64_tr_b16 a[140:141], v7 offset:40960
ds_read_b64_tr_b16 a[142:143], v7 offset:41984
v_mfma_f32_16x16x32_bf16 v[80:83], a[132:135], a[76:79], v[80:83]
v_cvt_pk_bf16_f32 v48, v48, v49
v_cvt_pk_bf16_f32 v49, v50, v51
v_mfma_f32_16x16x32_bf16 v[80:83], a[128:131], a[72:75], v[80:83]
s_add_u32 s63, s93, 0
s_and_b32 s63, s63, 7
s_xor_b32 s63, s63, s94
v_mfma_f32_16x16x32_bf16 v[84:87], a[128:131], a[80:83], v[84:87]
s_lshl_b32 s63, s63, 11
buffer_load_dwordx4 a[0:3], v16, s[4:7], s63 offen offset:0 sc1
v_mfma_f32_16x16x32_bf16 v[84:87], a[132:135], a[84:87], v[84:87]
v_accvgpr_read_b32 v50, a148
v_accvgpr_read_b32 v51, a149
v_mfma_f32_16x16x32_bf16 v[88:91], a[132:135], a[92:95], v[88:91]
v_accvgpr_read_b32 v254, a150
v_accvgpr_read_b32 v255, a151
v_mfma_f32_16x16x32_bf16 v[88:91], a[128:131], a[88:91], v[88:91]
buffer_load_dwordx4 a[4:7], v16, s[4:7], s63 offen offset:1024 sc1
v_mfma_f32_16x16x32_bf16 v[92:95], a[128:131], a[96:99], v[92:95]
v_cvt_pk_bf16_f32 v50, v50, v51
v_cvt_pk_bf16_f32 v51, v254, v255
v_mfma_f32_16x16x32_bf16 v[92:95], a[132:135], a[100:103], v[92:95]
v_cvt_pk_bf16_f32 v52, v52, v53
v_cvt_pk_bf16_f32 v53, v54, v55
v_mfma_f32_16x16x32_bf16 v[96:99], a[132:135], a[108:111], v[96:99]
v_accvgpr_read_b32 v54, a152
v_accvgpr_read_b32 v55, a153
v_mfma_f32_16x16x32_bf16 v[96:99], a[128:131], a[104:107], v[96:99]
buffer_load_dwordx4 a[8:11], v17, s[4:7], s63 offen offset:0 sc1
v_mfma_f32_16x16x32_bf16 v[100:103], a[128:131], a[112:115], v[100:103]
v_accvgpr_read_b32 v252, a154
v_accvgpr_read_b32 v253, a155
v_mfma_f32_16x16x32_bf16 v[100:103], a[132:135], a[116:119], v[100:103]
v_cvt_pk_bf16_f32 v54, v54, v55
v_cvt_pk_bf16_f32 v55, v252, v253
v_mfma_f32_16x16x32_bf16 v[104:107], a[132:135], a[124:127], v[104:107]
v_cvt_pk_bf16_f32 v56, v56, v57
v_cvt_pk_bf16_f32 v57, v58, v59
v_mfma_f32_16x16x32_bf16 v[104:107], a[128:131], a[120:123], v[104:107]
s_waitcnt lgkmcnt(0)
buffer_load_dwordx4 a[12:15], v17, s[4:7], s63 offen offset:1024 sc1
v_mfma_f32_16x16x32_bf16 a[176:179], a[136:139], a[64:67], a[176:179]
s_waitcnt vmcnt(63) lgkmcnt(0)
s_barrier
ds_read_b64_tr_b16 a[128:129], v4 offset:49152
v_mfma_f32_16x16x32_bf16 a[176:179], a[140:143], a[68:71], a[176:179]
ds_read_b64_tr_b16 a[130:131], v4 offset:50176
ds_read_b64_tr_b16 a[132:133], v4 offset:57344
v_mfma_f32_16x16x32_bf16 a[180:183], a[140:143], a[76:79], a[180:183]
ds_read_b64_tr_b16 a[134:135], v4 offset:58368
v_accvgpr_read_b32 v58, a156
v_mfma_f32_16x16x32_bf16 a[180:183], a[136:139], a[72:75], a[180:183]
buffer_load_dwordx4 a[16:19], v18, s[4:7], s63 offen offset:0 sc1
v_mfma_f32_16x16x32_bf16 a[184:187], a[136:139], a[80:83], a[184:187]
v_accvgpr_read_b32 v59, a157
v_accvgpr_read_b32 v254, a158
v_mfma_f32_16x16x32_bf16 a[184:187], a[140:143], a[84:87], a[184:187]
v_accvgpr_read_b32 v255, a159
v_cvt_pk_bf16_f32 v58, v58, v59
v_mfma_f32_16x16x32_bf16 a[188:191], a[140:143], a[92:95], a[188:191]
v_cvt_pk_bf16_f32 v59, v254, v255
v_cvt_pk_bf16_f32 v60, v60, v61
v_mfma_f32_16x16x32_bf16 a[188:191], a[136:139], a[88:91], a[188:191]
buffer_load_dwordx4 a[20:23], v18, s[4:7], s63 offen offset:1024 sc1
v_mfma_f32_16x16x32_bf16 a[216:219], a[136:139], a[96:99], a[216:219]
v_cvt_pk_bf16_f32 v61, v62, v63
v_accvgpr_read_b32 v62, a160
v_mfma_f32_16x16x32_bf16 a[216:219], a[140:143], a[100:103], a[216:219]
v_accvgpr_read_b32 v63, a161
v_accvgpr_read_b32 v252, a162
v_mfma_f32_16x16x32_bf16 a[220:223], a[140:143], a[108:111], a[220:223]
v_accvgpr_read_b32 v253, a163
v_cvt_pk_bf16_f32 v62, v62, v63
v_mfma_f32_16x16x32_bf16 a[220:223], a[136:139], a[104:107], a[220:223]
buffer_load_dwordx4 a[24:27], v19, s[4:7], s63 offen offset:0 sc1
v_mfma_f32_16x16x32_bf16 a[224:227], a[136:139], a[112:115], a[224:227]
v_cvt_pk_bf16_f32 v63, v252, v253
v_cvt_pk_bf16_f32 v64, v64, v65
v_mfma_f32_16x16x32_bf16 a[224:227], a[140:143], a[116:119], a[224:227]
v_cvt_pk_bf16_f32 v65, v66, v67
v_accvgpr_read_b32 v66, a164
v_mfma_f32_16x16x32_bf16 a[228:231], a[140:143], a[124:127], a[228:231]
v_accvgpr_read_b32 v67, a165
v_accvgpr_read_b32 v254, a166
v_mfma_f32_16x16x32_bf16 a[228:231], a[136:139], a[120:123], a[228:231]
s_waitcnt lgkmcnt(0)
buffer_load_dwordx4 a[28:31], v19, s[4:7], s63 offen offset:1024 sc1
v_mfma_f32_16x16x32_bf16 v[108:111], a[64:67], a[128:131], v[108:111]
ds_read_b64_tr_b16 a[136:137], v5 offset:49152
ds_read_b64_tr_b16 a[138:139], v5 offset:50176
v_mfma_f32_16x16x32_bf16 v[108:111], a[68:71], a[132:135], v[108:111]
ds_read_b64_tr_b16 a[140:141], v5 offset:57344
ds_read_b64_tr_b16 a[142:143], v5 offset:58368
v_mfma_f32_16x16x32_bf16 v[116:119], a[76:79], a[132:135], v[116:119]
v_accvgpr_read_b32 v255, a167
v_cvt_pk_bf16_f32 v66, v66, v67
v_mfma_f32_16x16x32_bf16 v[116:119], a[72:75], a[128:131], v[116:119]
s_add_u32 s63, s93, 1
s_and_b32 s63, s63, 7
s_xor_b32 s63, s63, s94
v_mfma_f32_16x16x32_bf16 a[232:235], a[80:83], a[128:131], a[232:235]
s_lshl_b32 s63, s63, 11
buffer_load_dwordx4 a[32:35], v16, s[4:7], s63 offen offset:0 sc1
v_mfma_f32_16x16x32_bf16 a[232:235], a[84:87], a[132:135], a[232:235]
v_cvt_pk_bf16_f32 v67, v254, v255
v_cvt_pk_bf16_f32 v68, v68, v69
v_mfma_f32_16x16x32_bf16 a[240:243], a[92:95], a[132:135], a[240:243]
v_cvt_pk_bf16_f32 v69, v70, v71
v_accvgpr_read_b32 v70, a168
v_mfma_f32_16x16x32_bf16 a[240:243], a[88:91], a[128:131], a[240:243]
buffer_load_dwordx4 a[36:39], v16, s[4:7], s63 offen offset:1024 sc1
v_mfma_f32_16x16x32_bf16 v[112:115], a[96:99], a[128:131], v[112:115]
v_accvgpr_read_b32 v71, a169
v_accvgpr_read_b32 v252, a170
v_mfma_f32_16x16x32_bf16 v[112:115], a[100:103], a[132:135], v[112:115]
v_accvgpr_read_b32 v253, a171
v_cvt_pk_bf16_f32 v70, v70, v71
v_mfma_f32_16x16x32_bf16 v[120:123], a[108:111], a[132:135], v[120:123]
v_cvt_pk_bf16_f32 v71, v252, v253
v_cvt_pk_bf16_f32 v72, v72, v73
v_mfma_f32_16x16x32_bf16 v[120:123], a[104:107], a[128:131], v[120:123]
buffer_load_dwordx4 a[40:43], v17, s[4:7], s63 offen offset:0 sc1
v_mfma_f32_16x16x32_bf16 a[236:239], a[112:115], a[128:131], a[236:239]
v_cvt_pk_bf16_f32 v73, v74, v75
v_accvgpr_read_b32 v74, a172
v_mfma_f32_16x16x32_bf16 a[236:239], a[116:119], a[132:135], a[236:239]
v_accvgpr_read_b32 v75, a173
v_accvgpr_read_b32 v254, a174
v_mfma_f32_16x16x32_bf16 a[244:247], a[124:127], a[132:135], a[244:247]
v_accvgpr_read_b32 v255, a175
v_cvt_pk_bf16_f32 v74, v74, v75
v_mfma_f32_16x16x32_bf16 a[244:247], a[120:123], a[128:131], a[244:247]
s_waitcnt lgkmcnt(0)
buffer_load_dwordx4 a[44:47], v17, s[4:7], s63 offen offset:1024 sc1
v_mfma_f32_16x16x32_bf16 v[124:127], a[64:67], a[136:139], v[124:127]
ds_read_b64_tr_b16 a[128:129], v6 offset:49152
ds_read_b64_tr_b16 a[130:131], v6 offset:50176
v_mfma_f32_16x16x32_bf16 v[124:127], a[68:71], a[140:143], v[124:127]
ds_read_b64_tr_b16 a[132:133], v6 offset:57344
ds_read_b64_tr_b16 a[134:135], v6 offset:58368
v_mfma_f32_16x16x32_bf16 v[132:135], a[76:79], a[140:143], v[132:135]
v_cvt_pk_bf16_f32 v75, v254, v255
v_cvt_pk_bf16_f32 v76, v76, v77
v_mfma_f32_16x16x32_bf16 v[132:135], a[72:75], a[136:139], v[132:135]
buffer_load_dwordx4 a[48:51], v18, s[4:7], s63 offen offset:0 sc1
v_mfma_f32_16x16x32_bf16 a[248:251], a[80:83], a[136:139], a[248:251]
v_cvt_pk_bf16_f32 v77, v78, v79
v_accvgpr_read_b32 v78, a176
v_mfma_f32_16x16x32_bf16 a[248:251], a[84:87], a[140:143], a[248:251]
v_accvgpr_read_b32 v79, a177
v_accvgpr_read_b32 v252, a178
v_mfma_f32_16x16x32_bf16 v[172:175], a[92:95], a[140:143], v[172:175]
v_accvgpr_read_b32 v253, a179
v_cvt_pk_bf16_f32 v78, v78, v79
v_mfma_f32_16x16x32_bf16 v[172:175], a[88:91], a[136:139], v[172:175]
buffer_load_dwordx4 a[52:55], v18, s[4:7], s63 offen offset:1024 sc1
v_mfma_f32_16x16x32_bf16 v[128:131], a[96:99], a[136:139], v[128:131]
v_cvt_pk_bf16_f32 v79, v252, v253
v_cvt_pk_bf16_f32 v80, v80, v81
v_mfma_f32_16x16x32_bf16 v[128:131], a[100:103], a[140:143], v[128:131]
v_cvt_pk_bf16_f32 v81, v82, v83
v_accvgpr_read_b32 v82, a180
v_mfma_f32_16x16x32_bf16 v[136:139], a[108:111], a[140:143], v[136:139]
v_accvgpr_read_b32 v83, a181
v_accvgpr_read_b32 v254, a182
v_mfma_f32_16x16x32_bf16 v[136:139], a[104:107], a[136:139], v[136:139]
buffer_load_dwordx4 a[56:59], v19, s[4:7], s63 offen offset:0 sc1
v_mfma_f32_16x16x32_bf16 a[252:255], a[112:115], a[136:139], a[252:255]
v_accvgpr_read_b32 v255, a183
v_cvt_pk_bf16_f32 v82, v82, v83
v_mfma_f32_16x16x32_bf16 a[252:255], a[116:119], a[140:143], a[252:255]
v_cvt_pk_bf16_f32 v83, v254, v255
v_cvt_pk_bf16_f32 v84, v84, v85
v_mfma_f32_16x16x32_bf16 v[176:179], a[124:127], a[140:143], v[176:179]
v_cvt_pk_bf16_f32 v85, v86, v87
v_accvgpr_read_b32 v86, a184
v_mfma_f32_16x16x32_bf16 v[176:179], a[120:123], a[136:139], v[176:179]
s_waitcnt lgkmcnt(0)
buffer_load_dwordx4 a[60:63], v19, s[4:7], s63 offen offset:1024 sc1
v_mfma_f32_16x16x32_bf16 v[140:143], a[64:67], a[128:131], v[140:143]
ds_read_b64_tr_b16 a[136:137], v7 offset:49152
ds_read_b64_tr_b16 a[138:139], v7 offset:50176
v_mfma_f32_16x16x32_bf16 v[140:143], a[68:71], a[132:135], v[140:143]
ds_read_b64_tr_b16 a[140:141], v7 offset:57344
ds_read_b64_tr_b16 a[142:143], v7 offset:58368
v_mfma_f32_16x16x32_bf16 v[148:151], a[76:79], a[132:135], v[148:151]
v_accvgpr_read_b32 v87, a185
v_accvgpr_read_b32 v252, a186
v_mfma_f32_16x16x32_bf16 v[148:151], a[72:75], a[128:131], v[148:151]
v_accvgpr_read_b32 v253, a187
v_cvt_pk_bf16_f32 v86, v86, v87
v_mfma_f32_16x16x32_bf16 v[180:183], a[80:83], a[128:131], v[180:183]
v_cvt_pk_bf16_f32 v87, v252, v253
v_cvt_pk_bf16_f32 v88, v88, v89
v_mfma_f32_16x16x32_bf16 v[180:183], a[84:87], a[132:135], v[180:183]
v_cvt_pk_bf16_f32 v89, v90, v91
v_accvgpr_read_b32 v90, a188
v_mfma_f32_16x16x32_bf16 v[188:191], a[92:95], a[132:135], v[188:191]
v_accvgpr_read_b32 v91, a189
v_accvgpr_read_b32 v254, a190
v_mfma_f32_16x16x32_bf16 v[188:191], a[88:91], a[128:131], v[188:191]
v_accvgpr_read_b32 v255, a191
v_cvt_pk_bf16_f32 v90, v90, v91
v_mfma_f32_16x16x32_bf16 v[144:147], a[96:99], a[128:131], v[144:147]
v_cvt_pk_bf16_f32 v91, v254, v255
v_cvt_pk_bf16_f32 v92, v92, v93
v_mfma_f32_16x16x32_bf16 v[144:147], a[100:103], a[132:135], v[144:147]
v_cvt_pk_bf16_f32 v93, v94, v95
v_accvgpr_read_b32 v94, a216
v_mfma_f32_16x16x32_bf16 v[152:155], a[108:111], a[132:135], v[152:155]
v_accvgpr_read_b32 v95, a217
v_accvgpr_read_b32 v252, a218
v_mfma_f32_16x16x32_bf16 v[152:155], a[104:107], a[128:131], v[152:155]
v_accvgpr_read_b32 v253, a219
v_cvt_pk_bf16_f32 v94, v94, v95
v_mfma_f32_16x16x32_bf16 v[184:187], a[112:115], a[128:131], v[184:187]
v_cvt_pk_bf16_f32 v95, v252, v253
v_cvt_pk_bf16_f32 v96, v96, v97
v_mfma_f32_16x16x32_bf16 v[184:187], a[116:119], a[132:135], v[184:187]
v_cvt_pk_bf16_f32 v97, v98, v99
v_accvgpr_read_b32 v98, a220
v_mfma_f32_16x16x32_bf16 v[192:195], a[124:127], a[132:135], v[192:195]
v_accvgpr_read_b32 v99, a221
v_accvgpr_read_b32 v254, a222
v_mfma_f32_16x16x32_bf16 v[192:195], a[120:123], a[128:131], v[192:195]
s_waitcnt lgkmcnt(0)
v_accvgpr_read_b32 v255, a223
v_cvt_pk_bf16_f32 v98, v98, v99
v_mfma_f32_16x16x32_bf16 v[156:159], a[64:67], a[136:139], v[156:159]
v_cvt_pk_bf16_f32 v99, v254, v255
v_mfma_f32_16x16x32_bf16 v[156:159], a[68:71], a[140:143], v[156:159]
ds_read_b64_tr_b16 a[192:193], v22 offset:0
ds_read_b64_tr_b16 a[194:195], v22 offset:1024
v_mfma_f32_16x16x32_bf16 v[164:167], a[76:79], a[140:143], v[164:167]
ds_read_b64_tr_b16 a[196:197], v22 offset:8192
ds_read_b64_tr_b16 a[198:199], v22 offset:9216
v_mfma_f32_16x16x32_bf16 v[164:167], a[72:75], a[136:139], v[164:167]
ds_read_b64_tr_b16 a[200:201], v23 offset:0
ds_read_b64_tr_b16 a[202:203], v23 offset:1024
v_mfma_f32_16x16x32_bf16 v[196:199], a[80:83], a[136:139], v[196:199]
ds_read_b64_tr_b16 a[204:205], v23 offset:8192
ds_read_b64_tr_b16 a[206:207], v23 offset:9216
v_mfma_f32_16x16x32_bf16 v[196:199], a[84:87], a[140:143], v[196:199]
v_mfma_f32_16x16x32_bf16 v[204:207], a[92:95], a[140:143], v[204:207]
v_mfma_f32_16x16x32_bf16 v[204:207], a[88:91], a[136:139], v[204:207]
v_mfma_f32_16x16x32_bf16 v[160:163], a[96:99], a[136:139], v[160:163]
v_mfma_f32_16x16x32_bf16 v[160:163], a[100:103], a[140:143], v[160:163]
v_mfma_f32_16x16x32_bf16 v[168:171], a[108:111], a[140:143], v[168:171]
v_mfma_f32_16x16x32_bf16 v[168:171], a[104:107], a[136:139], v[168:171]
v_mfma_f32_16x16x32_bf16 v[200:203], a[112:115], a[136:139], v[200:203]
v_mfma_f32_16x16x32_bf16 v[200:203], a[116:119], a[140:143], v[200:203]
v_mfma_f32_16x16x32_bf16 v[208:211], a[124:127], a[140:143], v[208:211]
v_mfma_f32_16x16x32_bf16 v[208:211], a[120:123], a[136:139], v[208:211]

s_cmp_ge_u32 s92, 27
s_cbranch_scc1 L_nof
s_waitcnt vmcnt(15) lgkmcnt(0)
v_mfma_f32_16x16x32_bf16 a[96:99], a[192:195], a[0:3], 0
s_waitcnt vmcnt(14)
ds_read_b64_tr_b16 a[208:209], v24 offset:0
ds_read_b64_tr_b16 a[210:211], v24 offset:1024
v_mfma_f32_16x16x32_bf16 a[96:99], a[196:199], a[4:7], a[96:99]
s_waitcnt vmcnt(12)
s_add_u32 s63, s93, 2
ds_read_b64_tr_b16 a[212:213], v24 offset:8192
ds_read_b64_tr_b16 a[214:215], v24 offset:9216
v_mfma_f32_16x16x32_bf16 a[100:103], a[196:199], a[12:15], 0
s_and_b32 s63, s63, 7
s_xor_b32 s63, s63, s94
s_lshl_b32 s63, s63, 11
v_mfma_f32_16x16x32_bf16 a[100:103], a[192:195], a[8:11], a[100:103]
s_waitcnt vmcnt(11)
buffer_load_dwordx4 a[64:67], v16, s[4:7], s63 offen offset:0 sc1
v_mfma_f32_16x16x32_bf16 a[104:107], a[192:195], a[16:19], 0
s_waitcnt vmcnt(11)
v_cvt_pk_bf16_f32 v100, v100, v101
v_cvt_pk_bf16_f32 v101, v102, v103
v_mfma_f32_16x16x32_bf16 a[104:107], a[196:199], a[20:23], a[104:107]
s_add_u32 s62, s60, 0
buffer_store_dwordx4 v[44:47], v1, s[4:7], s62 offen sc1
s_waitcnt vmcnt(10)
v_mfma_f32_16x16x32_bf16 a[108:111], a[196:199], a[28:31], 0
v_accvgpr_read_b32 v102, a224
v_accvgpr_read_b32 v103, a225
v_mfma_f32_16x16x32_bf16 a[108:111], a[192:195], a[24:27], a[108:111]
v_accvgpr_read_b32 v252, a226
v_accvgpr_read_b32 v253, a227
v_mfma_f32_16x16x32_bf16 a[112:115], a[200:203], a[0:3], 0
ds_read_b64_tr_b16 a[192:193], v25 offset:0
ds_read_b64_tr_b16 a[194:195], v25 offset:1024
v_mfma_f32_16x16x32_bf16 a[112:115], a[204:207], a[4:7], a[112:115]
ds_read_b64_tr_b16 a[196:197], v25 offset:8192
ds_read_b64_tr_b16 a[198:199], v25 offset:9216
v_mfma_f32_16x16x32_bf16 a[116:119], a[204:207], a[12:15], 0
buffer_load_dwordx4 a[68:71], v16, s[4:7], s63 offen offset:1024 sc1
v_mfma_f32_16x16x32_bf16 a[116:119], a[200:203], a[8:11], a[116:119]
v_cvt_pk_bf16_f32 v102, v102, v103
v_cvt_pk_bf16_f32 v103, v252, v253
v_mfma_f32_16x16x32_bf16 a[120:123], a[200:203], a[16:19], 0
v_cvt_pk_bf16_f32 v104, v104, v105
v_cvt_pk_bf16_f32 v105, v106, v107
v_mfma_f32_16x16x32_bf16 a[120:123], a[204:207], a[20:23], a[120:123]
s_add_u32 s62, s60, 16384
buffer_store_dwordx4 v[48:51], v1, s[4:7], s62 offen sc1
v_mfma_f32_16x16x32_bf16 a[124:127], a[204:207], a[28:31], 0
v_accvgpr_read_b32 v106, a228
v_accvgpr_read_b32 v107, a229
v_mfma_f32_16x16x32_bf16 a[124:127], a[200:203], a[24:27], a[124:127]
s_waitcnt lgkmcnt(4)
v_accvgpr_read_b32 v254, a230
v_accvgpr_read_b32 v255, a231
v_mfma_f32_16x16x32_bf16 a[128:131], a[208:211], a[0:3], 0
ds_read_b64_tr_b16 a[200:201], v26 offset:0
ds_read_b64_tr_b16 a[202:203], v26 offset:1024
v_mfma_f32_16x16x32_bf16 a[128:131], a[212:215], a[4:7], a[128:131]
ds_read_b64_tr_b16 a[204:205], v26 offset:8192
ds_read_b64_tr_b16 a[206:207], v26 offset:9216
v_mfma_f32_16x16x32_bf16 a[132:135], a[212:215], a[12:15], 0
buffer_load_dwordx4 a[72:75], v17, s[4:7], s63 offen offset:0 sc1
v_mfma_f32_16x16x32_bf16 a[132:135], a[208:211], a[8:11], a[132:135]
v_cvt_pk_bf16_f32 v106, v106, v107
v_cvt_pk_bf16_f32 v107, v254, v255
v_mfma_f32_16x16x32_bf16 a[136:139], a[208:211], a[16:19], 0
v_cvt_pk_bf16_f32 v108, v108, v109
v_cvt_pk_bf16_f32 v109, v110, v111
v_mfma_f32_16x16x32_bf16 a[136:139], a[212:215], a[20:23], a[136:139]
s_add_u32 s62, s60, 4096
buffer_store_dwordx4 v[52:55], v1, s[4:7], s62 offen sc1
v_mfma_f32_16x16x32_bf16 a[140:143], a[212:215], a[28:31], 0
v_accvgpr_read_b32 v110, a232
v_accvgpr_read_b32 v111, a233
v_mfma_f32_16x16x32_bf16 a[140:143], a[208:211], a[24:27], a[140:143]
s_waitcnt lgkmcnt(4)
v_accvgpr_read_b32 v252, a234
v_accvgpr_read_b32 v253, a235
v_mfma_f32_16x16x32_bf16 a[144:147], a[192:195], a[0:3], 0
ds_read_b64_tr_b16 a[208:209], v27 offset:0
ds_read_b64_tr_b16 a[210:211], v27 offset:1024
v_mfma_f32_16x16x32_bf16 a[144:147], a[196:199], a[4:7], a[144:147]
ds_read_b64_tr_b16 a[212:213], v27 offset:8192
ds_read_b64_tr_b16 a[214:215], v27 offset:9216
v_mfma_f32_16x16x32_bf16 a[148:151], a[196:199], a[12:15], 0
buffer_load_dwordx4 a[76:79], v17, s[4:7], s63 offen offset:1024 sc1
v_mfma_f32_16x16x32_bf16 a[148:151], a[192:195], a[8:11], a[148:151]
v_cvt_pk_bf16_f32 v110, v110, v111
v_cvt_pk_bf16_f32 v111, v252, v253
v_mfma_f32_16x16x32_bf16 a[152:155], a[192:195], a[16:19], 0
v_cvt_pk_bf16_f32 v112, v112, v113
v_cvt_pk_bf16_f32 v113, v114, v115
v_mfma_f32_16x16x32_bf16 a[152:155], a[196:199], a[20:23], a[152:155]
s_add_u32 s62, s60, 20480
buffer_store_dwordx4 v[56:59], v1, s[4:7], s62 offen sc1
v_mfma_f32_16x16x32_bf16 a[156:159], a[196:199], a[28:31], 0
v_accvgpr_read_b32 v114, a236
v_accvgpr_read_b32 v115, a237
v_mfma_f32_16x16x32_bf16 a[156:159], a[192:195], a[24:27], a[156:159]
s_waitcnt lgkmcnt(4)
v_accvgpr_read_b32 v254, a238
v_accvgpr_read_b32 v255, a239
v_mfma_f32_16x16x32_bf16 a[160:163], a[200:203], a[0:3], 0
ds_read_b64_tr_b16 a[192:193], v28 offset:0
ds_read_b64_tr_b16 a[194:195], v28 offset:1024
v_mfma_f32_16x16x32_bf16 a[160:163], a[204:207], a[4:7], a[160:163]
ds_read_b64_tr_b16 a[196:197], v28 offset:8192
ds_read_b64_tr_b16 a[198:199], v28 offset:9216
v_mfma_f32_16x16x32_bf16 a[164:167], a[204:207], a[12:15], 0
buffer_load_dwordx4 a[80:83], v18, s[4:7], s63 offen offset:0 sc1
v_mfma_f32_16x16x32_bf16 a[164:167], a[200:203], a[8:11], a[164:167]
v_cvt_pk_bf16_f32 v114, v114, v115
v_cvt_pk_bf16_f32 v115, v254, v255
v_mfma_f32_16x16x32_bf16 a[168:171], a[200:203], a[16:19], 0
v_cvt_pk_bf16_f32 v116, v116, v117
v_cvt_pk_bf16_f32 v117, v118, v119
v_mfma_f32_16x16x32_bf16 a[168:171], a[204:207], a[20:23], a[168:171]
buffer_load_dwordx4 a[84:87], v18, s[4:7], s63 offen offset:1024 sc1
v_mfma_f32_16x16x32_bf16 a[172:175], a[204:207], a[28:31], 0
v_accvgpr_read_b32 v118, a240
v_accvgpr_read_b32 v119, a241
v_mfma_f32_16x16x32_bf16 a[172:175], a[200:203], a[24:27], a[172:175]
s_waitcnt lgkmcnt(4)
v_accvgpr_read_b32 v252, a242
v_accvgpr_read_b32 v253, a243
v_mfma_f32_16x16x32_bf16 a[176:179], a[208:211], a[0:3], 0
ds_read_b64_tr_b16 a[200:201], v29 offset:0
ds_read_b64_tr_b16 a[202:203], v29 offset:1024
v_mfma_f32_16x16x32_bf16 a[176:179], a[212:215], a[4:7], a[176:179]
ds_read_b64_tr_b16 a[204:205], v29 offset:8192
ds_read_b64_tr_b16 a[206:207], v29 offset:9216
v_mfma_f32_16x16x32_bf16 a[180:183], a[212:215], a[12:15], 0
v_cvt_pk_bf16_f32 v118, v118, v119
v_cvt_pk_bf16_f32 v119, v252, v253
v_mfma_f32_16x16x32_bf16 a[180:183], a[208:211], a[8:11], a[180:183]
v_cvt_pk_bf16_f32 v120, v120, v121
v_cvt_pk_bf16_f32 v121, v122, v123
v_mfma_f32_16x16x32_bf16 a[184:187], a[208:211], a[16:19], 0
v_accvgpr_read_b32 v122, a244
v_accvgpr_read_b32 v123, a245
v_mfma_f32_16x16x32_bf16 a[184:187], a[212:215], a[20:23], a[184:187]
v_accvgpr_read_b32 v254, a246
v_accvgpr_read_b32 v255, a247
v_mfma_f32_16x16x32_bf16 a[188:191], a[212:215], a[28:31], 0
v_cvt_pk_bf16_f32 v122, v122, v123
v_cvt_pk_bf16_f32 v123, v254, v255
v_mfma_f32_16x16x32_bf16 a[188:191], a[208:211], a[24:27], a[188:191]
s_waitcnt lgkmcnt(4)
v_cvt_pk_bf16_f32 v124, v124, v125
v_cvt_pk_bf16_f32 v125, v126, v127
v_mfma_f32_16x16x32_bf16 a[216:219], a[192:195], a[0:3], 0
ds_read_b64_tr_b16 a[208:209], v30 offset:0
ds_read_b64_tr_b16 a[210:211], v30 offset:512
v_mfma_f32_16x16x32_bf16 a[216:219], a[196:199], a[4:7], a[216:219]
ds_read_b64_tr_b16 a[212:213], v30 offset:4096
ds_read_b64_tr_b16 a[214:215], v30 offset:4608
v_mfma_f32_16x16x32_bf16 a[220:223], a[196:199], a[12:15], 0
v_accvgpr_read_b32 v126, a248
v_accvgpr_read_b32 v127, a249
v_mfma_f32_16x16x32_bf16 a[220:223], a[192:195], a[8:11], a[220:223]
v_accvgpr_read_b32 v252, a250
v_accvgpr_read_b32 v253, a251
v_mfma_f32_16x16x32_bf16 a[224:227], a[192:195], a[16:19], 0
v_cvt_pk_bf16_f32 v126, v126, v127
v_cvt_pk_bf16_f32 v127, v252, v253
v_cvt_pk_bf16_f32 v128, v128, v129
v_cvt_pk_bf16_f32 v129, v130, v131
v_accvgpr_read_b32 v130, a252
v_accvgpr_read_b32 v131, a253
v_accvgpr_read_b32 v254, a254
v_accvgpr_read_b32 v255, a255
v_cvt_pk_bf16_f32 v130, v130, v131
v_cvt_pk_bf16_f32 v131, v254, v255
v_mfma_f32_16x16x32_bf16 a[224:227], a[196:199], a[20:23], a[224:227]
buffer_load_dwordx4 a[88:91], v19, s[4:7], s63 offen offset:0 sc1
v_mfma_f32_16x16x32_bf16 a[228:231], a[196:199], a[28:31], 0
buffer_load_dwordx4 a[92:95], v19, s[4:7], s63 offen offset:1024 sc1
v_mfma_f32_16x16x32_bf16 a[228:231], a[192:195], a[24:27], a[228:231]
s_waitcnt lgkmcnt(4)
v_cvt_pk_bf16_f32 v132, v132, v133
v_cvt_pk_bf16_f32 v133, v134, v135
v_mfma_f32_16x16x32_bf16 a[232:235], a[200:203], a[0:3], 0
ds_read_b64_tr_b16 a[192:193], v31 offset:0
ds_read_b64_tr_b16 a[194:195], v31 offset:512
v_mfma_f32_16x16x32_bf16 a[232:235], a[204:207], a[4:7], a[232:235]
ds_read_b64_tr_b16 a[196:197], v31 offset:4096
ds_read_b64_tr_b16 a[198:199], v31 offset:4608
v_mfma_f32_16x16x32_bf16 a[236:239], a[204:207], a[12:15], 0
v_cvt_pk_bf16_f32 v134, v172, v173
v_cvt_pk_bf16_f32 v135, v174, v175
v_mfma_f32_16x16x32_bf16 a[236:239], a[200:203], a[8:11], a[236:239]
v_cvt_pk_bf16_f32 v136, v136, v137
v_cvt_pk_bf16_f32 v137, v138, v139
v_mfma_f32_16x16x32_bf16 a[240:243], a[200:203], a[16:19], 0
v_cvt_pk_bf16_f32 v138, v176, v177
v_cvt_pk_bf16_f32 v139, v178, v179
v_mfma_f32_16x16x32_bf16 a[240:243], a[204:207], a[20:23], a[240:243]
v_cvt_pk_bf16_f32 v140, v140, v141
v_cvt_pk_bf16_f32 v141, v142, v143
v_cvt_pk_bf16_f32 v142, v180, v181
v_cvt_pk_bf16_f32 v143, v182, v183
v_cvt_pk_bf16_f32 v144, v144, v145
v_cvt_pk_bf16_f32 v145, v146, v147
v_cvt_pk_bf16_f32 v146, v184, v185
v_cvt_pk_bf16_f32 v147, v186, v187
v_cvt_pk_bf16_f32 v148, v148, v149
v_cvt_pk_bf16_f32 v149, v150, v151
v_cvt_pk_bf16_f32 v150, v188, v189
v_cvt_pk_bf16_f32 v151, v190, v191
v_cvt_pk_bf16_f32 v152, v152, v153
v_cvt_pk_bf16_f32 v153, v154, v155
v_cvt_pk_bf16_f32 v154, v192, v193
v_cvt_pk_bf16_f32 v155, v194, v195
v_cvt_pk_bf16_f32 v156, v156, v157
v_cvt_pk_bf16_f32 v157, v158, v159
v_cvt_pk_bf16_f32 v158, v196, v197
v_cvt_pk_bf16_f32 v159, v198, v199
v_cvt_pk_bf16_f32 v160, v160, v161
v_cvt_pk_bf16_f32 v161, v162, v163
v_cvt_pk_bf16_f32 v162, v200, v201
v_cvt_pk_bf16_f32 v163, v202, v203
v_cvt_pk_bf16_f32 v164, v164, v165
v_cvt_pk_bf16_f32 v165, v166, v167
v_cvt_pk_bf16_f32 v166, v204, v205
v_cvt_pk_bf16_f32 v167, v206, v207
v_cvt_pk_bf16_f32 v168, v168, v169
v_cvt_pk_bf16_f32 v169, v170, v171
v_cvt_pk_bf16_f32 v170, v208, v209
v_cvt_pk_bf16_f32 v171, v210, v211
v_mfma_f32_16x16x32_bf16 a[244:247], a[204:207], a[28:31], 0
v_mfma_f32_16x16x32_bf16 a[244:247], a[200:203], a[24:27], a[244:247]
s_waitcnt lgkmcnt(0)
v_mfma_f32_16x16x32_bf16 v[172:175], a[208:211], a[0:3], 0
ds_read_b64_tr_b16 a[200:201], v32 offset:0
ds_read_b64_tr_b16 a[202:203], v32 offset:512
v_mfma_f32_16x16x32_bf16 v[172:175], a[212:215], a[4:7], v[172:175]
ds_read_b64_tr_b16 a[204:205], v32 offset:4096
ds_read_b64_tr_b16 a[206:207], v32 offset:4608
v_mfma_f32_16x16x32_bf16 v[176:179], a[212:215], a[12:15], 0
v_mfma_f32_16x16x32_bf16 v[176:179], a[208:211], a[8:11], v[176:179]
v_mfma_f32_16x16x32_bf16 v[180:183], a[208:211], a[16:19], 0
v_mfma_f32_16x16x32_bf16 v[180:183], a[212:215], a[20:23], v[180:183]
v_mfma_f32_16x16x32_bf16 v[184:187], a[212:215], a[28:31], 0
v_mfma_f32_16x16x32_bf16 v[184:187], a[208:211], a[24:27], v[184:187]
v_mfma_f32_16x16x32_bf16 v[188:191], a[192:195], a[0:3], 0
ds_read_b64_tr_b16 a[208:209], v33 offset:0
ds_read_b64_tr_b16 a[210:211], v33 offset:512
v_mfma_f32_16x16x32_bf16 v[188:191], a[196:199], a[4:7], v[188:191]
ds_read_b64_tr_b16 a[212:213], v33 offset:4096
ds_read_b64_tr_b16 a[214:215], v33 offset:4608
v_mfma_f32_16x16x32_bf16 v[192:195], a[196:199], a[12:15], 0
v_mfma_f32_16x16x32_bf16 v[192:195], a[192:195], a[8:11], v[192:195]
v_mfma_f32_16x16x32_bf16 v[196:199], a[192:195], a[16:19], 0
v_mfma_f32_16x16x32_bf16 v[196:199], a[196:199], a[20:23], v[196:199]
v_mfma_f32_16x16x32_bf16 v[200:203], a[196:199], a[28:31], 0
v_mfma_f32_16x16x32_bf16 v[200:203], a[192:195], a[24:27], v[200:203]
s_waitcnt lgkmcnt(4)
v_mfma_f32_16x16x32_bf16 v[204:207], a[200:203], a[0:3], 0
v_mfma_f32_16x16x32_bf16 v[204:207], a[204:207], a[4:7], v[204:207]
v_mfma_f32_16x16x32_bf16 v[208:211], a[204:207], a[12:15], 0
v_mfma_f32_16x16x32_bf16 v[208:211], a[200:203], a[8:11], v[208:211]
v_mfma_f32_16x16x32_bf16 v[212:215], a[200:203], a[16:19], 0
s_waitcnt vmcnt(63) lgkmcnt(0)
s_barrier
ds_read_b64_tr_b16 a[192:193], v22 offset:24576
v_mfma_f32_16x16x32_bf16 v[212:215], a[204:207], a[20:23], v[212:215]
s_add_u32 m0, s65, 0
ds_read_b64_tr_b16 a[194:195], v22 offset:25600
ds_read_b64_tr_b16 a[196:197], v22 offset:32768
v_mfma_f32_16x16x32_bf16 v[216:219], a[204:207], a[28:31], 0
s_add_u32 s3, s93, 3
s_and_b32 s3, s3, 7
ds_read_b64_tr_b16 a[198:199], v22 offset:33792
v_mfma_f32_16x16x32_bf16 v[216:219], a[200:203], a[24:27], v[216:219]
s_xor_b32 s3, s3, s94
s_lshl_b32 s3, s3, 19
v_mfma_f32_16x16x32_bf16 v[220:223], a[208:211], a[0:3], 0
ds_read_b64_tr_b16 a[200:201], v23 offset:24576
ds_read_b64_tr_b16 a[202:203], v23 offset:25600
v_mfma_f32_16x16x32_bf16 v[220:223], a[212:215], a[4:7], v[220:223]
ds_read_b64_tr_b16 a[204:205], v23 offset:32768
ds_read_b64_tr_b16 a[206:207], v23 offset:33792
v_mfma_f32_16x16x32_bf16 v[224:227], a[212:215], a[12:15], 0
buffer_load_dwordx4 v12, s[16:19], s3 offen offset:0 lds
v_mfma_f32_16x16x32_bf16 v[224:227], a[208:211], a[8:11], v[224:227]
buffer_load_dwordx4 v13, s[16:19], s3 offen offset:1024 lds
v_mfma_f32_16x16x32_bf16 v[228:231], a[208:211], a[16:19], 0
v_mfma_f32_16x16x32_bf16 v[228:231], a[212:215], a[20:23], v[228:231]
buffer_load_dwordx4 v14, s[16:19], s3 offen offset:2048 lds
v_mfma_f32_16x16x32_bf16 v[232:235], a[212:215], a[28:31], 0
v_mfma_f32_16x16x32_bf16 v[232:235], a[208:211], a[24:27], v[232:235]
s_waitcnt vmcnt(22) lgkmcnt(5)
v_mfma_f32_16x16x32_bf16 a[96:99], a[192:195], a[32:35], a[96:99]
s_waitcnt vmcnt(21) lgkmcnt(4)
ds_read_b64_tr_b16 a[208:209], v24 offset:24576
ds_read_b64_tr_b16 a[210:211], v24 offset:25600
v_mfma_f32_16x16x32_bf16 a[96:99], a[196:199], a[36:39], a[96:99]
s_waitcnt vmcnt(19)
ds_read_b64_tr_b16 a[212:213], v24 offset:32768
ds_read_b64_tr_b16 a[214:215], v24 offset:33792
v_mfma_f32_16x16x32_bf16 a[100:103], a[196:199], a[44:47], a[100:103]
buffer_load_dwordx4 v15, s[16:19], s3 offen offset:3072 lds
v_mfma_f32_16x16x32_bf16 a[100:103], a[192:195], a[40:43], a[100:103]
s_waitcnt vmcnt(19)
v_mfma_f32_16x16x32_bf16 a[104:107], a[192:195], a[48:51], a[104:107]
s_waitcnt vmcnt(18)
v_mfma_f32_16x16x32_bf16 a[104:107], a[196:199], a[52:55], a[104:107]
s_waitcnt vmcnt(16)
s_add_u32 m0, s66, 16384
s_add_u32 s3, s93, 3
s_and_b32 s3, s3, 7
v_mfma_f32_16x16x32_bf16 a[108:111], a[196:199], a[60:63], a[108:111]
s_xor_b32 s3, s3, s94
s_mul_i32 s3, s3, 221184
s_add_u32 s3, s3, s67
v_mfma_f32_16x16x32_bf16 a[108:111], a[192:195], a[56:59], a[108:111]
s_waitcnt lgkmcnt(4)
buffer_load_dwordx4 v20, s[32:35], s3 offen offset:0 lds
v_mfma_f32_16x16x32_bf16 a[112:115], a[200:203], a[32:35], a[112:115]
ds_read_b64_tr_b16 a[192:193], v25 offset:24576
ds_read_b64_tr_b16 a[194:195], v25 offset:25600
v_mfma_f32_16x16x32_bf16 a[112:115], a[204:207], a[36:39], a[112:115]
ds_read_b64_tr_b16 a[196:197], v25 offset:32768
ds_read_b64_tr_b16 a[198:199], v25 offset:33792
v_mfma_f32_16x16x32_bf16 a[116:119], a[204:207], a[44:47], a[116:119]
buffer_load_dwordx4 v21, s[32:35], s3 offen offset:1024 lds
v_mfma_f32_16x16x32_bf16 a[116:119], a[200:203], a[40:43], a[116:119]
v_mfma_f32_16x16x32_bf16 a[120:123], a[200:203], a[48:51], a[120:123]
v_mfma_f32_16x16x32_bf16 a[120:123], a[204:207], a[52:55], a[120:123]
s_add_u32 s63, s93, 3
s_and_b32 s63, s63, 7
s_xor_b32 s63, s63, s94
v_mfma_f32_16x16x32_bf16 a[124:127], a[204:207], a[60:63], a[124:127]
s_lshl_b32 s63, s63, 11
buffer_load_dwordx4 a[0:3], v16, s[4:7], s63 offen offset:0 sc1
v_mfma_f32_16x16x32_bf16 a[124:127], a[200:203], a[56:59], a[124:127]
s_waitcnt lgkmcnt(4)
v_mfma_f32_16x16x32_bf16 a[128:131], a[208:211], a[32:35], a[128:131]
ds_read_b64_tr_b16 a[200:201], v26 offset:24576
ds_read_b64_tr_b16 a[202:203], v26 offset:25600
v_mfma_f32_16x16x32_bf16 a[128:131], a[212:215], a[36:39], a[128:131]
s_add_u32 s62, s60, 8192
ds_read_b64_tr_b16 a[204:205], v26 offset:32768
ds_read_b64_tr_b16 a[206:207], v26 offset:33792
v_mfma_f32_16x16x32_bf16 a[132:135], a[212:215], a[44:47], a[132:135]
buffer_store_dwordx4 v[60:63], v1, s[4:7], s62 offen sc1
v_mfma_f32_16x16x32_bf16 a[132:135], a[208:211], a[40:43], a[132:135]
v_mfma_f32_16x16x32_bf16 a[136:139], a[208:211], a[48:51], a[136:139]
v_mfma_f32_16x16x32_bf16 a[136:139], a[212:215], a[52:55], a[136:139]
buffer_load_dwordx4 a[4:7], v16, s[4:7], s63 offen offset:1024 sc1
v_mfma_f32_16x16x32_bf16 a[140:143], a[212:215], a[60:63], a[140:143]
v_mfma_f32_16x16x32_bf16 a[140:143], a[208:211], a[56:59], a[140:143]
s_waitcnt lgkmcnt(4)
v_mfma_f32_16x16x32_bf16 a[144:147], a[192:195], a[32:35], a[144:147]
ds_read_b64_tr_b16 a[208:209], v27 offset:24576
ds_read_b64_tr_b16 a[210:211], v27 offset:25600
v_mfma_f32_16x16x32_bf16 a[144:147], a[196:199], a[36:39], a[144:147]
s_add_u32 s62, s60, 24576
ds_read_b64_tr_b16 a[212:213], v27 offset:32768
ds_read_b64_tr_b16 a[214:215], v27 offset:33792
v_mfma_f32_16x16x32_bf16 a[148:151], a[196:199], a[44:47], a[148:151]
buffer_store_dwordx4 v[64:67], v1, s[4:7], s62 offen sc1
v_mfma_f32_16x16x32_bf16 a[148:151], a[192:195], a[40:43], a[148:151]
v_mfma_f32_16x16x32_bf16 a[152:155], a[192:195], a[48:51], a[152:155]
v_mfma_f32_16x16x32_bf16 a[152:155], a[196:199], a[52:55], a[152:155]
buffer_load_dwordx4 a[8:11], v17, s[4:7], s63 offen offset:0 sc1
v_mfma_f32_16x16x32_bf16 a[156:159], a[196:199], a[60:63], a[156:159]
v_mfma_f32_16x16x32_bf16 a[156:159], a[192:195], a[56:59], a[156:159]
s_waitcnt lgkmcnt(4)
v_mfma_f32_16x16x32_bf16 a[160:163], a[200:203], a[32:35], a[160:163]
ds_read_b64_tr_b16 a[192:193], v28 offset:24576
ds_read_b64_tr_b16 a[194:195], v28 offset:25600
v_mfma_f32_16x16x32_bf16 a[160:163], a[204:207], a[36:39], a[160:163]
s_add_u32 s62, s60, 12288
ds_read_b64_tr_b16 a[196:197], v28 offset:32768
ds_read_b64_tr_b16 a[198:199], v28 offset:33792
v_mfma_f32_16x16x32_bf16 a[164:167], a[204:207], a[44:47], a[164:167]
buffer_store_dwordx4 v[68:71], v1, s[4:7], s62 offen sc1
v_mfma_f32_16x16x32_bf16 a[164:167], a[200:203], a[40:43], a[164:167]
v_mfma_f32_16x16x32_bf16 a[168:171], a[200:203], a[48:51], a[168:171]
v_mfma_f32_16x16x32_bf16 a[168:171], a[204:207], a[52:55], a[168:171]
buffer_load_dwordx4 a[12:15], v17, s[4:7], s63 offen offset:1024 sc1
v_mfma_f32_16x16x32_bf16 a[172:175], a[204:207], a[60:63], a[172:175]
v_mfma_f32_16x16x32_bf16 a[172:175], a[200:203], a[56:59], a[172:175]
s_waitcnt lgkmcnt(4)
v_mfma_f32_16x16x32_bf16 a[176:179], a[208:211], a[32:35], a[176:179]
ds_read_b64_tr_b16 a[200:201], v29 offset:24576
ds_read_b64_tr_b16 a[202:203], v29 offset:25600
v_mfma_f32_16x16x32_bf16 a[176:179], a[212:215], a[36:39], a[176:179]
s_add_u32 s62, s60, 28672
ds_read_b64_tr_b16 a[204:205], v29 offset:32768
ds_read_b64_tr_b16 a[206:207], v29 offset:33792
v_mfma_f32_16x16x32_bf16 a[180:183], a[212:215], a[44:47], a[180:183]
buffer_store_dwordx4 v[72:75], v1, s[4:7], s62 offen sc1
v_mfma_f32_16x16x32_bf16 a[180:183], a[208:211], a[40:43], a[180:183]
v_mfma_f32_16x16x32_bf16 a[184:187], a[208:211], a[48:51], a[184:187]
v_mfma_f32_16x16x32_bf16 a[184:187], a[212:215], a[52:55], a[184:187]
buffer_load_dwordx4 a[16:19], v18, s[4:7], s63 offen offset:0 sc1
v_mfma_f32_16x16x32_bf16 a[188:191], a[212:215], a[60:63], a[188:191]
v_mfma_f32_16x16x32_bf16 a[188:191], a[208:211], a[56:59], a[188:191]
s_waitcnt lgkmcnt(4)
v_mfma_f32_16x16x32_bf16 a[216:219], a[192:195], a[32:35], a[216:219]
ds_read_b64_tr_b16 a[208:209], v30 offset:24576
ds_read_b64_tr_b16 a[210:211], v30 offset:25088
v_mfma_f32_16x16x32_bf16 a[216:219], a[196:199], a[36:39], a[216:219]
s_add_u32 s62, s60, 1024
ds_read_b64_tr_b16 a[212:213], v30 offset:28672
ds_read_b64_tr_b16 a[214:215], v30 offset:29184
v_mfma_f32_16x16x32_bf16 a[220:223], a[196:199], a[44:47], a[220:223]
buffer_store_dwordx4 v[76:79], v1, s[4:7], s62 offen sc1
v_mfma_f32_16x16x32_bf16 a[220:223], a[192:195], a[40:43], a[220:223]
v_mfma_f32_16x16x32_bf16 a[224:227], a[192:195], a[48:51], a[224:227]
v_mfma_f32_16x16x32_bf16 a[224:227], a[196:199], a[52:55], a[224:227]
buffer_load_dwordx4 a[20:23], v18, s[4:7], s63 offen offset:1024 sc1
v_mfma_f32_16x16x32_bf16 a[228:231], a[196:199], a[60:63], a[228:231]
v_mfma_f32_16x16x32_bf16 a[228:231], a[192:195], a[56:59], a[228:231]
s_waitcnt lgkmcnt(4)
v_mfma_f32_16x16x32_bf16 a[232:235], a[200:203], a[32:35], a[232:235]
ds_read_b64_tr_b16 a[192:193], v31 offset:24576
ds_read_b64_tr_b16 a[194:195], v31 offset:25088
v_mfma_f32_16x16x32_bf16 a[232:235], a[204:207], a[36:39], a[232:235]
ds_read_b64_tr_b16 a[196:197], v31 offset:28672
ds_read_b64_tr_b16 a[198:199], v31 offset:29184
v_mfma_f32_16x16x32_bf16 a[236:239], a[204:207], a[44:47], a[236:239]
buffer_load_dwordx4 a[24:27], v19, s[4:7], s63 offen offset:0 sc1
v_mfma_f32_16x16x32_bf16 a[236:239], a[200:203], a[40:43], a[236:239]
v_mfma_f32_16x16x32_bf16 a[240:243], a[200:203], a[48:51], a[240:243]
v_mfma_f32_16x16x32_bf16 a[240:243], a[204:207], a[52:55], a[240:243]
buffer_load_dwordx4 a[28:31], v19, s[4:7], s63 offen offset:1024 sc1
v_mfma_f32_16x16x32_bf16 a[244:247], a[204:207], a[60:63], a[244:247]
v_mfma_f32_16x16x32_bf16 a[244:247], a[200:203], a[56:59], a[244:247]
s_waitcnt lgkmcnt(4)
v_mfma_f32_16x16x32_bf16 v[172:175], a[208:211], a[32:35], v[172:175]
ds_read_b64_tr_b16 a[200:201], v32 offset:24576
ds_read_b64_tr_b16 a[202:203], v32 offset:25088
v_mfma_f32_16x16x32_bf16 v[172:175], a[212:215], a[36:39], v[172:175]
ds_read_b64_tr_b16 a[204:205], v32 offset:28672
ds_read_b64_tr_b16 a[206:207], v32 offset:29184
v_mfma_f32_16x16x32_bf16 v[176:179], a[212:215], a[44:47], v[176:179]
v_mfma_f32_16x16x32_bf16 v[176:179], a[208:211], a[40:43], v[176:179]
v_mfma_f32_16x16x32_bf16 v[180:183], a[208:211], a[48:51], v[180:183]
v_mfma_f32_16x16x32_bf16 v[180:183], a[212:215], a[52:55], v[180:183]
v_mfma_f32_16x16x32_bf16 v[184:187], a[212:215], a[60:63], v[184:187]
v_mfma_f32_16x16x32_bf16 v[184:187], a[208:211], a[56:59], v[184:187]
s_waitcnt lgkmcnt(4)
v_mfma_f32_16x16x32_bf16 v[188:191], a[192:195], a[32:35], v[188:191]
ds_read_b64_tr_b16 a[208:209], v33 offset:24576
ds_read_b64_tr_b16 a[210:211], v33 offset:25088
v_mfma_f32_16x16x32_bf16 v[188:191], a[196:199], a[36:39], v[188:191]
ds_read_b64_tr_b16 a[212:213], v33 offset:28672
ds_read_b64_tr_b16 a[214:215], v33 offset:29184
v_mfma_f32_16x16x32_bf16 v[192:195], a[196:199], a[44:47], v[192:195]
v_mfma_f32_16x16x32_bf16 v[192:195], a[192:195], a[40:43], v[192:195]
v_mfma_f32_16x16x32_bf16 v[196:199], a[192:195], a[48:51], v[196:199]
v_mfma_f32_16x16x32_bf16 v[196:199], a[196:199], a[52:55], v[196:199]
v_mfma_f32_16x16x32_bf16 v[200:203], a[196:199], a[60:63], v[200:203]
v_mfma_f32_16x16x32_bf16 v[200:203], a[192:195], a[56:59], v[200:203]
s_waitcnt lgkmcnt(4)
v_mfma_f32_16x16x32_bf16 v[204:207], a[200:203], a[32:35], v[204:207]
v_mfma_f32_16x16x32_bf16 v[204:207], a[204:207], a[36:39], v[204:207]
v_mfma_f32_16x16x32_bf16 v[208:211], a[204:207], a[44:47], v[208:211]
v_mfma_f32_16x16x32_bf16 v[208:211], a[200:203], a[40:43], v[208:211]
v_mfma_f32_16x16x32_bf16 v[212:215], a[200:203], a[48:51], v[212:215]
s_waitcnt vmcnt(63) lgkmcnt(0)
s_barrier
ds_read_b64_tr_b16 a[192:193], v22 offset:49152
v_mfma_f32_16x16x32_bf16 v[212:215], a[204:207], a[52:55], v[212:215]
s_add_u32 m0, s65, 24576
ds_read_b64_tr_b16 a[194:195], v22 offset:50176
ds_read_b64_tr_b16 a[196:197], v22 offset:57344
v_mfma_f32_16x16x32_bf16 v[216:219], a[204:207], a[60:63], v[216:219]
s_add_u32 s3, s93, 4
s_and_b32 s3, s3, 7
ds_read_b64_tr_b16 a[198:199], v22 offset:58368
v_mfma_f32_16x16x32_bf16 v[216:219], a[200:203], a[56:59], v[216:219]
s_xor_b32 s3, s3, s94
s_lshl_b32 s3, s3, 19
v_mfma_f32_16x16x32_bf16 v[220:223], a[208:211], a[32:35], v[220:223]
ds_read_b64_tr_b16 a[200:201], v23 offset:49152
ds_read_b64_tr_b16 a[202:203], v23 offset:50176
v_mfma_f32_16x16x32_bf16 v[220:223], a[212:215], a[36:39], v[220:223]
ds_read_b64_tr_b16 a[204:205], v23 offset:57344
ds_read_b64_tr_b16 a[206:207], v23 offset:58368
v_mfma_f32_16x16x32_bf16 v[224:227], a[212:215], a[44:47], v[224:227]
buffer_load_dwordx4 v12, s[16:19], s3 offen offset:0 lds
v_mfma_f32_16x16x32_bf16 v[224:227], a[208:211], a[40:43], v[224:227]
buffer_load_dwordx4 v13, s[16:19], s3 offen offset:1024 lds
v_mfma_f32_16x16x32_bf16 v[228:231], a[208:211], a[48:51], v[228:231]
v_mfma_f32_16x16x32_bf16 v[228:231], a[212:215], a[52:55], v[228:231]
buffer_load_dwordx4 v14, s[16:19], s3 offen offset:2048 lds
v_mfma_f32_16x16x32_bf16 v[232:235], a[212:215], a[60:63], v[232:235]
v_mfma_f32_16x16x32_bf16 v[232:235], a[208:211], a[56:59], v[232:235]
s_waitcnt vmcnt(33) lgkmcnt(5)
v_mfma_f32_16x16x32_bf16 a[96:99], a[192:195], a[64:67], a[96:99]
s_waitcnt vmcnt(31) lgkmcnt(4)
ds_read_b64_tr_b16 a[208:209], v24 offset:49152
ds_read_b64_tr_b16 a[210:211], v24 offset:50176
v_mfma_f32_16x16x32_bf16 a[96:99], a[196:199], a[68:71], a[96:99]
s_waitcnt vmcnt(27)
ds_read_b64_tr_b16 a[212:213], v24 offset:57344
ds_read_b64_tr_b16 a[214:215], v24 offset:58368
v_mfma_f32_16x16x32_bf16 a[100:103], a[196:199], a[76:79], a[100:103]
buffer_load_dwordx4 v15, s[16:19], s3 offen offset:3072 lds
v_mfma_f32_16x16x32_bf16 a[100:103], a[192:195], a[72:75], a[100:103]
s_waitcnt vmcnt(26)
v_mfma_f32_16x16x32_bf16 a[104:107], a[192:195], a[80:83], a[104:107]
s_waitcnt vmcnt(25)
v_mfma_f32_16x16x32_bf16 a[104:107], a[196:199], a[84:87], a[104:107]
s_waitcnt vmcnt(23)
s_add_u32 m0, s66, 40960
s_add_u32 s3, s93, 4
s_and_b32 s3, s3, 7
v_mfma_f32_16x16x32_bf16 a[108:111], a[196:199], a[92:95], a[108:111]
s_xor_b32 s3, s3, s94
s_mul_i32 s3, s3, 221184
s_add_u32 s3, s3, s67
v_mfma_f32_16x16x32_bf16 a[108:111], a[192:195], a[88:91], a[108:111]
s_waitcnt lgkmcnt(4)
buffer_load_dwordx4 v20, s[32:35], s3 offen offset:0 lds
v_mfma_f32_16x16x32_bf16 a[112:115], a[200:203], a[64:67], a[112:115]
ds_read_b64_tr_b16 a[192:193], v25 offset:49152
ds_read_b64_tr_b16 a[194:195], v25 offset:50176
v_mfma_f32_16x16x32_bf16 a[112:115], a[204:207], a[68:71], a[112:115]
ds_read_b64_tr_b16 a[196:197], v25 offset:57344
ds_read_b64_tr_b16 a[198:199], v25 offset:58368
v_mfma_f32_16x16x32_bf16 a[116:119], a[204:207], a[76:79], a[116:119]
buffer_load_dwordx4 v21, s[32:35], s3 offen offset:1024 lds
v_mfma_f32_16x16x32_bf16 a[116:119], a[200:203], a[72:75], a[116:119]
v_mfma_f32_16x16x32_bf16 a[120:123], a[200:203], a[80:83], a[120:123]
v_mfma_f32_16x16x32_bf16 a[120:123], a[204:207], a[84:87], a[120:123]
s_add_u32 s63, s93, 4
s_and_b32 s63, s63, 7
s_xor_b32 s63, s63, s94
v_mfma_f32_16x16x32_bf16 a[124:127], a[204:207], a[92:95], a[124:127]
s_lshl_b32 s63, s63, 11
buffer_load_dwordx4 a[32:35], v16, s[4:7], s63 offen offset:0 sc1
v_mfma_f32_16x16x32_bf16 a[124:127], a[200:203], a[88:91], a[124:127]
s_waitcnt lgkmcnt(4)
v_mfma_f32_16x16x32_bf16 a[128:131], a[208:211], a[64:67], a[128:131]
ds_read_b64_tr_b16 a[200:201], v26 offset:49152
ds_read_b64_tr_b16 a[202:203], v26 offset:50176
v_mfma_f32_16x16x32_bf16 a[128:131], a[212:215], a[68:71], a[128:131]
s_add_u32 s62, s60, 17408
ds_read_b64_tr_b16 a[204:205], v26 offset:57344
ds_read_b64_tr_b16 a[206:207], v26 offset:58368
v_mfma_f32_16x16x32_bf16 a[132:135], a[212:215], a[76:79], a[132:135]
buffer_store_dwordx4 v[80:83], v1, s[4:7], s62 offen sc1
v_mfma_f32_16x16x32_bf16 a[132:135], a[208:211], a[72:75], a[132:135]
v_mfma_f32_16x16x32_bf16 a[136:139], a[208:211], a[80:83], a[136:139]
v_mfma_f32_16x16x32_bf16 a[136:139], a[212:215], a[84:87], a[136:139]
buffer_load_dwordx4 a[36:39], v16, s[4:7], s63 offen offset:1024 sc1
v_mfma_f32_16x16x32_bf16 a[140:143], a[212:215], a[92:95], a[140:143]
v_mfma_f32_16x16x32_bf16 a[140:143], a[208:211], a[88:91], a[140:143]
s_waitcnt lgkmcnt(4)
v_mfma_f32_16x16x32_bf16 a[144:147], a[192:195], a[64:67], a[144:147]
ds_read_b64_tr_b16 a[208:209], v27 offset:49152
ds_read_b64_tr_b16 a[210:211], v27 offset:50176
v_mfma_f32_16x16x32_bf16 a[144:147], a[196:199], a[68:71], a[144:147]
s_add_u32 s62, s60, 5120
ds_read_b64_tr_b16 a[212:213], v27 offset:57344
ds_read_b64_tr_b16 a[214:215], v27 offset:58368
v_mfma_f32_16x16x32_bf16 a[148:151], a[196:199], a[76:79], a[148:151]
buffer_store_dwordx4 v[84:87], v1, s[4:7], s62 offen sc1
v_mfma_f32_16x16x32_bf16 a[148:151], a[192:195], a[72:75], a[148:151]
v_mfma_f32_16x16x32_bf16 a[152:155], a[192:195], a[80:83], a[152:155]
v_mfma_f32_16x16x32_bf16 a[152:155], a[196:199], a[84:87], a[152:155]
buffer_load_dwordx4 a[40:43], v17, s[4:7], s63 offen offset:0 sc1
v_mfma_f32_16x16x32_bf16 a[156:159], a[196:199], a[92:95], a[156:159]
v_mfma_f32_16x16x32_bf16 a[156:159], a[192:195], a[88:91], a[156:159]
s_waitcnt lgkmcnt(4)
v_mfma_f32_16x16x32_bf16 a[160:163], a[200:203], a[64:67], a[160:163]
ds_read_b64_tr_b16 a[192:193], v28 offset:49152
ds_read_b64_tr_b16 a[194:195], v28 offset:50176
v_mfma_f32_16x16x32_bf16 a[160:163], a[204:207], a[68:71], a[160:163]
s_add_u32 s62, s60, 21504
ds_read_b64_tr_b16 a[196:197], v28 offset:57344
ds_read_b64_tr_b16 a[198:199], v28 offset:58368
v_mfma_f32_16x16x32_bf16 a[164:167], a[204:207], a[76:79], a[164:167]
buffer_store_dwordx4 v[88:91], v1, s[4:7], s62 offen sc1
v_mfma_f32_16x16x32_bf16 a[164:167], a[200:203], a[72:75], a[164:167]
v_mfma_f32_16x16x32_bf16 a[168:171], a[200:203], a[80:83], a[168:171]
v_mfma_f32_16x16x32_bf16 a[168:171], a[204:207], a[84:87], a[168:171]
buffer_load_dwordx4 a[44:47], v17, s[4:7], s63 offen offset:1024 sc1
v_mfma_f32_16x16x32_bf16 a[172:175], a[204:207], a[92:95], a[172:175]
v_mfma_f32_16x16x32_bf16 a[172:175], a[200:203], a[88:91], a[172:175]
s_waitcnt lgkmcnt(4)
v_mfma_f32_16x16x32_bf16 a[176:179], a[208:211], a[64:67], a[176:179]
ds_read_b64_tr_b16 a[200:201], v29 offset:49152
ds_read_b64_tr_b16 a[202:203], v29 offset:50176
v_mfma_f32_16x16x32_bf16 a[176:179], a[212:215], a[68:71], a[176:179]
s_add_u32 s62, s60, 9216
ds_read_b64_tr_b16 a[204:205], v29 offset:57344
ds_read_b64_tr_b16 a[206:207], v29 offset:58368
v_mfma_f32_16x16x32_bf16 a[180:183], a[212:215], a[76:79], a[180:183]
buffer_store_dwordx4 v[92:95], v1, s[4:7], s62 offen sc1
v_mfma_f32_16x16x32_bf16 a[180:183], a[208:211], a[72:75], a[180:183]
v_mfma_f32_16x16x32_bf16 a[184:187], a[208:211], a[80:83], a[184:187]
v_mfma_f32_16x16x32_bf16 a[184:187], a[212:215], a[84:87], a[184:187]
buffer_load_dwordx4 a[48:51], v18, s[4:7], s63 offen offset:0 sc1
v_mfma_f32_16x16x32_bf16 a[188:191], a[212:215], a[92:95], a[188:191]
v_mfma_f32_16x16x32_bf16 a[188:191], a[208:211], a[88:91], a[188:191]
s_waitcnt lgkmcnt(4)
v_mfma_f32_16x16x32_bf16 a[216:219], a[192:195], a[64:67], a[216:219]
ds_read_b64_tr_b16 a[208:209], v30 offset:49152
ds_read_b64_tr_b16 a[210:211], v30 offset:49664
v_mfma_f32_16x16x32_bf16 a[216:219], a[196:199], a[68:71], a[216:219]
s_add_u32 s62, s60, 25600
ds_read_b64_tr_b16 a[212:213], v30 offset:53248
ds_read_b64_tr_b16 a[214:215], v30 offset:53760
v_mfma_f32_16x16x32_bf16 a[220:223], a[196:199], a[76:79], a[220:223]
buffer_store_dwordx4 v[96:99], v1, s[4:7], s62 offen sc1
v_mfma_f32_16x16x32_bf16 a[220:223], a[192:195], a[72:75], a[220:223]
v_mfma_f32_16x16x32_bf16 a[224:227], a[192:195], a[80:83], a[224:227]
v_mfma_f32_16x16x32_bf16 a[224:227], a[196:199], a[84:87], a[224:227]
buffer_load_dwordx4 a[52:55], v18, s[4:7], s63 offen offset:1024 sc1
v_mfma_f32_16x16x32_bf16 a[228:231], a[196:199], a[92:95], a[228:231]
v_mfma_f32_16x16x32_bf16 a[228:231], a[192:195], a[88:91], a[228:231]
s_waitcnt lgkmcnt(4)
v_mfma_f32_16x16x32_bf16 a[232:235], a[200:203], a[64:67], a[232:235]
ds_read_b64_tr_b16 a[192:193], v31 offset:49152
ds_read_b64_tr_b16 a[194:195], v31 offset:49664
v_mfma_f32_16x16x32_bf16 a[232:235], a[204:207], a[68:71], a[232:235]
ds_read_b64_tr_b16 a[196:197], v31 offset:53248
ds_read_b64_tr_b16 a[198:199], v31 offset:53760
v_mfma_f32_16x16x32_bf16 a[236:239], a[204:207], a[76:79], a[236:239]
buffer_load_dwordx4 a[56:59], v19, s[4:7], s63 offen offset:0 sc1
v_mfma_f32_16x16x32_bf16 a[236:239], a[200:203], a[72:75], a[236:239]
v_mfma_f32_16x16x32_bf16 a[240:243], a[200:203], a[80:83], a[240:243]
v_mfma_f32_16x16x32_bf16 a[240:243], a[204:207], a[84:87], a[240:243]
buffer_load_dwordx4 a[60:63], v19, s[4:7], s63 offen offset:1024 sc1
v_mfma_f32_16x16x32_bf16 a[244:247], a[204:207], a[92:95], a[244:247]
v_mfma_f32_16x16x32_bf16 a[244:247], a[200:203], a[88:91], a[244:247]
s_waitcnt lgkmcnt(4)
v_mfma_f32_16x16x32_bf16 v[172:175], a[208:211], a[64:67], v[172:175]
ds_read_b64_tr_b16 a[200:201], v32 offset:49152
ds_read_b64_tr_b16 a[202:203], v32 offset:49664
v_mfma_f32_16x16x32_bf16 v[172:175], a[212:215], a[68:71], v[172:175]
ds_read_b64_tr_b16 a[204:205], v32 offset:53248
ds_read_b64_tr_b16 a[206:207], v32 offset:53760
v_mfma_f32_16x16x32_bf16 v[176:179], a[212:215], a[76:79], v[176:179]
v_mfma_f32_16x16x32_bf16 v[176:179], a[208:211], a[72:75], v[176:179]
v_mfma_f32_16x16x32_bf16 v[180:183], a[208:211], a[80:83], v[180:183]
v_mfma_f32_16x16x32_bf16 v[180:183], a[212:215], a[84:87], v[180:183]
v_mfma_f32_16x16x32_bf16 v[184:187], a[212:215], a[92:95], v[184:187]
v_mfma_f32_16x16x32_bf16 v[184:187], a[208:211], a[88:91], v[184:187]
s_waitcnt lgkmcnt(4)
v_mfma_f32_16x16x32_bf16 v[188:191], a[192:195], a[64:67], v[188:191]
ds_read_b64_tr_b16 a[208:209], v33 offset:49152
ds_read_b64_tr_b16 a[210:211], v33 offset:49664
v_mfma_f32_16x16x32_bf16 v[188:191], a[196:199], a[68:71], v[188:191]
ds_read_b64_tr_b16 a[212:213], v33 offset:53248
ds_read_b64_tr_b16 a[214:215], v33 offset:53760
v_mfma_f32_16x16x32_bf16 v[192:195], a[196:199], a[76:79], v[192:195]
v_mfma_f32_16x16x32_bf16 v[192:195], a[192:195], a[72:75], v[192:195]
v_mfma_f32_16x16x32_bf16 v[196:199], a[192:195], a[80:83], v[196:199]
v_mfma_f32_16x16x32_bf16 v[196:199], a[196:199], a[84:87], v[196:199]
v_mfma_f32_16x16x32_bf16 v[200:203], a[196:199], a[92:95], v[200:203]
v_mfma_f32_16x16x32_bf16 v[200:203], a[192:195], a[88:91], v[200:203]
s_waitcnt lgkmcnt(4)
v_mfma_f32_16x16x32_bf16 v[204:207], a[200:203], a[64:67], v[204:207]
v_mfma_f32_16x16x32_bf16 v[204:207], a[204:207], a[68:71], v[204:207]
v_mfma_f32_16x16x32_bf16 v[208:211], a[204:207], a[76:79], v[208:211]
v_mfma_f32_16x16x32_bf16 v[208:211], a[200:203], a[72:75], v[208:211]
v_mfma_f32_16x16x32_bf16 v[212:215], a[200:203], a[80:83], v[212:215]
s_waitcnt vmcnt(32) lgkmcnt(0)
s_barrier
ds_read_b64_tr_b16 a[192:193], v22 offset:0
v_mfma_f32_16x16x32_bf16 v[212:215], a[204:207], a[84:87], v[212:215]
s_add_u32 m0, s65, 49152
ds_read_b64_tr_b16 a[194:195], v22 offset:1024
ds_read_b64_tr_b16 a[196:197], v22 offset:8192
v_mfma_f32_16x16x32_bf16 v[216:219], a[204:207], a[92:95], v[216:219]
s_add_u32 s3, s93, 5
s_and_b32 s3, s3, 7
ds_read_b64_tr_b16 a[198:199], v22 offset:9216
v_mfma_f32_16x16x32_bf16 v[216:219], a[200:203], a[88:91], v[216:219]
s_xor_b32 s3, s3, s94
s_lshl_b32 s3, s3, 19
v_mfma_f32_16x16x32_bf16 v[220:223], a[208:211], a[64:67], v[220:223]
ds_read_b64_tr_b16 a[200:201], v23 offset:0
ds_read_b64_tr_b16 a[202:203], v23 offset:1024
v_mfma_f32_16x16x32_bf16 v[220:223], a[212:215], a[68:71], v[220:223]
ds_read_b64_tr_b16 a[204:205], v23 offset:8192
ds_read_b64_tr_b16 a[206:207], v23 offset:9216
v_mfma_f32_16x16x32_bf16 v[224:227], a[212:215], a[76:79], v[224:227]
buffer_load_dwordx4 v12, s[16:19], s3 offen offset:0 lds
v_mfma_f32_16x16x32_bf16 v[224:227], a[208:211], a[72:75], v[224:227]
buffer_load_dwordx4 v13, s[16:19], s3 offen offset:1024 lds
v_mfma_f32_16x16x32_bf16 v[228:231], a[208:211], a[80:83], v[228:231]
v_mfma_f32_16x16x32_bf16 v[228:231], a[212:215], a[84:87], v[228:231]
buffer_load_dwordx4 v14, s[16:19], s3 offen offset:2048 lds
v_mfma_f32_16x16x32_bf16 v[232:235], a[212:215], a[92:95], v[232:235]
v_mfma_f32_16x16x32_bf16 v[232:235], a[208:211], a[88:91], v[232:235]
s_waitcnt vmcnt(34) lgkmcnt(5)
v_mfma_f32_16x16x32_bf16 a[96:99], a[192:195], a[0:3], a[96:99]
s_waitcnt vmcnt(32) lgkmcnt(4)
ds_read_b64_tr_b16 a[208:209], v24 offset:0
ds_read_b64_tr_b16 a[210:211], v24 offset:1024
v_mfma_f32_16x16x32_bf16 a[96:99], a[196:199], a[4:7], a[96:99]
s_waitcnt vmcnt(28)
ds_read_b64_tr_b16 a[212:213], v24 offset:8192
ds_read_b64_tr_b16 a[214:215], v24 offset:9216
v_mfma_f32_16x16x32_bf16 a[100:103], a[196:199], a[12:15], a[100:103]
buffer_load_dwordx4 v15, s[16:19], s3 offen offset:3072 lds
v_mfma_f32_16x16x32_bf16 a[100:103], a[192:195], a[8:11], a[100:103]
s_waitcnt vmcnt(27)
v_mfma_f32_16x16x32_bf16 a[104:107], a[192:195], a[16:19], a[104:107]
s_waitcnt vmcnt(25)
v_mfma_f32_16x16x32_bf16 a[104:107], a[196:199], a[20:23], a[104:107]
s_waitcnt vmcnt(23)
s_add_u32 m0, s66, 65536
s_add_u32 s3, s93, 5
s_and_b32 s3, s3, 7
v_mfma_f32_16x16x32_bf16 a[108:111], a[196:199], a[28:31], a[108:111]
s_xor_b32 s3, s3, s94
s_mul_i32 s3, s3, 221184
s_add_u32 s3, s3, s67
v_mfma_f32_16x16x32_bf16 a[108:111], a[192:195], a[24:27], a[108:111]
s_waitcnt lgkmcnt(4)
buffer_load_dwordx4 v20, s[32:35], s3 offen offset:0 lds
v_mfma_f32_16x16x32_bf16 a[112:115], a[200:203], a[0:3], a[112:115]
ds_read_b64_tr_b16 a[192:193], v25 offset:0
ds_read_b64_tr_b16 a[194:195], v25 offset:1024
v_mfma_f32_16x16x32_bf16 a[112:115], a[204:207], a[4:7], a[112:115]
ds_read_b64_tr_b16 a[196:197], v25 offset:8192
ds_read_b64_tr_b16 a[198:199], v25 offset:9216
v_mfma_f32_16x16x32_bf16 a[116:119], a[204:207], a[12:15], a[116:119]
buffer_load_dwordx4 v21, s[32:35], s3 offen offset:1024 lds
v_mfma_f32_16x16x32_bf16 a[116:119], a[200:203], a[8:11], a[116:119]
v_mfma_f32_16x16x32_bf16 a[120:123], a[200:203], a[16:19], a[120:123]
v_mfma_f32_16x16x32_bf16 a[120:123], a[204:207], a[20:23], a[120:123]
s_add_u32 s63, s93, 5
s_and_b32 s63, s63, 7
s_xor_b32 s63, s63, s94
v_mfma_f32_16x16x32_bf16 a[124:127], a[204:207], a[28:31], a[124:127]
s_lshl_b32 s63, s63, 11
buffer_load_dwordx4 a[64:67], v16, s[4:7], s63 offen offset:0 sc1
v_mfma_f32_16x16x32_bf16 a[124:127], a[200:203], a[24:27], a[124:127]
s_waitcnt lgkmcnt(4)
v_mfma_f32_16x16x32_bf16 a[128:131], a[208:211], a[0:3], a[128:131]
ds_read_b64_tr_b16 a[200:201], v26 offset:0
ds_read_b64_tr_b16 a[202:203], v26 offset:1024
v_mfma_f32_16x16x32_bf16 a[128:131], a[212:215], a[4:7], a[128:131]
s_add_u32 s62, s60, 13312
ds_read_b64_tr_b16 a[204:205], v26 offset:8192
ds_read_b64_tr_b16 a[206:207], v26 offset:9216
v_mfma_f32_16x16x32_bf16 a[132:135], a[212:215], a[12:15], a[132:135]
buffer_store_dwordx4 v[100:103], v1, s[4:7], s62 offen sc1
v_mfma_f32_16x16x32_bf16 a[132:135], a[208:211], a[8:11], a[132:135]
v_mfma_f32_16x16x32_bf16 a[136:139], a[208:211], a[16:19], a[136:139]
v_mfma_f32_16x16x32_bf16 a[136:139], a[212:215], a[20:23], a[136:139]
buffer_load_dwordx4 a[68:71], v16, s[4:7], s63 offen offset:1024 sc1
v_mfma_f32_16x16x32_bf16 a[140:143], a[212:215], a[28:31], a[140:143]
v_mfma_f32_16x16x32_bf16 a[140:143], a[208:211], a[24:27], a[140:143]
s_waitcnt lgkmcnt(4)
v_mfma_f32_16x16x32_bf16 a[144:147], a[192:195], a[0:3], a[144:147]
ds_read_b64_tr_b16 a[208:209], v27 offset:0
ds_read_b64_tr_b16 a[210:211], v27 offset:1024
v_mfma_f32_16x16x32_bf16 a[144:147], a[196:199], a[4:7], a[144:147]
s_add_u32 s62, s60, 29696
ds_read_b64_tr_b16 a[212:213], v27 offset:8192
ds_read_b64_tr_b16 a[214:215], v27 offset:9216
v_mfma_f32_16x16x32_bf16 a[148:151], a[196:199], a[12:15], a[148:151]
buffer_store_dwordx4 v[104:107], v1, s[4:7], s62 offen sc1
v_mfma_f32_16x16x32_bf16 a[148:151], a[192:195], a[8:11], a[148:151]
v_mfma_f32_16x16x32_bf16 a[152:155], a[192:195], a[16:19], a[152:155]
v_mfma_f32_16x16x32_bf16 a[152:155], a[196:199], a[20:23], a[152:155]
buffer_load_dwordx4 a[72:75], v17, s[4:7], s63 offen offset:0 sc1
v_mfma_f32_16x16x32_bf16 a[156:159], a[196:199], a[28:31], a[156:159]
v_mfma_f32_16x16x32_bf16 a[156:159], a[192:195], a[24:27], a[156:159]
s_waitcnt lgkmcnt(4)
v_mfma_f32_16x16x32_bf16 a[160:163], a[200:203], a[0:3], a[160:163]
ds_read_b64_tr_b16 a[192:193], v28 offset:0
ds_read_b64_tr_b16 a[194:195], v28 offset:1024
v_mfma_f32_16x16x32_bf16 a[160:163], a[204:207], a[4:7], a[160:163]
s_add_u32 s62, s61, 0
ds_read_b64_tr_b16 a[196:197], v28 offset:8192
ds_read_b64_tr_b16 a[198:199], v28 offset:9216
v_mfma_f32_16x16x32_bf16 a[164:167], a[204:207], a[12:15], a[164:167]
buffer_store_dwordx4 v[108:111], v1, s[4:7], s62 offen sc1
v_mfma_f32_16x16x32_bf16 a[164:167], a[200:203], a[8:11], a[164:167]
v_mfma_f32_16x16x32_bf16 a[168:171], a[200:203], a[16:19], a[168:171]
v_mfma_f32_16x16x32_bf16 a[168:171], a[204:207], a[20:23], a[168:171]
buffer_load_dwordx4 a[76:79], v17, s[4:7], s63 offen offset:1024 sc1
v_mfma_f32_16x16x32_bf16 a[172:175], a[204:207], a[28:31], a[172:175]
v_mfma_f32_16x16x32_bf16 a[172:175], a[200:203], a[24:27], a[172:175]
s_waitcnt lgkmcnt(4)
v_mfma_f32_16x16x32_bf16 a[176:179], a[208:211], a[0:3], a[176:179]
ds_read_b64_tr_b16 a[200:201], v29 offset:0
ds_read_b64_tr_b16 a[202:203], v29 offset:1024
v_mfma_f32_16x16x32_bf16 a[176:179], a[212:215], a[4:7], a[176:179]
s_add_u32 s62, s61, 1024
ds_read_b64_tr_b16 a[204:205], v29 offset:8192
ds_read_b64_tr_b16 a[206:207], v29 offset:9216
v_mfma_f32_16x16x32_bf16 a[180:183], a[212:215], a[12:15], a[180:183]
buffer_store_dwordx4 v[112:115], v1, s[4:7], s62 offen sc1
v_mfma_f32_16x16x32_bf16 a[180:183], a[208:211], a[8:11], a[180:183]
v_mfma_f32_16x16x32_bf16 a[184:187], a[208:211], a[16:19], a[184:187]
v_mfma_f32_16x16x32_bf16 a[184:187], a[212:215], a[20:23], a[184:187]
buffer_load_dwordx4 a[80:83], v18, s[4:7], s63 offen offset:0 sc1
v_mfma_f32_16x16x32_bf16 a[188:191], a[212:215], a[28:31], a[188:191]
v_mfma_f32_16x16x32_bf16 a[188:191], a[208:211], a[24:27], a[188:191]
s_waitcnt lgkmcnt(4)
v_mfma_f32_16x16x32_bf16 a[216:219], a[192:195], a[0:3], a[216:219]
ds_read_b64_tr_b16 a[208:209], v30 offset:0
ds_read_b64_tr_b16 a[210:211], v30 offset:512
v_mfma_f32_16x16x32_bf16 a[216:219], a[196:199], a[4:7], a[216:219]
s_add_u32 s62, s61, 16384
ds_read_b64_tr_b16 a[212:213], v30 offset:4096
ds_read_b64_tr_b16 a[214:215], v30 offset:4608
v_mfma_f32_16x16x32_bf16 a[220:223], a[196:199], a[12:15], a[220:223]
buffer_store_dwordx4 v[116:119], v1, s[4:7], s62 offen sc1
v_mfma_f32_16x16x32_bf16 a[220:223], a[192:195], a[8:11], a[220:223]
v_mfma_f32_16x16x32_bf16 a[224:227], a[192:195], a[16:19], a[224:227]
v_mfma_f32_16x16x32_bf16 a[224:227], a[196:199], a[20:23], a[224:227]
buffer_load_dwordx4 a[84:87], v18, s[4:7], s63 offen offset:1024 sc1
v_mfma_f32_16x16x32_bf16 a[228:231], a[196:199], a[28:31], a[228:231]
v_mfma_f32_16x16x32_bf16 a[228:231], a[192:195], a[24:27], a[228:231]
s_waitcnt lgkmcnt(4)
v_mfma_f32_16x16x32_bf16 a[232:235], a[200:203], a[0:3], a[232:235]
ds_read_b64_tr_b16 a[192:193], v31 offset:0
ds_read_b64_tr_b16 a[194:195], v31 offset:512
v_mfma_f32_16x16x32_bf16 a[232:235], a[204:207], a[4:7], a[232:235]
ds_read_b64_tr_b16 a[196:197], v31 offset:4096
ds_read_b64_tr_b16 a[198:199], v31 offset:4608
v_mfma_f32_16x16x32_bf16 a[236:239], a[204:207], a[12:15], a[236:239]
buffer_load_dwordx4 a[88:91], v19, s[4:7], s63 offen offset:0 sc1
v_mfma_f32_16x16x32_bf16 a[236:239], a[200:203], a[8:11], a[236:239]
v_mfma_f32_16x16x32_bf16 a[240:243], a[200:203], a[16:19], a[240:243]
v_mfma_f32_16x16x32_bf16 a[240:243], a[204:207], a[20:23], a[240:243]
buffer_load_dwordx4 a[92:95], v19, s[4:7], s63 offen offset:1024 sc1
v_mfma_f32_16x16x32_bf16 a[244:247], a[204:207], a[28:31], a[244:247]
v_mfma_f32_16x16x32_bf16 a[244:247], a[200:203], a[24:27], a[244:247]
s_waitcnt lgkmcnt(4)
v_mfma_f32_16x16x32_bf16 v[172:175], a[208:211], a[0:3], v[172:175]
ds_read_b64_tr_b16 a[200:201], v32 offset:0
ds_read_b64_tr_b16 a[202:203], v32 offset:512
v_mfma_f32_16x16x32_bf16 v[172:175], a[212:215], a[4:7], v[172:175]
ds_read_b64_tr_b16 a[204:205], v32 offset:4096
ds_read_b64_tr_b16 a[206:207], v32 offset:4608
v_mfma_f32_16x16x32_bf16 v[176:179], a[212:215], a[12:15], v[176:179]
v_mfma_f32_16x16x32_bf16 v[176:179], a[208:211], a[8:11], v[176:179]
v_mfma_f32_16x16x32_bf16 v[180:183], a[208:211], a[16:19], v[180:183]
v_mfma_f32_16x16x32_bf16 v[180:183], a[212:215], a[20:23], v[180:183]
v_mfma_f32_16x16x32_bf16 v[184:187], a[212:215], a[28:31], v[184:187]
v_mfma_f32_16x16x32_bf16 v[184:187], a[208:211], a[24:27], v[184:187]
s_waitcnt lgkmcnt(4)
v_mfma_f32_16x16x32_bf16 v[188:191], a[192:195], a[0:3], v[188:191]
ds_read_b64_tr_b16 a[208:209], v33 offset:0
ds_read_b64_tr_b16 a[210:211], v33 offset:512
v_mfma_f32_16x16x32_bf16 v[188:191], a[196:199], a[4:7], v[188:191]
ds_read_b64_tr_b16 a[212:213], v33 offset:4096
ds_read_b64_tr_b16 a[214:215], v33 offset:4608
v_mfma_f32_16x16x32_bf16 v[192:195], a[196:199], a[12:15], v[192:195]
v_mfma_f32_16x16x32_bf16 v[192:195], a[192:195], a[8:11], v[192:195]
v_mfma_f32_16x16x32_bf16 v[196:199], a[192:195], a[16:19], v[196:199]
v_mfma_f32_16x16x32_bf16 v[196:199], a[196:199], a[20:23], v[196:199]
v_mfma_f32_16x16x32_bf16 v[200:203], a[196:199], a[28:31], v[200:203]
v_mfma_f32_16x16x32_bf16 v[200:203], a[192:195], a[24:27], v[200:203]
s_waitcnt lgkmcnt(4)
v_mfma_f32_16x16x32_bf16 v[204:207], a[200:203], a[0:3], v[204:207]
v_mfma_f32_16x16x32_bf16 v[204:207], a[204:207], a[4:7], v[204:207]
v_mfma_f32_16x16x32_bf16 v[208:211], a[204:207], a[12:15], v[208:211]
v_mfma_f32_16x16x32_bf16 v[208:211], a[200:203], a[8:11], v[208:211]
v_mfma_f32_16x16x32_bf16 v[212:215], a[200:203], a[16:19], v[212:215]
s_waitcnt vmcnt(32) lgkmcnt(0)
s_barrier
ds_read_b64_tr_b16 a[192:193], v22 offset:24576
v_mfma_f32_16x16x32_bf16 v[212:215], a[204:207], a[20:23], v[212:215]
s_add_u32 m0, s65, 0
ds_read_b64_tr_b16 a[194:195], v22 offset:25600
ds_read_b64_tr_b16 a[196:197], v22 offset:32768
v_mfma_f32_16x16x32_bf16 v[216:219], a[204:207], a[28:31], v[216:219]
s_add_u32 s3, s93, 6
s_and_b32 s3, s3, 7
ds_read_b64_tr_b16 a[198:199], v22 offset:33792
v_mfma_f32_16x16x32_bf16 v[216:219], a[200:203], a[24:27], v[216:219]
s_xor_b32 s3, s3, s94
s_lshl_b32 s3, s3, 19
v_mfma_f32_16x16x32_bf16 v[220:223], a[208:211], a[0:3], v[220:223]
ds_read_b64_tr_b16 a[200:201], v23 offset:24576
ds_read_b64_tr_b16 a[202:203], v23 offset:25600
v_mfma_f32_16x16x32_bf16 v[220:223], a[212:215], a[4:7], v[220:223]
ds_read_b64_tr_b16 a[204:205], v23 offset:32768
ds_read_b64_tr_b16 a[206:207], v23 offset:33792
v_mfma_f32_16x16x32_bf16 v[224:227], a[212:215], a[12:15], v[224:227]
buffer_load_dwordx4 v12, s[16:19], s3 offen offset:0 lds
v_mfma_f32_16x16x32_bf16 v[224:227], a[208:211], a[8:11], v[224:227]
buffer_load_dwordx4 v13, s[16:19], s3 offen offset:1024 lds
v_mfma_f32_16x16x32_bf16 v[228:231], a[208:211], a[16:19], v[228:231]
v_mfma_f32_16x16x32_bf16 v[228:231], a[212:215], a[20:23], v[228:231]
buffer_load_dwordx4 v14, s[16:19], s3 offen offset:2048 lds
v_mfma_f32_16x16x32_bf16 v[232:235], a[212:215], a[28:31], v[232:235]
v_mfma_f32_16x16x32_bf16 v[232:235], a[208:211], a[24:27], v[232:235]
s_waitcnt vmcnt(34) lgkmcnt(5)
v_mfma_f32_16x16x32_bf16 a[96:99], a[192:195], a[32:35], a[96:99]
s_waitcnt vmcnt(32) lgkmcnt(4)
ds_read_b64_tr_b16 a[208:209], v24 offset:24576
ds_read_b64_tr_b16 a[210:211], v24 offset:25600
v_mfma_f32_16x16x32_bf16 a[96:99], a[196:199], a[36:39], a[96:99]
s_waitcnt vmcnt(28)
ds_read_b64_tr_b16 a[212:213], v24 offset:32768
ds_read_b64_tr_b16 a[214:215], v24 offset:33792
v_mfma_f32_16x16x32_bf16 a[100:103], a[196:199], a[44:47], a[100:103]
buffer_load_dwordx4 v15, s[16:19], s3 offen offset:3072 lds
v_mfma_f32_16x16x32_bf16 a[100:103], a[192:195], a[40:43], a[100:103]
s_waitcnt vmcnt(27)
v_mfma_f32_16x16x32_bf16 a[104:107], a[192:195], a[48:51], a[104:107]
s_waitcnt vmcnt(25)
v_mfma_f32_16x16x32_bf16 a[104:107], a[196:199], a[52:55], a[104:107]
s_waitcnt vmcnt(23)
s_add_u32 m0, s66, 16384
s_add_u32 s3, s93, 6
s_and_b32 s3, s3, 7
v_mfma_f32_16x16x32_bf16 a[108:111], a[196:199], a[60:63], a[108:111]
s_xor_b32 s3, s3, s94
s_mul_i32 s3, s3, 221184
s_add_u32 s3, s3, s67
v_mfma_f32_16x16x32_bf16 a[108:111], a[192:195], a[56:59], a[108:111]
s_waitcnt lgkmcnt(4)
buffer_load_dwordx4 v20, s[32:35], s3 offen offset:0 lds
v_mfma_f32_16x16x32_bf16 a[112:115], a[200:203], a[32:35], a[112:115]
ds_read_b64_tr_b16 a[192:193], v25 offset:24576
ds_read_b64_tr_b16 a[194:195], v25 offset:25600
v_mfma_f32_16x16x32_bf16 a[112:115], a[204:207], a[36:39], a[112:115]
ds_read_b64_tr_b16 a[196:197], v25 offset:32768
ds_read_b64_tr_b16 a[198:199], v25 offset:33792
v_mfma_f32_16x16x32_bf16 a[116:119], a[204:207], a[44:47], a[116:119]
buffer_load_dwordx4 v21, s[32:35], s3 offen offset:1024 lds
v_mfma_f32_16x16x32_bf16 a[116:119], a[200:203], a[40:43], a[116:119]
v_mfma_f32_16x16x32_bf16 a[120:123], a[200:203], a[48:51], a[120:123]
v_mfma_f32_16x16x32_bf16 a[120:123], a[204:207], a[52:55], a[120:123]
s_add_u32 s63, s93, 6
s_and_b32 s63, s63, 7
s_xor_b32 s63, s63, s94
v_mfma_f32_16x16x32_bf16 a[124:127], a[204:207], a[60:63], a[124:127]
s_lshl_b32 s63, s63, 11
buffer_load_dwordx4 a[0:3], v16, s[4:7], s63 offen offset:0 sc1
v_mfma_f32_16x16x32_bf16 a[124:127], a[200:203], a[56:59], a[124:127]
s_waitcnt lgkmcnt(4)
v_mfma_f32_16x16x32_bf16 a[128:131], a[208:211], a[32:35], a[128:131]
ds_read_b64_tr_b16 a[200:201], v26 offset:24576
ds_read_b64_tr_b16 a[202:203], v26 offset:25600
v_mfma_f32_16x16x32_bf16 a[128:131], a[212:215], a[36:39], a[128:131]
s_add_u32 s62, s61, 17408
ds_read_b64_tr_b16 a[204:205], v26 offset:32768
ds_read_b64_tr_b16 a[206:207], v26 offset:33792
v_mfma_f32_16x16x32_bf16 a[132:135], a[212:215], a[44:47], a[132:135]
buffer_store_dwordx4 v[120:123], v1, s[4:7], s62 offen sc1
v_mfma_f32_16x16x32_bf16 a[132:135], a[208:211], a[40:43], a[132:135]
v_mfma_f32_16x16x32_bf16 a[136:139], a[208:211], a[48:51], a[136:139]
v_mfma_f32_16x16x32_bf16 a[136:139], a[212:215], a[52:55], a[136:139]
buffer_load_dwordx4 a[4:7], v16, s[4:7], s63 offen offset:1024 sc1
v_mfma_f32_16x16x32_bf16 a[140:143], a[212:215], a[60:63], a[140:143]
v_mfma_f32_16x16x32_bf16 a[140:143], a[208:211], a[56:59], a[140:143]
s_waitcnt lgkmcnt(4)
v_mfma_f32_16x16x32_bf16 a[144:147], a[192:195], a[32:35], a[144:147]
ds_read_b64_tr_b16 a[208:209], v27 offset:24576
ds_read_b64_tr_b16 a[210:211], v27 offset:25600
v_mfma_f32_16x16x32_bf16 a[144:147], a[196:199], a[36:39], a[144:147]
s_add_u32 s62, s61, 2048
ds_read_b64_tr_b16 a[212:213], v27 offset:32768
ds_read_b64_tr_b16 a[214:215], v27 offset:33792
v_mfma_f32_16x16x32_bf16 a[148:151], a[196:199], a[44:47], a[148:151]
buffer_store_dwordx4 v[124:127], v1, s[4:7], s62 offen sc1
v_mfma_f32_16x16x32_bf16 a[148:151], a[192:195], a[40:43], a[148:151]
v_mfma_f32_16x16x32_bf16 a[152:155], a[192:195], a[48:51], a[152:155]
v_mfma_f32_16x16x32_bf16 a[152:155], a[196:199], a[52:55], a[152:155]
buffer_load_dwordx4 a[8:11], v17, s[4:7], s63 offen offset:0 sc1
v_mfma_f32_16x16x32_bf16 a[156:159], a[196:199], a[60:63], a[156:159]
v_mfma_f32_16x16x32_bf16 a[156:159], a[192:195], a[56:59], a[156:159]
s_waitcnt lgkmcnt(4)
v_mfma_f32_16x16x32_bf16 a[160:163], a[200:203], a[32:35], a[160:163]
ds_read_b64_tr_b16 a[192:193], v28 offset:24576
ds_read_b64_tr_b16 a[194:195], v28 offset:25600
v_mfma_f32_16x16x32_bf16 a[160:163], a[204:207], a[36:39], a[160:163]
s_add_u32 s62, s61, 3072
ds_read_b64_tr_b16 a[196:197], v28 offset:32768
ds_read_b64_tr_b16 a[198:199], v28 offset:33792
v_mfma_f32_16x16x32_bf16 a[164:167], a[204:207], a[44:47], a[164:167]
buffer_store_dwordx4 v[128:131], v1, s[4:7], s62 offen sc1
v_mfma_f32_16x16x32_bf16 a[164:167], a[200:203], a[40:43], a[164:167]
v_mfma_f32_16x16x32_bf16 a[168:171], a[200:203], a[48:51], a[168:171]
v_mfma_f32_16x16x32_bf16 a[168:171], a[204:207], a[52:55], a[168:171]
buffer_load_dwordx4 a[12:15], v17, s[4:7], s63 offen offset:1024 sc1
v_mfma_f32_16x16x32_bf16 a[172:175], a[204:207], a[60:63], a[172:175]
v_mfma_f32_16x16x32_bf16 a[172:175], a[200:203], a[56:59], a[172:175]
s_waitcnt lgkmcnt(4)
v_mfma_f32_16x16x32_bf16 a[176:179], a[208:211], a[32:35], a[176:179]
ds_read_b64_tr_b16 a[200:201], v29 offset:24576
ds_read_b64_tr_b16 a[202:203], v29 offset:25600
v_mfma_f32_16x16x32_bf16 a[176:179], a[212:215], a[36:39], a[176:179]
s_add_u32 s62, s61, 18432
ds_read_b64_tr_b16 a[204:205], v29 offset:32768
ds_read_b64_tr_b16 a[206:207], v29 offset:33792
v_mfma_f32_16x16x32_bf16 a[180:183], a[212:215], a[44:47], a[180:183]
buffer_store_dwordx4 v[132:135], v1, s[4:7], s62 offen sc1
v_mfma_f32_16x16x32_bf16 a[180:183], a[208:211], a[40:43], a[180:183]
v_mfma_f32_16x16x32_bf16 a[184:187], a[208:211], a[48:51], a[184:187]
v_mfma_f32_16x16x32_bf16 a[184:187], a[212:215], a[52:55], a[184:187]
buffer_load_dwordx4 a[16:19], v18, s[4:7], s63 offen offset:0 sc1
v_mfma_f32_16x16x32_bf16 a[188:191], a[212:215], a[60:63], a[188:191]
v_mfma_f32_16x16x32_bf16 a[188:191], a[208:211], a[56:59], a[188:191]
s_waitcnt lgkmcnt(4)
v_mfma_f32_16x16x32_bf16 a[216:219], a[192:195], a[32:35], a[216:219]
ds_read_b64_tr_b16 a[208:209], v30 offset:24576
ds_read_b64_tr_b16 a[210:211], v30 offset:25088
v_mfma_f32_16x16x32_bf16 a[216:219], a[196:199], a[36:39], a[216:219]
s_add_u32 s62, s61, 19456
ds_read_b64_tr_b16 a[212:213], v30 offset:28672
ds_read_b64_tr_b16 a[214:215], v30 offset:29184
v_mfma_f32_16x16x32_bf16 a[220:223], a[196:199], a[44:47], a[220:223]
buffer_store_dwordx4 v[136:139], v1, s[4:7], s62 offen sc1
v_mfma_f32_16x16x32_bf16 a[220:223], a[192:195], a[40:43], a[220:223]
v_mfma_f32_16x16x32_bf16 a[224:227], a[192:195], a[48:51], a[224:227]
v_mfma_f32_16x16x32_bf16 a[224:227], a[196:199], a[52:55], a[224:227]
buffer_load_dwordx4 a[20:23], v18, s[4:7], s63 offen offset:1024 sc1
v_mfma_f32_16x16x32_bf16 a[228:231], a[196:199], a[60:63], a[228:231]
v_mfma_f32_16x16x32_bf16 a[228:231], a[192:195], a[56:59], a[228:231]
s_waitcnt lgkmcnt(4)
v_mfma_f32_16x16x32_bf16 a[232:235], a[200:203], a[32:35], a[232:235]
ds_read_b64_tr_b16 a[192:193], v31 offset:24576
ds_read_b64_tr_b16 a[194:195], v31 offset:25088
v_mfma_f32_16x16x32_bf16 a[232:235], a[204:207], a[36:39], a[232:235]
ds_read_b64_tr_b16 a[196:197], v31 offset:28672
ds_read_b64_tr_b16 a[198:199], v31 offset:29184
v_mfma_f32_16x16x32_bf16 a[236:239], a[204:207], a[44:47], a[236:239]
buffer_load_dwordx4 a[24:27], v19, s[4:7], s63 offen offset:0 sc1
v_mfma_f32_16x16x32_bf16 a[236:239], a[200:203], a[40:43], a[236:239]
v_mfma_f32_16x16x32_bf16 a[240:243], a[200:203], a[48:51], a[240:243]
v_mfma_f32_16x16x32_bf16 a[240:243], a[204:207], a[52:55], a[240:243]
buffer_load_dwordx4 a[28:31], v19, s[4:7], s63 offen offset:1024 sc1
v_mfma_f32_16x16x32_bf16 a[244:247], a[204:207], a[60:63], a[244:247]
v_mfma_f32_16x16x32_bf16 a[244:247], a[200:203], a[56:59], a[244:247]
s_waitcnt lgkmcnt(4)
v_mfma_f32_16x16x32_bf16 v[172:175], a[208:211], a[32:35], v[172:175]
ds_read_b64_tr_b16 a[200:201], v32 offset:24576
ds_read_b64_tr_b16 a[202:203], v32 offset:25088
v_mfma_f32_16x16x32_bf16 v[172:175], a[212:215], a[36:39], v[172:175]
ds_read_b64_tr_b16 a[204:205], v32 offset:28672
ds_read_b64_tr_b16 a[206:207], v32 offset:29184
v_mfma_f32_16x16x32_bf16 v[176:179], a[212:215], a[44:47], v[176:179]
v_mfma_f32_16x16x32_bf16 v[176:179], a[208:211], a[40:43], v[176:179]
v_mfma_f32_16x16x32_bf16 v[180:183], a[208:211], a[48:51], v[180:183]
v_mfma_f32_16x16x32_bf16 v[180:183], a[212:215], a[52:55], v[180:183]
v_mfma_f32_16x16x32_bf16 v[184:187], a[212:215], a[60:63], v[184:187]
v_mfma_f32_16x16x32_bf16 v[184:187], a[208:211], a[56:59], v[184:187]
s_waitcnt lgkmcnt(4)
v_mfma_f32_16x16x32_bf16 v[188:191], a[192:195], a[32:35], v[188:191]
ds_read_b64_tr_b16 a[208:209], v33 offset:24576
ds_read_b64_tr_b16 a[210:211], v33 offset:25088
v_mfma_f32_16x16x32_bf16 v[188:191], a[196:199], a[36:39], v[188:191]
ds_read_b64_tr_b16 a[212:213], v33 offset:28672
ds_read_b64_tr_b16 a[214:215], v33 offset:29184
v_mfma_f32_16x16x32_bf16 v[192:195], a[196:199], a[44:47], v[192:195]
v_mfma_f32_16x16x32_bf16 v[192:195], a[192:195], a[40:43], v[192:195]
v_mfma_f32_16x16x32_bf16 v[196:199], a[192:195], a[48:51], v[196:199]
v_mfma_f32_16x16x32_bf16 v[196:199], a[196:199], a[52:55], v[196:199]
v_mfma_f32_16x16x32_bf16 v[200:203], a[196:199], a[60:63], v[200:203]
v_mfma_f32_16x16x32_bf16 v[200:203], a[192:195], a[56:59], v[200:203]
s_waitcnt lgkmcnt(4)
v_mfma_f32_16x16x32_bf16 v[204:207], a[200:203], a[32:35], v[204:207]
v_mfma_f32_16x16x32_bf16 v[204:207], a[204:207], a[36:39], v[204:207]
v_mfma_f32_16x16x32_bf16 v[208:211], a[204:207], a[44:47], v[208:211]
v_mfma_f32_16x16x32_bf16 v[208:211], a[200:203], a[40:43], v[208:211]
v_mfma_f32_16x16x32_bf16 v[212:215], a[200:203], a[48:51], v[212:215]
s_waitcnt vmcnt(32) lgkmcnt(0)
s_barrier
ds_read_b64_tr_b16 a[192:193], v22 offset:49152
v_mfma_f32_16x16x32_bf16 v[212:215], a[204:207], a[52:55], v[212:215]
s_add_u32 m0, s65, 24576
ds_read_b64_tr_b16 a[194:195], v22 offset:50176
ds_read_b64_tr_b16 a[196:197], v22 offset:57344
v_mfma_f32_16x16x32_bf16 v[216:219], a[204:207], a[60:63], v[216:219]
s_add_u32 s3, s93, 7
s_and_b32 s3, s3, 7
ds_read_b64_tr_b16 a[198:199], v22 offset:58368
v_mfma_f32_16x16x32_bf16 v[216:219], a[200:203], a[56:59], v[216:219]
s_xor_b32 s3, s3, s94
s_lshl_b32 s3, s3, 19
v_mfma_f32_16x16x32_bf16 v[220:223], a[208:211], a[32:35], v[220:223]
ds_read_b64_tr_b16 a[200:201], v23 offset:49152
ds_read_b64_tr_b16 a[202:203], v23 offset:50176
v_mfma_f32_16x16x32_bf16 v[220:223], a[212:215], a[36:39], v[220:223]
ds_read_b64_tr_b16 a[204:205], v23 offset:57344
ds_read_b64_tr_b16 a[206:207], v23 offset:58368
v_mfma_f32_16x16x32_bf16 v[224:227], a[212:215], a[44:47], v[224:227]
buffer_load_dwordx4 v12, s[16:19], s3 offen offset:0 lds
v_mfma_f32_16x16x32_bf16 v[224:227], a[208:211], a[40:43], v[224:227]
buffer_load_dwordx4 v13, s[16:19], s3 offen offset:1024 lds
v_mfma_f32_16x16x32_bf16 v[228:231], a[208:211], a[48:51], v[228:231]
v_mfma_f32_16x16x32_bf16 v[228:231], a[212:215], a[52:55], v[228:231]
buffer_load_dwordx4 v14, s[16:19], s3 offen offset:2048 lds
v_mfma_f32_16x16x32_bf16 v[232:235], a[212:215], a[60:63], v[232:235]
v_mfma_f32_16x16x32_bf16 v[232:235], a[208:211], a[56:59], v[232:235]
s_waitcnt vmcnt(34) lgkmcnt(5)
v_mfma_f32_16x16x32_bf16 a[96:99], a[192:195], a[64:67], a[96:99]
s_waitcnt vmcnt(32) lgkmcnt(4)
ds_read_b64_tr_b16 a[208:209], v24 offset:49152
ds_read_b64_tr_b16 a[210:211], v24 offset:50176
v_mfma_f32_16x16x32_bf16 a[96:99], a[196:199], a[68:71], a[96:99]
s_waitcnt vmcnt(28)
ds_read_b64_tr_b16 a[212:213], v24 offset:57344
ds_read_b64_tr_b16 a[214:215], v24 offset:58368
v_mfma_f32_16x16x32_bf16 a[100:103], a[196:199], a[76:79], a[100:103]
buffer_load_dwordx4 v15, s[16:19], s3 offen offset:3072 lds
v_mfma_f32_16x16x32_bf16 a[100:103], a[192:195], a[72:75], a[100:103]
s_waitcnt vmcnt(27)
v_mfma_f32_16x16x32_bf16 a[104:107], a[192:195], a[80:83], a[104:107]
s_waitcnt vmcnt(25)
v_mfma_f32_16x16x32_bf16 a[104:107], a[196:199], a[84:87], a[104:107]
s_waitcnt vmcnt(23)
s_add_u32 m0, s66, 40960
s_add_u32 s3, s93, 7
s_and_b32 s3, s3, 7
v_mfma_f32_16x16x32_bf16 a[108:111], a[196:199], a[92:95], a[108:111]
s_xor_b32 s3, s3, s94
s_mul_i32 s3, s3, 221184
s_add_u32 s3, s3, s67
v_mfma_f32_16x16x32_bf16 a[108:111], a[192:195], a[88:91], a[108:111]
s_waitcnt lgkmcnt(4)
buffer_load_dwordx4 v20, s[32:35], s3 offen offset:0 lds
v_mfma_f32_16x16x32_bf16 a[112:115], a[200:203], a[64:67], a[112:115]
ds_read_b64_tr_b16 a[192:193], v25 offset:49152
ds_read_b64_tr_b16 a[194:195], v25 offset:50176
v_mfma_f32_16x16x32_bf16 a[112:115], a[204:207], a[68:71], a[112:115]
ds_read_b64_tr_b16 a[196:197], v25 offset:57344
ds_read_b64_tr_b16 a[198:199], v25 offset:58368
v_mfma_f32_16x16x32_bf16 a[116:119], a[204:207], a[76:79], a[116:119]
buffer_load_dwordx4 v21, s[32:35], s3 offen offset:1024 lds
v_mfma_f32_16x16x32_bf16 a[116:119], a[200:203], a[72:75], a[116:119]
v_mfma_f32_16x16x32_bf16 a[120:123], a[200:203], a[80:83], a[120:123]
v_mfma_f32_16x16x32_bf16 a[120:123], a[204:207], a[84:87], a[120:123]
s_add_u32 s63, s93, 7
s_and_b32 s63, s63, 7
s_xor_b32 s63, s63, s94
v_mfma_f32_16x16x32_bf16 a[124:127], a[204:207], a[92:95], a[124:127]
s_lshl_b32 s63, s63, 11
buffer_load_dwordx4 a[32:35], v16, s[4:7], s63 offen offset:0 sc1
v_mfma_f32_16x16x32_bf16 a[124:127], a[200:203], a[88:91], a[124:127]
s_waitcnt lgkmcnt(4)
v_mfma_f32_16x16x32_bf16 a[128:131], a[208:211], a[64:67], a[128:131]
ds_read_b64_tr_b16 a[200:201], v26 offset:49152
ds_read_b64_tr_b16 a[202:203], v26 offset:50176
v_mfma_f32_16x16x32_bf16 a[128:131], a[212:215], a[68:71], a[128:131]
s_add_u32 s62, s61, 4096
ds_read_b64_tr_b16 a[204:205], v26 offset:57344
ds_read_b64_tr_b16 a[206:207], v26 offset:58368
v_mfma_f32_16x16x32_bf16 a[132:135], a[212:215], a[76:79], a[132:135]
buffer_store_dwordx4 v[140:143], v1, s[4:7], s62 offen sc1
v_mfma_f32_16x16x32_bf16 a[132:135], a[208:211], a[72:75], a[132:135]
v_mfma_f32_16x16x32_bf16 a[136:139], a[208:211], a[80:83], a[136:139]
v_mfma_f32_16x16x32_bf16 a[136:139], a[212:215], a[84:87], a[136:139]
buffer_load_dwordx4 a[36:39], v16, s[4:7], s63 offen offset:1024 sc1
v_mfma_f32_16x16x32_bf16 a[140:143], a[212:215], a[92:95], a[140:143]
v_mfma_f32_16x16x32_bf16 a[140:143], a[208:211], a[88:91], a[140:143]
s_waitcnt lgkmcnt(4)
v_mfma_f32_16x16x32_bf16 a[144:147], a[192:195], a[64:67], a[144:147]
ds_read_b64_tr_b16 a[208:209], v27 offset:49152
ds_read_b64_tr_b16 a[210:211], v27 offset:50176
v_mfma_f32_16x16x32_bf16 a[144:147], a[196:199], a[68:71], a[144:147]
s_add_u32 s62, s61, 5120
ds_read_b64_tr_b16 a[212:213], v27 offset:57344
ds_read_b64_tr_b16 a[214:215], v27 offset:58368
v_mfma_f32_16x16x32_bf16 a[148:151], a[196:199], a[76:79], a[148:151]
buffer_store_dwordx4 v[144:147], v1, s[4:7], s62 offen sc1
v_mfma_f32_16x16x32_bf16 a[148:151], a[192:195], a[72:75], a[148:151]
v_mfma_f32_16x16x32_bf16 a[152:155], a[192:195], a[80:83], a[152:155]
v_mfma_f32_16x16x32_bf16 a[152:155], a[196:199], a[84:87], a[152:155]
buffer_load_dwordx4 a[40:43], v17, s[4:7], s63 offen offset:0 sc1
v_mfma_f32_16x16x32_bf16 a[156:159], a[196:199], a[92:95], a[156:159]
v_mfma_f32_16x16x32_bf16 a[156:159], a[192:195], a[88:91], a[156:159]
s_waitcnt lgkmcnt(4)
v_mfma_f32_16x16x32_bf16 a[160:163], a[200:203], a[64:67], a[160:163]
ds_read_b64_tr_b16 a[192:193], v28 offset:49152
ds_read_b64_tr_b16 a[194:195], v28 offset:50176
v_mfma_f32_16x16x32_bf16 a[160:163], a[204:207], a[68:71], a[160:163]
s_add_u32 s62, s61, 20480
ds_read_b64_tr_b16 a[196:197], v28 offset:57344
ds_read_b64_tr_b16 a[198:199], v28 offset:58368
v_mfma_f32_16x16x32_bf16 a[164:167], a[204:207], a[76:79], a[164:167]
buffer_store_dwordx4 v[148:151], v1, s[4:7], s62 offen sc1
v_mfma_f32_16x16x32_bf16 a[164:167], a[200:203], a[72:75], a[164:167]
v_mfma_f32_16x16x32_bf16 a[168:171], a[200:203], a[80:83], a[168:171]
v_mfma_f32_16x16x32_bf16 a[168:171], a[204:207], a[84:87], a[168:171]
buffer_load_dwordx4 a[44:47], v17, s[4:7], s63 offen offset:1024 sc1
v_mfma_f32_16x16x32_bf16 a[172:175], a[204:207], a[92:95], a[172:175]
v_mfma_f32_16x16x32_bf16 a[172:175], a[200:203], a[88:91], a[172:175]
s_waitcnt lgkmcnt(4)
v_mfma_f32_16x16x32_bf16 a[176:179], a[208:211], a[64:67], a[176:179]
ds_read_b64_tr_b16 a[200:201], v29 offset:49152
ds_read_b64_tr_b16 a[202:203], v29 offset:50176
v_mfma_f32_16x16x32_bf16 a[176:179], a[212:215], a[68:71], a[176:179]
s_add_u32 s62, s61, 21504
ds_read_b64_tr_b16 a[204:205], v29 offset:57344
ds_read_b64_tr_b16 a[206:207], v29 offset:58368
v_mfma_f32_16x16x32_bf16 a[180:183], a[212:215], a[76:79], a[180:183]
buffer_store_dwordx4 v[152:155], v1, s[4:7], s62 offen sc1
v_mfma_f32_16x16x32_bf16 a[180:183], a[208:211], a[72:75], a[180:183]
v_mfma_f32_16x16x32_bf16 a[184:187], a[208:211], a[80:83], a[184:187]
v_mfma_f32_16x16x32_bf16 a[184:187], a[212:215], a[84:87], a[184:187]
buffer_load_dwordx4 a[48:51], v18, s[4:7], s63 offen offset:0 sc1
v_mfma_f32_16x16x32_bf16 a[188:191], a[212:215], a[92:95], a[188:191]
v_mfma_f32_16x16x32_bf16 a[188:191], a[208:211], a[88:91], a[188:191]
s_waitcnt lgkmcnt(4)
v_mfma_f32_16x16x32_bf16 a[216:219], a[192:195], a[64:67], a[216:219]
ds_read_b64_tr_b16 a[208:209], v30 offset:49152
ds_read_b64_tr_b16 a[210:211], v30 offset:49664
v_mfma_f32_16x16x32_bf16 a[216:219], a[196:199], a[68:71], a[216:219]
ds_read_b64_tr_b16 a[212:213], v30 offset:53248
ds_read_b64_tr_b16 a[214:215], v30 offset:53760
v_mfma_f32_16x16x32_bf16 a[220:223], a[196:199], a[76:79], a[220:223]
buffer_load_dwordx4 a[52:55], v18, s[4:7], s63 offen offset:1024 sc1
v_mfma_f32_16x16x32_bf16 a[220:223], a[192:195], a[72:75], a[220:223]
v_mfma_f32_16x16x32_bf16 a[224:227], a[192:195], a[80:83], a[224:227]
v_mfma_f32_16x16x32_bf16 a[224:227], a[196:199], a[84:87], a[224:227]
buffer_load_dwordx4 a[56:59], v19, s[4:7], s63 offen offset:0 sc1
v_mfma_f32_16x16x32_bf16 a[228:231], a[196:199], a[92:95], a[228:231]
v_mfma_f32_16x16x32_bf16 a[228:231], a[192:195], a[88:91], a[228:231]
s_waitcnt lgkmcnt(4)
v_mfma_f32_16x16x32_bf16 a[232:235], a[200:203], a[64:67], a[232:235]
ds_read_b64_tr_b16 a[192:193], v31 offset:49152
ds_read_b64_tr_b16 a[194:195], v31 offset:49664
v_mfma_f32_16x16x32_bf16 a[232:235], a[204:207], a[68:71], a[232:235]
ds_read_b64_tr_b16 a[196:197], v31 offset:53248
ds_read_b64_tr_b16 a[198:199], v31 offset:53760
v_mfma_f32_16x16x32_bf16 a[236:239], a[204:207], a[76:79], a[236:239]
buffer_load_dwordx4 a[60:63], v19, s[4:7], s63 offen offset:1024 sc1
v_mfma_f32_16x16x32_bf16 a[236:239], a[200:203], a[72:75], a[236:239]
v_mfma_f32_16x16x32_bf16 a[240:243], a[200:203], a[80:83], a[240:243]
v_mfma_f32_16x16x32_bf16 a[240:243], a[204:207], a[84:87], a[240:243]
v_mfma_f32_16x16x32_bf16 a[244:247], a[204:207], a[92:95], a[244:247]
v_mfma_f32_16x16x32_bf16 a[244:247], a[200:203], a[88:91], a[244:247]
s_waitcnt lgkmcnt(4)
v_mfma_f32_16x16x32_bf16 v[172:175], a[208:211], a[64:67], v[172:175]
ds_read_b64_tr_b16 a[200:201], v32 offset:49152
ds_read_b64_tr_b16 a[202:203], v32 offset:49664
v_mfma_f32_16x16x32_bf16 v[172:175], a[212:215], a[68:71], v[172:175]
ds_read_b64_tr_b16 a[204:205], v32 offset:53248
ds_read_b64_tr_b16 a[206:207], v32 offset:53760
v_mfma_f32_16x16x32_bf16 v[176:179], a[212:215], a[76:79], v[176:179]
v_mfma_f32_16x16x32_bf16 v[176:179], a[208:211], a[72:75], v[176:179]
v_mfma_f32_16x16x32_bf16 v[180:183], a[208:211], a[80:83], v[180:183]
v_mfma_f32_16x16x32_bf16 v[180:183], a[212:215], a[84:87], v[180:183]
v_mfma_f32_16x16x32_bf16 v[184:187], a[212:215], a[92:95], v[184:187]
v_mfma_f32_16x16x32_bf16 v[184:187], a[208:211], a[88:91], v[184:187]
s_waitcnt lgkmcnt(4)
v_mfma_f32_16x16x32_bf16 v[188:191], a[192:195], a[64:67], v[188:191]
ds_read_b64_tr_b16 a[208:209], v33 offset:49152
ds_read_b64_tr_b16 a[210:211], v33 offset:49664
v_mfma_f32_16x16x32_bf16 v[188:191], a[196:199], a[68:71], v[188:191]
ds_read_b64_tr_b16 a[212:213], v33 offset:53248
ds_read_b64_tr_b16 a[214:215], v33 offset:53760
v_mfma_f32_16x16x32_bf16 v[192:195], a[196:199], a[76:79], v[192:195]
v_mfma_f32_16x16x32_bf16 v[192:195], a[192:195], a[72:75], v[192:195]
v_mfma_f32_16x16x32_bf16 v[196:199], a[192:195], a[80:83], v[196:199]
v_mfma_f32_16x16x32_bf16 v[196:199], a[196:199], a[84:87], v[196:199]
v_mfma_f32_16x16x32_bf16 v[200:203], a[196:199], a[92:95], v[200:203]
v_mfma_f32_16x16x32_bf16 v[200:203], a[192:195], a[88:91], v[200:203]
s_waitcnt lgkmcnt(4)
v_mfma_f32_16x16x32_bf16 v[204:207], a[200:203], a[64:67], v[204:207]
v_mfma_f32_16x16x32_bf16 v[204:207], a[204:207], a[68:71], v[204:207]
v_mfma_f32_16x16x32_bf16 v[208:211], a[204:207], a[76:79], v[208:211]
v_mfma_f32_16x16x32_bf16 v[208:211], a[200:203], a[72:75], v[208:211]
v_mfma_f32_16x16x32_bf16 v[212:215], a[200:203], a[80:83], v[212:215]
s_waitcnt vmcnt(31) lgkmcnt(0)
s_barrier
ds_read_b64_tr_b16 a[192:193], v22 offset:0
v_mfma_f32_16x16x32_bf16 v[212:215], a[204:207], a[84:87], v[212:215]
s_add_u32 m0, s65, 49152
ds_read_b64_tr_b16 a[194:195], v22 offset:1024
ds_read_b64_tr_b16 a[196:197], v22 offset:8192
v_mfma_f32_16x16x32_bf16 v[216:219], a[204:207], a[92:95], v[216:219]
s_and_b32 s3, s94, 1
s_xor_b32 s3, s3, 8
ds_read_b64_tr_b16 a[198:199], v22 offset:9216
v_mfma_f32_16x16x32_bf16 v[216:219], a[200:203], a[88:91], v[216:219]
s_lshl_b32 s3, s3, 19
buffer_load_dwordx4 v12, s[16:19], s3 offen offset:0 lds
v_mfma_f32_16x16x32_bf16 v[220:223], a[208:211], a[64:67], v[220:223]
ds_read_b64_tr_b16 a[200:201], v23 offset:0
ds_read_b64_tr_b16 a[202:203], v23 offset:1024
v_mfma_f32_16x16x32_bf16 v[220:223], a[212:215], a[68:71], v[220:223]
ds_read_b64_tr_b16 a[204:205], v23 offset:8192
ds_read_b64_tr_b16 a[206:207], v23 offset:9216
v_mfma_f32_16x16x32_bf16 v[224:227], a[212:215], a[76:79], v[224:227]
buffer_load_dwordx4 v13, s[16:19], s3 offen offset:1024 lds
v_mfma_f32_16x16x32_bf16 v[224:227], a[208:211], a[72:75], v[224:227]
v_mfma_f32_16x16x32_bf16 v[228:231], a[208:211], a[80:83], v[228:231]
v_mfma_f32_16x16x32_bf16 v[228:231], a[212:215], a[84:87], v[228:231]
buffer_load_dwordx4 v14, s[16:19], s3 offen offset:2048 lds
v_mfma_f32_16x16x32_bf16 v[232:235], a[212:215], a[92:95], v[232:235]
v_mfma_f32_16x16x32_bf16 v[232:235], a[208:211], a[88:91], v[232:235]
s_waitcnt vmcnt(33) lgkmcnt(5)
v_mfma_f32_16x16x32_bf16 a[96:99], a[192:195], a[0:3], a[96:99]
s_waitcnt vmcnt(31) lgkmcnt(4)
ds_read_b64_tr_b16 a[208:209], v24 offset:0
ds_read_b64_tr_b16 a[210:211], v24 offset:1024
v_mfma_f32_16x16x32_bf16 a[96:99], a[196:199], a[4:7], a[96:99]
s_waitcnt vmcnt(27)
ds_read_b64_tr_b16 a[212:213], v24 offset:8192
ds_read_b64_tr_b16 a[214:215], v24 offset:9216
v_mfma_f32_16x16x32_bf16 a[100:103], a[196:199], a[12:15], a[100:103]
buffer_load_dwordx4 v15, s[16:19], s3 offen offset:3072 lds
v_mfma_f32_16x16x32_bf16 a[100:103], a[192:195], a[8:11], a[100:103]
s_waitcnt vmcnt(26)
v_mfma_f32_16x16x32_bf16 a[104:107], a[192:195], a[16:19], a[104:107]
s_waitcnt vmcnt(24)
v_mfma_f32_16x16x32_bf16 a[104:107], a[196:199], a[20:23], a[104:107]
s_waitcnt vmcnt(22)
s_add_u32 m0, s66, 65536
s_and_b32 s3, s94, 1
s_xor_b32 s3, s3, 8
v_mfma_f32_16x16x32_bf16 a[108:111], a[196:199], a[28:31], a[108:111]
s_mul_i32 s3, s3, 221184
s_add_u32 s3, s3, s67
v_mfma_f32_16x16x32_bf16 a[108:111], a[192:195], a[24:27], a[108:111]
s_waitcnt lgkmcnt(4)
buffer_load_dwordx4 v20, s[32:35], s3 offen offset:0 lds
v_mfma_f32_16x16x32_bf16 a[112:115], a[200:203], a[0:3], a[112:115]
ds_read_b64_tr_b16 a[192:193], v25 offset:0
ds_read_b64_tr_b16 a[194:195], v25 offset:1024
v_mfma_f32_16x16x32_bf16 a[112:115], a[204:207], a[4:7], a[112:115]
ds_read_b64_tr_b16 a[196:197], v25 offset:8192
ds_read_b64_tr_b16 a[198:199], v25 offset:9216
v_mfma_f32_16x16x32_bf16 a[116:119], a[204:207], a[12:15], a[116:119]
buffer_load_dwordx4 v21, s[32:35], s3 offen offset:1024 lds
v_mfma_f32_16x16x32_bf16 a[116:119], a[200:203], a[8:11], a[116:119]
v_mfma_f32_16x16x32_bf16 a[120:123], a[200:203], a[16:19], a[120:123]
v_mfma_f32_16x16x32_bf16 a[120:123], a[204:207], a[20:23], a[120:123]
s_and_b32 s63, s94, 1
s_xor_b32 s63, s63, 8
s_lshl_b32 s63, s63, 11
v_mfma_f32_16x16x32_bf16 a[124:127], a[204:207], a[28:31], a[124:127]
buffer_load_dwordx4 a[64:67], v16, s[4:7], s63 offen offset:0 sc1
v_mfma_f32_16x16x32_bf16 a[124:127], a[200:203], a[24:27], a[124:127]
s_waitcnt lgkmcnt(4)
v_mfma_f32_16x16x32_bf16 a[128:131], a[208:211], a[0:3], a[128:131]
ds_read_b64_tr_b16 a[200:201], v26 offset:0
ds_read_b64_tr_b16 a[202:203], v26 offset:1024
v_mfma_f32_16x16x32_bf16 a[128:131], a[212:215], a[4:7], a[128:131]
s_add_u32 s62, s61, 6144
ds_read_b64_tr_b16 a[204:205], v26 offset:8192
ds_read_b64_tr_b16 a[206:207], v26 offset:9216
v_mfma_f32_16x16x32_bf16 a[132:135], a[212:215], a[12:15], a[132:135]
buffer_store_dwordx4 v[156:159], v1, s[4:7], s62 offen sc1
v_mfma_f32_16x16x32_bf16 a[132:135], a[208:211], a[8:11], a[132:135]
v_mfma_f32_16x16x32_bf16 a[136:139], a[208:211], a[16:19], a[136:139]
v_mfma_f32_16x16x32_bf16 a[136:139], a[212:215], a[20:23], a[136:139]
buffer_load_dwordx4 a[68:71], v16, s[4:7], s63 offen offset:1024 sc1
v_mfma_f32_16x16x32_bf16 a[140:143], a[212:215], a[28:31], a[140:143]
v_mfma_f32_16x16x32_bf16 a[140:143], a[208:211], a[24:27], a[140:143]
s_waitcnt lgkmcnt(4)
v_mfma_f32_16x16x32_bf16 a[144:147], a[192:195], a[0:3], a[144:147]
ds_read_b64_tr_b16 a[208:209], v27 offset:0
ds_read_b64_tr_b16 a[210:211], v27 offset:1024
v_mfma_f32_16x16x32_bf16 a[144:147], a[196:199], a[4:7], a[144:147]
s_add_u32 s62, s61, 7168
ds_read_b64_tr_b16 a[212:213], v27 offset:8192
ds_read_b64_tr_b16 a[214:215], v27 offset:9216
v_mfma_f32_16x16x32_bf16 a[148:151], a[196:199], a[12:15], a[148:151]
buffer_store_dwordx4 v[160:163], v1, s[4:7], s62 offen sc1
v_mfma_f32_16x16x32_bf16 a[148:151], a[192:195], a[8:11], a[148:151]
v_mfma_f32_16x16x32_bf16 a[152:155], a[192:195], a[16:19], a[152:155]
v_mfma_f32_16x16x32_bf16 a[152:155], a[196:199], a[20:23], a[152:155]
buffer_load_dwordx4 a[72:75], v17, s[4:7], s63 offen offset:0 sc1
v_mfma_f32_16x16x32_bf16 a[156:159], a[196:199], a[28:31], a[156:159]
v_mfma_f32_16x16x32_bf16 a[156:159], a[192:195], a[24:27], a[156:159]
s_waitcnt lgkmcnt(4)
v_mfma_f32_16x16x32_bf16 a[160:163], a[200:203], a[0:3], a[160:163]
ds_read_b64_tr_b16 a[192:193], v28 offset:0
ds_read_b64_tr_b16 a[194:195], v28 offset:1024
v_mfma_f32_16x16x32_bf16 a[160:163], a[204:207], a[4:7], a[160:163]
s_add_u32 s62, s61, 22528
ds_read_b64_tr_b16 a[196:197], v28 offset:8192
ds_read_b64_tr_b16 a[198:199], v28 offset:9216
v_mfma_f32_16x16x32_bf16 a[164:167], a[204:207], a[12:15], a[164:167]
buffer_store_dwordx4 v[164:167], v1, s[4:7], s62 offen sc1
v_mfma_f32_16x16x32_bf16 a[164:167], a[200:203], a[8:11], a[164:167]
v_mfma_f32_16x16x32_bf16 a[168:171], a[200:203], a[16:19], a[168:171]
v_mfma_f32_16x16x32_bf16 a[168:171], a[204:207], a[20:23], a[168:171]
buffer_load_dwordx4 a[76:79], v17, s[4:7], s63 offen offset:1024 sc1
v_mfma_f32_16x16x32_bf16 a[172:175], a[204:207], a[28:31], a[172:175]
v_mfma_f32_16x16x32_bf16 a[172:175], a[200:203], a[24:27], a[172:175]
s_waitcnt lgkmcnt(4)
v_mfma_f32_16x16x32_bf16 a[176:179], a[208:211], a[0:3], a[176:179]
ds_read_b64_tr_b16 a[200:201], v29 offset:0
ds_read_b64_tr_b16 a[202:203], v29 offset:1024
v_mfma_f32_16x16x32_bf16 a[176:179], a[212:215], a[4:7], a[176:179]
s_add_u32 s62, s61, 23552
ds_read_b64_tr_b16 a[204:205], v29 offset:8192
ds_read_b64_tr_b16 a[206:207], v29 offset:9216
v_mfma_f32_16x16x32_bf16 a[180:183], a[212:215], a[12:15], a[180:183]
buffer_store_dwordx4 v[168:171], v1, s[4:7], s62 offen sc1
v_mfma_f32_16x16x32_bf16 a[180:183], a[208:211], a[8:11], a[180:183]
v_mfma_f32_16x16x32_bf16 a[184:187], a[208:211], a[16:19], a[184:187]
v_mfma_f32_16x16x32_bf16 a[184:187], a[212:215], a[20:23], a[184:187]
buffer_load_dwordx4 a[80:83], v18, s[4:7], s63 offen offset:0 sc1
v_mfma_f32_16x16x32_bf16 a[188:191], a[212:215], a[28:31], a[188:191]
v_mfma_f32_16x16x32_bf16 a[188:191], a[208:211], a[24:27], a[188:191]
s_waitcnt lgkmcnt(4)
v_mfma_f32_16x16x32_bf16 a[216:219], a[192:195], a[0:3], a[216:219]
ds_read_b64_tr_b16 a[208:209], v30 offset:0
ds_read_b64_tr_b16 a[210:211], v30 offset:512
v_mfma_f32_16x16x32_bf16 a[216:219], a[196:199], a[4:7], a[216:219]
ds_read_b64_tr_b16 a[212:213], v30 offset:4096
ds_read_b64_tr_b16 a[214:215], v30 offset:4608
v_mfma_f32_16x16x32_bf16 a[220:223], a[196:199], a[12:15], a[220:223]
buffer_load_dwordx4 a[84:87], v18, s[4:7], s63 offen offset:1024 sc1
v_mfma_f32_16x16x32_bf16 a[220:223], a[192:195], a[8:11], a[220:223]
v_mfma_f32_16x16x32_bf16 a[224:227], a[192:195], a[16:19], a[224:227]
v_mfma_f32_16x16x32_bf16 a[224:227], a[196:199], a[20:23], a[224:227]
buffer_load_dwordx4 a[88:91], v19, s[4:7], s63 offen offset:0 sc1
v_mfma_f32_16x16x32_bf16 a[228:231], a[196:199], a[28:31], a[228:231]
v_mfma_f32_16x16x32_bf16 a[228:231], a[192:195], a[24:27], a[228:231]
s_waitcnt lgkmcnt(4)
v_mfma_f32_16x16x32_bf16 a[232:235], a[200:203], a[0:3], a[232:235]
ds_read_b64_tr_b16 a[192:193], v31 offset:0
ds_read_b64_tr_b16 a[194:195], v31 offset:512
v_mfma_f32_16x16x32_bf16 a[232:235], a[204:207], a[4:7], a[232:235]
ds_read_b64_tr_b16 a[196:197], v31 offset:4096
ds_read_b64_tr_b16 a[198:199], v31 offset:4608
v_mfma_f32_16x16x32_bf16 a[236:239], a[204:207], a[12:15], a[236:239]
buffer_load_dwordx4 a[92:95], v19, s[4:7], s63 offen offset:1024 sc1
v_mfma_f32_16x16x32_bf16 a[236:239], a[200:203], a[8:11], a[236:239]
v_mfma_f32_16x16x32_bf16 a[240:243], a[200:203], a[16:19], a[240:243]
v_mfma_f32_16x16x32_bf16 a[240:243], a[204:207], a[20:23], a[240:243]
v_mfma_f32_16x16x32_bf16 a[244:247], a[204:207], a[28:31], a[244:247]
v_mfma_f32_16x16x32_bf16 a[244:247], a[200:203], a[24:27], a[244:247]
s_waitcnt lgkmcnt(4)
v_mfma_f32_16x16x32_bf16 v[172:175], a[208:211], a[0:3], v[172:175]
ds_read_b64_tr_b16 a[200:201], v32 offset:0
ds_read_b64_tr_b16 a[202:203], v32 offset:512
v_mfma_f32_16x16x32_bf16 v[172:175], a[212:215], a[4:7], v[172:175]
ds_read_b64_tr_b16 a[204:205], v32 offset:4096
ds_read_b64_tr_b16 a[206:207], v32 offset:4608
v_mfma_f32_16x16x32_bf16 v[176:179], a[212:215], a[12:15], v[176:179]
v_mfma_f32_16x16x32_bf16 v[176:179], a[208:211], a[8:11], v[176:179]
v_mfma_f32_16x16x32_bf16 v[180:183], a[208:211], a[16:19], v[180:183]
v_mfma_f32_16x16x32_bf16 v[180:183], a[212:215], a[20:23], v[180:183]
v_mfma_f32_16x16x32_bf16 v[184:187], a[212:215], a[28:31], v[184:187]
v_mfma_f32_16x16x32_bf16 v[184:187], a[208:211], a[24:27], v[184:187]
s_waitcnt lgkmcnt(4)
v_mfma_f32_16x16x32_bf16 v[188:191], a[192:195], a[0:3], v[188:191]
ds_read_b64_tr_b16 a[208:209], v33 offset:0
ds_read_b64_tr_b16 a[210:211], v33 offset:512
v_mfma_f32_16x16x32_bf16 v[188:191], a[196:199], a[4:7], v[188:191]
ds_read_b64_tr_b16 a[212:213], v33 offset:4096
ds_read_b64_tr_b16 a[214:215], v33 offset:4608
v_mfma_f32_16x16x32_bf16 v[192:195], a[196:199], a[12:15], v[192:195]
v_mfma_f32_16x16x32_bf16 v[192:195], a[192:195], a[8:11], v[192:195]
v_mfma_f32_16x16x32_bf16 v[196:199], a[192:195], a[16:19], v[196:199]
v_mfma_f32_16x16x32_bf16 v[196:199], a[196:199], a[20:23], v[196:199]
v_mfma_f32_16x16x32_bf16 v[200:203], a[196:199], a[28:31], v[200:203]
v_mfma_f32_16x16x32_bf16 v[200:203], a[192:195], a[24:27], v[200:203]
s_waitcnt lgkmcnt(4)
v_mfma_f32_16x16x32_bf16 v[204:207], a[200:203], a[0:3], v[204:207]
v_mfma_f32_16x16x32_bf16 v[204:207], a[204:207], a[4:7], v[204:207]
v_mfma_f32_16x16x32_bf16 v[208:211], a[204:207], a[12:15], v[208:211]
v_mfma_f32_16x16x32_bf16 v[208:211], a[200:203], a[8:11], v[208:211]
v_mfma_f32_16x16x32_bf16 v[212:215], a[200:203], a[16:19], v[212:215]
s_waitcnt vmcnt(30) lgkmcnt(0)
s_barrier
ds_read_b64_tr_b16 a[192:193], v22 offset:24576
v_mfma_f32_16x16x32_bf16 v[212:215], a[204:207], a[20:23], v[212:215]
s_add_u32 m0, s65, 0
ds_read_b64_tr_b16 a[194:195], v22 offset:25600
ds_read_b64_tr_b16 a[196:197], v22 offset:32768
v_mfma_f32_16x16x32_bf16 v[216:219], a[204:207], a[28:31], v[216:219]
s_and_b32 s3, s94, 1
s_xor_b32 s3, s3, 9
ds_read_b64_tr_b16 a[198:199], v22 offset:33792
v_mfma_f32_16x16x32_bf16 v[216:219], a[200:203], a[24:27], v[216:219]
s_lshl_b32 s3, s3, 19
buffer_load_dwordx4 v12, s[16:19], s3 offen offset:0 lds
v_mfma_f32_16x16x32_bf16 v[220:223], a[208:211], a[0:3], v[220:223]
ds_read_b64_tr_b16 a[200:201], v23 offset:24576
ds_read_b64_tr_b16 a[202:203], v23 offset:25600
v_mfma_f32_16x16x32_bf16 v[220:223], a[212:215], a[4:7], v[220:223]
ds_read_b64_tr_b16 a[204:205], v23 offset:32768
ds_read_b64_tr_b16 a[206:207], v23 offset:33792
v_mfma_f32_16x16x32_bf16 v[224:227], a[212:215], a[12:15], v[224:227]
buffer_load_dwordx4 v13, s[16:19], s3 offen offset:1024 lds
v_mfma_f32_16x16x32_bf16 v[224:227], a[208:211], a[8:11], v[224:227]
v_mfma_f32_16x16x32_bf16 v[228:231], a[208:211], a[16:19], v[228:231]
v_mfma_f32_16x16x32_bf16 v[228:231], a[212:215], a[20:23], v[228:231]
buffer_load_dwordx4 v14, s[16:19], s3 offen offset:2048 lds
v_mfma_f32_16x16x32_bf16 v[232:235], a[212:215], a[28:31], v[232:235]
v_mfma_f32_16x16x32_bf16 v[232:235], a[208:211], a[24:27], v[232:235]
s_waitcnt vmcnt(32) lgkmcnt(5)
v_mfma_f32_16x16x32_bf16 a[96:99], a[192:195], a[32:35], a[96:99]
s_waitcnt vmcnt(30) lgkmcnt(4)
ds_read_b64_tr_b16 a[208:209], v24 offset:24576
ds_read_b64_tr_b16 a[210:211], v24 offset:25600
v_mfma_f32_16x16x32_bf16 a[96:99], a[196:199], a[36:39], a[96:99]
s_waitcnt vmcnt(26)
ds_read_b64_tr_b16 a[212:213], v24 offset:32768
ds_read_b64_tr_b16 a[214:215], v24 offset:33792
v_mfma_f32_16x16x32_bf16 a[100:103], a[196:199], a[44:47], a[100:103]
buffer_load_dwordx4 v15, s[16:19], s3 offen offset:3072 lds
v_mfma_f32_16x16x32_bf16 a[100:103], a[192:195], a[40:43], a[100:103]
s_waitcnt vmcnt(25)
v_mfma_f32_16x16x32_bf16 a[104:107], a[192:195], a[48:51], a[104:107]
s_waitcnt vmcnt(24)
v_mfma_f32_16x16x32_bf16 a[104:107], a[196:199], a[52:55], a[104:107]
s_waitcnt vmcnt(22)
s_add_u32 m0, s66, 16384
s_and_b32 s3, s94, 1
s_xor_b32 s3, s3, 9
v_mfma_f32_16x16x32_bf16 a[108:111], a[196:199], a[60:63], a[108:111]
s_mul_i32 s3, s3, 221184
s_add_u32 s3, s3, s67
v_mfma_f32_16x16x32_bf16 a[108:111], a[192:195], a[56:59], a[108:111]
s_waitcnt lgkmcnt(4)
buffer_load_dwordx4 v20, s[32:35], s3 offen offset:0 lds
v_mfma_f32_16x16x32_bf16 a[112:115], a[200:203], a[32:35], a[112:115]
ds_read_b64_tr_b16 a[192:193], v25 offset:24576
ds_read_b64_tr_b16 a[194:195], v25 offset:25600
v_mfma_f32_16x16x32_bf16 a[112:115], a[204:207], a[36:39], a[112:115]
ds_read_b64_tr_b16 a[196:197], v25 offset:32768
ds_read_b64_tr_b16 a[198:199], v25 offset:33792
v_mfma_f32_16x16x32_bf16 a[116:119], a[204:207], a[44:47], a[116:119]
buffer_load_dwordx4 v21, s[32:35], s3 offen offset:1024 lds
v_mfma_f32_16x16x32_bf16 a[116:119], a[200:203], a[40:43], a[116:119]
v_accvgpr_read_b32 v44, a96
v_accvgpr_read_b32 v45, a97
v_mfma_f32_16x16x32_bf16 a[120:123], a[200:203], a[48:51], a[120:123]
v_accvgpr_read_b32 v46, a98
v_accvgpr_read_b32 v47, a99
v_mfma_f32_16x16x32_bf16 a[120:123], a[204:207], a[52:55], a[120:123]
s_and_b32 s63, s94, 1
s_xor_b32 s63, s63, 9
s_lshl_b32 s63, s63, 11
v_mfma_f32_16x16x32_bf16 a[124:127], a[204:207], a[60:63], a[124:127]
buffer_load_dwordx4 a[0:3], v16, s[4:7], s63 offen offset:0 sc1
v_mfma_f32_16x16x32_bf16 a[124:127], a[200:203], a[56:59], a[124:127]
s_waitcnt lgkmcnt(4)
v_accvgpr_read_b32 v48, a100
v_accvgpr_read_b32 v49, a101
v_mfma_f32_16x16x32_bf16 a[128:131], a[208:211], a[32:35], a[128:131]
ds_read_b64_tr_b16 a[200:201], v26 offset:24576
ds_read_b64_tr_b16 a[202:203], v26 offset:25600
v_mfma_f32_16x16x32_bf16 a[128:131], a[212:215], a[36:39], a[128:131]
ds_read_b64_tr_b16 a[204:205], v26 offset:32768
ds_read_b64_tr_b16 a[206:207], v26 offset:33792
v_mfma_f32_16x16x32_bf16 a[132:135], a[212:215], a[44:47], a[132:135]
buffer_load_dwordx4 a[4:7], v16, s[4:7], s63 offen offset:1024 sc1
v_mfma_f32_16x16x32_bf16 a[132:135], a[208:211], a[40:43], a[132:135]
v_accvgpr_read_b32 v50, a102
v_accvgpr_read_b32 v51, a103
v_mfma_f32_16x16x32_bf16 a[136:139], a[208:211], a[48:51], a[136:139]
v_accvgpr_read_b32 v52, a104
v_accvgpr_read_b32 v53, a105
v_mfma_f32_16x16x32_bf16 a[136:139], a[212:215], a[52:55], a[136:139]
buffer_load_dwordx4 a[8:11], v17, s[4:7], s63 offen offset:0 sc1
v_mfma_f32_16x16x32_bf16 a[140:143], a[212:215], a[60:63], a[140:143]
v_accvgpr_read_b32 v54, a106
v_accvgpr_read_b32 v55, a107
v_mfma_f32_16x16x32_bf16 a[140:143], a[208:211], a[56:59], a[140:143]
s_waitcnt lgkmcnt(4)
v_accvgpr_read_b32 v56, a108
v_accvgpr_read_b32 v57, a109
v_mfma_f32_16x16x32_bf16 a[144:147], a[192:195], a[32:35], a[144:147]
ds_read_b64_tr_b16 a[208:209], v27 offset:24576
ds_read_b64_tr_b16 a[210:211], v27 offset:25600
v_mfma_f32_16x16x32_bf16 a[144:147], a[196:199], a[36:39], a[144:147]
ds_read_b64_tr_b16 a[212:213], v27 offset:32768
ds_read_b64_tr_b16 a[214:215], v27 offset:33792
v_mfma_f32_16x16x32_bf16 a[148:151], a[196:199], a[44:47], a[148:151]
buffer_load_dwordx4 a[12:15], v17, s[4:7], s63 offen offset:1024 sc1
v_mfma_f32_16x16x32_bf16 a[148:151], a[192:195], a[40:43], a[148:151]
v_accvgpr_read_b32 v58, a110
v_accvgpr_read_b32 v59, a111
v_mfma_f32_16x16x32_bf16 a[152:155], a[192:195], a[48:51], a[152:155]
v_accvgpr_read_b32 v60, a112
v_accvgpr_read_b32 v61, a113
v_mfma_f32_16x16x32_bf16 a[152:155], a[196:199], a[52:55], a[152:155]
buffer_load_dwordx4 a[16:19], v18, s[4:7], s63 offen offset:0 sc1
v_mfma_f32_16x16x32_bf16 a[156:159], a[196:199], a[60:63], a[156:159]
v_accvgpr_read_b32 v62, a114
v_accvgpr_read_b32 v63, a115
v_mfma_f32_16x16x32_bf16 a[156:159], a[192:195], a[56:59], a[156:159]
s_waitcnt lgkmcnt(4)
v_accvgpr_read_b32 v64, a116
v_accvgpr_read_b32 v65, a117
v_mfma_f32_16x16x32_bf16 a[160:163], a[200:203], a[32:35], a[160:163]
ds_read_b64_tr_b16 a[192:193], v28 offset:24576
ds_read_b64_tr_b16 a[194:195], v28 offset:25600
v_mfma_f32_16x16x32_bf16 a[160:163], a[204:207], a[36:39], a[160:163]
ds_read_b64_tr_b16 a[196:197], v28 offset:32768
ds_read_b64_tr_b16 a[198:199], v28 offset:33792
v_mfma_f32_16x16x32_bf16 a[164:167], a[204:207], a[44:47], a[164:167]
buffer_load_dwordx4 a[20:23], v18, s[4:7], s63 offen offset:1024 sc1
v_mfma_f32_16x16x32_bf16 a[164:167], a[200:203], a[40:43], a[164:167]
v_accvgpr_read_b32 v66, a118
v_accvgpr_read_b32 v67, a119
v_mfma_f32_16x16x32_bf16 a[168:171], a[200:203], a[48:51], a[168:171]
v_accvgpr_read_b32 v68, a120
v_accvgpr_read_b32 v69, a121
v_mfma_f32_16x16x32_bf16 a[168:171], a[204:207], a[52:55], a[168:171]
buffer_load_dwordx4 a[24:27], v19, s[4:7], s63 offen offset:0 sc1
v_mfma_f32_16x16x32_bf16 a[172:175], a[204:207], a[60:63], a[172:175]
v_accvgpr_read_b32 v70, a122
v_accvgpr_read_b32 v71, a123
v_mfma_f32_16x16x32_bf16 a[172:175], a[200:203], a[56:59], a[172:175]
s_waitcnt lgkmcnt(4)
v_accvgpr_read_b32 v72, a124
v_accvgpr_read_b32 v73, a125
v_mfma_f32_16x16x32_bf16 a[176:179], a[208:211], a[32:35], a[176:179]
ds_read_b64_tr_b16 a[200:201], v29 offset:24576
ds_read_b64_tr_b16 a[202:203], v29 offset:25600
v_mfma_f32_16x16x32_bf16 a[176:179], a[212:215], a[36:39], a[176:179]
ds_read_b64_tr_b16 a[204:205], v29 offset:32768
ds_read_b64_tr_b16 a[206:207], v29 offset:33792
v_mfma_f32_16x16x32_bf16 a[180:183], a[212:215], a[44:47], a[180:183]
buffer_load_dwordx4 a[28:31], v19, s[4:7], s63 offen offset:1024 sc1
v_mfma_f32_16x16x32_bf16 a[180:183], a[208:211], a[40:43], a[180:183]
v_accvgpr_read_b32 v74, a126
v_accvgpr_read_b32 v75, a127
v_mfma_f32_16x16x32_bf16 a[184:187], a[208:211], a[48:51], a[184:187]
v_accvgpr_read_b32 v76, a128
v_accvgpr_read_b32 v77, a129
v_mfma_f32_16x16x32_bf16 a[184:187], a[212:215], a[52:55], a[184:187]
v_accvgpr_read_b32 v78, a130
v_accvgpr_read_b32 v79, a131
v_mfma_f32_16x16x32_bf16 a[188:191], a[212:215], a[60:63], a[188:191]
v_accvgpr_read_b32 v80, a132
v_accvgpr_read_b32 v81, a133
v_mfma_f32_16x16x32_bf16 a[188:191], a[208:211], a[56:59], a[188:191]
s_waitcnt lgkmcnt(4)
v_accvgpr_read_b32 v82, a134
v_accvgpr_read_b32 v83, a135
v_mfma_f32_16x16x32_bf16 a[216:219], a[192:195], a[32:35], a[216:219]
ds_read_b64_tr_b16 a[208:209], v30 offset:24576
ds_read_b64_tr_b16 a[210:211], v30 offset:25088
v_mfma_f32_16x16x32_bf16 a[216:219], a[196:199], a[36:39], a[216:219]
ds_read_b64_tr_b16 a[212:213], v30 offset:28672
ds_read_b64_tr_b16 a[214:215], v30 offset:29184
v_mfma_f32_16x16x32_bf16 a[220:223], a[196:199], a[44:47], a[220:223]
v_accvgpr_read_b32 v84, a136
v_accvgpr_read_b32 v85, a137
v_mfma_f32_16x16x32_bf16 a[220:223], a[192:195], a[40:43], a[220:223]
v_accvgpr_read_b32 v86, a138
v_accvgpr_read_b32 v87, a139
v_mfma_f32_16x16x32_bf16 a[224:227], a[192:195], a[48:51], a[224:227]
v_accvgpr_read_b32 v88, a140
v_accvgpr_read_b32 v89, a141
v_mfma_f32_16x16x32_bf16 a[224:227], a[196:199], a[52:55], a[224:227]
v_accvgpr_read_b32 v90, a142
v_accvgpr_read_b32 v91, a143
v_mfma_f32_16x16x32_bf16 a[228:231], a[196:199], a[60:63], a[228:231]
v_accvgpr_read_b32 v92, a144
v_accvgpr_read_b32 v93, a145
v_mfma_f32_16x16x32_bf16 a[228:231], a[192:195], a[56:59], a[228:231]
s_waitcnt lgkmcnt(4)
v_accvgpr_read_b32 v94, a146
v_accvgpr_read_b32 v95, a147
v_mfma_f32_16x16x32_bf16 a[232:235], a[200:203], a[32:35], a[232:235]
ds_read_b64_tr_b16 a[192:193], v31 offset:24576
ds_read_b64_tr_b16 a[194:195], v31 offset:25088
v_mfma_f32_16x16x32_bf16 a[232:235], a[204:207], a[36:39], a[232:235]
ds_read_b64_tr_b16 a[196:197], v31 offset:28672
ds_read_b64_tr_b16 a[198:199], v31 offset:29184
v_mfma_f32_16x16x32_bf16 a[236:239], a[204:207], a[44:47], a[236:239]
v_accvgpr_read_b32 v96, a148
v_accvgpr_read_b32 v97, a149
v_mfma_f32_16x16x32_bf16 a[236:239], a[200:203], a[40:43], a[236:239]
v_accvgpr_read_b32 v98, a150
v_accvgpr_read_b32 v99, a151
v_mfma_f32_16x16x32_bf16 a[240:243], a[200:203], a[48:51], a[240:243]
v_accvgpr_read_b32 v100, a152
v_accvgpr_read_b32 v101, a153
v_mfma_f32_16x16x32_bf16 a[240:243], a[204:207], a[52:55], a[240:243]
v_accvgpr_read_b32 v102, a154
v_accvgpr_read_b32 v103, a155
v_mfma_f32_16x16x32_bf16 a[244:247], a[204:207], a[60:63], a[244:247]
v_accvgpr_read_b32 v104, a156
v_accvgpr_read_b32 v105, a157
v_mfma_f32_16x16x32_bf16 a[244:247], a[200:203], a[56:59], a[244:247]
s_waitcnt lgkmcnt(4)
v_accvgpr_read_b32 v106, a158
v_accvgpr_read_b32 v107, a159
v_mfma_f32_16x16x32_bf16 v[172:175], a[208:211], a[32:35], v[172:175]
ds_read_b64_tr_b16 a[200:201], v32 offset:24576
ds_read_b64_tr_b16 a[202:203], v32 offset:25088
v_mfma_f32_16x16x32_bf16 v[172:175], a[212:215], a[36:39], v[172:175]
ds_read_b64_tr_b16 a[204:205], v32 offset:28672
ds_read_b64_tr_b16 a[206:207], v32 offset:29184
v_mfma_f32_16x16x32_bf16 v[176:179], a[212:215], a[44:47], v[176:179]
v_accvgpr_read_b32 v108, a160
v_accvgpr_read_b32 v109, a161
v_mfma_f32_16x16x32_bf16 v[176:179], a[208:211], a[40:43], v[176:179]
v_accvgpr_read_b32 v110, a162
v_accvgpr_read_b32 v111, a163
v_mfma_f32_16x16x32_bf16 v[180:183], a[208:211], a[48:51], v[180:183]
v_accvgpr_read_b32 v112, a164
v_accvgpr_read_b32 v113, a165
v_mfma_f32_16x16x32_bf16 v[180:183], a[212:215], a[52:55], v[180:183]
v_accvgpr_read_b32 v114, a166
v_accvgpr_read_b32 v115, a167
v_mfma_f32_16x16x32_bf16 v[184:187], a[212:215], a[60:63], v[184:187]
v_accvgpr_read_b32 v116, a168
v_accvgpr_read_b32 v117, a169
v_mfma_f32_16x16x32_bf16 v[184:187], a[208:211], a[56:59], v[184:187]
s_waitcnt lgkmcnt(4)
v_accvgpr_read_b32 v118, a170
v_accvgpr_read_b32 v119, a171
v_mfma_f32_16x16x32_bf16 v[188:191], a[192:195], a[32:35], v[188:191]
ds_read_b64_tr_b16 a[208:209], v33 offset:24576
ds_read_b64_tr_b16 a[210:211], v33 offset:25088
v_mfma_f32_16x16x32_bf16 v[188:191], a[196:199], a[36:39], v[188:191]
ds_read_b64_tr_b16 a[212:213], v33 offset:28672
ds_read_b64_tr_b16 a[214:215], v33 offset:29184
v_mfma_f32_16x16x32_bf16 v[192:195], a[196:199], a[44:47], v[192:195]
v_accvgpr_read_b32 v120, a172
v_accvgpr_read_b32 v121, a173
v_mfma_f32_16x16x32_bf16 v[192:195], a[192:195], a[40:43], v[192:195]
v_accvgpr_read_b32 v122, a174
v_accvgpr_read_b32 v123, a175
v_mfma_f32_16x16x32_bf16 v[196:199], a[192:195], a[48:51], v[196:199]
v_accvgpr_read_b32 v124, a176
v_accvgpr_read_b32 v125, a177
v_mfma_f32_16x16x32_bf16 v[196:199], a[196:199], a[52:55], v[196:199]
v_accvgpr_read_b32 v126, a178
v_accvgpr_read_b32 v127, a179
v_mfma_f32_16x16x32_bf16 v[200:203], a[196:199], a[60:63], v[200:203]
v_accvgpr_read_b32 v128, a180
v_accvgpr_read_b32 v129, a181
v_mfma_f32_16x16x32_bf16 v[200:203], a[192:195], a[56:59], v[200:203]
s_waitcnt lgkmcnt(4)
v_accvgpr_read_b32 v130, a182
v_accvgpr_read_b32 v131, a183
v_mfma_f32_16x16x32_bf16 v[204:207], a[200:203], a[32:35], v[204:207]
v_accvgpr_read_b32 v132, a184
v_accvgpr_read_b32 v133, a185
v_mfma_f32_16x16x32_bf16 v[204:207], a[204:207], a[36:39], v[204:207]
v_accvgpr_read_b32 v134, a186
v_accvgpr_read_b32 v135, a187
v_mfma_f32_16x16x32_bf16 v[208:211], a[204:207], a[44:47], v[208:211]
v_accvgpr_read_b32 v136, a188
v_accvgpr_read_b32 v137, a189
v_mfma_f32_16x16x32_bf16 v[208:211], a[200:203], a[40:43], v[208:211]
v_accvgpr_read_b32 v138, a190
v_accvgpr_read_b32 v139, a191
v_mfma_f32_16x16x32_bf16 v[212:215], a[200:203], a[48:51], v[212:215]
s_waitcnt vmcnt(18) lgkmcnt(0)
s_barrier
ds_read_b64_tr_b16 a[192:193], v30 offset:49152
v_mfma_f32_16x16x32_bf16 v[212:215], a[204:207], a[52:55], v[212:215]
s_lshl_b32 s57, s49, 7
ds_read_b64_tr_b16 a[194:195], v30 offset:49664
ds_read_b64_tr_b16 a[196:197], v30 offset:53248
v_mfma_f32_16x16x32_bf16 v[216:219], a[204:207], a[60:63], v[216:219]
s_add_u32 s57, s57, 70778880
s_lshl_b32 s52, s50, 2
ds_read_b64_tr_b16 a[198:199], v30 offset:53760
v_mfma_f32_16x16x32_bf16 v[216:219], a[200:203], a[56:59], v[216:219]
s_add_u32 s51, s57, s52
s_cmp_eq_u32 s48, 0
s_cselect_b32 s51, s51, 2146435072
v_mfma_f32_16x16x32_bf16 v[220:223], a[208:211], a[32:35], v[220:223]
ds_read_b64_tr_b16 a[200:201], v31 offset:49152
ds_read_b64_tr_b16 a[202:203], v31 offset:49664
v_mfma_f32_16x16x32_bf16 v[220:223], a[212:215], a[36:39], v[220:223]
ds_read_b64_tr_b16 a[204:205], v31 offset:53248
ds_read_b64_tr_b16 a[206:207], v31 offset:53760
v_mfma_f32_16x16x32_bf16 v[224:227], a[212:215], a[44:47], v[224:227]
s_cmp_eq_u32 s54, 0
buffer_store_dword v39, v38, s[4:7], s51 offen sc1
v_mfma_f32_16x16x32_bf16 v[224:227], a[208:211], a[40:43], v[224:227]
s_cselect_b32 s51, s50, s64
s_lshl_b32 s51, s51, 3
s_add_u32 s86, s51, s55
v_mfma_f32_16x16x32_bf16 v[228:231], a[208:211], a[48:51], v[228:231]
s_sub_u32 s87, s51, s55
s_add_u32 s87, s87, 3
s_mul_i32 s86, s86, 186368
v_mfma_f32_16x16x32_bf16 v[228:231], a[212:215], a[52:55], v[228:231]
s_mul_i32 s87, s87, 186368
s_lshl_b32 s51, s92, 11
s_add_u32 s51, s51, 37748736
v_mfma_f32_16x16x32_bf16 v[232:235], a[212:215], a[60:63], v[232:235]
s_add_u32 s86, s86, s51
s_add_u32 s87, s87, s51
s_mov_b32 s63, 0x3e0293ee
v_mfma_f32_16x16x32_bf16 v[232:235], a[208:211], a[56:59], v[232:235]
s_waitcnt lgkmcnt(4)
s_mov_b32 s12, s63
s_mov_b32 s13, s63
s_mov_b32 s14, 0xc13504f3
v_mfma_f32_16x16x32_bf16 v[172:175], a[192:195], a[64:67], v[172:175]
s_mov_b32 s15, s14
ds_read_b64_tr_b16 a[208:209], v32 offset:49152
ds_read_b64_tr_b16 a[210:211], v32 offset:49664
v_mfma_f32_16x16x32_bf16 v[172:175], a[196:199], a[68:71], v[172:175]
ds_read_b64_tr_b16 a[212:213], v32 offset:53248
ds_read_b64_tr_b16 a[214:215], v32 offset:53760
v_mfma_f32_16x16x32_bf16 v[176:179], a[196:199], a[76:79], v[176:179]
v_accvgpr_read_b32 v140, a216
v_accvgpr_read_b32 v141, a217
v_mfma_f32_16x16x32_bf16 v[176:179], a[192:195], a[72:75], v[176:179]
s_waitcnt vmcnt(18)
v_accvgpr_read_b32 v142, a218
v_accvgpr_read_b32 v143, a219
v_mfma_f32_16x16x32_bf16 v[180:183], a[192:195], a[80:83], v[180:183]
s_waitcnt vmcnt(17)
v_accvgpr_read_b32 v144, a220
v_accvgpr_read_b32 v145, a221
v_mfma_f32_16x16x32_bf16 v[180:183], a[196:199], a[84:87], v[180:183]
s_waitcnt vmcnt(15)
v_accvgpr_read_b32 v146, a222
v_accvgpr_read_b32 v147, a223
v_mfma_f32_16x16x32_bf16 v[184:187], a[196:199], a[92:95], v[184:187]
v_accvgpr_read_b32 v148, a224
v_accvgpr_read_b32 v149, a225
v_mfma_f32_16x16x32_bf16 v[184:187], a[192:195], a[88:91], v[184:187]
s_waitcnt lgkmcnt(4)
v_accvgpr_read_b32 v150, a226
v_accvgpr_read_b32 v151, a227
v_mfma_f32_16x16x32_bf16 v[188:191], a[200:203], a[64:67], v[188:191]
ds_read_b64_tr_b16 a[192:193], v33 offset:49152
ds_read_b64_tr_b16 a[194:195], v33 offset:49664
v_mfma_f32_16x16x32_bf16 v[188:191], a[204:207], a[68:71], v[188:191]
ds_read_b64_tr_b16 a[196:197], v33 offset:53248
ds_read_b64_tr_b16 a[198:199], v33 offset:53760
v_mfma_f32_16x16x32_bf16 v[192:195], a[204:207], a[76:79], v[192:195]
s_lshl_b32 s3, s55, 15
v_accvgpr_read_b32 v152, a228
v_accvgpr_read_b32 v153, a229
v_mfma_f32_16x16x32_bf16 v[192:195], a[200:203], a[72:75], v[192:195]
s_add_u32 s3, s3, 0x8000
v_accvgpr_read_b32 v154, a230
v_accvgpr_read_b32 v155, a231
v_mfma_f32_16x16x32_bf16 v[196:199], a[200:203], a[80:83], v[196:199]
v_add_u32 v37, s3, v1
v_accvgpr_read_b32 v156, a232
v_mfma_f32_16x16x32_bf16 v[196:199], a[204:207], a[84:87], v[196:199]
s_lshl_b32 s3, s54, 14
v_add_u32 v36, s3, v37
v_accvgpr_read_b32 v157, a233
v_mfma_f32_16x16x32_bf16 v[200:203], a[204:207], a[92:95], v[200:203]
v_accvgpr_read_b32 v158, a234
v_accvgpr_read_b32 v159, a235
v_mfma_f32_16x16x32_bf16 v[200:203], a[200:203], a[88:91], v[200:203]
s_waitcnt lgkmcnt(4)
v_accvgpr_read_b32 v160, a236
v_accvgpr_read_b32 v161, a237
v_mfma_f32_16x16x32_bf16 v[204:207], a[208:211], a[64:67], v[204:207]
v_accvgpr_read_b32 v162, a238
v_accvgpr_read_b32 v163, a239
v_mfma_f32_16x16x32_bf16 v[204:207], a[212:215], a[68:71], v[204:207]
v_accvgpr_read_b32 v164, a240
v_accvgpr_read_b32 v165, a241
v_mfma_f32_16x16x32_bf16 v[208:211], a[212:215], a[76:79], v[208:211]
v_accvgpr_read_b32 v166, a242
v_accvgpr_read_b32 v167, a243
v_mfma_f32_16x16x32_bf16 v[208:211], a[208:211], a[72:75], v[208:211]
v_accvgpr_read_b32 v168, a244
v_accvgpr_read_b32 v169, a245
v_mfma_f32_16x16x32_bf16 v[212:215], a[208:211], a[80:83], v[212:215]
s_waitcnt vmcnt(9) lgkmcnt(0)
s_barrier
ds_read_b64_tr_b16 a[200:201], v30 offset:0
v_mfma_f32_16x16x32_bf16 v[212:215], a[212:215], a[84:87], v[212:215]
ds_read_b64_tr_b16 a[202:203], v30 offset:512
ds_read_b64_tr_b16 a[204:205], v30 offset:4096
v_mfma_f32_16x16x32_bf16 v[216:219], a[212:215], a[92:95], v[216:219]
ds_read_b64_tr_b16 a[206:207], v30 offset:4608
v_accvgpr_read_b32 v170, a246
v_mfma_f32_16x16x32_bf16 v[216:219], a[208:211], a[88:91], v[216:219]
v_accvgpr_read_b32 v171, a247
v_mfma_f32_16x16x32_bf16 v[220:223], a[192:195], a[64:67], v[220:223]
ds_read_b64_tr_b16 a[208:209], v31 offset:0
ds_read_b64_tr_b16 a[210:211], v31 offset:512
v_mfma_f32_16x16x32_bf16 v[220:223], a[196:199], a[68:71], v[220:223]
ds_read_b64_tr_b16 a[212:213], v31 offset:4096
ds_read_b64_tr_b16 a[214:215], v31 offset:4608
v_mfma_f32_16x16x32_bf16 v[224:227], a[196:199], a[76:79], v[224:227]
v_mfma_f32_16x16x32_bf16 v[224:227], a[192:195], a[72:75], v[224:227]
v_mfma_f32_16x16x32_bf16 v[228:231], a[192:195], a[80:83], v[228:231]
v_mfma_f32_16x16x32_bf16 v[228:231], a[196:199], a[84:87], v[228:231]
v_mfma_f32_16x16x32_bf16 v[232:235], a[196:199], a[92:95], v[232:235]
v_mfma_f32_16x16x32_bf16 v[232:235], a[192:195], a[88:91], v[232:235]
s_waitcnt vmcnt(8) lgkmcnt(5)
v_mfma_f32_16x16x32_bf16 v[172:175], a[200:203], a[0:3], v[172:175]
s_waitcnt vmcnt(7) lgkmcnt(4)
ds_read_b64_tr_b16 a[192:193], v32 offset:0
ds_read_b64_tr_b16 a[194:195], v32 offset:512
v_mfma_f32_16x16x32_bf16 v[172:175], a[204:207], a[4:7], v[172:175]
s_waitcnt vmcnt(5)
ds_read_b64_tr_b16 a[196:197], v32 offset:4096
ds_read_b64_tr_b16 a[198:199], v32 offset:4608
v_mfma_f32_16x16x32_bf16 v[176:179], a[204:207], a[12:15], v[176:179]
v_mfma_f32_16x16x32_bf16 v[176:179], a[200:203], a[8:11], v[176:179]
s_waitcnt vmcnt(4)
v_mfma_f32_16x16x32_bf16 v[180:183], a[200:203], a[16:19], v[180:183]
s_waitcnt vmcnt(3)
v_mfma_f32_16x16x32_bf16 v[180:183], a[204:207], a[20:23], v[180:183]
s_waitcnt vmcnt(1)
v_mfma_f32_16x16x32_bf16 v[184:187], a[204:207], a[28:31], v[184:187]
v_mfma_f32_16x16x32_bf16 v[184:187], a[200:203], a[24:27], v[184:187]
s_waitcnt lgkmcnt(4)
v_mfma_f32_16x16x32_bf16 v[188:191], a[208:211], a[0:3], v[188:191]
ds_read_b64_tr_b16 a[200:201], v33 offset:0
ds_read_b64_tr_b16 a[202:203], v33 offset:512
v_mfma_f32_16x16x32_bf16 v[188:191], a[212:215], a[4:7], v[188:191]
ds_read_b64_tr_b16 a[204:205], v33 offset:4096
ds_read_b64_tr_b16 a[206:207], v33 offset:4608
v_mfma_f32_16x16x32_bf16 v[192:195], a[212:215], a[12:15], v[192:195]
v_mfma_f32_16x16x32_bf16 v[192:195], a[208:211], a[8:11], v[192:195]
v_mfma_f32_16x16x32_bf16 v[196:199], a[208:211], a[16:19], v[196:199]
v_mfma_f32_16x16x32_bf16 v[196:199], a[212:215], a[20:23], v[196:199]
v_mfma_f32_16x16x32_bf16 v[200:203], a[212:215], a[28:31], v[200:203]
v_mfma_f32_16x16x32_bf16 v[200:203], a[208:211], a[24:27], v[200:203]
s_waitcnt lgkmcnt(4)
v_mfma_f32_16x16x32_bf16 v[204:207], a[192:195], a[0:3], v[204:207]
ds_read_b64_tr_b16 a[208:209], v22 offset:49152
ds_read_b64_tr_b16 a[210:211], v22 offset:50176
v_mfma_f32_16x16x32_bf16 v[204:207], a[196:199], a[4:7], v[204:207]
ds_read_b64_tr_b16 a[212:213], v22 offset:57344
ds_read_b64_tr_b16 a[214:215], v22 offset:58368
v_mfma_f32_16x16x32_bf16 v[208:211], a[196:199], a[12:15], v[208:211]
v_mfma_f32_16x16x32_bf16 v[208:211], a[192:195], a[8:11], v[208:211]
v_mfma_f32_16x16x32_bf16 v[212:215], a[192:195], a[16:19], v[212:215]
v_mfma_f32_16x16x32_bf16 v[212:215], a[196:199], a[20:23], v[212:215]
v_mfma_f32_16x16x32_bf16 v[216:219], a[196:199], a[28:31], v[216:219]
v_mfma_f32_16x16x32_bf16 v[216:219], a[192:195], a[24:27], v[216:219]
s_waitcnt lgkmcnt(4)
v_mfma_f32_16x16x32_bf16 v[220:223], a[200:203], a[0:3], v[220:223]
ds_read_b64_tr_b16 a[192:193], v23 offset:49152
ds_read_b64_tr_b16 a[194:195], v23 offset:50176
v_mfma_f32_16x16x32_bf16 v[220:223], a[204:207], a[4:7], v[220:223]
ds_read_b64_tr_b16 a[196:197], v23 offset:57344
ds_read_b64_tr_b16 a[198:199], v23 offset:58368
v_mfma_f32_16x16x32_bf16 v[224:227], a[204:207], a[12:15], v[224:227]
v_mfma_f32_16x16x32_bf16 v[224:227], a[200:203], a[8:11], v[224:227]
v_mfma_f32_16x16x32_bf16 v[228:231], a[200:203], a[16:19], v[228:231]
v_mfma_f32_16x16x32_bf16 v[228:231], a[204:207], a[20:23], v[228:231]
v_mfma_f32_16x16x32_bf16 v[232:235], a[204:207], a[28:31], v[232:235]
v_mfma_f32_16x16x32_bf16 v[232:235], a[200:203], a[24:27], v[232:235]
s_waitcnt lgkmcnt(4)
v_mfma_f32_16x16x32_bf16 v[44:47], a[208:211], a[64:67], v[44:47]
ds_read_b64_tr_b16 a[200:201], v24 offset:49152
ds_read_b64_tr_b16 a[202:203], v24 offset:50176
v_mfma_f32_16x16x32_bf16 v[44:47], a[212:215], a[68:71], v[44:47]
ds_read_b64_tr_b16 a[204:205], v24 offset:57344
ds_read_b64_tr_b16 a[206:207], v24 offset:58368
v_mfma_f32_16x16x32_bf16 v[48:51], a[212:215], a[76:79], v[48:51]
v_mul_f32 v236, 0xc13504f3, v172
v_mul_f32 v237, 0xc13504f3, v173
v_mfma_f32_16x16x32_bf16 v[48:51], a[208:211], a[72:75], v[48:51]
v_mul_f32 v238, 0xc13504f3, v174
v_mul_f32 v239, 0xc13504f3, v175
v_mfma_f32_16x16x32_bf16 v[52:55], a[208:211], a[80:83], v[52:55]
v_mul_f32 v240, 0xc13504f3, v188
v_mul_f32 v241, 0xc13504f3, v189
v_mfma_f32_16x16x32_bf16 v[52:55], a[212:215], a[84:87], v[52:55]
v_mul_f32 v242, 0xc13504f3, v190
v_mul_f32 v243, 0xc13504f3, v191
v_mfma_f32_16x16x32_bf16 v[56:59], a[212:215], a[92:95], v[56:59]
v_exp_f32 v236, v236
v_mfma_f32_16x16x32_bf16 v[56:59], a[208:211], a[88:91], v[56:59]
s_waitcnt lgkmcnt(4)
v_exp_f32 v237, v237
v_mfma_f32_16x16x32_bf16 v[60:63], a[192:195], a[64:67], v[60:63]
ds_read_b64_tr_b16 a[208:209], v25 offset:49152
ds_read_b64_tr_b16 a[210:211], v25 offset:50176
v_mfma_f32_16x16x32_bf16 v[60:63], a[196:199], a[68:71], v[60:63]
ds_read_b64_tr_b16 a[212:213], v25 offset:57344
ds_read_b64_tr_b16 a[214:215], v25 offset:58368
v_mfma_f32_16x16x32_bf16 v[64:67], a[196:199], a[76:79], v[64:67]
v_exp_f32 v238, v238
v_mfma_f32_16x16x32_bf16 v[64:67], a[192:195], a[72:75], v[64:67]
v_exp_f32 v239, v239
v_mfma_f32_16x16x32_bf16 v[68:71], a[192:195], a[80:83], v[68:71]
v_exp_f32 v240, v240
v_mfma_f32_16x16x32_bf16 v[68:71], a[196:199], a[84:87], v[68:71]
v_exp_f32 v241, v241
v_mfma_f32_16x16x32_bf16 v[72:75], a[196:199], a[92:95], v[72:75]
v_exp_f32 v242, v242
v_mfma_f32_16x16x32_bf16 v[72:75], a[192:195], a[88:91], v[72:75]
s_waitcnt lgkmcnt(4)
v_exp_f32 v243, v243
v_mfma_f32_16x16x32_bf16 v[76:79], a[200:203], a[64:67], v[76:79]
ds_read_b64_tr_b16 a[192:193], v26 offset:49152
ds_read_b64_tr_b16 a[194:195], v26 offset:50176
v_mfma_f32_16x16x32_bf16 v[76:79], a[204:207], a[68:71], v[76:79]
ds_read_b64_tr_b16 a[196:197], v26 offset:57344
ds_read_b64_tr_b16 a[198:199], v26 offset:58368
v_mfma_f32_16x16x32_bf16 v[80:83], a[204:207], a[76:79], v[80:83]
v_fma_f32 v236, v236, s63, s63
v_fma_f32 v237, v237, s63, s63
v_mfma_f32_16x16x32_bf16 v[80:83], a[200:203], a[72:75], v[80:83]
v_fma_f32 v238, v238, s63, s63
v_fma_f32 v239, v239, s63, s63
v_mfma_f32_16x16x32_bf16 v[84:87], a[200:203], a[80:83], v[84:87]
v_fma_f32 v240, v240, s63, s63
v_fma_f32 v241, v241, s63, s63
v_mfma_f32_16x16x32_bf16 v[84:87], a[204:207], a[84:87], v[84:87]
v_fma_f32 v242, v242, s63, s63
v_fma_f32 v243, v243, s63, s63
v_mfma_f32_16x16x32_bf16 v[88:91], a[204:207], a[92:95], v[88:91]
v_rcp_f32 v236, v236
v_mfma_f32_16x16x32_bf16 v[88:91], a[200:203], a[88:91], v[88:91]
s_waitcnt lgkmcnt(4)
v_rcp_f32 v237, v237
v_mfma_f32_16x16x32_bf16 v[92:95], a[208:211], a[64:67], v[92:95]
ds_read_b64_tr_b16 a[200:201], v27 offset:49152
ds_read_b64_tr_b16 a[202:203], v27 offset:50176
v_mfma_f32_16x16x32_bf16 v[92:95], a[212:215], a[68:71], v[92:95]
ds_read_b64_tr_b16 a[204:205], v27 offset:57344
ds_read_b64_tr_b16 a[206:207], v27 offset:58368
v_mfma_f32_16x16x32_bf16 v[96:99], a[212:215], a[76:79], v[96:99]
v_rcp_f32 v238, v238
v_mfma_f32_16x16x32_bf16 v[96:99], a[208:211], a[72:75], v[96:99]
v_rcp_f32 v239, v239
v_mfma_f32_16x16x32_bf16 v[100:103], a[208:211], a[80:83], v[100:103]
v_rcp_f32 v240, v240
v_mfma_f32_16x16x32_bf16 v[100:103], a[212:215], a[84:87], v[100:103]
v_rcp_f32 v241, v241
v_mfma_f32_16x16x32_bf16 v[104:107], a[212:215], a[92:95], v[104:107]
v_rcp_f32 v242, v242
v_mfma_f32_16x16x32_bf16 v[104:107], a[208:211], a[88:91], v[104:107]
s_waitcnt lgkmcnt(4)
v_rcp_f32 v243, v243
v_mfma_f32_16x16x32_bf16 v[108:111], a[192:195], a[64:67], v[108:111]
ds_read_b64_tr_b16 a[208:209], v28 offset:49152
ds_read_b64_tr_b16 a[210:211], v28 offset:50176
v_mfma_f32_16x16x32_bf16 v[108:111], a[196:199], a[68:71], v[108:111]
ds_read_b64_tr_b16 a[212:213], v28 offset:57344
ds_read_b64_tr_b16 a[214:215], v28 offset:58368
v_mfma_f32_16x16x32_bf16 v[112:115], a[196:199], a[76:79], v[112:115]
v_mul_f32 v172, v172, v236
v_mul_f32 v173, v173, v237
v_mfma_f32_16x16x32_bf16 v[112:115], a[192:195], a[72:75], v[112:115]
v_mul_f32 v174, v174, v238
v_mul_f32 v175, v175, v239
v_mfma_f32_16x16x32_bf16 v[116:119], a[192:195], a[80:83], v[116:119]
v_mul_f32 v188, v188, v240
v_mul_f32 v189, v189, v241
v_mfma_f32_16x16x32_bf16 v[116:119], a[196:199], a[84:87], v[116:119]
v_mul_f32 v190, v190, v242
v_mul_f32 v191, v191, v243
v_mfma_f32_16x16x32_bf16 v[120:123], a[196:199], a[92:95], v[120:123]
v_cvt_pk_bf16_f32 v172, v172, v173
v_cvt_pk_bf16_f32 v173, v174, v175
v_mfma_f32_16x16x32_bf16 v[120:123], a[192:195], a[88:91], v[120:123]
s_waitcnt lgkmcnt(4)
v_cvt_pk_bf16_f32 v174, v188, v189
v_cvt_pk_bf16_f32 v175, v190, v191
v_mfma_f32_16x16x32_bf16 v[124:127], a[200:203], a[64:67], v[124:127]
ds_read_b64_tr_b16 a[192:193], v29 offset:49152
ds_read_b64_tr_b16 a[194:195], v29 offset:50176
v_mfma_f32_16x16x32_bf16 v[124:127], a[204:207], a[68:71], v[124:127]
ds_read_b64_tr_b16 a[196:197], v29 offset:57344
ds_read_b64_tr_b16 a[198:199], v29 offset:58368
v_mfma_f32_16x16x32_bf16 v[128:131], a[204:207], a[76:79], v[128:131]
v_mul_f32 v244, 0xc13504f3, v176
v_mul_f32 v245, 0xc13504f3, v177
v_mfma_f32_16x16x32_bf16 v[128:131], a[200:203], a[72:75], v[128:131]
v_mul_f32 v246, 0xc13504f3, v178
v_mul_f32 v247, 0xc13504f3, v179
v_mfma_f32_16x16x32_bf16 v[132:135], a[200:203], a[80:83], v[132:135]
s_mov_b64 s[88:89], 255
v_lshlrev_b32 v34, 2, v0
v_mul_f32 v248, 0xc13504f3, v192
v_mfma_f32_16x16x32_bf16 v[132:135], a[204:207], a[84:87], v[132:135]
buffer_load_dword v35, v34, s[4:7], s57 offen sc1
v_mfma_f32_16x16x32_bf16 v[136:139], a[204:207], a[92:95], v[136:139]
v_mul_f32 v249, 0xc13504f3, v193
v_mul_f32 v250, 0xc13504f3, v194
v_mfma_f32_16x16x32_bf16 v[136:139], a[200:203], a[88:91], v[136:139]
s_waitcnt lgkmcnt(4)
v_mul_f32 v251, 0xc13504f3, v195
v_mfma_f32_16x16x32_bf16 v[140:143], a[208:211], a[64:67], v[140:143]
v_exp_f32 v244, v244
v_mfma_f32_16x16x32_bf16 v[140:143], a[212:215], a[68:71], v[140:143]
v_exp_f32 v245, v245
v_mfma_f32_16x16x32_bf16 v[144:147], a[212:215], a[76:79], v[144:147]
v_exp_f32 v246, v246
v_mfma_f32_16x16x32_bf16 v[144:147], a[208:211], a[72:75], v[144:147]
v_exp_f32 v247, v247
v_mfma_f32_16x16x32_bf16 v[148:151], a[208:211], a[80:83], v[148:151]
s_waitcnt lgkmcnt(0)
s_barrier
ds_read_b64_tr_b16 a[200:201], v22 offset:0
v_mfma_f32_16x16x32_bf16 v[148:151], a[212:215], a[84:87], v[148:151]
ds_read_b64_tr_b16 a[202:203], v22 offset:1024
ds_read_b64_tr_b16 a[204:205], v22 offset:8192
v_mfma_f32_16x16x32_bf16 v[152:155], a[212:215], a[92:95], v[152:155]
ds_read_b64_tr_b16 a[206:207], v22 offset:9216
v_mfma_f32_16x16x32_bf16 v[152:155], a[208:211], a[88:91], v[152:155]
v_exp_f32 v248, v248
v_mfma_f32_16x16x32_bf16 v[156:159], a[192:195], a[64:67], v[156:159]
ds_read_b64_tr_b16 a[208:209], v23 offset:0
ds_read_b64_tr_b16 a[210:211], v23 offset:1024
v_mfma_f32_16x16x32_bf16 v[156:159], a[196:199], a[68:71], v[156:159]
ds_read_b64_tr_b16 a[212:213], v23 offset:8192
ds_read_b64_tr_b16 a[214:215], v23 offset:9216
v_mfma_f32_16x16x32_bf16 v[160:163], a[196:199], a[76:79], v[160:163]
v_exp_f32 v249, v249
v_mfma_f32_16x16x32_bf16 v[160:163], a[192:195], a[72:75], v[160:163]
v_exp_f32 v250, v250
v_mfma_f32_16x16x32_bf16 v[164:167], a[192:195], a[80:83], v[164:167]
v_exp_f32 v251, v251
v_mfma_f32_16x16x32_bf16 v[164:167], a[196:199], a[84:87], v[164:167]
v_fma_f32 v244, v244, s63, s63
v_fma_f32 v245, v245, s63, s63
v_mfma_f32_16x16x32_bf16 v[168:171], a[196:199], a[92:95], v[168:171]
v_fma_f32 v246, v246, s63, s63
v_fma_f32 v247, v247, s63, s63
v_mfma_f32_16x16x32_bf16 v[168:171], a[192:195], a[88:91], v[168:171]
s_waitcnt lgkmcnt(5)
v_fma_f32 v248, v248, s63, s63
v_fma_f32 v249, v249, s63, s63
v_mfma_f32_16x16x32_bf16 v[44:47], a[200:203], a[0:3], v[44:47]
s_waitcnt lgkmcnt(4)
ds_read_b64_tr_b16 a[192:193], v24 offset:0
ds_read_b64_tr_b16 a[194:195], v24 offset:1024
v_mfma_f32_16x16x32_bf16 v[44:47], a[204:207], a[4:7], v[44:47]
ds_read_b64_tr_b16 a[196:197], v24 offset:8192
ds_read_b64_tr_b16 a[198:199], v24 offset:9216
v_mfma_f32_16x16x32_bf16 v[48:51], a[204:207], a[12:15], v[48:51]
v_fma_f32 v250, v250, s63, s63
v_fma_f32 v251, v251, s63, s63
v_mfma_f32_16x16x32_bf16 v[48:51], a[200:203], a[8:11], v[48:51]
v_rcp_f32 v244, v244
v_mfma_f32_16x16x32_bf16 v[52:55], a[200:203], a[16:19], v[52:55]
v_rcp_f32 v245, v245
v_mfma_f32_16x16x32_bf16 v[52:55], a[204:207], a[20:23], v[52:55]
v_rcp_f32 v246, v246
v_mfma_f32_16x16x32_bf16 v[56:59], a[204:207], a[28:31], v[56:59]
v_rcp_f32 v247, v247
v_mfma_f32_16x16x32_bf16 v[56:59], a[200:203], a[24:27], v[56:59]
s_waitcnt lgkmcnt(4)
v_rcp_f32 v248, v248
v_mfma_f32_16x16x32_bf16 v[60:63], a[208:211], a[0:3], v[60:63]
ds_read_b64_tr_b16 a[200:201], v25 offset:0
ds_read_b64_tr_b16 a[202:203], v25 offset:1024
v_mfma_f32_16x16x32_bf16 v[60:63], a[212:215], a[4:7], v[60:63]
ds_read_b64_tr_b16 a[204:205], v25 offset:8192
ds_read_b64_tr_b16 a[206:207], v25 offset:9216
v_mfma_f32_16x16x32_bf16 v[64:67], a[212:215], a[12:15], v[64:67]
s_waitcnt vmcnt(0)
v_cmp_ne_u32 vcc, 1, v35
v_mfma_f32_16x16x32_bf16 v[64:67], a[208:211], a[8:11], v[64:67]
v_rcp_f32 v249, v249
v_mfma_f32_16x16x32_bf16 v[68:71], a[208:211], a[16:19], v[68:71]
s_nop 0
s_and_b64 vcc, vcc, s[88:89]
v_rcp_f32 v250, v250
v_mfma_f32_16x16x32_bf16 v[68:71], a[212:215], a[20:23], v[68:71]
v_rcp_f32 v251, v251
v_mfma_f32_16x16x32_bf16 v[72:75], a[212:215], a[28:31], v[72:75]
s_cbranch_vccnz L_slow_kv1
L_slow_kv1_back:
v_mul_f32 v176, v176, v244
v_mfma_f32_16x16x32_bf16 v[72:75], a[208:211], a[24:27], v[72:75]
s_waitcnt lgkmcnt(4)
v_cvt_pk_bf16_f32 v44, v44, v45
v_cvt_pk_bf16_f32 v45, v46, v47
v_mfma_f32_16x16x32_bf16 v[76:79], a[192:195], a[0:3], v[76:79]
s_mov_b32 s58, 4194304
ds_read_b64_tr_b16 a[208:209], v26 offset:0
ds_read_b64_tr_b16 a[210:211], v26 offset:1024
v_mfma_f32_16x16x32_bf16 v[76:79], a[196:199], a[4:7], v[76:79]
s_add_u32 m0, s56, 98304
ds_read_b64_tr_b16 a[212:213], v26 offset:8192
ds_read_b64_tr_b16 a[214:215], v26 offset:9216
v_mfma_f32_16x16x32_bf16 v[80:83], a[196:199], a[12:15], v[80:83]
buffer_load_dwordx4 v40, s[4:7], s58 offen offset:0 sc1 lds
v_mfma_f32_16x16x32_bf16 v[80:83], a[192:195], a[8:11], v[80:83]
v_cvt_pk_bf16_f32 v46, v60, v61
v_cvt_pk_bf16_f32 v47, v62, v63
v_mfma_f32_16x16x32_bf16 v[84:87], a[192:195], a[16:19], v[84:87]
buffer_load_dwordx4 v40, s[4:7], s58 offen offset:1024 sc1 lds
v_mfma_f32_16x16x32_bf16 v[84:87], a[196:199], a[20:23], v[84:87]
ds_write_b128 v36, v[44:47] offset:0
v_mfma_f32_16x16x32_bf16 v[88:91], a[196:199], a[28:31], v[88:91]
v_cvt_pk_bf16_f32 v48, v48, v49
v_cvt_pk_bf16_f32 v49, v50, v51
v_mfma_f32_16x16x32_bf16 v[88:91], a[192:195], a[24:27], v[88:91]
s_waitcnt lgkmcnt(5)
v_cvt_pk_bf16_f32 v50, v64, v65
v_cvt_pk_bf16_f32 v51, v66, v67
v_mfma_f32_16x16x32_bf16 v[92:95], a[200:203], a[0:3], v[92:95]
ds_read_b64_tr_b16 a[192:193], v27 offset:0
ds_read_b64_tr_b16 a[194:195], v27 offset:1024
v_mfma_f32_16x16x32_bf16 v[92:95], a[204:207], a[4:7], v[92:95]
ds_read_b64_tr_b16 a[196:197], v27 offset:8192
ds_read_b64_tr_b16 a[198:199], v27 offset:9216
v_mfma_f32_16x16x32_bf16 v[96:99], a[204:207], a[12:15], v[96:99]
buffer_load_dwordx4 v40, s[4:7], s58 offen offset:2048 sc1 lds
v_mfma_f32_16x16x32_bf16 v[96:99], a[200:203], a[8:11], v[96:99]
ds_write_b128 v36, v[48:51] offset:4096
v_mfma_f32_16x16x32_bf16 v[100:103], a[200:203], a[16:19], v[100:103]
buffer_load_dwordx4 v40, s[4:7], s58 offen offset:3072 sc1 lds
v_mfma_f32_16x16x32_bf16 v[100:103], a[204:207], a[20:23], v[100:103]
v_cvt_pk_bf16_f32 v52, v52, v53
v_cvt_pk_bf16_f32 v53, v54, v55
v_mfma_f32_16x16x32_bf16 v[104:107], a[204:207], a[28:31], v[104:107]
v_cvt_pk_bf16_f32 v54, v68, v69
v_cvt_pk_bf16_f32 v55, v70, v71
v_mfma_f32_16x16x32_bf16 v[104:107], a[200:203], a[24:27], v[104:107]
ds_write_b128 v36, v[52:55] offset:8192
s_waitcnt lgkmcnt(6)
v_mfma_f32_16x16x32_bf16 v[108:111], a[208:211], a[0:3], v[108:111]
s_add_u32 m0, s56, 102400
ds_read_b64_tr_b16 a[200:201], v28 offset:0
ds_read_b64_tr_b16 a[202:203], v28 offset:1024
v_mfma_f32_16x16x32_bf16 v[108:111], a[212:215], a[4:7], v[108:111]
ds_read_b64_tr_b16 a[204:205], v28 offset:8192
ds_read_b64_tr_b16 a[206:207], v28 offset:9216
v_mfma_f32_16x16x32_bf16 v[112:115], a[212:215], a[12:15], v[112:115]
buffer_load_dwordx4 v41, s[4:7], s58 offen offset:0 sc1 lds
v_mfma_f32_16x16x32_bf16 v[112:115], a[208:211], a[8:11], v[112:115]
v_cvt_pk_bf16_f32 v56, v56, v57
v_cvt_pk_bf16_f32 v57, v58, v59
v_mfma_f32_16x16x32_bf16 v[116:119], a[208:211], a[16:19], v[116:119]
buffer_load_dwordx4 v41, s[4:7], s58 offen offset:1024 sc1 lds
v_mfma_f32_16x16x32_bf16 v[116:119], a[212:215], a[20:23], v[116:119]
v_cvt_pk_bf16_f32 v58, v72, v73
v_cvt_pk_bf16_f32 v59, v74, v75
v_mfma_f32_16x16x32_bf16 v[120:123], a[212:215], a[28:31], v[120:123]
ds_write_b128 v36, v[56:59] offset:12288
v_mfma_f32_16x16x32_bf16 v[120:123], a[208:211], a[24:27], v[120:123]
s_waitcnt lgkmcnt(6)
v_cvt_pk_bf16_f32 v76, v76, v77
v_cvt_pk_bf16_f32 v77, v78, v79
v_mfma_f32_16x16x32_bf16 v[124:127], a[192:195], a[0:3], v[124:127]
ds_read_b64_tr_b16 a[208:209], v29 offset:0
ds_read_b64_tr_b16 a[210:211], v29 offset:1024
v_mfma_f32_16x16x32_bf16 v[124:127], a[196:199], a[4:7], v[124:127]
ds_read_b64_tr_b16 a[212:213], v29 offset:8192
ds_read_b64_tr_b16 a[214:215], v29 offset:9216
v_mfma_f32_16x16x32_bf16 v[128:131], a[196:199], a[12:15], v[128:131]
buffer_load_dwordx4 v41, s[4:7], s58 offen offset:2048 sc1 lds
v_mfma_f32_16x16x32_bf16 v[128:131], a[192:195], a[8:11], v[128:131]
v_cvt_pk_bf16_f32 v78, v92, v93
v_cvt_pk_bf16_f32 v79, v94, v95
v_mfma_f32_16x16x32_bf16 v[132:135], a[192:195], a[16:19], v[132:135]
buffer_load_dwordx4 v41, s[4:7], s58 offen offset:3072 sc1 lds
v_mfma_f32_16x16x32_bf16 v[132:135], a[196:199], a[20:23], v[132:135]
ds_write_b128 v36, v[76:79] offset:1024
v_mfma_f32_16x16x32_bf16 v[136:139], a[196:199], a[28:31], v[136:139]
v_cvt_pk_bf16_f32 v80, v80, v81
v_cvt_pk_bf16_f32 v81, v82, v83
v_mfma_f32_16x16x32_bf16 v[136:139], a[192:195], a[24:27], v[136:139]
s_waitcnt lgkmcnt(6)
v_cvt_pk_bf16_f32 v82, v96, v97
v_cvt_pk_bf16_f32 v83, v98, v99
v_mfma_f32_16x16x32_bf16 v[140:143], a[200:203], a[0:3], v[140:143]
s_mov_b32 s59, 20971520
s_add_u32 m0, s56, 131072
v_mul_f32 v177, v177, v245
v_mfma_f32_16x16x32_bf16 v[140:143], a[204:207], a[4:7], v[140:143]
buffer_load_dwordx4 v40, s[4:7], s59 offen offset:0 sc1 lds
v_mfma_f32_16x16x32_bf16 v[144:147], a[204:207], a[12:15], v[144:147]
ds_write_b128 v36, v[80:83] offset:5120
v_mfma_f32_16x16x32_bf16 v[144:147], a[200:203], a[8:11], v[144:147]
v_cvt_pk_bf16_f32 v84, v84, v85
v_cvt_pk_bf16_f32 v85, v86, v87
v_mfma_f32_16x16x32_bf16 v[148:151], a[200:203], a[16:19], v[148:151]
buffer_load_dwordx4 v40, s[4:7], s59 offen offset:1024 sc1 lds
v_mfma_f32_16x16x32_bf16 v[148:151], a[204:207], a[20:23], v[148:151]
v_cvt_pk_bf16_f32 v86, v100, v101
v_cvt_pk_bf16_f32 v87, v102, v103
v_mfma_f32_16x16x32_bf16 v[152:155], a[204:207], a[28:31], v[152:155]
ds_write_b128 v36, v[84:87] offset:9216
v_mfma_f32_16x16x32_bf16 v[152:155], a[200:203], a[24:27], v[152:155]
s_waitcnt lgkmcnt(2)
v_cvt_pk_bf16_f32 v88, v88, v89
v_cvt_pk_bf16_f32 v89, v90, v91
v_mfma_f32_16x16x32_bf16 v[156:159], a[208:211], a[0:3], v[156:159]
buffer_load_dwordx4 v40, s[4:7], s59 offen offset:2048 sc1 lds
v_mfma_f32_16x16x32_bf16 v[156:159], a[212:215], a[4:7], v[156:159]
v_cvt_pk_bf16_f32 v90, v104, v105
v_cvt_pk_bf16_f32 v91, v106, v107
v_mfma_f32_16x16x32_bf16 v[160:163], a[212:215], a[12:15], v[160:163]
ds_write_b128 v36, v[88:91] offset:13312
v_mfma_f32_16x16x32_bf16 v[160:163], a[208:211], a[8:11], v[160:163]
v_cvt_pk_bf16_f32 v108, v108, v109
v_cvt_pk_bf16_f32 v109, v110, v111
v_mfma_f32_16x16x32_bf16 v[164:167], a[208:211], a[16:19], v[164:167]
buffer_load_dwordx4 v40, s[4:7], s59 offen offset:3072 sc1 lds
v_mfma_f32_16x16x32_bf16 v[164:167], a[212:215], a[20:23], v[164:167]
v_cvt_pk_bf16_f32 v110, v124, v125
v_cvt_pk_bf16_f32 v111, v126, v127
v_mfma_f32_16x16x32_bf16 v[168:171], a[212:215], a[28:31], v[168:171]
ds_write_b128 v36, v[108:111] offset:2048
v_mfma_f32_16x16x32_bf16 v[168:171], a[208:211], a[24:27], v[168:171]
v_cvt_pk_bf16_f32 v112, v112, v113
v_cvt_pk_bf16_f32 v113, v114, v115
v_cvt_pk_bf16_f32 v114, v128, v129
v_cvt_pk_bf16_f32 v115, v130, v131
ds_write_b128 v36, v[112:115] offset:6144
v_cvt_pk_bf16_f32 v116, v116, v117
v_cvt_pk_bf16_f32 v117, v118, v119
v_cvt_pk_bf16_f32 v118, v132, v133
v_cvt_pk_bf16_f32 v119, v134, v135
ds_write_b128 v36, v[116:119] offset:10240
v_cvt_pk_bf16_f32 v120, v120, v121
v_cvt_pk_bf16_f32 v121, v122, v123
v_cvt_pk_bf16_f32 v122, v136, v137
v_cvt_pk_bf16_f32 v123, v138, v139
ds_write_b128 v36, v[120:123] offset:14336
v_mul_f32 v178, v178, v246
v_mul_f32 v179, v179, v247
v_mul_f32 v192, v192, v248
v_mul_f32 v193, v193, v249
v_mul_f32 v194, v194, v250
v_mul_f32 v195, v195, v251
v_cvt_pk_bf16_f32 v176, v176, v177
v_cvt_pk_bf16_f32 v177, v178, v179
v_cvt_pk_bf16_f32 v178, v192, v193
v_cvt_pk_bf16_f32 v179, v194, v195
v_mul_f32 v236, 0xc13504f3, v180
v_mul_f32 v237, 0xc13504f3, v181
v_mul_f32 v238, 0xc13504f3, v182
v_mul_f32 v239, 0xc13504f3, v183
v_mul_f32 v240, 0xc13504f3, v196
v_mul_f32 v241, 0xc13504f3, v197
v_mul_f32 v242, 0xc13504f3, v198
v_mul_f32 v243, 0xc13504f3, v199
v_exp_f32 v236, v236
v_exp_f32 v237, v237
v_exp_f32 v238, v238
v_exp_f32 v239, v239
v_exp_f32 v240, v240
v_exp_f32 v241, v241
v_exp_f32 v242, v242
v_exp_f32 v243, v243
v_fma_f32 v236, v236, s63, s63
v_fma_f32 v237, v237, s63, s63
v_fma_f32 v238, v238, s63, s63
v_fma_f32 v239, v239, s63, s63
v_fma_f32 v240, v240, s63, s63
v_fma_f32 v241, v241, s63, s63
v_fma_f32 v242, v242, s63, s63
v_fma_f32 v243, v243, s63, s63
v_rcp_f32 v236, v236
v_rcp_f32 v237, v237
v_rcp_f32 v238, v238
v_rcp_f32 v239, v239
v_rcp_f32 v240, v240
v_rcp_f32 v241, v241
v_rcp_f32 v242, v242
v_rcp_f32 v243, v243
v_mul_f32 v180, v180, v236
v_mul_f32 v181, v181, v237
v_mul_f32 v182, v182, v238
v_mul_f32 v183, v183, v239
v_mul_f32 v196, v196, v240
v_mul_f32 v197, v197, v241
v_mul_f32 v198, v198, v242
v_mul_f32 v199, v199, v243
v_cvt_pk_bf16_f32 v180, v180, v181
v_cvt_pk_bf16_f32 v181, v182, v183
v_cvt_pk_bf16_f32 v182, v196, v197
v_cvt_pk_bf16_f32 v183, v198, v199
s_add_u32 m0, s56, 135168
s_nop 0
buffer_load_dwordx4 v41, s[4:7], s59 offen offset:0 sc1 lds
buffer_load_dwordx4 v41, s[4:7], s59 offen offset:1024 sc1 lds
buffer_load_dwordx4 v41, s[4:7], s59 offen offset:2048 sc1 lds
buffer_load_dwordx4 v41, s[4:7], s59 offen offset:3072 sc1 lds
v_cvt_pk_bf16_f32 v140, v140, v141
v_cvt_pk_bf16_f32 v141, v142, v143
v_cvt_pk_bf16_f32 v142, v156, v157
v_cvt_pk_bf16_f32 v143, v158, v159
ds_write_b128 v36, v[140:143] offset:3072
v_cvt_pk_bf16_f32 v144, v144, v145
v_cvt_pk_bf16_f32 v145, v146, v147
v_cvt_pk_bf16_f32 v146, v160, v161
v_cvt_pk_bf16_f32 v147, v162, v163
ds_write_b128 v36, v[144:147] offset:7168
v_cvt_pk_bf16_f32 v148, v148, v149
v_cvt_pk_bf16_f32 v149, v150, v151
v_cvt_pk_bf16_f32 v150, v164, v165
v_cvt_pk_bf16_f32 v151, v166, v167
ds_write_b128 v36, v[148:151] offset:11264
v_cvt_pk_bf16_f32 v152, v152, v153
v_cvt_pk_bf16_f32 v153, v154, v155
v_cvt_pk_bf16_f32 v154, v168, v169
v_cvt_pk_bf16_f32 v155, v170, v171
ds_write_b128 v36, v[152:155] offset:15360

v_mov_b32 v4, v40
v_mov_b32 v5, v41
s_mov_b32 s60, 2
s_cmp_eq_u32 s50, 0
s_cselect_b32 s58, 0, 0x8000
s_add_u32 s58, s58, 4194304
s_add_u32 s61, s50, 1
s_add_u32 s57, s56, 65536
s_add_u32 s56, s56, 98304
v_and_b32 v6, 15, v0
v_lshrrev_b32 v7, 4, v0
s_lshl_b32 s51, s54, 14
s_add_u32 s51, s51, 98304
v_add_u32 v2, s51, v1
v_cmp_eq_u32 vcc, 0, v6
v_mov_b32 v8, 0x3f803f80
v_lshlrev_b32 v7, 2, v7
v_cndmask_b32 v8, 0, v8, vcc
v_sub_u32 v7, v6, v7
v_mov_b32 v9, v8
v_mov_b32 v10, v8
v_mov_b32 v11, v8
s_sub_i32 s51, s54, s55
s_lshl_b32 s51, s51, 4
s_add_i32 s52, s54, s55
s_sub_i32 s52, s52, 1
s_lshl_b32 s52, s52, 4
v_mov_b32 v6, 0xf149f2ca
v_subrev_u32 v20, s51, v7
v_subrev_u32 v21, s52, v7
v_cmp_le_i32 vcc, 0, v20
v_cmp_le_i32 s[52:53], 0, v21
s_nop 0
v_cndmask_b32 v12, v6, 0, vcc
v_cndmask_b32 v16, v6, 0, s[52:53]
v_cmp_le_i32 vcc, 1, v20
v_cmp_le_i32 s[52:53], 1, v21
s_nop 0
v_cndmask_b32 v13, v6, 0, vcc
v_cndmask_b32 v17, v6, 0, s[52:53]
v_cmp_le_i32 vcc, 2, v20
v_cmp_le_i32 s[52:53], 2, v21
s_nop 0
v_cndmask_b32 v14, v6, 0, vcc
v_cndmask_b32 v18, v6, 0, s[52:53]
v_cmp_le_i32 vcc, 3, v20
v_cmp_le_i32 s[52:53], 3, v21
s_nop 0
v_cndmask_b32 v15, v6, 0, vcc
v_cndmask_b32 v19, v6, 0, s[52:53]
s_waitcnt vmcnt(8) lgkmcnt(0)
s_barrier
ds_read_b128 a[0:3], v37 offset:0
ds_read_b128 a[4:7], v37 offset:1024
ds_read_b128 a[8:11], v37 offset:2048
ds_read_b128 a[12:15], v37 offset:3072
ds_read_b128 a[16:19], v37 offset:4096
ds_read_b128 a[20:23], v37 offset:5120
ds_read_b128 a[24:27], v37 offset:6144
ds_read_b128 a[28:31], v37 offset:7168
ds_read_b128 a[32:35], v37 offset:8192
ds_read_b128 a[36:39], v37 offset:9216
ds_read_b128 a[40:43], v37 offset:10240
ds_read_b128 a[44:47], v37 offset:11264
ds_read_b128 a[48:51], v37 offset:12288
ds_read_b128 a[52:55], v37 offset:13312
ds_read_b128 a[56:59], v37 offset:14336
ds_read_b128 a[60:63], v37 offset:15360
ds_read_b128 a[64:67], v37 offset:16384
ds_read_b128 a[68:71], v37 offset:17408
ds_read_b128 a[72:75], v37 offset:18432
ds_read_b128 a[76:79], v37 offset:19456
ds_read_b128 a[80:83], v37 offset:20480
ds_read_b128 a[84:87], v37 offset:21504
ds_read_b128 a[88:91], v37 offset:22528
ds_read_b128 a[92:95], v37 offset:23552
ds_read_b128 a[96:99], v37 offset:24576
ds_read_b128 a[100:103], v37 offset:25600
ds_read_b128 a[104:107], v37 offset:26624
ds_read_b128 a[108:111], v37 offset:27648
ds_read_b128 a[112:115], v37 offset:28672
ds_read_b128 a[116:119], v37 offset:29696
ds_read_b128 a[120:123], v37 offset:30720
ds_read_b128 a[124:127], v37 offset:31744
v_add_u32 v3, 32768, v2
ds_read_b128 v[100:103], v2 offset:0
ds_read_b128 v[104:107], v2 offset:1024
ds_read_b128 v[108:111], v2 offset:2048
ds_read_b128 v[112:115], v2 offset:3072
ds_read_b128 v[116:119], v2 offset:4096
ds_read_b128 v[120:123], v2 offset:5120
ds_read_b128 v[124:127], v2 offset:6144
ds_read_b128 v[128:131], v2 offset:7168
ds_read_b128 v[132:135], v2 offset:8192
ds_read_b128 v[136:139], v2 offset:9216
ds_read_b128 v[140:143], v2 offset:10240
ds_read_b128 v[144:147], v2 offset:11264
ds_read_b128 v[148:151], v2 offset:12288
ds_read_b128 v[152:155], v2 offset:13312
ds_read_b128 v[156:159], v2 offset:14336
ds_read_b128 v[160:163], v2 offset:15360
v_xor_b32 v2, 65536, v2

s_add_u32 s62, s86, 0
buffer_store_dwordx4 v[172:175], v1, s[4:7], s62 offen offset:0 sc1
s_add_u32 s62, s87, 0
buffer_store_dwordx4 v[176:179], v1, s[4:7], s62 offen offset:0 sc1
s_add_u32 s62, s86, 745472
buffer_store_dwordx4 v[180:183], v1, s[4:7], s62 offen offset:0 sc1
v_pk_mul_f32 v[244:245], v[184:185], s[14:15]
v_pk_mul_f32 v[246:247], v[186:187], s[14:15]
v_pk_mul_f32 v[248:249], v[200:201], s[14:15]
v_pk_mul_f32 v[250:251], v[202:203], s[14:15]
v_exp_f32 v244, v244
v_exp_f32 v245, v245
v_exp_f32 v246, v246
v_exp_f32 v247, v247
v_exp_f32 v248, v248
v_exp_f32 v249, v249
v_exp_f32 v250, v250
v_exp_f32 v251, v251
v_pk_fma_f32 v[244:245], v[244:245], s[12:13], s[12:13]
v_pk_fma_f32 v[246:247], v[246:247], s[12:13], s[12:13]
v_pk_fma_f32 v[248:249], v[248:249], s[12:13], s[12:13]
v_pk_fma_f32 v[250:251], v[250:251], s[12:13], s[12:13]
v_rcp_f32 v244, v244
v_rcp_f32 v245, v245
v_rcp_f32 v246, v246
v_rcp_f32 v247, v247
v_rcp_f32 v248, v248
v_rcp_f32 v249, v249
v_rcp_f32 v250, v250
v_rcp_f32 v251, v251
v_pk_mul_f32 v[184:185], v[184:185], v[244:245]
v_pk_mul_f32 v[186:187], v[186:187], v[246:247]
v_pk_mul_f32 v[200:201], v[200:201], v[248:249]
v_pk_mul_f32 v[202:203], v[202:203], v[250:251]
v_cvt_pk_bf16_f32 v184, v184, v185
v_cvt_pk_bf16_f32 v185, v186, v187
v_cvt_pk_bf16_f32 v186, v200, v201
v_cvt_pk_bf16_f32 v187, v202, v203
s_add_u32 s62, s87, 745472
buffer_store_dwordx4 v[184:187], v1, s[4:7], s62 offen offset:0 sc1
v_pk_mul_f32 v[236:237], v[204:205], s[14:15]
v_pk_mul_f32 v[238:239], v[206:207], s[14:15]
v_pk_mul_f32 v[240:241], v[220:221], s[14:15]
v_pk_mul_f32 v[242:243], v[222:223], s[14:15]
v_exp_f32 v236, v236
v_exp_f32 v237, v237
v_exp_f32 v238, v238
v_exp_f32 v239, v239
v_exp_f32 v240, v240
v_exp_f32 v241, v241
v_exp_f32 v242, v242
v_exp_f32 v243, v243
v_pk_fma_f32 v[236:237], v[236:237], s[12:13], s[12:13]
v_pk_fma_f32 v[238:239], v[238:239], s[12:13], s[12:13]
v_pk_fma_f32 v[240:241], v[240:241], s[12:13], s[12:13]
v_pk_fma_f32 v[242:243], v[242:243], s[12:13], s[12:13]
v_rcp_f32 v236, v236
v_rcp_f32 v237, v237
v_rcp_f32 v238, v238
v_rcp_f32 v239, v239
v_rcp_f32 v240, v240
v_rcp_f32 v241, v241
v_rcp_f32 v242, v242
v_rcp_f32 v243, v243
v_pk_mul_f32 v[204:205], v[204:205], v[236:237]
v_pk_mul_f32 v[206:207], v[206:207], v[238:239]
v_pk_mul_f32 v[220:221], v[220:221], v[240:241]
v_pk_mul_f32 v[222:223], v[222:223], v[242:243]
v_cvt_pk_bf16_f32 v204, v204, v205
v_cvt_pk_bf16_f32 v205, v206, v207
v_cvt_pk_bf16_f32 v206, v220, v221
v_cvt_pk_bf16_f32 v207, v222, v223
s_add_u32 s62, s86, 0
buffer_store_dwordx4 v[204:207], v1, s[4:7], s62 offen offset:1024 sc1
v_pk_mul_f32 v[244:245], v[208:209], s[14:15]
v_pk_mul_f32 v[246:247], v[210:211], s[14:15]
v_pk_mul_f32 v[248:249], v[224:225], s[14:15]
v_pk_mul_f32 v[250:251], v[226:227], s[14:15]
v_exp_f32 v244, v244
v_exp_f32 v245, v245
v_exp_f32 v246, v246
v_exp_f32 v247, v247
v_exp_f32 v248, v248
v_exp_f32 v249, v249
v_exp_f32 v250, v250
v_exp_f32 v251, v251
v_pk_fma_f32 v[244:245], v[244:245], s[12:13], s[12:13]
v_pk_fma_f32 v[246:247], v[246:247], s[12:13], s[12:13]
v_pk_fma_f32 v[248:249], v[248:249], s[12:13], s[12:13]
v_pk_fma_f32 v[250:251], v[250:251], s[12:13], s[12:13]
v_rcp_f32 v244, v244
v_rcp_f32 v245, v245
v_rcp_f32 v246, v246
v_rcp_f32 v247, v247
v_rcp_f32 v248, v248
v_rcp_f32 v249, v249
v_rcp_f32 v250, v250
v_rcp_f32 v251, v251
v_pk_mul_f32 v[208:209], v[208:209], v[244:245]
v_pk_mul_f32 v[210:211], v[210:211], v[246:247]
v_pk_mul_f32 v[224:225], v[224:225], v[248:249]
v_pk_mul_f32 v[226:227], v[226:227], v[250:251]
v_cvt_pk_bf16_f32 v208, v208, v209
v_cvt_pk_bf16_f32 v209, v210, v211
v_cvt_pk_bf16_f32 v210, v224, v225
v_cvt_pk_bf16_f32 v211, v226, v227
s_add_u32 s62, s87, 0
buffer_store_dwordx4 v[208:211], v1, s[4:7], s62 offen offset:1024 sc1
v_pk_mul_f32 v[236:237], v[212:213], s[14:15]
v_pk_mul_f32 v[238:239], v[214:215], s[14:15]
v_pk_mul_f32 v[240:241], v[228:229], s[14:15]
v_pk_mul_f32 v[242:243], v[230:231], s[14:15]
v_exp_f32 v236, v236
v_exp_f32 v237, v237
v_exp_f32 v238, v238
v_exp_f32 v239, v239
v_exp_f32 v240, v240
v_exp_f32 v241, v241
v_exp_f32 v242, v242
v_exp_f32 v243, v243
v_pk_fma_f32 v[236:237], v[236:237], s[12:13], s[12:13]
v_pk_fma_f32 v[238:239], v[238:239], s[12:13], s[12:13]
v_pk_fma_f32 v[240:241], v[240:241], s[12:13], s[12:13]
v_pk_fma_f32 v[242:243], v[242:243], s[12:13], s[12:13]
v_rcp_f32 v236, v236
v_rcp_f32 v237, v237
v_rcp_f32 v238, v238
v_rcp_f32 v239, v239
v_rcp_f32 v240, v240
v_rcp_f32 v241, v241
v_rcp_f32 v242, v242
v_rcp_f32 v243, v243
v_pk_mul_f32 v[212:213], v[212:213], v[236:237]
v_pk_mul_f32 v[214:215], v[214:215], v[238:239]
v_pk_mul_f32 v[228:229], v[228:229], v[240:241]
v_pk_mul_f32 v[230:231], v[230:231], v[242:243]
v_cvt_pk_bf16_f32 v212, v212, v213
v_cvt_pk_bf16_f32 v213, v214, v215
v_cvt_pk_bf16_f32 v214, v228, v229
v_cvt_pk_bf16_f32 v215, v230, v231
s_add_u32 s62, s86, 745472
buffer_store_dwordx4 v[212:215], v1, s[4:7], s62 offen offset:1024 sc1
v_pk_mul_f32 v[244:245], v[216:217], s[14:15]
v_pk_mul_f32 v[246:247], v[218:219], s[14:15]
v_pk_mul_f32 v[248:249], v[232:233], s[14:15]
v_pk_mul_f32 v[250:251], v[234:235], s[14:15]
v_exp_f32 v244, v244
v_exp_f32 v245, v245
v_exp_f32 v246, v246
v_exp_f32 v247, v247
v_exp_f32 v248, v248
v_exp_f32 v249, v249
v_exp_f32 v250, v250
v_exp_f32 v251, v251
v_pk_fma_f32 v[244:245], v[244:245], s[12:13], s[12:13]
v_pk_fma_f32 v[246:247], v[246:247], s[12:13], s[12:13]
v_pk_fma_f32 v[248:249], v[248:249], s[12:13], s[12:13]
v_pk_fma_f32 v[250:251], v[250:251], s[12:13], s[12:13]
v_rcp_f32 v244, v244
v_rcp_f32 v245, v245
v_rcp_f32 v246, v246
v_rcp_f32 v247, v247
v_rcp_f32 v248, v248
v_rcp_f32 v249, v249
v_rcp_f32 v250, v250
v_rcp_f32 v251, v251
v_pk_mul_f32 v[216:217], v[216:217], v[244:245]
v_pk_mul_f32 v[218:219], v[218:219], v[246:247]
v_pk_mul_f32 v[232:233], v[232:233], v[248:249]
v_pk_mul_f32 v[234:235], v[234:235], v[250:251]
v_cvt_pk_bf16_f32 v216, v216, v217
v_cvt_pk_bf16_f32 v217, v218, v219
v_cvt_pk_bf16_f32 v218, v232, v233
v_cvt_pk_bf16_f32 v219, v234, v235
s_add_u32 s62, s87, 745472
buffer_store_dwordx4 v[216:219], v1, s[4:7], s62 offen offset:1024 sc1

s_branch L_join
L_nof:
s_waitcnt vmcnt(15) lgkmcnt(0)
v_mfma_f32_16x16x32_bf16 a[96:99], a[192:195], a[0:3], 0
s_waitcnt vmcnt(14)
ds_read_b64_tr_b16 a[208:209], v24 offset:0
ds_read_b64_tr_b16 a[210:211], v24 offset:1024
v_mfma_f32_16x16x32_bf16 a[96:99], a[196:199], a[4:7], a[96:99]
s_waitcnt vmcnt(12)
s_add_u32 s63, s93, 2
ds_read_b64_tr_b16 a[212:213], v24 offset:8192
ds_read_b64_tr_b16 a[214:215], v24 offset:9216
v_mfma_f32_16x16x32_bf16 a[100:103], a[196:199], a[12:15], 0
s_and_b32 s63, s63, 7
s_xor_b32 s63, s63, s94
s_lshl_b32 s63, s63, 11
v_mfma_f32_16x16x32_bf16 a[100:103], a[192:195], a[8:11], a[100:103]
s_waitcnt vmcnt(11)
buffer_load_dwordx4 a[64:67], v16, s[4:7], s63 offen offset:0 sc1
v_mfma_f32_16x16x32_bf16 a[104:107], a[192:195], a[16:19], 0
s_waitcnt vmcnt(11)
v_cvt_pk_bf16_f32 v100, v100, v101
v_cvt_pk_bf16_f32 v101, v102, v103
v_mfma_f32_16x16x32_bf16 a[104:107], a[196:199], a[20:23], a[104:107]
s_add_u32 s62, s60, 0
buffer_store_dwordx4 v[44:47], v1, s[4:7], s62 offen sc1
s_waitcnt vmcnt(10)
v_mfma_f32_16x16x32_bf16 a[108:111], a[196:199], a[28:31], 0
v_accvgpr_read_b32 v102, a224
v_accvgpr_read_b32 v103, a225
v_mfma_f32_16x16x32_bf16 a[108:111], a[192:195], a[24:27], a[108:111]
v_accvgpr_read_b32 v252, a226
v_accvgpr_read_b32 v253, a227
v_mfma_f32_16x16x32_bf16 a[112:115], a[200:203], a[0:3], 0
ds_read_b64_tr_b16 a[192:193], v25 offset:0
ds_read_b64_tr_b16 a[194:195], v25 offset:1024
v_mfma_f32_16x16x32_bf16 a[112:115], a[204:207], a[4:7], a[112:115]
ds_read_b64_tr_b16 a[196:197], v25 offset:8192
ds_read_b64_tr_b16 a[198:199], v25 offset:9216
v_mfma_f32_16x16x32_bf16 a[116:119], a[204:207], a[12:15], 0
buffer_load_dwordx4 a[68:71], v16, s[4:7], s63 offen offset:1024 sc1
v_mfma_f32_16x16x32_bf16 a[116:119], a[200:203], a[8:11], a[116:119]
v_cvt_pk_bf16_f32 v102, v102, v103
v_cvt_pk_bf16_f32 v103, v252, v253
v_mfma_f32_16x16x32_bf16 a[120:123], a[200:203], a[16:19], 0
v_cvt_pk_bf16_f32 v104, v104, v105
v_cvt_pk_bf16_f32 v105, v106, v107
v_mfma_f32_16x16x32_bf16 a[120:123], a[204:207], a[20:23], a[120:123]
s_add_u32 s62, s60, 16384
buffer_store_dwordx4 v[48:51], v1, s[4:7], s62 offen sc1
v_mfma_f32_16x16x32_bf16 a[124:127], a[204:207], a[28:31], 0
v_accvgpr_read_b32 v106, a228
v_accvgpr_read_b32 v107, a229
v_mfma_f32_16x16x32_bf16 a[124:127], a[200:203], a[24:27], a[124:127]
s_waitcnt lgkmcnt(4)
v_accvgpr_read_b32 v254, a230
v_accvgpr_read_b32 v255, a231
v_mfma_f32_16x16x32_bf16 a[128:131], a[208:211], a[0:3], 0
ds_read_b64_tr_b16 a[200:201], v26 offset:0
ds_read_b64_tr_b16 a[202:203], v26 offset:1024
v_mfma_f32_16x16x32_bf16 a[128:131], a[212:215], a[4:7], a[128:131]
ds_read_b64_tr_b16 a[204:205], v26 offset:8192
ds_read_b64_tr_b16 a[206:207], v26 offset:9216
v_mfma_f32_16x16x32_bf16 a[132:135], a[212:215], a[12:15], 0
buffer_load_dwordx4 a[72:75], v17, s[4:7], s63 offen offset:0 sc1
v_mfma_f32_16x16x32_bf16 a[132:135], a[208:211], a[8:11], a[132:135]
v_cvt_pk_bf16_f32 v106, v106, v107
v_cvt_pk_bf16_f32 v107, v254, v255
v_mfma_f32_16x16x32_bf16 a[136:139], a[208:211], a[16:19], 0
v_cvt_pk_bf16_f32 v108, v108, v109
v_cvt_pk_bf16_f32 v109, v110, v111
v_mfma_f32_16x16x32_bf16 a[136:139], a[212:215], a[20:23], a[136:139]
buffer_load_dwordx4 a[76:79], v17, s[4:7], s63 offen offset:1024 sc1
v_mfma_f32_16x16x32_bf16 a[140:143], a[212:215], a[28:31], 0
v_accvgpr_read_b32 v110, a232
v_accvgpr_read_b32 v111, a233
v_mfma_f32_16x16x32_bf16 a[140:143], a[208:211], a[24:27], a[140:143]
s_waitcnt lgkmcnt(4)
v_accvgpr_read_b32 v252, a234
v_accvgpr_read_b32 v253, a235
v_mfma_f32_16x16x32_bf16 a[144:147], a[192:195], a[0:3], 0
ds_read_b64_tr_b16 a[208:209], v27 offset:0
ds_read_b64_tr_b16 a[210:211], v27 offset:1024
v_mfma_f32_16x16x32_bf16 a[144:147], a[196:199], a[4:7], a[144:147]
ds_read_b64_tr_b16 a[212:213], v27 offset:8192
ds_read_b64_tr_b16 a[214:215], v27 offset:9216
v_mfma_f32_16x16x32_bf16 a[148:151], a[196:199], a[12:15], 0
buffer_load_dwordx4 a[80:83], v18, s[4:7], s63 offen offset:0 sc1
v_mfma_f32_16x16x32_bf16 a[148:151], a[192:195], a[8:11], a[148:151]
v_cvt_pk_bf16_f32 v110, v110, v111
v_cvt_pk_bf16_f32 v111, v252, v253
v_mfma_f32_16x16x32_bf16 a[152:155], a[192:195], a[16:19], 0
v_cvt_pk_bf16_f32 v112, v112, v113
v_cvt_pk_bf16_f32 v113, v114, v115
v_mfma_f32_16x16x32_bf16 a[152:155], a[196:199], a[20:23], a[152:155]
buffer_load_dwordx4 a[84:87], v18, s[4:7], s63 offen offset:1024 sc1
v_mfma_f32_16x16x32_bf16 a[156:159], a[196:199], a[28:31], 0
v_accvgpr_read_b32 v114, a236
v_accvgpr_read_b32 v115, a237
v_mfma_f32_16x16x32_bf16 a[156:159], a[192:195], a[24:27], a[156:159]
s_waitcnt lgkmcnt(4)
v_accvgpr_read_b32 v254, a238
v_accvgpr_read_b32 v255, a239
v_mfma_f32_16x16x32_bf16 a[160:163], a[200:203], a[0:3], 0
ds_read_b64_tr_b16 a[192:193], v28 offset:0
ds_read_b64_tr_b16 a[194:195], v28 offset:1024
v_mfma_f32_16x16x32_bf16 a[160:163], a[204:207], a[4:7], a[160:163]
ds_read_b64_tr_b16 a[196:197], v28 offset:8192
ds_read_b64_tr_b16 a[198:199], v28 offset:9216
v_mfma_f32_16x16x32_bf16 a[164:167], a[204:207], a[12:15], 0
buffer_load_dwordx4 a[88:91], v19, s[4:7], s63 offen offset:0 sc1
v_mfma_f32_16x16x32_bf16 a[164:167], a[200:203], a[8:11], a[164:167]
v_cvt_pk_bf16_f32 v114, v114, v115
v_cvt_pk_bf16_f32 v115, v254, v255
v_mfma_f32_16x16x32_bf16 a[168:171], a[200:203], a[16:19], 0
v_cvt_pk_bf16_f32 v116, v116, v117
v_cvt_pk_bf16_f32 v117, v118, v119
v_mfma_f32_16x16x32_bf16 a[168:171], a[204:207], a[20:23], a[168:171]
buffer_load_dwordx4 a[92:95], v19, s[4:7], s63 offen offset:1024 sc1
v_mfma_f32_16x16x32_bf16 a[172:175], a[204:207], a[28:31], 0
v_accvgpr_read_b32 v118, a240
v_accvgpr_read_b32 v119, a241
v_mfma_f32_16x16x32_bf16 a[172:175], a[200:203], a[24:27], a[172:175]
s_waitcnt lgkmcnt(4)
v_accvgpr_read_b32 v252, a242
v_accvgpr_read_b32 v253, a243
v_mfma_f32_16x16x32_bf16 a[176:179], a[208:211], a[0:3], 0
ds_read_b64_tr_b16 a[200:201], v29 offset:0
ds_read_b64_tr_b16 a[202:203], v29 offset:1024
v_mfma_f32_16x16x32_bf16 a[176:179], a[212:215], a[4:7], a[176:179]
ds_read_b64_tr_b16 a[204:205], v29 offset:8192
ds_read_b64_tr_b16 a[206:207], v29 offset:9216
v_mfma_f32_16x16x32_bf16 a[180:183], a[212:215], a[12:15], 0
v_cvt_pk_bf16_f32 v118, v118, v119
v_cvt_pk_bf16_f32 v119, v252, v253
v_mfma_f32_16x16x32_bf16 a[180:183], a[208:211], a[8:11], a[180:183]
v_cvt_pk_bf16_f32 v120, v120, v121
v_cvt_pk_bf16_f32 v121, v122, v123
v_mfma_f32_16x16x32_bf16 a[184:187], a[208:211], a[16:19], 0
v_accvgpr_read_b32 v122, a244
v_accvgpr_read_b32 v123, a245
v_mfma_f32_16x16x32_bf16 a[184:187], a[212:215], a[20:23], a[184:187]
v_accvgpr_read_b32 v254, a246
v_accvgpr_read_b32 v255, a247
v_mfma_f32_16x16x32_bf16 a[188:191], a[212:215], a[28:31], 0
v_cvt_pk_bf16_f32 v122, v122, v123
v_cvt_pk_bf16_f32 v123, v254, v255
v_mfma_f32_16x16x32_bf16 a[188:191], a[208:211], a[24:27], a[188:191]
s_waitcnt lgkmcnt(4)
v_cvt_pk_bf16_f32 v124, v124, v125
v_cvt_pk_bf16_f32 v125, v126, v127
v_mfma_f32_16x16x32_bf16 a[216:219], a[192:195], a[0:3], 0
v_accvgpr_read_b32 v126, a248
v_accvgpr_read_b32 v127, a249
v_mfma_f32_16x16x32_bf16 a[216:219], a[196:199], a[4:7], a[216:219]
v_accvgpr_read_b32 v252, a250
v_accvgpr_read_b32 v253, a251
v_mfma_f32_16x16x32_bf16 a[220:223], a[196:199], a[12:15], 0
v_cvt_pk_bf16_f32 v126, v126, v127
v_cvt_pk_bf16_f32 v127, v252, v253
v_mfma_f32_16x16x32_bf16 a[220:223], a[192:195], a[8:11], a[220:223]
v_cvt_pk_bf16_f32 v128, v128, v129
v_cvt_pk_bf16_f32 v129, v130, v131
v_mfma_f32_16x16x32_bf16 a[224:227], a[192:195], a[16:19], 0
s_waitcnt vmcnt(63) lgkmcnt(0)
s_barrier
v_accvgpr_read_b32 v130, a252
v_accvgpr_read_b32 v131, a253
v_accvgpr_read_b32 v254, a254
v_accvgpr_read_b32 v255, a255
v_cvt_pk_bf16_f32 v130, v130, v131
v_cvt_pk_bf16_f32 v131, v254, v255
v_mfma_f32_16x16x32_bf16 a[224:227], a[196:199], a[20:23], a[224:227]
s_add_u32 m0, s65, 0
ds_read_b64_tr_b16 a[208:209], v22 offset:24576
ds_read_b64_tr_b16 a[210:211], v22 offset:25600
v_mfma_f32_16x16x32_bf16 a[228:231], a[196:199], a[28:31], 0
s_add_u32 s3, s93, 3
ds_read_b64_tr_b16 a[212:213], v22 offset:32768
ds_read_b64_tr_b16 a[214:215], v22 offset:33792
v_mfma_f32_16x16x32_bf16 a[228:231], a[192:195], a[24:27], a[228:231]
s_and_b32 s3, s3, 7
v_cvt_pk_bf16_f32 v132, v132, v133
v_cvt_pk_bf16_f32 v133, v134, v135
v_mfma_f32_16x16x32_bf16 a[232:235], a[200:203], a[0:3], 0
s_xor_b32 s3, s3, s94
ds_read_b64_tr_b16 a[192:193], v23 offset:24576
ds_read_b64_tr_b16 a[194:195], v23 offset:25600
v_mfma_f32_16x16x32_bf16 a[232:235], a[204:207], a[4:7], a[232:235]
s_lshl_b32 s3, s3, 19
ds_read_b64_tr_b16 a[196:197], v23 offset:32768
ds_read_b64_tr_b16 a[198:199], v23 offset:33792
v_mfma_f32_16x16x32_bf16 a[236:239], a[204:207], a[12:15], 0
v_cvt_pk_bf16_f32 v134, v172, v173
v_cvt_pk_bf16_f32 v135, v174, v175
v_mfma_f32_16x16x32_bf16 a[236:239], a[200:203], a[8:11], a[236:239]
v_cvt_pk_bf16_f32 v136, v136, v137
v_cvt_pk_bf16_f32 v137, v138, v139
v_mfma_f32_16x16x32_bf16 a[240:243], a[200:203], a[16:19], 0
v_cvt_pk_bf16_f32 v138, v176, v177
v_cvt_pk_bf16_f32 v139, v178, v179
v_mfma_f32_16x16x32_bf16 a[240:243], a[204:207], a[20:23], a[240:243]
v_cvt_pk_bf16_f32 v140, v140, v141
v_cvt_pk_bf16_f32 v141, v142, v143
v_cvt_pk_bf16_f32 v142, v180, v181
v_cvt_pk_bf16_f32 v143, v182, v183
v_cvt_pk_bf16_f32 v144, v144, v145
v_cvt_pk_bf16_f32 v145, v146, v147
v_cvt_pk_bf16_f32 v146, v184, v185
v_cvt_pk_bf16_f32 v147, v186, v187
v_cvt_pk_bf16_f32 v148, v148, v149
v_cvt_pk_bf16_f32 v149, v150, v151
v_cvt_pk_bf16_f32 v150, v188, v189
v_cvt_pk_bf16_f32 v151, v190, v191
v_cvt_pk_bf16_f32 v152, v152, v153
v_cvt_pk_bf16_f32 v153, v154, v155
v_cvt_pk_bf16_f32 v154, v192, v193
v_cvt_pk_bf16_f32 v155, v194, v195
v_cvt_pk_bf16_f32 v156, v156, v157
v_cvt_pk_bf16_f32 v157, v158, v159
v_cvt_pk_bf16_f32 v158, v196, v197
v_cvt_pk_bf16_f32 v159, v198, v199
v_cvt_pk_bf16_f32 v160, v160, v161
v_cvt_pk_bf16_f32 v161, v162, v163
v_cvt_pk_bf16_f32 v162, v200, v201
v_cvt_pk_bf16_f32 v163, v202, v203
v_cvt_pk_bf16_f32 v164, v164, v165
v_cvt_pk_bf16_f32 v165, v166, v167
v_cvt_pk_bf16_f32 v166, v204, v205
v_cvt_pk_bf16_f32 v167, v206, v207
v_cvt_pk_bf16_f32 v168, v168, v169
v_cvt_pk_bf16_f32 v169, v170, v171
v_cvt_pk_bf16_f32 v170, v208, v209
v_cvt_pk_bf16_f32 v171, v210, v211
v_mfma_f32_16x16x32_bf16 a[244:247], a[204:207], a[28:31], 0
buffer_load_dwordx4 v12, s[16:19], s3 offen offset:0 lds
v_mfma_f32_16x16x32_bf16 a[244:247], a[200:203], a[24:27], a[244:247]
s_waitcnt vmcnt(18) lgkmcnt(0)
buffer_load_dwordx4 v13, s[16:19], s3 offen offset:1024 lds
v_mfma_f32_16x16x32_bf16 a[96:99], a[208:211], a[32:35], a[96:99]
s_waitcnt vmcnt(18)
ds_read_b64_tr_b16 a[200:201], v24 offset:24576
ds_read_b64_tr_b16 a[202:203], v24 offset:25600
v_mfma_f32_16x16x32_bf16 a[96:99], a[212:215], a[36:39], a[96:99]
s_waitcnt vmcnt(16)
ds_read_b64_tr_b16 a[204:205], v24 offset:32768
ds_read_b64_tr_b16 a[206:207], v24 offset:33792
v_mfma_f32_16x16x32_bf16 a[100:103], a[212:215], a[44:47], a[100:103]
buffer_load_dwordx4 v14, s[16:19], s3 offen offset:2048 lds
v_mfma_f32_16x16x32_bf16 a[100:103], a[208:211], a[40:43], a[100:103]
s_waitcnt vmcnt(16)
buffer_load_dwordx4 v15, s[16:19], s3 offen offset:3072 lds
v_mfma_f32_16x16x32_bf16 a[104:107], a[208:211], a[48:51], a[104:107]
s_waitcnt vmcnt(16)
v_mfma_f32_16x16x32_bf16 a[104:107], a[212:215], a[52:55], a[104:107]
s_waitcnt vmcnt(14)
s_add_u32 s63, s93, 3
s_and_b32 s63, s63, 7
s_xor_b32 s63, s63, s94
v_mfma_f32_16x16x32_bf16 a[108:111], a[212:215], a[60:63], a[108:111]
s_lshl_b32 s63, s63, 11
buffer_load_dwordx4 a[0:3], v16, s[4:7], s63 offen offset:0 sc1
v_mfma_f32_16x16x32_bf16 a[108:111], a[208:211], a[56:59], a[108:111]
v_mfma_f32_16x16x32_bf16 a[112:115], a[192:195], a[32:35], a[112:115]
ds_read_b64_tr_b16 a[208:209], v25 offset:24576
ds_read_b64_tr_b16 a[210:211], v25 offset:25600
v_mfma_f32_16x16x32_bf16 a[112:115], a[196:199], a[36:39], a[112:115]
s_add_u32 s62, s60, 4096
ds_read_b64_tr_b16 a[212:213], v25 offset:32768
ds_read_b64_tr_b16 a[214:215], v25 offset:33792
v_mfma_f32_16x16x32_bf16 a[116:119], a[196:199], a[44:47], a[116:119]
buffer_store_dwordx4 v[52:55], v1, s[4:7], s62 offen sc1
v_mfma_f32_16x16x32_bf16 a[116:119], a[192:195], a[40:43], a[116:119]
v_mfma_f32_16x16x32_bf16 a[120:123], a[192:195], a[48:51], a[120:123]
v_mfma_f32_16x16x32_bf16 a[120:123], a[196:199], a[52:55], a[120:123]
buffer_load_dwordx4 a[4:7], v16, s[4:7], s63 offen offset:1024 sc1
v_mfma_f32_16x16x32_bf16 a[124:127], a[196:199], a[60:63], a[124:127]
v_mfma_f32_16x16x32_bf16 a[124:127], a[192:195], a[56:59], a[124:127]
s_waitcnt lgkmcnt(4)
v_mfma_f32_16x16x32_bf16 a[128:131], a[200:203], a[32:35], a[128:131]
ds_read_b64_tr_b16 a[192:193], v26 offset:24576
ds_read_b64_tr_b16 a[194:195], v26 offset:25600
v_mfma_f32_16x16x32_bf16 a[128:131], a[204:207], a[36:39], a[128:131]
s_add_u32 s62, s60, 20480
ds_read_b64_tr_b16 a[196:197], v26 offset:32768
ds_read_b64_tr_b16 a[198:199], v26 offset:33792
v_mfma_f32_16x16x32_bf16 a[132:135], a[204:207], a[44:47], a[132:135]
buffer_store_dwordx4 v[56:59], v1, s[4:7], s62 offen sc1
v_mfma_f32_16x16x32_bf16 a[132:135], a[200:203], a[40:43], a[132:135]
v_mfma_f32_16x16x32_bf16 a[136:139], a[200:203], a[48:51], a[136:139]
v_mfma_f32_16x16x32_bf16 a[136:139], a[204:207], a[52:55], a[136:139]
buffer_load_dwordx4 a[8:11], v17, s[4:7], s63 offen offset:0 sc1
v_mfma_f32_16x16x32_bf16 a[140:143], a[204:207], a[60:63], a[140:143]
v_mfma_f32_16x16x32_bf16 a[140:143], a[200:203], a[56:59], a[140:143]
s_waitcnt lgkmcnt(4)
v_mfma_f32_16x16x32_bf16 a[144:147], a[208:211], a[32:35], a[144:147]
ds_read_b64_tr_b16 a[200:201], v27 offset:24576
ds_read_b64_tr_b16 a[202:203], v27 offset:25600
v_mfma_f32_16x16x32_bf16 a[144:147], a[212:215], a[36:39], a[144:147]
s_add_u32 s62, s60, 8192
ds_read_b64_tr_b16 a[204:205], v27 offset:32768
ds_read_b64_tr_b16 a[206:207], v27 offset:33792
v_mfma_f32_16x16x32_bf16 a[148:151], a[212:215], a[44:47], a[148:151]
buffer_store_dwordx4 v[60:63], v1, s[4:7], s62 offen sc1
v_mfma_f32_16x16x32_bf16 a[148:151], a[208:211], a[40:43], a[148:151]
v_mfma_f32_16x16x32_bf16 a[152:155], a[208:211], a[48:51], a[152:155]
v_mfma_f32_16x16x32_bf16 a[152:155], a[212:215], a[52:55], a[152:155]
buffer_load_dwordx4 a[12:15], v17, s[4:7], s63 offen offset:1024 sc1
v_mfma_f32_16x16x32_bf16 a[156:159], a[212:215], a[60:63], a[156:159]
v_mfma_f32_16x16x32_bf16 a[156:159], a[208:211], a[56:59], a[156:159]
s_waitcnt lgkmcnt(4)
v_mfma_f32_16x16x32_bf16 a[160:163], a[192:195], a[32:35], a[160:163]
ds_read_b64_tr_b16 a[208:209], v28 offset:24576
ds_read_b64_tr_b16 a[210:211], v28 offset:25600
v_mfma_f32_16x16x32_bf16 a[160:163], a[196:199], a[36:39], a[160:163]
s_add_u32 s62, s60, 24576
ds_read_b64_tr_b16 a[212:213], v28 offset:32768
ds_read_b64_tr_b16 a[214:215], v28 offset:33792
v_mfma_f32_16x16x32_bf16 a[164:167], a[196:199], a[44:47], a[164:167]
buffer_store_dwordx4 v[64:67], v1, s[4:7], s62 offen sc1
v_mfma_f32_16x16x32_bf16 a[164:167], a[192:195], a[40:43], a[164:167]
v_mfma_f32_16x16x32_bf16 a[168:171], a[192:195], a[48:51], a[168:171]
v_mfma_f32_16x16x32_bf16 a[168:171], a[196:199], a[52:55], a[168:171]
buffer_load_dwordx4 a[16:19], v18, s[4:7], s63 offen offset:0 sc1
v_mfma_f32_16x16x32_bf16 a[172:175], a[196:199], a[60:63], a[172:175]
v_mfma_f32_16x16x32_bf16 a[172:175], a[192:195], a[56:59], a[172:175]
s_waitcnt lgkmcnt(4)
v_mfma_f32_16x16x32_bf16 a[176:179], a[200:203], a[32:35], a[176:179]
ds_read_b64_tr_b16 a[192:193], v29 offset:24576
ds_read_b64_tr_b16 a[194:195], v29 offset:25600
v_mfma_f32_16x16x32_bf16 a[176:179], a[204:207], a[36:39], a[176:179]
s_add_u32 s62, s60, 12288
ds_read_b64_tr_b16 a[196:197], v29 offset:32768
ds_read_b64_tr_b16 a[198:199], v29 offset:33792
v_mfma_f32_16x16x32_bf16 a[180:183], a[204:207], a[44:47], a[180:183]
buffer_store_dwordx4 v[68:71], v1, s[4:7], s62 offen sc1
v_mfma_f32_16x16x32_bf16 a[180:183], a[200:203], a[40:43], a[180:183]
v_mfma_f32_16x16x32_bf16 a[184:187], a[200:203], a[48:51], a[184:187]
v_mfma_f32_16x16x32_bf16 a[184:187], a[204:207], a[52:55], a[184:187]
buffer_load_dwordx4 a[20:23], v18, s[4:7], s63 offen offset:1024 sc1
v_mfma_f32_16x16x32_bf16 a[188:191], a[204:207], a[60:63], a[188:191]
v_mfma_f32_16x16x32_bf16 a[188:191], a[200:203], a[56:59], a[188:191]
s_waitcnt lgkmcnt(4)
v_mfma_f32_16x16x32_bf16 a[216:219], a[208:211], a[32:35], a[216:219]
v_mfma_f32_16x16x32_bf16 a[216:219], a[212:215], a[36:39], a[216:219]
buffer_load_dwordx4 a[24:27], v19, s[4:7], s63 offen offset:0 sc1
v_mfma_f32_16x16x32_bf16 a[220:223], a[212:215], a[44:47], a[220:223]
v_mfma_f32_16x16x32_bf16 a[220:223], a[208:211], a[40:43], a[220:223]
v_mfma_f32_16x16x32_bf16 a[224:227], a[208:211], a[48:51], a[224:227]
s_waitcnt vmcnt(63) lgkmcnt(0)
s_barrier
ds_read_b64_tr_b16 a[200:201], v22 offset:49152
v_mfma_f32_16x16x32_bf16 a[224:227], a[212:215], a[52:55], a[224:227]
ds_read_b64_tr_b16 a[202:203], v22 offset:50176
ds_read_b64_tr_b16 a[204:205], v22 offset:57344
v_mfma_f32_16x16x32_bf16 a[228:231], a[212:215], a[60:63], a[228:231]
ds_read_b64_tr_b16 a[206:207], v22 offset:58368
v_mfma_f32_16x16x32_bf16 a[228:231], a[208:211], a[56:59], a[228:231]
buffer_load_dwordx4 a[28:31], v19, s[4:7], s63 offen offset:1024 sc1
v_mfma_f32_16x16x32_bf16 a[232:235], a[192:195], a[32:35], a[232:235]
ds_read_b64_tr_b16 a[208:209], v23 offset:49152
ds_read_b64_tr_b16 a[210:211], v23 offset:50176
v_mfma_f32_16x16x32_bf16 a[232:235], a[196:199], a[36:39], a[232:235]
s_add_u32 m0, s65, 24576
ds_read_b64_tr_b16 a[212:213], v23 offset:57344
ds_read_b64_tr_b16 a[214:215], v23 offset:58368
v_mfma_f32_16x16x32_bf16 a[236:239], a[196:199], a[44:47], a[236:239]
s_add_u32 s3, s93, 4
s_and_b32 s3, s3, 7
s_xor_b32 s3, s3, s94
v_mfma_f32_16x16x32_bf16 a[236:239], a[192:195], a[40:43], a[236:239]
s_lshl_b32 s3, s3, 19
buffer_load_dwordx4 v12, s[16:19], s3 offen offset:0 lds
v_mfma_f32_16x16x32_bf16 a[240:243], a[192:195], a[48:51], a[240:243]
v_mfma_f32_16x16x32_bf16 a[240:243], a[196:199], a[52:55], a[240:243]
buffer_load_dwordx4 v13, s[16:19], s3 offen offset:1024 lds
v_mfma_f32_16x16x32_bf16 a[244:247], a[196:199], a[60:63], a[244:247]
v_mfma_f32_16x16x32_bf16 a[244:247], a[192:195], a[56:59], a[244:247]
s_waitcnt vmcnt(28) lgkmcnt(4)
v_mfma_f32_16x16x32_bf16 a[96:99], a[200:203], a[64:67], a[96:99]
s_waitcnt vmcnt(26)
ds_read_b64_tr_b16 a[192:193], v24 offset:49152
ds_read_b64_tr_b16 a[194:195], v24 offset:50176
v_mfma_f32_16x16x32_bf16 a[96:99], a[204:207], a[68:71], a[96:99]
s_waitcnt vmcnt(23)
ds_read_b64_tr_b16 a[196:197], v24 offset:57344
ds_read_b64_tr_b16 a[198:199], v24 offset:58368
v_mfma_f32_16x16x32_bf16 a[100:103], a[204:207], a[76:79], a[100:103]
buffer_load_dwordx4 v14, s[16:19], s3 offen offset:2048 lds
v_mfma_f32_16x16x32_bf16 a[100:103], a[200:203], a[72:75], a[100:103]
s_waitcnt vmcnt(23)
v_mfma_f32_16x16x32_bf16 a[104:107], a[200:203], a[80:83], a[104:107]
s_waitcnt vmcnt(22)
v_mfma_f32_16x16x32_bf16 a[104:107], a[204:207], a[84:87], a[104:107]
s_waitcnt vmcnt(20)
buffer_load_dwordx4 v15, s[16:19], s3 offen offset:3072 lds
v_mfma_f32_16x16x32_bf16 a[108:111], a[204:207], a[92:95], a[108:111]
v_mfma_f32_16x16x32_bf16 a[108:111], a[200:203], a[88:91], a[108:111]
s_waitcnt lgkmcnt(4)
v_mfma_f32_16x16x32_bf16 a[112:115], a[208:211], a[64:67], a[112:115]
ds_read_b64_tr_b16 a[200:201], v25 offset:49152
ds_read_b64_tr_b16 a[202:203], v25 offset:50176
v_mfma_f32_16x16x32_bf16 a[112:115], a[212:215], a[68:71], a[112:115]
s_add_u32 s63, s93, 4
ds_read_b64_tr_b16 a[204:205], v25 offset:57344
ds_read_b64_tr_b16 a[206:207], v25 offset:58368
v_mfma_f32_16x16x32_bf16 a[116:119], a[212:215], a[76:79], a[116:119]
s_and_b32 s63, s63, 7
s_xor_b32 s63, s63, s94
s_lshl_b32 s63, s63, 11
v_mfma_f32_16x16x32_bf16 a[116:119], a[208:211], a[72:75], a[116:119]
buffer_load_dwordx4 a[32:35], v16, s[4:7], s63 offen offset:0 sc1
v_mfma_f32_16x16x32_bf16 a[120:123], a[208:211], a[80:83], a[120:123]
v_mfma_f32_16x16x32_bf16 a[120:123], a[212:215], a[84:87], a[120:123]
s_add_u32 s62, s60, 28672
buffer_store_dwordx4 v[72:75], v1, s[4:7], s62 offen sc1
v_mfma_f32_16x16x32_bf16 a[124:127], a[212:215], a[92:95], a[124:127]
v_mfma_f32_16x16x32_bf16 a[124:127], a[208:211], a[88:91], a[124:127]
s_waitcnt lgkmcnt(4)
v_mfma_f32_16x16x32_bf16 a[128:131], a[192:195], a[64:67], a[128:131]
ds_read_b64_tr_b16 a[208:209], v26 offset:49152
ds_read_b64_tr_b16 a[210:211], v26 offset:50176
v_mfma_f32_16x16x32_bf16 a[128:131], a[196:199], a[68:71], a[128:131]
ds_read_b64_tr_b16 a[212:213], v26 offset:57344
ds_read_b64_tr_b16 a[214:215], v26 offset:58368
v_mfma_f32_16x16x32_bf16 a[132:135], a[196:199], a[76:79], a[132:135]
buffer_load_dwordx4 a[36:39], v16, s[4:7], s63 offen offset:1024 sc1
v_mfma_f32_16x16x32_bf16 a[132:135], a[192:195], a[72:75], a[132:135]
v_mfma_f32_16x16x32_bf16 a[136:139], a[192:195], a[80:83], a[136:139]
v_mfma_f32_16x16x32_bf16 a[136:139], a[196:199], a[84:87], a[136:139]
s_add_u32 s62, s60, 1024
buffer_store_dwordx4 v[76:79], v1, s[4:7], s62 offen sc1
v_mfma_f32_16x16x32_bf16 a[140:143], a[196:199], a[92:95], a[140:143]
v_mfma_f32_16x16x32_bf16 a[140:143], a[192:195], a[88:91], a[140:143]
s_waitcnt lgkmcnt(4)
v_mfma_f32_16x16x32_bf16 a[144:147], a[200:203], a[64:67], a[144:147]
ds_read_b64_tr_b16 a[192:193], v27 offset:49152
ds_read_b64_tr_b16 a[194:195], v27 offset:50176
v_mfma_f32_16x16x32_bf16 a[144:147], a[204:207], a[68:71], a[144:147]
ds_read_b64_tr_b16 a[196:197], v27 offset:57344
ds_read_b64_tr_b16 a[198:199], v27 offset:58368
v_mfma_f32_16x16x32_bf16 a[148:151], a[204:207], a[76:79], a[148:151]
buffer_load_dwordx4 a[40:43], v17, s[4:7], s63 offen offset:0 sc1
v_mfma_f32_16x16x32_bf16 a[148:151], a[200:203], a[72:75], a[148:151]
v_mfma_f32_16x16x32_bf16 a[152:155], a[200:203], a[80:83], a[152:155]
v_mfma_f32_16x16x32_bf16 a[152:155], a[204:207], a[84:87], a[152:155]
s_add_u32 s62, s60, 17408
buffer_store_dwordx4 v[80:83], v1, s[4:7], s62 offen sc1
v_mfma_f32_16x16x32_bf16 a[156:159], a[204:207], a[92:95], a[156:159]
v_mfma_f32_16x16x32_bf16 a[156:159], a[200:203], a[88:91], a[156:159]
s_waitcnt lgkmcnt(4)
v_mfma_f32_16x16x32_bf16 a[160:163], a[208:211], a[64:67], a[160:163]
ds_read_b64_tr_b16 a[200:201], v28 offset:49152
ds_read_b64_tr_b16 a[202:203], v28 offset:50176
v_mfma_f32_16x16x32_bf16 a[160:163], a[212:215], a[68:71], a[160:163]
ds_read_b64_tr_b16 a[204:205], v28 offset:57344
ds_read_b64_tr_b16 a[206:207], v28 offset:58368
v_mfma_f32_16x16x32_bf16 a[164:167], a[212:215], a[76:79], a[164:167]
buffer_load_dwordx4 a[44:47], v17, s[4:7], s63 offen offset:1024 sc1
v_mfma_f32_16x16x32_bf16 a[164:167], a[208:211], a[72:75], a[164:167]
v_mfma_f32_16x16x32_bf16 a[168:171], a[208:211], a[80:83], a[168:171]
v_mfma_f32_16x16x32_bf16 a[168:171], a[212:215], a[84:87], a[168:171]
s_add_u32 s62, s60, 5120
buffer_store_dwordx4 v[84:87], v1, s[4:7], s62 offen sc1
v_mfma_f32_16x16x32_bf16 a[172:175], a[212:215], a[92:95], a[172:175]
v_mfma_f32_16x16x32_bf16 a[172:175], a[208:211], a[88:91], a[172:175]
s_waitcnt lgkmcnt(4)
v_mfma_f32_16x16x32_bf16 a[176:179], a[192:195], a[64:67], a[176:179]
ds_read_b64_tr_b16 a[208:209], v29 offset:49152
ds_read_b64_tr_b16 a[210:211], v29 offset:50176
v_mfma_f32_16x16x32_bf16 a[176:179], a[196:199], a[68:71], a[176:179]
ds_read_b64_tr_b16 a[212:213], v29 offset:57344
ds_read_b64_tr_b16 a[214:215], v29 offset:58368
v_mfma_f32_16x16x32_bf16 a[180:183], a[196:199], a[76:79], a[180:183]
buffer_load_dwordx4 a[48:51], v18, s[4:7], s63 offen offset:0 sc1
v_mfma_f32_16x16x32_bf16 a[180:183], a[192:195], a[72:75], a[180:183]
v_mfma_f32_16x16x32_bf16 a[184:187], a[192:195], a[80:83], a[184:187]
v_mfma_f32_16x16x32_bf16 a[184:187], a[196:199], a[84:87], a[184:187]
s_add_u32 s62, s60, 21504
buffer_store_dwordx4 v[88:91], v1, s[4:7], s62 offen sc1
v_mfma_f32_16x16x32_bf16 a[188:191], a[196:199], a[92:95], a[188:191]
v_mfma_f32_16x16x32_bf16 a[188:191], a[192:195], a[88:91], a[188:191]
s_waitcnt lgkmcnt(4)
v_mfma_f32_16x16x32_bf16 a[216:219], a[200:203], a[64:67], a[216:219]
v_mfma_f32_16x16x32_bf16 a[216:219], a[204:207], a[68:71], a[216:219]
buffer_load_dwordx4 a[52:55], v18, s[4:7], s63 offen offset:1024 sc1
v_mfma_f32_16x16x32_bf16 a[220:223], a[204:207], a[76:79], a[220:223]
v_mfma_f32_16x16x32_bf16 a[220:223], a[200:203], a[72:75], a[220:223]
v_mfma_f32_16x16x32_bf16 a[224:227], a[200:203], a[80:83], a[224:227]
s_waitcnt vmcnt(28) lgkmcnt(0)
s_barrier
ds_read_b64_tr_b16 a[192:193], v22 offset:0
v_mfma_f32_16x16x32_bf16 a[224:227], a[204:207], a[84:87], a[224:227]
ds_read_b64_tr_b16 a[194:195], v22 offset:1024
ds_read_b64_tr_b16 a[196:197], v22 offset:8192
v_mfma_f32_16x16x32_bf16 a[228:231], a[204:207], a[92:95], a[228:231]
ds_read_b64_tr_b16 a[198:199], v22 offset:9216
v_mfma_f32_16x16x32_bf16 a[228:231], a[200:203], a[88:91], a[228:231]
buffer_load_dwordx4 a[56:59], v19, s[4:7], s63 offen offset:0 sc1
v_mfma_f32_16x16x32_bf16 a[232:235], a[208:211], a[64:67], a[232:235]
ds_read_b64_tr_b16 a[200:201], v23 offset:0
ds_read_b64_tr_b16 a[202:203], v23 offset:1024
v_mfma_f32_16x16x32_bf16 a[232:235], a[212:215], a[68:71], a[232:235]
ds_read_b64_tr_b16 a[204:205], v23 offset:8192
ds_read_b64_tr_b16 a[206:207], v23 offset:9216
v_mfma_f32_16x16x32_bf16 a[236:239], a[212:215], a[76:79], a[236:239]
buffer_load_dwordx4 a[60:63], v19, s[4:7], s63 offen offset:1024 sc1
v_mfma_f32_16x16x32_bf16 a[236:239], a[208:211], a[72:75], a[236:239]
v_mfma_f32_16x16x32_bf16 a[240:243], a[208:211], a[80:83], a[240:243]
v_mfma_f32_16x16x32_bf16 a[240:243], a[212:215], a[84:87], a[240:243]
s_add_u32 m0, s65, 49152
s_add_u32 s3, s93, 5
s_and_b32 s3, s3, 7
v_mfma_f32_16x16x32_bf16 a[244:247], a[212:215], a[92:95], a[244:247]
s_xor_b32 s3, s3, s94
s_lshl_b32 s3, s3, 19
v_mfma_f32_16x16x32_bf16 a[244:247], a[208:211], a[88:91], a[244:247]
s_waitcnt vmcnt(29) lgkmcnt(4)
buffer_load_dwordx4 v12, s[16:19], s3 offen offset:0 lds
v_mfma_f32_16x16x32_bf16 a[96:99], a[192:195], a[0:3], a[96:99]
s_waitcnt vmcnt(28)
ds_read_b64_tr_b16 a[208:209], v24 offset:0
ds_read_b64_tr_b16 a[210:211], v24 offset:1024
v_mfma_f32_16x16x32_bf16 a[96:99], a[196:199], a[4:7], a[96:99]
s_waitcnt vmcnt(24)
ds_read_b64_tr_b16 a[212:213], v24 offset:8192
ds_read_b64_tr_b16 a[214:215], v24 offset:9216
v_mfma_f32_16x16x32_bf16 a[100:103], a[196:199], a[12:15], a[100:103]
buffer_load_dwordx4 v13, s[16:19], s3 offen offset:1024 lds
v_mfma_f32_16x16x32_bf16 a[100:103], a[192:195], a[8:11], a[100:103]
s_waitcnt vmcnt(23)
v_mfma_f32_16x16x32_bf16 a[104:107], a[192:195], a[16:19], a[104:107]
s_waitcnt vmcnt(21)
v_mfma_f32_16x16x32_bf16 a[104:107], a[196:199], a[20:23], a[104:107]
s_waitcnt vmcnt(19)
buffer_load_dwordx4 v14, s[16:19], s3 offen offset:2048 lds
v_mfma_f32_16x16x32_bf16 a[108:111], a[196:199], a[28:31], a[108:111]
v_mfma_f32_16x16x32_bf16 a[108:111], a[192:195], a[24:27], a[108:111]
s_waitcnt lgkmcnt(4)
v_mfma_f32_16x16x32_bf16 a[112:115], a[200:203], a[0:3], a[112:115]
ds_read_b64_tr_b16 a[192:193], v25 offset:0
ds_read_b64_tr_b16 a[194:195], v25 offset:1024
v_mfma_f32_16x16x32_bf16 a[112:115], a[204:207], a[4:7], a[112:115]
ds_read_b64_tr_b16 a[196:197], v25 offset:8192
ds_read_b64_tr_b16 a[198:199], v25 offset:9216
v_mfma_f32_16x16x32_bf16 a[116:119], a[204:207], a[12:15], a[116:119]
buffer_load_dwordx4 v15, s[16:19], s3 offen offset:3072 lds
v_mfma_f32_16x16x32_bf16 a[116:119], a[200:203], a[8:11], a[116:119]
v_mfma_f32_16x16x32_bf16 a[120:123], a[200:203], a[16:19], a[120:123]
v_mfma_f32_16x16x32_bf16 a[120:123], a[204:207], a[20:23], a[120:123]
s_add_u32 s63, s93, 5
s_and_b32 s63, s63, 7
s_xor_b32 s63, s63, s94
v_mfma_f32_16x16x32_bf16 a[124:127], a[204:207], a[28:31], a[124:127]
s_lshl_b32 s63, s63, 11
buffer_load_dwordx4 a[64:67], v16, s[4:7], s63 offen offset:0 sc1
v_mfma_f32_16x16x32_bf16 a[124:127], a[200:203], a[24:27], a[124:127]
s_waitcnt lgkmcnt(4)
v_mfma_f32_16x16x32_bf16 a[128:131], a[208:211], a[0:3], a[128:131]
ds_read_b64_tr_b16 a[200:201], v26 offset:0
ds_read_b64_tr_b16 a[202:203], v26 offset:1024
v_mfma_f32_16x16x32_bf16 a[128:131], a[212:215], a[4:7], a[128:131]
s_add_u32 s62, s60, 9216
ds_read_b64_tr_b16 a[204:205], v26 offset:8192
ds_read_b64_tr_b16 a[206:207], v26 offset:9216
v_mfma_f32_16x16x32_bf16 a[132:135], a[212:215], a[12:15], a[132:135]
buffer_store_dwordx4 v[92:95], v1, s[4:7], s62 offen sc1
v_mfma_f32_16x16x32_bf16 a[132:135], a[208:211], a[8:11], a[132:135]
v_mfma_f32_16x16x32_bf16 a[136:139], a[208:211], a[16:19], a[136:139]
v_mfma_f32_16x16x32_bf16 a[136:139], a[212:215], a[20:23], a[136:139]
buffer_load_dwordx4 a[68:71], v16, s[4:7], s63 offen offset:1024 sc1
v_mfma_f32_16x16x32_bf16 a[140:143], a[212:215], a[28:31], a[140:143]
v_mfma_f32_16x16x32_bf16 a[140:143], a[208:211], a[24:27], a[140:143]
s_waitcnt lgkmcnt(4)
v_mfma_f32_16x16x32_bf16 a[144:147], a[192:195], a[0:3], a[144:147]
ds_read_b64_tr_b16 a[208:209], v27 offset:0
ds_read_b64_tr_b16 a[210:211], v27 offset:1024
v_mfma_f32_16x16x32_bf16 a[144:147], a[196:199], a[4:7], a[144:147]
s_add_u32 s62, s60, 25600
ds_read_b64_tr_b16 a[212:213], v27 offset:8192
ds_read_b64_tr_b16 a[214:215], v27 offset:9216
v_mfma_f32_16x16x32_bf16 a[148:151], a[196:199], a[12:15], a[148:151]
buffer_store_dwordx4 v[96:99], v1, s[4:7], s62 offen sc1
v_mfma_f32_16x16x32_bf16 a[148:151], a[192:195], a[8:11], a[148:151]
v_mfma_f32_16x16x32_bf16 a[152:155], a[192:195], a[16:19], a[152:155]
v_mfma_f32_16x16x32_bf16 a[152:155], a[196:199], a[20:23], a[152:155]
buffer_load_dwordx4 a[72:75], v17, s[4:7], s63 offen offset:0 sc1
v_mfma_f32_16x16x32_bf16 a[156:159], a[196:199], a[28:31], a[156:159]
v_mfma_f32_16x16x32_bf16 a[156:159], a[192:195], a[24:27], a[156:159]
s_waitcnt lgkmcnt(4)
v_mfma_f32_16x16x32_bf16 a[160:163], a[200:203], a[0:3], a[160:163]
ds_read_b64_tr_b16 a[192:193], v28 offset:0
ds_read_b64_tr_b16 a[194:195], v28 offset:1024
v_mfma_f32_16x16x32_bf16 a[160:163], a[204:207], a[4:7], a[160:163]
s_add_u32 s62, s60, 13312
ds_read_b64_tr_b16 a[196:197], v28 offset:8192
ds_read_b64_tr_b16 a[198:199], v28 offset:9216
v_mfma_f32_16x16x32_bf16 a[164:167], a[204:207], a[12:15], a[164:167]
buffer_store_dwordx4 v[100:103], v1, s[4:7], s62 offen sc1
v_mfma_f32_16x16x32_bf16 a[164:167], a[200:203], a[8:11], a[164:167]
v_mfma_f32_16x16x32_bf16 a[168:171], a[200:203], a[16:19], a[168:171]
v_mfma_f32_16x16x32_bf16 a[168:171], a[204:207], a[20:23], a[168:171]
buffer_load_dwordx4 a[76:79], v17, s[4:7], s63 offen offset:1024 sc1
v_mfma_f32_16x16x32_bf16 a[172:175], a[204:207], a[28:31], a[172:175]
v_mfma_f32_16x16x32_bf16 a[172:175], a[200:203], a[24:27], a[172:175]
s_waitcnt lgkmcnt(4)
v_mfma_f32_16x16x32_bf16 a[176:179], a[208:211], a[0:3], a[176:179]
ds_read_b64_tr_b16 a[200:201], v29 offset:0
ds_read_b64_tr_b16 a[202:203], v29 offset:1024
v_mfma_f32_16x16x32_bf16 a[176:179], a[212:215], a[4:7], a[176:179]
s_add_u32 s62, s60, 29696
ds_read_b64_tr_b16 a[204:205], v29 offset:8192
ds_read_b64_tr_b16 a[206:207], v29 offset:9216
v_mfma_f32_16x16x32_bf16 a[180:183], a[212:215], a[12:15], a[180:183]
buffer_store_dwordx4 v[104:107], v1, s[4:7], s62 offen sc1
v_mfma_f32_16x16x32_bf16 a[180:183], a[208:211], a[8:11], a[180:183]
v_mfma_f32_16x16x32_bf16 a[184:187], a[208:211], a[16:19], a[184:187]
v_mfma_f32_16x16x32_bf16 a[184:187], a[212:215], a[20:23], a[184:187]
buffer_load_dwordx4 a[80:83], v18, s[4:7], s63 offen offset:0 sc1
v_mfma_f32_16x16x32_bf16 a[188:191], a[212:215], a[28:31], a[188:191]
v_mfma_f32_16x16x32_bf16 a[188:191], a[208:211], a[24:27], a[188:191]
s_waitcnt lgkmcnt(4)
v_mfma_f32_16x16x32_bf16 a[216:219], a[192:195], a[0:3], a[216:219]
v_mfma_f32_16x16x32_bf16 a[216:219], a[196:199], a[4:7], a[216:219]
s_add_u32 s62, s61, 0
buffer_store_dwordx4 v[108:111], v1, s[4:7], s62 offen sc1
v_mfma_f32_16x16x32_bf16 a[220:223], a[196:199], a[12:15], a[220:223]
v_mfma_f32_16x16x32_bf16 a[220:223], a[192:195], a[8:11], a[220:223]
v_mfma_f32_16x16x32_bf16 a[224:227], a[192:195], a[16:19], a[224:227]
s_waitcnt vmcnt(27) lgkmcnt(0)
s_barrier
ds_read_b64_tr_b16 a[208:209], v22 offset:24576
v_mfma_f32_16x16x32_bf16 a[224:227], a[196:199], a[20:23], a[224:227]
ds_read_b64_tr_b16 a[210:211], v22 offset:25600
ds_read_b64_tr_b16 a[212:213], v22 offset:32768
v_mfma_f32_16x16x32_bf16 a[228:231], a[196:199], a[28:31], a[228:231]
ds_read_b64_tr_b16 a[214:215], v22 offset:33792
v_mfma_f32_16x16x32_bf16 a[228:231], a[192:195], a[24:27], a[228:231]
buffer_load_dwordx4 a[84:87], v18, s[4:7], s63 offen offset:1024 sc1
v_mfma_f32_16x16x32_bf16 a[232:235], a[200:203], a[0:3], a[232:235]
ds_read_b64_tr_b16 a[192:193], v23 offset:24576
ds_read_b64_tr_b16 a[194:195], v23 offset:25600
v_mfma_f32_16x16x32_bf16 a[232:235], a[204:207], a[4:7], a[232:235]
ds_read_b64_tr_b16 a[196:197], v23 offset:32768
ds_read_b64_tr_b16 a[198:199], v23 offset:33792
v_mfma_f32_16x16x32_bf16 a[236:239], a[204:207], a[12:15], a[236:239]
buffer_load_dwordx4 a[88:91], v19, s[4:7], s63 offen offset:0 sc1
v_mfma_f32_16x16x32_bf16 a[236:239], a[200:203], a[8:11], a[236:239]
v_mfma_f32_16x16x32_bf16 a[240:243], a[200:203], a[16:19], a[240:243]
v_mfma_f32_16x16x32_bf16 a[240:243], a[204:207], a[20:23], a[240:243]
buffer_load_dwordx4 a[92:95], v19, s[4:7], s63 offen offset:1024 sc1
v_mfma_f32_16x16x32_bf16 a[244:247], a[204:207], a[28:31], a[244:247]
v_mfma_f32_16x16x32_bf16 a[244:247], a[200:203], a[24:27], a[244:247]
s_waitcnt vmcnt(29) lgkmcnt(5)
v_mfma_f32_16x16x32_bf16 a[96:99], a[208:211], a[32:35], a[96:99]
s_waitcnt vmcnt(27) lgkmcnt(4)
ds_read_b64_tr_b16 a[200:201], v24 offset:24576
ds_read_b64_tr_b16 a[202:203], v24 offset:25600
v_mfma_f32_16x16x32_bf16 a[96:99], a[212:215], a[36:39], a[96:99]
s_waitcnt vmcnt(23)
s_add_u32 m0, s65, 0
ds_read_b64_tr_b16 a[204:205], v24 offset:32768
ds_read_b64_tr_b16 a[206:207], v24 offset:33792
v_mfma_f32_16x16x32_bf16 a[100:103], a[212:215], a[44:47], a[100:103]
s_add_u32 s3, s93, 6
s_and_b32 s3, s3, 7
s_xor_b32 s3, s3, s94
v_mfma_f32_16x16x32_bf16 a[100:103], a[208:211], a[40:43], a[100:103]
s_waitcnt vmcnt(21)
s_lshl_b32 s3, s3, 19
buffer_load_dwordx4 v12, s[16:19], s3 offen offset:0 lds
v_mfma_f32_16x16x32_bf16 a[104:107], a[208:211], a[48:51], a[104:107]
s_waitcnt vmcnt(20)
v_mfma_f32_16x16x32_bf16 a[104:107], a[212:215], a[52:55], a[104:107]
s_waitcnt vmcnt(18)
buffer_load_dwordx4 v13, s[16:19], s3 offen offset:1024 lds
v_mfma_f32_16x16x32_bf16 a[108:111], a[212:215], a[60:63], a[108:111]
v_mfma_f32_16x16x32_bf16 a[108:111], a[208:211], a[56:59], a[108:111]
s_waitcnt lgkmcnt(4)
v_mfma_f32_16x16x32_bf16 a[112:115], a[192:195], a[32:35], a[112:115]
ds_read_b64_tr_b16 a[208:209], v25 offset:24576
ds_read_b64_tr_b16 a[210:211], v25 offset:25600
v_mfma_f32_16x16x32_bf16 a[112:115], a[196:199], a[36:39], a[112:115]
ds_read_b64_tr_b16 a[212:213], v25 offset:32768
ds_read_b64_tr_b16 a[214:215], v25 offset:33792
v_mfma_f32_16x16x32_bf16 a[116:119], a[196:199], a[44:47], a[116:119]
buffer_load_dwordx4 v14, s[16:19], s3 offen offset:2048 lds
v_mfma_f32_16x16x32_bf16 a[116:119], a[192:195], a[40:43], a[116:119]
v_mfma_f32_16x16x32_bf16 a[120:123], a[192:195], a[48:51], a[120:123]
v_mfma_f32_16x16x32_bf16 a[120:123], a[196:199], a[52:55], a[120:123]
buffer_load_dwordx4 v15, s[16:19], s3 offen offset:3072 lds
v_mfma_f32_16x16x32_bf16 a[124:127], a[196:199], a[60:63], a[124:127]
v_mfma_f32_16x16x32_bf16 a[124:127], a[192:195], a[56:59], a[124:127]
s_waitcnt lgkmcnt(4)
v_mfma_f32_16x16x32_bf16 a[128:131], a[200:203], a[32:35], a[128:131]
ds_read_b64_tr_b16 a[192:193], v26 offset:24576
ds_read_b64_tr_b16 a[194:195], v26 offset:25600
v_mfma_f32_16x16x32_bf16 a[128:131], a[204:207], a[36:39], a[128:131]
s_add_u32 s63, s93, 6
ds_read_b64_tr_b16 a[196:197], v26 offset:32768
ds_read_b64_tr_b16 a[198:199], v26 offset:33792
v_mfma_f32_16x16x32_bf16 a[132:135], a[204:207], a[44:47], a[132:135]
s_and_b32 s63, s63, 7
s_xor_b32 s63, s63, s94
s_lshl_b32 s63, s63, 11
v_mfma_f32_16x16x32_bf16 a[132:135], a[200:203], a[40:43], a[132:135]
buffer_load_dwordx4 a[0:3], v16, s[4:7], s63 offen offset:0 sc1
v_mfma_f32_16x16x32_bf16 a[136:139], a[200:203], a[48:51], a[136:139]
v_mfma_f32_16x16x32_bf16 a[136:139], a[204:207], a[52:55], a[136:139]
s_add_u32 s62, s61, 1024
buffer_store_dwordx4 v[112:115], v1, s[4:7], s62 offen sc1
v_mfma_f32_16x16x32_bf16 a[140:143], a[204:207], a[60:63], a[140:143]
v_mfma_f32_16x16x32_bf16 a[140:143], a[200:203], a[56:59], a[140:143]
s_waitcnt lgkmcnt(4)
v_mfma_f32_16x16x32_bf16 a[144:147], a[208:211], a[32:35], a[144:147]
ds_read_b64_tr_b16 a[200:201], v27 offset:24576
ds_read_b64_tr_b16 a[202:203], v27 offset:25600
v_mfma_f32_16x16x32_bf16 a[144:147], a[212:215], a[36:39], a[144:147]
ds_read_b64_tr_b16 a[204:205], v27 offset:32768
ds_read_b64_tr_b16 a[206:207], v27 offset:33792
v_mfma_f32_16x16x32_bf16 a[148:151], a[212:215], a[44:47], a[148:151]
buffer_load_dwordx4 a[4:7], v16, s[4:7], s63 offen offset:1024 sc1
v_mfma_f32_16x16x32_bf16 a[148:151], a[208:211], a[40:43], a[148:151]
v_mfma_f32_16x16x32_bf16 a[152:155], a[208:211], a[48:51], a[152:155]
v_mfma_f32_16x16x32_bf16 a[152:155], a[212:215], a[52:55], a[152:155]
s_add_u32 s62, s61, 16384
buffer_store_dwordx4 v[116:119], v1, s[4:7], s62 offen sc1
v_mfma_f32_16x16x32_bf16 a[156:159], a[212:215], a[60:63], a[156:159]
v_mfma_f32_16x16x32_bf16 a[156:159], a[208:211], a[56:59], a[156:159]
s_waitcnt lgkmcnt(4)
v_mfma_f32_16x16x32_bf16 a[160:163], a[192:195], a[32:35], a[160:163]
ds_read_b64_tr_b16 a[208:209], v28 offset:24576
ds_read_b64_tr_b16 a[210:211], v28 offset:25600
v_mfma_f32_16x16x32_bf16 a[160:163], a[196:199], a[36:39], a[160:163]
ds_read_b64_tr_b16 a[212:213], v28 offset:32768
ds_read_b64_tr_b16 a[214:215], v28 offset:33792
v_mfma_f32_16x16x32_bf16 a[164:167], a[196:199], a[44:47], a[164:167]
buffer_load_dwordx4 a[8:11], v17, s[4:7], s63 offen offset:0 sc1
v_mfma_f32_16x16x32_bf16 a[164:167], a[192:195], a[40:43], a[164:167]
v_mfma_f32_16x16x32_bf16 a[168:171], a[192:195], a[48:51], a[168:171]
v_mfma_f32_16x16x32_bf16 a[168:171], a[196:199], a[52:55], a[168:171]
s_add_u32 s62, s61, 17408
buffer_store_dwordx4 v[120:123], v1, s[4:7], s62 offen sc1
v_mfma_f32_16x16x32_bf16 a[172:175], a[196:199], a[60:63], a[172:175]
v_mfma_f32_16x16x32_bf16 a[172:175], a[192:195], a[56:59], a[172:175]
s_waitcnt lgkmcnt(4)
v_mfma_f32_16x16x32_bf16 a[176:179], a[200:203], a[32:35], a[176:179]
ds_read_b64_tr_b16 a[192:193], v29 offset:24576
ds_read_b64_tr_b16 a[194:195], v29 offset:25600
v_mfma_f32_16x16x32_bf16 a[176:179], a[204:207], a[36:39], a[176:179]
ds_read_b64_tr_b16 a[196:197], v29 offset:32768
ds_read_b64_tr_b16 a[198:199], v29 offset:33792
v_mfma_f32_16x16x32_bf16 a[180:183], a[204:207], a[44:47], a[180:183]
buffer_load_dwordx4 a[12:15], v17, s[4:7], s63 offen offset:1024 sc1
v_mfma_f32_16x16x32_bf16 a[180:183], a[200:203], a[40:43], a[180:183]
v_mfma_f32_16x16x32_bf16 a[184:187], a[200:203], a[48:51], a[184:187]
v_mfma_f32_16x16x32_bf16 a[184:187], a[204:207], a[52:55], a[184:187]
s_add_u32 s62, s61, 2048
buffer_store_dwordx4 v[124:127], v1, s[4:7], s62 offen sc1
v_mfma_f32_16x16x32_bf16 a[188:191], a[204:207], a[60:63], a[188:191]
v_mfma_f32_16x16x32_bf16 a[188:191], a[200:203], a[56:59], a[188:191]
s_waitcnt lgkmcnt(4)
v_mfma_f32_16x16x32_bf16 a[216:219], a[208:211], a[32:35], a[216:219]
v_mfma_f32_16x16x32_bf16 a[216:219], a[212:215], a[36:39], a[216:219]
buffer_load_dwordx4 a[16:19], v18, s[4:7], s63 offen offset:0 sc1
v_mfma_f32_16x16x32_bf16 a[220:223], a[212:215], a[44:47], a[220:223]
v_mfma_f32_16x16x32_bf16 a[220:223], a[208:211], a[40:43], a[220:223]
v_mfma_f32_16x16x32_bf16 a[224:227], a[208:211], a[48:51], a[224:227]
s_waitcnt vmcnt(26) lgkmcnt(0)
s_barrier
ds_read_b64_tr_b16 a[200:201], v22 offset:49152
v_mfma_f32_16x16x32_bf16 a[224:227], a[212:215], a[52:55], a[224:227]
s_add_u32 s62, s61, 3072
ds_read_b64_tr_b16 a[202:203], v22 offset:50176
ds_read_b64_tr_b16 a[204:205], v22 offset:57344
v_mfma_f32_16x16x32_bf16 a[228:231], a[212:215], a[60:63], a[228:231]
ds_read_b64_tr_b16 a[206:207], v22 offset:58368
v_mfma_f32_16x16x32_bf16 a[228:231], a[208:211], a[56:59], a[228:231]
buffer_store_dwordx4 v[128:131], v1, s[4:7], s62 offen sc1
v_mfma_f32_16x16x32_bf16 a[232:235], a[192:195], a[32:35], a[232:235]
ds_read_b64_tr_b16 a[208:209], v23 offset:49152
ds_read_b64_tr_b16 a[210:211], v23 offset:50176
v_mfma_f32_16x16x32_bf16 a[232:235], a[196:199], a[36:39], a[232:235]
ds_read_b64_tr_b16 a[212:213], v23 offset:57344
ds_read_b64_tr_b16 a[214:215], v23 offset:58368
v_mfma_f32_16x16x32_bf16 a[236:239], a[196:199], a[44:47], a[236:239]
buffer_load_dwordx4 a[20:23], v18, s[4:7], s63 offen offset:1024 sc1
v_mfma_f32_16x16x32_bf16 a[236:239], a[192:195], a[40:43], a[236:239]
v_mfma_f32_16x16x32_bf16 a[240:243], a[192:195], a[48:51], a[240:243]
v_mfma_f32_16x16x32_bf16 a[240:243], a[196:199], a[52:55], a[240:243]
buffer_load_dwordx4 a[24:27], v19, s[4:7], s63 offen offset:0 sc1
v_mfma_f32_16x16x32_bf16 a[244:247], a[196:199], a[60:63], a[244:247]
v_mfma_f32_16x16x32_bf16 a[244:247], a[192:195], a[56:59], a[244:247]
s_waitcnt vmcnt(28) lgkmcnt(5)
v_mfma_f32_16x16x32_bf16 a[96:99], a[200:203], a[64:67], a[96:99]
s_waitcnt vmcnt(26) lgkmcnt(4)
ds_read_b64_tr_b16 a[192:193], v24 offset:49152
ds_read_b64_tr_b16 a[194:195], v24 offset:50176
v_mfma_f32_16x16x32_bf16 a[96:99], a[204:207], a[68:71], a[96:99]
s_waitcnt vmcnt(22)
ds_read_b64_tr_b16 a[196:197], v24 offset:57344
ds_read_b64_tr_b16 a[198:199], v24 offset:58368
v_mfma_f32_16x16x32_bf16 a[100:103], a[204:207], a[76:79], a[100:103]
buffer_load_dwordx4 a[28:31], v19, s[4:7], s63 offen offset:1024 sc1
v_mfma_f32_16x16x32_bf16 a[100:103], a[200:203], a[72:75], a[100:103]
s_waitcnt vmcnt(21)
v_mfma_f32_16x16x32_bf16 a[104:107], a[200:203], a[80:83], a[104:107]
s_waitcnt vmcnt(19)
v_mfma_f32_16x16x32_bf16 a[104:107], a[204:207], a[84:87], a[104:107]
s_waitcnt vmcnt(17)
s_add_u32 m0, s65, 24576
s_add_u32 s3, s93, 7
s_and_b32 s3, s3, 7
v_mfma_f32_16x16x32_bf16 a[108:111], a[204:207], a[92:95], a[108:111]
s_xor_b32 s3, s3, s94
s_lshl_b32 s3, s3, 19
v_mfma_f32_16x16x32_bf16 a[108:111], a[200:203], a[88:91], a[108:111]
s_waitcnt lgkmcnt(4)
buffer_load_dwordx4 v12, s[16:19], s3 offen offset:0 lds
v_mfma_f32_16x16x32_bf16 a[112:115], a[208:211], a[64:67], a[112:115]
ds_read_b64_tr_b16 a[200:201], v25 offset:49152
ds_read_b64_tr_b16 a[202:203], v25 offset:50176
v_mfma_f32_16x16x32_bf16 a[112:115], a[212:215], a[68:71], a[112:115]
ds_read_b64_tr_b16 a[204:205], v25 offset:57344
ds_read_b64_tr_b16 a[206:207], v25 offset:58368
v_mfma_f32_16x16x32_bf16 a[116:119], a[212:215], a[76:79], a[116:119]
buffer_load_dwordx4 v13, s[16:19], s3 offen offset:1024 lds
v_mfma_f32_16x16x32_bf16 a[116:119], a[208:211], a[72:75], a[116:119]
v_mfma_f32_16x16x32_bf16 a[120:123], a[208:211], a[80:83], a[120:123]
v_mfma_f32_16x16x32_bf16 a[120:123], a[212:215], a[84:87], a[120:123]
buffer_load_dwordx4 v14, s[16:19], s3 offen offset:2048 lds
v_mfma_f32_16x16x32_bf16 a[124:127], a[212:215], a[92:95], a[124:127]
v_mfma_f32_16x16x32_bf16 a[124:127], a[208:211], a[88:91], a[124:127]
s_waitcnt lgkmcnt(4)
v_mfma_f32_16x16x32_bf16 a[128:131], a[192:195], a[64:67], a[128:131]
ds_read_b64_tr_b16 a[208:209], v26 offset:49152
ds_read_b64_tr_b16 a[210:211], v26 offset:50176
v_mfma_f32_16x16x32_bf16 a[128:131], a[196:199], a[68:71], a[128:131]
ds_read_b64_tr_b16 a[212:213], v26 offset:57344
ds_read_b64_tr_b16 a[214:215], v26 offset:58368
v_mfma_f32_16x16x32_bf16 a[132:135], a[196:199], a[76:79], a[132:135]
buffer_load_dwordx4 v15, s[16:19], s3 offen offset:3072 lds
v_mfma_f32_16x16x32_bf16 a[132:135], a[192:195], a[72:75], a[132:135]
v_mfma_f32_16x16x32_bf16 a[136:139], a[192:195], a[80:83], a[136:139]
v_mfma_f32_16x16x32_bf16 a[136:139], a[196:199], a[84:87], a[136:139]
s_add_u32 s63, s93, 7
s_and_b32 s63, s63, 7
s_xor_b32 s63, s63, s94
v_mfma_f32_16x16x32_bf16 a[140:143], a[196:199], a[92:95], a[140:143]
s_lshl_b32 s63, s63, 11
buffer_load_dwordx4 a[32:35], v16, s[4:7], s63 offen offset:0 sc1
v_mfma_f32_16x16x32_bf16 a[140:143], a[192:195], a[88:91], a[140:143]
s_waitcnt lgkmcnt(4)
v_mfma_f32_16x16x32_bf16 a[144:147], a[200:203], a[64:67], a[144:147]
ds_read_b64_tr_b16 a[192:193], v27 offset:49152
ds_read_b64_tr_b16 a[194:195], v27 offset:50176
v_mfma_f32_16x16x32_bf16 a[144:147], a[204:207], a[68:71], a[144:147]
s_add_u32 s62, s61, 18432
ds_read_b64_tr_b16 a[196:197], v27 offset:57344
ds_read_b64_tr_b16 a[198:199], v27 offset:58368
v_mfma_f32_16x16x32_bf16 a[148:151], a[204:207], a[76:79], a[148:151]
buffer_store_dwordx4 v[132:135], v1, s[4:7], s62 offen sc1
v_mfma_f32_16x16x32_bf16 a[148:151], a[200:203], a[72:75], a[148:151]
v_mfma_f32_16x16x32_bf16 a[152:155], a[200:203], a[80:83], a[152:155]
v_mfma_f32_16x16x32_bf16 a[152:155], a[204:207], a[84:87], a[152:155]
buffer_load_dwordx4 a[36:39], v16, s[4:7], s63 offen offset:1024 sc1
v_mfma_f32_16x16x32_bf16 a[156:159], a[204:207], a[92:95], a[156:159]
v_mfma_f32_16x16x32_bf16 a[156:159], a[200:203], a[88:91], a[156:159]
s_waitcnt lgkmcnt(4)
v_mfma_f32_16x16x32_bf16 a[160:163], a[208:211], a[64:67], a[160:163]
ds_read_b64_tr_b16 a[200:201], v28 offset:49152
ds_read_b64_tr_b16 a[202:203], v28 offset:50176
v_mfma_f32_16x16x32_bf16 a[160:163], a[212:215], a[68:71], a[160:163]
s_add_u32 s62, s61, 19456
ds_read_b64_tr_b16 a[204:205], v28 offset:57344
ds_read_b64_tr_b16 a[206:207], v28 offset:58368
v_mfma_f32_16x16x32_bf16 a[164:167], a[212:215], a[76:79], a[164:167]
buffer_store_dwordx4 v[136:139], v1, s[4:7], s62 offen sc1
v_mfma_f32_16x16x32_bf16 a[164:167], a[208:211], a[72:75], a[164:167]
v_mfma_f32_16x16x32_bf16 a[168:171], a[208:211], a[80:83], a[168:171]
v_mfma_f32_16x16x32_bf16 a[168:171], a[212:215], a[84:87], a[168:171]
buffer_load_dwordx4 a[40:43], v17, s[4:7], s63 offen offset:0 sc1
v_mfma_f32_16x16x32_bf16 a[172:175], a[212:215], a[92:95], a[172:175]
v_mfma_f32_16x16x32_bf16 a[172:175], a[208:211], a[88:91], a[172:175]
s_waitcnt lgkmcnt(4)
v_mfma_f32_16x16x32_bf16 a[176:179], a[192:195], a[64:67], a[176:179]
ds_read_b64_tr_b16 a[208:209], v29 offset:49152
ds_read_b64_tr_b16 a[210:211], v29 offset:50176
v_mfma_f32_16x16x32_bf16 a[176:179], a[196:199], a[68:71], a[176:179]
s_add_u32 s62, s61, 4096
ds_read_b64_tr_b16 a[212:213], v29 offset:57344
ds_read_b64_tr_b16 a[214:215], v29 offset:58368
v_mfma_f32_16x16x32_bf16 a[180:183], a[196:199], a[76:79], a[180:183]
buffer_store_dwordx4 v[140:143], v1, s[4:7], s62 offen sc1
v_mfma_f32_16x16x32_bf16 a[180:183], a[192:195], a[72:75], a[180:183]
v_mfma_f32_16x16x32_bf16 a[184:187], a[192:195], a[80:83], a[184:187]
v_mfma_f32_16x16x32_bf16 a[184:187], a[196:199], a[84:87], a[184:187]
buffer_load_dwordx4 a[44:47], v17, s[4:7], s63 offen offset:1024 sc1
v_mfma_f32_16x16x32_bf16 a[188:191], a[196:199], a[92:95], a[188:191]
v_mfma_f32_16x16x32_bf16 a[188:191], a[192:195], a[88:91], a[188:191]
s_waitcnt lgkmcnt(4)
v_mfma_f32_16x16x32_bf16 a[216:219], a[200:203], a[64:67], a[216:219]
v_mfma_f32_16x16x32_bf16 a[216:219], a[204:207], a[68:71], a[216:219]
s_add_u32 s62, s61, 5120
buffer_store_dwordx4 v[144:147], v1, s[4:7], s62 offen sc1
v_mfma_f32_16x16x32_bf16 a[220:223], a[204:207], a[76:79], a[220:223]
v_mfma_f32_16x16x32_bf16 a[220:223], a[200:203], a[72:75], a[220:223]
v_mfma_f32_16x16x32_bf16 a[224:227], a[200:203], a[80:83], a[224:227]
s_waitcnt vmcnt(25) lgkmcnt(0)
s_barrier
ds_read_b64_tr_b16 a[192:193], v22 offset:0
v_mfma_f32_16x16x32_bf16 a[224:227], a[204:207], a[84:87], a[224:227]
ds_read_b64_tr_b16 a[194:195], v22 offset:1024
ds_read_b64_tr_b16 a[196:197], v22 offset:8192
v_mfma_f32_16x16x32_bf16 a[228:231], a[204:207], a[92:95], a[228:231]
ds_read_b64_tr_b16 a[198:199], v22 offset:9216
v_mfma_f32_16x16x32_bf16 a[228:231], a[200:203], a[88:91], a[228:231]
buffer_load_dwordx4 a[48:51], v18, s[4:7], s63 offen offset:0 sc1
v_mfma_f32_16x16x32_bf16 a[232:235], a[208:211], a[64:67], a[232:235]
ds_read_b64_tr_b16 a[200:201], v23 offset:0
ds_read_b64_tr_b16 a[202:203], v23 offset:1024
v_mfma_f32_16x16x32_bf16 a[232:235], a[212:215], a[68:71], a[232:235]
s_add_u32 s62, s61, 20480
ds_read_b64_tr_b16 a[204:205], v23 offset:8192
ds_read_b64_tr_b16 a[206:207], v23 offset:9216
v_mfma_f32_16x16x32_bf16 a[236:239], a[212:215], a[76:79], a[236:239]
buffer_store_dwordx4 v[148:151], v1, s[4:7], s62 offen sc1
v_mfma_f32_16x16x32_bf16 a[236:239], a[208:211], a[72:75], a[236:239]
v_mfma_f32_16x16x32_bf16 a[240:243], a[208:211], a[80:83], a[240:243]
v_mfma_f32_16x16x32_bf16 a[240:243], a[212:215], a[84:87], a[240:243]
buffer_load_dwordx4 a[52:55], v18, s[4:7], s63 offen offset:1024 sc1
v_mfma_f32_16x16x32_bf16 a[244:247], a[212:215], a[92:95], a[244:247]
v_mfma_f32_16x16x32_bf16 a[244:247], a[208:211], a[88:91], a[244:247]
s_waitcnt vmcnt(27) lgkmcnt(4)
v_mfma_f32_16x16x32_bf16 a[96:99], a[192:195], a[0:3], a[96:99]
s_waitcnt vmcnt(25)
ds_read_b64_tr_b16 a[208:209], v24 offset:0
ds_read_b64_tr_b16 a[210:211], v24 offset:1024
v_mfma_f32_16x16x32_bf16 a[96:99], a[196:199], a[4:7], a[96:99]
s_waitcnt vmcnt(21)
ds_read_b64_tr_b16 a[212:213], v24 offset:8192
ds_read_b64_tr_b16 a[214:215], v24 offset:9216
v_mfma_f32_16x16x32_bf16 a[100:103], a[196:199], a[12:15], a[100:103]
buffer_load_dwordx4 a[56:59], v19, s[4:7], s63 offen offset:0 sc1
v_mfma_f32_16x16x32_bf16 a[100:103], a[192:195], a[8:11], a[100:103]
s_waitcnt vmcnt(20)
v_mfma_f32_16x16x32_bf16 a[104:107], a[192:195], a[16:19], a[104:107]
s_waitcnt vmcnt(18)
v_mfma_f32_16x16x32_bf16 a[104:107], a[196:199], a[20:23], a[104:107]
s_waitcnt vmcnt(16)
buffer_load_dwordx4 a[60:63], v19, s[4:7], s63 offen offset:1024 sc1
v_mfma_f32_16x16x32_bf16 a[108:111], a[196:199], a[28:31], a[108:111]
v_mfma_f32_16x16x32_bf16 a[108:111], a[192:195], a[24:27], a[108:111]
s_waitcnt lgkmcnt(4)
v_mfma_f32_16x16x32_bf16 a[112:115], a[200:203], a[0:3], a[112:115]
ds_read_b64_tr_b16 a[192:193], v25 offset:0
ds_read_b64_tr_b16 a[194:195], v25 offset:1024
v_mfma_f32_16x16x32_bf16 a[112:115], a[204:207], a[4:7], a[112:115]
s_add_u32 m0, s65, 49152
ds_read_b64_tr_b16 a[196:197], v25 offset:8192
ds_read_b64_tr_b16 a[198:199], v25 offset:9216
v_mfma_f32_16x16x32_bf16 a[116:119], a[204:207], a[12:15], a[116:119]
s_and_b32 s3, s94, 1
s_xor_b32 s3, s3, 8
s_lshl_b32 s3, s3, 19
v_mfma_f32_16x16x32_bf16 a[116:119], a[200:203], a[8:11], a[116:119]
buffer_load_dwordx4 v12, s[16:19], s3 offen offset:0 lds
v_mfma_f32_16x16x32_bf16 a[120:123], a[200:203], a[16:19], a[120:123]
v_mfma_f32_16x16x32_bf16 a[120:123], a[204:207], a[20:23], a[120:123]
buffer_load_dwordx4 v13, s[16:19], s3 offen offset:1024 lds
v_mfma_f32_16x16x32_bf16 a[124:127], a[204:207], a[28:31], a[124:127]
v_mfma_f32_16x16x32_bf16 a[124:127], a[200:203], a[24:27], a[124:127]
s_waitcnt lgkmcnt(4)
v_mfma_f32_16x16x32_bf16 a[128:131], a[208:211], a[0:3], a[128:131]
ds_read_b64_tr_b16 a[200:201], v26 offset:0
ds_read_b64_tr_b16 a[202:203], v26 offset:1024
v_mfma_f32_16x16x32_bf16 a[128:131], a[212:215], a[4:7], a[128:131]
ds_read_b64_tr_b16 a[204:205], v26 offset:8192
ds_read_b64_tr_b16 a[206:207], v26 offset:9216
v_mfma_f32_16x16x32_bf16 a[132:135], a[212:215], a[12:15], a[132:135]
buffer_load_dwordx4 v14, s[16:19], s3 offen offset:2048 lds
v_mfma_f32_16x16x32_bf16 a[132:135], a[208:211], a[8:11], a[132:135]
v_mfma_f32_16x16x32_bf16 a[136:139], a[208:211], a[16:19], a[136:139]
v_mfma_f32_16x16x32_bf16 a[136:139], a[212:215], a[20:23], a[136:139]
buffer_load_dwordx4 v15, s[16:19], s3 offen offset:3072 lds
v_mfma_f32_16x16x32_bf16 a[140:143], a[212:215], a[28:31], a[140:143]
v_mfma_f32_16x16x32_bf16 a[140:143], a[208:211], a[24:27], a[140:143]
s_waitcnt lgkmcnt(4)
v_mfma_f32_16x16x32_bf16 a[144:147], a[192:195], a[0:3], a[144:147]
ds_read_b64_tr_b16 a[208:209], v27 offset:0
ds_read_b64_tr_b16 a[210:211], v27 offset:1024
v_mfma_f32_16x16x32_bf16 a[144:147], a[196:199], a[4:7], a[144:147]
s_and_b32 s63, s94, 1
ds_read_b64_tr_b16 a[212:213], v27 offset:8192
ds_read_b64_tr_b16 a[214:215], v27 offset:9216
v_mfma_f32_16x16x32_bf16 a[148:151], a[196:199], a[12:15], a[148:151]
s_xor_b32 s63, s63, 8
s_lshl_b32 s63, s63, 11
v_mfma_f32_16x16x32_bf16 a[148:151], a[192:195], a[8:11], a[148:151]
buffer_load_dwordx4 a[64:67], v16, s[4:7], s63 offen offset:0 sc1
v_mfma_f32_16x16x32_bf16 a[152:155], a[192:195], a[16:19], a[152:155]
v_mfma_f32_16x16x32_bf16 a[152:155], a[196:199], a[20:23], a[152:155]
s_add_u32 s62, s61, 21504
buffer_store_dwordx4 v[152:155], v1, s[4:7], s62 offen sc1
v_mfma_f32_16x16x32_bf16 a[156:159], a[196:199], a[28:31], a[156:159]
v_mfma_f32_16x16x32_bf16 a[156:159], a[192:195], a[24:27], a[156:159]
s_waitcnt lgkmcnt(4)
v_mfma_f32_16x16x32_bf16 a[160:163], a[200:203], a[0:3], a[160:163]
ds_read_b64_tr_b16 a[192:193], v28 offset:0
ds_read_b64_tr_b16 a[194:195], v28 offset:1024
v_mfma_f32_16x16x32_bf16 a[160:163], a[204:207], a[4:7], a[160:163]
ds_read_b64_tr_b16 a[196:197], v28 offset:8192
ds_read_b64_tr_b16 a[198:199], v28 offset:9216
v_mfma_f32_16x16x32_bf16 a[164:167], a[204:207], a[12:15], a[164:167]
buffer_load_dwordx4 a[68:71], v16, s[4:7], s63 offen offset:1024 sc1
v_mfma_f32_16x16x32_bf16 a[164:167], a[200:203], a[8:11], a[164:167]
v_mfma_f32_16x16x32_bf16 a[168:171], a[200:203], a[16:19], a[168:171]
v_mfma_f32_16x16x32_bf16 a[168:171], a[204:207], a[20:23], a[168:171]
s_add_u32 s62, s61, 6144
buffer_store_dwordx4 v[156:159], v1, s[4:7], s62 offen sc1
v_mfma_f32_16x16x32_bf16 a[172:175], a[204:207], a[28:31], a[172:175]
v_mfma_f32_16x16x32_bf16 a[172:175], a[200:203], a[24:27], a[172:175]
s_waitcnt lgkmcnt(4)
v_mfma_f32_16x16x32_bf16 a[176:179], a[208:211], a[0:3], a[176:179]
ds_read_b64_tr_b16 a[200:201], v29 offset:0
ds_read_b64_tr_b16 a[202:203], v29 offset:1024
v_mfma_f32_16x16x32_bf16 a[176:179], a[212:215], a[4:7], a[176:179]
ds_read_b64_tr_b16 a[204:205], v29 offset:8192
ds_read_b64_tr_b16 a[206:207], v29 offset:9216
v_mfma_f32_16x16x32_bf16 a[180:183], a[212:215], a[12:15], a[180:183]
buffer_load_dwordx4 a[72:75], v17, s[4:7], s63 offen offset:0 sc1
v_mfma_f32_16x16x32_bf16 a[180:183], a[208:211], a[8:11], a[180:183]
v_mfma_f32_16x16x32_bf16 a[184:187], a[208:211], a[16:19], a[184:187]
v_mfma_f32_16x16x32_bf16 a[184:187], a[212:215], a[20:23], a[184:187]
s_add_u32 s62, s61, 7168
buffer_store_dwordx4 v[160:163], v1, s[4:7], s62 offen sc1
v_mfma_f32_16x16x32_bf16 a[188:191], a[212:215], a[28:31], a[188:191]
v_mfma_f32_16x16x32_bf16 a[188:191], a[208:211], a[24:27], a[188:191]
s_waitcnt lgkmcnt(4)
v_mfma_f32_16x16x32_bf16 a[216:219], a[192:195], a[0:3], a[216:219]
v_mfma_f32_16x16x32_bf16 a[216:219], a[196:199], a[4:7], a[216:219]
buffer_load_dwordx4 a[76:79], v17, s[4:7], s63 offen offset:1024 sc1
v_mfma_f32_16x16x32_bf16 a[220:223], a[196:199], a[12:15], a[220:223]
v_mfma_f32_16x16x32_bf16 a[220:223], a[192:195], a[8:11], a[220:223]
v_mfma_f32_16x16x32_bf16 a[224:227], a[192:195], a[16:19], a[224:227]
s_waitcnt vmcnt(24) lgkmcnt(0)
s_barrier
ds_read_b64_tr_b16 a[208:209], v22 offset:24576
v_mfma_f32_16x16x32_bf16 a[224:227], a[196:199], a[20:23], a[224:227]
s_add_u32 s62, s61, 22528
ds_read_b64_tr_b16 a[210:211], v22 offset:25600
ds_read_b64_tr_b16 a[212:213], v22 offset:32768
v_mfma_f32_16x16x32_bf16 a[228:231], a[196:199], a[28:31], a[228:231]
ds_read_b64_tr_b16 a[214:215], v22 offset:33792
v_mfma_f32_16x16x32_bf16 a[228:231], a[192:195], a[24:27], a[228:231]
buffer_store_dwordx4 v[164:167], v1, s[4:7], s62 offen sc1
v_mfma_f32_16x16x32_bf16 a[232:235], a[200:203], a[0:3], a[232:235]
ds_read_b64_tr_b16 a[192:193], v23 offset:24576
ds_read_b64_tr_b16 a[194:195], v23 offset:25600
v_mfma_f32_16x16x32_bf16 a[232:235], a[204:207], a[4:7], a[232:235]
ds_read_b64_tr_b16 a[196:197], v23 offset:32768
ds_read_b64_tr_b16 a[198:199], v23 offset:33792
v_mfma_f32_16x16x32_bf16 a[236:239], a[204:207], a[12:15], a[236:239]
buffer_load_dwordx4 a[80:83], v18, s[4:7], s63 offen offset:0 sc1
v_mfma_f32_16x16x32_bf16 a[236:239], a[200:203], a[8:11], a[236:239]
v_mfma_f32_16x16x32_bf16 a[240:243], a[200:203], a[16:19], a[240:243]
v_mfma_f32_16x16x32_bf16 a[240:243], a[204:207], a[20:23], a[240:243]
s_add_u32 s62, s61, 23552
buffer_store_dwordx4 v[168:171], v1, s[4:7], s62 offen sc1
v_mfma_f32_16x16x32_bf16 a[244:247], a[204:207], a[28:31], a[244:247]
v_mfma_f32_16x16x32_bf16 a[244:247], a[200:203], a[24:27], a[244:247]
s_waitcnt vmcnt(26) lgkmcnt(4)
v_mfma_f32_16x16x32_bf16 a[96:99], a[208:211], a[32:35], a[96:99]
s_waitcnt vmcnt(24)
ds_read_b64_tr_b16 a[200:201], v24 offset:24576
ds_read_b64_tr_b16 a[202:203], v24 offset:25600
v_mfma_f32_16x16x32_bf16 a[96:99], a[212:215], a[36:39], a[96:99]
s_waitcnt vmcnt(20)
ds_read_b64_tr_b16 a[204:205], v24 offset:32768
ds_read_b64_tr_b16 a[206:207], v24 offset:33792
v_mfma_f32_16x16x32_bf16 a[100:103], a[212:215], a[44:47], a[100:103]
buffer_load_dwordx4 a[84:87], v18, s[4:7], s63 offen offset:1024 sc1
v_mfma_f32_16x16x32_bf16 a[100:103], a[208:211], a[40:43], a[100:103]
s_waitcnt vmcnt(19)
v_mfma_f32_16x16x32_bf16 a[104:107], a[208:211], a[48:51], a[104:107]
s_waitcnt vmcnt(17)
v_mfma_f32_16x16x32_bf16 a[104:107], a[212:215], a[52:55], a[104:107]
s_waitcnt vmcnt(15)
buffer_load_dwordx4 a[88:91], v19, s[4:7], s63 offen offset:0 sc1
v_mfma_f32_16x16x32_bf16 a[108:111], a[212:215], a[60:63], a[108:111]
v_mfma_f32_16x16x32_bf16 a[108:111], a[208:211], a[56:59], a[108:111]
s_waitcnt lgkmcnt(4)
v_accvgpr_read_b32 v44, a96
v_accvgpr_read_b32 v45, a97
v_mfma_f32_16x16x32_bf16 a[112:115], a[192:195], a[32:35], a[112:115]
ds_read_b64_tr_b16 a[208:209], v25 offset:24576
ds_read_b64_tr_b16 a[210:211], v25 offset:25600
v_mfma_f32_16x16x32_bf16 a[112:115], a[196:199], a[36:39], a[112:115]
ds_read_b64_tr_b16 a[212:213], v25 offset:32768
ds_read_b64_tr_b16 a[214:215], v25 offset:33792
v_mfma_f32_16x16x32_bf16 a[116:119], a[196:199], a[44:47], a[116:119]
buffer_load_dwordx4 a[92:95], v19, s[4:7], s63 offen offset:1024 sc1
v_mfma_f32_16x16x32_bf16 a[116:119], a[192:195], a[40:43], a[116:119]
v_accvgpr_read_b32 v46, a98
v_accvgpr_read_b32 v47, a99
v_mfma_f32_16x16x32_bf16 a[120:123], a[192:195], a[48:51], a[120:123]
v_accvgpr_read_b32 v48, a100
v_accvgpr_read_b32 v49, a101
v_mfma_f32_16x16x32_bf16 a[120:123], a[196:199], a[52:55], a[120:123]
s_add_u32 m0, s65, 0
s_and_b32 s3, s94, 1
s_xor_b32 s3, s3, 9
v_mfma_f32_16x16x32_bf16 a[124:127], a[196:199], a[60:63], a[124:127]
s_lshl_b32 s3, s3, 19
buffer_load_dwordx4 v12, s[16:19], s3 offen offset:0 lds
v_mfma_f32_16x16x32_bf16 a[124:127], a[192:195], a[56:59], a[124:127]
s_waitcnt lgkmcnt(4)
v_accvgpr_read_b32 v50, a102
v_accvgpr_read_b32 v51, a103
v_mfma_f32_16x16x32_bf16 a[128:131], a[200:203], a[32:35], a[128:131]
ds_read_b64_tr_b16 a[192:193], v26 offset:24576
ds_read_b64_tr_b16 a[194:195], v26 offset:25600
v_mfma_f32_16x16x32_bf16 a[128:131], a[204:207], a[36:39], a[128:131]
ds_read_b64_tr_b16 a[196:197], v26 offset:32768
ds_read_b64_tr_b16 a[198:199], v26 offset:33792
v_mfma_f32_16x16x32_bf16 a[132:135], a[204:207], a[44:47], a[132:135]
buffer_load_dwordx4 v13, s[16:19], s3 offen offset:1024 lds
v_mfma_f32_16x16x32_bf16 a[132:135], a[200:203], a[40:43], a[132:135]
v_accvgpr_read_b32 v52, a104
v_accvgpr_read_b32 v53, a105
v_mfma_f32_16x16x32_bf16 a[136:139], a[200:203], a[48:51], a[136:139]
v_accvgpr_read_b32 v54, a106
v_accvgpr_read_b32 v55, a107
v_mfma_f32_16x16x32_bf16 a[136:139], a[204:207], a[52:55], a[136:139]
buffer_load_dwordx4 v14, s[16:19], s3 offen offset:2048 lds
v_mfma_f32_16x16x32_bf16 a[140:143], a[204:207], a[60:63], a[140:143]
v_accvgpr_read_b32 v56, a108
v_accvgpr_read_b32 v57, a109
v_mfma_f32_16x16x32_bf16 a[140:143], a[200:203], a[56:59], a[140:143]
s_waitcnt lgkmcnt(4)
v_accvgpr_read_b32 v58, a110
v_accvgpr_read_b32 v59, a111
v_mfma_f32_16x16x32_bf16 a[144:147], a[208:211], a[32:35], a[144:147]
ds_read_b64_tr_b16 a[200:201], v27 offset:24576
ds_read_b64_tr_b16 a[202:203], v27 offset:25600
v_mfma_f32_16x16x32_bf16 a[144:147], a[212:215], a[36:39], a[144:147]
ds_read_b64_tr_b16 a[204:205], v27 offset:32768
ds_read_b64_tr_b16 a[206:207], v27 offset:33792
v_mfma_f32_16x16x32_bf16 a[148:151], a[212:215], a[44:47], a[148:151]
buffer_load_dwordx4 v15, s[16:19], s3 offen offset:3072 lds
v_mfma_f32_16x16x32_bf16 a[148:151], a[208:211], a[40:43], a[148:151]
v_accvgpr_read_b32 v60, a112
v_accvgpr_read_b32 v61, a113
v_mfma_f32_16x16x32_bf16 a[152:155], a[208:211], a[48:51], a[152:155]
v_accvgpr_read_b32 v62, a114
v_accvgpr_read_b32 v63, a115
v_mfma_f32_16x16x32_bf16 a[152:155], a[212:215], a[52:55], a[152:155]
s_and_b32 s63, s94, 1
s_xor_b32 s63, s63, 9
s_lshl_b32 s63, s63, 11
v_mfma_f32_16x16x32_bf16 a[156:159], a[212:215], a[60:63], a[156:159]
buffer_load_dwordx4 a[0:3], v16, s[4:7], s63 offen offset:0 sc1
v_mfma_f32_16x16x32_bf16 a[156:159], a[208:211], a[56:59], a[156:159]
s_waitcnt lgkmcnt(4)
v_accvgpr_read_b32 v64, a116
v_accvgpr_read_b32 v65, a117
v_mfma_f32_16x16x32_bf16 a[160:163], a[192:195], a[32:35], a[160:163]
ds_read_b64_tr_b16 a[208:209], v28 offset:24576
ds_read_b64_tr_b16 a[210:211], v28 offset:25600
v_mfma_f32_16x16x32_bf16 a[160:163], a[196:199], a[36:39], a[160:163]
ds_read_b64_tr_b16 a[212:213], v28 offset:32768
ds_read_b64_tr_b16 a[214:215], v28 offset:33792
v_mfma_f32_16x16x32_bf16 a[164:167], a[196:199], a[44:47], a[164:167]
buffer_load_dwordx4 a[4:7], v16, s[4:7], s63 offen offset:1024 sc1
v_mfma_f32_16x16x32_bf16 a[164:167], a[192:195], a[40:43], a[164:167]
v_accvgpr_read_b32 v66, a118
v_accvgpr_read_b32 v67, a119
v_mfma_f32_16x16x32_bf16 a[168:171], a[192:195], a[48:51], a[168:171]
v_accvgpr_read_b32 v68, a120
v_accvgpr_read_b32 v69, a121
v_mfma_f32_16x16x32_bf16 a[168:171], a[196:199], a[52:55], a[168:171]
buffer_load_dwordx4 a[8:11], v17, s[4:7], s63 offen offset:0 sc1
v_mfma_f32_16x16x32_bf16 a[172:175], a[196:199], a[60:63], a[172:175]
v_accvgpr_read_b32 v70, a122
v_accvgpr_read_b32 v71, a123
v_mfma_f32_16x16x32_bf16 a[172:175], a[192:195], a[56:59], a[172:175]
s_waitcnt lgkmcnt(4)
v_accvgpr_read_b32 v72, a124
v_accvgpr_read_b32 v73, a125
v_mfma_f32_16x16x32_bf16 a[176:179], a[200:203], a[32:35], a[176:179]
ds_read_b64_tr_b16 a[192:193], v29 offset:24576
ds_read_b64_tr_b16 a[194:195], v29 offset:25600
v_mfma_f32_16x16x32_bf16 a[176:179], a[204:207], a[36:39], a[176:179]
ds_read_b64_tr_b16 a[196:197], v29 offset:32768
ds_read_b64_tr_b16 a[198:199], v29 offset:33792
v_mfma_f32_16x16x32_bf16 a[180:183], a[204:207], a[44:47], a[180:183]
buffer_load_dwordx4 a[12:15], v17, s[4:7], s63 offen offset:1024 sc1
v_mfma_f32_16x16x32_bf16 a[180:183], a[200:203], a[40:43], a[180:183]
v_accvgpr_read_b32 v74, a126
v_accvgpr_read_b32 v75, a127
v_mfma_f32_16x16x32_bf16 a[184:187], a[200:203], a[48:51], a[184:187]
v_accvgpr_read_b32 v76, a128
v_accvgpr_read_b32 v77, a129
v_mfma_f32_16x16x32_bf16 a[184:187], a[204:207], a[52:55], a[184:187]
buffer_load_dwordx4 a[16:19], v18, s[4:7], s63 offen offset:0 sc1
v_mfma_f32_16x16x32_bf16 a[188:191], a[204:207], a[60:63], a[188:191]
v_accvgpr_read_b32 v78, a130
v_accvgpr_read_b32 v79, a131
v_mfma_f32_16x16x32_bf16 a[188:191], a[200:203], a[56:59], a[188:191]
s_waitcnt lgkmcnt(4)
v_accvgpr_read_b32 v80, a132
v_accvgpr_read_b32 v81, a133
v_mfma_f32_16x16x32_bf16 a[216:219], a[208:211], a[32:35], a[216:219]
v_accvgpr_read_b32 v82, a134
v_accvgpr_read_b32 v83, a135
v_mfma_f32_16x16x32_bf16 a[216:219], a[212:215], a[36:39], a[216:219]
buffer_load_dwordx4 a[20:23], v18, s[4:7], s63 offen offset:1024 sc1
v_mfma_f32_16x16x32_bf16 a[220:223], a[212:215], a[44:47], a[220:223]
v_accvgpr_read_b32 v84, a136
v_accvgpr_read_b32 v85, a137
v_mfma_f32_16x16x32_bf16 a[220:223], a[208:211], a[40:43], a[220:223]
v_accvgpr_read_b32 v86, a138
v_accvgpr_read_b32 v87, a139
v_mfma_f32_16x16x32_bf16 a[224:227], a[208:211], a[48:51], a[224:227]
s_waitcnt vmcnt(23) lgkmcnt(0)
s_barrier
ds_read_b64_tr_b16 a[200:201], v22 offset:49152
v_mfma_f32_16x16x32_bf16 a[224:227], a[212:215], a[52:55], a[224:227]
ds_read_b64_tr_b16 a[202:203], v22 offset:50176
ds_read_b64_tr_b16 a[204:205], v22 offset:57344
v_mfma_f32_16x16x32_bf16 a[228:231], a[212:215], a[60:63], a[228:231]
ds_read_b64_tr_b16 a[206:207], v22 offset:58368
v_accvgpr_read_b32 v88, a140
v_mfma_f32_16x16x32_bf16 a[228:231], a[208:211], a[56:59], a[228:231]
buffer_load_dwordx4 a[24:27], v19, s[4:7], s63 offen offset:0 sc1
v_mfma_f32_16x16x32_bf16 a[232:235], a[192:195], a[32:35], a[232:235]
ds_read_b64_tr_b16 a[208:209], v23 offset:49152
ds_read_b64_tr_b16 a[210:211], v23 offset:50176
v_mfma_f32_16x16x32_bf16 a[232:235], a[196:199], a[36:39], a[232:235]
ds_read_b64_tr_b16 a[212:213], v23 offset:57344
ds_read_b64_tr_b16 a[214:215], v23 offset:58368
v_mfma_f32_16x16x32_bf16 a[236:239], a[196:199], a[44:47], a[236:239]
buffer_load_dwordx4 a[28:31], v19, s[4:7], s63 offen offset:1024 sc1
v_mfma_f32_16x16x32_bf16 a[236:239], a[192:195], a[40:43], a[236:239]
v_accvgpr_read_b32 v89, a141
v_accvgpr_read_b32 v90, a142
v_mfma_f32_16x16x32_bf16 a[240:243], a[192:195], a[48:51], a[240:243]
v_accvgpr_read_b32 v91, a143
v_accvgpr_read_b32 v92, a144
v_mfma_f32_16x16x32_bf16 a[240:243], a[196:199], a[52:55], a[240:243]
v_accvgpr_read_b32 v93, a145
v_accvgpr_read_b32 v94, a146
v_mfma_f32_16x16x32_bf16 a[244:247], a[196:199], a[60:63], a[244:247]
v_accvgpr_read_b32 v95, a147
v_accvgpr_read_b32 v96, a148
v_mfma_f32_16x16x32_bf16 a[244:247], a[192:195], a[56:59], a[244:247]
s_waitcnt vmcnt(24) lgkmcnt(5)
v_accvgpr_read_b32 v97, a149
v_accvgpr_read_b32 v98, a150
v_mfma_f32_16x16x32_bf16 v[44:47], a[200:203], a[64:67], v[44:47]
s_waitcnt vmcnt(22) lgkmcnt(4)
ds_read_b64_tr_b16 a[192:193], v24 offset:49152
ds_read_b64_tr_b16 a[194:195], v24 offset:50176
v_mfma_f32_16x16x32_bf16 v[44:47], a[204:207], a[68:71], v[44:47]
s_waitcnt vmcnt(18)
ds_read_b64_tr_b16 a[196:197], v24 offset:57344
ds_read_b64_tr_b16 a[198:199], v24 offset:58368
v_mfma_f32_16x16x32_bf16 v[48:51], a[204:207], a[76:79], v[48:51]
v_accvgpr_read_b32 v99, a151
v_accvgpr_read_b32 v100, a152
v_mfma_f32_16x16x32_bf16 v[48:51], a[200:203], a[72:75], v[48:51]
s_waitcnt vmcnt(16)
v_accvgpr_read_b32 v101, a153
v_accvgpr_read_b32 v102, a154
v_mfma_f32_16x16x32_bf16 v[52:55], a[200:203], a[80:83], v[52:55]
s_waitcnt vmcnt(14)
v_accvgpr_read_b32 v103, a155
v_accvgpr_read_b32 v104, a156
v_mfma_f32_16x16x32_bf16 v[52:55], a[204:207], a[84:87], v[52:55]
s_waitcnt vmcnt(12)
v_accvgpr_read_b32 v105, a157
v_accvgpr_read_b32 v106, a158
v_mfma_f32_16x16x32_bf16 v[56:59], a[204:207], a[92:95], v[56:59]
v_accvgpr_read_b32 v107, a159
v_mfma_f32_16x16x32_bf16 v[56:59], a[200:203], a[88:91], v[56:59]
s_waitcnt lgkmcnt(4)
v_mfma_f32_16x16x32_bf16 v[60:63], a[208:211], a[64:67], v[60:63]
ds_read_b64_tr_b16 a[200:201], v25 offset:49152
ds_read_b64_tr_b16 a[202:203], v25 offset:50176
v_mfma_f32_16x16x32_bf16 v[60:63], a[212:215], a[68:71], v[60:63]
ds_read_b64_tr_b16 a[204:205], v25 offset:57344
ds_read_b64_tr_b16 a[206:207], v25 offset:58368
v_mfma_f32_16x16x32_bf16 v[64:67], a[212:215], a[76:79], v[64:67]
v_mfma_f32_16x16x32_bf16 v[64:67], a[208:211], a[72:75], v[64:67]
v_mfma_f32_16x16x32_bf16 v[68:71], a[208:211], a[80:83], v[68:71]
v_mfma_f32_16x16x32_bf16 v[68:71], a[212:215], a[84:87], v[68:71]
v_mfma_f32_16x16x32_bf16 v[72:75], a[212:215], a[92:95], v[72:75]
v_mfma_f32_16x16x32_bf16 v[72:75], a[208:211], a[88:91], v[72:75]
s_waitcnt lgkmcnt(4)
v_mfma_f32_16x16x32_bf16 v[76:79], a[192:195], a[64:67], v[76:79]
ds_read_b64_tr_b16 a[208:209], v26 offset:49152
ds_read_b64_tr_b16 a[210:211], v26 offset:50176
v_mfma_f32_16x16x32_bf16 v[76:79], a[196:199], a[68:71], v[76:79]
ds_read_b64_tr_b16 a[212:213], v26 offset:57344
ds_read_b64_tr_b16 a[214:215], v26 offset:58368
v_mfma_f32_16x16x32_bf16 v[80:83], a[196:199], a[76:79], v[80:83]
v_mfma_f32_16x16x32_bf16 v[80:83], a[192:195], a[72:75], v[80:83]
v_mfma_f32_16x16x32_bf16 v[84:87], a[192:195], a[80:83], v[84:87]
v_mfma_f32_16x16x32_bf16 v[84:87], a[196:199], a[84:87], v[84:87]
v_mfma_f32_16x16x32_bf16 v[88:91], a[196:199], a[92:95], v[88:91]
v_mfma_f32_16x16x32_bf16 v[88:91], a[192:195], a[88:91], v[88:91]
s_waitcnt lgkmcnt(4)
v_mfma_f32_16x16x32_bf16 v[92:95], a[200:203], a[64:67], v[92:95]
ds_read_b64_tr_b16 a[192:193], v27 offset:49152
ds_read_b64_tr_b16 a[194:195], v27 offset:50176
v_mfma_f32_16x16x32_bf16 v[92:95], a[204:207], a[68:71], v[92:95]
ds_read_b64_tr_b16 a[196:197], v27 offset:57344
ds_read_b64_tr_b16 a[198:199], v27 offset:58368
v_mfma_f32_16x16x32_bf16 v[96:99], a[204:207], a[76:79], v[96:99]
v_mfma_f32_16x16x32_bf16 v[96:99], a[200:203], a[72:75], v[96:99]
v_mfma_f32_16x16x32_bf16 v[100:103], a[200:203], a[80:83], v[100:103]
v_mfma_f32_16x16x32_bf16 v[100:103], a[204:207], a[84:87], v[100:103]
v_mfma_f32_16x16x32_bf16 v[104:107], a[204:207], a[92:95], v[104:107]
v_mfma_f32_16x16x32_bf16 v[104:107], a[200:203], a[88:91], v[104:107]
s_waitcnt lgkmcnt(4)
v_mfma_f32_16x16x32_bf16 a[160:163], a[208:211], a[64:67], a[160:163]
ds_read_b64_tr_b16 a[200:201], v28 offset:49152
ds_read_b64_tr_b16 a[202:203], v28 offset:50176
v_mfma_f32_16x16x32_bf16 a[160:163], a[212:215], a[68:71], a[160:163]
ds_read_b64_tr_b16 a[204:205], v28 offset:57344
ds_read_b64_tr_b16 a[206:207], v28 offset:58368
v_mfma_f32_16x16x32_bf16 a[164:167], a[212:215], a[76:79], a[164:167]
v_mfma_f32_16x16x32_bf16 a[164:167], a[208:211], a[72:75], a[164:167]
v_mfma_f32_16x16x32_bf16 a[168:171], a[208:211], a[80:83], a[168:171]
v_mfma_f32_16x16x32_bf16 a[168:171], a[212:215], a[84:87], a[168:171]
v_mfma_f32_16x16x32_bf16 a[172:175], a[212:215], a[92:95], a[172:175]
v_mfma_f32_16x16x32_bf16 a[172:175], a[208:211], a[88:91], a[172:175]
s_waitcnt lgkmcnt(4)
v_accvgpr_read_b32 v108, a160
v_accvgpr_read_b32 v109, a161
v_mfma_f32_16x16x32_bf16 a[176:179], a[192:195], a[64:67], a[176:179]
ds_read_b64_tr_b16 a[208:209], v29 offset:49152
ds_read_b64_tr_b16 a[210:211], v29 offset:50176
v_mfma_f32_16x16x32_bf16 a[176:179], a[196:199], a[68:71], a[176:179]
ds_read_b64_tr_b16 a[212:213], v29 offset:57344
ds_read_b64_tr_b16 a[214:215], v29 offset:58368
v_mfma_f32_16x16x32_bf16 a[180:183], a[196:199], a[76:79], a[180:183]
v_accvgpr_read_b32 v110, a162
v_accvgpr_read_b32 v111, a163
v_mfma_f32_16x16x32_bf16 a[180:183], a[192:195], a[72:75], a[180:183]
v_accvgpr_read_b32 v112, a164
v_accvgpr_read_b32 v113, a165
v_mfma_f32_16x16x32_bf16 a[184:187], a[192:195], a[80:83], a[184:187]
v_accvgpr_read_b32 v114, a166
v_accvgpr_read_b32 v115, a167
v_mfma_f32_16x16x32_bf16 a[184:187], a[196:199], a[84:87], a[184:187]
v_accvgpr_read_b32 v116, a168
v_accvgpr_read_b32 v117, a169
v_mfma_f32_16x16x32_bf16 a[188:191], a[196:199], a[92:95], a[188:191]
v_accvgpr_read_b32 v118, a170
v_accvgpr_read_b32 v119, a171
v_mfma_f32_16x16x32_bf16 a[188:191], a[192:195], a[88:91], a[188:191]
s_waitcnt lgkmcnt(4)
v_accvgpr_read_b32 v120, a172
v_accvgpr_read_b32 v121, a173
v_mfma_f32_16x16x32_bf16 a[216:219], a[200:203], a[64:67], a[216:219]
v_accvgpr_read_b32 v122, a174
v_accvgpr_read_b32 v123, a175
v_mfma_f32_16x16x32_bf16 a[216:219], a[204:207], a[68:71], a[216:219]
v_accvgpr_read_b32 v124, a176
v_accvgpr_read_b32 v125, a177
v_mfma_f32_16x16x32_bf16 a[220:223], a[204:207], a[76:79], a[220:223]
v_accvgpr_read_b32 v126, a178
v_accvgpr_read_b32 v127, a179
v_mfma_f32_16x16x32_bf16 a[220:223], a[200:203], a[72:75], a[220:223]
v_accvgpr_read_b32 v128, a180
v_accvgpr_read_b32 v129, a181
v_mfma_f32_16x16x32_bf16 a[224:227], a[200:203], a[80:83], a[224:227]
s_waitcnt vmcnt(8) lgkmcnt(0)
s_barrier
s_waitcnt lgkmcnt(0)
s_barrier
v_mfma_f32_16x16x32_bf16 a[224:227], a[204:207], a[84:87], a[224:227]
s_lshl_b32 s57, s49, 7
ds_read_b64_tr_b16 a[192:193], v22 offset:0
ds_read_b64_tr_b16 a[194:195], v22 offset:1024
v_mfma_f32_16x16x32_bf16 a[228:231], a[204:207], a[92:95], a[228:231]
s_add_u32 s57, s57, 70778880
ds_read_b64_tr_b16 a[196:197], v22 offset:8192
ds_read_b64_tr_b16 a[198:199], v22 offset:9216
v_mfma_f32_16x16x32_bf16 a[228:231], a[200:203], a[88:91], a[228:231]
s_lshl_b32 s52, s50, 2
s_add_u32 s51, s57, s52
s_cmp_eq_u32 s48, 0
v_mfma_f32_16x16x32_bf16 a[232:235], a[208:211], a[64:67], a[232:235]
s_cselect_b32 s51, s51, 2146435072
ds_read_b64_tr_b16 a[200:201], v23 offset:0
ds_read_b64_tr_b16 a[202:203], v23 offset:1024
v_mfma_f32_16x16x32_bf16 a[232:235], a[212:215], a[68:71], a[232:235]
ds_read_b64_tr_b16 a[204:205], v23 offset:8192
ds_read_b64_tr_b16 a[206:207], v23 offset:9216
v_mfma_f32_16x16x32_bf16 a[236:239], a[212:215], a[76:79], a[236:239]
buffer_store_dword v39, v38, s[4:7], s51 offen sc1
v_mfma_f32_16x16x32_bf16 a[236:239], a[208:211], a[72:75], a[236:239]
v_accvgpr_read_b32 v130, a182
v_accvgpr_read_b32 v131, a183
v_mfma_f32_16x16x32_bf16 a[240:243], a[208:211], a[80:83], a[240:243]
v_accvgpr_read_b32 v132, a184
v_accvgpr_read_b32 v133, a185
v_mfma_f32_16x16x32_bf16 a[240:243], a[212:215], a[84:87], a[240:243]
v_accvgpr_read_b32 v134, a186
v_accvgpr_read_b32 v135, a187
v_mfma_f32_16x16x32_bf16 a[244:247], a[212:215], a[92:95], a[244:247]
v_accvgpr_read_b32 v136, a188
v_accvgpr_read_b32 v137, a189
v_mfma_f32_16x16x32_bf16 a[244:247], a[208:211], a[88:91], a[244:247]
s_waitcnt vmcnt(8) lgkmcnt(4)
v_accvgpr_read_b32 v138, a190
v_accvgpr_read_b32 v139, a191
v_mfma_f32_16x16x32_bf16 v[44:47], a[192:195], a[0:3], v[44:47]
s_waitcnt vmcnt(7)
ds_read_b64_tr_b16 a[208:209], v24 offset:0
ds_read_b64_tr_b16 a[210:211], v24 offset:1024
v_mfma_f32_16x16x32_bf16 v[44:47], a[196:199], a[4:7], v[44:47]
s_waitcnt vmcnt(5)
ds_read_b64_tr_b16 a[212:213], v24 offset:8192
ds_read_b64_tr_b16 a[214:215], v24 offset:9216
v_mfma_f32_16x16x32_bf16 v[48:51], a[196:199], a[12:15], v[48:51]
v_accvgpr_read_b32 v140, a216
v_accvgpr_read_b32 v141, a217
v_mfma_f32_16x16x32_bf16 v[48:51], a[192:195], a[8:11], v[48:51]
s_waitcnt vmcnt(4)
v_accvgpr_read_b32 v142, a218
v_accvgpr_read_b32 v143, a219
v_mfma_f32_16x16x32_bf16 v[52:55], a[192:195], a[16:19], v[52:55]
s_waitcnt vmcnt(3)
v_accvgpr_read_b32 v144, a220
v_accvgpr_read_b32 v145, a221
v_mfma_f32_16x16x32_bf16 v[52:55], a[196:199], a[20:23], v[52:55]
s_waitcnt vmcnt(1)
v_accvgpr_read_b32 v146, a222
v_accvgpr_read_b32 v147, a223
v_mfma_f32_16x16x32_bf16 v[56:59], a[196:199], a[28:31], v[56:59]
v_accvgpr_read_b32 v148, a224
v_accvgpr_read_b32 v149, a225
v_mfma_f32_16x16x32_bf16 v[56:59], a[192:195], a[24:27], v[56:59]
s_waitcnt lgkmcnt(4)
v_accvgpr_read_b32 v150, a226
v_accvgpr_read_b32 v151, a227
v_mfma_f32_16x16x32_bf16 v[60:63], a[200:203], a[0:3], v[60:63]
ds_read_b64_tr_b16 a[192:193], v25 offset:0
ds_read_b64_tr_b16 a[194:195], v25 offset:1024
v_mfma_f32_16x16x32_bf16 v[60:63], a[204:207], a[4:7], v[60:63]
ds_read_b64_tr_b16 a[196:197], v25 offset:8192
ds_read_b64_tr_b16 a[198:199], v25 offset:9216
v_mfma_f32_16x16x32_bf16 v[64:67], a[204:207], a[12:15], v[64:67]
s_lshl_b32 s3, s55, 15
s_add_u32 s3, s3, 0x8000
v_add_u32 v37, s3, v1
s_lshl_b32 s3, s54, 14
v_add_u32 v36, s3, v37
v_mfma_f32_16x16x32_bf16 v[64:67], a[200:203], a[8:11], v[64:67]
v_accvgpr_read_b32 v152, a228
v_accvgpr_read_b32 v153, a229
v_mfma_f32_16x16x32_bf16 v[68:71], a[200:203], a[16:19], v[68:71]
v_accvgpr_read_b32 v154, a230
v_accvgpr_read_b32 v155, a231
v_mfma_f32_16x16x32_bf16 v[68:71], a[204:207], a[20:23], v[68:71]
v_accvgpr_read_b32 v156, a232
v_accvgpr_read_b32 v157, a233
v_mfma_f32_16x16x32_bf16 v[72:75], a[204:207], a[28:31], v[72:75]
v_accvgpr_read_b32 v158, a234
v_accvgpr_read_b32 v159, a235
v_mfma_f32_16x16x32_bf16 v[72:75], a[200:203], a[24:27], v[72:75]
s_waitcnt lgkmcnt(4)
v_accvgpr_read_b32 v160, a236
v_accvgpr_read_b32 v161, a237
v_mfma_f32_16x16x32_bf16 v[76:79], a[208:211], a[0:3], v[76:79]
ds_read_b64_tr_b16 a[200:201], v26 offset:0
ds_read_b64_tr_b16 a[202:203], v26 offset:1024
v_mfma_f32_16x16x32_bf16 v[76:79], a[212:215], a[4:7], v[76:79]
ds_read_b64_tr_b16 a[204:205], v26 offset:8192
ds_read_b64_tr_b16 a[206:207], v26 offset:9216
v_mfma_f32_16x16x32_bf16 v[80:83], a[212:215], a[12:15], v[80:83]
v_accvgpr_read_b32 v162, a238
v_accvgpr_read_b32 v163, a239
v_mfma_f32_16x16x32_bf16 v[80:83], a[208:211], a[8:11], v[80:83]
v_accvgpr_read_b32 v164, a240
v_accvgpr_read_b32 v165, a241
v_mfma_f32_16x16x32_bf16 v[84:87], a[208:211], a[16:19], v[84:87]
v_accvgpr_read_b32 v166, a242
v_accvgpr_read_b32 v167, a243
v_mfma_f32_16x16x32_bf16 v[84:87], a[212:215], a[20:23], v[84:87]
v_accvgpr_read_b32 v168, a244
v_accvgpr_read_b32 v169, a245
v_mfma_f32_16x16x32_bf16 v[88:91], a[212:215], a[28:31], v[88:91]
v_accvgpr_read_b32 v170, a246
v_accvgpr_read_b32 v171, a247
v_mfma_f32_16x16x32_bf16 v[88:91], a[208:211], a[24:27], v[88:91]
s_waitcnt lgkmcnt(4)
v_cvt_pk_bf16_f32 v44, v44, v45
v_cvt_pk_bf16_f32 v45, v46, v47
v_mfma_f32_16x16x32_bf16 v[92:95], a[192:195], a[0:3], v[92:95]
ds_read_b64_tr_b16 a[208:209], v27 offset:0
ds_read_b64_tr_b16 a[210:211], v27 offset:1024
v_mfma_f32_16x16x32_bf16 v[92:95], a[196:199], a[4:7], v[92:95]
ds_read_b64_tr_b16 a[212:213], v27 offset:8192
ds_read_b64_tr_b16 a[214:215], v27 offset:9216
v_mfma_f32_16x16x32_bf16 v[96:99], a[196:199], a[12:15], v[96:99]
v_cvt_pk_bf16_f32 v46, v60, v61
v_cvt_pk_bf16_f32 v47, v62, v63
v_mfma_f32_16x16x32_bf16 v[96:99], a[192:195], a[8:11], v[96:99]
ds_write_b128 v36, v[44:47] offset:0
v_mfma_f32_16x16x32_bf16 v[100:103], a[192:195], a[16:19], v[100:103]
s_mov_b64 s[88:89], 255
v_lshlrev_b32 v34, 2, v0
v_cvt_pk_bf16_f32 v48, v48, v49
v_mfma_f32_16x16x32_bf16 v[100:103], a[196:199], a[20:23], v[100:103]
buffer_load_dword v35, v34, s[4:7], s57 offen sc1
v_mfma_f32_16x16x32_bf16 v[104:107], a[196:199], a[28:31], v[104:107]
v_cvt_pk_bf16_f32 v49, v50, v51
v_cvt_pk_bf16_f32 v50, v64, v65
v_mfma_f32_16x16x32_bf16 v[104:107], a[192:195], a[24:27], v[104:107]
s_waitcnt lgkmcnt(5)
v_cvt_pk_bf16_f32 v51, v66, v67
v_mfma_f32_16x16x32_bf16 v[108:111], a[200:203], a[0:3], v[108:111]
ds_read_b64_tr_b16 a[192:193], v28 offset:0
ds_read_b64_tr_b16 a[194:195], v28 offset:1024
v_mfma_f32_16x16x32_bf16 v[108:111], a[204:207], a[4:7], v[108:111]
ds_read_b64_tr_b16 a[196:197], v28 offset:8192
ds_read_b64_tr_b16 a[198:199], v28 offset:9216
v_mfma_f32_16x16x32_bf16 v[112:115], a[204:207], a[12:15], v[112:115]
ds_write_b128 v36, v[48:51] offset:4096
v_mfma_f32_16x16x32_bf16 v[112:115], a[200:203], a[8:11], v[112:115]
v_cvt_pk_bf16_f32 v52, v52, v53
v_cvt_pk_bf16_f32 v53, v54, v55
v_mfma_f32_16x16x32_bf16 v[116:119], a[200:203], a[16:19], v[116:119]
v_cvt_pk_bf16_f32 v54, v68, v69
v_cvt_pk_bf16_f32 v55, v70, v71
v_mfma_f32_16x16x32_bf16 v[116:119], a[204:207], a[20:23], v[116:119]
ds_write_b128 v36, v[52:55] offset:8192
v_mfma_f32_16x16x32_bf16 v[120:123], a[204:207], a[28:31], v[120:123]
v_cvt_pk_bf16_f32 v56, v56, v57
v_cvt_pk_bf16_f32 v57, v58, v59
v_mfma_f32_16x16x32_bf16 v[120:123], a[200:203], a[24:27], v[120:123]
s_waitcnt lgkmcnt(6)
v_cvt_pk_bf16_f32 v58, v72, v73
v_cvt_pk_bf16_f32 v59, v74, v75
v_mfma_f32_16x16x32_bf16 v[124:127], a[208:211], a[0:3], v[124:127]
ds_read_b64_tr_b16 a[200:201], v29 offset:0
ds_read_b64_tr_b16 a[202:203], v29 offset:1024
v_mfma_f32_16x16x32_bf16 v[124:127], a[212:215], a[4:7], v[124:127]
ds_read_b64_tr_b16 a[204:205], v29 offset:8192
ds_read_b64_tr_b16 a[206:207], v29 offset:9216
v_mfma_f32_16x16x32_bf16 v[128:131], a[212:215], a[12:15], v[128:131]
ds_write_b128 v36, v[56:59] offset:12288
v_mfma_f32_16x16x32_bf16 v[128:131], a[208:211], a[8:11], v[128:131]
v_cvt_pk_bf16_f32 v76, v76, v77
v_cvt_pk_bf16_f32 v77, v78, v79
v_mfma_f32_16x16x32_bf16 v[132:135], a[208:211], a[16:19], v[132:135]
v_cvt_pk_bf16_f32 v78, v92, v93
v_cvt_pk_bf16_f32 v79, v94, v95
v_mfma_f32_16x16x32_bf16 v[132:135], a[212:215], a[20:23], v[132:135]
ds_write_b128 v36, v[76:79] offset:1024
v_mfma_f32_16x16x32_bf16 v[136:139], a[212:215], a[28:31], v[136:139]
v_cvt_pk_bf16_f32 v80, v80, v81
v_cvt_pk_bf16_f32 v81, v82, v83
v_mfma_f32_16x16x32_bf16 v[136:139], a[208:211], a[24:27], v[136:139]
s_waitcnt lgkmcnt(6)
v_cvt_pk_bf16_f32 v82, v96, v97
v_cvt_pk_bf16_f32 v83, v98, v99
v_mfma_f32_16x16x32_bf16 v[140:143], a[192:195], a[0:3], v[140:143]
ds_write_b128 v36, v[80:83] offset:5120
v_mfma_f32_16x16x32_bf16 v[140:143], a[196:199], a[4:7], v[140:143]
v_cvt_pk_bf16_f32 v84, v84, v85
v_cvt_pk_bf16_f32 v85, v86, v87
v_mfma_f32_16x16x32_bf16 v[144:147], a[196:199], a[12:15], v[144:147]
v_cvt_pk_bf16_f32 v86, v100, v101
v_cvt_pk_bf16_f32 v87, v102, v103
v_mfma_f32_16x16x32_bf16 v[144:147], a[192:195], a[8:11], v[144:147]
ds_write_b128 v36, v[84:87] offset:9216
v_mfma_f32_16x16x32_bf16 v[148:151], a[192:195], a[16:19], v[148:151]
v_cvt_pk_bf16_f32 v88, v88, v89
v_cvt_pk_bf16_f32 v89, v90, v91
v_mfma_f32_16x16x32_bf16 v[148:151], a[196:199], a[20:23], v[148:151]
v_cvt_pk_bf16_f32 v90, v104, v105
v_cvt_pk_bf16_f32 v91, v106, v107
v_mfma_f32_16x16x32_bf16 v[152:155], a[196:199], a[28:31], v[152:155]
ds_write_b128 v36, v[88:91] offset:13312
v_mfma_f32_16x16x32_bf16 v[152:155], a[192:195], a[24:27], v[152:155]
s_waitcnt lgkmcnt(3)
v_cvt_pk_bf16_f32 v108, v108, v109
v_cvt_pk_bf16_f32 v109, v110, v111
v_mfma_f32_16x16x32_bf16 v[156:159], a[200:203], a[0:3], v[156:159]
v_cvt_pk_bf16_f32 v110, v124, v125
v_cvt_pk_bf16_f32 v111, v126, v127
v_mfma_f32_16x16x32_bf16 v[156:159], a[204:207], a[4:7], v[156:159]
ds_write_b128 v36, v[108:111] offset:2048
v_mfma_f32_16x16x32_bf16 v[160:163], a[204:207], a[12:15], v[160:163]
s_waitcnt vmcnt(0)
v_cmp_ne_u32 vcc, 1, v35
v_cvt_pk_bf16_f32 v112, v112, v113
v_mfma_f32_16x16x32_bf16 v[160:163], a[200:203], a[8:11], v[160:163]
v_cvt_pk_bf16_f32 v113, v114, v115
v_cvt_pk_bf16_f32 v114, v128, v129
v_mfma_f32_16x16x32_bf16 v[164:167], a[200:203], a[16:19], v[164:167]
s_and_b64 vcc, vcc, s[88:89]
v_cvt_pk_bf16_f32 v115, v130, v131
v_mfma_f32_16x16x32_bf16 v[164:167], a[204:207], a[20:23], v[164:167]
ds_write_b128 v36, v[112:115] offset:6144
v_mfma_f32_16x16x32_bf16 v[168:171], a[204:207], a[28:31], v[168:171]
s_cbranch_vccnz L_slow_kv0
L_slow_kv0_back:
v_cvt_pk_bf16_f32 v116, v116, v117
v_mfma_f32_16x16x32_bf16 v[168:171], a[200:203], a[24:27], v[168:171]
v_cvt_pk_bf16_f32 v117, v118, v119
v_cvt_pk_bf16_f32 v118, v132, v133
v_cvt_pk_bf16_f32 v119, v134, v135
ds_write_b128 v36, v[116:119] offset:10240
v_cvt_pk_bf16_f32 v120, v120, v121
v_cvt_pk_bf16_f32 v121, v122, v123
v_cvt_pk_bf16_f32 v122, v136, v137
v_cvt_pk_bf16_f32 v123, v138, v139
ds_write_b128 v36, v[120:123] offset:14336
s_mov_b32 s58, 4194304
s_add_u32 m0, s56, 98304
s_nop 0
buffer_load_dwordx4 v40, s[4:7], s58 offen offset:0 sc1 lds
buffer_load_dwordx4 v40, s[4:7], s58 offen offset:1024 sc1 lds
buffer_load_dwordx4 v40, s[4:7], s58 offen offset:2048 sc1 lds
buffer_load_dwordx4 v40, s[4:7], s58 offen offset:3072 sc1 lds
s_add_u32 m0, s56, 102400
s_nop 0
buffer_load_dwordx4 v41, s[4:7], s58 offen offset:0 sc1 lds
buffer_load_dwordx4 v41, s[4:7], s58 offen offset:1024 sc1 lds
buffer_load_dwordx4 v41, s[4:7], s58 offen offset:2048 sc1 lds
buffer_load_dwordx4 v41, s[4:7], s58 offen offset:3072 sc1 lds
s_mov_b32 s59, 20971520
s_add_u32 m0, s56, 131072
s_nop 0
buffer_load_dwordx4 v40, s[4:7], s59 offen offset:0 sc1 lds
buffer_load_dwordx4 v40, s[4:7], s59 offen offset:1024 sc1 lds
buffer_load_dwordx4 v40, s[4:7], s59 offen offset:2048 sc1 lds
buffer_load_dwordx4 v40, s[4:7], s59 offen offset:3072 sc1 lds
s_add_u32 m0, s56, 135168
s_nop 0
buffer_load_dwordx4 v41, s[4:7], s59 offen offset:0 sc1 lds
buffer_load_dwordx4 v41, s[4:7], s59 offen offset:1024 sc1 lds
buffer_load_dwordx4 v41, s[4:7], s59 offen offset:2048 sc1 lds
buffer_load_dwordx4 v41, s[4:7], s59 offen offset:3072 sc1 lds
v_cvt_pk_bf16_f32 v140, v140, v141
v_cvt_pk_bf16_f32 v141, v142, v143
v_cvt_pk_bf16_f32 v142, v156, v157
v_cvt_pk_bf16_f32 v143, v158, v159
ds_write_b128 v36, v[140:143] offset:3072
v_cvt_pk_bf16_f32 v144, v144, v145
v_cvt_pk_bf16_f32 v145, v146, v147
v_cvt_pk_bf16_f32 v146, v160, v161
v_cvt_pk_bf16_f32 v147, v162, v163
ds_write_b128 v36, v[144:147] offset:7168
v_cvt_pk_bf16_f32 v148, v148, v149
v_cvt_pk_bf16_f32 v149, v150, v151
v_cvt_pk_bf16_f32 v150, v164, v165
v_cvt_pk_bf16_f32 v151, v166, v167
ds_write_b128 v36, v[148:151] offset:11264
v_cvt_pk_bf16_f32 v152, v152, v153
v_cvt_pk_bf16_f32 v153, v154, v155
v_cvt_pk_bf16_f32 v154, v168, v169
v_cvt_pk_bf16_f32 v155, v170, v171
ds_write_b128 v36, v[152:155] offset:15360

v_mov_b32 v4, v40
v_mov_b32 v5, v41
s_mov_b32 s60, 2
s_cmp_eq_u32 s50, 0
s_cselect_b32 s58, 0, 0x8000
s_add_u32 s58, s58, 4194304
s_add_u32 s61, s50, 1
s_add_u32 s57, s56, 65536
s_add_u32 s56, s56, 98304
v_and_b32 v6, 15, v0
v_lshrrev_b32 v7, 4, v0
s_lshl_b32 s51, s54, 14
s_add_u32 s51, s51, 98304
v_add_u32 v2, s51, v1
v_cmp_eq_u32 vcc, 0, v6
v_mov_b32 v8, 0x3f803f80
v_lshlrev_b32 v7, 2, v7
v_cndmask_b32 v8, 0, v8, vcc
v_sub_u32 v7, v6, v7
v_mov_b32 v9, v8
v_mov_b32 v10, v8
v_mov_b32 v11, v8
s_sub_i32 s51, s54, s55
s_lshl_b32 s51, s51, 4
s_add_i32 s52, s54, s55
s_sub_i32 s52, s52, 1
s_lshl_b32 s52, s52, 4
v_mov_b32 v6, 0xf149f2ca
v_subrev_u32 v20, s51, v7
v_subrev_u32 v21, s52, v7
v_cmp_le_i32 vcc, 0, v20
v_cmp_le_i32 s[52:53], 0, v21
s_nop 0
v_cndmask_b32 v12, v6, 0, vcc
v_cndmask_b32 v16, v6, 0, s[52:53]
v_cmp_le_i32 vcc, 1, v20
v_cmp_le_i32 s[52:53], 1, v21
s_nop 0
v_cndmask_b32 v13, v6, 0, vcc
v_cndmask_b32 v17, v6, 0, s[52:53]
v_cmp_le_i32 vcc, 2, v20
v_cmp_le_i32 s[52:53], 2, v21
s_nop 0
v_cndmask_b32 v14, v6, 0, vcc
v_cndmask_b32 v18, v6, 0, s[52:53]
v_cmp_le_i32 vcc, 3, v20
v_cmp_le_i32 s[52:53], 3, v21
s_nop 0
v_cndmask_b32 v15, v6, 0, vcc
v_cndmask_b32 v19, v6, 0, s[52:53]
s_waitcnt vmcnt(8) lgkmcnt(0)
s_barrier
ds_read_b128 a[0:3], v37 offset:0
ds_read_b128 a[4:7], v37 offset:1024
ds_read_b128 a[8:11], v37 offset:2048
ds_read_b128 a[12:15], v37 offset:3072
ds_read_b128 a[16:19], v37 offset:4096
ds_read_b128 a[20:23], v37 offset:5120
ds_read_b128 a[24:27], v37 offset:6144
ds_read_b128 a[28:31], v37 offset:7168
ds_read_b128 a[32:35], v37 offset:8192
ds_read_b128 a[36:39], v37 offset:9216
ds_read_b128 a[40:43], v37 offset:10240
ds_read_b128 a[44:47], v37 offset:11264
ds_read_b128 a[48:51], v37 offset:12288
ds_read_b128 a[52:55], v37 offset:13312
ds_read_b128 a[56:59], v37 offset:14336
ds_read_b128 a[60:63], v37 offset:15360
ds_read_b128 a[64:67], v37 offset:16384
ds_read_b128 a[68:71], v37 offset:17408
ds_read_b128 a[72:75], v37 offset:18432
ds_read_b128 a[76:79], v37 offset:19456
ds_read_b128 a[80:83], v37 offset:20480
ds_read_b128 a[84:87], v37 offset:21504
ds_read_b128 a[88:91], v37 offset:22528
ds_read_b128 a[92:95], v37 offset:23552
ds_read_b128 a[96:99], v37 offset:24576
ds_read_b128 a[100:103], v37 offset:25600
ds_read_b128 a[104:107], v37 offset:26624
ds_read_b128 a[108:111], v37 offset:27648
ds_read_b128 a[112:115], v37 offset:28672
ds_read_b128 a[116:119], v37 offset:29696
ds_read_b128 a[120:123], v37 offset:30720
ds_read_b128 a[124:127], v37 offset:31744
v_add_u32 v3, 32768, v2
ds_read_b128 v[100:103], v2 offset:0
ds_read_b128 v[104:107], v2 offset:1024
ds_read_b128 v[108:111], v2 offset:2048
ds_read_b128 v[112:115], v2 offset:3072
ds_read_b128 v[116:119], v2 offset:4096
ds_read_b128 v[120:123], v2 offset:5120
ds_read_b128 v[124:127], v2 offset:6144
ds_read_b128 v[128:131], v2 offset:7168
ds_read_b128 v[132:135], v2 offset:8192
ds_read_b128 v[136:139], v2 offset:9216
ds_read_b128 v[140:143], v2 offset:10240
ds_read_b128 v[144:147], v2 offset:11264
ds_read_b128 v[148:151], v2 offset:12288
ds_read_b128 v[152:155], v2 offset:13312
ds_read_b128 v[156:159], v2 offset:14336
ds_read_b128 v[160:163], v2 offset:15360
v_xor_b32 v2, 65536, v2

L_join:
s_mov_b64 s[66:67], 0
s_cmp_eq_u32 s50, 0
s_cbranch_scc1 L_at_prod
s_mov_b32 s88, s58
s_waitcnt vmcnt(63) lgkmcnt(0)
s_barrier
s_add_u32 s59, s58, 16777216
s_add_u32 s58, s58, 32768
s_cmp_eq_u32 s60, s61
s_cselect_b32 s58, 4194304, s58
s_cmp_gt_u32 s60, 16
s_cselect_b32 s58, 2146435072, s58
s_add_u32 s60, s60, 1
s_add_u32 m0, s56, -65536
v_mfma_f32_16x16x32_bf16 v[36:39], v[100:103], a[0:3], 0
buffer_load_dwordx4 v4, s[4:7], s88 offen offset:0 sc1 lds
v_mfma_f32_16x16x32_bf16 v[36:39], v[104:107], a[4:7], v[36:39]
v_mfma_f32_16x16x32_bf16 v[36:39], v[108:111], a[8:11], v[36:39]
buffer_load_dwordx4 v4, s[4:7], s88 offen offset:1024 sc1 lds
v_mfma_f32_16x16x32_bf16 v[36:39], v[112:115], a[12:15], v[36:39]
v_mfma_f32_16x16x32_bf16 v[40:43], v[128:131], a[12:15], 0
buffer_load_dwordx4 v4, s[4:7], s88 offen offset:2048 sc1 lds
v_mfma_f32_16x16x32_bf16 v[40:43], v[124:127], a[8:11], v[40:43]
v_mfma_f32_16x16x32_bf16 v[40:43], v[120:123], a[4:7], v[40:43]
buffer_load_dwordx4 v4, s[4:7], s88 offen offset:3072 sc1 lds
v_mfma_f32_16x16x32_bf16 v[40:43], v[116:119], a[0:3], v[40:43]
s_add_u32 m0, s56, -61440
v_mfma_f32_16x16x32_bf16 v[44:47], v[132:135], a[0:3], 0
buffer_load_dwordx4 v5, s[4:7], s88 offen offset:0 sc1 lds
v_mfma_f32_16x16x32_bf16 v[44:47], v[136:139], a[4:7], v[44:47]
v_exp_f32 v36, v36
v_mfma_f32_16x16x32_bf16 v[44:47], v[140:143], a[8:11], v[44:47]
buffer_load_dwordx4 v5, s[4:7], s88 offen offset:1024 sc1 lds
v_mfma_f32_16x16x32_bf16 v[44:47], v[144:147], a[12:15], v[44:47]
v_exp_f32 v37, v37
v_mfma_f32_16x16x32_bf16 v[48:51], v[160:163], a[12:15], 0
buffer_load_dwordx4 v5, s[4:7], s88 offen offset:2048 sc1 lds
v_mfma_f32_16x16x32_bf16 v[48:51], v[156:159], a[8:11], v[48:51]
buffer_load_dwordx4 v5, s[4:7], s88 offen offset:3072 sc1 lds
v_exp_f32 v38, v38
v_mfma_f32_16x16x32_bf16 v[48:51], v[152:155], a[4:7], v[48:51]
s_waitcnt vmcnt(8) lgkmcnt(0)
s_barrier
v_mfma_f32_16x16x32_bf16 v[48:51], v[148:151], a[0:3], v[48:51]
s_add_u32 m0, s56, 0
s_nop 0
buffer_load_dwordx4 v4, s[4:7], s58 offen offset:0 sc1 lds
v_exp_f32 v39, v39
v_cvt_pk_bf16_f32 v68, v36, v37
v_cvt_pk_bf16_f32 v69, v38, v39
v_exp_f32 v40, v40
ds_read_b128 v[164:167], v3 offset:0
ds_read_b128 v[168:171], v3 offset:1024
v_exp_f32 v41, v41
buffer_load_dwordx4 v4, s[4:7], s58 offen offset:1024 sc1 lds
v_exp_f32 v42, v42
ds_read_b128 v[172:175], v3 offset:2048
ds_read_b128 v[176:179], v3 offset:3072
v_exp_f32 v43, v43
v_cvt_pk_bf16_f32 v70, v40, v41
v_cvt_pk_bf16_f32 v71, v42, v43
v_exp_f32 v44, v44
ds_read_b128 v[180:183], v3 offset:4096
ds_read_b128 v[184:187], v3 offset:5120
v_exp_f32 v45, v45
buffer_load_dwordx4 v4, s[4:7], s58 offen offset:2048 sc1 lds
v_exp_f32 v46, v46
ds_read_b128 v[188:191], v3 offset:6144
ds_read_b128 v[192:195], v3 offset:7168
v_exp_f32 v47, v47
v_mfma_f32_16x16x32_bf16 v[52:55], v[100:103], a[16:19], 0
v_cvt_pk_bf16_f32 v72, v44, v45
v_cvt_pk_bf16_f32 v73, v46, v47
v_mfma_f32_16x16x32_bf16 v[52:55], v[104:107], a[20:23], v[52:55]
v_exp_f32 v48, v48
v_mfma_f32_16x16x32_bf16 v[52:55], v[108:111], a[24:27], v[52:55]
ds_read_b128 v[196:199], v3 offset:8192
ds_read_b128 v[200:203], v3 offset:9216
v_mfma_f32_16x16x32_bf16 v[52:55], v[112:115], a[28:31], v[52:55]
v_exp_f32 v49, v49
v_mfma_f32_16x16x32_bf16 v[56:59], v[128:131], a[28:31], 0
ds_read_b128 v[204:207], v3 offset:10240
ds_read_b128 v[208:211], v3 offset:11264
v_mfma_f32_16x16x32_bf16 v[56:59], v[124:127], a[24:27], v[56:59]
v_exp_f32 v50, v50
v_mfma_f32_16x16x32_bf16 v[56:59], v[120:123], a[20:23], v[56:59]
ds_read_b128 v[212:215], v3 offset:12288
ds_read_b128 v[216:219], v3 offset:13312
v_mfma_f32_16x16x32_bf16 v[56:59], v[116:119], a[16:19], v[56:59]
v_exp_f32 v51, v51
v_mfma_f32_16x16x32_bf16 v[60:63], v[132:135], a[16:19], 0
v_cvt_pk_bf16_f32 v74, v48, v49
v_cvt_pk_bf16_f32 v75, v50, v51
v_mfma_f32_16x16x32_bf16 v[60:63], v[136:139], a[20:23], v[60:63]
v_exp_f32 v52, v52
v_mfma_f32_16x16x32_bf16 v[60:63], v[140:143], a[24:27], v[60:63]
ds_read_b128 v[220:223], v3 offset:14336
ds_read_b128 v[224:227], v3 offset:15360
v_mfma_f32_16x16x32_bf16 v[60:63], v[144:147], a[28:31], v[60:63]
v_exp_f32 v53, v53
v_mfma_f32_16x16x32_bf16 v[64:67], v[160:163], a[28:31], 0
buffer_load_dwordx4 v4, s[4:7], s58 offen offset:3072 sc1 lds
v_mfma_f32_16x16x32_bf16 v[64:67], v[156:159], a[24:27], v[64:67]
s_add_u32 m0, s56, 4096
v_exp_f32 v54, v54
v_mfma_f32_16x16x32_bf16 v[64:67], v[152:155], a[20:23], v[64:67]
v_xor_b32 v3, 196608, v3
v_mfma_f32_16x16x32_bf16 v[64:67], v[148:151], a[16:19], v[64:67]
s_cmp_eq_u32 s50, 1
s_cbranch_scc1 L_at_b1fd
s_waitcnt lgkmcnt(3)
v_mfma_f32_16x16x32_bf16 a[128:131], v[164:167], v[68:71], 0
buffer_load_dwordx4 v5, s[4:7], s58 offen offset:0 sc1 lds
v_mfma_f32_16x16x32_bf16 a[128:131], v[168:171], v[72:75], a[128:131]
v_exp_f32 v55, v55
v_mfma_f32_16x16x32_bf16 a[132:135], v[176:179], v[72:75], 0
v_cvt_pk_bf16_f32 v76, v52, v53
v_cvt_pk_bf16_f32 v77, v54, v55
v_mfma_f32_16x16x32_bf16 a[132:135], v[172:175], v[68:71], a[132:135]
v_exp_f32 v56, v56
v_mfma_f32_16x16x32_bf16 a[136:139], v[180:183], v[68:71], 0
buffer_load_dwordx4 v5, s[4:7], s58 offen offset:1024 sc1 lds
v_mfma_f32_16x16x32_bf16 a[136:139], v[184:187], v[72:75], a[136:139]
v_exp_f32 v57, v57
v_mfma_f32_16x16x32_bf16 a[140:143], v[192:195], v[72:75], 0
v_mfma_f32_16x16x32_bf16 a[140:143], v[188:191], v[68:71], a[140:143]
v_exp_f32 v58, v58
v_mfma_f32_16x16x32_bf16 a[144:147], v[196:199], v[68:71], 0
buffer_load_dwordx4 v5, s[4:7], s58 offen offset:2048 sc1 lds
v_mfma_f32_16x16x32_bf16 a[144:147], v[200:203], v[72:75], a[144:147]
v_exp_f32 v59, v59
v_mfma_f32_16x16x32_bf16 a[148:151], v[208:211], v[72:75], 0
v_cvt_pk_bf16_f32 v78, v56, v57
v_cvt_pk_bf16_f32 v79, v58, v59
v_mfma_f32_16x16x32_bf16 a[148:151], v[204:207], v[68:71], a[148:151]
v_exp_f32 v60, v60
v_mfma_f32_16x16x32_bf16 a[152:155], v[212:215], v[68:71], 0
s_waitcnt lgkmcnt(0)
buffer_load_dwordx4 v5, s[4:7], s58 offen offset:3072 sc1 lds
v_mfma_f32_16x16x32_bf16 a[152:155], v[216:219], v[72:75], a[152:155]
s_add_u32 m0, s57, 0
v_exp_f32 v61, v61
v_mfma_f32_16x16x32_bf16 a[156:159], v[224:227], v[72:75], 0
buffer_load_dwordx4 v4, s[4:7], s59 offen offset:0 sc1 lds
v_mfma_f32_16x16x32_bf16 a[156:159], v[220:223], v[68:71], a[156:159]
v_exp_f32 v62, v62
v_mfma_f32_16x16x32_bf16 v[20:23], v[8:11], v[68:71], 0
buffer_load_dwordx4 v4, s[4:7], s59 offen offset:1024 sc1 lds
v_mfma_f32_16x16x32_bf16 v[20:23], v[8:11], v[72:75], v[20:23]
v_exp_f32 v63, v63
v_mfma_f32_16x16x32_bf16 v[36:39], v[100:103], a[32:35], 0
v_cvt_pk_bf16_f32 v80, v60, v61
v_cvt_pk_bf16_f32 v81, v62, v63
v_mfma_f32_16x16x32_bf16 v[36:39], v[104:107], a[36:39], v[36:39]
v_exp_f32 v64, v64
v_mfma_f32_16x16x32_bf16 v[36:39], v[108:111], a[40:43], v[36:39]
buffer_load_dwordx4 v4, s[4:7], s59 offen offset:2048 sc1 lds
v_mfma_f32_16x16x32_bf16 v[36:39], v[112:115], a[44:47], v[36:39]
v_exp_f32 v65, v65
v_mfma_f32_16x16x32_bf16 v[40:43], v[128:131], a[44:47], 0
buffer_load_dwordx4 v4, s[4:7], s59 offen offset:3072 sc1 lds
v_mfma_f32_16x16x32_bf16 v[40:43], v[124:127], a[40:43], v[40:43]
s_add_u32 m0, s57, 4096
v_exp_f32 v66, v66
v_mfma_f32_16x16x32_bf16 v[40:43], v[120:123], a[36:39], v[40:43]
buffer_load_dwordx4 v5, s[4:7], s59 offen offset:0 sc1 lds
v_mfma_f32_16x16x32_bf16 v[40:43], v[116:119], a[32:35], v[40:43]
v_exp_f32 v67, v67
v_mfma_f32_16x16x32_bf16 v[44:47], v[132:135], a[32:35], 0
v_cvt_pk_bf16_f32 v82, v64, v65
v_cvt_pk_bf16_f32 v83, v66, v67
v_mfma_f32_16x16x32_bf16 v[44:47], v[136:139], a[36:39], v[44:47]
v_exp_f32 v36, v36
v_mfma_f32_16x16x32_bf16 v[44:47], v[140:143], a[40:43], v[44:47]
buffer_load_dwordx4 v5, s[4:7], s59 offen offset:1024 sc1 lds
v_mfma_f32_16x16x32_bf16 v[44:47], v[144:147], a[44:47], v[44:47]
v_exp_f32 v37, v37
v_mfma_f32_16x16x32_bf16 v[48:51], v[160:163], a[44:47], 0
buffer_load_dwordx4 v5, s[4:7], s59 offen offset:2048 sc1 lds
v_mfma_f32_16x16x32_bf16 v[48:51], v[156:159], a[40:43], v[48:51]
v_exp_f32 v38, v38
v_mfma_f32_16x16x32_bf16 v[48:51], v[152:155], a[36:39], v[48:51]
buffer_load_dwordx4 v5, s[4:7], s59 offen offset:3072 sc1 lds
v_mfma_f32_16x16x32_bf16 v[48:51], v[148:151], a[32:35], v[48:51]
s_xor_b32 s57, s57, 196608
v_mfma_f32_16x16x32_bf16 a[160:163], v[164:167], v[76:79], 0
s_waitcnt vmcnt(16) lgkmcnt(0)
s_barrier
v_mfma_f32_16x16x32_bf16 a[160:163], v[168:171], v[80:83], a[160:163]
s_add_u32 s59, s58, 16777216
v_exp_f32 v39, v39
v_mfma_f32_16x16x32_bf16 a[164:167], v[176:179], v[80:83], 0
v_cvt_pk_bf16_f32 v84, v36, v37
v_cvt_pk_bf16_f32 v85, v38, v39
v_mfma_f32_16x16x32_bf16 a[164:167], v[172:175], v[76:79], a[164:167]
s_add_u32 m0, s57, 0
v_exp_f32 v40, v40
v_mfma_f32_16x16x32_bf16 a[168:171], v[180:183], v[76:79], 0
buffer_load_dwordx4 v4, s[4:7], s59 offen offset:0 sc1 lds
v_mfma_f32_16x16x32_bf16 a[168:171], v[184:187], v[80:83], a[168:171]
s_add_u32 s58, s58, 32768
v_exp_f32 v41, v41
v_mfma_f32_16x16x32_bf16 a[172:175], v[192:195], v[80:83], 0
s_cmp_eq_u32 s60, s61
v_mfma_f32_16x16x32_bf16 a[172:175], v[188:191], v[76:79], a[172:175]
s_cselect_b32 s58, 4194304, s58
v_exp_f32 v42, v42
v_mfma_f32_16x16x32_bf16 a[176:179], v[196:199], v[76:79], 0
buffer_load_dwordx4 v4, s[4:7], s59 offen offset:1024 sc1 lds
v_mfma_f32_16x16x32_bf16 a[176:179], v[200:203], v[80:83], a[176:179]
s_cmp_gt_u32 s60, 16
v_exp_f32 v43, v43
v_mfma_f32_16x16x32_bf16 a[180:183], v[208:211], v[80:83], 0
s_cselect_b32 s58, 2146435072, s58
v_cvt_pk_bf16_f32 v86, v40, v41
v_cvt_pk_bf16_f32 v87, v42, v43
v_mfma_f32_16x16x32_bf16 a[180:183], v[204:207], v[76:79], a[180:183]
s_xor_b32 s56, s56, 65536
v_exp_f32 v44, v44
v_mfma_f32_16x16x32_bf16 a[184:187], v[212:215], v[76:79], 0
buffer_load_dwordx4 v4, s[4:7], s59 offen offset:2048 sc1 lds
v_mfma_f32_16x16x32_bf16 a[184:187], v[216:219], v[80:83], a[184:187]
s_add_u32 s60, s60, 1
v_exp_f32 v45, v45
v_mfma_f32_16x16x32_bf16 a[188:191], v[224:227], v[80:83], 0
v_mfma_f32_16x16x32_bf16 a[188:191], v[220:223], v[76:79], a[188:191]
v_exp_f32 v46, v46
v_mfma_f32_16x16x32_bf16 v[24:27], v[8:11], v[76:79], 0
buffer_load_dwordx4 v4, s[4:7], s59 offen offset:3072 sc1 lds
v_mfma_f32_16x16x32_bf16 v[24:27], v[8:11], v[80:83], v[24:27]
v_exp_f32 v47, v47
v_mfma_f32_16x16x32_bf16 v[52:55], v[100:103], a[48:51], 0
v_cvt_pk_bf16_f32 v88, v44, v45
v_cvt_pk_bf16_f32 v89, v46, v47
v_mfma_f32_16x16x32_bf16 v[52:55], v[104:107], a[52:55], v[52:55]
v_exp_f32 v48, v48
v_mfma_f32_16x16x32_bf16 v[52:55], v[108:111], a[56:59], v[52:55]
ds_read_b128 v[100:103], v2 offset:0
ds_read_b128 v[104:107], v2 offset:1024
v_mfma_f32_16x16x32_bf16 v[52:55], v[112:115], a[60:63], v[52:55]
s_add_u32 m0, s57, 4096
v_exp_f32 v49, v49
v_mfma_f32_16x16x32_bf16 v[56:59], v[128:131], a[60:63], 0
buffer_load_dwordx4 v5, s[4:7], s59 offen offset:0 sc1 lds
v_mfma_f32_16x16x32_bf16 v[56:59], v[124:127], a[56:59], v[56:59]
v_exp_f32 v50, v50
v_mfma_f32_16x16x32_bf16 v[56:59], v[120:123], a[52:55], v[56:59]
ds_read_b128 v[108:111], v2 offset:2048
ds_read_b128 v[112:115], v2 offset:3072
v_mfma_f32_16x16x32_bf16 v[56:59], v[116:119], a[48:51], v[56:59]
v_exp_f32 v51, v51
v_mfma_f32_16x16x32_bf16 v[60:63], v[132:135], a[48:51], 0
v_cvt_pk_bf16_f32 v90, v48, v49
v_cvt_pk_bf16_f32 v91, v50, v51
v_mfma_f32_16x16x32_bf16 v[60:63], v[136:139], a[52:55], v[60:63]
v_exp_f32 v52, v52
v_mfma_f32_16x16x32_bf16 v[60:63], v[140:143], a[56:59], v[60:63]
ds_read_b128 v[116:119], v2 offset:4096
ds_read_b128 v[120:123], v2 offset:5120
v_mfma_f32_16x16x32_bf16 v[60:63], v[144:147], a[60:63], v[60:63]
v_exp_f32 v53, v53
v_mfma_f32_16x16x32_bf16 v[64:67], v[160:163], a[60:63], 0
buffer_load_dwordx4 v5, s[4:7], s59 offen offset:1024 sc1 lds
v_mfma_f32_16x16x32_bf16 v[64:67], v[156:159], a[56:59], v[64:67]
v_exp_f32 v54, v54
v_mfma_f32_16x16x32_bf16 v[64:67], v[152:155], a[52:55], v[64:67]
ds_read_b128 v[124:127], v2 offset:6144
ds_read_b128 v[128:131], v2 offset:7168
v_mfma_f32_16x16x32_bf16 v[64:67], v[148:151], a[48:51], v[64:67]
v_mfma_f32_16x16x32_bf16 a[192:195], v[164:167], v[84:87], 0
ds_read_b128 v[132:135], v2 offset:8192
ds_read_b128 v[136:139], v2 offset:9216
v_mfma_f32_16x16x32_bf16 a[192:195], v[168:171], v[88:91], a[192:195]
v_exp_f32 v55, v55
v_mfma_f32_16x16x32_bf16 a[196:199], v[176:179], v[88:91], 0
v_cvt_pk_bf16_f32 v92, v52, v53
v_cvt_pk_bf16_f32 v93, v54, v55
v_mfma_f32_16x16x32_bf16 a[196:199], v[172:175], v[84:87], a[196:199]
v_exp_f32 v56, v56
v_mfma_f32_16x16x32_bf16 a[200:203], v[180:183], v[84:87], 0
ds_read_b128 v[140:143], v2 offset:10240
ds_read_b128 v[144:147], v2 offset:11264
v_mfma_f32_16x16x32_bf16 a[200:203], v[184:187], v[88:91], a[200:203]
v_exp_f32 v57, v57
v_mfma_f32_16x16x32_bf16 a[204:207], v[192:195], v[88:91], 0
buffer_load_dwordx4 v5, s[4:7], s59 offen offset:2048 sc1 lds
v_mfma_f32_16x16x32_bf16 a[204:207], v[188:191], v[84:87], a[204:207]
v_exp_f32 v58, v58
v_mfma_f32_16x16x32_bf16 a[208:211], v[196:199], v[84:87], 0
ds_read_b128 v[148:151], v2 offset:12288
ds_read_b128 v[152:155], v2 offset:13312
v_mfma_f32_16x16x32_bf16 a[208:211], v[200:203], v[88:91], a[208:211]
v_exp_f32 v59, v59
v_mfma_f32_16x16x32_bf16 a[212:215], v[208:211], v[88:91], 0
v_cvt_pk_bf16_f32 v94, v56, v57
v_cvt_pk_bf16_f32 v95, v58, v59
v_mfma_f32_16x16x32_bf16 a[212:215], v[204:207], v[84:87], a[212:215]
v_exp_f32 v60, v60
v_mfma_f32_16x16x32_bf16 a[216:219], v[212:215], v[84:87], 0
ds_read_b128 v[156:159], v2 offset:14336
ds_read_b128 v[160:163], v2 offset:15360
v_mfma_f32_16x16x32_bf16 a[216:219], v[216:219], v[88:91], a[216:219]
v_exp_f32 v61, v61
v_mfma_f32_16x16x32_bf16 a[220:223], v[224:227], v[88:91], 0
buffer_load_dwordx4 v5, s[4:7], s59 offen offset:3072 sc1 lds
v_mfma_f32_16x16x32_bf16 a[220:223], v[220:223], v[84:87], a[220:223]
s_xor_b32 s57, s57, 196608
v_exp_f32 v62, v62
v_mfma_f32_16x16x32_bf16 v[28:31], v[8:11], v[84:87], 0
v_xor_b32 v2, 65536, v2
v_mfma_f32_16x16x32_bf16 v[28:31], v[8:11], v[88:91], v[28:31]
s_waitcnt lgkmcnt(3)
v_exp_f32 v63, v63
v_mfma_f32_16x16x32_bf16 v[36:39], v[100:103], a[0:3], 0
v_cvt_pk_bf16_f32 v96, v60, v61
v_cvt_pk_bf16_f32 v97, v62, v63
v_mfma_f32_16x16x32_bf16 v[36:39], v[104:107], a[4:7], v[36:39]
v_exp_f32 v64, v64
v_mfma_f32_16x16x32_bf16 v[36:39], v[108:111], a[8:11], v[36:39]
v_mfma_f32_16x16x32_bf16 v[36:39], v[112:115], a[12:15], v[36:39]
v_exp_f32 v65, v65
v_mfma_f32_16x16x32_bf16 v[40:43], v[128:131], a[12:15], 0
v_mfma_f32_16x16x32_bf16 v[40:43], v[124:127], a[8:11], v[40:43]
v_exp_f32 v66, v66
v_mfma_f32_16x16x32_bf16 v[40:43], v[120:123], a[4:7], v[40:43]
v_mfma_f32_16x16x32_bf16 v[40:43], v[116:119], a[0:3], v[40:43]
v_exp_f32 v67, v67
v_mfma_f32_16x16x32_bf16 v[44:47], v[132:135], a[0:3], 0
v_cvt_pk_bf16_f32 v98, v64, v65
v_cvt_pk_bf16_f32 v99, v66, v67
v_mfma_f32_16x16x32_bf16 v[44:47], v[136:139], a[4:7], v[44:47]
v_exp_f32 v36, v36
v_mfma_f32_16x16x32_bf16 v[44:47], v[140:143], a[8:11], v[44:47]
v_mfma_f32_16x16x32_bf16 v[44:47], v[144:147], a[12:15], v[44:47]
s_waitcnt lgkmcnt(0)
v_exp_f32 v37, v37
v_mfma_f32_16x16x32_bf16 v[48:51], v[160:163], a[12:15], 0
v_mfma_f32_16x16x32_bf16 v[48:51], v[156:159], a[8:11], v[48:51]
v_exp_f32 v38, v38
v_mfma_f32_16x16x32_bf16 v[48:51], v[152:155], a[4:7], v[48:51]
s_waitcnt vmcnt(8) lgkmcnt(0)
s_barrier
v_mfma_f32_16x16x32_bf16 v[48:51], v[148:151], a[0:3], v[48:51]
s_add_u32 m0, s56, 0
v_mfma_f32_16x16x32_bf16 a[224:227], v[164:167], v[92:95], 0
buffer_load_dwordx4 v4, s[4:7], s58 offen offset:0 sc1 lds
v_mfma_f32_16x16x32_bf16 a[224:227], v[168:171], v[96:99], a[224:227]
v_exp_f32 v39, v39
v_mfma_f32_16x16x32_bf16 a[228:231], v[176:179], v[96:99], 0
v_cvt_pk_bf16_f32 v68, v36, v37
v_cvt_pk_bf16_f32 v69, v38, v39
v_mfma_f32_16x16x32_bf16 a[228:231], v[172:175], v[92:95], a[228:231]
v_exp_f32 v40, v40
v_mfma_f32_16x16x32_bf16 a[232:235], v[180:183], v[92:95], 0
ds_read_b128 v[164:167], v3 offset:0
ds_read_b128 v[168:171], v3 offset:1024
v_mfma_f32_16x16x32_bf16 a[232:235], v[184:187], v[96:99], a[232:235]
v_exp_f32 v41, v41
v_mfma_f32_16x16x32_bf16 a[236:239], v[192:195], v[96:99], 0
buffer_load_dwordx4 v4, s[4:7], s58 offen offset:1024 sc1 lds
v_mfma_f32_16x16x32_bf16 a[236:239], v[188:191], v[92:95], a[236:239]
v_exp_f32 v42, v42
v_mfma_f32_16x16x32_bf16 a[240:243], v[196:199], v[92:95], 0
ds_read_b128 v[172:175], v3 offset:2048
ds_read_b128 v[176:179], v3 offset:3072
v_mfma_f32_16x16x32_bf16 a[240:243], v[200:203], v[96:99], a[240:243]
v_exp_f32 v43, v43
v_mfma_f32_16x16x32_bf16 a[244:247], v[208:211], v[96:99], 0
v_cvt_pk_bf16_f32 v70, v40, v41
v_cvt_pk_bf16_f32 v71, v42, v43
v_mfma_f32_16x16x32_bf16 a[244:247], v[204:207], v[92:95], a[244:247]
v_exp_f32 v44, v44
v_mfma_f32_16x16x32_bf16 a[248:251], v[212:215], v[92:95], 0
ds_read_b128 v[180:183], v3 offset:4096
ds_read_b128 v[184:187], v3 offset:5120
v_mfma_f32_16x16x32_bf16 a[248:251], v[216:219], v[96:99], a[248:251]
v_exp_f32 v45, v45
v_mfma_f32_16x16x32_bf16 a[252:255], v[224:227], v[96:99], 0
buffer_load_dwordx4 v4, s[4:7], s58 offen offset:2048 sc1 lds
v_mfma_f32_16x16x32_bf16 a[252:255], v[220:223], v[92:95], a[252:255]
v_exp_f32 v46, v46
v_mfma_f32_16x16x32_bf16 v[32:35], v[8:11], v[92:95], 0
ds_read_b128 v[188:191], v3 offset:6144
ds_read_b128 v[192:195], v3 offset:7168
v_mfma_f32_16x16x32_bf16 v[32:35], v[8:11], v[96:99], v[32:35]
v_exp_f32 v47, v47
v_mfma_f32_16x16x32_bf16 v[52:55], v[100:103], a[16:19], 0
v_cvt_pk_bf16_f32 v72, v44, v45
v_cvt_pk_bf16_f32 v73, v46, v47
v_mfma_f32_16x16x32_bf16 v[52:55], v[104:107], a[20:23], v[52:55]
v_exp_f32 v48, v48
v_mfma_f32_16x16x32_bf16 v[52:55], v[108:111], a[24:27], v[52:55]
ds_read_b128 v[196:199], v3 offset:8192
ds_read_b128 v[200:203], v3 offset:9216
v_mfma_f32_16x16x32_bf16 v[52:55], v[112:115], a[28:31], v[52:55]
v_exp_f32 v49, v49
v_mfma_f32_16x16x32_bf16 v[56:59], v[128:131], a[28:31], 0
ds_read_b128 v[204:207], v3 offset:10240
ds_read_b128 v[208:211], v3 offset:11264
v_mfma_f32_16x16x32_bf16 v[56:59], v[124:127], a[24:27], v[56:59]
v_exp_f32 v50, v50
v_mfma_f32_16x16x32_bf16 v[56:59], v[120:123], a[20:23], v[56:59]
ds_read_b128 v[212:215], v3 offset:12288
ds_read_b128 v[216:219], v3 offset:13312
v_mfma_f32_16x16x32_bf16 v[56:59], v[116:119], a[16:19], v[56:59]
v_exp_f32 v51, v51
v_mfma_f32_16x16x32_bf16 v[60:63], v[132:135], a[16:19], 0
v_cvt_pk_bf16_f32 v74, v48, v49
v_cvt_pk_bf16_f32 v75, v50, v51
v_mfma_f32_16x16x32_bf16 v[60:63], v[136:139], a[20:23], v[60:63]
v_exp_f32 v52, v52
v_mfma_f32_16x16x32_bf16 v[60:63], v[140:143], a[24:27], v[60:63]
ds_read_b128 v[220:223], v3 offset:14336
ds_read_b128 v[224:227], v3 offset:15360
v_mfma_f32_16x16x32_bf16 v[60:63], v[144:147], a[28:31], v[60:63]
v_exp_f32 v53, v53
v_mfma_f32_16x16x32_bf16 v[64:67], v[160:163], a[28:31], 0
buffer_load_dwordx4 v4, s[4:7], s58 offen offset:3072 sc1 lds
v_mfma_f32_16x16x32_bf16 v[64:67], v[156:159], a[24:27], v[64:67]
s_add_u32 m0, s56, 4096
v_exp_f32 v54, v54
v_mfma_f32_16x16x32_bf16 v[64:67], v[152:155], a[20:23], v[64:67]
v_xor_b32 v3, 196608, v3
v_mfma_f32_16x16x32_bf16 v[64:67], v[148:151], a[16:19], v[64:67]
s_sub_u32 s62, s50, 2
s_cmp_eq_u32 s62, 0
s_cbranch_scc1 L_at_b1d
L_at_b1:
s_waitcnt lgkmcnt(2)
v_mfma_f32_16x16x32_bf16 a[128:131], v[164:167], v[68:71], a[128:131]
buffer_load_dwordx4 v5, s[4:7], s58 offen offset:0 sc1 lds
v_mfma_f32_16x16x32_bf16 a[128:131], v[168:171], v[72:75], a[128:131]
v_exp_f32 v55, v55
v_mfma_f32_16x16x32_bf16 a[132:135], v[176:179], v[72:75], a[132:135]
v_cvt_pk_bf16_f32 v76, v52, v53
v_cvt_pk_bf16_f32 v77, v54, v55
v_mfma_f32_16x16x32_bf16 a[132:135], v[172:175], v[68:71], a[132:135]
v_exp_f32 v56, v56
v_mfma_f32_16x16x32_bf16 a[136:139], v[180:183], v[68:71], a[136:139]
buffer_load_dwordx4 v5, s[4:7], s58 offen offset:1024 sc1 lds
v_mfma_f32_16x16x32_bf16 a[136:139], v[184:187], v[72:75], a[136:139]
v_exp_f32 v57, v57
v_mfma_f32_16x16x32_bf16 a[140:143], v[192:195], v[72:75], a[140:143]
v_mfma_f32_16x16x32_bf16 a[140:143], v[188:191], v[68:71], a[140:143]
v_exp_f32 v58, v58
v_mfma_f32_16x16x32_bf16 a[144:147], v[196:199], v[68:71], a[144:147]
buffer_load_dwordx4 v5, s[4:7], s58 offen offset:2048 sc1 lds
v_mfma_f32_16x16x32_bf16 a[144:147], v[200:203], v[72:75], a[144:147]
v_exp_f32 v59, v59
v_mfma_f32_16x16x32_bf16 a[148:151], v[208:211], v[72:75], a[148:151]
v_cvt_pk_bf16_f32 v78, v56, v57
v_cvt_pk_bf16_f32 v79, v58, v59
v_mfma_f32_16x16x32_bf16 a[148:151], v[204:207], v[68:71], a[148:151]
v_exp_f32 v60, v60
v_mfma_f32_16x16x32_bf16 a[152:155], v[212:215], v[68:71], a[152:155]
buffer_load_dwordx4 v5, s[4:7], s58 offen offset:3072 sc1 lds
v_mfma_f32_16x16x32_bf16 a[152:155], v[216:219], v[72:75], a[152:155]
s_waitcnt lgkmcnt(0)
v_exp_f32 v61, v61
v_mfma_f32_16x16x32_bf16 a[156:159], v[224:227], v[72:75], a[156:159]
v_mfma_f32_16x16x32_bf16 a[156:159], v[220:223], v[68:71], a[156:159]
v_exp_f32 v62, v62
v_mfma_f32_16x16x32_bf16 v[20:23], v[8:11], v[68:71], v[20:23]
v_mfma_f32_16x16x32_bf16 v[20:23], v[8:11], v[72:75], v[20:23]
v_exp_f32 v63, v63
v_mfma_f32_16x16x32_bf16 v[36:39], v[100:103], a[32:35], 0
v_cvt_pk_bf16_f32 v80, v60, v61
v_cvt_pk_bf16_f32 v81, v62, v63
v_mfma_f32_16x16x32_bf16 v[36:39], v[104:107], a[36:39], v[36:39]
v_exp_f32 v64, v64
v_mfma_f32_16x16x32_bf16 v[36:39], v[108:111], a[40:43], v[36:39]
v_mfma_f32_16x16x32_bf16 v[36:39], v[112:115], a[44:47], v[36:39]
v_exp_f32 v65, v65
v_mfma_f32_16x16x32_bf16 v[40:43], v[128:131], a[44:47], 0
v_mfma_f32_16x16x32_bf16 v[40:43], v[124:127], a[40:43], v[40:43]
v_exp_f32 v66, v66
v_mfma_f32_16x16x32_bf16 v[40:43], v[120:123], a[36:39], v[40:43]
v_mfma_f32_16x16x32_bf16 v[40:43], v[116:119], a[32:35], v[40:43]
v_exp_f32 v67, v67
v_mfma_f32_16x16x32_bf16 v[44:47], v[132:135], a[32:35], 0
v_cvt_pk_bf16_f32 v82, v64, v65
v_cvt_pk_bf16_f32 v83, v66, v67
v_mfma_f32_16x16x32_bf16 v[44:47], v[136:139], a[36:39], v[44:47]
v_exp_f32 v36, v36
v_mfma_f32_16x16x32_bf16 v[44:47], v[140:143], a[40:43], v[44:47]
v_mfma_f32_16x16x32_bf16 v[44:47], v[144:147], a[44:47], v[44:47]
v_exp_f32 v37, v37
v_mfma_f32_16x16x32_bf16 v[48:51], v[160:163], a[44:47], 0
v_mfma_f32_16x16x32_bf16 v[48:51], v[156:159], a[40:43], v[48:51]
v_exp_f32 v38, v38
v_mfma_f32_16x16x32_bf16 v[48:51], v[152:155], a[36:39], v[48:51]
v_mfma_f32_16x16x32_bf16 v[48:51], v[148:151], a[32:35], v[48:51]
v_mfma_f32_16x16x32_bf16 a[160:163], v[164:167], v[76:79], a[160:163]
s_waitcnt vmcnt(16) lgkmcnt(0)
s_barrier
v_mfma_f32_16x16x32_bf16 a[160:163], v[168:171], v[80:83], a[160:163]
s_add_u32 s59, s58, 16777216
v_exp_f32 v39, v39
v_mfma_f32_16x16x32_bf16 a[164:167], v[176:179], v[80:83], a[164:167]
v_cvt_pk_bf16_f32 v84, v36, v37
v_cvt_pk_bf16_f32 v85, v38, v39
v_mfma_f32_16x16x32_bf16 a[164:167], v[172:175], v[76:79], a[164:167]
s_add_u32 m0, s57, 0
v_exp_f32 v40, v40
v_mfma_f32_16x16x32_bf16 a[168:171], v[180:183], v[76:79], a[168:171]
buffer_load_dwordx4 v4, s[4:7], s59 offen offset:0 sc1 lds
v_mfma_f32_16x16x32_bf16 a[168:171], v[184:187], v[80:83], a[168:171]
s_add_u32 s58, s58, 32768
v_exp_f32 v41, v41
v_mfma_f32_16x16x32_bf16 a[172:175], v[192:195], v[80:83], a[172:175]
s_cmp_eq_u32 s60, s61
v_mfma_f32_16x16x32_bf16 a[172:175], v[188:191], v[76:79], a[172:175]
s_cselect_b32 s58, 4194304, s58
v_exp_f32 v42, v42
v_mfma_f32_16x16x32_bf16 a[176:179], v[196:199], v[76:79], a[176:179]
buffer_load_dwordx4 v4, s[4:7], s59 offen offset:1024 sc1 lds
v_mfma_f32_16x16x32_bf16 a[176:179], v[200:203], v[80:83], a[176:179]
s_cmp_gt_u32 s60, 16
v_exp_f32 v43, v43
v_mfma_f32_16x16x32_bf16 a[180:183], v[208:211], v[80:83], a[180:183]
s_cselect_b32 s58, 2146435072, s58
v_cvt_pk_bf16_f32 v86, v40, v41
v_cvt_pk_bf16_f32 v87, v42, v43
v_mfma_f32_16x16x32_bf16 a[180:183], v[204:207], v[76:79], a[180:183]
s_xor_b32 s56, s56, 65536
v_exp_f32 v44, v44
v_mfma_f32_16x16x32_bf16 a[184:187], v[212:215], v[76:79], a[184:187]
buffer_load_dwordx4 v4, s[4:7], s59 offen offset:2048 sc1 lds
v_mfma_f32_16x16x32_bf16 a[184:187], v[216:219], v[80:83], a[184:187]
s_add_u32 s60, s60, 1
v_exp_f32 v45, v45
v_mfma_f32_16x16x32_bf16 a[188:191], v[224:227], v[80:83], a[188:191]
v_mfma_f32_16x16x32_bf16 a[188:191], v[220:223], v[76:79], a[188:191]
v_exp_f32 v46, v46
v_mfma_f32_16x16x32_bf16 v[24:27], v[8:11], v[76:79], v[24:27]
buffer_load_dwordx4 v4, s[4:7], s59 offen offset:3072 sc1 lds
v_mfma_f32_16x16x32_bf16 v[24:27], v[8:11], v[80:83], v[24:27]
v_exp_f32 v47, v47
v_mfma_f32_16x16x32_bf16 v[52:55], v[100:103], a[48:51], 0
v_cvt_pk_bf16_f32 v88, v44, v45
v_cvt_pk_bf16_f32 v89, v46, v47
v_mfma_f32_16x16x32_bf16 v[52:55], v[104:107], a[52:55], v[52:55]
v_exp_f32 v48, v48
v_mfma_f32_16x16x32_bf16 v[52:55], v[108:111], a[56:59], v[52:55]
ds_read_b128 v[100:103], v2 offset:0
ds_read_b128 v[104:107], v2 offset:1024
v_mfma_f32_16x16x32_bf16 v[52:55], v[112:115], a[60:63], v[52:55]
s_add_u32 m0, s57, 4096
v_exp_f32 v49, v49
v_mfma_f32_16x16x32_bf16 v[56:59], v[128:131], a[60:63], 0
buffer_load_dwordx4 v5, s[4:7], s59 offen offset:0 sc1 lds
v_mfma_f32_16x16x32_bf16 v[56:59], v[124:127], a[56:59], v[56:59]
v_exp_f32 v50, v50
v_mfma_f32_16x16x32_bf16 v[56:59], v[120:123], a[52:55], v[56:59]
ds_read_b128 v[108:111], v2 offset:2048
ds_read_b128 v[112:115], v2 offset:3072
v_mfma_f32_16x16x32_bf16 v[56:59], v[116:119], a[48:51], v[56:59]
v_exp_f32 v51, v51
v_mfma_f32_16x16x32_bf16 v[60:63], v[132:135], a[48:51], 0
v_cvt_pk_bf16_f32 v90, v48, v49
v_cvt_pk_bf16_f32 v91, v50, v51
v_mfma_f32_16x16x32_bf16 v[60:63], v[136:139], a[52:55], v[60:63]
v_exp_f32 v52, v52
v_mfma_f32_16x16x32_bf16 v[60:63], v[140:143], a[56:59], v[60:63]
ds_read_b128 v[116:119], v2 offset:4096
ds_read_b128 v[120:123], v2 offset:5120
v_mfma_f32_16x16x32_bf16 v[60:63], v[144:147], a[60:63], v[60:63]
v_exp_f32 v53, v53
v_mfma_f32_16x16x32_bf16 v[64:67], v[160:163], a[60:63], 0
buffer_load_dwordx4 v5, s[4:7], s59 offen offset:1024 sc1 lds
v_mfma_f32_16x16x32_bf16 v[64:67], v[156:159], a[56:59], v[64:67]
v_exp_f32 v54, v54
v_mfma_f32_16x16x32_bf16 v[64:67], v[152:155], a[52:55], v[64:67]
ds_read_b128 v[124:127], v2 offset:6144
ds_read_b128 v[128:131], v2 offset:7168
v_mfma_f32_16x16x32_bf16 v[64:67], v[148:151], a[48:51], v[64:67]
v_mfma_f32_16x16x32_bf16 a[192:195], v[164:167], v[84:87], a[192:195]
ds_read_b128 v[132:135], v2 offset:8192
ds_read_b128 v[136:139], v2 offset:9216
v_mfma_f32_16x16x32_bf16 a[192:195], v[168:171], v[88:91], a[192:195]
v_exp_f32 v55, v55
v_mfma_f32_16x16x32_bf16 a[196:199], v[176:179], v[88:91], a[196:199]
v_cvt_pk_bf16_f32 v92, v52, v53
v_cvt_pk_bf16_f32 v93, v54, v55
v_mfma_f32_16x16x32_bf16 a[196:199], v[172:175], v[84:87], a[196:199]
v_exp_f32 v56, v56
v_mfma_f32_16x16x32_bf16 a[200:203], v[180:183], v[84:87], a[200:203]
ds_read_b128 v[140:143], v2 offset:10240
ds_read_b128 v[144:147], v2 offset:11264
v_mfma_f32_16x16x32_bf16 a[200:203], v[184:187], v[88:91], a[200:203]
v_exp_f32 v57, v57
v_mfma_f32_16x16x32_bf16 a[204:207], v[192:195], v[88:91], a[204:207]
buffer_load_dwordx4 v5, s[4:7], s59 offen offset:2048 sc1 lds
v_mfma_f32_16x16x32_bf16 a[204:207], v[188:191], v[84:87], a[204:207]
v_exp_f32 v58, v58
v_mfma_f32_16x16x32_bf16 a[208:211], v[196:199], v[84:87], a[208:211]
ds_read_b128 v[148:151], v2 offset:12288
ds_read_b128 v[152:155], v2 offset:13312
v_mfma_f32_16x16x32_bf16 a[208:211], v[200:203], v[88:91], a[208:211]
v_exp_f32 v59, v59
v_mfma_f32_16x16x32_bf16 a[212:215], v[208:211], v[88:91], a[212:215]
v_cvt_pk_bf16_f32 v94, v56, v57
v_cvt_pk_bf16_f32 v95, v58, v59
v_mfma_f32_16x16x32_bf16 a[212:215], v[204:207], v[84:87], a[212:215]
v_exp_f32 v60, v60
v_mfma_f32_16x16x32_bf16 a[216:219], v[212:215], v[84:87], a[216:219]
ds_read_b128 v[156:159], v2 offset:14336
ds_read_b128 v[160:163], v2 offset:15360
v_mfma_f32_16x16x32_bf16 a[216:219], v[216:219], v[88:91], a[216:219]
v_exp_f32 v61, v61
v_mfma_f32_16x16x32_bf16 a[220:223], v[224:227], v[88:91], a[220:223]
buffer_load_dwordx4 v5, s[4:7], s59 offen offset:3072 sc1 lds
v_mfma_f32_16x16x32_bf16 a[220:223], v[220:223], v[84:87], a[220:223]
s_xor_b32 s57, s57, 196608
v_exp_f32 v62, v62
v_mfma_f32_16x16x32_bf16 v[28:31], v[8:11], v[84:87], v[28:31]
v_xor_b32 v2, 65536, v2
v_mfma_f32_16x16x32_bf16 v[28:31], v[8:11], v[88:91], v[28:31]
s_waitcnt lgkmcnt(3)
v_exp_f32 v63, v63
v_mfma_f32_16x16x32_bf16 v[36:39], v[100:103], a[0:3], 0
v_cvt_pk_bf16_f32 v96, v60, v61
v_cvt_pk_bf16_f32 v97, v62, v63
v_mfma_f32_16x16x32_bf16 v[36:39], v[104:107], a[4:7], v[36:39]
v_exp_f32 v64, v64
v_mfma_f32_16x16x32_bf16 v[36:39], v[108:111], a[8:11], v[36:39]
v_mfma_f32_16x16x32_bf16 v[36:39], v[112:115], a[12:15], v[36:39]
v_exp_f32 v65, v65
v_mfma_f32_16x16x32_bf16 v[40:43], v[128:131], a[12:15], 0
v_mfma_f32_16x16x32_bf16 v[40:43], v[124:127], a[8:11], v[40:43]
v_exp_f32 v66, v66
v_mfma_f32_16x16x32_bf16 v[40:43], v[120:123], a[4:7], v[40:43]
v_mfma_f32_16x16x32_bf16 v[40:43], v[116:119], a[0:3], v[40:43]
v_exp_f32 v67, v67
v_mfma_f32_16x16x32_bf16 v[44:47], v[132:135], a[0:3], 0
v_cvt_pk_bf16_f32 v98, v64, v65
v_cvt_pk_bf16_f32 v99, v66, v67
v_mfma_f32_16x16x32_bf16 v[44:47], v[136:139], a[4:7], v[44:47]
v_exp_f32 v36, v36
v_mfma_f32_16x16x32_bf16 v[44:47], v[140:143], a[8:11], v[44:47]
v_mfma_f32_16x16x32_bf16 v[44:47], v[144:147], a[12:15], v[44:47]
s_waitcnt lgkmcnt(0)
v_exp_f32 v37, v37
v_mfma_f32_16x16x32_bf16 v[48:51], v[160:163], a[12:15], 0
v_mfma_f32_16x16x32_bf16 v[48:51], v[156:159], a[8:11], v[48:51]
v_exp_f32 v38, v38
v_mfma_f32_16x16x32_bf16 v[48:51], v[152:155], a[4:7], v[48:51]
s_waitcnt vmcnt(16) lgkmcnt(0)
s_barrier
v_mfma_f32_16x16x32_bf16 v[48:51], v[148:151], a[0:3], v[48:51]
s_add_u32 m0, s56, 0
v_mfma_f32_16x16x32_bf16 a[224:227], v[164:167], v[92:95], a[224:227]
buffer_load_dwordx4 v4, s[4:7], s58 offen offset:0 sc1 lds
v_mfma_f32_16x16x32_bf16 a[224:227], v[168:171], v[96:99], a[224:227]
v_exp_f32 v39, v39
v_mfma_f32_16x16x32_bf16 a[228:231], v[176:179], v[96:99], a[228:231]
v_cvt_pk_bf16_f32 v68, v36, v37
v_cvt_pk_bf16_f32 v69, v38, v39
v_mfma_f32_16x16x32_bf16 a[228:231], v[172:175], v[92:95], a[228:231]
v_exp_f32 v40, v40
v_mfma_f32_16x16x32_bf16 a[232:235], v[180:183], v[92:95], a[232:235]
ds_read_b128 v[164:167], v3 offset:0
ds_read_b128 v[168:171], v3 offset:1024
v_mfma_f32_16x16x32_bf16 a[232:235], v[184:187], v[96:99], a[232:235]
v_exp_f32 v41, v41
v_mfma_f32_16x16x32_bf16 a[236:239], v[192:195], v[96:99], a[236:239]
buffer_load_dwordx4 v4, s[4:7], s58 offen offset:1024 sc1 lds
v_mfma_f32_16x16x32_bf16 a[236:239], v[188:191], v[92:95], a[236:239]
v_exp_f32 v42, v42
v_mfma_f32_16x16x32_bf16 a[240:243], v[196:199], v[92:95], a[240:243]
ds_read_b128 v[172:175], v3 offset:2048
ds_read_b128 v[176:179], v3 offset:3072
v_mfma_f32_16x16x32_bf16 a[240:243], v[200:203], v[96:99], a[240:243]
v_exp_f32 v43, v43
v_mfma_f32_16x16x32_bf16 a[244:247], v[208:211], v[96:99], a[244:247]
v_cvt_pk_bf16_f32 v70, v40, v41
v_cvt_pk_bf16_f32 v71, v42, v43
v_mfma_f32_16x16x32_bf16 a[244:247], v[204:207], v[92:95], a[244:247]
v_exp_f32 v44, v44
v_mfma_f32_16x16x32_bf16 a[248:251], v[212:215], v[92:95], a[248:251]
ds_read_b128 v[180:183], v3 offset:4096
ds_read_b128 v[184:187], v3 offset:5120
v_mfma_f32_16x16x32_bf16 a[248:251], v[216:219], v[96:99], a[248:251]
v_exp_f32 v45, v45
v_mfma_f32_16x16x32_bf16 a[252:255], v[224:227], v[96:99], a[252:255]
buffer_load_dwordx4 v4, s[4:7], s58 offen offset:2048 sc1 lds
v_mfma_f32_16x16x32_bf16 a[252:255], v[220:223], v[92:95], a[252:255]
v_exp_f32 v46, v46
v_mfma_f32_16x16x32_bf16 v[32:35], v[8:11], v[92:95], v[32:35]
ds_read_b128 v[188:191], v3 offset:6144
ds_read_b128 v[192:195], v3 offset:7168
v_mfma_f32_16x16x32_bf16 v[32:35], v[8:11], v[96:99], v[32:35]
v_exp_f32 v47, v47
v_mfma_f32_16x16x32_bf16 v[52:55], v[100:103], a[16:19], 0
v_cvt_pk_bf16_f32 v72, v44, v45
v_cvt_pk_bf16_f32 v73, v46, v47
v_mfma_f32_16x16x32_bf16 v[52:55], v[104:107], a[20:23], v[52:55]
v_exp_f32 v48, v48
v_mfma_f32_16x16x32_bf16 v[52:55], v[108:111], a[24:27], v[52:55]
ds_read_b128 v[196:199], v3 offset:8192
ds_read_b128 v[200:203], v3 offset:9216
v_mfma_f32_16x16x32_bf16 v[52:55], v[112:115], a[28:31], v[52:55]
v_exp_f32 v49, v49
v_mfma_f32_16x16x32_bf16 v[56:59], v[128:131], a[28:31], 0
ds_read_b128 v[204:207], v3 offset:10240
ds_read_b128 v[208:211], v3 offset:11264
v_mfma_f32_16x16x32_bf16 v[56:59], v[124:127], a[24:27], v[56:59]
v_exp_f32 v50, v50
v_mfma_f32_16x16x32_bf16 v[56:59], v[120:123], a[20:23], v[56:59]
ds_read_b128 v[212:215], v3 offset:12288
ds_read_b128 v[216:219], v3 offset:13312
v_mfma_f32_16x16x32_bf16 v[56:59], v[116:119], a[16:19], v[56:59]
v_exp_f32 v51, v51
v_mfma_f32_16x16x32_bf16 v[60:63], v[132:135], a[16:19], 0
v_cvt_pk_bf16_f32 v74, v48, v49
v_cvt_pk_bf16_f32 v75, v50, v51
v_mfma_f32_16x16x32_bf16 v[60:63], v[136:139], a[20:23], v[60:63]
v_exp_f32 v52, v52
v_mfma_f32_16x16x32_bf16 v[60:63], v[140:143], a[24:27], v[60:63]
ds_read_b128 v[220:223], v3 offset:14336
ds_read_b128 v[224:227], v3 offset:15360
v_mfma_f32_16x16x32_bf16 v[60:63], v[144:147], a[28:31], v[60:63]
s_sub_u32 s62, s62, 1
v_exp_f32 v53, v53
v_mfma_f32_16x16x32_bf16 v[64:67], v[160:163], a[28:31], 0
buffer_load_dwordx4 v4, s[4:7], s58 offen offset:3072 sc1 lds
v_mfma_f32_16x16x32_bf16 v[64:67], v[156:159], a[24:27], v[64:67]
s_add_u32 m0, s56, 4096
v_exp_f32 v54, v54
v_mfma_f32_16x16x32_bf16 v[64:67], v[152:155], a[20:23], v[64:67]
s_cmp_lg_u32 s62, 0
v_xor_b32 v3, 196608, v3
v_mfma_f32_16x16x32_bf16 v[64:67], v[148:151], a[16:19], v[64:67]
s_cbranch_scc1 L_at_b1
L_at_b1d:
s_waitcnt lgkmcnt(2)
v_mfma_f32_16x16x32_bf16 a[128:131], v[164:167], v[68:71], a[128:131]
buffer_load_dwordx4 v5, s[4:7], s58 offen offset:0 sc1 lds
v_mfma_f32_16x16x32_bf16 a[128:131], v[168:171], v[72:75], a[128:131]
v_exp_f32 v55, v55
v_mfma_f32_16x16x32_bf16 a[132:135], v[176:179], v[72:75], a[132:135]
v_cvt_pk_bf16_f32 v76, v52, v53
v_cvt_pk_bf16_f32 v77, v54, v55
v_mfma_f32_16x16x32_bf16 a[132:135], v[172:175], v[68:71], a[132:135]
v_exp_f32 v56, v56
v_mfma_f32_16x16x32_bf16 a[136:139], v[180:183], v[68:71], a[136:139]
buffer_load_dwordx4 v5, s[4:7], s58 offen offset:1024 sc1 lds
v_mfma_f32_16x16x32_bf16 a[136:139], v[184:187], v[72:75], a[136:139]
v_exp_f32 v57, v57
v_mfma_f32_16x16x32_bf16 a[140:143], v[192:195], v[72:75], a[140:143]
v_mfma_f32_16x16x32_bf16 a[140:143], v[188:191], v[68:71], a[140:143]
v_exp_f32 v58, v58
v_mfma_f32_16x16x32_bf16 a[144:147], v[196:199], v[68:71], a[144:147]
buffer_load_dwordx4 v5, s[4:7], s58 offen offset:2048 sc1 lds
v_mfma_f32_16x16x32_bf16 a[144:147], v[200:203], v[72:75], a[144:147]
v_exp_f32 v59, v59
v_mfma_f32_16x16x32_bf16 a[148:151], v[208:211], v[72:75], a[148:151]
v_cvt_pk_bf16_f32 v78, v56, v57
v_cvt_pk_bf16_f32 v79, v58, v59
v_mfma_f32_16x16x32_bf16 a[148:151], v[204:207], v[68:71], a[148:151]
v_exp_f32 v60, v60
v_mfma_f32_16x16x32_bf16 a[152:155], v[212:215], v[68:71], a[152:155]
buffer_load_dwordx4 v5, s[4:7], s58 offen offset:3072 sc1 lds
v_mfma_f32_16x16x32_bf16 a[152:155], v[216:219], v[72:75], a[152:155]
s_waitcnt lgkmcnt(0)
v_exp_f32 v61, v61
v_mfma_f32_16x16x32_bf16 a[156:159], v[224:227], v[72:75], a[156:159]
v_mfma_f32_16x16x32_bf16 a[156:159], v[220:223], v[68:71], a[156:159]
v_exp_f32 v62, v62
v_mfma_f32_16x16x32_bf16 v[20:23], v[8:11], v[68:71], v[20:23]
v_mfma_f32_16x16x32_bf16 v[20:23], v[8:11], v[72:75], v[20:23]
v_exp_f32 v63, v63
v_mfma_f32_16x16x32_bf16 v[36:39], v[100:103], a[32:35], 0
v_cvt_pk_bf16_f32 v80, v60, v61
v_cvt_pk_bf16_f32 v81, v62, v63
v_mfma_f32_16x16x32_bf16 v[36:39], v[104:107], a[36:39], v[36:39]
v_exp_f32 v64, v64
v_mfma_f32_16x16x32_bf16 v[36:39], v[108:111], a[40:43], v[36:39]
v_mfma_f32_16x16x32_bf16 v[36:39], v[112:115], a[44:47], v[36:39]
v_exp_f32 v65, v65
v_mfma_f32_16x16x32_bf16 v[40:43], v[128:131], a[44:47], 0
v_mfma_f32_16x16x32_bf16 v[40:43], v[124:127], a[40:43], v[40:43]
v_exp_f32 v66, v66
v_mfma_f32_16x16x32_bf16 v[40:43], v[120:123], a[36:39], v[40:43]
v_mfma_f32_16x16x32_bf16 v[40:43], v[116:119], a[32:35], v[40:43]
v_exp_f32 v67, v67
v_mfma_f32_16x16x32_bf16 v[44:47], v[132:135], a[32:35], 0
v_cvt_pk_bf16_f32 v82, v64, v65
v_cvt_pk_bf16_f32 v83, v66, v67
v_mfma_f32_16x16x32_bf16 v[44:47], v[136:139], a[36:39], v[44:47]
v_exp_f32 v36, v36
v_mfma_f32_16x16x32_bf16 v[44:47], v[140:143], a[40:43], v[44:47]
v_mfma_f32_16x16x32_bf16 v[44:47], v[144:147], a[44:47], v[44:47]
v_exp_f32 v37, v37
v_mfma_f32_16x16x32_bf16 v[48:51], v[160:163], a[44:47], 0
v_mfma_f32_16x16x32_bf16 v[48:51], v[156:159], a[40:43], v[48:51]
v_exp_f32 v38, v38
v_mfma_f32_16x16x32_bf16 v[48:51], v[152:155], a[36:39], v[48:51]
v_mfma_f32_16x16x32_bf16 v[48:51], v[148:151], a[32:35], v[48:51]
v_mfma_f32_16x16x32_bf16 a[160:163], v[164:167], v[76:79], a[160:163]
s_waitcnt vmcnt(16) lgkmcnt(0)
s_barrier
v_mfma_f32_16x16x32_bf16 a[160:163], v[168:171], v[80:83], a[160:163]
s_add_u32 s59, s58, 16777216
v_exp_f32 v39, v39
v_mfma_f32_16x16x32_bf16 a[164:167], v[176:179], v[80:83], a[164:167]
v_cvt_pk_bf16_f32 v84, v36, v37
v_cvt_pk_bf16_f32 v85, v38, v39
v_mfma_f32_16x16x32_bf16 a[164:167], v[172:175], v[76:79], a[164:167]
s_add_u32 m0, s57, 0
v_exp_f32 v40, v40
v_mfma_f32_16x16x32_bf16 a[168:171], v[180:183], v[76:79], a[168:171]
buffer_load_dwordx4 v4, s[4:7], s59 offen offset:0 sc1 lds
v_mfma_f32_16x16x32_bf16 a[168:171], v[184:187], v[80:83], a[168:171]
s_add_u32 s58, s58, 32768
v_exp_f32 v41, v41
v_mfma_f32_16x16x32_bf16 a[172:175], v[192:195], v[80:83], a[172:175]
s_cmp_eq_u32 s60, s61
v_mfma_f32_16x16x32_bf16 a[172:175], v[188:191], v[76:79], a[172:175]
s_cselect_b32 s58, 4194304, s58
v_exp_f32 v42, v42
v_mfma_f32_16x16x32_bf16 a[176:179], v[196:199], v[76:79], a[176:179]
buffer_load_dwordx4 v4, s[4:7], s59 offen offset:1024 sc1 lds
v_mfma_f32_16x16x32_bf16 a[176:179], v[200:203], v[80:83], a[176:179]
s_cmp_gt_u32 s60, 16
v_exp_f32 v43, v43
v_mfma_f32_16x16x32_bf16 a[180:183], v[208:211], v[80:83], a[180:183]
s_cselect_b32 s58, 2146435072, s58
v_cvt_pk_bf16_f32 v86, v40, v41
v_cvt_pk_bf16_f32 v87, v42, v43
v_mfma_f32_16x16x32_bf16 a[180:183], v[204:207], v[76:79], a[180:183]
s_xor_b32 s56, s56, 65536
v_exp_f32 v44, v44
v_mfma_f32_16x16x32_bf16 a[184:187], v[212:215], v[76:79], a[184:187]
buffer_load_dwordx4 v4, s[4:7], s59 offen offset:2048 sc1 lds
v_mfma_f32_16x16x32_bf16 a[184:187], v[216:219], v[80:83], a[184:187]
s_add_u32 s60, s60, 1
v_exp_f32 v45, v45
v_mfma_f32_16x16x32_bf16 a[188:191], v[224:227], v[80:83], a[188:191]
v_mfma_f32_16x16x32_bf16 a[188:191], v[220:223], v[76:79], a[188:191]
v_exp_f32 v46, v46
v_mfma_f32_16x16x32_bf16 v[24:27], v[8:11], v[76:79], v[24:27]
buffer_load_dwordx4 v4, s[4:7], s59 offen offset:3072 sc1 lds
v_mfma_f32_16x16x32_bf16 v[24:27], v[8:11], v[80:83], v[24:27]
v_exp_f32 v47, v47
v_mfma_f32_16x16x32_bf16 v[52:55], v[100:103], a[48:51], 0
v_cvt_pk_bf16_f32 v88, v44, v45
v_cvt_pk_bf16_f32 v89, v46, v47
v_mfma_f32_16x16x32_bf16 v[52:55], v[104:107], a[52:55], v[52:55]
v_exp_f32 v48, v48
v_mfma_f32_16x16x32_bf16 v[52:55], v[108:111], a[56:59], v[52:55]
ds_read_b128 v[100:103], v2 offset:0
ds_read_b128 v[104:107], v2 offset:1024
v_mfma_f32_16x16x32_bf16 v[52:55], v[112:115], a[60:63], v[52:55]
s_add_u32 m0, s57, 4096
v_exp_f32 v49, v49
v_mfma_f32_16x16x32_bf16 v[56:59], v[128:131], a[60:63], 0
buffer_load_dwordx4 v5, s[4:7], s59 offen offset:0 sc1 lds
v_mfma_f32_16x16x32_bf16 v[56:59], v[124:127], a[56:59], v[56:59]
v_exp_f32 v50, v50
v_mfma_f32_16x16x32_bf16 v[56:59], v[120:123], a[52:55], v[56:59]
ds_read_b128 v[108:111], v2 offset:2048
ds_read_b128 v[112:115], v2 offset:3072
v_mfma_f32_16x16x32_bf16 v[56:59], v[116:119], a[48:51], v[56:59]
v_exp_f32 v51, v51
v_mfma_f32_16x16x32_bf16 v[60:63], v[132:135], a[48:51], 0
v_cvt_pk_bf16_f32 v90, v48, v49
v_cvt_pk_bf16_f32 v91, v50, v51
v_mfma_f32_16x16x32_bf16 v[60:63], v[136:139], a[52:55], v[60:63]
v_exp_f32 v52, v52
v_mfma_f32_16x16x32_bf16 v[60:63], v[140:143], a[56:59], v[60:63]
ds_read_b128 v[116:119], v2 offset:4096
ds_read_b128 v[120:123], v2 offset:5120
v_mfma_f32_16x16x32_bf16 v[60:63], v[144:147], a[60:63], v[60:63]
v_exp_f32 v53, v53
v_mfma_f32_16x16x32_bf16 v[64:67], v[160:163], a[60:63], 0
buffer_load_dwordx4 v5, s[4:7], s59 offen offset:1024 sc1 lds
v_mfma_f32_16x16x32_bf16 v[64:67], v[156:159], a[56:59], v[64:67]
v_exp_f32 v54, v54
v_mfma_f32_16x16x32_bf16 v[64:67], v[152:155], a[52:55], v[64:67]
ds_read_b128 v[124:127], v2 offset:6144
ds_read_b128 v[128:131], v2 offset:7168
v_mfma_f32_16x16x32_bf16 v[64:67], v[148:151], a[48:51], v[64:67]
v_mfma_f32_16x16x32_bf16 a[192:195], v[164:167], v[84:87], a[192:195]
ds_read_b128 v[132:135], v2 offset:8192
ds_read_b128 v[136:139], v2 offset:9216
v_mfma_f32_16x16x32_bf16 a[192:195], v[168:171], v[88:91], a[192:195]
v_exp_f32 v55, v55
v_mfma_f32_16x16x32_bf16 a[196:199], v[176:179], v[88:91], a[196:199]
v_cvt_pk_bf16_f32 v92, v52, v53
v_cvt_pk_bf16_f32 v93, v54, v55
v_mfma_f32_16x16x32_bf16 a[196:199], v[172:175], v[84:87], a[196:199]
v_exp_f32 v56, v56
v_mfma_f32_16x16x32_bf16 a[200:203], v[180:183], v[84:87], a[200:203]
ds_read_b128 v[140:143], v2 offset:10240
ds_read_b128 v[144:147], v2 offset:11264
v_mfma_f32_16x16x32_bf16 a[200:203], v[184:187], v[88:91], a[200:203]
v_exp_f32 v57, v57
v_mfma_f32_16x16x32_bf16 a[204:207], v[192:195], v[88:91], a[204:207]
buffer_load_dwordx4 v5, s[4:7], s59 offen offset:2048 sc1 lds
v_mfma_f32_16x16x32_bf16 a[204:207], v[188:191], v[84:87], a[204:207]
v_exp_f32 v58, v58
v_mfma_f32_16x16x32_bf16 a[208:211], v[196:199], v[84:87], a[208:211]
ds_read_b128 v[148:151], v2 offset:12288
ds_read_b128 v[152:155], v2 offset:13312
v_mfma_f32_16x16x32_bf16 a[208:211], v[200:203], v[88:91], a[208:211]
v_exp_f32 v59, v59
v_mfma_f32_16x16x32_bf16 a[212:215], v[208:211], v[88:91], a[212:215]
v_cvt_pk_bf16_f32 v94, v56, v57
v_cvt_pk_bf16_f32 v95, v58, v59
v_mfma_f32_16x16x32_bf16 a[212:215], v[204:207], v[84:87], a[212:215]
v_exp_f32 v60, v60
v_mfma_f32_16x16x32_bf16 a[216:219], v[212:215], v[84:87], a[216:219]
ds_read_b128 v[156:159], v2 offset:14336
ds_read_b128 v[160:163], v2 offset:15360
v_mfma_f32_16x16x32_bf16 a[216:219], v[216:219], v[88:91], a[216:219]
v_exp_f32 v61, v61
v_mfma_f32_16x16x32_bf16 a[220:223], v[224:227], v[88:91], a[220:223]
buffer_load_dwordx4 v5, s[4:7], s59 offen offset:3072 sc1 lds
v_mfma_f32_16x16x32_bf16 a[220:223], v[220:223], v[84:87], a[220:223]
s_xor_b32 s57, s57, 196608
v_exp_f32 v62, v62
v_mfma_f32_16x16x32_bf16 v[28:31], v[8:11], v[84:87], v[28:31]
v_xor_b32 v2, 65536, v2
v_mfma_f32_16x16x32_bf16 v[28:31], v[8:11], v[88:91], v[28:31]
s_waitcnt lgkmcnt(3)
v_exp_f32 v63, v63
v_mfma_f32_16x16x32_bf16 v[36:39], v[100:103], a[0:3], v[12:15]
v_cvt_pk_bf16_f32 v96, v60, v61
v_cvt_pk_bf16_f32 v97, v62, v63
v_mfma_f32_16x16x32_bf16 v[36:39], v[104:107], a[4:7], v[36:39]
v_exp_f32 v64, v64
v_mfma_f32_16x16x32_bf16 v[36:39], v[108:111], a[8:11], v[36:39]
v_mfma_f32_16x16x32_bf16 v[36:39], v[112:115], a[12:15], v[36:39]
v_exp_f32 v65, v65
v_exp_f32 v66, v66
v_exp_f32 v67, v67
v_cvt_pk_bf16_f32 v98, v64, v65
v_cvt_pk_bf16_f32 v99, v66, v67
s_nop 2
v_exp_f32 v36, v36
v_exp_f32 v37, v37
v_exp_f32 v38, v38
s_waitcnt vmcnt(16) lgkmcnt(0)
s_barrier
s_add_u32 m0, s56, 0
v_mfma_f32_16x16x32_bf16 a[224:227], v[164:167], v[92:95], a[224:227]
buffer_load_dwordx4 v4, s[4:7], s58 offen offset:0 sc1 lds
v_mfma_f32_16x16x32_bf16 a[224:227], v[168:171], v[96:99], a[224:227]
v_exp_f32 v39, v39
v_mfma_f32_16x16x32_bf16 a[228:231], v[176:179], v[96:99], a[228:231]
v_cvt_pk_bf16_f32 v68, v36, v37
v_cvt_pk_bf16_f32 v69, v38, v39
v_mfma_f32_16x16x32_bf16 a[228:231], v[172:175], v[92:95], a[228:231]
v_mfma_f32_16x16x32_bf16 a[232:235], v[180:183], v[92:95], a[232:235]
ds_read_b128 v[164:167], v3 offset:0
ds_read_b128 v[168:171], v3 offset:1024
v_mfma_f32_16x16x32_bf16 a[232:235], v[184:187], v[96:99], a[232:235]
v_mfma_f32_16x16x32_bf16 a[236:239], v[192:195], v[96:99], a[236:239]
buffer_load_dwordx4 v4, s[4:7], s58 offen offset:1024 sc1 lds
v_mfma_f32_16x16x32_bf16 a[236:239], v[188:191], v[92:95], a[236:239]
v_mfma_f32_16x16x32_bf16 a[240:243], v[196:199], v[92:95], a[240:243]
ds_read_b128 v[172:175], v3 offset:2048
ds_read_b128 v[176:179], v3 offset:3072
v_mfma_f32_16x16x32_bf16 a[240:243], v[200:203], v[96:99], a[240:243]
v_mfma_f32_16x16x32_bf16 a[244:247], v[208:211], v[96:99], a[244:247]
v_mov_b32 v70, 0
v_mov_b32 v71, 0
v_mfma_f32_16x16x32_bf16 a[244:247], v[204:207], v[92:95], a[244:247]
v_mfma_f32_16x16x32_bf16 a[248:251], v[212:215], v[92:95], a[248:251]
ds_read_b128 v[180:183], v3 offset:4096
ds_read_b128 v[184:187], v3 offset:5120
v_mfma_f32_16x16x32_bf16 a[248:251], v[216:219], v[96:99], a[248:251]
v_mfma_f32_16x16x32_bf16 a[252:255], v[224:227], v[96:99], a[252:255]
buffer_load_dwordx4 v4, s[4:7], s58 offen offset:2048 sc1 lds
v_mfma_f32_16x16x32_bf16 a[252:255], v[220:223], v[92:95], a[252:255]
v_mfma_f32_16x16x32_bf16 v[32:35], v[8:11], v[92:95], v[32:35]
ds_read_b128 v[188:191], v3 offset:6144
ds_read_b128 v[192:195], v3 offset:7168
v_mfma_f32_16x16x32_bf16 v[32:35], v[8:11], v[96:99], v[32:35]
v_mfma_f32_16x16x32_bf16 v[52:55], v[100:103], a[16:19], 0
v_mfma_f32_16x16x32_bf16 v[52:55], v[104:107], a[20:23], v[52:55]
v_mfma_f32_16x16x32_bf16 v[52:55], v[108:111], a[24:27], v[52:55]
ds_read_b128 v[196:199], v3 offset:8192
ds_read_b128 v[200:203], v3 offset:9216
v_mfma_f32_16x16x32_bf16 v[52:55], v[112:115], a[28:31], v[52:55]
v_mfma_f32_16x16x32_bf16 v[56:59], v[128:131], a[28:31], v[16:19]
ds_read_b128 v[204:207], v3 offset:10240
ds_read_b128 v[208:211], v3 offset:11264
v_mfma_f32_16x16x32_bf16 v[56:59], v[124:127], a[24:27], v[56:59]
v_mfma_f32_16x16x32_bf16 v[56:59], v[120:123], a[20:23], v[56:59]
ds_read_b128 v[212:215], v3 offset:12288
ds_read_b128 v[216:219], v3 offset:13312
v_mfma_f32_16x16x32_bf16 v[56:59], v[116:119], a[16:19], v[56:59]
v_exp_f32 v52, v52
ds_read_b128 v[220:223], v3 offset:14336
ds_read_b128 v[224:227], v3 offset:15360
v_exp_f32 v53, v53
buffer_load_dwordx4 v4, s[4:7], s58 offen offset:3072 sc1 lds
s_add_u32 m0, s56, 4096
v_exp_f32 v54, v54
v_xor_b32 v3, 196608, v3
L_at_x:
s_waitcnt lgkmcnt(8)
v_mfma_f32_16x16x32_bf16 a[128:131], v[164:167], v[68:71], a[128:131]
buffer_load_dwordx4 v5, s[4:7], s58 offen offset:0 sc1 lds
s_and_b32 s26, s2, 31
v_exp_f32 v55, v55
v_mfma_f32_16x16x32_bf16 a[132:135], v[172:175], v[68:71], a[132:135]
s_lshl_b32 s27, 1, s26
v_cvt_pk_bf16_f32 v76, v52, v53
v_cvt_pk_bf16_f32 v77, v54, v55
s_sub_u32 s27, s27, 1
v_exp_f32 v56, v56
v_mfma_f32_16x16x32_bf16 a[136:139], v[180:183], v[68:71], a[136:139]
s_and_b32 s27, s27, 21504
buffer_load_dwordx4 v5, s[4:7], s58 offen offset:1024 sc1 lds
s_bcnt1_i32_b32 s27, s27
v_exp_f32 v57, v57
v_mfma_f32_16x16x32_bf16 a[140:143], v[188:191], v[68:71], a[140:143]
s_waitcnt lgkmcnt(0)
s_mul_i32 s89, s50, 29
s_add_u32 s89, s89, s26
v_exp_f32 v58, v58
v_mfma_f32_16x16x32_bf16 a[144:147], v[196:199], v[68:71], a[144:147]
s_sub_u32 s89, s89, s27
buffer_load_dwordx4 v5, s[4:7], s58 offen offset:2048 sc1 lds
s_bitcmp1_b32 21504, s26
v_exp_f32 v59, v59
v_mfma_f32_16x16x32_bf16 a[148:151], v[204:207], v[68:71], a[148:151]
s_cselect_b32 s89, 0x400, s89
v_cvt_pk_bf16_f32 v78, v56, v57
v_cvt_pk_bf16_f32 v79, v58, v59
v_mfma_f32_16x16x32_bf16 a[152:155], v[212:215], v[68:71], a[152:155]
buffer_load_dwordx4 v5, s[4:7], s58 offen offset:3072 sc1 lds
v_mfma_f32_16x16x32_bf16 a[156:159], v[220:223], v[68:71], a[156:159]
s_cmp_lt_u32 s89, 38
s_cselect_b32 s20, s36, s28
v_mfma_f32_16x16x32_bf16 v[20:23], v[8:11], v[68:71], v[20:23]
s_cselect_b32 s21, s37, s29
s_cselect_b32 s22, s38, s30
v_mfma_f32_16x16x32_bf16 v[36:39], v[100:103], a[32:35], 0
s_cselect_b32 s24, 0, 2211840
v_mfma_f32_16x16x32_bf16 v[36:39], v[104:107], a[36:39], v[36:39]
s_lshl_b32 s88, s48, 11
v_mfma_f32_16x16x32_bf16 v[36:39], v[108:111], a[40:43], v[36:39]
s_lshl_b32 s25, s48, 10
v_mfma_f32_16x16x32_bf16 v[36:39], v[112:115], a[44:47], v[36:39]
s_add_u32 s25, s25, 62914560
v_mfma_f32_16x16x32_bf16 v[40:43], v[128:131], a[44:47], 0
s_add_u32 s26, s89, 0
v_mfma_f32_16x16x32_bf16 v[40:43], v[124:127], a[40:43], v[40:43]
v_mfma_f32_16x16x32_bf16 v[40:43], v[120:123], a[36:39], v[40:43]
s_mul_i32 s27, s26, 52429
v_mfma_f32_16x16x32_bf16 v[40:43], v[116:119], a[32:35], v[40:43]
s_lshr_b32 s27, s27, 18
v_mfma_f32_16x16x32_bf16 v[44:47], v[132:135], a[32:35], v[12:15]
s_mul_i32 s12, s27, 5
v_mfma_f32_16x16x32_bf16 v[44:47], v[136:139], a[36:39], v[44:47]
s_sub_u32 s26, s26, s12
v_exp_f32 v36, v36
v_mfma_f32_16x16x32_bf16 v[44:47], v[140:143], a[40:43], v[44:47]
s_mul_i32 s27, s27, 40960
v_mfma_f32_16x16x32_bf16 v[44:47], v[144:147], a[44:47], v[44:47]
s_lshl_b32 s12, s26, 8
v_exp_f32 v37, v37
s_add_u32 s12, s12, s27
s_sub_u32 s12, s12, 0
v_exp_f32 v38, v38
s_lshl_b32 s26, s26, 13
v_mfma_f32_16x16x32_bf16 a[160:163], v[164:167], v[76:79], a[160:163]
s_waitcnt vmcnt(16) lgkmcnt(0)
s_barrier
s_add_u32 s59, s58, 16777216
v_exp_f32 v39, v39
v_mfma_f32_16x16x32_bf16 a[164:167], v[172:175], v[76:79], a[164:167]
v_cvt_pk_bf16_f32 v84, v36, v37
v_cvt_pk_bf16_f32 v85, v38, v39
s_add_u32 m0, s57, 0
v_exp_f32 v40, v40
v_mfma_f32_16x16x32_bf16 a[168:171], v[180:183], v[76:79], a[168:171]
buffer_load_dwordx4 v4, s[4:7], s59 offen offset:0 sc1 lds
s_add_u32 s58, s58, 32768
v_exp_f32 v41, v41
v_mfma_f32_16x16x32_bf16 a[172:175], v[188:191], v[76:79], a[172:175]
s_cmp_eq_u32 s60, s61
s_cselect_b32 s58, 4194304, s58
v_exp_f32 v42, v42
v_mfma_f32_16x16x32_bf16 a[176:179], v[196:199], v[76:79], a[176:179]
buffer_load_dwordx4 v4, s[4:7], s59 offen offset:1024 sc1 lds
s_cmp_gt_u32 s60, 16
v_exp_f32 v43, v43
v_mfma_f32_16x16x32_bf16 a[180:183], v[204:207], v[76:79], a[180:183]
s_cselect_b32 s58, 2146435072, s58
v_cvt_pk_bf16_f32 v86, v40, v41
v_cvt_pk_bf16_f32 v87, v42, v43
s_xor_b32 s56, s56, 65536
v_exp_f32 v44, v44
v_mfma_f32_16x16x32_bf16 a[184:187], v[212:215], v[76:79], a[184:187]
buffer_load_dwordx4 v4, s[4:7], s59 offen offset:2048 sc1 lds
s_add_u32 s60, s60, 1
v_exp_f32 v45, v45
v_mfma_f32_16x16x32_bf16 a[188:191], v[220:223], v[76:79], a[188:191]
s_add_u32 s26, s26, s27
s_add_u32 s16, s26, s25
v_exp_f32 v46, v46
v_mfma_f32_16x16x32_bf16 v[24:27], v[8:11], v[76:79], v[24:27]
s_add_u32 s26, s89, 232
buffer_load_dwordx4 v4, s[4:7], s59 offen offset:3072 sc1 lds
s_mul_i32 s27, s26, 52429
v_exp_f32 v47, v47
v_mfma_f32_16x16x32_bf16 v[52:55], v[100:103], a[48:51], 0
s_lshr_b32 s27, s27, 18
v_cvt_pk_bf16_f32 v88, v44, v45
v_cvt_pk_bf16_f32 v89, v46, v47
v_mfma_f32_16x16x32_bf16 v[52:55], v[104:107], a[52:55], v[52:55]
s_mul_i32 s13, s27, 5
v_mfma_f32_16x16x32_bf16 v[52:55], v[108:111], a[56:59], v[52:55]
s_sub_u32 s26, s26, s13
ds_read_b128 v[100:103], v2 offset:0
ds_read_b128 v[104:107], v2 offset:1024
v_mfma_f32_16x16x32_bf16 v[52:55], v[112:115], a[60:63], v[52:55]
s_add_u32 m0, s57, 4096
v_mfma_f32_16x16x32_bf16 v[56:59], v[128:131], a[60:63], 0
s_mul_i32 s27, s27, 40960
buffer_load_dwordx4 v5, s[4:7], s59 offen offset:0 sc1 lds
v_mfma_f32_16x16x32_bf16 v[56:59], v[124:127], a[56:59], v[56:59]
s_lshl_b32 s13, s26, 8
v_mfma_f32_16x16x32_bf16 v[56:59], v[120:123], a[52:55], v[56:59]
s_add_u32 s13, s13, s27
ds_read_b128 v[108:111], v2 offset:2048
ds_read_b128 v[112:115], v2 offset:3072
v_mfma_f32_16x16x32_bf16 v[56:59], v[116:119], a[48:51], v[56:59]
s_sub_u32 s13, s13, s24
v_mfma_f32_16x16x32_bf16 v[60:63], v[132:135], a[48:51], 0
s_lshl_b32 s26, s26, 13
v_mov_b32 v90, 0
v_mov_b32 v91, 0
v_mfma_f32_16x16x32_bf16 v[60:63], v[136:139], a[52:55], v[60:63]
s_add_u32 s26, s26, s27
v_exp_f32 v52, v52
v_mfma_f32_16x16x32_bf16 v[60:63], v[140:143], a[56:59], v[60:63]
s_add_u32 s17, s26, s25
ds_read_b128 v[116:119], v2 offset:4096
ds_read_b128 v[120:123], v2 offset:5120
v_mfma_f32_16x16x32_bf16 v[60:63], v[144:147], a[60:63], v[60:63]
s_add_u32 s26, s89, 464
v_exp_f32 v53, v53
v_mfma_f32_16x16x32_bf16 v[64:67], v[160:163], a[60:63], v[16:19]
s_mul_i32 s27, s26, 52429
buffer_load_dwordx4 v5, s[4:7], s59 offen offset:1024 sc1 lds
v_mfma_f32_16x16x32_bf16 v[64:67], v[156:159], a[56:59], v[64:67]
s_lshr_b32 s27, s27, 18
v_exp_f32 v54, v54
v_mfma_f32_16x16x32_bf16 v[64:67], v[152:155], a[52:55], v[64:67]
s_mul_i32 s14, s27, 5
ds_read_b128 v[124:127], v2 offset:6144
ds_read_b128 v[128:131], v2 offset:7168
v_mfma_f32_16x16x32_bf16 v[64:67], v[148:151], a[48:51], v[64:67]
s_sub_u32 s26, s26, s14
v_mfma_f32_16x16x32_bf16 a[192:195], v[164:167], v[84:87], a[192:195]
s_mul_i32 s27, s27, 40960
ds_read_b128 v[132:135], v2 offset:8192
ds_read_b128 v[136:139], v2 offset:9216
v_mfma_f32_16x16x32_bf16 a[192:195], v[168:171], v[88:91], a[192:195]
s_lshl_b32 s14, s26, 8
v_exp_f32 v55, v55
v_mfma_f32_16x16x32_bf16 a[196:199], v[176:179], v[88:91], a[196:199]
s_add_u32 s14, s14, s27
v_cvt_pk_bf16_f32 v92, v52, v53
v_cvt_pk_bf16_f32 v93, v54, v55
v_mfma_f32_16x16x32_bf16 a[196:199], v[172:175], v[84:87], a[196:199]
s_sub_u32 s14, s14, 2211840
v_exp_f32 v56, v56
v_mfma_f32_16x16x32_bf16 a[200:203], v[180:183], v[84:87], a[200:203]
s_lshl_b32 s26, s26, 13
ds_read_b128 v[140:143], v2 offset:10240
ds_read_b128 v[144:147], v2 offset:11264
v_mfma_f32_16x16x32_bf16 a[200:203], v[184:187], v[88:91], a[200:203]
s_add_u32 s26, s26, s27
v_exp_f32 v57, v57
v_mfma_f32_16x16x32_bf16 a[204:207], v[192:195], v[88:91], a[204:207]
s_add_u32 s18, s26, s25
buffer_load_dwordx4 v5, s[4:7], s59 offen offset:2048 sc1 lds
v_mfma_f32_16x16x32_bf16 a[204:207], v[188:191], v[84:87], a[204:207]
s_add_u32 s26, s89, 696
v_exp_f32 v58, v58
v_mfma_f32_16x16x32_bf16 a[208:211], v[196:199], v[84:87], a[208:211]
s_mul_i32 s27, s26, 52429
ds_read_b128 v[148:151], v2 offset:12288
ds_read_b128 v[152:155], v2 offset:13312
v_mfma_f32_16x16x32_bf16 a[208:211], v[200:203], v[88:91], a[208:211]
s_lshr_b32 s27, s27, 18
v_exp_f32 v59, v59
v_mfma_f32_16x16x32_bf16 a[212:215], v[208:211], v[88:91], a[212:215]
s_mul_i32 s15, s27, 5
v_cvt_pk_bf16_f32 v94, v56, v57
v_cvt_pk_bf16_f32 v95, v58, v59
v_mfma_f32_16x16x32_bf16 a[212:215], v[204:207], v[84:87], a[212:215]
s_sub_u32 s26, s26, s15
v_exp_f32 v60, v60
v_mfma_f32_16x16x32_bf16 a[216:219], v[212:215], v[84:87], a[216:219]
s_mul_i32 s27, s27, 40960
ds_read_b128 v[156:159], v2 offset:14336
ds_read_b128 v[160:163], v2 offset:15360
v_mfma_f32_16x16x32_bf16 a[216:219], v[216:219], v[88:91], a[216:219]
s_lshl_b32 s15, s26, 8
v_exp_f32 v61, v61
v_mfma_f32_16x16x32_bf16 a[220:223], v[224:227], v[88:91], a[220:223]
s_add_u32 s15, s15, s27
buffer_load_dwordx4 v5, s[4:7], s59 offen offset:3072 sc1 lds
v_mfma_f32_16x16x32_bf16 a[220:223], v[220:223], v[84:87], a[220:223]
s_xor_b32 s57, s57, 196608
v_exp_f32 v62, v62
v_mfma_f32_16x16x32_bf16 v[28:31], v[8:11], v[84:87], v[28:31]
s_sub_u32 s15, s15, 2211840
v_xor_b32 v2, 65536, v2
v_mfma_f32_16x16x32_bf16 v[28:31], v[8:11], v[88:91], v[28:31]
s_waitcnt lgkmcnt(2)
s_lshl_b32 s26, s26, 13
v_exp_f32 v63, v63
v_mfma_f32_16x16x32_bf16 v[36:39], v[100:103], a[64:67], 0
s_add_u32 s26, s26, s27
v_cvt_pk_bf16_f32 v96, v60, v61
v_cvt_pk_bf16_f32 v97, v62, v63
v_mfma_f32_16x16x32_bf16 v[36:39], v[104:107], a[68:71], v[36:39]
s_add_u32 s19, s26, s25
v_exp_f32 v64, v64
v_mfma_f32_16x16x32_bf16 v[36:39], v[108:111], a[72:75], v[36:39]
s_cmp_lt_u32 s89, 232
v_lshrrev_b32 v6, 1, v0
v_mul_u32_u24 v6, 1280, v6
v_mfma_f32_16x16x32_bf16 v[36:39], v[112:115], a[76:79], v[36:39]
s_cselect_b32 s16, s16, 2146435072
v_exp_f32 v65, v65
v_mfma_f32_16x16x32_bf16 v[40:43], v[128:131], a[76:79], 0
s_cselect_b32 s17, s17, 2146435072
v_and_b32 v7, 1, v0
v_lshl_add_u32 v6, v7, 7, v6
v_mfma_f32_16x16x32_bf16 v[40:43], v[124:127], a[72:75], v[40:43]
s_cselect_b32 s18, s18, 2146435072
v_exp_f32 v66, v66
v_mfma_f32_16x16x32_bf16 v[40:43], v[120:123], a[68:71], v[40:43]
s_cmp_lt_u32 s89, 214
v_mfma_f32_16x16x32_bf16 v[40:43], v[116:119], a[64:67], v[40:43]
s_cselect_b32 s19, s19, 2146435072
v_exp_f32 v67, v67
v_mfma_f32_16x16x32_bf16 v[44:47], v[132:135], a[64:67], 0
s_cmp_eq_u32 s48, 0
v_cvt_pk_bf16_f32 v98, v64, v65
v_cvt_pk_bf16_f32 v99, v66, v67
v_mfma_f32_16x16x32_bf16 v[44:47], v[136:139], a[68:71], v[44:47]
s_cselect_b32 s24, s36, s20
v_exp_f32 v36, v36
v_mfma_f32_16x16x32_bf16 v[44:47], v[140:143], a[72:75], v[44:47]
s_cselect_b32 s25, s37, s21
v_mfma_f32_16x16x32_bf16 v[44:47], v[144:147], a[76:79], v[44:47]
s_waitcnt lgkmcnt(0)
s_cselect_b32 s26, s38, s22
v_exp_f32 v37, v37
v_mfma_f32_16x16x32_bf16 v[48:51], v[160:163], a[76:79], 0
s_cselect_b32 s63, s12, s13
v_mfma_f32_16x16x32_bf16 v[48:51], v[156:159], a[72:75], v[48:51]
v_exp_f32 v38, v38
v_mfma_f32_16x16x32_bf16 v[48:51], v[152:155], a[68:71], v[48:51]
s_waitcnt vmcnt(16) lgkmcnt(0)
s_barrier
v_mfma_f32_16x16x32_bf16 v[48:51], v[148:151], a[64:67], v[48:51]
s_add_u32 m0, s56, 0
v_mfma_f32_16x16x32_bf16 a[224:227], v[164:167], v[92:95], a[224:227]
s_cmp_eq_u32 s48, 2
buffer_load_dwordx4 v4, s[4:7], s58 offen offset:0 sc1 lds
v_mfma_f32_16x16x32_bf16 a[224:227], v[168:171], v[96:99], a[224:227]
s_cselect_b32 s65, s14, s15
v_exp_f32 v39, v39
v_mfma_f32_16x16x32_bf16 a[228:231], v[176:179], v[96:99], a[228:231]
s_cmp_ge_u32 s48, 2
v_cvt_pk_bf16_f32 v68, v36, v37
v_cvt_pk_bf16_f32 v69, v38, v39
v_mfma_f32_16x16x32_bf16 a[228:231], v[172:175], v[92:95], a[228:231]
s_cselect_b32 s24, s28, s24
v_exp_f32 v40, v40
v_mfma_f32_16x16x32_bf16 a[232:235], v[180:183], v[92:95], a[232:235]
s_cselect_b32 s25, s29, s25
ds_read_b128 v[164:167], v3 offset:0
ds_read_b128 v[168:171], v3 offset:1024
v_mfma_f32_16x16x32_bf16 a[232:235], v[184:187], v[96:99], a[232:235]
s_cselect_b32 s26, s30, s26
v_exp_f32 v41, v41
v_mfma_f32_16x16x32_bf16 a[236:239], v[192:195], v[96:99], a[236:239]
s_cselect_b32 s63, s65, s63
buffer_load_dwordx4 v4, s[4:7], s58 offen offset:1024 sc1 lds
v_mfma_f32_16x16x32_bf16 a[236:239], v[188:191], v[92:95], a[236:239]
s_mov_b32 s27, 0x20000
v_exp_f32 v42, v42
v_mfma_f32_16x16x32_bf16 a[240:243], v[196:199], v[92:95], a[240:243]
ds_read_b128 v[172:175], v3 offset:2048
ds_read_b128 v[176:179], v3 offset:3072
v_mfma_f32_16x16x32_bf16 a[240:243], v[200:203], v[96:99], a[240:243]
v_exp_f32 v43, v43
v_mfma_f32_16x16x32_bf16 a[244:247], v[208:211], v[96:99], a[244:247]
v_cvt_pk_bf16_f32 v70, v40, v41
v_cvt_pk_bf16_f32 v71, v42, v43
v_mfma_f32_16x16x32_bf16 a[244:247], v[204:207], v[92:95], a[244:247]
v_exp_f32 v44, v44
v_mfma_f32_16x16x32_bf16 a[248:251], v[212:215], v[92:95], a[248:251]
ds_read_b128 v[180:183], v3 offset:4096
ds_read_b128 v[184:187], v3 offset:5120
v_mfma_f32_16x16x32_bf16 a[248:251], v[216:219], v[96:99], a[248:251]
v_exp_f32 v45, v45
v_mfma_f32_16x16x32_bf16 a[252:255], v[224:227], v[96:99], a[252:255]
buffer_load_dwordx4 v4, s[4:7], s58 offen offset:2048 sc1 lds
v_mfma_f32_16x16x32_bf16 a[252:255], v[220:223], v[92:95], a[252:255]
v_exp_f32 v46, v46
v_mfma_f32_16x16x32_bf16 v[32:35], v[8:11], v[92:95], v[32:35]
ds_read_b128 v[188:191], v3 offset:6144
ds_read_b128 v[192:195], v3 offset:7168
v_mfma_f32_16x16x32_bf16 v[32:35], v[8:11], v[96:99], v[32:35]
v_exp_f32 v47, v47
v_mfma_f32_16x16x32_bf16 v[52:55], v[100:103], a[80:83], 0
v_cvt_pk_bf16_f32 v72, v44, v45
v_cvt_pk_bf16_f32 v73, v46, v47
v_mfma_f32_16x16x32_bf16 v[52:55], v[104:107], a[84:87], v[52:55]
v_exp_f32 v48, v48
v_mfma_f32_16x16x32_bf16 v[52:55], v[108:111], a[88:91], v[52:55]
ds_read_b128 v[196:199], v3 offset:8192
ds_read_b128 v[200:203], v3 offset:9216
v_mfma_f32_16x16x32_bf16 v[52:55], v[112:115], a[92:95], v[52:55]
v_exp_f32 v49, v49
v_mfma_f32_16x16x32_bf16 v[56:59], v[128:131], a[92:95], 0
ds_read_b128 v[204:207], v3 offset:10240
ds_read_b128 v[208:211], v3 offset:11264
v_mfma_f32_16x16x32_bf16 v[56:59], v[124:127], a[88:91], v[56:59]
v_exp_f32 v50, v50
v_mfma_f32_16x16x32_bf16 v[56:59], v[120:123], a[84:87], v[56:59]
ds_read_b128 v[212:215], v3 offset:12288
ds_read_b128 v[216:219], v3 offset:13312
v_mfma_f32_16x16x32_bf16 v[56:59], v[116:119], a[80:83], v[56:59]
v_exp_f32 v51, v51
v_mfma_f32_16x16x32_bf16 v[60:63], v[132:135], a[80:83], 0
v_cvt_pk_bf16_f32 v74, v48, v49
v_cvt_pk_bf16_f32 v75, v50, v51
v_mfma_f32_16x16x32_bf16 v[60:63], v[136:139], a[84:87], v[60:63]
v_exp_f32 v52, v52
v_mfma_f32_16x16x32_bf16 v[60:63], v[140:143], a[88:91], v[60:63]
ds_read_b128 v[220:223], v3 offset:14336
ds_read_b128 v[224:227], v3 offset:15360
v_mfma_f32_16x16x32_bf16 v[60:63], v[144:147], a[92:95], v[60:63]
v_exp_f32 v53, v53
v_mfma_f32_16x16x32_bf16 v[64:67], v[160:163], a[92:95], 0
buffer_load_dwordx4 v4, s[4:7], s58 offen offset:3072 sc1 lds
v_mfma_f32_16x16x32_bf16 v[64:67], v[156:159], a[88:91], v[64:67]
s_add_u32 m0, s56, 4096
v_exp_f32 v54, v54
v_mfma_f32_16x16x32_bf16 v[64:67], v[152:155], a[84:87], v[64:67]
v_xor_b32 v3, 196608, v3
v_mfma_f32_16x16x32_bf16 v[64:67], v[148:151], a[80:83], v[64:67]
buffer_load_dword v7, v6, s[24:27], s63 offen
L_at_f1:
s_cmp_eq_u32 s54, 1
s_cbranch_scc1 L_at_f11
s_lshl_b32 s51, s48, 13
v_add_u32 v228, s51, v1
s_sub_u32 s52, s51, 0
v_xor_b32 v229, 196608, v3
v_add_u32 v229, s52, v229
v_xor_b32 v230, 65536, v2
v_and_b32 v230, 0x38000, v230
v_lshrrev_b32 v231, 2, v1
s_lshl_b32 s52, s48, 10
s_add_u32 s52, s52, 4096
v_add3_u32 v231, v230, v231, s52
v_and_b32 v232, 63, v231
v_add3_u32 v230, v230, v232, s52
v_xor_b32 v232, 0x400, v230
s_waitcnt lgkmcnt(0)
s_barrier
ds_write_b32 v231, v20 offset:0
ds_write_b32 v231, v24 offset:256
ds_write_b32 v231, v28 offset:512
ds_write_b32 v231, v32 offset:768
ds_write_b128 v228, a[192:195] offset:0
s_lshl_b32 s51, s50, 3
s_add_u32 s51, s51, 0
s_add_u32 s52, s51, s55
s_sub_u32 s53, s51, s55
ds_write_b128 v228, a[196:199] offset:1024
s_add_u32 s53, s53, 3
s_mul_i32 s52, s52, 186368
s_mul_i32 s53, s53, 186368
s_lshl_b32 s51, s49, 12
ds_write_b128 v228, a[200:203] offset:2048
s_add_u32 s51, s51, 37804032
s_add_u32 s52, s52, s51
s_add_u32 s53, s53, s51
v_accvgpr_read_b32 v28, a128
ds_write_b128 v228, a[204:207] offset:3072
v_accvgpr_read_b32 v29, a129
v_accvgpr_read_b32 v30, a130
v_accvgpr_read_b32 v31, a131
v_accvgpr_read_b32 v32, a132
ds_write_b128 v228, a[208:211] offset:4096
v_accvgpr_read_b32 v33, a133
v_accvgpr_read_b32 v34, a134
v_accvgpr_read_b32 v35, a135
v_accvgpr_read_b32 v36, a136
ds_write_b128 v228, a[212:215] offset:5120
v_accvgpr_read_b32 v37, a137
v_accvgpr_read_b32 v38, a138
v_accvgpr_read_b32 v39, a139
v_accvgpr_read_b32 v40, a140
ds_write_b128 v228, a[216:219] offset:6144
v_accvgpr_read_b32 v41, a141
v_accvgpr_read_b32 v42, a142
v_accvgpr_read_b32 v43, a143
v_accvgpr_read_b32 v44, a144
ds_write_b128 v228, a[220:223] offset:7168
v_accvgpr_read_b32 v45, a145
v_accvgpr_read_b32 v46, a146
v_accvgpr_read_b32 v47, a147
v_accvgpr_read_b32 v48, a148
ds_write_b128 v229, a[224:227] offset:0
v_accvgpr_read_b32 v49, a149
v_accvgpr_read_b32 v50, a150
v_accvgpr_read_b32 v51, a151
v_accvgpr_read_b32 v84, a152
ds_write_b128 v229, a[228:231] offset:1024
v_accvgpr_read_b32 v85, a153
v_accvgpr_read_b32 v86, a154
v_accvgpr_read_b32 v87, a155
v_accvgpr_read_b32 v88, a156
ds_write_b128 v229, a[232:235] offset:2048
v_accvgpr_read_b32 v89, a157
v_accvgpr_read_b32 v90, a158
v_accvgpr_read_b32 v91, a159
v_accvgpr_read_b32 v92, a160
ds_write_b128 v229, a[236:239] offset:3072
v_accvgpr_read_b32 v93, a161
v_accvgpr_read_b32 v94, a162
v_accvgpr_read_b32 v95, a163
v_accvgpr_read_b32 v96, a164
ds_write_b128 v229, a[240:243] offset:4096
v_accvgpr_read_b32 v97, a165
v_accvgpr_read_b32 v98, a166
v_accvgpr_read_b32 v99, a167
ds_write_b128 v229, a[244:247] offset:5120
ds_write_b128 v229, a[248:251] offset:6144
ds_write_b128 v229, a[252:255] offset:7168
v_xor_b32 v228, 0x2000, v228
v_xor_b32 v229, 0x2000, v229
s_waitcnt lgkmcnt(0)
s_barrier
ds_read_b32 v233, v230 offset:0
ds_read_b32 v234, v232 offset:0
ds_read_b32 v235, v230 offset:256
ds_read_b32 v236, v232 offset:256
ds_read_b128 v[244:247], v228 offset:0
ds_read_b128 v[248:251], v228 offset:1024
ds_read_b128 v[20:23], v228 offset:2048
ds_read_b128 v[24:27], v228 offset:3072
s_mov_b32 s86, 0x2b800000
s_mov_b32 s87, 0x5d800000
s_waitcnt lgkmcnt(6)
v_add_f32 v233, v233, v234
v_cmp_nle_f32 s[32:33], s86, v233
v_cmp_nge_f32 s[34:35], s87, v233
v_rcp_f32 v234, v233
s_waitcnt lgkmcnt(4)
v_add_f32 v235, v235, v236
v_cmp_nle_f32 s[96:97], s86, v235
v_cmp_nge_f32 s[98:99], s87, v235
v_rcp_f32 v236, v235
s_barrier
s_waitcnt lgkmcnt(3)
v_pk_add_f32 v[28:29], v[28:29], v[244:245]
v_pk_add_f32 v[30:31], v[30:31], v[246:247]
s_waitcnt lgkmcnt(2)
v_pk_add_f32 v[32:33], v[32:33], v[248:249]
v_pk_add_f32 v[34:35], v[34:35], v[250:251]
ds_read_b128 v[244:247], v228 offset:4096
ds_read_b128 v[248:251], v228 offset:5120
v_pk_mul_f32 v[28:29], v[28:29], v[234:235] op_sel_hi:[1,0]
v_pk_mul_f32 v[30:31], v[30:31], v[234:235] op_sel_hi:[1,0]
v_pk_mul_f32 v[32:33], v[32:33], v[234:235] op_sel_hi:[1,0]
v_pk_mul_f32 v[34:35], v[34:35], v[234:235] op_sel_hi:[1,0]
v_cvt_pk_bf16_f32 v28, v28, v29
v_cvt_pk_bf16_f32 v29, v30, v31
v_cvt_pk_bf16_f32 v30, v32, v33
v_cvt_pk_bf16_f32 v31, v34, v35
buffer_store_dwordx4 v[28:31], v1, s[4:7], s52 offen offset:0 sc1
s_nop 0
v_mfma_f32_16x16x32_bf16 v[240:243], v[8:11], v[28:31], 0
v_accvgpr_read_b32 v28, a168
v_accvgpr_read_b32 v29, a169
v_accvgpr_read_b32 v30, a170
v_accvgpr_read_b32 v31, a171
v_accvgpr_read_b32 v32, a172
v_accvgpr_read_b32 v33, a173
v_accvgpr_read_b32 v34, a174
v_accvgpr_read_b32 v35, a175
s_waitcnt lgkmcnt(2)
v_pk_add_f32 v[36:37], v[36:37], v[20:21]
v_pk_add_f32 v[38:39], v[38:39], v[22:23]
v_pk_add_f32 v[40:41], v[40:41], v[24:25]
v_pk_add_f32 v[42:43], v[42:43], v[26:27]
ds_read_b128 v[20:23], v228 offset:6144
ds_read_b128 v[24:27], v228 offset:7168
v_pk_mul_f32 v[36:37], v[36:37], v[234:235] op_sel_hi:[1,0]
v_pk_mul_f32 v[38:39], v[38:39], v[234:235] op_sel_hi:[1,0]
v_pk_mul_f32 v[40:41], v[40:41], v[234:235] op_sel_hi:[1,0]
v_pk_mul_f32 v[42:43], v[42:43], v[234:235] op_sel_hi:[1,0]
v_cvt_pk_bf16_f32 v36, v36, v37
v_cvt_pk_bf16_f32 v37, v38, v39
v_cvt_pk_bf16_f32 v38, v40, v41
v_cvt_pk_bf16_f32 v39, v42, v43
buffer_store_dwordx4 v[36:39], v1, s[4:7], s52 offen offset:1024 sc1
s_nop 0
v_mfma_f32_16x16x32_bf16 v[240:243], v[8:11], v[36:39], v[240:243]
v_accvgpr_read_b32 v36, a176
v_accvgpr_read_b32 v37, a177
v_accvgpr_read_b32 v38, a178
v_accvgpr_read_b32 v39, a179
v_accvgpr_read_b32 v40, a180
v_accvgpr_read_b32 v41, a181
v_accvgpr_read_b32 v42, a182
v_accvgpr_read_b32 v43, a183
s_waitcnt lgkmcnt(2)
v_pk_add_f32 v[44:45], v[44:45], v[244:245]
v_pk_add_f32 v[46:47], v[46:47], v[246:247]
v_pk_add_f32 v[48:49], v[48:49], v[248:249]
v_pk_add_f32 v[50:51], v[50:51], v[250:251]
ds_read_b128 v[244:247], v229 offset:0
ds_read_b128 v[248:251], v229 offset:1024
v_pk_mul_f32 v[44:45], v[44:45], v[234:235] op_sel_hi:[1,0]
v_pk_mul_f32 v[46:47], v[46:47], v[234:235] op_sel_hi:[1,0]
v_pk_mul_f32 v[48:49], v[48:49], v[234:235] op_sel_hi:[1,0]
v_pk_mul_f32 v[50:51], v[50:51], v[234:235] op_sel_hi:[1,0]
v_cvt_pk_bf16_f32 v44, v44, v45
v_cvt_pk_bf16_f32 v45, v46, v47
v_cvt_pk_bf16_f32 v46, v48, v49
v_cvt_pk_bf16_f32 v47, v50, v51
buffer_store_dwordx4 v[44:47], v1, s[4:7], s52 offen offset:2048 sc1
s_nop 0
v_mfma_f32_16x16x32_bf16 v[240:243], v[8:11], v[44:47], v[240:243]
v_accvgpr_read_b32 v44, a184
v_accvgpr_read_b32 v45, a185
v_accvgpr_read_b32 v46, a186
v_accvgpr_read_b32 v47, a187
v_accvgpr_read_b32 v48, a188
v_accvgpr_read_b32 v49, a189
v_accvgpr_read_b32 v50, a190
v_accvgpr_read_b32 v51, a191
s_waitcnt lgkmcnt(2)
v_pk_add_f32 v[84:85], v[84:85], v[20:21]
v_pk_add_f32 v[86:87], v[86:87], v[22:23]
v_pk_add_f32 v[88:89], v[88:89], v[24:25]
v_pk_add_f32 v[90:91], v[90:91], v[26:27]
ds_read_b128 v[20:23], v229 offset:2048
ds_read_b128 v[24:27], v229 offset:3072
v_pk_mul_f32 v[84:85], v[84:85], v[234:235] op_sel_hi:[1,0]
v_pk_mul_f32 v[86:87], v[86:87], v[234:235] op_sel_hi:[1,0]
v_pk_mul_f32 v[88:89], v[88:89], v[234:235] op_sel_hi:[1,0]
v_pk_mul_f32 v[90:91], v[90:91], v[234:235] op_sel_hi:[1,0]
v_cvt_pk_bf16_f32 v84, v84, v85
v_cvt_pk_bf16_f32 v85, v86, v87
v_cvt_pk_bf16_f32 v86, v88, v89
v_cvt_pk_bf16_f32 v87, v90, v91
buffer_store_dwordx4 v[84:87], v1, s[4:7], s52 offen offset:3072 sc1
s_nop 0
v_mfma_f32_16x16x32_bf16 v[240:243], v[8:11], v[84:87], v[240:243]
s_waitcnt lgkmcnt(3)
v_pk_add_f32 v[92:93], v[92:93], v[244:245]
v_pk_add_f32 v[94:95], v[94:95], v[246:247]
s_waitcnt lgkmcnt(2)
v_pk_add_f32 v[96:97], v[96:97], v[248:249]
v_pk_add_f32 v[98:99], v[98:99], v[250:251]
ds_read_b128 v[244:247], v229 offset:4096
ds_read_b128 v[248:251], v229 offset:5120
v_pk_mul_f32 v[92:93], v[92:93], v[236:237] op_sel_hi:[1,0]
v_pk_mul_f32 v[94:95], v[94:95], v[236:237] op_sel_hi:[1,0]
v_pk_mul_f32 v[96:97], v[96:97], v[236:237] op_sel_hi:[1,0]
v_pk_mul_f32 v[98:99], v[98:99], v[236:237] op_sel_hi:[1,0]
v_cvt_pk_bf16_f32 v92, v92, v93
v_cvt_pk_bf16_f32 v93, v94, v95
v_cvt_pk_bf16_f32 v94, v96, v97
v_cvt_pk_bf16_f32 v95, v98, v99
buffer_store_dwordx4 v[92:95], v1, s[4:7], s53 offen offset:0 sc1
s_nop 0
v_mfma_f32_16x16x32_bf16 v[240:243], v[8:11], v[92:95], v[240:243]
s_waitcnt lgkmcnt(3)
v_pk_add_f32 v[28:29], v[28:29], v[20:21]
v_pk_add_f32 v[30:31], v[30:31], v[22:23]
s_waitcnt lgkmcnt(2)
v_pk_add_f32 v[32:33], v[32:33], v[24:25]
v_pk_add_f32 v[34:35], v[34:35], v[26:27]
ds_read_b128 v[20:23], v229 offset:6144
ds_read_b128 v[24:27], v229 offset:7168
v_pk_mul_f32 v[28:29], v[28:29], v[236:237] op_sel_hi:[1,0]
v_pk_mul_f32 v[30:31], v[30:31], v[236:237] op_sel_hi:[1,0]
v_pk_mul_f32 v[32:33], v[32:33], v[236:237] op_sel_hi:[1,0]
v_pk_mul_f32 v[34:35], v[34:35], v[236:237] op_sel_hi:[1,0]
v_cvt_pk_bf16_f32 v28, v28, v29
v_cvt_pk_bf16_f32 v29, v30, v31
v_cvt_pk_bf16_f32 v30, v32, v33
v_cvt_pk_bf16_f32 v31, v34, v35
buffer_store_dwordx4 v[28:31], v1, s[4:7], s53 offen offset:1024 sc1
s_nop 0
v_mfma_f32_16x16x32_bf16 v[240:243], v[8:11], v[28:31], v[240:243]
s_waitcnt lgkmcnt(3)
v_pk_add_f32 v[36:37], v[36:37], v[244:245]
v_pk_add_f32 v[38:39], v[38:39], v[246:247]
s_waitcnt lgkmcnt(2)
v_pk_add_f32 v[40:41], v[40:41], v[248:249]
v_pk_add_f32 v[42:43], v[42:43], v[250:251]
v_pk_mul_f32 v[36:37], v[36:37], v[236:237] op_sel_hi:[1,0]
v_pk_mul_f32 v[38:39], v[38:39], v[236:237] op_sel_hi:[1,0]
v_pk_mul_f32 v[40:41], v[40:41], v[236:237] op_sel_hi:[1,0]
v_pk_mul_f32 v[42:43], v[42:43], v[236:237] op_sel_hi:[1,0]
v_cvt_pk_bf16_f32 v36, v36, v37
v_cvt_pk_bf16_f32 v37, v38, v39
v_cvt_pk_bf16_f32 v38, v40, v41
v_cvt_pk_bf16_f32 v39, v42, v43
buffer_store_dwordx4 v[36:39], v1, s[4:7], s53 offen offset:2048 sc1
s_nop 0
v_mfma_f32_16x16x32_bf16 v[240:243], v[8:11], v[36:39], v[240:243]
s_waitcnt lgkmcnt(1)
v_pk_add_f32 v[44:45], v[44:45], v[20:21]
v_pk_add_f32 v[46:47], v[46:47], v[22:23]
s_waitcnt lgkmcnt(0)
v_pk_add_f32 v[48:49], v[48:49], v[24:25]
v_pk_add_f32 v[50:51], v[50:51], v[26:27]
v_pk_mul_f32 v[44:45], v[44:45], v[236:237] op_sel_hi:[1,0]
v_pk_mul_f32 v[46:47], v[46:47], v[236:237] op_sel_hi:[1,0]
v_pk_mul_f32 v[48:49], v[48:49], v[236:237] op_sel_hi:[1,0]
v_pk_mul_f32 v[50:51], v[50:51], v[236:237] op_sel_hi:[1,0]
v_cvt_pk_bf16_f32 v44, v44, v45
v_cvt_pk_bf16_f32 v45, v46, v47
v_cvt_pk_bf16_f32 v46, v48, v49
v_cvt_pk_bf16_f32 v47, v50, v51
buffer_store_dwordx4 v[44:47], v1, s[4:7], s53 offen offset:3072 sc1
s_nop 0
v_mfma_f32_16x16x32_bf16 v[240:243], v[8:11], v[44:47], v[240:243]
s_or_b64 s[66:67], s[66:67], s[32:33]
s_or_b64 s[66:67], s[66:67], s[34:35]
s_or_b64 s[66:67], s[66:67], s[96:97]
s_or_b64 s[66:67], s[66:67], s[98:99]
s_nop 3
v_cmp_u_f32 vcc, v241, v241
s_nop 3
s_or_b64 s[66:67], s[66:67], vcc
s_branch L_at_b2f
L_at_f11:
s_lshl_b32 s51, s48, 13
v_add_u32 v228, s51, v1
s_sub_u32 s52, s51, 16384
v_xor_b32 v229, 196608, v3
v_add_u32 v229, s52, v229
v_xor_b32 v230, 65536, v2
v_and_b32 v230, 0x38000, v230
v_lshrrev_b32 v231, 2, v1
s_lshl_b32 s52, s48, 10
s_add_u32 s52, s52, 4096
v_add3_u32 v231, v230, v231, s52
v_and_b32 v232, 63, v231
v_add3_u32 v230, v230, v232, s52
v_xor_b32 v232, 0x400, v230
s_waitcnt lgkmcnt(0)
s_barrier
ds_write_b32 v231, v20 offset:0
ds_write_b32 v231, v24 offset:256
ds_write_b32 v231, v28 offset:512
ds_write_b32 v231, v32 offset:768
ds_write_b128 v228, a[128:131] offset:0
s_lshl_b32 s51, s50, 3
s_add_u32 s51, s51, 4
s_add_u32 s52, s51, s55
s_sub_u32 s53, s51, s55
ds_write_b128 v228, a[132:135] offset:1024
s_add_u32 s53, s53, 3
s_mul_i32 s52, s52, 186368
s_mul_i32 s53, s53, 186368
s_lshl_b32 s51, s49, 12
ds_write_b128 v228, a[136:139] offset:2048
s_add_u32 s51, s51, 37804032
s_add_u32 s52, s52, s51
s_add_u32 s53, s53, s51
v_accvgpr_read_b32 v28, a192
ds_write_b128 v228, a[140:143] offset:3072
v_accvgpr_read_b32 v29, a193
v_accvgpr_read_b32 v30, a194
v_accvgpr_read_b32 v31, a195
v_accvgpr_read_b32 v32, a196
ds_write_b128 v228, a[144:147] offset:4096
v_accvgpr_read_b32 v33, a197
v_accvgpr_read_b32 v34, a198
v_accvgpr_read_b32 v35, a199
v_accvgpr_read_b32 v36, a200
ds_write_b128 v228, a[148:151] offset:5120
v_accvgpr_read_b32 v37, a201
v_accvgpr_read_b32 v38, a202
v_accvgpr_read_b32 v39, a203
v_accvgpr_read_b32 v40, a204
ds_write_b128 v228, a[152:155] offset:6144
v_accvgpr_read_b32 v41, a205
v_accvgpr_read_b32 v42, a206
v_accvgpr_read_b32 v43, a207
v_accvgpr_read_b32 v44, a208
ds_write_b128 v228, a[156:159] offset:7168
v_accvgpr_read_b32 v45, a209
v_accvgpr_read_b32 v46, a210
v_accvgpr_read_b32 v47, a211
v_accvgpr_read_b32 v48, a212
ds_write_b128 v229, a[160:163] offset:0
v_accvgpr_read_b32 v49, a213
v_accvgpr_read_b32 v50, a214
v_accvgpr_read_b32 v51, a215
v_accvgpr_read_b32 v84, a216
ds_write_b128 v229, a[164:167] offset:1024
v_accvgpr_read_b32 v85, a217
v_accvgpr_read_b32 v86, a218
v_accvgpr_read_b32 v87, a219
v_accvgpr_read_b32 v88, a220
ds_write_b128 v229, a[168:171] offset:2048
v_accvgpr_read_b32 v89, a221
v_accvgpr_read_b32 v90, a222
v_accvgpr_read_b32 v91, a223
v_accvgpr_read_b32 v92, a224
ds_write_b128 v229, a[172:175] offset:3072
v_accvgpr_read_b32 v93, a225
v_accvgpr_read_b32 v94, a226
v_accvgpr_read_b32 v95, a227
v_accvgpr_read_b32 v96, a228
ds_write_b128 v229, a[176:179] offset:4096
v_accvgpr_read_b32 v97, a229
v_accvgpr_read_b32 v98, a230
v_accvgpr_read_b32 v99, a231
ds_write_b128 v229, a[180:183] offset:5120
ds_write_b128 v229, a[184:187] offset:6144
ds_write_b128 v229, a[188:191] offset:7168
v_xor_b32 v228, 0x2000, v228
v_xor_b32 v229, 0x2000, v229
s_waitcnt lgkmcnt(0)
s_barrier
ds_read_b32 v233, v230 offset:512
ds_read_b32 v234, v232 offset:512
ds_read_b32 v235, v230 offset:768
ds_read_b32 v236, v232 offset:768
ds_read_b128 v[244:247], v228 offset:0
ds_read_b128 v[248:251], v228 offset:1024
ds_read_b128 v[20:23], v228 offset:2048
ds_read_b128 v[24:27], v228 offset:3072
s_mov_b32 s86, 0x2b800000
s_mov_b32 s87, 0x5d800000
s_waitcnt lgkmcnt(6)
v_add_f32 v233, v233, v234
v_cmp_nle_f32 s[32:33], s86, v233
v_cmp_nge_f32 s[34:35], s87, v233
v_rcp_f32 v234, v233
s_waitcnt lgkmcnt(4)
v_add_f32 v235, v235, v236
v_cmp_nle_f32 s[96:97], s86, v235
v_cmp_nge_f32 s[98:99], s87, v235
v_rcp_f32 v236, v235
s_barrier
s_waitcnt lgkmcnt(3)
v_pk_add_f32 v[28:29], v[28:29], v[244:245]
v_pk_add_f32 v[30:31], v[30:31], v[246:247]
s_waitcnt lgkmcnt(2)
v_pk_add_f32 v[32:33], v[32:33], v[248:249]
v_pk_add_f32 v[34:35], v[34:35], v[250:251]
ds_read_b128 v[244:247], v228 offset:4096
ds_read_b128 v[248:251], v228 offset:5120
v_pk_mul_f32 v[28:29], v[28:29], v[234:235] op_sel_hi:[1,0]
v_pk_mul_f32 v[30:31], v[30:31], v[234:235] op_sel_hi:[1,0]
v_pk_mul_f32 v[32:33], v[32:33], v[234:235] op_sel_hi:[1,0]
v_pk_mul_f32 v[34:35], v[34:35], v[234:235] op_sel_hi:[1,0]
v_cvt_pk_bf16_f32 v28, v28, v29
v_cvt_pk_bf16_f32 v29, v30, v31
v_cvt_pk_bf16_f32 v30, v32, v33
v_cvt_pk_bf16_f32 v31, v34, v35
buffer_store_dwordx4 v[28:31], v1, s[4:7], s52 offen offset:0 sc1
s_nop 0
v_mfma_f32_16x16x32_bf16 v[240:243], v[8:11], v[28:31], 0
v_accvgpr_read_b32 v28, a232
v_accvgpr_read_b32 v29, a233
v_accvgpr_read_b32 v30, a234
v_accvgpr_read_b32 v31, a235
v_accvgpr_read_b32 v32, a236
v_accvgpr_read_b32 v33, a237
v_accvgpr_read_b32 v34, a238
v_accvgpr_read_b32 v35, a239
s_waitcnt lgkmcnt(2)
v_pk_add_f32 v[36:37], v[36:37], v[20:21]
v_pk_add_f32 v[38:39], v[38:39], v[22:23]
v_pk_add_f32 v[40:41], v[40:41], v[24:25]
v_pk_add_f32 v[42:43], v[42:43], v[26:27]
ds_read_b128 v[20:23], v228 offset:6144
ds_read_b128 v[24:27], v228 offset:7168
v_pk_mul_f32 v[36:37], v[36:37], v[234:235] op_sel_hi:[1,0]
v_pk_mul_f32 v[38:39], v[38:39], v[234:235] op_sel_hi:[1,0]
v_pk_mul_f32 v[40:41], v[40:41], v[234:235] op_sel_hi:[1,0]
v_pk_mul_f32 v[42:43], v[42:43], v[234:235] op_sel_hi:[1,0]
v_cvt_pk_bf16_f32 v36, v36, v37
v_cvt_pk_bf16_f32 v37, v38, v39
v_cvt_pk_bf16_f32 v38, v40, v41
v_cvt_pk_bf16_f32 v39, v42, v43
buffer_store_dwordx4 v[36:39], v1, s[4:7], s52 offen offset:1024 sc1
s_nop 0
v_mfma_f32_16x16x32_bf16 v[240:243], v[8:11], v[36:39], v[240:243]
v_accvgpr_read_b32 v36, a240
v_accvgpr_read_b32 v37, a241
v_accvgpr_read_b32 v38, a242
v_accvgpr_read_b32 v39, a243
v_accvgpr_read_b32 v40, a244
v_accvgpr_read_b32 v41, a245
v_accvgpr_read_b32 v42, a246
v_accvgpr_read_b32 v43, a247
s_waitcnt lgkmcnt(2)
v_pk_add_f32 v[44:45], v[44:45], v[244:245]
v_pk_add_f32 v[46:47], v[46:47], v[246:247]
v_pk_add_f32 v[48:49], v[48:49], v[248:249]
v_pk_add_f32 v[50:51], v[50:51], v[250:251]
ds_read_b128 v[244:247], v229 offset:0
ds_read_b128 v[248:251], v229 offset:1024
v_pk_mul_f32 v[44:45], v[44:45], v[234:235] op_sel_hi:[1,0]
v_pk_mul_f32 v[46:47], v[46:47], v[234:235] op_sel_hi:[1,0]
v_pk_mul_f32 v[48:49], v[48:49], v[234:235] op_sel_hi:[1,0]
v_pk_mul_f32 v[50:51], v[50:51], v[234:235] op_sel_hi:[1,0]
v_cvt_pk_bf16_f32 v44, v44, v45
v_cvt_pk_bf16_f32 v45, v46, v47
v_cvt_pk_bf16_f32 v46, v48, v49
v_cvt_pk_bf16_f32 v47, v50, v51
buffer_store_dwordx4 v[44:47], v1, s[4:7], s52 offen offset:2048 sc1
s_nop 0
v_mfma_f32_16x16x32_bf16 v[240:243], v[8:11], v[44:47], v[240:243]
v_accvgpr_read_b32 v44, a248
v_accvgpr_read_b32 v45, a249
v_accvgpr_read_b32 v46, a250
v_accvgpr_read_b32 v47, a251
v_accvgpr_read_b32 v48, a252
v_accvgpr_read_b32 v49, a253
v_accvgpr_read_b32 v50, a254
v_accvgpr_read_b32 v51, a255
s_waitcnt lgkmcnt(2)
v_pk_add_f32 v[84:85], v[84:85], v[20:21]
v_pk_add_f32 v[86:87], v[86:87], v[22:23]
v_pk_add_f32 v[88:89], v[88:89], v[24:25]
v_pk_add_f32 v[90:91], v[90:91], v[26:27]
ds_read_b128 v[20:23], v229 offset:2048
ds_read_b128 v[24:27], v229 offset:3072
v_pk_mul_f32 v[84:85], v[84:85], v[234:235] op_sel_hi:[1,0]
v_pk_mul_f32 v[86:87], v[86:87], v[234:235] op_sel_hi:[1,0]
v_pk_mul_f32 v[88:89], v[88:89], v[234:235] op_sel_hi:[1,0]
v_pk_mul_f32 v[90:91], v[90:91], v[234:235] op_sel_hi:[1,0]
v_cvt_pk_bf16_f32 v84, v84, v85
v_cvt_pk_bf16_f32 v85, v86, v87
v_cvt_pk_bf16_f32 v86, v88, v89
v_cvt_pk_bf16_f32 v87, v90, v91
buffer_store_dwordx4 v[84:87], v1, s[4:7], s52 offen offset:3072 sc1
s_nop 0
v_mfma_f32_16x16x32_bf16 v[240:243], v[8:11], v[84:87], v[240:243]
s_waitcnt lgkmcnt(3)
v_pk_add_f32 v[92:93], v[92:93], v[244:245]
v_pk_add_f32 v[94:95], v[94:95], v[246:247]
s_waitcnt lgkmcnt(2)
v_pk_add_f32 v[96:97], v[96:97], v[248:249]
v_pk_add_f32 v[98:99], v[98:99], v[250:251]
ds_read_b128 v[244:247], v229 offset:4096
ds_read_b128 v[248:251], v229 offset:5120
v_pk_mul_f32 v[92:93], v[92:93], v[236:237] op_sel_hi:[1,0]
v_pk_mul_f32 v[94:95], v[94:95], v[236:237] op_sel_hi:[1,0]
v_pk_mul_f32 v[96:97], v[96:97], v[236:237] op_sel_hi:[1,0]
v_pk_mul_f32 v[98:99], v[98:99], v[236:237] op_sel_hi:[1,0]
v_cvt_pk_bf16_f32 v92, v92, v93
v_cvt_pk_bf16_f32 v93, v94, v95
v_cvt_pk_bf16_f32 v94, v96, v97
v_cvt_pk_bf16_f32 v95, v98, v99
buffer_store_dwordx4 v[92:95], v1, s[4:7], s53 offen offset:0 sc1
s_nop 0
v_mfma_f32_16x16x32_bf16 v[240:243], v[8:11], v[92:95], v[240:243]
s_waitcnt lgkmcnt(3)
v_pk_add_f32 v[28:29], v[28:29], v[20:21]
v_pk_add_f32 v[30:31], v[30:31], v[22:23]
s_waitcnt lgkmcnt(2)
v_pk_add_f32 v[32:33], v[32:33], v[24:25]
v_pk_add_f32 v[34:35], v[34:35], v[26:27]
ds_read_b128 v[20:23], v229 offset:6144
ds_read_b128 v[24:27], v229 offset:7168
v_pk_mul_f32 v[28:29], v[28:29], v[236:237] op_sel_hi:[1,0]
v_pk_mul_f32 v[30:31], v[30:31], v[236:237] op_sel_hi:[1,0]
v_pk_mul_f32 v[32:33], v[32:33], v[236:237] op_sel_hi:[1,0]
v_pk_mul_f32 v[34:35], v[34:35], v[236:237] op_sel_hi:[1,0]
v_cvt_pk_bf16_f32 v28, v28, v29
v_cvt_pk_bf16_f32 v29, v30, v31
v_cvt_pk_bf16_f32 v30, v32, v33
v_cvt_pk_bf16_f32 v31, v34, v35
buffer_store_dwordx4 v[28:31], v1, s[4:7], s53 offen offset:1024 sc1
s_nop 0
v_mfma_f32_16x16x32_bf16 v[240:243], v[8:11], v[28:31], v[240:243]
s_waitcnt lgkmcnt(3)
v_pk_add_f32 v[36:37], v[36:37], v[244:245]
v_pk_add_f32 v[38:39], v[38:39], v[246:247]
s_waitcnt lgkmcnt(2)
v_pk_add_f32 v[40:41], v[40:41], v[248:249]
v_pk_add_f32 v[42:43], v[42:43], v[250:251]
v_pk_mul_f32 v[36:37], v[36:37], v[236:237] op_sel_hi:[1,0]
v_pk_mul_f32 v[38:39], v[38:39], v[236:237] op_sel_hi:[1,0]
v_pk_mul_f32 v[40:41], v[40:41], v[236:237] op_sel_hi:[1,0]
v_pk_mul_f32 v[42:43], v[42:43], v[236:237] op_sel_hi:[1,0]
v_cvt_pk_bf16_f32 v36, v36, v37
v_cvt_pk_bf16_f32 v37, v38, v39
v_cvt_pk_bf16_f32 v38, v40, v41
v_cvt_pk_bf16_f32 v39, v42, v43
buffer_store_dwordx4 v[36:39], v1, s[4:7], s53 offen offset:2048 sc1
s_nop 0
v_mfma_f32_16x16x32_bf16 v[240:243], v[8:11], v[36:39], v[240:243]
s_waitcnt lgkmcnt(1)
v_pk_add_f32 v[44:45], v[44:45], v[20:21]
v_pk_add_f32 v[46:47], v[46:47], v[22:23]
s_waitcnt lgkmcnt(0)
v_pk_add_f32 v[48:49], v[48:49], v[24:25]
v_pk_add_f32 v[50:51], v[50:51], v[26:27]
v_pk_mul_f32 v[44:45], v[44:45], v[236:237] op_sel_hi:[1,0]
v_pk_mul_f32 v[46:47], v[46:47], v[236:237] op_sel_hi:[1,0]
v_pk_mul_f32 v[48:49], v[48:49], v[236:237] op_sel_hi:[1,0]
v_pk_mul_f32 v[50:51], v[50:51], v[236:237] op_sel_hi:[1,0]
v_cvt_pk_bf16_f32 v44, v44, v45
v_cvt_pk_bf16_f32 v45, v46, v47
v_cvt_pk_bf16_f32 v46, v48, v49
v_cvt_pk_bf16_f32 v47, v50, v51
buffer_store_dwordx4 v[44:47], v1, s[4:7], s53 offen offset:3072 sc1
s_nop 0
v_mfma_f32_16x16x32_bf16 v[240:243], v[8:11], v[44:47], v[240:243]
s_or_b64 s[66:67], s[66:67], s[32:33]
s_or_b64 s[66:67], s[66:67], s[34:35]
s_or_b64 s[66:67], s[66:67], s[96:97]
s_or_b64 s[66:67], s[66:67], s[98:99]
s_nop 3
v_cmp_u_f32 vcc, v241, v241
s_nop 3
s_or_b64 s[66:67], s[66:67], vcc
L_at_b2f:
v_mfma_f32_16x16x32_bf16 a[128:131], v[164:167], v[68:71], 0
buffer_load_dwordx4 v5, s[4:7], s58 offen offset:0 sc1 lds
v_mfma_f32_16x16x32_bf16 a[128:131], v[168:171], v[72:75], a[128:131]
s_lshl_b32 s51, s48, 3
v_exp_f32 v55, v55
v_mfma_f32_16x16x32_bf16 a[132:135], v[176:179], v[72:75], 0
s_movk_i32 s53, 1280
v_cvt_pk_bf16_f32 v76, v52, v53
v_cvt_pk_bf16_f32 v77, v54, v55
v_mfma_f32_16x16x32_bf16 a[132:135], v[172:175], v[68:71], a[132:135]
v_exp_f32 v56, v56
v_mfma_f32_16x16x32_bf16 a[136:139], v[180:183], v[68:71], 0
buffer_load_dwordx4 v5, s[4:7], s58 offen offset:1024 sc1 lds
v_mfma_f32_16x16x32_bf16 a[136:139], v[184:187], v[72:75], a[136:139]
v_exp_f32 v57, v57
v_mfma_f32_16x16x32_bf16 a[140:143], v[192:195], v[72:75], 0
v_and_b32 v228, 15, v0
v_lshrrev_b32 v229, 4, v0
v_mfma_f32_16x16x32_bf16 a[140:143], v[188:191], v[68:71], a[140:143]
v_exp_f32 v58, v58
v_mfma_f32_16x16x32_bf16 a[144:147], v[196:199], v[68:71], 0
buffer_load_dwordx4 v5, s[4:7], s58 offen offset:2048 sc1 lds
v_mfma_f32_16x16x32_bf16 a[144:147], v[200:203], v[72:75], a[144:147]
v_exp_f32 v59, v59
v_mfma_f32_16x16x32_bf16 a[148:151], v[208:211], v[72:75], 0
v_cvt_pk_bf16_f32 v78, v56, v57
v_cvt_pk_bf16_f32 v79, v58, v59
v_mfma_f32_16x16x32_bf16 a[148:151], v[204:207], v[68:71], a[148:151]
v_exp_f32 v60, v60
v_mfma_f32_16x16x32_bf16 a[152:155], v[212:215], v[68:71], 0
buffer_load_dwordx4 v5, s[4:7], s58 offen offset:3072 sc1 lds
v_mfma_f32_16x16x32_bf16 a[152:155], v[216:219], v[72:75], a[152:155]
v_exp_f32 v61, v61
v_mfma_f32_16x16x32_bf16 a[156:159], v[224:227], v[72:75], 0
v_add_u32 v230, s51, v229
v_mul_lo_u32 v230, v230, s53
v_mfma_f32_16x16x32_bf16 a[156:159], v[220:223], v[68:71], a[156:159]
v_exp_f32 v62, v62
v_mfma_f32_16x16x32_bf16 v[20:23], v[8:11], v[68:71], 0
v_lshlrev_b32 v231, 1, v229
v_xor_b32 v231, v231, v228
v_mfma_f32_16x16x32_bf16 v[20:23], v[8:11], v[72:75], v[20:23]
v_exp_f32 v63, v63
v_mfma_f32_16x16x32_bf16 v[36:39], v[100:103], a[96:99], 0
v_cvt_pk_bf16_f32 v80, v60, v61
v_cvt_pk_bf16_f32 v81, v62, v63
v_mfma_f32_16x16x32_bf16 v[36:39], v[104:107], a[100:103], v[36:39]
v_exp_f32 v64, v64
v_mfma_f32_16x16x32_bf16 v[36:39], v[108:111], a[104:107], v[36:39]
v_lshl_add_u32 v254, v231, 4, v230
v_xor_b32 v231, 8, v231
v_mfma_f32_16x16x32_bf16 v[36:39], v[112:115], a[108:111], v[36:39]
v_exp_f32 v65, v65
v_mfma_f32_16x16x32_bf16 v[40:43], v[128:131], a[108:111], 0
v_lshl_add_u32 v255, v231, 4, v230
v_add_u32 v255, 4096, v255
v_mfma_f32_16x16x32_bf16 v[40:43], v[124:127], a[104:107], v[40:43]
v_exp_f32 v66, v66
v_mfma_f32_16x16x32_bf16 v[40:43], v[120:123], a[100:103], v[40:43]
v_lshrrev_b32 v230, 2, v228
v_lshl_add_u32 v230, v229, 2, v230
v_mfma_f32_16x16x32_bf16 v[40:43], v[116:119], a[96:99], v[40:43]
v_exp_f32 v67, v67
v_mfma_f32_16x16x32_bf16 v[44:47], v[132:135], a[96:99], 0
v_cvt_pk_bf16_f32 v82, v64, v65
v_cvt_pk_bf16_f32 v83, v66, v67
v_mfma_f32_16x16x32_bf16 v[44:47], v[136:139], a[100:103], v[44:47]
v_exp_f32 v36, v36
v_mfma_f32_16x16x32_bf16 v[44:47], v[140:143], a[104:107], v[44:47]
v_and_b32 v231, 7, v230
v_xor_b32 v231, s48, v231
v_mfma_f32_16x16x32_bf16 v[44:47], v[144:147], a[108:111], v[44:47]
v_exp_f32 v37, v37
v_mfma_f32_16x16x32_bf16 v[48:51], v[160:163], a[108:111], 0
v_lshlrev_b32 v230, 8, v230
v_lshl_add_u32 v230, v231, 5, v230
v_mfma_f32_16x16x32_bf16 v[48:51], v[156:159], a[104:107], v[48:51]
v_exp_f32 v38, v38
v_mfma_f32_16x16x32_bf16 v[48:51], v[152:155], a[100:103], v[48:51]
v_and_b32 v231, 3, v228
v_lshl_add_u32 v252, v231, 3, v230
v_mfma_f32_16x16x32_bf16 v[48:51], v[148:151], a[96:99], v[48:51]
v_xor_b32 v253, 128, v252
v_mov_b32 v6, 2146435072
v_mfma_f32_16x16x32_bf16 a[160:163], v[164:167], v[76:79], 0
s_waitcnt vmcnt(25) lgkmcnt(0)
s_barrier
v_mfma_f32_16x16x32_bf16 a[160:163], v[168:171], v[80:83], a[160:163]
s_add_u32 s59, s58, 16777216
v_exp_f32 v39, v39
v_mfma_f32_16x16x32_bf16 a[164:167], v[176:179], v[80:83], 0
v_cvt_pk_bf16_f32 v84, v36, v37
v_cvt_pk_bf16_f32 v85, v38, v39
v_mfma_f32_16x16x32_bf16 a[164:167], v[172:175], v[76:79], a[164:167]
s_add_u32 m0, s57, 0
v_exp_f32 v40, v40
v_mfma_f32_16x16x32_bf16 a[168:171], v[180:183], v[76:79], 0
buffer_load_dwordx4 v4, s[4:7], s59 offen offset:0 sc1 lds
v_mfma_f32_16x16x32_bf16 a[168:171], v[184:187], v[80:83], a[168:171]
s_add_u32 s58, s58, 32768
v_exp_f32 v41, v41
v_mfma_f32_16x16x32_bf16 a[172:175], v[192:195], v[80:83], 0
s_cmp_eq_u32 s60, s61
s_waitcnt vmcnt(13)
v_mov_b32 v7, 1
v_writelane_b32 v6, 0, 0
v_mfma_f32_16x16x32_bf16 a[172:175], v[188:191], v[76:79], a[172:175]
s_cselect_b32 s58, 4194304, s58
v_exp_f32 v42, v42
v_mfma_f32_16x16x32_bf16 a[176:179], v[196:199], v[76:79], 0
buffer_load_dwordx4 v4, s[4:7], s59 offen offset:1024 sc1 lds
v_mfma_f32_16x16x32_bf16 a[176:179], v[200:203], v[80:83], a[176:179]
s_cmp_gt_u32 s60, 16
v_exp_f32 v43, v43
v_mfma_f32_16x16x32_bf16 a[180:183], v[208:211], v[80:83], 0
s_cselect_b32 s58, 2146435072, s58
v_cvt_pk_bf16_f32 v86, v40, v41
v_cvt_pk_bf16_f32 v87, v42, v43
v_mfma_f32_16x16x32_bf16 a[180:183], v[204:207], v[76:79], a[180:183]
s_xor_b32 s56, s56, 65536
v_exp_f32 v44, v44
v_mfma_f32_16x16x32_bf16 a[184:187], v[212:215], v[76:79], 0
buffer_load_dwordx4 v4, s[4:7], s59 offen offset:2048 sc1 lds
v_mfma_f32_16x16x32_bf16 a[184:187], v[216:219], v[80:83], a[184:187]
s_add_u32 s60, s60, 1
v_exp_f32 v45, v45
v_mfma_f32_16x16x32_bf16 a[188:191], v[224:227], v[80:83], 0
v_mfma_f32_16x16x32_bf16 a[188:191], v[220:223], v[76:79], a[188:191]
v_exp_f32 v46, v46
v_mfma_f32_16x16x32_bf16 v[24:27], v[8:11], v[76:79], 0
buffer_load_dwordx4 v4, s[4:7], s59 offen offset:3072 sc1 lds
v_mfma_f32_16x16x32_bf16 v[24:27], v[8:11], v[80:83], v[24:27]
v_exp_f32 v47, v47
v_mfma_f32_16x16x32_bf16 v[52:55], v[100:103], a[112:115], 0
v_cvt_pk_bf16_f32 v88, v44, v45
v_cvt_pk_bf16_f32 v89, v46, v47
v_mfma_f32_16x16x32_bf16 v[52:55], v[104:107], a[116:119], v[52:55]
v_exp_f32 v48, v48
v_mfma_f32_16x16x32_bf16 v[52:55], v[108:111], a[120:123], v[52:55]
ds_read_b128 v[100:103], v2 offset:0
ds_read_b128 v[104:107], v2 offset:1024
v_mfma_f32_16x16x32_bf16 v[52:55], v[112:115], a[124:127], v[52:55]
s_add_u32 m0, s57, 4096
v_exp_f32 v49, v49
v_mfma_f32_16x16x32_bf16 v[56:59], v[128:131], a[124:127], 0
buffer_load_dwordx4 v5, s[4:7], s59 offen offset:0 sc1 lds
v_mfma_f32_16x16x32_bf16 v[56:59], v[124:127], a[120:123], v[56:59]
v_exp_f32 v50, v50
v_mfma_f32_16x16x32_bf16 v[56:59], v[120:123], a[116:119], v[56:59]
ds_read_b128 v[108:111], v2 offset:2048
ds_read_b128 v[112:115], v2 offset:3072
v_mfma_f32_16x16x32_bf16 v[56:59], v[116:119], a[112:115], v[56:59]
v_exp_f32 v51, v51
v_mfma_f32_16x16x32_bf16 v[60:63], v[132:135], a[112:115], 0
v_cvt_pk_bf16_f32 v90, v48, v49
v_cvt_pk_bf16_f32 v91, v50, v51
v_mfma_f32_16x16x32_bf16 v[60:63], v[136:139], a[116:119], v[60:63]
v_exp_f32 v52, v52
v_mfma_f32_16x16x32_bf16 v[60:63], v[140:143], a[120:123], v[60:63]
ds_read_b128 v[116:119], v2 offset:4096
ds_read_b128 v[120:123], v2 offset:5120
v_mfma_f32_16x16x32_bf16 v[60:63], v[144:147], a[124:127], v[60:63]
v_exp_f32 v53, v53
v_mfma_f32_16x16x32_bf16 v[64:67], v[160:163], a[124:127], 0
buffer_load_dwordx4 v5, s[4:7], s59 offen offset:1024 sc1 lds
v_mfma_f32_16x16x32_bf16 v[64:67], v[156:159], a[120:123], v[64:67]
v_exp_f32 v54, v54
v_mfma_f32_16x16x32_bf16 v[64:67], v[152:155], a[116:119], v[64:67]
ds_read_b128 v[124:127], v2 offset:6144
ds_read_b128 v[128:131], v2 offset:7168
v_mfma_f32_16x16x32_bf16 v[64:67], v[148:151], a[112:115], v[64:67]
v_mfma_f32_16x16x32_bf16 a[192:195], v[164:167], v[84:87], 0
ds_read_b128 v[132:135], v2 offset:8192
ds_read_b128 v[136:139], v2 offset:9216
v_mfma_f32_16x16x32_bf16 a[192:195], v[168:171], v[88:91], a[192:195]
v_exp_f32 v55, v55
v_mfma_f32_16x16x32_bf16 a[196:199], v[176:179], v[88:91], 0
v_cvt_pk_bf16_f32 v92, v52, v53
v_cvt_pk_bf16_f32 v93, v54, v55
v_mfma_f32_16x16x32_bf16 a[196:199], v[172:175], v[84:87], a[196:199]
v_exp_f32 v56, v56
v_mfma_f32_16x16x32_bf16 a[200:203], v[180:183], v[84:87], 0
ds_read_b128 v[140:143], v2 offset:10240
ds_read_b128 v[144:147], v2 offset:11264
v_mfma_f32_16x16x32_bf16 a[200:203], v[184:187], v[88:91], a[200:203]
v_exp_f32 v57, v57
v_mfma_f32_16x16x32_bf16 a[204:207], v[192:195], v[88:91], 0
buffer_load_dwordx4 v5, s[4:7], s59 offen offset:2048 sc1 lds
v_mfma_f32_16x16x32_bf16 a[204:207], v[188:191], v[84:87], a[204:207]
v_exp_f32 v58, v58
v_mfma_f32_16x16x32_bf16 a[208:211], v[196:199], v[84:87], 0
ds_read_b128 v[148:151], v2 offset:12288
ds_read_b128 v[152:155], v2 offset:13312
v_mfma_f32_16x16x32_bf16 a[208:211], v[200:203], v[88:91], a[208:211]
v_exp_f32 v59, v59
v_mfma_f32_16x16x32_bf16 a[212:215], v[208:211], v[88:91], 0
v_cvt_pk_bf16_f32 v94, v56, v57
v_cvt_pk_bf16_f32 v95, v58, v59
v_mfma_f32_16x16x32_bf16 a[212:215], v[204:207], v[84:87], a[212:215]
v_exp_f32 v60, v60
v_mfma_f32_16x16x32_bf16 a[216:219], v[212:215], v[84:87], 0
ds_read_b128 v[156:159], v2 offset:14336
ds_read_b128 v[160:163], v2 offset:15360
v_mfma_f32_16x16x32_bf16 a[216:219], v[216:219], v[88:91], a[216:219]
v_exp_f32 v61, v61
v_mfma_f32_16x16x32_bf16 a[220:223], v[224:227], v[88:91], 0
buffer_load_dwordx4 v5, s[4:7], s59 offen offset:3072 sc1 lds
v_mfma_f32_16x16x32_bf16 a[220:223], v[220:223], v[84:87], a[220:223]
s_xor_b32 s57, s57, 196608
v_exp_f32 v62, v62
v_mfma_f32_16x16x32_bf16 v[28:31], v[8:11], v[84:87], 0
v_xor_b32 v2, 65536, v2
v_mfma_f32_16x16x32_bf16 v[28:31], v[8:11], v[88:91], v[28:31]
s_waitcnt lgkmcnt(3)
v_exp_f32 v63, v63
v_mfma_f32_16x16x32_bf16 v[36:39], v[100:103], a[64:67], 0
v_cvt_pk_bf16_f32 v96, v60, v61
v_cvt_pk_bf16_f32 v97, v62, v63
v_mfma_f32_16x16x32_bf16 v[36:39], v[104:107], a[68:71], v[36:39]
v_exp_f32 v64, v64
v_mfma_f32_16x16x32_bf16 v[36:39], v[108:111], a[72:75], v[36:39]
v_mfma_f32_16x16x32_bf16 v[36:39], v[112:115], a[76:79], v[36:39]
v_exp_f32 v65, v65
v_mfma_f32_16x16x32_bf16 v[40:43], v[128:131], a[76:79], 0
v_mfma_f32_16x16x32_bf16 v[40:43], v[124:127], a[72:75], v[40:43]
v_exp_f32 v66, v66
v_mfma_f32_16x16x32_bf16 v[40:43], v[120:123], a[68:71], v[40:43]
v_mfma_f32_16x16x32_bf16 v[40:43], v[116:119], a[64:67], v[40:43]
v_exp_f32 v67, v67
v_mfma_f32_16x16x32_bf16 v[44:47], v[132:135], a[64:67], 0
v_cvt_pk_bf16_f32 v98, v64, v65
v_cvt_pk_bf16_f32 v99, v66, v67
v_mfma_f32_16x16x32_bf16 v[44:47], v[136:139], a[68:71], v[44:47]
v_exp_f32 v36, v36
v_mfma_f32_16x16x32_bf16 v[44:47], v[140:143], a[72:75], v[44:47]
v_mfma_f32_16x16x32_bf16 v[44:47], v[144:147], a[76:79], v[44:47]
s_waitcnt lgkmcnt(0)
v_exp_f32 v37, v37
v_mfma_f32_16x16x32_bf16 v[48:51], v[160:163], a[76:79], 0
v_mfma_f32_16x16x32_bf16 v[48:51], v[156:159], a[72:75], v[48:51]
v_exp_f32 v38, v38
v_mfma_f32_16x16x32_bf16 v[48:51], v[152:155], a[68:71], v[48:51]
s_waitcnt vmcnt(63) lgkmcnt(0)
s_barrier
v_mfma_f32_16x16x32_bf16 v[48:51], v[148:151], a[64:67], v[48:51]
s_add_u32 m0, s56, 0
v_mfma_f32_16x16x32_bf16 a[224:227], v[164:167], v[92:95], 0
buffer_load_dwordx4 v4, s[4:7], s58 offen offset:0 sc1 lds
v_mfma_f32_16x16x32_bf16 a[224:227], v[168:171], v[96:99], a[224:227]
v_exp_f32 v39, v39
v_mfma_f32_16x16x32_bf16 a[228:231], v[176:179], v[96:99], 0
v_cvt_pk_bf16_f32 v68, v36, v37
v_cvt_pk_bf16_f32 v69, v38, v39
v_mfma_f32_16x16x32_bf16 a[228:231], v[172:175], v[92:95], a[228:231]
v_exp_f32 v40, v40
v_mfma_f32_16x16x32_bf16 a[232:235], v[180:183], v[92:95], 0
ds_read_b128 v[164:167], v3 offset:0
ds_read_b128 v[168:171], v3 offset:1024
v_mfma_f32_16x16x32_bf16 a[232:235], v[184:187], v[96:99], a[232:235]
v_exp_f32 v41, v41
v_mfma_f32_16x16x32_bf16 a[236:239], v[192:195], v[96:99], 0
buffer_load_dwordx4 v4, s[4:7], s58 offen offset:1024 sc1 lds
v_mfma_f32_16x16x32_bf16 a[236:239], v[188:191], v[92:95], a[236:239]
v_exp_f32 v42, v42
v_mfma_f32_16x16x32_bf16 a[240:243], v[196:199], v[92:95], 0
ds_read_b128 v[172:175], v3 offset:2048
ds_read_b128 v[176:179], v3 offset:3072
v_mfma_f32_16x16x32_bf16 a[240:243], v[200:203], v[96:99], a[240:243]
v_exp_f32 v43, v43
v_mfma_f32_16x16x32_bf16 a[244:247], v[208:211], v[96:99], 0
v_cvt_pk_bf16_f32 v70, v40, v41
v_cvt_pk_bf16_f32 v71, v42, v43
v_mfma_f32_16x16x32_bf16 a[244:247], v[204:207], v[92:95], a[244:247]
v_exp_f32 v44, v44
v_mfma_f32_16x16x32_bf16 a[248:251], v[212:215], v[92:95], 0
ds_read_b128 v[180:183], v3 offset:4096
ds_read_b128 v[184:187], v3 offset:5120
v_mfma_f32_16x16x32_bf16 a[248:251], v[216:219], v[96:99], a[248:251]
v_exp_f32 v45, v45
v_mfma_f32_16x16x32_bf16 a[252:255], v[224:227], v[96:99], 0
buffer_load_dwordx4 v4, s[4:7], s58 offen offset:2048 sc1 lds
v_mfma_f32_16x16x32_bf16 a[252:255], v[220:223], v[92:95], a[252:255]
v_exp_f32 v46, v46
v_mfma_f32_16x16x32_bf16 v[32:35], v[8:11], v[92:95], 0
ds_read_b128 v[188:191], v3 offset:6144
ds_read_b128 v[192:195], v3 offset:7168
v_mfma_f32_16x16x32_bf16 v[32:35], v[8:11], v[96:99], v[32:35]
v_exp_f32 v47, v47
v_mfma_f32_16x16x32_bf16 v[52:55], v[100:103], a[80:83], 0
v_cvt_pk_bf16_f32 v72, v44, v45
v_cvt_pk_bf16_f32 v73, v46, v47
v_mfma_f32_16x16x32_bf16 v[52:55], v[104:107], a[84:87], v[52:55]
v_exp_f32 v48, v48
v_mfma_f32_16x16x32_bf16 v[52:55], v[108:111], a[88:91], v[52:55]
ds_read_b128 v[196:199], v3 offset:8192
ds_read_b128 v[200:203], v3 offset:9216
v_mfma_f32_16x16x32_bf16 v[52:55], v[112:115], a[92:95], v[52:55]
v_exp_f32 v49, v49
v_mfma_f32_16x16x32_bf16 v[56:59], v[128:131], a[92:95], 0
ds_read_b128 v[204:207], v3 offset:10240
ds_read_b128 v[208:211], v3 offset:11264
v_mfma_f32_16x16x32_bf16 v[56:59], v[124:127], a[88:91], v[56:59]
v_exp_f32 v50, v50
v_mfma_f32_16x16x32_bf16 v[56:59], v[120:123], a[84:87], v[56:59]
ds_read_b128 v[212:215], v3 offset:12288
ds_read_b128 v[216:219], v3 offset:13312
v_mfma_f32_16x16x32_bf16 v[56:59], v[116:119], a[80:83], v[56:59]
v_exp_f32 v51, v51
v_mfma_f32_16x16x32_bf16 v[60:63], v[132:135], a[80:83], 0
v_cvt_pk_bf16_f32 v74, v48, v49
v_cvt_pk_bf16_f32 v75, v50, v51
v_mfma_f32_16x16x32_bf16 v[60:63], v[136:139], a[84:87], v[60:63]
v_exp_f32 v52, v52
v_mfma_f32_16x16x32_bf16 v[60:63], v[140:143], a[88:91], v[60:63]
ds_read_b128 v[220:223], v3 offset:14336
ds_read_b128 v[224:227], v3 offset:15360
v_mfma_f32_16x16x32_bf16 v[60:63], v[144:147], a[92:95], v[60:63]
v_exp_f32 v53, v53
v_mfma_f32_16x16x32_bf16 v[64:67], v[160:163], a[92:95], 0
buffer_load_dwordx4 v4, s[4:7], s58 offen offset:3072 sc1 lds
v_mfma_f32_16x16x32_bf16 v[64:67], v[156:159], a[88:91], v[64:67]
s_add_u32 m0, s56, 4096
v_exp_f32 v54, v54
v_mfma_f32_16x16x32_bf16 v[64:67], v[152:155], a[84:87], v[64:67]
v_xor_b32 v3, 196608, v3
v_mfma_f32_16x16x32_bf16 v[64:67], v[148:151], a[80:83], v[64:67]
s_waitcnt lgkmcnt(3)
v_mfma_f32_16x16x32_bf16 a[128:131], v[164:167], v[68:71], a[128:131]
buffer_load_dwordx4 v5, s[4:7], s58 offen offset:0 sc1 lds
v_mfma_f32_16x16x32_bf16 a[128:131], v[168:171], v[72:75], a[128:131]
v_exp_f32 v55, v55
v_mfma_f32_16x16x32_bf16 a[132:135], v[176:179], v[72:75], a[132:135]
v_cvt_pk_bf16_f32 v76, v52, v53
v_cvt_pk_bf16_f32 v77, v54, v55
v_mfma_f32_16x16x32_bf16 a[132:135], v[172:175], v[68:71], a[132:135]
v_exp_f32 v56, v56
v_mfma_f32_16x16x32_bf16 a[136:139], v[180:183], v[68:71], a[136:139]
buffer_load_dwordx4 v5, s[4:7], s58 offen offset:1024 sc1 lds
v_mfma_f32_16x16x32_bf16 a[136:139], v[184:187], v[72:75], a[136:139]
v_exp_f32 v57, v57
v_mfma_f32_16x16x32_bf16 a[140:143], v[192:195], v[72:75], a[140:143]
v_mfma_f32_16x16x32_bf16 a[140:143], v[188:191], v[68:71], a[140:143]
v_exp_f32 v58, v58
v_mfma_f32_16x16x32_bf16 a[144:147], v[196:199], v[68:71], a[144:147]
buffer_load_dwordx4 v5, s[4:7], s58 offen offset:2048 sc1 lds
v_mfma_f32_16x16x32_bf16 a[144:147], v[200:203], v[72:75], a[144:147]
v_exp_f32 v59, v59
v_mfma_f32_16x16x32_bf16 a[148:151], v[208:211], v[72:75], a[148:151]
v_cvt_pk_bf16_f32 v78, v56, v57
v_cvt_pk_bf16_f32 v79, v58, v59
v_mfma_f32_16x16x32_bf16 a[148:151], v[204:207], v[68:71], a[148:151]
v_exp_f32 v60, v60
v_mfma_f32_16x16x32_bf16 a[152:155], v[212:215], v[68:71], a[152:155]
s_waitcnt lgkmcnt(0)
buffer_load_dwordx4 v5, s[4:7], s58 offen offset:3072 sc1 lds
v_mfma_f32_16x16x32_bf16 a[152:155], v[216:219], v[72:75], a[152:155]
s_add_u32 m0, s88, 0
v_exp_f32 v61, v61
v_mfma_f32_16x16x32_bf16 a[156:159], v[224:227], v[72:75], a[156:159]
buffer_load_dwordx4 v254, s[36:39], s12 offen offset:0 nt lds
v_mfma_f32_16x16x32_bf16 a[156:159], v[220:223], v[68:71], a[156:159]
v_exp_f32 v62, v62
v_mfma_f32_16x16x32_bf16 v[20:23], v[8:11], v[68:71], v[20:23]
buffer_load_dwordx4 v255, s[36:39], s12 offen offset:1024 nt lds
v_mfma_f32_16x16x32_bf16 v[20:23], v[8:11], v[72:75], v[20:23]
v_exp_f32 v63, v63
v_mfma_f32_16x16x32_bf16 v[36:39], v[100:103], a[96:99], 0
v_cvt_pk_bf16_f32 v80, v60, v61
v_cvt_pk_bf16_f32 v81, v62, v63
v_mfma_f32_16x16x32_bf16 v[36:39], v[104:107], a[100:103], v[36:39]
s_add_u32 m0, s88, 8192
v_exp_f32 v64, v64
v_mfma_f32_16x16x32_bf16 v[36:39], v[108:111], a[104:107], v[36:39]
buffer_load_dwordx4 v254, s[20:23], s13 offen offset:0 nt lds
v_mfma_f32_16x16x32_bf16 v[36:39], v[112:115], a[108:111], v[36:39]
v_exp_f32 v65, v65
v_mfma_f32_16x16x32_bf16 v[40:43], v[128:131], a[108:111], 0
buffer_load_dwordx4 v255, s[20:23], s13 offen offset:1024 nt lds
v_mfma_f32_16x16x32_bf16 v[40:43], v[124:127], a[104:107], v[40:43]
s_add_u32 m0, s88, 16384
v_exp_f32 v66, v66
v_mfma_f32_16x16x32_bf16 v[40:43], v[120:123], a[100:103], v[40:43]
buffer_load_dwordx4 v254, s[28:31], s14 offen offset:0 nt lds
v_mfma_f32_16x16x32_bf16 v[40:43], v[116:119], a[96:99], v[40:43]
v_exp_f32 v67, v67
v_mfma_f32_16x16x32_bf16 v[44:47], v[132:135], a[96:99], 0
v_cvt_pk_bf16_f32 v82, v64, v65
v_cvt_pk_bf16_f32 v83, v66, v67
v_mfma_f32_16x16x32_bf16 v[44:47], v[136:139], a[100:103], v[44:47]
v_exp_f32 v36, v36
v_mfma_f32_16x16x32_bf16 v[44:47], v[140:143], a[104:107], v[44:47]
buffer_load_dwordx4 v255, s[28:31], s14 offen offset:1024 nt lds
v_mfma_f32_16x16x32_bf16 v[44:47], v[144:147], a[108:111], v[44:47]
s_add_u32 m0, s88, 24576
v_exp_f32 v37, v37
v_mfma_f32_16x16x32_bf16 v[48:51], v[160:163], a[108:111], 0
buffer_load_dwordx4 v254, s[28:31], s15 offen offset:0 nt lds
v_mfma_f32_16x16x32_bf16 v[48:51], v[156:159], a[104:107], v[48:51]
v_exp_f32 v38, v38
v_mfma_f32_16x16x32_bf16 v[48:51], v[152:155], a[100:103], v[48:51]
buffer_load_dwordx4 v255, s[28:31], s15 offen offset:1024 nt lds
v_mfma_f32_16x16x32_bf16 v[48:51], v[148:151], a[96:99], v[48:51]
v_mfma_f32_16x16x32_bf16 a[160:163], v[164:167], v[76:79], a[160:163]
s_waitcnt vmcnt(24) lgkmcnt(0)
s_barrier
v_mfma_f32_16x16x32_bf16 a[160:163], v[168:171], v[80:83], a[160:163]
s_add_u32 s59, s58, 16777216
v_exp_f32 v39, v39
v_mfma_f32_16x16x32_bf16 a[164:167], v[176:179], v[80:83], a[164:167]
v_cvt_pk_bf16_f32 v84, v36, v37
v_cvt_pk_bf16_f32 v85, v38, v39
v_mfma_f32_16x16x32_bf16 a[164:167], v[172:175], v[76:79], a[164:167]
s_add_u32 m0, s57, 0
v_exp_f32 v40, v40
v_mfma_f32_16x16x32_bf16 a[168:171], v[180:183], v[76:79], a[168:171]
buffer_load_dwordx4 v4, s[4:7], s59 offen offset:0 sc1 lds
v_mfma_f32_16x16x32_bf16 a[168:171], v[184:187], v[80:83], a[168:171]
s_add_u32 s58, s58, 32768
v_exp_f32 v41, v41
v_mfma_f32_16x16x32_bf16 a[172:175], v[192:195], v[80:83], a[172:175]
s_cmp_eq_u32 s60, s61
v_mfma_f32_16x16x32_bf16 a[172:175], v[188:191], v[76:79], a[172:175]
s_cselect_b32 s58, 4194304, s58
v_exp_f32 v42, v42
v_mfma_f32_16x16x32_bf16 a[176:179], v[196:199], v[76:79], a[176:179]
buffer_load_dwordx4 v4, s[4:7], s59 offen offset:1024 sc1 lds
v_mfma_f32_16x16x32_bf16 a[176:179], v[200:203], v[80:83], a[176:179]
s_cmp_gt_u32 s60, 16
v_exp_f32 v43, v43
v_mfma_f32_16x16x32_bf16 a[180:183], v[208:211], v[80:83], a[180:183]
s_cselect_b32 s58, 2146435072, s58
v_cvt_pk_bf16_f32 v86, v40, v41
v_cvt_pk_bf16_f32 v87, v42, v43
v_mfma_f32_16x16x32_bf16 a[180:183], v[204:207], v[76:79], a[180:183]
s_xor_b32 s56, s56, 65536
v_exp_f32 v44, v44
v_mfma_f32_16x16x32_bf16 a[184:187], v[212:215], v[76:79], a[184:187]
buffer_load_dwordx4 v4, s[4:7], s59 offen offset:2048 sc1 lds
v_mfma_f32_16x16x32_bf16 a[184:187], v[216:219], v[80:83], a[184:187]
s_add_u32 s60, s60, 1
v_exp_f32 v45, v45
v_mfma_f32_16x16x32_bf16 a[188:191], v[224:227], v[80:83], a[188:191]
v_mfma_f32_16x16x32_bf16 a[188:191], v[220:223], v[76:79], a[188:191]
v_exp_f32 v46, v46
v_mfma_f32_16x16x32_bf16 v[24:27], v[8:11], v[76:79], v[24:27]
buffer_load_dwordx4 v4, s[4:7], s59 offen offset:3072 sc1 lds
v_mfma_f32_16x16x32_bf16 v[24:27], v[8:11], v[80:83], v[24:27]
v_exp_f32 v47, v47
v_mfma_f32_16x16x32_bf16 v[52:55], v[100:103], a[112:115], 0
v_cvt_pk_bf16_f32 v88, v44, v45
v_cvt_pk_bf16_f32 v89, v46, v47
v_mfma_f32_16x16x32_bf16 v[52:55], v[104:107], a[116:119], v[52:55]
v_exp_f32 v48, v48
v_mfma_f32_16x16x32_bf16 v[52:55], v[108:111], a[120:123], v[52:55]
ds_read_b128 v[100:103], v2 offset:0
ds_read_b128 v[104:107], v2 offset:1024
v_mfma_f32_16x16x32_bf16 v[52:55], v[112:115], a[124:127], v[52:55]
s_add_u32 m0, s57, 4096
v_exp_f32 v49, v49
v_mfma_f32_16x16x32_bf16 v[56:59], v[128:131], a[124:127], 0
buffer_load_dwordx4 v5, s[4:7], s59 offen offset:0 sc1 lds
v_mfma_f32_16x16x32_bf16 v[56:59], v[124:127], a[120:123], v[56:59]
v_exp_f32 v50, v50
v_mfma_f32_16x16x32_bf16 v[56:59], v[120:123], a[116:119], v[56:59]
ds_read_b128 v[108:111], v2 offset:2048
ds_read_b128 v[112:115], v2 offset:3072
v_mfma_f32_16x16x32_bf16 v[56:59], v[116:119], a[112:115], v[56:59]
v_exp_f32 v51, v51
v_mfma_f32_16x16x32_bf16 v[60:63], v[132:135], a[112:115], 0
v_cvt_pk_bf16_f32 v90, v48, v49
v_cvt_pk_bf16_f32 v91, v50, v51
v_mfma_f32_16x16x32_bf16 v[60:63], v[136:139], a[116:119], v[60:63]
v_exp_f32 v52, v52
v_mfma_f32_16x16x32_bf16 v[60:63], v[140:143], a[120:123], v[60:63]
ds_read_b128 v[116:119], v2 offset:4096
ds_read_b128 v[120:123], v2 offset:5120
v_mfma_f32_16x16x32_bf16 v[60:63], v[144:147], a[124:127], v[60:63]
v_exp_f32 v53, v53
v_mfma_f32_16x16x32_bf16 v[64:67], v[160:163], a[124:127], 0
buffer_load_dwordx4 v5, s[4:7], s59 offen offset:1024 sc1 lds
v_mfma_f32_16x16x32_bf16 v[64:67], v[156:159], a[120:123], v[64:67]
v_exp_f32 v54, v54
v_mfma_f32_16x16x32_bf16 v[64:67], v[152:155], a[116:119], v[64:67]
ds_read_b128 v[124:127], v2 offset:6144
ds_read_b128 v[128:131], v2 offset:7168
v_mfma_f32_16x16x32_bf16 v[64:67], v[148:151], a[112:115], v[64:67]
v_mfma_f32_16x16x32_bf16 a[192:195], v[164:167], v[84:87], a[192:195]
ds_read_b128 v[132:135], v2 offset:8192
ds_read_b128 v[136:139], v2 offset:9216
v_mfma_f32_16x16x32_bf16 a[192:195], v[168:171], v[88:91], a[192:195]
v_exp_f32 v55, v55
v_mfma_f32_16x16x32_bf16 a[196:199], v[176:179], v[88:91], a[196:199]
v_cvt_pk_bf16_f32 v92, v52, v53
v_cvt_pk_bf16_f32 v93, v54, v55
v_mfma_f32_16x16x32_bf16 a[196:199], v[172:175], v[84:87], a[196:199]
v_exp_f32 v56, v56
v_mfma_f32_16x16x32_bf16 a[200:203], v[180:183], v[84:87], a[200:203]
ds_read_b128 v[140:143], v2 offset:10240
ds_read_b128 v[144:147], v2 offset:11264
v_mfma_f32_16x16x32_bf16 a[200:203], v[184:187], v[88:91], a[200:203]
v_exp_f32 v57, v57
v_mfma_f32_16x16x32_bf16 a[204:207], v[192:195], v[88:91], a[204:207]
buffer_load_dwordx4 v5, s[4:7], s59 offen offset:2048 sc1 lds
v_mfma_f32_16x16x32_bf16 a[204:207], v[188:191], v[84:87], a[204:207]
v_exp_f32 v58, v58
v_mfma_f32_16x16x32_bf16 a[208:211], v[196:199], v[84:87], a[208:211]
ds_read_b128 v[148:151], v2 offset:12288
ds_read_b128 v[152:155], v2 offset:13312
v_mfma_f32_16x16x32_bf16 a[208:211], v[200:203], v[88:91], a[208:211]
v_exp_f32 v59, v59
v_mfma_f32_16x16x32_bf16 a[212:215], v[208:211], v[88:91], a[212:215]
v_cvt_pk_bf16_f32 v94, v56, v57
v_cvt_pk_bf16_f32 v95, v58, v59
v_mfma_f32_16x16x32_bf16 a[212:215], v[204:207], v[84:87], a[212:215]
v_exp_f32 v60, v60
v_mfma_f32_16x16x32_bf16 a[216:219], v[212:215], v[84:87], a[216:219]
ds_read_b128 v[156:159], v2 offset:14336
ds_read_b128 v[160:163], v2 offset:15360
v_mfma_f32_16x16x32_bf16 a[216:219], v[216:219], v[88:91], a[216:219]
v_exp_f32 v61, v61
v_mfma_f32_16x16x32_bf16 a[220:223], v[224:227], v[88:91], a[220:223]
buffer_load_dwordx4 v5, s[4:7], s59 offen offset:3072 sc1 lds
v_mfma_f32_16x16x32_bf16 a[220:223], v[220:223], v[84:87], a[220:223]
s_xor_b32 s57, s57, 196608
v_exp_f32 v62, v62
v_mfma_f32_16x16x32_bf16 v[28:31], v[8:11], v[84:87], v[28:31]
v_xor_b32 v2, 65536, v2
v_mfma_f32_16x16x32_bf16 v[28:31], v[8:11], v[88:91], v[28:31]
s_waitcnt lgkmcnt(3)
v_exp_f32 v63, v63
v_mfma_f32_16x16x32_bf16 v[36:39], v[100:103], a[64:67], 0
v_cvt_pk_bf16_f32 v96, v60, v61
v_cvt_pk_bf16_f32 v97, v62, v63
v_mfma_f32_16x16x32_bf16 v[36:39], v[104:107], a[68:71], v[36:39]
v_exp_f32 v64, v64
v_mfma_f32_16x16x32_bf16 v[36:39], v[108:111], a[72:75], v[36:39]
v_mfma_f32_16x16x32_bf16 v[36:39], v[112:115], a[76:79], v[36:39]
v_exp_f32 v65, v65
v_mfma_f32_16x16x32_bf16 v[40:43], v[128:131], a[76:79], 0
v_mfma_f32_16x16x32_bf16 v[40:43], v[124:127], a[72:75], v[40:43]
v_exp_f32 v66, v66
v_mfma_f32_16x16x32_bf16 v[40:43], v[120:123], a[68:71], v[40:43]
v_mfma_f32_16x16x32_bf16 v[40:43], v[116:119], a[64:67], v[40:43]
v_exp_f32 v67, v67
v_mfma_f32_16x16x32_bf16 v[44:47], v[132:135], a[64:67], 0
v_cvt_pk_bf16_f32 v98, v64, v65
v_cvt_pk_bf16_f32 v99, v66, v67
v_mfma_f32_16x16x32_bf16 v[44:47], v[136:139], a[68:71], v[44:47]
v_exp_f32 v36, v36
v_mfma_f32_16x16x32_bf16 v[44:47], v[140:143], a[72:75], v[44:47]
v_mfma_f32_16x16x32_bf16 v[44:47], v[144:147], a[76:79], v[44:47]
s_waitcnt lgkmcnt(0)
v_exp_f32 v37, v37
v_mfma_f32_16x16x32_bf16 v[48:51], v[160:163], a[76:79], 0
v_mfma_f32_16x16x32_bf16 v[48:51], v[156:159], a[72:75], v[48:51]
v_exp_f32 v38, v38
v_mfma_f32_16x16x32_bf16 v[48:51], v[152:155], a[68:71], v[48:51]
s_waitcnt vmcnt(24) lgkmcnt(0)
s_barrier
v_mfma_f32_16x16x32_bf16 v[48:51], v[148:151], a[64:67], v[48:51]
s_add_u32 m0, s56, 0
v_mfma_f32_16x16x32_bf16 a[224:227], v[164:167], v[92:95], a[224:227]
buffer_load_dwordx4 v4, s[4:7], s58 offen offset:0 sc1 lds
v_mfma_f32_16x16x32_bf16 a[224:227], v[168:171], v[96:99], a[224:227]
v_exp_f32 v39, v39
v_mfma_f32_16x16x32_bf16 a[228:231], v[176:179], v[96:99], a[228:231]
v_cvt_pk_bf16_f32 v68, v36, v37
v_cvt_pk_bf16_f32 v69, v38, v39
v_mfma_f32_16x16x32_bf16 a[228:231], v[172:175], v[92:95], a[228:231]
v_exp_f32 v40, v40
v_mfma_f32_16x16x32_bf16 a[232:235], v[180:183], v[92:95], a[232:235]
ds_read_b128 v[164:167], v3 offset:0
ds_read_b128 v[168:171], v3 offset:1024
v_mfma_f32_16x16x32_bf16 a[232:235], v[184:187], v[96:99], a[232:235]
v_exp_f32 v41, v41
v_mfma_f32_16x16x32_bf16 a[236:239], v[192:195], v[96:99], a[236:239]
buffer_load_dwordx4 v4, s[4:7], s58 offen offset:1024 sc1 lds
v_mfma_f32_16x16x32_bf16 a[236:239], v[188:191], v[92:95], a[236:239]
v_exp_f32 v42, v42
v_mfma_f32_16x16x32_bf16 a[240:243], v[196:199], v[92:95], a[240:243]
ds_read_b128 v[172:175], v3 offset:2048
ds_read_b128 v[176:179], v3 offset:3072
v_mfma_f32_16x16x32_bf16 a[240:243], v[200:203], v[96:99], a[240:243]
v_exp_f32 v43, v43
v_mfma_f32_16x16x32_bf16 a[244:247], v[208:211], v[96:99], a[244:247]
v_cvt_pk_bf16_f32 v70, v40, v41
v_cvt_pk_bf16_f32 v71, v42, v43
v_mfma_f32_16x16x32_bf16 a[244:247], v[204:207], v[92:95], a[244:247]
v_exp_f32 v44, v44
v_mfma_f32_16x16x32_bf16 a[248:251], v[212:215], v[92:95], a[248:251]
ds_read_b128 v[180:183], v3 offset:4096
ds_read_b128 v[184:187], v3 offset:5120
v_mfma_f32_16x16x32_bf16 a[248:251], v[216:219], v[96:99], a[248:251]
v_exp_f32 v45, v45
v_mfma_f32_16x16x32_bf16 a[252:255], v[224:227], v[96:99], a[252:255]
buffer_load_dwordx4 v4, s[4:7], s58 offen offset:2048 sc1 lds
v_mfma_f32_16x16x32_bf16 a[252:255], v[220:223], v[92:95], a[252:255]
v_exp_f32 v46, v46
v_mfma_f32_16x16x32_bf16 v[32:35], v[8:11], v[92:95], v[32:35]
ds_read_b128 v[188:191], v3 offset:6144
ds_read_b128 v[192:195], v3 offset:7168
v_mfma_f32_16x16x32_bf16 v[32:35], v[8:11], v[96:99], v[32:35]
v_exp_f32 v47, v47
v_mfma_f32_16x16x32_bf16 v[52:55], v[100:103], a[80:83], 0
v_cvt_pk_bf16_f32 v72, v44, v45
v_cvt_pk_bf16_f32 v73, v46, v47
v_mfma_f32_16x16x32_bf16 v[52:55], v[104:107], a[84:87], v[52:55]
v_exp_f32 v48, v48
v_mfma_f32_16x16x32_bf16 v[52:55], v[108:111], a[88:91], v[52:55]
ds_read_b128 v[196:199], v3 offset:8192
ds_read_b128 v[200:203], v3 offset:9216
v_mfma_f32_16x16x32_bf16 v[52:55], v[112:115], a[92:95], v[52:55]
v_exp_f32 v49, v49
v_mfma_f32_16x16x32_bf16 v[56:59], v[128:131], a[92:95], 0
ds_read_b128 v[204:207], v3 offset:10240
ds_read_b128 v[208:211], v3 offset:11264
v_mfma_f32_16x16x32_bf16 v[56:59], v[124:127], a[88:91], v[56:59]
v_exp_f32 v50, v50
v_mfma_f32_16x16x32_bf16 v[56:59], v[120:123], a[84:87], v[56:59]
ds_read_b128 v[212:215], v3 offset:12288
ds_read_b128 v[216:219], v3 offset:13312
v_mfma_f32_16x16x32_bf16 v[56:59], v[116:119], a[80:83], v[56:59]
v_exp_f32 v51, v51
v_mfma_f32_16x16x32_bf16 v[60:63], v[132:135], a[80:83], 0
v_cvt_pk_bf16_f32 v74, v48, v49
v_cvt_pk_bf16_f32 v75, v50, v51
v_mfma_f32_16x16x32_bf16 v[60:63], v[136:139], a[84:87], v[60:63]
v_exp_f32 v52, v52
v_mfma_f32_16x16x32_bf16 v[60:63], v[140:143], a[88:91], v[60:63]
ds_read_b128 v[220:223], v3 offset:14336
ds_read_b128 v[224:227], v3 offset:15360
v_mfma_f32_16x16x32_bf16 v[60:63], v[144:147], a[92:95], v[60:63]
v_exp_f32 v53, v53
v_mfma_f32_16x16x32_bf16 v[64:67], v[160:163], a[92:95], 0
buffer_load_dwordx4 v4, s[4:7], s58 offen offset:3072 sc1 lds
v_mfma_f32_16x16x32_bf16 v[64:67], v[156:159], a[88:91], v[64:67]
s_add_u32 m0, s56, 4096
v_exp_f32 v54, v54
v_mfma_f32_16x16x32_bf16 v[64:67], v[152:155], a[84:87], v[64:67]
v_xor_b32 v3, 196608, v3
v_mfma_f32_16x16x32_bf16 v[64:67], v[148:151], a[80:83], v[64:67]
s_waitcnt lgkmcnt(3)
v_mfma_f32_16x16x32_bf16 a[128:131], v[164:167], v[68:71], a[128:131]
buffer_load_dwordx4 v5, s[4:7], s58 offen offset:0 sc1 lds
v_mfma_f32_16x16x32_bf16 a[128:131], v[168:171], v[72:75], a[128:131]
v_exp_f32 v55, v55
v_mfma_f32_16x16x32_bf16 a[132:135], v[176:179], v[72:75], a[132:135]
v_cvt_pk_bf16_f32 v76, v52, v53
v_cvt_pk_bf16_f32 v77, v54, v55
v_mfma_f32_16x16x32_bf16 a[132:135], v[172:175], v[68:71], a[132:135]
v_exp_f32 v56, v56
v_mfma_f32_16x16x32_bf16 a[136:139], v[180:183], v[68:71], a[136:139]
buffer_load_dwordx4 v5, s[4:7], s58 offen offset:1024 sc1 lds
v_mfma_f32_16x16x32_bf16 a[136:139], v[184:187], v[72:75], a[136:139]
v_exp_f32 v57, v57
v_mfma_f32_16x16x32_bf16 a[140:143], v[192:195], v[72:75], a[140:143]
v_mfma_f32_16x16x32_bf16 a[140:143], v[188:191], v[68:71], a[140:143]
v_exp_f32 v58, v58
v_mfma_f32_16x16x32_bf16 a[144:147], v[196:199], v[68:71], a[144:147]
buffer_load_dwordx4 v5, s[4:7], s58 offen offset:2048 sc1 lds
v_mfma_f32_16x16x32_bf16 a[144:147], v[200:203], v[72:75], a[144:147]
v_exp_f32 v59, v59
v_mfma_f32_16x16x32_bf16 a[148:151], v[208:211], v[72:75], a[148:151]
v_cvt_pk_bf16_f32 v78, v56, v57
v_cvt_pk_bf16_f32 v79, v58, v59
v_mfma_f32_16x16x32_bf16 a[148:151], v[204:207], v[68:71], a[148:151]
v_exp_f32 v60, v60
v_mfma_f32_16x16x32_bf16 a[152:155], v[212:215], v[68:71], a[152:155]
s_waitcnt lgkmcnt(0)
buffer_load_dwordx4 v5, s[4:7], s58 offen offset:3072 sc1 lds
v_mfma_f32_16x16x32_bf16 a[152:155], v[216:219], v[72:75], a[152:155]
v_exp_f32 v61, v61
v_mfma_f32_16x16x32_bf16 a[156:159], v[224:227], v[72:75], a[156:159]
v_mfma_f32_16x16x32_bf16 a[156:159], v[220:223], v[68:71], a[156:159]
v_exp_f32 v62, v62
v_mfma_f32_16x16x32_bf16 v[20:23], v[8:11], v[68:71], v[20:23]
v_mfma_f32_16x16x32_bf16 v[20:23], v[8:11], v[72:75], v[20:23]
v_exp_f32 v63, v63
v_mfma_f32_16x16x32_bf16 v[36:39], v[100:103], a[96:99], 0
v_cvt_pk_bf16_f32 v80, v60, v61
v_cvt_pk_bf16_f32 v81, v62, v63
v_mfma_f32_16x16x32_bf16 v[36:39], v[104:107], a[100:103], v[36:39]
v_exp_f32 v64, v64
v_mfma_f32_16x16x32_bf16 v[36:39], v[108:111], a[104:107], v[36:39]
v_mfma_f32_16x16x32_bf16 v[36:39], v[112:115], a[108:111], v[36:39]
v_exp_f32 v65, v65
v_mfma_f32_16x16x32_bf16 v[40:43], v[128:131], a[108:111], 0
v_mfma_f32_16x16x32_bf16 v[40:43], v[124:127], a[104:107], v[40:43]
v_exp_f32 v66, v66
v_mfma_f32_16x16x32_bf16 v[40:43], v[120:123], a[100:103], v[40:43]
v_mfma_f32_16x16x32_bf16 v[40:43], v[116:119], a[96:99], v[40:43]
v_exp_f32 v67, v67
v_mfma_f32_16x16x32_bf16 v[44:47], v[132:135], a[96:99], 0
v_cvt_pk_bf16_f32 v82, v64, v65
v_cvt_pk_bf16_f32 v83, v66, v67
v_mfma_f32_16x16x32_bf16 v[44:47], v[136:139], a[100:103], v[44:47]
v_exp_f32 v36, v36
v_mfma_f32_16x16x32_bf16 v[44:47], v[140:143], a[104:107], v[44:47]
v_mfma_f32_16x16x32_bf16 v[44:47], v[144:147], a[108:111], v[44:47]
v_exp_f32 v37, v37
v_mfma_f32_16x16x32_bf16 v[48:51], v[160:163], a[108:111], 0
v_mfma_f32_16x16x32_bf16 v[48:51], v[156:159], a[104:107], v[48:51]
v_exp_f32 v38, v38
v_mfma_f32_16x16x32_bf16 v[48:51], v[152:155], a[100:103], v[48:51]
v_mfma_f32_16x16x32_bf16 v[48:51], v[148:151], a[96:99], v[48:51]
v_mfma_f32_16x16x32_bf16 a[160:163], v[164:167], v[76:79], a[160:163]
s_waitcnt vmcnt(24) lgkmcnt(0)
s_barrier
v_mfma_f32_16x16x32_bf16 a[160:163], v[168:171], v[80:83], a[160:163]
s_add_u32 s59, s58, 16777216
v_exp_f32 v39, v39
v_mfma_f32_16x16x32_bf16 a[164:167], v[176:179], v[80:83], a[164:167]
v_cvt_pk_bf16_f32 v84, v36, v37
v_cvt_pk_bf16_f32 v85, v38, v39
v_mfma_f32_16x16x32_bf16 a[164:167], v[172:175], v[76:79], a[164:167]
s_add_u32 m0, s57, 0
v_exp_f32 v40, v40
v_mfma_f32_16x16x32_bf16 a[168:171], v[180:183], v[76:79], a[168:171]
buffer_load_dwordx4 v4, s[4:7], s59 offen offset:0 sc1 lds
v_mfma_f32_16x16x32_bf16 a[168:171], v[184:187], v[80:83], a[168:171]
s_add_u32 s58, s58, 32768
v_exp_f32 v41, v41
v_mfma_f32_16x16x32_bf16 a[172:175], v[192:195], v[80:83], a[172:175]
s_cmp_eq_u32 s60, s61
v_mfma_f32_16x16x32_bf16 a[172:175], v[188:191], v[76:79], a[172:175]
s_cselect_b32 s58, 4194304, s58
v_exp_f32 v42, v42
v_mfma_f32_16x16x32_bf16 a[176:179], v[196:199], v[76:79], a[176:179]
buffer_load_dwordx4 v4, s[4:7], s59 offen offset:1024 sc1 lds
v_mfma_f32_16x16x32_bf16 a[176:179], v[200:203], v[80:83], a[176:179]
s_cmp_gt_u32 s60, 16
v_exp_f32 v43, v43
v_mfma_f32_16x16x32_bf16 a[180:183], v[208:211], v[80:83], a[180:183]
s_cselect_b32 s58, 2146435072, s58
v_cvt_pk_bf16_f32 v86, v40, v41
v_cvt_pk_bf16_f32 v87, v42, v43
v_mfma_f32_16x16x32_bf16 a[180:183], v[204:207], v[76:79], a[180:183]
s_xor_b32 s56, s56, 65536
v_exp_f32 v44, v44
v_mfma_f32_16x16x32_bf16 a[184:187], v[212:215], v[76:79], a[184:187]
buffer_load_dwordx4 v4, s[4:7], s59 offen offset:2048 sc1 lds
v_mfma_f32_16x16x32_bf16 a[184:187], v[216:219], v[80:83], a[184:187]
s_add_u32 s60, s60, 1
v_exp_f32 v45, v45
v_mfma_f32_16x16x32_bf16 a[188:191], v[224:227], v[80:83], a[188:191]
v_mfma_f32_16x16x32_bf16 a[188:191], v[220:223], v[76:79], a[188:191]
v_exp_f32 v46, v46
v_mfma_f32_16x16x32_bf16 v[24:27], v[8:11], v[76:79], v[24:27]
buffer_load_dwordx4 v4, s[4:7], s59 offen offset:3072 sc1 lds
v_mfma_f32_16x16x32_bf16 v[24:27], v[8:11], v[80:83], v[24:27]
v_exp_f32 v47, v47
v_mfma_f32_16x16x32_bf16 v[52:55], v[100:103], a[112:115], 0
v_cvt_pk_bf16_f32 v88, v44, v45
v_cvt_pk_bf16_f32 v89, v46, v47
v_mfma_f32_16x16x32_bf16 v[52:55], v[104:107], a[116:119], v[52:55]
v_exp_f32 v48, v48
v_mfma_f32_16x16x32_bf16 v[52:55], v[108:111], a[120:123], v[52:55]
ds_read_b128 v[100:103], v2 offset:0
ds_read_b128 v[104:107], v2 offset:1024
v_mfma_f32_16x16x32_bf16 v[52:55], v[112:115], a[124:127], v[52:55]
s_add_u32 m0, s57, 4096
v_exp_f32 v49, v49
v_mfma_f32_16x16x32_bf16 v[56:59], v[128:131], a[124:127], 0
buffer_load_dwordx4 v5, s[4:7], s59 offen offset:0 sc1 lds
v_mfma_f32_16x16x32_bf16 v[56:59], v[124:127], a[120:123], v[56:59]
v_exp_f32 v50, v50
v_mfma_f32_16x16x32_bf16 v[56:59], v[120:123], a[116:119], v[56:59]
ds_read_b128 v[108:111], v2 offset:2048
ds_read_b128 v[112:115], v2 offset:3072
v_mfma_f32_16x16x32_bf16 v[56:59], v[116:119], a[112:115], v[56:59]
v_exp_f32 v51, v51
v_mfma_f32_16x16x32_bf16 v[60:63], v[132:135], a[112:115], 0
v_cvt_pk_bf16_f32 v90, v48, v49
v_cvt_pk_bf16_f32 v91, v50, v51
v_mfma_f32_16x16x32_bf16 v[60:63], v[136:139], a[116:119], v[60:63]
v_exp_f32 v52, v52
v_mfma_f32_16x16x32_bf16 v[60:63], v[140:143], a[120:123], v[60:63]
ds_read_b128 v[116:119], v2 offset:4096
ds_read_b128 v[120:123], v2 offset:5120
v_mfma_f32_16x16x32_bf16 v[60:63], v[144:147], a[124:127], v[60:63]
v_exp_f32 v53, v53
v_mfma_f32_16x16x32_bf16 v[64:67], v[160:163], a[124:127], 0
buffer_load_dwordx4 v5, s[4:7], s59 offen offset:1024 sc1 lds
v_mfma_f32_16x16x32_bf16 v[64:67], v[156:159], a[120:123], v[64:67]
v_exp_f32 v54, v54
v_mfma_f32_16x16x32_bf16 v[64:67], v[152:155], a[116:119], v[64:67]
ds_read_b128 v[124:127], v2 offset:6144
ds_read_b128 v[128:131], v2 offset:7168
v_mfma_f32_16x16x32_bf16 v[64:67], v[148:151], a[112:115], v[64:67]
v_mfma_f32_16x16x32_bf16 a[192:195], v[164:167], v[84:87], a[192:195]
ds_read_b128 v[132:135], v2 offset:8192
ds_read_b128 v[136:139], v2 offset:9216
v_mfma_f32_16x16x32_bf16 a[192:195], v[168:171], v[88:91], a[192:195]
v_exp_f32 v55, v55
v_mfma_f32_16x16x32_bf16 a[196:199], v[176:179], v[88:91], a[196:199]
v_cvt_pk_bf16_f32 v92, v52, v53
v_cvt_pk_bf16_f32 v93, v54, v55
v_mfma_f32_16x16x32_bf16 a[196:199], v[172:175], v[84:87], a[196:199]
v_exp_f32 v56, v56
v_mfma_f32_16x16x32_bf16 a[200:203], v[180:183], v[84:87], a[200:203]
ds_read_b128 v[140:143], v2 offset:10240
ds_read_b128 v[144:147], v2 offset:11264
v_mfma_f32_16x16x32_bf16 a[200:203], v[184:187], v[88:91], a[200:203]
v_exp_f32 v57, v57
v_mfma_f32_16x16x32_bf16 a[204:207], v[192:195], v[88:91], a[204:207]
buffer_load_dwordx4 v5, s[4:7], s59 offen offset:2048 sc1 lds
v_mfma_f32_16x16x32_bf16 a[204:207], v[188:191], v[84:87], a[204:207]
v_exp_f32 v58, v58
v_mfma_f32_16x16x32_bf16 a[208:211], v[196:199], v[84:87], a[208:211]
ds_read_b128 v[148:151], v2 offset:12288
ds_read_b128 v[152:155], v2 offset:13312
v_mfma_f32_16x16x32_bf16 a[208:211], v[200:203], v[88:91], a[208:211]
v_exp_f32 v59, v59
v_mfma_f32_16x16x32_bf16 a[212:215], v[208:211], v[88:91], a[212:215]
v_cvt_pk_bf16_f32 v94, v56, v57
v_cvt_pk_bf16_f32 v95, v58, v59
v_mfma_f32_16x16x32_bf16 a[212:215], v[204:207], v[84:87], a[212:215]
v_exp_f32 v60, v60
v_mfma_f32_16x16x32_bf16 a[216:219], v[212:215], v[84:87], a[216:219]
ds_read_b128 v[156:159], v2 offset:14336
ds_read_b128 v[160:163], v2 offset:15360
v_mfma_f32_16x16x32_bf16 a[216:219], v[216:219], v[88:91], a[216:219]
v_exp_f32 v61, v61
v_mfma_f32_16x16x32_bf16 a[220:223], v[224:227], v[88:91], a[220:223]
buffer_load_dwordx4 v5, s[4:7], s59 offen offset:3072 sc1 lds
v_mfma_f32_16x16x32_bf16 a[220:223], v[220:223], v[84:87], a[220:223]
s_xor_b32 s57, s57, 196608
v_exp_f32 v62, v62
v_mfma_f32_16x16x32_bf16 v[28:31], v[8:11], v[84:87], v[28:31]
v_xor_b32 v2, 65536, v2
v_mfma_f32_16x16x32_bf16 v[28:31], v[8:11], v[88:91], v[28:31]
s_waitcnt lgkmcnt(3)
v_exp_f32 v63, v63
v_mfma_f32_16x16x32_bf16 v[36:39], v[100:103], a[64:67], 0
v_cvt_pk_bf16_f32 v96, v60, v61
v_cvt_pk_bf16_f32 v97, v62, v63
v_mfma_f32_16x16x32_bf16 v[36:39], v[104:107], a[68:71], v[36:39]
v_exp_f32 v64, v64
v_mfma_f32_16x16x32_bf16 v[36:39], v[108:111], a[72:75], v[36:39]
v_mfma_f32_16x16x32_bf16 v[36:39], v[112:115], a[76:79], v[36:39]
v_exp_f32 v65, v65
v_mfma_f32_16x16x32_bf16 v[40:43], v[128:131], a[76:79], 0
v_mfma_f32_16x16x32_bf16 v[40:43], v[124:127], a[72:75], v[40:43]
v_exp_f32 v66, v66
v_mfma_f32_16x16x32_bf16 v[40:43], v[120:123], a[68:71], v[40:43]
v_mfma_f32_16x16x32_bf16 v[40:43], v[116:119], a[64:67], v[40:43]
v_exp_f32 v67, v67
v_mfma_f32_16x16x32_bf16 v[44:47], v[132:135], a[64:67], 0
v_cvt_pk_bf16_f32 v98, v64, v65
v_cvt_pk_bf16_f32 v99, v66, v67
v_mfma_f32_16x16x32_bf16 v[44:47], v[136:139], a[68:71], v[44:47]
v_exp_f32 v36, v36
v_mfma_f32_16x16x32_bf16 v[44:47], v[140:143], a[72:75], v[44:47]
v_mfma_f32_16x16x32_bf16 v[44:47], v[144:147], a[76:79], v[44:47]
s_waitcnt lgkmcnt(0)
v_exp_f32 v37, v37
v_mfma_f32_16x16x32_bf16 v[48:51], v[160:163], a[76:79], 0
v_mfma_f32_16x16x32_bf16 v[48:51], v[156:159], a[72:75], v[48:51]
v_exp_f32 v38, v38
v_mfma_f32_16x16x32_bf16 v[48:51], v[152:155], a[68:71], v[48:51]
s_waitcnt vmcnt(16) lgkmcnt(0)
s_barrier
v_mfma_f32_16x16x32_bf16 v[48:51], v[148:151], a[64:67], v[48:51]
s_add_u32 m0, s56, 0
v_mfma_f32_16x16x32_bf16 a[224:227], v[164:167], v[92:95], a[224:227]
buffer_load_dwordx4 v4, s[4:7], s58 offen offset:0 sc1 lds
v_mfma_f32_16x16x32_bf16 a[224:227], v[168:171], v[96:99], a[224:227]
v_exp_f32 v39, v39
v_mfma_f32_16x16x32_bf16 a[228:231], v[176:179], v[96:99], a[228:231]
v_cvt_pk_bf16_f32 v68, v36, v37
v_cvt_pk_bf16_f32 v69, v38, v39
v_mfma_f32_16x16x32_bf16 a[228:231], v[172:175], v[92:95], a[228:231]
v_exp_f32 v40, v40
v_mfma_f32_16x16x32_bf16 a[232:235], v[180:183], v[92:95], a[232:235]
ds_read_b128 v[164:167], v3 offset:0
ds_read_b128 v[168:171], v3 offset:1024
v_mfma_f32_16x16x32_bf16 a[232:235], v[184:187], v[96:99], a[232:235]
v_exp_f32 v41, v41
v_mfma_f32_16x16x32_bf16 a[236:239], v[192:195], v[96:99], a[236:239]
buffer_load_dwordx4 v4, s[4:7], s58 offen offset:1024 sc1 lds
v_mfma_f32_16x16x32_bf16 a[236:239], v[188:191], v[92:95], a[236:239]
v_exp_f32 v42, v42
v_mfma_f32_16x16x32_bf16 a[240:243], v[196:199], v[92:95], a[240:243]
ds_read_b128 v[172:175], v3 offset:2048
ds_read_b128 v[176:179], v3 offset:3072
v_mfma_f32_16x16x32_bf16 a[240:243], v[200:203], v[96:99], a[240:243]
v_exp_f32 v43, v43
v_mfma_f32_16x16x32_bf16 a[244:247], v[208:211], v[96:99], a[244:247]
v_cvt_pk_bf16_f32 v70, v40, v41
v_cvt_pk_bf16_f32 v71, v42, v43
v_mfma_f32_16x16x32_bf16 a[244:247], v[204:207], v[92:95], a[244:247]
v_exp_f32 v44, v44
v_mfma_f32_16x16x32_bf16 a[248:251], v[212:215], v[92:95], a[248:251]
ds_read_b128 v[180:183], v3 offset:4096
ds_read_b128 v[184:187], v3 offset:5120
v_mfma_f32_16x16x32_bf16 a[248:251], v[216:219], v[96:99], a[248:251]
v_exp_f32 v45, v45
v_mfma_f32_16x16x32_bf16 a[252:255], v[224:227], v[96:99], a[252:255]
buffer_load_dwordx4 v4, s[4:7], s58 offen offset:2048 sc1 lds
v_mfma_f32_16x16x32_bf16 a[252:255], v[220:223], v[92:95], a[252:255]
v_exp_f32 v46, v46
v_mfma_f32_16x16x32_bf16 v[32:35], v[8:11], v[92:95], v[32:35]
ds_read_b128 v[188:191], v3 offset:6144
ds_read_b128 v[192:195], v3 offset:7168
v_mfma_f32_16x16x32_bf16 v[32:35], v[8:11], v[96:99], v[32:35]
v_exp_f32 v47, v47
v_mfma_f32_16x16x32_bf16 v[52:55], v[100:103], a[80:83], 0
v_cvt_pk_bf16_f32 v72, v44, v45
v_cvt_pk_bf16_f32 v73, v46, v47
v_mfma_f32_16x16x32_bf16 v[52:55], v[104:107], a[84:87], v[52:55]
v_exp_f32 v48, v48
v_mfma_f32_16x16x32_bf16 v[52:55], v[108:111], a[88:91], v[52:55]
ds_read_b128 v[196:199], v3 offset:8192
ds_read_b128 v[200:203], v3 offset:9216
v_mfma_f32_16x16x32_bf16 v[52:55], v[112:115], a[92:95], v[52:55]
v_exp_f32 v49, v49
v_mfma_f32_16x16x32_bf16 v[56:59], v[128:131], a[92:95], 0
ds_read_b128 v[204:207], v3 offset:10240
ds_read_b128 v[208:211], v3 offset:11264
v_mfma_f32_16x16x32_bf16 v[56:59], v[124:127], a[88:91], v[56:59]
v_exp_f32 v50, v50
v_mfma_f32_16x16x32_bf16 v[56:59], v[120:123], a[84:87], v[56:59]
ds_read_b128 v[212:215], v3 offset:12288
ds_read_b128 v[216:219], v3 offset:13312
v_mfma_f32_16x16x32_bf16 v[56:59], v[116:119], a[80:83], v[56:59]
v_exp_f32 v51, v51
v_mfma_f32_16x16x32_bf16 v[60:63], v[132:135], a[80:83], 0
v_cvt_pk_bf16_f32 v74, v48, v49
v_cvt_pk_bf16_f32 v75, v50, v51
v_mfma_f32_16x16x32_bf16 v[60:63], v[136:139], a[84:87], v[60:63]
v_exp_f32 v52, v52
v_mfma_f32_16x16x32_bf16 v[60:63], v[140:143], a[88:91], v[60:63]
ds_read_b128 v[220:223], v3 offset:14336
ds_read_b128 v[224:227], v3 offset:15360
v_mfma_f32_16x16x32_bf16 v[60:63], v[144:147], a[92:95], v[60:63]
v_exp_f32 v53, v53
v_mfma_f32_16x16x32_bf16 v[64:67], v[160:163], a[92:95], 0
buffer_load_dwordx4 v4, s[4:7], s58 offen offset:3072 sc1 lds
v_mfma_f32_16x16x32_bf16 v[64:67], v[156:159], a[88:91], v[64:67]
s_add_u32 m0, s56, 4096
v_exp_f32 v54, v54
v_mfma_f32_16x16x32_bf16 v[64:67], v[152:155], a[84:87], v[64:67]
v_xor_b32 v3, 196608, v3
v_mfma_f32_16x16x32_bf16 v[64:67], v[148:151], a[80:83], v[64:67]
s_waitcnt lgkmcnt(3)
v_mfma_f32_16x16x32_bf16 a[128:131], v[164:167], v[68:71], a[128:131]
buffer_load_dwordx4 v5, s[4:7], s58 offen offset:0 sc1 lds
v_mfma_f32_16x16x32_bf16 a[128:131], v[168:171], v[72:75], a[128:131]
v_exp_f32 v55, v55
v_mfma_f32_16x16x32_bf16 a[132:135], v[176:179], v[72:75], a[132:135]
v_cvt_pk_bf16_f32 v76, v52, v53
v_cvt_pk_bf16_f32 v77, v54, v55
v_mfma_f32_16x16x32_bf16 a[132:135], v[172:175], v[68:71], a[132:135]
v_exp_f32 v56, v56
v_mfma_f32_16x16x32_bf16 a[136:139], v[180:183], v[68:71], a[136:139]
buffer_load_dwordx4 v5, s[4:7], s58 offen offset:1024 sc1 lds
v_mfma_f32_16x16x32_bf16 a[136:139], v[184:187], v[72:75], a[136:139]
v_exp_f32 v57, v57
v_mfma_f32_16x16x32_bf16 a[140:143], v[192:195], v[72:75], a[140:143]
ds_read_b64_tr_b16 v[228:229], v252 offset:0
ds_read_b64_tr_b16 v[230:231], v252 offset:4096
v_mfma_f32_16x16x32_bf16 a[140:143], v[188:191], v[68:71], a[140:143]
v_exp_f32 v58, v58
v_mfma_f32_16x16x32_bf16 a[144:147], v[196:199], v[68:71], a[144:147]
buffer_load_dwordx4 v5, s[4:7], s58 offen offset:2048 sc1 lds
v_mfma_f32_16x16x32_bf16 a[144:147], v[200:203], v[72:75], a[144:147]
v_exp_f32 v59, v59
v_mfma_f32_16x16x32_bf16 a[148:151], v[208:211], v[72:75], a[148:151]
v_cvt_pk_bf16_f32 v78, v56, v57
v_cvt_pk_bf16_f32 v79, v58, v59
v_mfma_f32_16x16x32_bf16 a[148:151], v[204:207], v[68:71], a[148:151]
v_exp_f32 v60, v60
v_mfma_f32_16x16x32_bf16 a[152:155], v[212:215], v[68:71], a[152:155]
s_waitcnt lgkmcnt(2)
buffer_load_dwordx4 v5, s[4:7], s58 offen offset:3072 sc1 lds
v_mfma_f32_16x16x32_bf16 a[152:155], v[216:219], v[72:75], a[152:155]
v_exp_f32 v61, v61
v_mfma_f32_16x16x32_bf16 a[156:159], v[224:227], v[72:75], a[156:159]
ds_read_b64_tr_b16 v[232:233], v253 offset:0
ds_read_b64_tr_b16 v[234:235], v253 offset:4096
v_mfma_f32_16x16x32_bf16 a[156:159], v[220:223], v[68:71], a[156:159]
v_exp_f32 v62, v62
v_mfma_f32_16x16x32_bf16 v[20:23], v[8:11], v[68:71], v[20:23]
ds_read_b64_tr_b16 v[236:237], v252 offset:8192
ds_read_b64_tr_b16 v[238:239], v252 offset:12288
v_mfma_f32_16x16x32_bf16 v[20:23], v[8:11], v[72:75], v[20:23]
v_exp_f32 v63, v63
v_mfma_f32_16x16x32_bf16 v[36:39], v[100:103], a[96:99], 0
v_cvt_pk_bf16_f32 v80, v60, v61
v_cvt_pk_bf16_f32 v81, v62, v63
v_mfma_f32_16x16x32_bf16 v[36:39], v[104:107], a[100:103], v[36:39]
v_exp_f32 v64, v64
v_mfma_f32_16x16x32_bf16 v[36:39], v[108:111], a[104:107], v[36:39]
ds_read_b64_tr_b16 v[240:241], v253 offset:8192
ds_read_b64_tr_b16 v[242:243], v253 offset:12288
v_mfma_f32_16x16x32_bf16 v[36:39], v[112:115], a[108:111], v[36:39]
v_exp_f32 v65, v65
v_mfma_f32_16x16x32_bf16 v[40:43], v[128:131], a[108:111], 0
ds_read_b64_tr_b16 v[244:245], v252 offset:16384
ds_read_b64_tr_b16 v[246:247], v252 offset:20480
v_mfma_f32_16x16x32_bf16 v[40:43], v[124:127], a[104:107], v[40:43]
v_exp_f32 v66, v66
v_mfma_f32_16x16x32_bf16 v[40:43], v[120:123], a[100:103], v[40:43]
ds_read_b64_tr_b16 v[248:249], v253 offset:16384
ds_read_b64_tr_b16 v[250:251], v253 offset:20480
v_mfma_f32_16x16x32_bf16 v[40:43], v[116:119], a[96:99], v[40:43]
v_exp_f32 v67, v67
v_mfma_f32_16x16x32_bf16 v[44:47], v[132:135], a[96:99], 0
v_cvt_pk_bf16_f32 v82, v64, v65
v_cvt_pk_bf16_f32 v83, v66, v67
v_mfma_f32_16x16x32_bf16 v[44:47], v[136:139], a[100:103], v[44:47]
s_add_u32 s3, s16, 0
v_exp_f32 v36, v36
v_mfma_f32_16x16x32_bf16 v[44:47], v[140:143], a[104:107], v[44:47]
s_waitcnt lgkmcnt(6)
buffer_store_dwordx4 v[228:231], v1, s[4:7], s3 offen sc1
v_mfma_f32_16x16x32_bf16 v[44:47], v[144:147], a[108:111], v[44:47]
v_exp_f32 v37, v37
v_mfma_f32_16x16x32_bf16 v[48:51], v[160:163], a[108:111], 0
v_mfma_f32_16x16x32_bf16 v[48:51], v[156:159], a[104:107], v[48:51]
s_add_u32 s3, s16, 4096
v_exp_f32 v38, v38
v_mfma_f32_16x16x32_bf16 v[48:51], v[152:155], a[100:103], v[48:51]
buffer_store_dwordx4 v[232:235], v1, s[4:7], s3 offen sc1
v_mfma_f32_16x16x32_bf16 v[48:51], v[148:151], a[96:99], v[48:51]
v_mfma_f32_16x16x32_bf16 a[160:163], v[164:167], v[76:79], a[160:163]
s_waitcnt vmcnt(18) lgkmcnt(0)
s_barrier
v_mfma_f32_16x16x32_bf16 a[160:163], v[168:171], v[80:83], a[160:163]
s_add_u32 s59, s58, 16777216
v_exp_f32 v39, v39
v_mfma_f32_16x16x32_bf16 a[164:167], v[176:179], v[80:83], a[164:167]
v_cvt_pk_bf16_f32 v84, v36, v37
v_cvt_pk_bf16_f32 v85, v38, v39
v_mfma_f32_16x16x32_bf16 a[164:167], v[172:175], v[76:79], a[164:167]
s_add_u32 m0, s57, 0
v_exp_f32 v40, v40
v_mfma_f32_16x16x32_bf16 a[168:171], v[180:183], v[76:79], a[168:171]
buffer_load_dwordx4 v4, s[4:7], s59 offen offset:0 sc1 lds
v_mfma_f32_16x16x32_bf16 a[168:171], v[184:187], v[80:83], a[168:171]
s_add_u32 s58, s58, 32768
v_exp_f32 v41, v41
v_mfma_f32_16x16x32_bf16 a[172:175], v[192:195], v[80:83], a[172:175]
s_cmp_eq_u32 s60, s61
ds_read_b64_tr_b16 v[228:229], v252 offset:24576
ds_read_b64_tr_b16 v[230:231], v252 offset:28672
v_mfma_f32_16x16x32_bf16 a[172:175], v[188:191], v[76:79], a[172:175]
s_cselect_b32 s58, 4194304, s58
v_exp_f32 v42, v42
v_mfma_f32_16x16x32_bf16 a[176:179], v[196:199], v[76:79], a[176:179]
buffer_load_dwordx4 v4, s[4:7], s59 offen offset:1024 sc1 lds
v_mfma_f32_16x16x32_bf16 a[176:179], v[200:203], v[80:83], a[176:179]
s_cmp_gt_u32 s60, 16
v_exp_f32 v43, v43
v_mfma_f32_16x16x32_bf16 a[180:183], v[208:211], v[80:83], a[180:183]
s_cselect_b32 s58, 2146435072, s58
v_cvt_pk_bf16_f32 v86, v40, v41
v_cvt_pk_bf16_f32 v87, v42, v43
v_mfma_f32_16x16x32_bf16 a[180:183], v[204:207], v[76:79], a[180:183]
s_xor_b32 s56, s56, 65536
v_exp_f32 v44, v44
v_mfma_f32_16x16x32_bf16 a[184:187], v[212:215], v[76:79], a[184:187]
buffer_load_dwordx4 v4, s[4:7], s59 offen offset:2048 sc1 lds
v_mfma_f32_16x16x32_bf16 a[184:187], v[216:219], v[80:83], a[184:187]
s_add_u32 s60, s60, 1
v_exp_f32 v45, v45
v_mfma_f32_16x16x32_bf16 a[188:191], v[224:227], v[80:83], a[188:191]
ds_read_b64_tr_b16 v[232:233], v253 offset:24576
ds_read_b64_tr_b16 v[234:235], v253 offset:28672
v_mfma_f32_16x16x32_bf16 a[188:191], v[220:223], v[76:79], a[188:191]
v_exp_f32 v46, v46
v_mfma_f32_16x16x32_bf16 v[24:27], v[8:11], v[76:79], v[24:27]
buffer_load_dwordx4 v4, s[4:7], s59 offen offset:3072 sc1 lds
v_mfma_f32_16x16x32_bf16 v[24:27], v[8:11], v[80:83], v[24:27]
v_exp_f32 v47, v47
v_mfma_f32_16x16x32_bf16 v[52:55], v[100:103], a[112:115], 0
v_cvt_pk_bf16_f32 v88, v44, v45
v_cvt_pk_bf16_f32 v89, v46, v47
v_mfma_f32_16x16x32_bf16 v[52:55], v[104:107], a[116:119], v[52:55]
v_exp_f32 v48, v48
v_mfma_f32_16x16x32_bf16 v[52:55], v[108:111], a[120:123], v[52:55]
ds_read_b128 v[100:103], v2 offset:0
ds_read_b128 v[104:107], v2 offset:1024
v_mfma_f32_16x16x32_bf16 v[52:55], v[112:115], a[124:127], v[52:55]
s_add_u32 m0, s57, 4096
v_exp_f32 v49, v49
v_mfma_f32_16x16x32_bf16 v[56:59], v[128:131], a[124:127], 0
buffer_load_dwordx4 v5, s[4:7], s59 offen offset:0 sc1 lds
v_mfma_f32_16x16x32_bf16 v[56:59], v[124:127], a[120:123], v[56:59]
v_exp_f32 v50, v50
v_mfma_f32_16x16x32_bf16 v[56:59], v[120:123], a[116:119], v[56:59]
ds_read_b128 v[108:111], v2 offset:2048
ds_read_b128 v[112:115], v2 offset:3072
v_mfma_f32_16x16x32_bf16 v[56:59], v[116:119], a[112:115], v[56:59]
v_exp_f32 v51, v51
v_mfma_f32_16x16x32_bf16 v[60:63], v[132:135], a[112:115], 0
v_cvt_pk_bf16_f32 v90, v48, v49
v_cvt_pk_bf16_f32 v91, v50, v51
v_mfma_f32_16x16x32_bf16 v[60:63], v[136:139], a[116:119], v[60:63]
v_exp_f32 v52, v52
v_mfma_f32_16x16x32_bf16 v[60:63], v[140:143], a[120:123], v[60:63]
ds_read_b128 v[116:119], v2 offset:4096
ds_read_b128 v[120:123], v2 offset:5120
v_mfma_f32_16x16x32_bf16 v[60:63], v[144:147], a[124:127], v[60:63]
v_exp_f32 v53, v53
v_mfma_f32_16x16x32_bf16 v[64:67], v[160:163], a[124:127], 0
buffer_load_dwordx4 v5, s[4:7], s59 offen offset:1024 sc1 lds
v_mfma_f32_16x16x32_bf16 v[64:67], v[156:159], a[120:123], v[64:67]
v_exp_f32 v54, v54
v_mfma_f32_16x16x32_bf16 v[64:67], v[152:155], a[116:119], v[64:67]
s_add_u32 s3, s17, 0
ds_read_b128 v[124:127], v2 offset:6144
ds_read_b128 v[128:131], v2 offset:7168
v_mfma_f32_16x16x32_bf16 v[64:67], v[148:151], a[112:115], v[64:67]
buffer_store_dwordx4 v[236:239], v1, s[4:7], s3 offen sc1
v_mfma_f32_16x16x32_bf16 a[192:195], v[164:167], v[84:87], a[192:195]
ds_read_b128 v[132:135], v2 offset:8192
ds_read_b128 v[136:139], v2 offset:9216
v_mfma_f32_16x16x32_bf16 a[192:195], v[168:171], v[88:91], a[192:195]
v_exp_f32 v55, v55
v_mfma_f32_16x16x32_bf16 a[196:199], v[176:179], v[88:91], a[196:199]
v_cvt_pk_bf16_f32 v92, v52, v53
v_cvt_pk_bf16_f32 v93, v54, v55
v_mfma_f32_16x16x32_bf16 a[196:199], v[172:175], v[84:87], a[196:199]
v_exp_f32 v56, v56
v_mfma_f32_16x16x32_bf16 a[200:203], v[180:183], v[84:87], a[200:203]
ds_read_b128 v[140:143], v2 offset:10240
ds_read_b128 v[144:147], v2 offset:11264
v_mfma_f32_16x16x32_bf16 a[200:203], v[184:187], v[88:91], a[200:203]
v_exp_f32 v57, v57
v_mfma_f32_16x16x32_bf16 a[204:207], v[192:195], v[88:91], a[204:207]
buffer_load_dwordx4 v5, s[4:7], s59 offen offset:2048 sc1 lds
v_mfma_f32_16x16x32_bf16 a[204:207], v[188:191], v[84:87], a[204:207]
v_exp_f32 v58, v58
v_mfma_f32_16x16x32_bf16 a[208:211], v[196:199], v[84:87], a[208:211]
ds_read_b128 v[148:151], v2 offset:12288
ds_read_b128 v[152:155], v2 offset:13312
v_mfma_f32_16x16x32_bf16 a[208:211], v[200:203], v[88:91], a[208:211]
v_exp_f32 v59, v59
v_mfma_f32_16x16x32_bf16 a[212:215], v[208:211], v[88:91], a[212:215]
v_cvt_pk_bf16_f32 v94, v56, v57
v_cvt_pk_bf16_f32 v95, v58, v59
v_mfma_f32_16x16x32_bf16 a[212:215], v[204:207], v[84:87], a[212:215]
v_exp_f32 v60, v60
v_mfma_f32_16x16x32_bf16 a[216:219], v[212:215], v[84:87], a[216:219]
ds_read_b128 v[156:159], v2 offset:14336
ds_read_b128 v[160:163], v2 offset:15360
v_mfma_f32_16x16x32_bf16 a[216:219], v[216:219], v[88:91], a[216:219]
v_exp_f32 v61, v61
v_mfma_f32_16x16x32_bf16 a[220:223], v[224:227], v[88:91], a[220:223]
buffer_load_dwordx4 v5, s[4:7], s59 offen offset:3072 sc1 lds
v_mfma_f32_16x16x32_bf16 a[220:223], v[220:223], v[84:87], a[220:223]
s_xor_b32 s57, s57, 196608
v_exp_f32 v62, v62
v_mfma_f32_16x16x32_bf16 v[28:31], v[8:11], v[84:87], v[28:31]
v_xor_b32 v2, 65536, v2
v_mfma_f32_16x16x32_bf16 v[28:31], v[8:11], v[88:91], v[28:31]
s_waitcnt lgkmcnt(3)
v_exp_f32 v63, v63
v_mfma_f32_16x16x32_bf16 v[36:39], v[100:103], a[64:67], 0
v_cvt_pk_bf16_f32 v96, v60, v61
v_cvt_pk_bf16_f32 v97, v62, v63
v_mfma_f32_16x16x32_bf16 v[36:39], v[104:107], a[68:71], v[36:39]
s_add_u32 s3, s17, 4096
v_exp_f32 v64, v64
v_mfma_f32_16x16x32_bf16 v[36:39], v[108:111], a[72:75], v[36:39]
buffer_store_dwordx4 v[240:243], v1, s[4:7], s3 offen sc1
v_mfma_f32_16x16x32_bf16 v[36:39], v[112:115], a[76:79], v[36:39]
s_add_u32 s3, s18, 0
v_exp_f32 v65, v65
v_mfma_f32_16x16x32_bf16 v[40:43], v[128:131], a[76:79], 0
buffer_store_dwordx4 v[244:247], v1, s[4:7], s3 offen sc1
v_mfma_f32_16x16x32_bf16 v[40:43], v[124:127], a[72:75], v[40:43]
s_add_u32 s3, s18, 4096
v_exp_f32 v66, v66
v_mfma_f32_16x16x32_bf16 v[40:43], v[120:123], a[68:71], v[40:43]
buffer_store_dwordx4 v[248:251], v1, s[4:7], s3 offen sc1
v_mfma_f32_16x16x32_bf16 v[40:43], v[116:119], a[64:67], v[40:43]
v_exp_f32 v67, v67
v_mfma_f32_16x16x32_bf16 v[44:47], v[132:135], a[64:67], 0
v_cvt_pk_bf16_f32 v98, v64, v65
v_cvt_pk_bf16_f32 v99, v66, v67
v_mfma_f32_16x16x32_bf16 v[44:47], v[136:139], a[68:71], v[44:47]
s_add_u32 s3, s19, 0
v_exp_f32 v36, v36
v_mfma_f32_16x16x32_bf16 v[44:47], v[140:143], a[72:75], v[44:47]
buffer_store_dwordx4 v[228:231], v1, s[4:7], s3 offen sc1
v_mfma_f32_16x16x32_bf16 v[44:47], v[144:147], a[76:79], v[44:47]
s_waitcnt lgkmcnt(0)
s_add_u32 s3, s19, 4096
v_exp_f32 v37, v37
v_mfma_f32_16x16x32_bf16 v[48:51], v[160:163], a[76:79], 0
buffer_store_dwordx4 v[232:235], v1, s[4:7], s3 offen sc1
v_mfma_f32_16x16x32_bf16 v[48:51], v[156:159], a[72:75], v[48:51]
v_exp_f32 v38, v38
v_mfma_f32_16x16x32_bf16 v[48:51], v[152:155], a[68:71], v[48:51]
s_waitcnt vmcnt(24) lgkmcnt(0)
s_barrier
v_mfma_f32_16x16x32_bf16 v[48:51], v[148:151], a[64:67], v[48:51]
s_add_u32 m0, s56, 0
v_mfma_f32_16x16x32_bf16 a[224:227], v[164:167], v[92:95], a[224:227]
buffer_load_dwordx4 v4, s[4:7], s58 offen offset:0 sc1 lds
v_mfma_f32_16x16x32_bf16 a[224:227], v[168:171], v[96:99], a[224:227]
v_exp_f32 v39, v39
v_mfma_f32_16x16x32_bf16 a[228:231], v[176:179], v[96:99], a[228:231]
v_cvt_pk_bf16_f32 v68, v36, v37
v_cvt_pk_bf16_f32 v69, v38, v39
v_mfma_f32_16x16x32_bf16 a[228:231], v[172:175], v[92:95], a[228:231]
v_exp_f32 v40, v40
v_mfma_f32_16x16x32_bf16 a[232:235], v[180:183], v[92:95], a[232:235]
ds_read_b128 v[164:167], v3 offset:0
ds_read_b128 v[168:171], v3 offset:1024
v_mfma_f32_16x16x32_bf16 a[232:235], v[184:187], v[96:99], a[232:235]
v_exp_f32 v41, v41
v_mfma_f32_16x16x32_bf16 a[236:239], v[192:195], v[96:99], a[236:239]
buffer_load_dwordx4 v4, s[4:7], s58 offen offset:1024 sc1 lds
v_mfma_f32_16x16x32_bf16 a[236:239], v[188:191], v[92:95], a[236:239]
v_exp_f32 v42, v42
v_mfma_f32_16x16x32_bf16 a[240:243], v[196:199], v[92:95], a[240:243]
ds_read_b128 v[172:175], v3 offset:2048
ds_read_b128 v[176:179], v3 offset:3072
v_mfma_f32_16x16x32_bf16 a[240:243], v[200:203], v[96:99], a[240:243]
v_exp_f32 v43, v43
v_mfma_f32_16x16x32_bf16 a[244:247], v[208:211], v[96:99], a[244:247]
v_cvt_pk_bf16_f32 v70, v40, v41
v_cvt_pk_bf16_f32 v71, v42, v43
v_mfma_f32_16x16x32_bf16 a[244:247], v[204:207], v[92:95], a[244:247]
v_exp_f32 v44, v44
v_mfma_f32_16x16x32_bf16 a[248:251], v[212:215], v[92:95], a[248:251]
ds_read_b128 v[180:183], v3 offset:4096
ds_read_b128 v[184:187], v3 offset:5120
v_mfma_f32_16x16x32_bf16 a[248:251], v[216:219], v[96:99], a[248:251]
v_exp_f32 v45, v45
v_mfma_f32_16x16x32_bf16 a[252:255], v[224:227], v[96:99], a[252:255]
buffer_load_dwordx4 v4, s[4:7], s58 offen offset:2048 sc1 lds
v_mfma_f32_16x16x32_bf16 a[252:255], v[220:223], v[92:95], a[252:255]
v_exp_f32 v46, v46
v_mfma_f32_16x16x32_bf16 v[32:35], v[8:11], v[92:95], v[32:35]
ds_read_b128 v[188:191], v3 offset:6144
ds_read_b128 v[192:195], v3 offset:7168
v_mfma_f32_16x16x32_bf16 v[32:35], v[8:11], v[96:99], v[32:35]
v_exp_f32 v47, v47
v_mfma_f32_16x16x32_bf16 v[52:55], v[100:103], a[80:83], 0
v_cvt_pk_bf16_f32 v72, v44, v45
v_cvt_pk_bf16_f32 v73, v46, v47
v_mfma_f32_16x16x32_bf16 v[52:55], v[104:107], a[84:87], v[52:55]
v_exp_f32 v48, v48
v_mfma_f32_16x16x32_bf16 v[52:55], v[108:111], a[88:91], v[52:55]
ds_read_b128 v[196:199], v3 offset:8192
ds_read_b128 v[200:203], v3 offset:9216
v_mfma_f32_16x16x32_bf16 v[52:55], v[112:115], a[92:95], v[52:55]
v_exp_f32 v49, v49
v_mfma_f32_16x16x32_bf16 v[56:59], v[128:131], a[92:95], 0
ds_read_b128 v[204:207], v3 offset:10240
ds_read_b128 v[208:211], v3 offset:11264
v_mfma_f32_16x16x32_bf16 v[56:59], v[124:127], a[88:91], v[56:59]
v_exp_f32 v50, v50
v_mfma_f32_16x16x32_bf16 v[56:59], v[120:123], a[84:87], v[56:59]
ds_read_b128 v[212:215], v3 offset:12288
ds_read_b128 v[216:219], v3 offset:13312
v_mfma_f32_16x16x32_bf16 v[56:59], v[116:119], a[80:83], v[56:59]
v_exp_f32 v51, v51
v_mfma_f32_16x16x32_bf16 v[60:63], v[132:135], a[80:83], 0
v_cvt_pk_bf16_f32 v74, v48, v49
v_cvt_pk_bf16_f32 v75, v50, v51
v_mfma_f32_16x16x32_bf16 v[60:63], v[136:139], a[84:87], v[60:63]
v_exp_f32 v52, v52
v_mfma_f32_16x16x32_bf16 v[60:63], v[140:143], a[88:91], v[60:63]
ds_read_b128 v[220:223], v3 offset:14336
ds_read_b128 v[224:227], v3 offset:15360
v_mfma_f32_16x16x32_bf16 v[60:63], v[144:147], a[92:95], v[60:63]
v_exp_f32 v53, v53
v_mfma_f32_16x16x32_bf16 v[64:67], v[160:163], a[92:95], 0
buffer_load_dwordx4 v4, s[4:7], s58 offen offset:3072 sc1 lds
v_mfma_f32_16x16x32_bf16 v[64:67], v[156:159], a[88:91], v[64:67]
s_add_u32 m0, s56, 4096
v_exp_f32 v54, v54
v_mfma_f32_16x16x32_bf16 v[64:67], v[152:155], a[84:87], v[64:67]
v_xor_b32 v3, 196608, v3
v_mfma_f32_16x16x32_bf16 v[64:67], v[148:151], a[80:83], v[64:67]
s_waitcnt lgkmcnt(3)
v_mfma_f32_16x16x32_bf16 a[128:131], v[164:167], v[68:71], a[128:131]
buffer_load_dwordx4 v5, s[4:7], s58 offen offset:0 sc1 lds
v_mfma_f32_16x16x32_bf16 a[128:131], v[168:171], v[72:75], a[128:131]
v_exp_f32 v55, v55
v_mfma_f32_16x16x32_bf16 a[132:135], v[176:179], v[72:75], a[132:135]
v_cvt_pk_bf16_f32 v76, v52, v53
v_cvt_pk_bf16_f32 v77, v54, v55
v_mfma_f32_16x16x32_bf16 a[132:135], v[172:175], v[68:71], a[132:135]
v_exp_f32 v56, v56
v_mfma_f32_16x16x32_bf16 a[136:139], v[180:183], v[68:71], a[136:139]
buffer_load_dwordx4 v5, s[4:7], s58 offen offset:1024 sc1 lds
v_mfma_f32_16x16x32_bf16 a[136:139], v[184:187], v[72:75], a[136:139]
v_exp_f32 v57, v57
v_mfma_f32_16x16x32_bf16 a[140:143], v[192:195], v[72:75], a[140:143]
v_mfma_f32_16x16x32_bf16 a[140:143], v[188:191], v[68:71], a[140:143]
v_exp_f32 v58, v58
v_mfma_f32_16x16x32_bf16 a[144:147], v[196:199], v[68:71], a[144:147]
buffer_load_dwordx4 v5, s[4:7], s58 offen offset:2048 sc1 lds
v_mfma_f32_16x16x32_bf16 a[144:147], v[200:203], v[72:75], a[144:147]
v_exp_f32 v59, v59
v_mfma_f32_16x16x32_bf16 a[148:151], v[208:211], v[72:75], a[148:151]
v_cvt_pk_bf16_f32 v78, v56, v57
v_cvt_pk_bf16_f32 v79, v58, v59
v_mfma_f32_16x16x32_bf16 a[148:151], v[204:207], v[68:71], a[148:151]
v_exp_f32 v60, v60
v_mfma_f32_16x16x32_bf16 a[152:155], v[212:215], v[68:71], a[152:155]
s_waitcnt lgkmcnt(0)
buffer_load_dwordx4 v5, s[4:7], s58 offen offset:3072 sc1 lds
v_mfma_f32_16x16x32_bf16 a[152:155], v[216:219], v[72:75], a[152:155]
v_exp_f32 v61, v61
v_mfma_f32_16x16x32_bf16 a[156:159], v[224:227], v[72:75], a[156:159]
v_mfma_f32_16x16x32_bf16 a[156:159], v[220:223], v[68:71], a[156:159]
v_exp_f32 v62, v62
v_mfma_f32_16x16x32_bf16 v[20:23], v[8:11], v[68:71], v[20:23]
v_mfma_f32_16x16x32_bf16 v[20:23], v[8:11], v[72:75], v[20:23]
v_exp_f32 v63, v63
v_mfma_f32_16x16x32_bf16 v[36:39], v[100:103], a[96:99], 0
v_cvt_pk_bf16_f32 v80, v60, v61
v_cvt_pk_bf16_f32 v81, v62, v63
v_mfma_f32_16x16x32_bf16 v[36:39], v[104:107], a[100:103], v[36:39]
v_exp_f32 v64, v64
v_mfma_f32_16x16x32_bf16 v[36:39], v[108:111], a[104:107], v[36:39]
v_mfma_f32_16x16x32_bf16 v[36:39], v[112:115], a[108:111], v[36:39]
v_exp_f32 v65, v65
v_mfma_f32_16x16x32_bf16 v[40:43], v[128:131], a[108:111], 0
v_mfma_f32_16x16x32_bf16 v[40:43], v[124:127], a[104:107], v[40:43]
v_exp_f32 v66, v66
v_mfma_f32_16x16x32_bf16 v[40:43], v[120:123], a[100:103], v[40:43]
v_mfma_f32_16x16x32_bf16 v[40:43], v[116:119], a[96:99], v[40:43]
v_exp_f32 v67, v67
v_mfma_f32_16x16x32_bf16 v[44:47], v[132:135], a[96:99], 0
v_cvt_pk_bf16_f32 v82, v64, v65
v_cvt_pk_bf16_f32 v83, v66, v67
v_mfma_f32_16x16x32_bf16 v[44:47], v[136:139], a[100:103], v[44:47]
v_exp_f32 v36, v36
v_mfma_f32_16x16x32_bf16 v[44:47], v[140:143], a[104:107], v[44:47]
v_mfma_f32_16x16x32_bf16 v[44:47], v[144:147], a[108:111], v[44:47]
v_exp_f32 v37, v37
v_mfma_f32_16x16x32_bf16 v[48:51], v[160:163], a[108:111], 0
v_mfma_f32_16x16x32_bf16 v[48:51], v[156:159], a[104:107], v[48:51]
v_exp_f32 v38, v38
v_mfma_f32_16x16x32_bf16 v[48:51], v[152:155], a[100:103], v[48:51]
v_mfma_f32_16x16x32_bf16 v[48:51], v[148:151], a[96:99], v[48:51]
v_mfma_f32_16x16x32_bf16 a[160:163], v[164:167], v[76:79], a[160:163]
s_waitcnt vmcnt(24) lgkmcnt(0)
s_barrier
v_mfma_f32_16x16x32_bf16 a[160:163], v[168:171], v[80:83], a[160:163]
s_add_u32 s59, s58, 16777216
v_exp_f32 v39, v39
v_mfma_f32_16x16x32_bf16 a[164:167], v[176:179], v[80:83], a[164:167]
v_cvt_pk_bf16_f32 v84, v36, v37
v_cvt_pk_bf16_f32 v85, v38, v39
v_mfma_f32_16x16x32_bf16 a[164:167], v[172:175], v[76:79], a[164:167]
s_add_u32 m0, s57, 0
v_exp_f32 v40, v40
v_mfma_f32_16x16x32_bf16 a[168:171], v[180:183], v[76:79], a[168:171]
buffer_load_dwordx4 v4, s[4:7], s59 offen offset:0 sc1 lds
v_mfma_f32_16x16x32_bf16 a[168:171], v[184:187], v[80:83], a[168:171]
s_add_u32 s58, s58, 32768
v_exp_f32 v41, v41
v_mfma_f32_16x16x32_bf16 a[172:175], v[192:195], v[80:83], a[172:175]
s_cmp_eq_u32 s60, s61
v_mfma_f32_16x16x32_bf16 a[172:175], v[188:191], v[76:79], a[172:175]
s_cselect_b32 s58, 4194304, s58
v_exp_f32 v42, v42
v_mfma_f32_16x16x32_bf16 a[176:179], v[196:199], v[76:79], a[176:179]
buffer_load_dwordx4 v4, s[4:7], s59 offen offset:1024 sc1 lds
v_mfma_f32_16x16x32_bf16 a[176:179], v[200:203], v[80:83], a[176:179]
s_cmp_gt_u32 s60, 16
v_exp_f32 v43, v43
v_mfma_f32_16x16x32_bf16 a[180:183], v[208:211], v[80:83], a[180:183]
s_cselect_b32 s58, 2146435072, s58
v_cvt_pk_bf16_f32 v86, v40, v41
v_cvt_pk_bf16_f32 v87, v42, v43
v_mfma_f32_16x16x32_bf16 a[180:183], v[204:207], v[76:79], a[180:183]
s_xor_b32 s56, s56, 65536
v_exp_f32 v44, v44
v_mfma_f32_16x16x32_bf16 a[184:187], v[212:215], v[76:79], a[184:187]
buffer_load_dwordx4 v4, s[4:7], s59 offen offset:2048 sc1 lds
v_mfma_f32_16x16x32_bf16 a[184:187], v[216:219], v[80:83], a[184:187]
s_add_u32 s60, s60, 1
v_exp_f32 v45, v45
v_mfma_f32_16x16x32_bf16 a[188:191], v[224:227], v[80:83], a[188:191]
v_mfma_f32_16x16x32_bf16 a[188:191], v[220:223], v[76:79], a[188:191]
v_exp_f32 v46, v46
v_mfma_f32_16x16x32_bf16 v[24:27], v[8:11], v[76:79], v[24:27]
buffer_load_dwordx4 v4, s[4:7], s59 offen offset:3072 sc1 lds
v_mfma_f32_16x16x32_bf16 v[24:27], v[8:11], v[80:83], v[24:27]
v_exp_f32 v47, v47
v_mfma_f32_16x16x32_bf16 v[52:55], v[100:103], a[112:115], 0
v_cvt_pk_bf16_f32 v88, v44, v45
v_cvt_pk_bf16_f32 v89, v46, v47
v_mfma_f32_16x16x32_bf16 v[52:55], v[104:107], a[116:119], v[52:55]
v_exp_f32 v48, v48
v_mfma_f32_16x16x32_bf16 v[52:55], v[108:111], a[120:123], v[52:55]
ds_read_b128 v[100:103], v2 offset:0
ds_read_b128 v[104:107], v2 offset:1024
v_mfma_f32_16x16x32_bf16 v[52:55], v[112:115], a[124:127], v[52:55]
s_add_u32 m0, s57, 4096
v_exp_f32 v49, v49
v_mfma_f32_16x16x32_bf16 v[56:59], v[128:131], a[124:127], 0
buffer_load_dwordx4 v5, s[4:7], s59 offen offset:0 sc1 lds
v_mfma_f32_16x16x32_bf16 v[56:59], v[124:127], a[120:123], v[56:59]
v_exp_f32 v50, v50
v_mfma_f32_16x16x32_bf16 v[56:59], v[120:123], a[116:119], v[56:59]
ds_read_b128 v[108:111], v2 offset:2048
ds_read_b128 v[112:115], v2 offset:3072
v_mfma_f32_16x16x32_bf16 v[56:59], v[116:119], a[112:115], v[56:59]
v_exp_f32 v51, v51
v_mfma_f32_16x16x32_bf16 v[60:63], v[132:135], a[112:115], 0
v_cvt_pk_bf16_f32 v90, v48, v49
v_cvt_pk_bf16_f32 v91, v50, v51
v_mfma_f32_16x16x32_bf16 v[60:63], v[136:139], a[116:119], v[60:63]
v_exp_f32 v52, v52
v_mfma_f32_16x16x32_bf16 v[60:63], v[140:143], a[120:123], v[60:63]
ds_read_b128 v[116:119], v2 offset:4096
ds_read_b128 v[120:123], v2 offset:5120
v_mfma_f32_16x16x32_bf16 v[60:63], v[144:147], a[124:127], v[60:63]
v_exp_f32 v53, v53
v_mfma_f32_16x16x32_bf16 v[64:67], v[160:163], a[124:127], 0
buffer_load_dwordx4 v5, s[4:7], s59 offen offset:1024 sc1 lds
v_mfma_f32_16x16x32_bf16 v[64:67], v[156:159], a[120:123], v[64:67]
v_exp_f32 v54, v54
v_mfma_f32_16x16x32_bf16 v[64:67], v[152:155], a[116:119], v[64:67]
ds_read_b128 v[124:127], v2 offset:6144
ds_read_b128 v[128:131], v2 offset:7168
v_mfma_f32_16x16x32_bf16 v[64:67], v[148:151], a[112:115], v[64:67]
v_mfma_f32_16x16x32_bf16 a[192:195], v[164:167], v[84:87], a[192:195]
ds_read_b128 v[132:135], v2 offset:8192
ds_read_b128 v[136:139], v2 offset:9216
v_mfma_f32_16x16x32_bf16 a[192:195], v[168:171], v[88:91], a[192:195]
v_exp_f32 v55, v55
v_mfma_f32_16x16x32_bf16 a[196:199], v[176:179], v[88:91], a[196:199]
v_cvt_pk_bf16_f32 v92, v52, v53
v_cvt_pk_bf16_f32 v93, v54, v55
v_mfma_f32_16x16x32_bf16 a[196:199], v[172:175], v[84:87], a[196:199]
v_exp_f32 v56, v56
v_mfma_f32_16x16x32_bf16 a[200:203], v[180:183], v[84:87], a[200:203]
ds_read_b128 v[140:143], v2 offset:10240
ds_read_b128 v[144:147], v2 offset:11264
v_mfma_f32_16x16x32_bf16 a[200:203], v[184:187], v[88:91], a[200:203]
v_exp_f32 v57, v57
v_mfma_f32_16x16x32_bf16 a[204:207], v[192:195], v[88:91], a[204:207]
buffer_load_dwordx4 v5, s[4:7], s59 offen offset:2048 sc1 lds
v_mfma_f32_16x16x32_bf16 a[204:207], v[188:191], v[84:87], a[204:207]
v_exp_f32 v58, v58
v_mfma_f32_16x16x32_bf16 a[208:211], v[196:199], v[84:87], a[208:211]
ds_read_b128 v[148:151], v2 offset:12288
ds_read_b128 v[152:155], v2 offset:13312
v_mfma_f32_16x16x32_bf16 a[208:211], v[200:203], v[88:91], a[208:211]
v_exp_f32 v59, v59
v_mfma_f32_16x16x32_bf16 a[212:215], v[208:211], v[88:91], a[212:215]
v_cvt_pk_bf16_f32 v94, v56, v57
v_cvt_pk_bf16_f32 v95, v58, v59
v_mfma_f32_16x16x32_bf16 a[212:215], v[204:207], v[84:87], a[212:215]
v_exp_f32 v60, v60
v_mfma_f32_16x16x32_bf16 a[216:219], v[212:215], v[84:87], a[216:219]
ds_read_b128 v[156:159], v2 offset:14336
ds_read_b128 v[160:163], v2 offset:15360
v_mfma_f32_16x16x32_bf16 a[216:219], v[216:219], v[88:91], a[216:219]
v_exp_f32 v61, v61
v_mfma_f32_16x16x32_bf16 a[220:223], v[224:227], v[88:91], a[220:223]
buffer_load_dwordx4 v5, s[4:7], s59 offen offset:3072 sc1 lds
v_mfma_f32_16x16x32_bf16 a[220:223], v[220:223], v[84:87], a[220:223]
s_xor_b32 s57, s57, 196608
v_exp_f32 v62, v62
v_mfma_f32_16x16x32_bf16 v[28:31], v[8:11], v[84:87], v[28:31]
v_xor_b32 v2, 65536, v2
v_mfma_f32_16x16x32_bf16 v[28:31], v[8:11], v[88:91], v[28:31]
s_waitcnt lgkmcnt(3)
v_exp_f32 v63, v63
v_mfma_f32_16x16x32_bf16 v[36:39], v[100:103], a[64:67], 0
v_cvt_pk_bf16_f32 v96, v60, v61
v_cvt_pk_bf16_f32 v97, v62, v63
v_mfma_f32_16x16x32_bf16 v[36:39], v[104:107], a[68:71], v[36:39]
v_exp_f32 v64, v64
v_mfma_f32_16x16x32_bf16 v[36:39], v[108:111], a[72:75], v[36:39]
s_lshr_b32 s3, s2, 3
v_mfma_f32_16x16x32_bf16 v[36:39], v[112:115], a[76:79], v[36:39]
s_lshl_b32 s3, s3, 7
v_exp_f32 v65, v65
v_mfma_f32_16x16x32_bf16 v[40:43], v[128:131], a[76:79], 0
s_and_b32 s51, s2, 7
v_mfma_f32_16x16x32_bf16 v[40:43], v[124:127], a[72:75], v[40:43]
s_lshl_b32 s51, s51, 2
v_exp_f32 v66, v66
v_mfma_f32_16x16x32_bf16 v[40:43], v[120:123], a[68:71], v[40:43]
s_add_u32 s3, s3, s51
v_mfma_f32_16x16x32_bf16 v[40:43], v[116:119], a[64:67], v[40:43]
s_add_u32 s3, s3, 70801408
v_exp_f32 v67, v67
v_mfma_f32_16x16x32_bf16 v[44:47], v[132:135], a[64:67], 0
s_cmp_eq_u32 s48, 0
v_cvt_pk_bf16_f32 v98, v64, v65
v_cvt_pk_bf16_f32 v99, v66, v67
v_mfma_f32_16x16x32_bf16 v[44:47], v[136:139], a[68:71], v[44:47]
s_cselect_b32 s3, s3, 2146435072
v_exp_f32 v36, v36
v_mfma_f32_16x16x32_bf16 v[44:47], v[140:143], a[72:75], v[44:47]
v_mfma_f32_16x16x32_bf16 v[44:47], v[144:147], a[76:79], v[44:47]
s_waitcnt lgkmcnt(0)
v_exp_f32 v37, v37
v_mfma_f32_16x16x32_bf16 v[48:51], v[160:163], a[76:79], 0
v_mfma_f32_16x16x32_bf16 v[48:51], v[156:159], a[72:75], v[48:51]
v_exp_f32 v38, v38
v_mfma_f32_16x16x32_bf16 v[48:51], v[152:155], a[68:71], v[48:51]
s_waitcnt vmcnt(16) lgkmcnt(0)
s_barrier
v_mfma_f32_16x16x32_bf16 v[48:51], v[148:151], a[64:67], v[48:51]
s_add_u32 m0, s56, 0
v_mfma_f32_16x16x32_bf16 a[224:227], v[164:167], v[92:95], a[224:227]
buffer_load_dwordx4 v4, s[4:7], s58 offen offset:0 sc1 lds
v_mfma_f32_16x16x32_bf16 a[224:227], v[168:171], v[96:99], a[224:227]
v_exp_f32 v39, v39
v_mfma_f32_16x16x32_bf16 a[228:231], v[176:179], v[96:99], a[228:231]
v_cvt_pk_bf16_f32 v68, v36, v37
v_cvt_pk_bf16_f32 v69, v38, v39
v_mfma_f32_16x16x32_bf16 a[228:231], v[172:175], v[92:95], a[228:231]
v_exp_f32 v40, v40
v_mfma_f32_16x16x32_bf16 a[232:235], v[180:183], v[92:95], a[232:235]
ds_read_b128 v[164:167], v3 offset:0
ds_read_b128 v[168:171], v3 offset:1024
v_mfma_f32_16x16x32_bf16 a[232:235], v[184:187], v[96:99], a[232:235]
v_exp_f32 v41, v41
v_mfma_f32_16x16x32_bf16 a[236:239], v[192:195], v[96:99], a[236:239]
buffer_load_dwordx4 v4, s[4:7], s58 offen offset:1024 sc1 lds
v_mfma_f32_16x16x32_bf16 a[236:239], v[188:191], v[92:95], a[236:239]
v_exp_f32 v42, v42
v_mfma_f32_16x16x32_bf16 a[240:243], v[196:199], v[92:95], a[240:243]
ds_read_b128 v[172:175], v3 offset:2048
ds_read_b128 v[176:179], v3 offset:3072
v_mfma_f32_16x16x32_bf16 a[240:243], v[200:203], v[96:99], a[240:243]
v_exp_f32 v43, v43
v_mfma_f32_16x16x32_bf16 a[244:247], v[208:211], v[96:99], a[244:247]
v_cvt_pk_bf16_f32 v70, v40, v41
v_cvt_pk_bf16_f32 v71, v42, v43
v_mfma_f32_16x16x32_bf16 a[244:247], v[204:207], v[92:95], a[244:247]
v_exp_f32 v44, v44
v_mfma_f32_16x16x32_bf16 a[248:251], v[212:215], v[92:95], a[248:251]
ds_read_b128 v[180:183], v3 offset:4096
ds_read_b128 v[184:187], v3 offset:5120
v_mfma_f32_16x16x32_bf16 a[248:251], v[216:219], v[96:99], a[248:251]
v_exp_f32 v45, v45
v_mfma_f32_16x16x32_bf16 a[252:255], v[224:227], v[96:99], a[252:255]
buffer_load_dwordx4 v4, s[4:7], s58 offen offset:2048 sc1 lds
v_mfma_f32_16x16x32_bf16 a[252:255], v[220:223], v[92:95], a[252:255]
v_exp_f32 v46, v46
v_mfma_f32_16x16x32_bf16 v[32:35], v[8:11], v[92:95], v[32:35]
ds_read_b128 v[188:191], v3 offset:6144
ds_read_b128 v[192:195], v3 offset:7168
v_mfma_f32_16x16x32_bf16 v[32:35], v[8:11], v[96:99], v[32:35]
v_exp_f32 v47, v47
v_mfma_f32_16x16x32_bf16 v[52:55], v[100:103], a[80:83], 0
v_cvt_pk_bf16_f32 v72, v44, v45
v_cvt_pk_bf16_f32 v73, v46, v47
v_mfma_f32_16x16x32_bf16 v[52:55], v[104:107], a[84:87], v[52:55]
v_exp_f32 v48, v48
v_mfma_f32_16x16x32_bf16 v[52:55], v[108:111], a[88:91], v[52:55]
ds_read_b128 v[196:199], v3 offset:8192
ds_read_b128 v[200:203], v3 offset:9216
v_mfma_f32_16x16x32_bf16 v[52:55], v[112:115], a[92:95], v[52:55]
v_exp_f32 v49, v49
v_mfma_f32_16x16x32_bf16 v[56:59], v[128:131], a[92:95], 0
ds_read_b128 v[204:207], v3 offset:10240
ds_read_b128 v[208:211], v3 offset:11264
v_mfma_f32_16x16x32_bf16 v[56:59], v[124:127], a[88:91], v[56:59]
v_exp_f32 v50, v50
v_mfma_f32_16x16x32_bf16 v[56:59], v[120:123], a[84:87], v[56:59]
ds_read_b128 v[212:215], v3 offset:12288
ds_read_b128 v[216:219], v3 offset:13312
v_mfma_f32_16x16x32_bf16 v[56:59], v[116:119], a[80:83], v[56:59]
v_exp_f32 v51, v51
v_mfma_f32_16x16x32_bf16 v[60:63], v[132:135], a[80:83], 0
v_cvt_pk_bf16_f32 v74, v48, v49
v_cvt_pk_bf16_f32 v75, v50, v51
v_mfma_f32_16x16x32_bf16 v[60:63], v[136:139], a[84:87], v[60:63]
v_exp_f32 v52, v52
v_mfma_f32_16x16x32_bf16 v[60:63], v[140:143], a[88:91], v[60:63]
ds_read_b128 v[220:223], v3 offset:14336
ds_read_b128 v[224:227], v3 offset:15360
v_mfma_f32_16x16x32_bf16 v[60:63], v[144:147], a[92:95], v[60:63]
v_exp_f32 v53, v53
v_mfma_f32_16x16x32_bf16 v[64:67], v[160:163], a[92:95], 0
buffer_load_dwordx4 v4, s[4:7], s58 offen offset:3072 sc1 lds
v_mfma_f32_16x16x32_bf16 v[64:67], v[156:159], a[88:91], v[64:67]
s_add_u32 m0, s56, 4096
v_exp_f32 v54, v54
v_mfma_f32_16x16x32_bf16 v[64:67], v[152:155], a[84:87], v[64:67]
v_xor_b32 v3, 196608, v3
v_mfma_f32_16x16x32_bf16 v[64:67], v[148:151], a[80:83], v[64:67]
buffer_store_dword v7, v6, s[4:7], s3 offen sc1
s_sub_u32 s62, s64, 6
L_at_b2:
s_waitcnt lgkmcnt(2)
v_mfma_f32_16x16x32_bf16 a[128:131], v[164:167], v[68:71], a[128:131]
buffer_load_dwordx4 v5, s[4:7], s58 offen offset:0 sc1 lds
v_mfma_f32_16x16x32_bf16 a[128:131], v[168:171], v[72:75], a[128:131]
v_exp_f32 v55, v55
v_mfma_f32_16x16x32_bf16 a[132:135], v[176:179], v[72:75], a[132:135]
v_cvt_pk_bf16_f32 v76, v52, v53
v_cvt_pk_bf16_f32 v77, v54, v55
v_mfma_f32_16x16x32_bf16 a[132:135], v[172:175], v[68:71], a[132:135]
v_exp_f32 v56, v56
v_mfma_f32_16x16x32_bf16 a[136:139], v[180:183], v[68:71], a[136:139]
buffer_load_dwordx4 v5, s[4:7], s58 offen offset:1024 sc1 lds
v_mfma_f32_16x16x32_bf16 a[136:139], v[184:187], v[72:75], a[136:139]
v_exp_f32 v57, v57
v_mfma_f32_16x16x32_bf16 a[140:143], v[192:195], v[72:75], a[140:143]
v_mfma_f32_16x16x32_bf16 a[140:143], v[188:191], v[68:71], a[140:143]
v_exp_f32 v58, v58
v_mfma_f32_16x16x32_bf16 a[144:147], v[196:199], v[68:71], a[144:147]
buffer_load_dwordx4 v5, s[4:7], s58 offen offset:2048 sc1 lds
v_mfma_f32_16x16x32_bf16 a[144:147], v[200:203], v[72:75], a[144:147]
v_exp_f32 v59, v59
v_mfma_f32_16x16x32_bf16 a[148:151], v[208:211], v[72:75], a[148:151]
v_cvt_pk_bf16_f32 v78, v56, v57
v_cvt_pk_bf16_f32 v79, v58, v59
v_mfma_f32_16x16x32_bf16 a[148:151], v[204:207], v[68:71], a[148:151]
v_exp_f32 v60, v60
v_mfma_f32_16x16x32_bf16 a[152:155], v[212:215], v[68:71], a[152:155]
buffer_load_dwordx4 v5, s[4:7], s58 offen offset:3072 sc1 lds
v_mfma_f32_16x16x32_bf16 a[152:155], v[216:219], v[72:75], a[152:155]
s_waitcnt lgkmcnt(0)
v_exp_f32 v61, v61
v_mfma_f32_16x16x32_bf16 a[156:159], v[224:227], v[72:75], a[156:159]
v_mfma_f32_16x16x32_bf16 a[156:159], v[220:223], v[68:71], a[156:159]
v_exp_f32 v62, v62
v_mfma_f32_16x16x32_bf16 v[20:23], v[8:11], v[68:71], v[20:23]
v_mfma_f32_16x16x32_bf16 v[20:23], v[8:11], v[72:75], v[20:23]
v_exp_f32 v63, v63
v_mfma_f32_16x16x32_bf16 v[36:39], v[100:103], a[96:99], 0
v_cvt_pk_bf16_f32 v80, v60, v61
v_cvt_pk_bf16_f32 v81, v62, v63
v_mfma_f32_16x16x32_bf16 v[36:39], v[104:107], a[100:103], v[36:39]
v_exp_f32 v64, v64
v_mfma_f32_16x16x32_bf16 v[36:39], v[108:111], a[104:107], v[36:39]
v_mfma_f32_16x16x32_bf16 v[36:39], v[112:115], a[108:111], v[36:39]
v_exp_f32 v65, v65
v_mfma_f32_16x16x32_bf16 v[40:43], v[128:131], a[108:111], 0
v_mfma_f32_16x16x32_bf16 v[40:43], v[124:127], a[104:107], v[40:43]
v_exp_f32 v66, v66
v_mfma_f32_16x16x32_bf16 v[40:43], v[120:123], a[100:103], v[40:43]
v_mfma_f32_16x16x32_bf16 v[40:43], v[116:119], a[96:99], v[40:43]
v_exp_f32 v67, v67
v_mfma_f32_16x16x32_bf16 v[44:47], v[132:135], a[96:99], 0
v_cvt_pk_bf16_f32 v82, v64, v65
v_cvt_pk_bf16_f32 v83, v66, v67
v_mfma_f32_16x16x32_bf16 v[44:47], v[136:139], a[100:103], v[44:47]
v_exp_f32 v36, v36
v_mfma_f32_16x16x32_bf16 v[44:47], v[140:143], a[104:107], v[44:47]
v_mfma_f32_16x16x32_bf16 v[44:47], v[144:147], a[108:111], v[44:47]
v_exp_f32 v37, v37
v_mfma_f32_16x16x32_bf16 v[48:51], v[160:163], a[108:111], 0
v_mfma_f32_16x16x32_bf16 v[48:51], v[156:159], a[104:107], v[48:51]
v_exp_f32 v38, v38
v_mfma_f32_16x16x32_bf16 v[48:51], v[152:155], a[100:103], v[48:51]
v_mfma_f32_16x16x32_bf16 v[48:51], v[148:151], a[96:99], v[48:51]
v_mfma_f32_16x16x32_bf16 a[160:163], v[164:167], v[76:79], a[160:163]
s_waitcnt vmcnt(16) lgkmcnt(0)
s_barrier
v_mfma_f32_16x16x32_bf16 a[160:163], v[168:171], v[80:83], a[160:163]
s_add_u32 s59, s58, 16777216
v_exp_f32 v39, v39
v_mfma_f32_16x16x32_bf16 a[164:167], v[176:179], v[80:83], a[164:167]
v_cvt_pk_bf16_f32 v84, v36, v37
v_cvt_pk_bf16_f32 v85, v38, v39
v_mfma_f32_16x16x32_bf16 a[164:167], v[172:175], v[76:79], a[164:167]
s_add_u32 m0, s57, 0
v_exp_f32 v40, v40
v_mfma_f32_16x16x32_bf16 a[168:171], v[180:183], v[76:79], a[168:171]
buffer_load_dwordx4 v4, s[4:7], s59 offen offset:0 sc1 lds
v_mfma_f32_16x16x32_bf16 a[168:171], v[184:187], v[80:83], a[168:171]
s_add_u32 s58, s58, 32768
v_exp_f32 v41, v41
v_mfma_f32_16x16x32_bf16 a[172:175], v[192:195], v[80:83], a[172:175]
s_cmp_eq_u32 s60, s61
v_mfma_f32_16x16x32_bf16 a[172:175], v[188:191], v[76:79], a[172:175]
s_cselect_b32 s58, 4194304, s58
v_exp_f32 v42, v42
v_mfma_f32_16x16x32_bf16 a[176:179], v[196:199], v[76:79], a[176:179]
buffer_load_dwordx4 v4, s[4:7], s59 offen offset:1024 sc1 lds
v_mfma_f32_16x16x32_bf16 a[176:179], v[200:203], v[80:83], a[176:179]
s_cmp_gt_u32 s60, 16
v_exp_f32 v43, v43
v_mfma_f32_16x16x32_bf16 a[180:183], v[208:211], v[80:83], a[180:183]
s_cselect_b32 s58, 2146435072, s58
v_cvt_pk_bf16_f32 v86, v40, v41
v_cvt_pk_bf16_f32 v87, v42, v43
v_mfma_f32_16x16x32_bf16 a[180:183], v[204:207], v[76:79], a[180:183]
s_xor_b32 s56, s56, 65536
v_exp_f32 v44, v44
v_mfma_f32_16x16x32_bf16 a[184:187], v[212:215], v[76:79], a[184:187]
buffer_load_dwordx4 v4, s[4:7], s59 offen offset:2048 sc1 lds
v_mfma_f32_16x16x32_bf16 a[184:187], v[216:219], v[80:83], a[184:187]
s_add_u32 s60, s60, 1
v_exp_f32 v45, v45
v_mfma_f32_16x16x32_bf16 a[188:191], v[224:227], v[80:83], a[188:191]
v_mfma_f32_16x16x32_bf16 a[188:191], v[220:223], v[76:79], a[188:191]
v_exp_f32 v46, v46
v_mfma_f32_16x16x32_bf16 v[24:27], v[8:11], v[76:79], v[24:27]
buffer_load_dwordx4 v4, s[4:7], s59 offen offset:3072 sc1 lds
v_mfma_f32_16x16x32_bf16 v[24:27], v[8:11], v[80:83], v[24:27]
v_exp_f32 v47, v47
v_mfma_f32_16x16x32_bf16 v[52:55], v[100:103], a[112:115], 0
v_cvt_pk_bf16_f32 v88, v44, v45
v_cvt_pk_bf16_f32 v89, v46, v47
v_mfma_f32_16x16x32_bf16 v[52:55], v[104:107], a[116:119], v[52:55]
v_exp_f32 v48, v48
v_mfma_f32_16x16x32_bf16 v[52:55], v[108:111], a[120:123], v[52:55]
ds_read_b128 v[100:103], v2 offset:0
ds_read_b128 v[104:107], v2 offset:1024
v_mfma_f32_16x16x32_bf16 v[52:55], v[112:115], a[124:127], v[52:55]
s_add_u32 m0, s57, 4096
v_exp_f32 v49, v49
v_mfma_f32_16x16x32_bf16 v[56:59], v[128:131], a[124:127], 0
buffer_load_dwordx4 v5, s[4:7], s59 offen offset:0 sc1 lds
v_mfma_f32_16x16x32_bf16 v[56:59], v[124:127], a[120:123], v[56:59]
v_exp_f32 v50, v50
v_mfma_f32_16x16x32_bf16 v[56:59], v[120:123], a[116:119], v[56:59]
ds_read_b128 v[108:111], v2 offset:2048
ds_read_b128 v[112:115], v2 offset:3072
v_mfma_f32_16x16x32_bf16 v[56:59], v[116:119], a[112:115], v[56:59]
v_exp_f32 v51, v51
v_mfma_f32_16x16x32_bf16 v[60:63], v[132:135], a[112:115], 0
v_cvt_pk_bf16_f32 v90, v48, v49
v_cvt_pk_bf16_f32 v91, v50, v51
v_mfma_f32_16x16x32_bf16 v[60:63], v[136:139], a[116:119], v[60:63]
v_exp_f32 v52, v52
v_mfma_f32_16x16x32_bf16 v[60:63], v[140:143], a[120:123], v[60:63]
ds_read_b128 v[116:119], v2 offset:4096
ds_read_b128 v[120:123], v2 offset:5120
v_mfma_f32_16x16x32_bf16 v[60:63], v[144:147], a[124:127], v[60:63]
v_exp_f32 v53, v53
v_mfma_f32_16x16x32_bf16 v[64:67], v[160:163], a[124:127], 0
buffer_load_dwordx4 v5, s[4:7], s59 offen offset:1024 sc1 lds
v_mfma_f32_16x16x32_bf16 v[64:67], v[156:159], a[120:123], v[64:67]
v_exp_f32 v54, v54
v_mfma_f32_16x16x32_bf16 v[64:67], v[152:155], a[116:119], v[64:67]
ds_read_b128 v[124:127], v2 offset:6144
ds_read_b128 v[128:131], v2 offset:7168
v_mfma_f32_16x16x32_bf16 v[64:67], v[148:151], a[112:115], v[64:67]
v_mfma_f32_16x16x32_bf16 a[192:195], v[164:167], v[84:87], a[192:195]
ds_read_b128 v[132:135], v2 offset:8192
ds_read_b128 v[136:139], v2 offset:9216
v_mfma_f32_16x16x32_bf16 a[192:195], v[168:171], v[88:91], a[192:195]
v_exp_f32 v55, v55
v_mfma_f32_16x16x32_bf16 a[196:199], v[176:179], v[88:91], a[196:199]
v_cvt_pk_bf16_f32 v92, v52, v53
v_cvt_pk_bf16_f32 v93, v54, v55
v_mfma_f32_16x16x32_bf16 a[196:199], v[172:175], v[84:87], a[196:199]
v_exp_f32 v56, v56
v_mfma_f32_16x16x32_bf16 a[200:203], v[180:183], v[84:87], a[200:203]
ds_read_b128 v[140:143], v2 offset:10240
ds_read_b128 v[144:147], v2 offset:11264
v_mfma_f32_16x16x32_bf16 a[200:203], v[184:187], v[88:91], a[200:203]
v_exp_f32 v57, v57
v_mfma_f32_16x16x32_bf16 a[204:207], v[192:195], v[88:91], a[204:207]
buffer_load_dwordx4 v5, s[4:7], s59 offen offset:2048 sc1 lds
v_mfma_f32_16x16x32_bf16 a[204:207], v[188:191], v[84:87], a[204:207]
v_exp_f32 v58, v58
v_mfma_f32_16x16x32_bf16 a[208:211], v[196:199], v[84:87], a[208:211]
ds_read_b128 v[148:151], v2 offset:12288
ds_read_b128 v[152:155], v2 offset:13312
v_mfma_f32_16x16x32_bf16 a[208:211], v[200:203], v[88:91], a[208:211]
v_exp_f32 v59, v59
v_mfma_f32_16x16x32_bf16 a[212:215], v[208:211], v[88:91], a[212:215]
v_cvt_pk_bf16_f32 v94, v56, v57
v_cvt_pk_bf16_f32 v95, v58, v59
v_mfma_f32_16x16x32_bf16 a[212:215], v[204:207], v[84:87], a[212:215]
v_exp_f32 v60, v60
v_mfma_f32_16x16x32_bf16 a[216:219], v[212:215], v[84:87], a[216:219]
ds_read_b128 v[156:159], v2 offset:14336
ds_read_b128 v[160:163], v2 offset:15360
v_mfma_f32_16x16x32_bf16 a[216:219], v[216:219], v[88:91], a[216:219]
v_exp_f32 v61, v61
v_mfma_f32_16x16x32_bf16 a[220:223], v[224:227], v[88:91], a[220:223]
buffer_load_dwordx4 v5, s[4:7], s59 offen offset:3072 sc1 lds
v_mfma_f32_16x16x32_bf16 a[220:223], v[220:223], v[84:87], a[220:223]
s_xor_b32 s57, s57, 196608
v_exp_f32 v62, v62
v_mfma_f32_16x16x32_bf16 v[28:31], v[8:11], v[84:87], v[28:31]
v_xor_b32 v2, 65536, v2
v_mfma_f32_16x16x32_bf16 v[28:31], v[8:11], v[88:91], v[28:31]
s_waitcnt lgkmcnt(3)
v_exp_f32 v63, v63
v_mfma_f32_16x16x32_bf16 v[36:39], v[100:103], a[64:67], 0
v_cvt_pk_bf16_f32 v96, v60, v61
v_cvt_pk_bf16_f32 v97, v62, v63
v_mfma_f32_16x16x32_bf16 v[36:39], v[104:107], a[68:71], v[36:39]
v_exp_f32 v64, v64
v_mfma_f32_16x16x32_bf16 v[36:39], v[108:111], a[72:75], v[36:39]
v_mfma_f32_16x16x32_bf16 v[36:39], v[112:115], a[76:79], v[36:39]
v_exp_f32 v65, v65
v_mfma_f32_16x16x32_bf16 v[40:43], v[128:131], a[76:79], 0
v_mfma_f32_16x16x32_bf16 v[40:43], v[124:127], a[72:75], v[40:43]
v_exp_f32 v66, v66
v_mfma_f32_16x16x32_bf16 v[40:43], v[120:123], a[68:71], v[40:43]
v_mfma_f32_16x16x32_bf16 v[40:43], v[116:119], a[64:67], v[40:43]
v_exp_f32 v67, v67
v_mfma_f32_16x16x32_bf16 v[44:47], v[132:135], a[64:67], 0
v_cvt_pk_bf16_f32 v98, v64, v65
v_cvt_pk_bf16_f32 v99, v66, v67
v_mfma_f32_16x16x32_bf16 v[44:47], v[136:139], a[68:71], v[44:47]
v_exp_f32 v36, v36
v_mfma_f32_16x16x32_bf16 v[44:47], v[140:143], a[72:75], v[44:47]
v_mfma_f32_16x16x32_bf16 v[44:47], v[144:147], a[76:79], v[44:47]
s_waitcnt lgkmcnt(0)
v_exp_f32 v37, v37
v_mfma_f32_16x16x32_bf16 v[48:51], v[160:163], a[76:79], 0
v_mfma_f32_16x16x32_bf16 v[48:51], v[156:159], a[72:75], v[48:51]
v_exp_f32 v38, v38
v_mfma_f32_16x16x32_bf16 v[48:51], v[152:155], a[68:71], v[48:51]
s_waitcnt vmcnt(16) lgkmcnt(0)
s_barrier
v_mfma_f32_16x16x32_bf16 v[48:51], v[148:151], a[64:67], v[48:51]
s_add_u32 m0, s56, 0
v_mfma_f32_16x16x32_bf16 a[224:227], v[164:167], v[92:95], a[224:227]
buffer_load_dwordx4 v4, s[4:7], s58 offen offset:0 sc1 lds
v_mfma_f32_16x16x32_bf16 a[224:227], v[168:171], v[96:99], a[224:227]
v_exp_f32 v39, v39
v_mfma_f32_16x16x32_bf16 a[228:231], v[176:179], v[96:99], a[228:231]
v_cvt_pk_bf16_f32 v68, v36, v37
v_cvt_pk_bf16_f32 v69, v38, v39
v_mfma_f32_16x16x32_bf16 a[228:231], v[172:175], v[92:95], a[228:231]
v_exp_f32 v40, v40
v_mfma_f32_16x16x32_bf16 a[232:235], v[180:183], v[92:95], a[232:235]
ds_read_b128 v[164:167], v3 offset:0
ds_read_b128 v[168:171], v3 offset:1024
v_mfma_f32_16x16x32_bf16 a[232:235], v[184:187], v[96:99], a[232:235]
v_exp_f32 v41, v41
v_mfma_f32_16x16x32_bf16 a[236:239], v[192:195], v[96:99], a[236:239]
buffer_load_dwordx4 v4, s[4:7], s58 offen offset:1024 sc1 lds
v_mfma_f32_16x16x32_bf16 a[236:239], v[188:191], v[92:95], a[236:239]
v_exp_f32 v42, v42
v_mfma_f32_16x16x32_bf16 a[240:243], v[196:199], v[92:95], a[240:243]
ds_read_b128 v[172:175], v3 offset:2048
ds_read_b128 v[176:179], v3 offset:3072
v_mfma_f32_16x16x32_bf16 a[240:243], v[200:203], v[96:99], a[240:243]
v_exp_f32 v43, v43
v_mfma_f32_16x16x32_bf16 a[244:247], v[208:211], v[96:99], a[244:247]
v_cvt_pk_bf16_f32 v70, v40, v41
v_cvt_pk_bf16_f32 v71, v42, v43
v_mfma_f32_16x16x32_bf16 a[244:247], v[204:207], v[92:95], a[244:247]
v_exp_f32 v44, v44
v_mfma_f32_16x16x32_bf16 a[248:251], v[212:215], v[92:95], a[248:251]
ds_read_b128 v[180:183], v3 offset:4096
ds_read_b128 v[184:187], v3 offset:5120
v_mfma_f32_16x16x32_bf16 a[248:251], v[216:219], v[96:99], a[248:251]
v_exp_f32 v45, v45
v_mfma_f32_16x16x32_bf16 a[252:255], v[224:227], v[96:99], a[252:255]
buffer_load_dwordx4 v4, s[4:7], s58 offen offset:2048 sc1 lds
v_mfma_f32_16x16x32_bf16 a[252:255], v[220:223], v[92:95], a[252:255]
v_exp_f32 v46, v46
v_mfma_f32_16x16x32_bf16 v[32:35], v[8:11], v[92:95], v[32:35]
ds_read_b128 v[188:191], v3 offset:6144
ds_read_b128 v[192:195], v3 offset:7168
v_mfma_f32_16x16x32_bf16 v[32:35], v[8:11], v[96:99], v[32:35]
v_exp_f32 v47, v47
v_mfma_f32_16x16x32_bf16 v[52:55], v[100:103], a[80:83], 0
v_cvt_pk_bf16_f32 v72, v44, v45
v_cvt_pk_bf16_f32 v73, v46, v47
v_mfma_f32_16x16x32_bf16 v[52:55], v[104:107], a[84:87], v[52:55]
v_exp_f32 v48, v48
v_mfma_f32_16x16x32_bf16 v[52:55], v[108:111], a[88:91], v[52:55]
ds_read_b128 v[196:199], v3 offset:8192
ds_read_b128 v[200:203], v3 offset:9216
v_mfma_f32_16x16x32_bf16 v[52:55], v[112:115], a[92:95], v[52:55]
v_exp_f32 v49, v49
v_mfma_f32_16x16x32_bf16 v[56:59], v[128:131], a[92:95], 0
ds_read_b128 v[204:207], v3 offset:10240
ds_read_b128 v[208:211], v3 offset:11264
v_mfma_f32_16x16x32_bf16 v[56:59], v[124:127], a[88:91], v[56:59]
v_exp_f32 v50, v50
v_mfma_f32_16x16x32_bf16 v[56:59], v[120:123], a[84:87], v[56:59]
ds_read_b128 v[212:215], v3 offset:12288
ds_read_b128 v[216:219], v3 offset:13312
v_mfma_f32_16x16x32_bf16 v[56:59], v[116:119], a[80:83], v[56:59]
v_exp_f32 v51, v51
v_mfma_f32_16x16x32_bf16 v[60:63], v[132:135], a[80:83], 0
v_cvt_pk_bf16_f32 v74, v48, v49
v_cvt_pk_bf16_f32 v75, v50, v51
v_mfma_f32_16x16x32_bf16 v[60:63], v[136:139], a[84:87], v[60:63]
v_exp_f32 v52, v52
v_mfma_f32_16x16x32_bf16 v[60:63], v[140:143], a[88:91], v[60:63]
ds_read_b128 v[220:223], v3 offset:14336
ds_read_b128 v[224:227], v3 offset:15360
v_mfma_f32_16x16x32_bf16 v[60:63], v[144:147], a[92:95], v[60:63]
s_sub_u32 s62, s62, 1
v_exp_f32 v53, v53
v_mfma_f32_16x16x32_bf16 v[64:67], v[160:163], a[92:95], 0
buffer_load_dwordx4 v4, s[4:7], s58 offen offset:3072 sc1 lds
v_mfma_f32_16x16x32_bf16 v[64:67], v[156:159], a[88:91], v[64:67]
s_add_u32 m0, s56, 4096
v_exp_f32 v54, v54
v_mfma_f32_16x16x32_bf16 v[64:67], v[152:155], a[84:87], v[64:67]
s_cmp_lg_u32 s62, 0
v_xor_b32 v3, 196608, v3
v_mfma_f32_16x16x32_bf16 v[64:67], v[148:151], a[80:83], v[64:67]
s_cbranch_scc1 L_at_b2
s_waitcnt lgkmcnt(2)
v_mfma_f32_16x16x32_bf16 a[128:131], v[164:167], v[68:71], a[128:131]
v_mfma_f32_16x16x32_bf16 a[128:131], v[168:171], v[72:75], a[128:131]
v_exp_f32 v55, v55
v_mfma_f32_16x16x32_bf16 a[132:135], v[176:179], v[72:75], a[132:135]
v_cvt_pk_bf16_f32 v76, v52, v53
v_cvt_pk_bf16_f32 v77, v54, v55
v_mfma_f32_16x16x32_bf16 a[132:135], v[172:175], v[68:71], a[132:135]
v_exp_f32 v56, v56
v_mfma_f32_16x16x32_bf16 a[136:139], v[180:183], v[68:71], a[136:139]
v_mfma_f32_16x16x32_bf16 a[136:139], v[184:187], v[72:75], a[136:139]
v_exp_f32 v57, v57
v_mfma_f32_16x16x32_bf16 a[140:143], v[192:195], v[72:75], a[140:143]
v_mfma_f32_16x16x32_bf16 a[140:143], v[188:191], v[68:71], a[140:143]
v_exp_f32 v58, v58
v_mfma_f32_16x16x32_bf16 a[144:147], v[196:199], v[68:71], a[144:147]
v_mfma_f32_16x16x32_bf16 a[144:147], v[200:203], v[72:75], a[144:147]
v_exp_f32 v59, v59
v_mfma_f32_16x16x32_bf16 a[148:151], v[208:211], v[72:75], a[148:151]
v_cvt_pk_bf16_f32 v78, v56, v57
v_cvt_pk_bf16_f32 v79, v58, v59
v_mfma_f32_16x16x32_bf16 a[148:151], v[204:207], v[68:71], a[148:151]
v_exp_f32 v60, v60
v_mfma_f32_16x16x32_bf16 a[152:155], v[212:215], v[68:71], a[152:155]
v_mfma_f32_16x16x32_bf16 a[152:155], v[216:219], v[72:75], a[152:155]
s_waitcnt lgkmcnt(0)
v_exp_f32 v61, v61
v_mfma_f32_16x16x32_bf16 a[156:159], v[224:227], v[72:75], a[156:159]
v_mfma_f32_16x16x32_bf16 a[156:159], v[220:223], v[68:71], a[156:159]
v_exp_f32 v62, v62
v_mfma_f32_16x16x32_bf16 v[20:23], v[8:11], v[68:71], v[20:23]
v_mfma_f32_16x16x32_bf16 v[20:23], v[8:11], v[72:75], v[20:23]
v_exp_f32 v63, v63
v_mfma_f32_16x16x32_bf16 v[36:39], v[100:103], a[96:99], 0
v_cvt_pk_bf16_f32 v80, v60, v61
v_cvt_pk_bf16_f32 v81, v62, v63
v_mfma_f32_16x16x32_bf16 v[36:39], v[104:107], a[100:103], v[36:39]
v_exp_f32 v64, v64
v_mfma_f32_16x16x32_bf16 v[36:39], v[108:111], a[104:107], v[36:39]
v_mfma_f32_16x16x32_bf16 v[36:39], v[112:115], a[108:111], v[36:39]
v_exp_f32 v65, v65
v_mfma_f32_16x16x32_bf16 v[40:43], v[128:131], a[108:111], 0
v_mfma_f32_16x16x32_bf16 v[40:43], v[124:127], a[104:107], v[40:43]
v_exp_f32 v66, v66
v_mfma_f32_16x16x32_bf16 v[40:43], v[120:123], a[100:103], v[40:43]
v_mfma_f32_16x16x32_bf16 v[40:43], v[116:119], a[96:99], v[40:43]
v_exp_f32 v67, v67
v_mfma_f32_16x16x32_bf16 v[44:47], v[132:135], a[96:99], 0
v_cvt_pk_bf16_f32 v82, v64, v65
v_cvt_pk_bf16_f32 v83, v66, v67
v_mfma_f32_16x16x32_bf16 v[44:47], v[136:139], a[100:103], v[44:47]
v_exp_f32 v36, v36
v_mfma_f32_16x16x32_bf16 v[44:47], v[140:143], a[104:107], v[44:47]
v_mfma_f32_16x16x32_bf16 v[44:47], v[144:147], a[108:111], v[44:47]
v_exp_f32 v37, v37
v_mfma_f32_16x16x32_bf16 v[48:51], v[160:163], a[108:111], 0
v_mfma_f32_16x16x32_bf16 v[48:51], v[156:159], a[104:107], v[48:51]
v_exp_f32 v38, v38
v_mfma_f32_16x16x32_bf16 v[48:51], v[152:155], a[100:103], v[48:51]
v_mfma_f32_16x16x32_bf16 v[48:51], v[148:151], a[96:99], v[48:51]
v_mfma_f32_16x16x32_bf16 a[160:163], v[164:167], v[76:79], a[160:163]
s_waitcnt vmcnt(12) lgkmcnt(0)
s_barrier
v_mfma_f32_16x16x32_bf16 a[160:163], v[168:171], v[80:83], a[160:163]
v_exp_f32 v39, v39
v_mfma_f32_16x16x32_bf16 a[164:167], v[176:179], v[80:83], a[164:167]
v_cvt_pk_bf16_f32 v84, v36, v37
v_cvt_pk_bf16_f32 v85, v38, v39
v_mfma_f32_16x16x32_bf16 a[164:167], v[172:175], v[76:79], a[164:167]
v_exp_f32 v40, v40
v_mfma_f32_16x16x32_bf16 a[168:171], v[180:183], v[76:79], a[168:171]
v_mfma_f32_16x16x32_bf16 a[168:171], v[184:187], v[80:83], a[168:171]
v_exp_f32 v41, v41
v_mfma_f32_16x16x32_bf16 a[172:175], v[192:195], v[80:83], a[172:175]
v_mfma_f32_16x16x32_bf16 a[172:175], v[188:191], v[76:79], a[172:175]
v_exp_f32 v42, v42
v_mfma_f32_16x16x32_bf16 a[176:179], v[196:199], v[76:79], a[176:179]
v_mfma_f32_16x16x32_bf16 a[176:179], v[200:203], v[80:83], a[176:179]
v_exp_f32 v43, v43
v_mfma_f32_16x16x32_bf16 a[180:183], v[208:211], v[80:83], a[180:183]
v_cvt_pk_bf16_f32 v86, v40, v41
v_cvt_pk_bf16_f32 v87, v42, v43
v_mfma_f32_16x16x32_bf16 a[180:183], v[204:207], v[76:79], a[180:183]
v_exp_f32 v44, v44
v_mfma_f32_16x16x32_bf16 a[184:187], v[212:215], v[76:79], a[184:187]
v_mfma_f32_16x16x32_bf16 a[184:187], v[216:219], v[80:83], a[184:187]
v_exp_f32 v45, v45
v_mfma_f32_16x16x32_bf16 a[188:191], v[224:227], v[80:83], a[188:191]
v_mfma_f32_16x16x32_bf16 a[188:191], v[220:223], v[76:79], a[188:191]
v_exp_f32 v46, v46
v_mfma_f32_16x16x32_bf16 v[24:27], v[8:11], v[76:79], v[24:27]
v_mfma_f32_16x16x32_bf16 v[24:27], v[8:11], v[80:83], v[24:27]
v_exp_f32 v47, v47
v_mfma_f32_16x16x32_bf16 v[52:55], v[100:103], a[112:115], 0
v_cvt_pk_bf16_f32 v88, v44, v45
v_cvt_pk_bf16_f32 v89, v46, v47
v_mfma_f32_16x16x32_bf16 v[52:55], v[104:107], a[116:119], v[52:55]
v_exp_f32 v48, v48
v_mfma_f32_16x16x32_bf16 v[52:55], v[108:111], a[120:123], v[52:55]
ds_read_b128 v[100:103], v2 offset:0
ds_read_b128 v[104:107], v2 offset:1024
v_mfma_f32_16x16x32_bf16 v[52:55], v[112:115], a[124:127], v[52:55]
v_exp_f32 v49, v49
v_mfma_f32_16x16x32_bf16 v[56:59], v[128:131], a[124:127], 0
v_mfma_f32_16x16x32_bf16 v[56:59], v[124:127], a[120:123], v[56:59]
v_exp_f32 v50, v50
v_mfma_f32_16x16x32_bf16 v[56:59], v[120:123], a[116:119], v[56:59]
ds_read_b128 v[108:111], v2 offset:2048
ds_read_b128 v[112:115], v2 offset:3072
v_mfma_f32_16x16x32_bf16 v[56:59], v[116:119], a[112:115], v[56:59]
v_exp_f32 v51, v51
v_mfma_f32_16x16x32_bf16 v[60:63], v[132:135], a[112:115], 0
v_cvt_pk_bf16_f32 v90, v48, v49
v_cvt_pk_bf16_f32 v91, v50, v51
v_mfma_f32_16x16x32_bf16 v[60:63], v[136:139], a[116:119], v[60:63]
v_exp_f32 v52, v52
v_mfma_f32_16x16x32_bf16 v[60:63], v[140:143], a[120:123], v[60:63]
ds_read_b128 v[116:119], v2 offset:4096
ds_read_b128 v[120:123], v2 offset:5120
v_mfma_f32_16x16x32_bf16 v[60:63], v[144:147], a[124:127], v[60:63]
v_exp_f32 v53, v53
v_mfma_f32_16x16x32_bf16 v[64:67], v[160:163], a[124:127], 0
v_mfma_f32_16x16x32_bf16 v[64:67], v[156:159], a[120:123], v[64:67]
v_exp_f32 v54, v54
v_mfma_f32_16x16x32_bf16 v[64:67], v[152:155], a[116:119], v[64:67]
ds_read_b128 v[124:127], v2 offset:6144
ds_read_b128 v[128:131], v2 offset:7168
v_mfma_f32_16x16x32_bf16 v[64:67], v[148:151], a[112:115], v[64:67]
v_mfma_f32_16x16x32_bf16 a[192:195], v[164:167], v[84:87], a[192:195]
ds_read_b128 v[132:135], v2 offset:8192
ds_read_b128 v[136:139], v2 offset:9216
v_mfma_f32_16x16x32_bf16 a[192:195], v[168:171], v[88:91], a[192:195]
v_exp_f32 v55, v55
v_mfma_f32_16x16x32_bf16 a[196:199], v[176:179], v[88:91], a[196:199]
v_cvt_pk_bf16_f32 v92, v52, v53
v_cvt_pk_bf16_f32 v93, v54, v55
v_mfma_f32_16x16x32_bf16 a[196:199], v[172:175], v[84:87], a[196:199]
v_exp_f32 v56, v56
v_mfma_f32_16x16x32_bf16 a[200:203], v[180:183], v[84:87], a[200:203]
ds_read_b128 v[140:143], v2 offset:10240
ds_read_b128 v[144:147], v2 offset:11264
v_mfma_f32_16x16x32_bf16 a[200:203], v[184:187], v[88:91], a[200:203]
v_exp_f32 v57, v57
v_mfma_f32_16x16x32_bf16 a[204:207], v[192:195], v[88:91], a[204:207]
v_mfma_f32_16x16x32_bf16 a[204:207], v[188:191], v[84:87], a[204:207]
v_exp_f32 v58, v58
v_mfma_f32_16x16x32_bf16 a[208:211], v[196:199], v[84:87], a[208:211]
ds_read_b128 v[148:151], v2 offset:12288
ds_read_b128 v[152:155], v2 offset:13312
v_mfma_f32_16x16x32_bf16 a[208:211], v[200:203], v[88:91], a[208:211]
v_exp_f32 v59, v59
v_mfma_f32_16x16x32_bf16 a[212:215], v[208:211], v[88:91], a[212:215]
v_cvt_pk_bf16_f32 v94, v56, v57
v_cvt_pk_bf16_f32 v95, v58, v59
v_mfma_f32_16x16x32_bf16 a[212:215], v[204:207], v[84:87], a[212:215]
v_exp_f32 v60, v60
v_mfma_f32_16x16x32_bf16 a[216:219], v[212:215], v[84:87], a[216:219]
ds_read_b128 v[156:159], v2 offset:14336
ds_read_b128 v[160:163], v2 offset:15360
v_mfma_f32_16x16x32_bf16 a[216:219], v[216:219], v[88:91], a[216:219]
v_exp_f32 v61, v61
v_mfma_f32_16x16x32_bf16 a[220:223], v[224:227], v[88:91], a[220:223]
v_mfma_f32_16x16x32_bf16 a[220:223], v[220:223], v[84:87], a[220:223]
v_exp_f32 v62, v62
v_mfma_f32_16x16x32_bf16 v[28:31], v[8:11], v[84:87], v[28:31]
v_xor_b32 v2, 65536, v2
v_mfma_f32_16x16x32_bf16 v[28:31], v[8:11], v[88:91], v[28:31]
s_waitcnt lgkmcnt(4)
v_exp_f32 v63, v63
v_mfma_f32_16x16x32_bf16 v[36:39], v[100:103], a[64:67], v[12:15]
v_cvt_pk_bf16_f32 v96, v60, v61
v_cvt_pk_bf16_f32 v97, v62, v63
v_mfma_f32_16x16x32_bf16 v[36:39], v[104:107], a[68:71], v[36:39]
v_exp_f32 v64, v64
v_mfma_f32_16x16x32_bf16 v[36:39], v[108:111], a[72:75], v[36:39]
v_mfma_f32_16x16x32_bf16 v[36:39], v[112:115], a[76:79], v[36:39]
v_exp_f32 v65, v65
v_exp_f32 v66, v66
v_exp_f32 v67, v67
v_cvt_pk_bf16_f32 v98, v64, v65
v_cvt_pk_bf16_f32 v99, v66, v67
s_nop 2
v_exp_f32 v36, v36
v_exp_f32 v37, v37
v_exp_f32 v38, v38
s_waitcnt vmcnt(4) lgkmcnt(0)
s_barrier
v_mfma_f32_16x16x32_bf16 a[224:227], v[164:167], v[92:95], a[224:227]
v_mfma_f32_16x16x32_bf16 a[224:227], v[168:171], v[96:99], a[224:227]
v_exp_f32 v39, v39
v_mfma_f32_16x16x32_bf16 a[228:231], v[176:179], v[96:99], a[228:231]
v_cvt_pk_bf16_f32 v68, v36, v37
v_cvt_pk_bf16_f32 v69, v38, v39
v_mfma_f32_16x16x32_bf16 a[228:231], v[172:175], v[92:95], a[228:231]
v_mfma_f32_16x16x32_bf16 a[232:235], v[180:183], v[92:95], a[232:235]
ds_read_b128 v[164:167], v3 offset:0
ds_read_b128 v[168:171], v3 offset:1024
v_mfma_f32_16x16x32_bf16 a[232:235], v[184:187], v[96:99], a[232:235]
v_mfma_f32_16x16x32_bf16 a[236:239], v[192:195], v[96:99], a[236:239]
v_mfma_f32_16x16x32_bf16 a[236:239], v[188:191], v[92:95], a[236:239]
v_mfma_f32_16x16x32_bf16 a[240:243], v[196:199], v[92:95], a[240:243]
ds_read_b128 v[172:175], v3 offset:2048
ds_read_b128 v[176:179], v3 offset:3072
v_mfma_f32_16x16x32_bf16 a[240:243], v[200:203], v[96:99], a[240:243]
v_mfma_f32_16x16x32_bf16 a[244:247], v[208:211], v[96:99], a[244:247]
v_mov_b32 v70, 0
v_mov_b32 v71, 0
v_mfma_f32_16x16x32_bf16 a[244:247], v[204:207], v[92:95], a[244:247]
v_mfma_f32_16x16x32_bf16 a[248:251], v[212:215], v[92:95], a[248:251]
ds_read_b128 v[180:183], v3 offset:4096
ds_read_b128 v[184:187], v3 offset:5120
v_mfma_f32_16x16x32_bf16 a[248:251], v[216:219], v[96:99], a[248:251]
v_mfma_f32_16x16x32_bf16 a[252:255], v[224:227], v[96:99], a[252:255]
v_mfma_f32_16x16x32_bf16 a[252:255], v[220:223], v[92:95], a[252:255]
v_mfma_f32_16x16x32_bf16 v[32:35], v[8:11], v[92:95], v[32:35]
ds_read_b128 v[188:191], v3 offset:6144
ds_read_b128 v[192:195], v3 offset:7168
v_mfma_f32_16x16x32_bf16 v[32:35], v[8:11], v[96:99], v[32:35]
v_mfma_f32_16x16x32_bf16 v[52:55], v[100:103], a[80:83], 0
v_mfma_f32_16x16x32_bf16 v[52:55], v[104:107], a[84:87], v[52:55]
v_mfma_f32_16x16x32_bf16 v[52:55], v[108:111], a[88:91], v[52:55]
ds_read_b128 v[196:199], v3 offset:8192
ds_read_b128 v[200:203], v3 offset:9216
v_mfma_f32_16x16x32_bf16 v[52:55], v[112:115], a[92:95], v[52:55]
v_mfma_f32_16x16x32_bf16 v[56:59], v[128:131], a[92:95], v[16:19]
ds_read_b128 v[204:207], v3 offset:10240
ds_read_b128 v[208:211], v3 offset:11264
v_mfma_f32_16x16x32_bf16 v[56:59], v[124:127], a[88:91], v[56:59]
v_mfma_f32_16x16x32_bf16 v[56:59], v[120:123], a[84:87], v[56:59]
ds_read_b128 v[212:215], v3 offset:12288
ds_read_b128 v[216:219], v3 offset:13312
v_mfma_f32_16x16x32_bf16 v[56:59], v[116:119], a[80:83], v[56:59]
v_exp_f32 v52, v52
ds_read_b128 v[220:223], v3 offset:14336
ds_read_b128 v[224:227], v3 offset:15360
v_exp_f32 v53, v53
v_exp_f32 v54, v54
v_xor_b32 v3, 196608, v3
s_waitcnt lgkmcnt(8)
v_mfma_f32_16x16x32_bf16 a[128:131], v[164:167], v[68:71], a[128:131]
v_lshrrev_b32 v6, 1, v0
v_lshlrev_b32 v6, 7, v6
v_exp_f32 v55, v55
v_mfma_f32_16x16x32_bf16 a[132:135], v[172:175], v[68:71], a[132:135]
v_cvt_pk_bf16_f32 v76, v52, v53
v_cvt_pk_bf16_f32 v77, v54, v55
v_exp_f32 v56, v56
v_mfma_f32_16x16x32_bf16 a[136:139], v[180:183], v[68:71], a[136:139]
v_and_b32 v7, 16, v1
v_add_u32 v6, v6, v7
v_exp_f32 v57, v57
v_mfma_f32_16x16x32_bf16 a[140:143], v[188:191], v[68:71], a[140:143]
s_waitcnt lgkmcnt(4)
v_add_u32 v6, 70801408, v6
v_exp_f32 v58, v58
v_mfma_f32_16x16x32_bf16 a[144:147], v[196:199], v[68:71], a[144:147]
v_exp_f32 v59, v59
v_mfma_f32_16x16x32_bf16 a[148:151], v[204:207], v[68:71], a[148:151]
s_waitcnt lgkmcnt(2)
v_cvt_pk_bf16_f32 v78, v56, v57
v_cvt_pk_bf16_f32 v79, v58, v59
v_mfma_f32_16x16x32_bf16 a[152:155], v[212:215], v[68:71], a[152:155]
s_waitcnt lgkmcnt(0)
v_mfma_f32_16x16x32_bf16 a[156:159], v[220:223], v[68:71], a[156:159]
v_mfma_f32_16x16x32_bf16 v[20:23], v[8:11], v[68:71], v[20:23]
v_mfma_f32_16x16x32_bf16 v[36:39], v[100:103], a[96:99], 0
v_mfma_f32_16x16x32_bf16 v[36:39], v[104:107], a[100:103], v[36:39]
v_mfma_f32_16x16x32_bf16 v[36:39], v[108:111], a[104:107], v[36:39]
v_mfma_f32_16x16x32_bf16 v[36:39], v[112:115], a[108:111], v[36:39]
v_mfma_f32_16x16x32_bf16 v[40:43], v[128:131], a[108:111], 0
v_mfma_f32_16x16x32_bf16 v[40:43], v[124:127], a[104:107], v[40:43]
v_mfma_f32_16x16x32_bf16 v[40:43], v[120:123], a[100:103], v[40:43]
v_mfma_f32_16x16x32_bf16 v[40:43], v[116:119], a[96:99], v[40:43]
v_mfma_f32_16x16x32_bf16 v[44:47], v[132:135], a[96:99], v[12:15]
v_mfma_f32_16x16x32_bf16 v[44:47], v[136:139], a[100:103], v[44:47]
s_nop 1
v_exp_f32 v36, v36
v_mfma_f32_16x16x32_bf16 v[44:47], v[140:143], a[104:107], v[44:47]
v_mfma_f32_16x16x32_bf16 v[44:47], v[144:147], a[108:111], v[44:47]
v_exp_f32 v37, v37
v_exp_f32 v38, v38
v_mfma_f32_16x16x32_bf16 a[160:163], v[164:167], v[76:79], a[160:163]
v_exp_f32 v39, v39
v_mfma_f32_16x16x32_bf16 a[164:167], v[172:175], v[76:79], a[164:167]
v_cvt_pk_bf16_f32 v84, v36, v37
v_cvt_pk_bf16_f32 v85, v38, v39
v_exp_f32 v40, v40
v_mfma_f32_16x16x32_bf16 a[168:171], v[180:183], v[76:79], a[168:171]
v_exp_f32 v41, v41
v_mfma_f32_16x16x32_bf16 a[172:175], v[188:191], v[76:79], a[172:175]
v_exp_f32 v42, v42
v_mfma_f32_16x16x32_bf16 a[176:179], v[196:199], v[76:79], a[176:179]
v_exp_f32 v43, v43
v_mfma_f32_16x16x32_bf16 a[180:183], v[204:207], v[76:79], a[180:183]
v_cvt_pk_bf16_f32 v86, v40, v41
v_cvt_pk_bf16_f32 v87, v42, v43
v_exp_f32 v44, v44
v_mfma_f32_16x16x32_bf16 a[184:187], v[212:215], v[76:79], a[184:187]
v_exp_f32 v45, v45
v_mfma_f32_16x16x32_bf16 a[188:191], v[220:223], v[76:79], a[188:191]
v_exp_f32 v46, v46
v_mfma_f32_16x16x32_bf16 v[24:27], v[8:11], v[76:79], v[24:27]
v_exp_f32 v47, v47
v_mfma_f32_16x16x32_bf16 v[52:55], v[100:103], a[112:115], 0
v_cvt_pk_bf16_f32 v88, v44, v45
v_cvt_pk_bf16_f32 v89, v46, v47
v_mfma_f32_16x16x32_bf16 v[52:55], v[104:107], a[116:119], v[52:55]
v_mfma_f32_16x16x32_bf16 v[52:55], v[108:111], a[120:123], v[52:55]
v_mfma_f32_16x16x32_bf16 v[52:55], v[112:115], a[124:127], v[52:55]
v_mfma_f32_16x16x32_bf16 v[56:59], v[128:131], a[124:127], 0
v_mfma_f32_16x16x32_bf16 v[56:59], v[124:127], a[120:123], v[56:59]
v_mfma_f32_16x16x32_bf16 v[56:59], v[120:123], a[116:119], v[56:59]
v_mfma_f32_16x16x32_bf16 v[56:59], v[116:119], a[112:115], v[56:59]
v_mfma_f32_16x16x32_bf16 v[60:63], v[132:135], a[112:115], 0
v_mov_b32 v90, 0
v_mov_b32 v91, 0
v_mfma_f32_16x16x32_bf16 v[60:63], v[136:139], a[116:119], v[60:63]
v_exp_f32 v52, v52
v_mfma_f32_16x16x32_bf16 v[60:63], v[140:143], a[120:123], v[60:63]
v_mfma_f32_16x16x32_bf16 v[60:63], v[144:147], a[124:127], v[60:63]
v_exp_f32 v53, v53
v_mfma_f32_16x16x32_bf16 v[64:67], v[160:163], a[124:127], v[16:19]
v_mfma_f32_16x16x32_bf16 v[64:67], v[156:159], a[120:123], v[64:67]
v_exp_f32 v54, v54
v_mfma_f32_16x16x32_bf16 v[64:67], v[152:155], a[116:119], v[64:67]
v_mfma_f32_16x16x32_bf16 v[64:67], v[148:151], a[112:115], v[64:67]
v_mfma_f32_16x16x32_bf16 a[192:195], v[164:167], v[84:87], a[192:195]
buffer_load_dwordx4 v[252:255], v6, s[4:7], 0 offen sc1
v_mfma_f32_16x16x32_bf16 a[192:195], v[168:171], v[88:91], a[192:195]
v_exp_f32 v55, v55
v_mfma_f32_16x16x32_bf16 a[196:199], v[176:179], v[88:91], a[196:199]
v_cvt_pk_bf16_f32 v92, v52, v53
v_cvt_pk_bf16_f32 v93, v54, v55
v_mfma_f32_16x16x32_bf16 a[196:199], v[172:175], v[84:87], a[196:199]
v_exp_f32 v56, v56
v_mfma_f32_16x16x32_bf16 a[200:203], v[180:183], v[84:87], a[200:203]
v_mfma_f32_16x16x32_bf16 a[200:203], v[184:187], v[88:91], a[200:203]
v_exp_f32 v57, v57
v_mfma_f32_16x16x32_bf16 a[204:207], v[192:195], v[88:91], a[204:207]
v_mfma_f32_16x16x32_bf16 a[204:207], v[188:191], v[84:87], a[204:207]
v_exp_f32 v58, v58
v_mfma_f32_16x16x32_bf16 a[208:211], v[196:199], v[84:87], a[208:211]
v_mfma_f32_16x16x32_bf16 a[208:211], v[200:203], v[88:91], a[208:211]
v_exp_f32 v59, v59
v_mfma_f32_16x16x32_bf16 a[212:215], v[208:211], v[88:91], a[212:215]
v_cvt_pk_bf16_f32 v94, v56, v57
v_cvt_pk_bf16_f32 v95, v58, v59
v_mfma_f32_16x16x32_bf16 a[212:215], v[204:207], v[84:87], a[212:215]
v_exp_f32 v60, v60
v_mfma_f32_16x16x32_bf16 a[216:219], v[212:215], v[84:87], a[216:219]
v_mfma_f32_16x16x32_bf16 a[216:219], v[216:219], v[88:91], a[216:219]
v_exp_f32 v61, v61
v_mfma_f32_16x16x32_bf16 a[220:223], v[224:227], v[88:91], a[220:223]
v_mfma_f32_16x16x32_bf16 a[220:223], v[220:223], v[84:87], a[220:223]
v_exp_f32 v62, v62
v_mfma_f32_16x16x32_bf16 v[28:31], v[8:11], v[84:87], v[28:31]
v_mfma_f32_16x16x32_bf16 v[28:31], v[8:11], v[88:91], v[28:31]
v_exp_f32 v63, v63
v_cvt_pk_bf16_f32 v96, v60, v61
v_cvt_pk_bf16_f32 v97, v62, v63
v_exp_f32 v64, v64
v_exp_f32 v65, v65
v_exp_f32 v66, v66
v_exp_f32 v67, v67
v_cvt_pk_bf16_f32 v98, v64, v65
v_cvt_pk_bf16_f32 v99, v66, v67
v_mfma_f32_16x16x32_bf16 a[224:227], v[164:167], v[92:95], a[224:227]
s_nop 0
v_mfma_f32_16x16x32_bf16 a[224:227], v[168:171], v[96:99], a[224:227]
v_mfma_f32_16x16x32_bf16 a[228:231], v[176:179], v[96:99], a[228:231]
v_mfma_f32_16x16x32_bf16 a[228:231], v[172:175], v[92:95], a[228:231]
v_mfma_f32_16x16x32_bf16 a[232:235], v[180:183], v[92:95], a[232:235]
v_mfma_f32_16x16x32_bf16 a[232:235], v[184:187], v[96:99], a[232:235]
v_mfma_f32_16x16x32_bf16 a[236:239], v[192:195], v[96:99], a[236:239]
v_mfma_f32_16x16x32_bf16 a[236:239], v[188:191], v[92:95], a[236:239]
v_mfma_f32_16x16x32_bf16 a[240:243], v[196:199], v[92:95], a[240:243]
v_mfma_f32_16x16x32_bf16 a[240:243], v[200:203], v[96:99], a[240:243]
v_mfma_f32_16x16x32_bf16 a[244:247], v[208:211], v[96:99], a[244:247]
v_mfma_f32_16x16x32_bf16 a[244:247], v[204:207], v[92:95], a[244:247]
v_mfma_f32_16x16x32_bf16 a[248:251], v[212:215], v[92:95], a[248:251]
v_mfma_f32_16x16x32_bf16 a[248:251], v[216:219], v[96:99], a[248:251]
v_mfma_f32_16x16x32_bf16 a[252:255], v[224:227], v[96:99], a[252:255]
v_mfma_f32_16x16x32_bf16 a[252:255], v[220:223], v[92:95], a[252:255]
v_mfma_f32_16x16x32_bf16 v[32:35], v[8:11], v[92:95], v[32:35]
v_mfma_f32_16x16x32_bf16 v[32:35], v[8:11], v[96:99], v[32:35]
s_cmp_eq_u32 s54, 1
s_cbranch_scc1 L_at_f21
s_lshl_b32 s51, s48, 13
v_add_u32 v228, s51, v1
s_sub_u32 s52, s51, 0
v_xor_b32 v229, 0, v3
v_add_u32 v229, s52, v229
v_xor_b32 v230, 0, v2
v_and_b32 v230, 0x38000, v230
v_lshrrev_b32 v231, 2, v1
s_lshl_b32 s52, s48, 10
s_add_u32 s52, s52, 4096
v_add3_u32 v231, v230, v231, s52
v_and_b32 v232, 63, v231
v_add3_u32 v230, v230, v232, s52
v_xor_b32 v232, 0x400, v230
ds_write_b32 v231, v20 offset:0
ds_write_b32 v231, v24 offset:256
ds_write_b32 v231, v28 offset:512
ds_write_b32 v231, v32 offset:768
ds_write_b128 v228, a[192:195] offset:0
s_waitcnt vmcnt(0)
v_and_b32 v252, v252, v253
v_and_b32 v254, v254, v255
v_and_b32 v7, v252, v254
v_cmp_ne_u32 vcc, 1, v7
s_and_b32 s63, s2, 7
s_and_b32 s51, s63, 1
s_lshr_b32 s63, s63, 1
s_lshr_b32 s56, s2, 3
s_lshr_b32 s61, s56, 3
s_lshr_b32 s100, s56, 2
ds_write_b128 v228, a[196:199] offset:1024
s_and_b32 s100, s100, 1
s_xor_b32 s100, s100, s61
s_and_b32 s100, s100, 3
s_and_b32 s101, s56, 3
s_mul_i32 s61, s61, 10
s_and_b32 s56, s56, 7
s_lshl_b32 s51, s51, 3
s_add_u32 s60, s51, s56
s_lshl_b32 s60, s60, 3
s_mul_i32 s65, s48, 5120
ds_write_b128 v228, a[200:203] offset:2048
s_and_b32 s51, s63, 1
s_lshl_b32 s51, s51, 2
s_add_u32 s51, s51, s60
s_add_u32 s87, s51, s48
s_mul_i32 s51, s87, 186368
v_add_u32 v18, s51, v1
s_lshr_b32 s51, s63, 1
s_mul_i32 s51, s51, 5
s_add_u32 s3, s51, s61
s_lshl_b32 s51, s3, 10
ds_write_b128 v228, a[204:207] offset:3072
s_mul_i32 s56, s48, 40960
s_add_u32 s51, s51, s56
v_add_u32 v16, s51, v1
v_add_u32 v17, 4096, v16
s_cbranch_vccnz L_slow_hw1
L_slow_hw1_back:
v_add_u32 v7, 28672, v1
v_add_u32 v252, 73728, v7
s_mul_i32 s51, s54, 5120
s_add_u32 s51, s51, 16384
v_add_u32 v5, s51, v1
s_mov_b32 s57, 37748736
buffer_load_dwordx4 v[36:39], v18, s[4:7], s57 offen offset:0 sc1
ds_write_b128 v228, a[208:211] offset:4096
v_add_u32 v6, 73728, v5
s_lshl_b32 s51, s55, 13
s_add_u32 s51, s51, 36864
v_add_u32 v253, s51, v1
v_add_u32 v254, 73728, v253
v_lshlrev_b32 v255, 2, v0
s_lshl_b32 s86, s48, 12
s_lshl_b32 s51, s48, 1
s_add_u32 s51, s51, s60
s_mul_i32 s51, s51, 186368
buffer_load_dwordx4 v[40:43], v18, s[4:7], s57 offen offset:1024 sc1
ds_write_b128 v228, a[212:215] offset:5120
s_lshl_b32 s52, s63, 15
s_add_u32 s51, s51, s52
v_add_u32 v12, s51, v1
v_add_u32 v13, 184320, v12
s_mul_i32 s51, s63, 1310720
s_mul_i32 s52, s55, 40960
s_add_u32 s51, s51, s52
s_mul_i32 s52, s54, 5
s_add_u32 s52, s52, s61
s_lshl_b32 s52, s52, 10
buffer_load_dwordx4 v[44:47], v18, s[4:7], s57 offen offset:2048 sc1
ds_write_b128 v228, a[216:219] offset:6144
s_add_u32 s51, s51, s52
v_add_u32 v14, s51, v1
v_add_u32 v15, 4096, v14
s_lshl_b32 s88, s60, 6
s_lshl_b32 s51, s63, 7
s_add_u32 s88, s88, s51
s_add_u32 s88, s88, 70782976
s_mov_b64 s[12:13], 0xff
s_lshr_b32 s51, s60, 1
s_mul_i32 s52, s61, 6554
buffer_load_dwordx4 v[48:51], v18, s[4:7], s57 offen offset:3072 sc1
ds_write_b128 v228, a[220:223] offset:7168
s_lshr_b32 s52, s52, 16
s_add_u32 s51, s51, s52
s_lshl_b32 s89, s51, 7
s_add_u32 s89, s89, 70791168
s_mul_i32 s51, s51, 163840
s_add_u32 s51, s51, 75497472
s_lshl_b32 s52, s54, 1
s_add_u32 s52, s52, s55
s_lshl_b32 s52, s52, 2
s_add_u32 s52, s52, s63
s_mov_b32 s57, 37752832
buffer_load_dwordx4 v[52:55], v18, s[4:7], s57 offen offset:0 sc1
ds_write_b128 v229, a[224:227] offset:0
s_mul_i32 s52, s52, 10240
s_add_u32 s60, s51, s52
s_mul_i32 s52, s63, 40960
s_add_u32 s61, s51, s52
s_mul_i32 s52, s48, 2560
s_add_u32 s61, s61, s52
v_lshlrev_b32 v19, 3, v0
s_lshl_b32 s51, s54, 1
s_add_u32 s51, s51, s55
s_cmp_eq_u32 s51, s63
buffer_load_dwordx4 v[56:59], v18, s[4:7], s57 offen offset:1024 sc1
ds_write_b128 v229, a[228:231] offset:1024
s_cselect_b32 s60, 2146435072, s60
s_lshl_b32 s51, s64, 3
s_add_u32 s51, s51, 0
s_add_u32 s52, s51, s55
s_sub_u32 s53, s51, s55
s_add_u32 s53, s53, 3
s_mul_i32 s52, s52, 186368
s_mul_i32 s53, s53, 186368
s_lshl_b32 s51, s49, 12
s_add_u32 s51, s51, 37804032
buffer_load_dwordx4 v[60:63], v18, s[4:7], s57 offen offset:2048 sc1
ds_write_b128 v229, a[232:235] offset:2048
s_add_u32 s52, s52, s51
s_add_u32 s53, s53, s51
v_accvgpr_read_b32 v28, a128
v_accvgpr_read_b32 v29, a129
v_accvgpr_read_b32 v30, a130
v_accvgpr_read_b32 v31, a131
v_accvgpr_read_b32 v32, a132
v_accvgpr_read_b32 v33, a133
v_accvgpr_read_b32 v34, a134
v_accvgpr_read_b32 v35, a135
buffer_load_dwordx4 v[64:67], v18, s[4:7], s57 offen offset:3072 sc1
ds_write_b128 v229, a[236:239] offset:3072
v_accvgpr_read_b32 v180, a136
v_accvgpr_read_b32 v181, a137
v_accvgpr_read_b32 v182, a138
v_accvgpr_read_b32 v183, a139
v_accvgpr_read_b32 v184, a140
v_accvgpr_read_b32 v185, a141
v_accvgpr_read_b32 v186, a142
v_accvgpr_read_b32 v187, a143
v_accvgpr_read_b32 v188, a144
v_accvgpr_read_b32 v189, a145
s_mov_b32 s57, 37756928
buffer_load_dwordx4 v[68:71], v18, s[4:7], s57 offen offset:0 sc1
ds_write_b128 v229, a[240:243] offset:4096
v_accvgpr_read_b32 v190, a146
v_accvgpr_read_b32 v191, a147
v_accvgpr_read_b32 v192, a148
v_accvgpr_read_b32 v193, a149
v_accvgpr_read_b32 v194, a150
v_accvgpr_read_b32 v195, a151
v_accvgpr_read_b32 v196, a152
v_accvgpr_read_b32 v197, a153
v_accvgpr_read_b32 v198, a154
v_accvgpr_read_b32 v199, a155
buffer_load_dwordx4 v[72:75], v18, s[4:7], s57 offen offset:1024 sc1
ds_write_b128 v229, a[244:247] offset:5120
v_accvgpr_read_b32 v200, a156
v_accvgpr_read_b32 v201, a157
v_accvgpr_read_b32 v202, a158
v_accvgpr_read_b32 v203, a159
v_accvgpr_read_b32 v204, a160
v_accvgpr_read_b32 v205, a161
v_accvgpr_read_b32 v206, a162
v_accvgpr_read_b32 v207, a163
v_accvgpr_read_b32 v208, a164
v_accvgpr_read_b32 v209, a165
buffer_load_dwordx4 v[76:79], v18, s[4:7], s57 offen offset:2048 sc1
ds_write_b128 v229, a[248:251] offset:6144
v_accvgpr_read_b32 v210, a166
v_accvgpr_read_b32 v211, a167
v_accvgpr_read_b32 v212, a168
v_accvgpr_read_b32 v213, a169
v_accvgpr_read_b32 v214, a170
v_accvgpr_read_b32 v215, a171
v_accvgpr_read_b32 v216, a172
v_accvgpr_read_b32 v217, a173
v_accvgpr_read_b32 v218, a174
v_accvgpr_read_b32 v219, a175
buffer_load_dwordx4 v[80:83], v18, s[4:7], s57 offen offset:3072 sc1
s_mov_b32 s57, 37761024
ds_write_b128 v229, a[252:255] offset:7168
v_accvgpr_read_b32 v220, a176
v_accvgpr_read_b32 v221, a177
v_accvgpr_read_b32 v222, a178
v_accvgpr_read_b32 v223, a179
v_accvgpr_read_b32 v224, a180
v_accvgpr_read_b32 v225, a181
v_accvgpr_read_b32 v226, a182
v_accvgpr_read_b32 v227, a183
buffer_load_dwordx4 v[84:87], v18, s[4:7], s57 offen offset:0 sc1
buffer_load_dwordx4 v[88:91], v18, s[4:7], s57 offen offset:1024 sc1
buffer_load_dwordx4 v[92:95], v18, s[4:7], s57 offen offset:2048 sc1
buffer_load_dwordx4 v[96:99], v18, s[4:7], s57 offen offset:3072 sc1
v_xor_b32 v228, 0x2000, v228
v_xor_b32 v229, 0x2000, v229
s_waitcnt lgkmcnt(0)
s_barrier
ds_read_b32 v233, v230 offset:0
ds_read_b32 v234, v232 offset:0
ds_read_b32 v235, v230 offset:256
ds_read_b32 v236, v232 offset:256
ds_read_b128 v[244:247], v228 offset:0
ds_read_b128 v[248:251], v228 offset:1024
ds_read_b128 v[20:23], v228 offset:2048
ds_read_b128 v[24:27], v228 offset:3072
s_mov_b32 s56, 62914560
s_add_u32 m0, s65, 102400
s_nop 0
buffer_load_dwordx4 v16, s[4:7], s56 offen offset:0 sc1 lds
buffer_load_dwordx4 v16, s[4:7], s56 offen offset:1024 sc1 lds
buffer_load_dwordx4 v16, s[4:7], s56 offen offset:2048 sc1 lds
buffer_load_dwordx4 v16, s[4:7], s56 offen offset:3072 sc1 lds
s_add_u32 m0, s65, 106496
s_nop 0
buffer_load_dwordx4 v17, s[4:7], s56 offen sc1 lds
s_mov_b32 s56, 63078400
s_add_u32 m0, s65, 139264
s_nop 0
buffer_load_dwordx4 v16, s[4:7], s56 offen offset:0 sc1 lds
buffer_load_dwordx4 v16, s[4:7], s56 offen offset:1024 sc1 lds
buffer_load_dwordx4 v16, s[4:7], s56 offen offset:2048 sc1 lds
buffer_load_dwordx4 v16, s[4:7], s56 offen offset:3072 sc1 lds
s_add_u32 m0, s65, 143360
s_nop 0
buffer_load_dwordx4 v17, s[4:7], s56 offen sc1 lds
s_mov_b32 s14, 0x2b800000
s_mov_b32 s15, 0x5d800000
s_waitcnt lgkmcnt(6)
v_add_f32 v233, v233, v234
v_cmp_nle_f32 s[32:33], s14, v233
v_cmp_nge_f32 s[34:35], s15, v233
v_rcp_f32 v234, v233
s_waitcnt lgkmcnt(4)
v_add_f32 v235, v235, v236
v_cmp_nle_f32 s[96:97], s14, v235
v_cmp_nge_f32 s[98:99], s15, v235
v_rcp_f32 v236, v235
s_waitcnt lgkmcnt(1)
v_pk_add_f32 v[28:29], v[28:29], v[244:245]
v_pk_add_f32 v[30:31], v[30:31], v[246:247]
v_pk_add_f32 v[32:33], v[32:33], v[248:249]
v_pk_add_f32 v[34:35], v[34:35], v[250:251]
ds_read_b128 v[244:247], v228 offset:4096
ds_read_b128 v[248:251], v228 offset:5120
v_pk_mul_f32 v[28:29], v[28:29], v[234:235] op_sel_hi:[1,0]
v_pk_mul_f32 v[30:31], v[30:31], v[234:235] op_sel_hi:[1,0]
v_pk_mul_f32 v[32:33], v[32:33], v[234:235] op_sel_hi:[1,0]
v_pk_mul_f32 v[34:35], v[34:35], v[234:235] op_sel_hi:[1,0]
v_cvt_pk_bf16_f32 v28, v28, v29
v_cvt_pk_bf16_f32 v29, v30, v31
v_cvt_pk_bf16_f32 v30, v32, v33
v_cvt_pk_bf16_f32 v31, v34, v35
buffer_store_dwordx4 v[28:31], v1, s[4:7], s52 offen offset:0 sc1
s_nop 0
v_mfma_f32_16x16x32_bf16 v[240:243], v[8:11], v[28:31], 0
v_accvgpr_read_b32 v28, a184
v_accvgpr_read_b32 v29, a185
v_accvgpr_read_b32 v30, a186
v_accvgpr_read_b32 v31, a187
v_accvgpr_read_b32 v32, a188
v_accvgpr_read_b32 v33, a189
v_accvgpr_read_b32 v34, a190
v_accvgpr_read_b32 v35, a191
v_pk_add_f32 v[180:181], v[180:181], v[20:21]
v_pk_add_f32 v[182:183], v[182:183], v[22:23]
s_waitcnt lgkmcnt(2)
v_pk_add_f32 v[184:185], v[184:185], v[24:25]
v_pk_add_f32 v[186:187], v[186:187], v[26:27]
ds_read_b128 v[20:23], v228 offset:6144
ds_read_b128 v[24:27], v228 offset:7168
v_pk_mul_f32 v[180:181], v[180:181], v[234:235] op_sel_hi:[1,0]
v_pk_mul_f32 v[182:183], v[182:183], v[234:235] op_sel_hi:[1,0]
v_pk_mul_f32 v[184:185], v[184:185], v[234:235] op_sel_hi:[1,0]
v_pk_mul_f32 v[186:187], v[186:187], v[234:235] op_sel_hi:[1,0]
v_cvt_pk_bf16_f32 v180, v180, v181
v_cvt_pk_bf16_f32 v181, v182, v183
v_cvt_pk_bf16_f32 v182, v184, v185
v_cvt_pk_bf16_f32 v183, v186, v187
buffer_store_dwordx4 v[180:183], v1, s[4:7], s52 offen offset:1024 sc1
s_nop 0
v_mfma_f32_16x16x32_bf16 v[240:243], v[8:11], v[180:183], v[240:243]
s_waitcnt lgkmcnt(3)
v_pk_add_f32 v[188:189], v[188:189], v[244:245]
v_pk_add_f32 v[190:191], v[190:191], v[246:247]
s_waitcnt lgkmcnt(2)
v_pk_add_f32 v[192:193], v[192:193], v[248:249]
v_pk_add_f32 v[194:195], v[194:195], v[250:251]
ds_read_b128 v[244:247], v229 offset:0
ds_read_b128 v[248:251], v229 offset:1024
v_pk_mul_f32 v[188:189], v[188:189], v[234:235] op_sel_hi:[1,0]
v_pk_mul_f32 v[190:191], v[190:191], v[234:235] op_sel_hi:[1,0]
v_pk_mul_f32 v[192:193], v[192:193], v[234:235] op_sel_hi:[1,0]
v_pk_mul_f32 v[194:195], v[194:195], v[234:235] op_sel_hi:[1,0]
v_cvt_pk_bf16_f32 v188, v188, v189
v_cvt_pk_bf16_f32 v189, v190, v191
v_cvt_pk_bf16_f32 v190, v192, v193
v_cvt_pk_bf16_f32 v191, v194, v195
buffer_store_dwordx4 v[188:191], v1, s[4:7], s52 offen offset:2048 sc1
s_nop 0
v_mfma_f32_16x16x32_bf16 v[240:243], v[8:11], v[188:191], v[240:243]
s_waitcnt lgkmcnt(3)
v_pk_add_f32 v[196:197], v[196:197], v[20:21]
v_pk_add_f32 v[198:199], v[198:199], v[22:23]
s_waitcnt lgkmcnt(2)
v_pk_add_f32 v[200:201], v[200:201], v[24:25]
v_pk_add_f32 v[202:203], v[202:203], v[26:27]
ds_read_b128 v[20:23], v229 offset:2048
ds_read_b128 v[24:27], v229 offset:3072
v_pk_mul_f32 v[196:197], v[196:197], v[234:235] op_sel_hi:[1,0]
v_pk_mul_f32 v[198:199], v[198:199], v[234:235] op_sel_hi:[1,0]
v_pk_mul_f32 v[200:201], v[200:201], v[234:235] op_sel_hi:[1,0]
v_pk_mul_f32 v[202:203], v[202:203], v[234:235] op_sel_hi:[1,0]
v_cvt_pk_bf16_f32 v196, v196, v197
v_cvt_pk_bf16_f32 v197, v198, v199
v_cvt_pk_bf16_f32 v198, v200, v201
v_cvt_pk_bf16_f32 v199, v202, v203
buffer_store_dwordx4 v[196:199], v1, s[4:7], s52 offen offset:3072 sc1
s_nop 0
v_mfma_f32_16x16x32_bf16 v[240:243], v[8:11], v[196:199], v[240:243]
s_waitcnt lgkmcnt(3)
v_pk_add_f32 v[204:205], v[204:205], v[244:245]
v_pk_add_f32 v[206:207], v[206:207], v[246:247]
s_waitcnt lgkmcnt(2)
v_pk_add_f32 v[208:209], v[208:209], v[248:249]
v_pk_add_f32 v[210:211], v[210:211], v[250:251]
ds_read_b128 v[244:247], v229 offset:4096
ds_read_b128 v[248:251], v229 offset:5120
v_pk_mul_f32 v[204:205], v[204:205], v[236:237] op_sel_hi:[1,0]
v_pk_mul_f32 v[206:207], v[206:207], v[236:237] op_sel_hi:[1,0]
v_pk_mul_f32 v[208:209], v[208:209], v[236:237] op_sel_hi:[1,0]
v_pk_mul_f32 v[210:211], v[210:211], v[236:237] op_sel_hi:[1,0]
v_cvt_pk_bf16_f32 v204, v204, v205
v_cvt_pk_bf16_f32 v205, v206, v207
v_cvt_pk_bf16_f32 v206, v208, v209
v_cvt_pk_bf16_f32 v207, v210, v211
buffer_store_dwordx4 v[204:207], v1, s[4:7], s53 offen offset:0 sc1
s_nop 0
v_mfma_f32_16x16x32_bf16 v[240:243], v[8:11], v[204:207], v[240:243]
s_waitcnt lgkmcnt(3)
v_pk_add_f32 v[212:213], v[212:213], v[20:21]
v_pk_add_f32 v[214:215], v[214:215], v[22:23]
s_waitcnt lgkmcnt(2)
v_pk_add_f32 v[216:217], v[216:217], v[24:25]
v_pk_add_f32 v[218:219], v[218:219], v[26:27]
ds_read_b128 v[20:23], v229 offset:6144
ds_read_b128 v[24:27], v229 offset:7168
v_pk_mul_f32 v[212:213], v[212:213], v[236:237] op_sel_hi:[1,0]
v_pk_mul_f32 v[214:215], v[214:215], v[236:237] op_sel_hi:[1,0]
v_pk_mul_f32 v[216:217], v[216:217], v[236:237] op_sel_hi:[1,0]
v_pk_mul_f32 v[218:219], v[218:219], v[236:237] op_sel_hi:[1,0]
v_cvt_pk_bf16_f32 v212, v212, v213
v_cvt_pk_bf16_f32 v213, v214, v215
v_cvt_pk_bf16_f32 v214, v216, v217
v_cvt_pk_bf16_f32 v215, v218, v219
buffer_store_dwordx4 v[212:215], v1, s[4:7], s53 offen offset:1024 sc1
s_nop 0
v_mfma_f32_16x16x32_bf16 v[240:243], v[8:11], v[212:215], v[240:243]
s_waitcnt lgkmcnt(3)
v_pk_add_f32 v[220:221], v[220:221], v[244:245]
v_pk_add_f32 v[222:223], v[222:223], v[246:247]
s_waitcnt lgkmcnt(2)
v_pk_add_f32 v[224:225], v[224:225], v[248:249]
v_pk_add_f32 v[226:227], v[226:227], v[250:251]
v_pk_mul_f32 v[220:221], v[220:221], v[236:237] op_sel_hi:[1,0]
v_pk_mul_f32 v[222:223], v[222:223], v[236:237] op_sel_hi:[1,0]
v_pk_mul_f32 v[224:225], v[224:225], v[236:237] op_sel_hi:[1,0]
v_pk_mul_f32 v[226:227], v[226:227], v[236:237] op_sel_hi:[1,0]
v_cvt_pk_bf16_f32 v220, v220, v221
v_cvt_pk_bf16_f32 v221, v222, v223
v_cvt_pk_bf16_f32 v222, v224, v225
v_cvt_pk_bf16_f32 v223, v226, v227
buffer_store_dwordx4 v[220:223], v1, s[4:7], s53 offen offset:2048 sc1
s_nop 0
v_mfma_f32_16x16x32_bf16 v[240:243], v[8:11], v[220:223], v[240:243]
s_waitcnt lgkmcnt(1)
v_pk_add_f32 v[28:29], v[28:29], v[20:21]
v_pk_add_f32 v[30:31], v[30:31], v[22:23]
s_waitcnt lgkmcnt(0)
v_pk_add_f32 v[32:33], v[32:33], v[24:25]
v_pk_add_f32 v[34:35], v[34:35], v[26:27]
v_pk_mul_f32 v[28:29], v[28:29], v[236:237] op_sel_hi:[1,0]
v_pk_mul_f32 v[30:31], v[30:31], v[236:237] op_sel_hi:[1,0]
v_pk_mul_f32 v[32:33], v[32:33], v[236:237] op_sel_hi:[1,0]
v_pk_mul_f32 v[34:35], v[34:35], v[236:237] op_sel_hi:[1,0]
v_cvt_pk_bf16_f32 v28, v28, v29
v_cvt_pk_bf16_f32 v29, v30, v31
v_cvt_pk_bf16_f32 v30, v32, v33
v_cvt_pk_bf16_f32 v31, v34, v35
buffer_store_dwordx4 v[28:31], v1, s[4:7], s53 offen offset:3072 sc1
s_nop 0
v_mfma_f32_16x16x32_bf16 v[240:243], v[8:11], v[28:31], v[240:243]
s_or_b64 s[66:67], s[66:67], s[32:33]
s_or_b64 s[66:67], s[66:67], s[34:35]
s_or_b64 s[66:67], s[66:67], s[96:97]
s_or_b64 s[66:67], s[66:67], s[98:99]
s_nop 3
v_cmp_u_f32 vcc, v241, v241
s_nop 3
s_or_b64 s[66:67], s[66:67], vcc
s_branch L_at_done
L_at_prod:
s_mov_b32 s88, s58
s_waitcnt vmcnt(63) lgkmcnt(0)
s_barrier
s_add_u32 s59, s58, 16777216
s_add_u32 s58, s58, 32768
s_cmp_eq_u32 s60, s61
s_cselect_b32 s58, 4194304, s58
s_cmp_gt_u32 s60, 16
s_cselect_b32 s58, 2146435072, s58
s_add_u32 s60, s60, 1
s_add_u32 m0, s56, -65536
v_mfma_f32_16x16x32_bf16 v[36:39], v[100:103], a[0:3], v[12:15]
buffer_load_dwordx4 v4, s[4:7], s88 offen offset:0 sc1 lds
v_mfma_f32_16x16x32_bf16 v[36:39], v[104:107], a[4:7], v[36:39]
v_mfma_f32_16x16x32_bf16 v[36:39], v[108:111], a[8:11], v[36:39]
buffer_load_dwordx4 v4, s[4:7], s88 offen offset:1024 sc1 lds
v_mfma_f32_16x16x32_bf16 v[36:39], v[112:115], a[12:15], v[36:39]
buffer_load_dwordx4 v4, s[4:7], s88 offen offset:2048 sc1 lds
buffer_load_dwordx4 v4, s[4:7], s88 offen offset:3072 sc1 lds
s_add_u32 m0, s56, -61440
s_nop 0
buffer_load_dwordx4 v5, s[4:7], s88 offen offset:0 sc1 lds
s_nop 2
v_exp_f32 v36, v36
buffer_load_dwordx4 v5, s[4:7], s88 offen offset:1024 sc1 lds
v_exp_f32 v37, v37
buffer_load_dwordx4 v5, s[4:7], s88 offen offset:2048 sc1 lds
buffer_load_dwordx4 v5, s[4:7], s88 offen offset:3072 sc1 lds
v_exp_f32 v38, v38
s_waitcnt vmcnt(8) lgkmcnt(0)
s_barrier
s_add_u32 m0, s56, 0
s_nop 0
buffer_load_dwordx4 v4, s[4:7], s58 offen offset:0 sc1 lds
v_exp_f32 v39, v39
v_cvt_pk_bf16_f32 v68, v36, v37
v_cvt_pk_bf16_f32 v69, v38, v39
ds_read_b128 v[164:167], v3 offset:0
ds_read_b128 v[168:171], v3 offset:1024
buffer_load_dwordx4 v4, s[4:7], s58 offen offset:1024 sc1 lds
ds_read_b128 v[172:175], v3 offset:2048
ds_read_b128 v[176:179], v3 offset:3072
v_mov_b32 v70, 0
v_mov_b32 v71, 0
ds_read_b128 v[180:183], v3 offset:4096
ds_read_b128 v[184:187], v3 offset:5120
buffer_load_dwordx4 v4, s[4:7], s58 offen offset:2048 sc1 lds
ds_read_b128 v[188:191], v3 offset:6144
ds_read_b128 v[192:195], v3 offset:7168
v_mfma_f32_16x16x32_bf16 v[52:55], v[100:103], a[16:19], 0
v_mfma_f32_16x16x32_bf16 v[52:55], v[104:107], a[20:23], v[52:55]
v_mfma_f32_16x16x32_bf16 v[52:55], v[108:111], a[24:27], v[52:55]
ds_read_b128 v[196:199], v3 offset:8192
ds_read_b128 v[200:203], v3 offset:9216
v_mfma_f32_16x16x32_bf16 v[52:55], v[112:115], a[28:31], v[52:55]
v_mfma_f32_16x16x32_bf16 v[56:59], v[128:131], a[28:31], v[16:19]
ds_read_b128 v[204:207], v3 offset:10240
ds_read_b128 v[208:211], v3 offset:11264
v_mfma_f32_16x16x32_bf16 v[56:59], v[124:127], a[24:27], v[56:59]
v_mfma_f32_16x16x32_bf16 v[56:59], v[120:123], a[20:23], v[56:59]
ds_read_b128 v[212:215], v3 offset:12288
ds_read_b128 v[216:219], v3 offset:13312
v_mfma_f32_16x16x32_bf16 v[56:59], v[116:119], a[16:19], v[56:59]
v_exp_f32 v52, v52
ds_read_b128 v[220:223], v3 offset:14336
ds_read_b128 v[224:227], v3 offset:15360
v_exp_f32 v53, v53
buffer_load_dwordx4 v4, s[4:7], s58 offen offset:3072 sc1 lds
s_add_u32 m0, s56, 4096
v_exp_f32 v54, v54
v_xor_b32 v3, 196608, v3
s_waitcnt lgkmcnt(8)
v_mfma_f32_16x16x32_bf16 a[128:131], v[164:167], v[68:71], 0
buffer_load_dwordx4 v5, s[4:7], s58 offen offset:0 sc1 lds
s_and_b32 s26, s2, 31
v_exp_f32 v55, v55
v_mfma_f32_16x16x32_bf16 a[132:135], v[172:175], v[68:71], 0
s_lshl_b32 s27, 1, s26
v_cvt_pk_bf16_f32 v76, v52, v53
v_cvt_pk_bf16_f32 v77, v54, v55
s_sub_u32 s27, s27, 1
v_exp_f32 v56, v56
v_mfma_f32_16x16x32_bf16 a[136:139], v[180:183], v[68:71], 0
s_and_b32 s27, s27, 21504
buffer_load_dwordx4 v5, s[4:7], s58 offen offset:1024 sc1 lds
s_bcnt1_i32_b32 s27, s27
v_exp_f32 v57, v57
v_mfma_f32_16x16x32_bf16 a[140:143], v[188:191], v[68:71], 0
s_waitcnt lgkmcnt(1)
s_mul_i32 s89, s50, 29
s_add_u32 s89, s89, s26
v_exp_f32 v58, v58
v_mfma_f32_16x16x32_bf16 a[144:147], v[196:199], v[68:71], 0
s_sub_u32 s89, s89, s27
buffer_load_dwordx4 v5, s[4:7], s58 offen offset:2048 sc1 lds
s_bitcmp1_b32 21504, s26
v_exp_f32 v59, v59
v_mfma_f32_16x16x32_bf16 a[148:151], v[204:207], v[68:71], 0
s_cselect_b32 s89, 0x400, s89
v_cvt_pk_bf16_f32 v78, v56, v57
v_cvt_pk_bf16_f32 v79, v58, v59
v_mfma_f32_16x16x32_bf16 a[152:155], v[212:215], v[68:71], 0
buffer_load_dwordx4 v5, s[4:7], s58 offen offset:3072 sc1 lds
s_add_u32 m0, s57, 0
v_mfma_f32_16x16x32_bf16 a[156:159], v[220:223], v[68:71], 0
s_cmp_lt_u32 s89, 38
buffer_load_dwordx4 v4, s[4:7], s59 offen offset:0 sc1 lds
s_cselect_b32 s20, s36, s28
v_mfma_f32_16x16x32_bf16 v[20:23], v[8:11], v[68:71], 0
s_cselect_b32 s21, s37, s29
buffer_load_dwordx4 v4, s[4:7], s59 offen offset:1024 sc1 lds
s_cselect_b32 s22, s38, s30
v_mfma_f32_16x16x32_bf16 v[36:39], v[100:103], a[32:35], 0
s_cselect_b32 s24, 0, 2211840
v_mfma_f32_16x16x32_bf16 v[36:39], v[104:107], a[36:39], v[36:39]
s_lshl_b32 s88, s48, 11
v_mfma_f32_16x16x32_bf16 v[36:39], v[108:111], a[40:43], v[36:39]
s_lshl_b32 s25, s48, 10
buffer_load_dwordx4 v4, s[4:7], s59 offen offset:2048 sc1 lds
v_mfma_f32_16x16x32_bf16 v[36:39], v[112:115], a[44:47], v[36:39]
s_add_u32 s25, s25, 62914560
v_mfma_f32_16x16x32_bf16 v[40:43], v[128:131], a[44:47], 0
s_add_u32 s26, s89, 0
buffer_load_dwordx4 v4, s[4:7], s59 offen offset:3072 sc1 lds
v_mfma_f32_16x16x32_bf16 v[40:43], v[124:127], a[40:43], v[40:43]
s_add_u32 m0, s57, 4096
v_mfma_f32_16x16x32_bf16 v[40:43], v[120:123], a[36:39], v[40:43]
s_mul_i32 s27, s26, 52429
buffer_load_dwordx4 v5, s[4:7], s59 offen offset:0 sc1 lds
v_mfma_f32_16x16x32_bf16 v[40:43], v[116:119], a[32:35], v[40:43]
s_lshr_b32 s27, s27, 18
v_mfma_f32_16x16x32_bf16 v[44:47], v[132:135], a[32:35], v[12:15]
s_mul_i32 s12, s27, 5
v_mfma_f32_16x16x32_bf16 v[44:47], v[136:139], a[36:39], v[44:47]
s_sub_u32 s26, s26, s12
v_exp_f32 v36, v36
v_mfma_f32_16x16x32_bf16 v[44:47], v[140:143], a[40:43], v[44:47]
s_mul_i32 s27, s27, 40960
buffer_load_dwordx4 v5, s[4:7], s59 offen offset:1024 sc1 lds
v_mfma_f32_16x16x32_bf16 v[44:47], v[144:147], a[44:47], v[44:47]
s_lshl_b32 s12, s26, 8
v_exp_f32 v37, v37
s_add_u32 s12, s12, s27
buffer_load_dwordx4 v5, s[4:7], s59 offen offset:2048 sc1 lds
s_sub_u32 s12, s12, 0
v_exp_f32 v38, v38
s_lshl_b32 s26, s26, 13
buffer_load_dwordx4 v5, s[4:7], s59 offen offset:3072 sc1 lds
s_xor_b32 s57, s57, 196608
v_mfma_f32_16x16x32_bf16 a[160:163], v[164:167], v[76:79], 0
s_waitcnt vmcnt(16) lgkmcnt(0)
s_barrier
s_add_u32 s59, s58, 16777216
v_exp_f32 v39, v39
v_mfma_f32_16x16x32_bf16 a[164:167], v[172:175], v[76:79], 0
v_cvt_pk_bf16_f32 v84, v36, v37
v_cvt_pk_bf16_f32 v85, v38, v39
s_add_u32 m0, s57, 0
v_exp_f32 v40, v40
v_mfma_f32_16x16x32_bf16 a[168:171], v[180:183], v[76:79], 0
buffer_load_dwordx4 v4, s[4:7], s59 offen offset:0 sc1 lds
s_add_u32 s58, s58, 32768
v_exp_f32 v41, v41
v_mfma_f32_16x16x32_bf16 a[172:175], v[188:191], v[76:79], 0
s_cmp_eq_u32 s60, s61
s_cselect_b32 s58, 4194304, s58
v_exp_f32 v42, v42
v_mfma_f32_16x16x32_bf16 a[176:179], v[196:199], v[76:79], 0
buffer_load_dwordx4 v4, s[4:7], s59 offen offset:1024 sc1 lds
s_cmp_gt_u32 s60, 16
v_exp_f32 v43, v43
v_mfma_f32_16x16x32_bf16 a[180:183], v[204:207], v[76:79], 0
s_cselect_b32 s58, 2146435072, s58
v_cvt_pk_bf16_f32 v86, v40, v41
v_cvt_pk_bf16_f32 v87, v42, v43
s_xor_b32 s56, s56, 65536
v_exp_f32 v44, v44
v_mfma_f32_16x16x32_bf16 a[184:187], v[212:215], v[76:79], 0
buffer_load_dwordx4 v4, s[4:7], s59 offen offset:2048 sc1 lds
s_add_u32 s60, s60, 1
v_exp_f32 v45, v45
v_mfma_f32_16x16x32_bf16 a[188:191], v[220:223], v[76:79], 0
s_add_u32 s26, s26, s27
s_add_u32 s16, s26, s25
v_exp_f32 v46, v46
v_mfma_f32_16x16x32_bf16 v[24:27], v[8:11], v[76:79], 0
s_add_u32 s26, s89, 232
buffer_load_dwordx4 v4, s[4:7], s59 offen offset:3072 sc1 lds
s_mul_i32 s27, s26, 52429
v_exp_f32 v47, v47
v_mfma_f32_16x16x32_bf16 v[52:55], v[100:103], a[48:51], 0
s_lshr_b32 s27, s27, 18
v_cvt_pk_bf16_f32 v88, v44, v45
v_cvt_pk_bf16_f32 v89, v46, v47
v_mfma_f32_16x16x32_bf16 v[52:55], v[104:107], a[52:55], v[52:55]
s_mul_i32 s13, s27, 5
v_mfma_f32_16x16x32_bf16 v[52:55], v[108:111], a[56:59], v[52:55]
s_sub_u32 s26, s26, s13
ds_read_b128 v[100:103], v2 offset:0
ds_read_b128 v[104:107], v2 offset:1024
v_mfma_f32_16x16x32_bf16 v[52:55], v[112:115], a[60:63], v[52:55]
s_add_u32 m0, s57, 4096
v_mfma_f32_16x16x32_bf16 v[56:59], v[128:131], a[60:63], 0
s_mul_i32 s27, s27, 40960
buffer_load_dwordx4 v5, s[4:7], s59 offen offset:0 sc1 lds
v_mfma_f32_16x16x32_bf16 v[56:59], v[124:127], a[56:59], v[56:59]
s_lshl_b32 s13, s26, 8
v_mfma_f32_16x16x32_bf16 v[56:59], v[120:123], a[52:55], v[56:59]
s_add_u32 s13, s13, s27
ds_read_b128 v[108:111], v2 offset:2048
ds_read_b128 v[112:115], v2 offset:3072
v_mfma_f32_16x16x32_bf16 v[56:59], v[116:119], a[48:51], v[56:59]
s_sub_u32 s13, s13, s24
v_mfma_f32_16x16x32_bf16 v[60:63], v[132:135], a[48:51], 0
s_lshl_b32 s26, s26, 13
v_mov_b32 v90, 0
v_mov_b32 v91, 0
v_mfma_f32_16x16x32_bf16 v[60:63], v[136:139], a[52:55], v[60:63]
s_add_u32 s26, s26, s27
v_exp_f32 v52, v52
v_mfma_f32_16x16x32_bf16 v[60:63], v[140:143], a[56:59], v[60:63]
s_add_u32 s17, s26, s25
ds_read_b128 v[116:119], v2 offset:4096
ds_read_b128 v[120:123], v2 offset:5120
v_mfma_f32_16x16x32_bf16 v[60:63], v[144:147], a[60:63], v[60:63]
s_add_u32 s26, s89, 464
v_exp_f32 v53, v53
v_mfma_f32_16x16x32_bf16 v[64:67], v[160:163], a[60:63], v[16:19]
s_mul_i32 s27, s26, 52429
buffer_load_dwordx4 v5, s[4:7], s59 offen offset:1024 sc1 lds
v_mfma_f32_16x16x32_bf16 v[64:67], v[156:159], a[56:59], v[64:67]
s_lshr_b32 s27, s27, 18
v_exp_f32 v54, v54
v_mfma_f32_16x16x32_bf16 v[64:67], v[152:155], a[52:55], v[64:67]
s_mul_i32 s14, s27, 5
ds_read_b128 v[124:127], v2 offset:6144
ds_read_b128 v[128:131], v2 offset:7168
v_mfma_f32_16x16x32_bf16 v[64:67], v[148:151], a[48:51], v[64:67]
s_sub_u32 s26, s26, s14
v_mfma_f32_16x16x32_bf16 a[192:195], v[164:167], v[84:87], 0
s_mul_i32 s27, s27, 40960
ds_read_b128 v[132:135], v2 offset:8192
ds_read_b128 v[136:139], v2 offset:9216
v_mfma_f32_16x16x32_bf16 a[192:195], v[168:171], v[88:91], a[192:195]
s_lshl_b32 s14, s26, 8
v_exp_f32 v55, v55
v_mfma_f32_16x16x32_bf16 a[196:199], v[176:179], v[88:91], 0
s_add_u32 s14, s14, s27
v_cvt_pk_bf16_f32 v92, v52, v53
v_cvt_pk_bf16_f32 v93, v54, v55
v_mfma_f32_16x16x32_bf16 a[196:199], v[172:175], v[84:87], a[196:199]
s_sub_u32 s14, s14, 2211840
v_exp_f32 v56, v56
v_mfma_f32_16x16x32_bf16 a[200:203], v[180:183], v[84:87], 0
s_lshl_b32 s26, s26, 13
ds_read_b128 v[140:143], v2 offset:10240
ds_read_b128 v[144:147], v2 offset:11264
v_mfma_f32_16x16x32_bf16 a[200:203], v[184:187], v[88:91], a[200:203]
s_add_u32 s26, s26, s27
v_exp_f32 v57, v57
v_mfma_f32_16x16x32_bf16 a[204:207], v[192:195], v[88:91], 0
s_add_u32 s18, s26, s25
buffer_load_dwordx4 v5, s[4:7], s59 offen offset:2048 sc1 lds
v_mfma_f32_16x16x32_bf16 a[204:207], v[188:191], v[84:87], a[204:207]
s_add_u32 s26, s89, 696
v_exp_f32 v58, v58
v_mfma_f32_16x16x32_bf16 a[208:211], v[196:199], v[84:87], 0
s_mul_i32 s27, s26, 52429
ds_read_b128 v[148:151], v2 offset:12288
ds_read_b128 v[152:155], v2 offset:13312
v_mfma_f32_16x16x32_bf16 a[208:211], v[200:203], v[88:91], a[208:211]
s_lshr_b32 s27, s27, 18
v_exp_f32 v59, v59
v_mfma_f32_16x16x32_bf16 a[212:215], v[208:211], v[88:91], 0
s_mul_i32 s15, s27, 5
v_cvt_pk_bf16_f32 v94, v56, v57
v_cvt_pk_bf16_f32 v95, v58, v59
v_mfma_f32_16x16x32_bf16 a[212:215], v[204:207], v[84:87], a[212:215]
s_sub_u32 s26, s26, s15
v_exp_f32 v60, v60
v_mfma_f32_16x16x32_bf16 a[216:219], v[212:215], v[84:87], 0
s_mul_i32 s27, s27, 40960
ds_read_b128 v[156:159], v2 offset:14336
ds_read_b128 v[160:163], v2 offset:15360
v_mfma_f32_16x16x32_bf16 a[216:219], v[216:219], v[88:91], a[216:219]
s_lshl_b32 s15, s26, 8
v_exp_f32 v61, v61
v_mfma_f32_16x16x32_bf16 a[220:223], v[224:227], v[88:91], 0
s_add_u32 s15, s15, s27
buffer_load_dwordx4 v5, s[4:7], s59 offen offset:3072 sc1 lds
v_mfma_f32_16x16x32_bf16 a[220:223], v[220:223], v[84:87], a[220:223]
s_xor_b32 s57, s57, 196608
v_exp_f32 v62, v62
v_mfma_f32_16x16x32_bf16 v[28:31], v[8:11], v[84:87], 0
s_sub_u32 s15, s15, 2211840
v_xor_b32 v2, 65536, v2
v_mfma_f32_16x16x32_bf16 v[28:31], v[8:11], v[88:91], v[28:31]
s_waitcnt lgkmcnt(2)
s_lshl_b32 s26, s26, 13
v_exp_f32 v63, v63
v_mfma_f32_16x16x32_bf16 v[36:39], v[100:103], a[64:67], 0
s_add_u32 s26, s26, s27
v_cvt_pk_bf16_f32 v96, v60, v61
v_cvt_pk_bf16_f32 v97, v62, v63
v_mfma_f32_16x16x32_bf16 v[36:39], v[104:107], a[68:71], v[36:39]
s_add_u32 s19, s26, s25
v_exp_f32 v64, v64
v_mfma_f32_16x16x32_bf16 v[36:39], v[108:111], a[72:75], v[36:39]
s_cmp_lt_u32 s89, 232
v_lshrrev_b32 v6, 1, v0
v_mul_u32_u24 v6, 1280, v6
v_mfma_f32_16x16x32_bf16 v[36:39], v[112:115], a[76:79], v[36:39]
s_cselect_b32 s16, s16, 2146435072
v_exp_f32 v65, v65
v_mfma_f32_16x16x32_bf16 v[40:43], v[128:131], a[76:79], 0
s_cselect_b32 s17, s17, 2146435072
v_and_b32 v7, 1, v0
v_lshl_add_u32 v6, v7, 7, v6
v_mfma_f32_16x16x32_bf16 v[40:43], v[124:127], a[72:75], v[40:43]
s_cselect_b32 s18, s18, 2146435072
v_exp_f32 v66, v66
v_mfma_f32_16x16x32_bf16 v[40:43], v[120:123], a[68:71], v[40:43]
s_cmp_lt_u32 s89, 214
v_mfma_f32_16x16x32_bf16 v[40:43], v[116:119], a[64:67], v[40:43]
s_cselect_b32 s19, s19, 2146435072
v_exp_f32 v67, v67
v_mfma_f32_16x16x32_bf16 v[44:47], v[132:135], a[64:67], 0
s_cmp_eq_u32 s48, 0
v_cvt_pk_bf16_f32 v98, v64, v65
v_cvt_pk_bf16_f32 v99, v66, v67
v_mfma_f32_16x16x32_bf16 v[44:47], v[136:139], a[68:71], v[44:47]
s_cselect_b32 s24, s36, s20
v_exp_f32 v36, v36
v_mfma_f32_16x16x32_bf16 v[44:47], v[140:143], a[72:75], v[44:47]
s_cselect_b32 s25, s37, s21
v_mfma_f32_16x16x32_bf16 v[44:47], v[144:147], a[76:79], v[44:47]
s_waitcnt lgkmcnt(0)
s_cselect_b32 s26, s38, s22
v_exp_f32 v37, v37
v_mfma_f32_16x16x32_bf16 v[48:51], v[160:163], a[76:79], 0
s_cselect_b32 s63, s12, s13
v_mfma_f32_16x16x32_bf16 v[48:51], v[156:159], a[72:75], v[48:51]
v_exp_f32 v38, v38
v_mfma_f32_16x16x32_bf16 v[48:51], v[152:155], a[68:71], v[48:51]
s_waitcnt vmcnt(8) lgkmcnt(0)
s_barrier
v_mfma_f32_16x16x32_bf16 v[48:51], v[148:151], a[64:67], v[48:51]
s_add_u32 m0, s56, 0
v_mfma_f32_16x16x32_bf16 a[224:227], v[164:167], v[92:95], 0
s_cmp_eq_u32 s48, 2
buffer_load_dwordx4 v4, s[4:7], s58 offen offset:0 sc1 lds
v_mfma_f32_16x16x32_bf16 a[224:227], v[168:171], v[96:99], a[224:227]
s_cselect_b32 s65, s14, s15
v_exp_f32 v39, v39
v_mfma_f32_16x16x32_bf16 a[228:231], v[176:179], v[96:99], 0
s_cmp_ge_u32 s48, 2
v_cvt_pk_bf16_f32 v68, v36, v37
v_cvt_pk_bf16_f32 v69, v38, v39
v_mfma_f32_16x16x32_bf16 a[228:231], v[172:175], v[92:95], a[228:231]
s_cselect_b32 s24, s28, s24
v_exp_f32 v40, v40
v_mfma_f32_16x16x32_bf16 a[232:235], v[180:183], v[92:95], 0
s_cselect_b32 s25, s29, s25
ds_read_b128 v[164:167], v3 offset:0
ds_read_b128 v[168:171], v3 offset:1024
v_mfma_f32_16x16x32_bf16 a[232:235], v[184:187], v[96:99], a[232:235]
s_cselect_b32 s26, s30, s26
v_exp_f32 v41, v41
v_mfma_f32_16x16x32_bf16 a[236:239], v[192:195], v[96:99], 0
s_cselect_b32 s63, s65, s63
buffer_load_dwordx4 v4, s[4:7], s58 offen offset:1024 sc1 lds
v_mfma_f32_16x16x32_bf16 a[236:239], v[188:191], v[92:95], a[236:239]
s_mov_b32 s27, 0x20000
v_exp_f32 v42, v42
v_mfma_f32_16x16x32_bf16 a[240:243], v[196:199], v[92:95], 0
ds_read_b128 v[172:175], v3 offset:2048
ds_read_b128 v[176:179], v3 offset:3072
v_mfma_f32_16x16x32_bf16 a[240:243], v[200:203], v[96:99], a[240:243]
v_exp_f32 v43, v43
v_mfma_f32_16x16x32_bf16 a[244:247], v[208:211], v[96:99], 0
v_cvt_pk_bf16_f32 v70, v40, v41
v_cvt_pk_bf16_f32 v71, v42, v43
v_mfma_f32_16x16x32_bf16 a[244:247], v[204:207], v[92:95], a[244:247]
v_exp_f32 v44, v44
v_mfma_f32_16x16x32_bf16 a[248:251], v[212:215], v[92:95], 0
ds_read_b128 v[180:183], v3 offset:4096
ds_read_b128 v[184:187], v3 offset:5120
v_mfma_f32_16x16x32_bf16 a[248:251], v[216:219], v[96:99], a[248:251]
v_exp_f32 v45, v45
v_mfma_f32_16x16x32_bf16 a[252:255], v[224:227], v[96:99], 0
buffer_load_dwordx4 v4, s[4:7], s58 offen offset:2048 sc1 lds
v_mfma_f32_16x16x32_bf16 a[252:255], v[220:223], v[92:95], a[252:255]
v_exp_f32 v46, v46
v_mfma_f32_16x16x32_bf16 v[32:35], v[8:11], v[92:95], 0
ds_read_b128 v[188:191], v3 offset:6144
ds_read_b128 v[192:195], v3 offset:7168
v_mfma_f32_16x16x32_bf16 v[32:35], v[8:11], v[96:99], v[32:35]
v_exp_f32 v47, v47
v_mfma_f32_16x16x32_bf16 v[52:55], v[100:103], a[80:83], 0
v_cvt_pk_bf16_f32 v72, v44, v45
v_cvt_pk_bf16_f32 v73, v46, v47
v_mfma_f32_16x16x32_bf16 v[52:55], v[104:107], a[84:87], v[52:55]
v_exp_f32 v48, v48
v_mfma_f32_16x16x32_bf16 v[52:55], v[108:111], a[88:91], v[52:55]
ds_read_b128 v[196:199], v3 offset:8192
ds_read_b128 v[200:203], v3 offset:9216
v_mfma_f32_16x16x32_bf16 v[52:55], v[112:115], a[92:95], v[52:55]
v_exp_f32 v49, v49
v_mfma_f32_16x16x32_bf16 v[56:59], v[128:131], a[92:95], 0
ds_read_b128 v[204:207], v3 offset:10240
ds_read_b128 v[208:211], v3 offset:11264
v_mfma_f32_16x16x32_bf16 v[56:59], v[124:127], a[88:91], v[56:59]
v_exp_f32 v50, v50
v_mfma_f32_16x16x32_bf16 v[56:59], v[120:123], a[84:87], v[56:59]
ds_read_b128 v[212:215], v3 offset:12288
ds_read_b128 v[216:219], v3 offset:13312
v_mfma_f32_16x16x32_bf16 v[56:59], v[116:119], a[80:83], v[56:59]
v_exp_f32 v51, v51
v_mfma_f32_16x16x32_bf16 v[60:63], v[132:135], a[80:83], 0
v_cvt_pk_bf16_f32 v74, v48, v49
v_cvt_pk_bf16_f32 v75, v50, v51
v_mfma_f32_16x16x32_bf16 v[60:63], v[136:139], a[84:87], v[60:63]
v_exp_f32 v52, v52
v_mfma_f32_16x16x32_bf16 v[60:63], v[140:143], a[88:91], v[60:63]
ds_read_b128 v[220:223], v3 offset:14336
ds_read_b128 v[224:227], v3 offset:15360
v_mfma_f32_16x16x32_bf16 v[60:63], v[144:147], a[92:95], v[60:63]
v_exp_f32 v53, v53
v_mfma_f32_16x16x32_bf16 v[64:67], v[160:163], a[92:95], 0
buffer_load_dwordx4 v4, s[4:7], s58 offen offset:3072 sc1 lds
v_mfma_f32_16x16x32_bf16 v[64:67], v[156:159], a[88:91], v[64:67]
s_add_u32 m0, s56, 4096
v_exp_f32 v54, v54
v_mfma_f32_16x16x32_bf16 v[64:67], v[152:155], a[84:87], v[64:67]
v_xor_b32 v3, 196608, v3
v_mfma_f32_16x16x32_bf16 v[64:67], v[148:151], a[80:83], v[64:67]
buffer_load_dword v7, v6, s[24:27], s63 offen
s_branch L_at_f1
L_at_b1fd:
s_waitcnt lgkmcnt(3)
v_mfma_f32_16x16x32_bf16 a[128:131], v[164:167], v[68:71], 0
buffer_load_dwordx4 v5, s[4:7], s58 offen offset:0 sc1 lds
v_mfma_f32_16x16x32_bf16 a[128:131], v[168:171], v[72:75], a[128:131]
v_exp_f32 v55, v55
v_mfma_f32_16x16x32_bf16 a[132:135], v[176:179], v[72:75], 0
v_cvt_pk_bf16_f32 v76, v52, v53
v_cvt_pk_bf16_f32 v77, v54, v55
v_mfma_f32_16x16x32_bf16 a[132:135], v[172:175], v[68:71], a[132:135]
v_exp_f32 v56, v56
v_mfma_f32_16x16x32_bf16 a[136:139], v[180:183], v[68:71], 0
buffer_load_dwordx4 v5, s[4:7], s58 offen offset:1024 sc1 lds
v_mfma_f32_16x16x32_bf16 a[136:139], v[184:187], v[72:75], a[136:139]
v_exp_f32 v57, v57
v_mfma_f32_16x16x32_bf16 a[140:143], v[192:195], v[72:75], 0
v_mfma_f32_16x16x32_bf16 a[140:143], v[188:191], v[68:71], a[140:143]
v_exp_f32 v58, v58
v_mfma_f32_16x16x32_bf16 a[144:147], v[196:199], v[68:71], 0
buffer_load_dwordx4 v5, s[4:7], s58 offen offset:2048 sc1 lds
v_mfma_f32_16x16x32_bf16 a[144:147], v[200:203], v[72:75], a[144:147]
v_exp_f32 v59, v59
v_mfma_f32_16x16x32_bf16 a[148:151], v[208:211], v[72:75], 0
v_cvt_pk_bf16_f32 v78, v56, v57
v_cvt_pk_bf16_f32 v79, v58, v59
v_mfma_f32_16x16x32_bf16 a[148:151], v[204:207], v[68:71], a[148:151]
v_exp_f32 v60, v60
v_mfma_f32_16x16x32_bf16 a[152:155], v[212:215], v[68:71], 0
s_waitcnt lgkmcnt(0)
buffer_load_dwordx4 v5, s[4:7], s58 offen offset:3072 sc1 lds
v_mfma_f32_16x16x32_bf16 a[152:155], v[216:219], v[72:75], a[152:155]
s_add_u32 m0, s57, 0
v_exp_f32 v61, v61
v_mfma_f32_16x16x32_bf16 a[156:159], v[224:227], v[72:75], 0
buffer_load_dwordx4 v4, s[4:7], s59 offen offset:0 sc1 lds
v_mfma_f32_16x16x32_bf16 a[156:159], v[220:223], v[68:71], a[156:159]
v_exp_f32 v62, v62
v_mfma_f32_16x16x32_bf16 v[20:23], v[8:11], v[68:71], 0
buffer_load_dwordx4 v4, s[4:7], s59 offen offset:1024 sc1 lds
v_mfma_f32_16x16x32_bf16 v[20:23], v[8:11], v[72:75], v[20:23]
v_exp_f32 v63, v63
v_mfma_f32_16x16x32_bf16 v[36:39], v[100:103], a[32:35], 0
v_cvt_pk_bf16_f32 v80, v60, v61
v_cvt_pk_bf16_f32 v81, v62, v63
v_mfma_f32_16x16x32_bf16 v[36:39], v[104:107], a[36:39], v[36:39]
v_exp_f32 v64, v64
v_mfma_f32_16x16x32_bf16 v[36:39], v[108:111], a[40:43], v[36:39]
buffer_load_dwordx4 v4, s[4:7], s59 offen offset:2048 sc1 lds
v_mfma_f32_16x16x32_bf16 v[36:39], v[112:115], a[44:47], v[36:39]
v_exp_f32 v65, v65
v_mfma_f32_16x16x32_bf16 v[40:43], v[128:131], a[44:47], 0
buffer_load_dwordx4 v4, s[4:7], s59 offen offset:3072 sc1 lds
v_mfma_f32_16x16x32_bf16 v[40:43], v[124:127], a[40:43], v[40:43]
s_add_u32 m0, s57, 4096
v_exp_f32 v66, v66
v_mfma_f32_16x16x32_bf16 v[40:43], v[120:123], a[36:39], v[40:43]
buffer_load_dwordx4 v5, s[4:7], s59 offen offset:0 sc1 lds
v_mfma_f32_16x16x32_bf16 v[40:43], v[116:119], a[32:35], v[40:43]
v_exp_f32 v67, v67
v_mfma_f32_16x16x32_bf16 v[44:47], v[132:135], a[32:35], 0
v_cvt_pk_bf16_f32 v82, v64, v65
v_cvt_pk_bf16_f32 v83, v66, v67
v_mfma_f32_16x16x32_bf16 v[44:47], v[136:139], a[36:39], v[44:47]
v_exp_f32 v36, v36
v_mfma_f32_16x16x32_bf16 v[44:47], v[140:143], a[40:43], v[44:47]
buffer_load_dwordx4 v5, s[4:7], s59 offen offset:1024 sc1 lds
v_mfma_f32_16x16x32_bf16 v[44:47], v[144:147], a[44:47], v[44:47]
v_exp_f32 v37, v37
v_mfma_f32_16x16x32_bf16 v[48:51], v[160:163], a[44:47], 0
buffer_load_dwordx4 v5, s[4:7], s59 offen offset:2048 sc1 lds
v_mfma_f32_16x16x32_bf16 v[48:51], v[156:159], a[40:43], v[48:51]
v_exp_f32 v38, v38
v_mfma_f32_16x16x32_bf16 v[48:51], v[152:155], a[36:39], v[48:51]
buffer_load_dwordx4 v5, s[4:7], s59 offen offset:3072 sc1 lds
v_mfma_f32_16x16x32_bf16 v[48:51], v[148:151], a[32:35], v[48:51]
s_xor_b32 s57, s57, 196608
v_mfma_f32_16x16x32_bf16 a[160:163], v[164:167], v[76:79], 0
s_waitcnt vmcnt(16) lgkmcnt(0)
s_barrier
v_mfma_f32_16x16x32_bf16 a[160:163], v[168:171], v[80:83], a[160:163]
s_add_u32 s59, s58, 16777216
v_exp_f32 v39, v39
v_mfma_f32_16x16x32_bf16 a[164:167], v[176:179], v[80:83], 0
v_cvt_pk_bf16_f32 v84, v36, v37
v_cvt_pk_bf16_f32 v85, v38, v39
v_mfma_f32_16x16x32_bf16 a[164:167], v[172:175], v[76:79], a[164:167]
s_add_u32 m0, s57, 0
v_exp_f32 v40, v40
v_mfma_f32_16x16x32_bf16 a[168:171], v[180:183], v[76:79], 0
buffer_load_dwordx4 v4, s[4:7], s59 offen offset:0 sc1 lds
v_mfma_f32_16x16x32_bf16 a[168:171], v[184:187], v[80:83], a[168:171]
s_add_u32 s58, s58, 32768
v_exp_f32 v41, v41
v_mfma_f32_16x16x32_bf16 a[172:175], v[192:195], v[80:83], 0
s_cmp_eq_u32 s60, s61
v_mfma_f32_16x16x32_bf16 a[172:175], v[188:191], v[76:79], a[172:175]
s_cselect_b32 s58, 4194304, s58
v_exp_f32 v42, v42
v_mfma_f32_16x16x32_bf16 a[176:179], v[196:199], v[76:79], 0
buffer_load_dwordx4 v4, s[4:7], s59 offen offset:1024 sc1 lds
v_mfma_f32_16x16x32_bf16 a[176:179], v[200:203], v[80:83], a[176:179]
s_cmp_gt_u32 s60, 16
v_exp_f32 v43, v43
v_mfma_f32_16x16x32_bf16 a[180:183], v[208:211], v[80:83], 0
s_cselect_b32 s58, 2146435072, s58
v_cvt_pk_bf16_f32 v86, v40, v41
v_cvt_pk_bf16_f32 v87, v42, v43
v_mfma_f32_16x16x32_bf16 a[180:183], v[204:207], v[76:79], a[180:183]
s_xor_b32 s56, s56, 65536
v_exp_f32 v44, v44
v_mfma_f32_16x16x32_bf16 a[184:187], v[212:215], v[76:79], 0
buffer_load_dwordx4 v4, s[4:7], s59 offen offset:2048 sc1 lds
v_mfma_f32_16x16x32_bf16 a[184:187], v[216:219], v[80:83], a[184:187]
s_add_u32 s60, s60, 1
v_exp_f32 v45, v45
v_mfma_f32_16x16x32_bf16 a[188:191], v[224:227], v[80:83], 0
v_mfma_f32_16x16x32_bf16 a[188:191], v[220:223], v[76:79], a[188:191]
v_exp_f32 v46, v46
v_mfma_f32_16x16x32_bf16 v[24:27], v[8:11], v[76:79], 0
buffer_load_dwordx4 v4, s[4:7], s59 offen offset:3072 sc1 lds
v_mfma_f32_16x16x32_bf16 v[24:27], v[8:11], v[80:83], v[24:27]
v_exp_f32 v47, v47
v_mfma_f32_16x16x32_bf16 v[52:55], v[100:103], a[48:51], 0
v_cvt_pk_bf16_f32 v88, v44, v45
v_cvt_pk_bf16_f32 v89, v46, v47
v_mfma_f32_16x16x32_bf16 v[52:55], v[104:107], a[52:55], v[52:55]
v_exp_f32 v48, v48
v_mfma_f32_16x16x32_bf16 v[52:55], v[108:111], a[56:59], v[52:55]
ds_read_b128 v[100:103], v2 offset:0
ds_read_b128 v[104:107], v2 offset:1024
v_mfma_f32_16x16x32_bf16 v[52:55], v[112:115], a[60:63], v[52:55]
s_add_u32 m0, s57, 4096
v_exp_f32 v49, v49
v_mfma_f32_16x16x32_bf16 v[56:59], v[128:131], a[60:63], 0
buffer_load_dwordx4 v5, s[4:7], s59 offen offset:0 sc1 lds
v_mfma_f32_16x16x32_bf16 v[56:59], v[124:127], a[56:59], v[56:59]
v_exp_f32 v50, v50
v_mfma_f32_16x16x32_bf16 v[56:59], v[120:123], a[52:55], v[56:59]
ds_read_b128 v[108:111], v2 offset:2048
ds_read_b128 v[112:115], v2 offset:3072
v_mfma_f32_16x16x32_bf16 v[56:59], v[116:119], a[48:51], v[56:59]
v_exp_f32 v51, v51
v_mfma_f32_16x16x32_bf16 v[60:63], v[132:135], a[48:51], 0
v_cvt_pk_bf16_f32 v90, v48, v49
v_cvt_pk_bf16_f32 v91, v50, v51
v_mfma_f32_16x16x32_bf16 v[60:63], v[136:139], a[52:55], v[60:63]
v_exp_f32 v52, v52
v_mfma_f32_16x16x32_bf16 v[60:63], v[140:143], a[56:59], v[60:63]
ds_read_b128 v[116:119], v2 offset:4096
ds_read_b128 v[120:123], v2 offset:5120
v_mfma_f32_16x16x32_bf16 v[60:63], v[144:147], a[60:63], v[60:63]
v_exp_f32 v53, v53
v_mfma_f32_16x16x32_bf16 v[64:67], v[160:163], a[60:63], 0
buffer_load_dwordx4 v5, s[4:7], s59 offen offset:1024 sc1 lds
v_mfma_f32_16x16x32_bf16 v[64:67], v[156:159], a[56:59], v[64:67]
v_exp_f32 v54, v54
v_mfma_f32_16x16x32_bf16 v[64:67], v[152:155], a[52:55], v[64:67]
ds_read_b128 v[124:127], v2 offset:6144
ds_read_b128 v[128:131], v2 offset:7168
v_mfma_f32_16x16x32_bf16 v[64:67], v[148:151], a[48:51], v[64:67]
v_mfma_f32_16x16x32_bf16 a[192:195], v[164:167], v[84:87], 0
ds_read_b128 v[132:135], v2 offset:8192
ds_read_b128 v[136:139], v2 offset:9216
v_mfma_f32_16x16x32_bf16 a[192:195], v[168:171], v[88:91], a[192:195]
v_exp_f32 v55, v55
v_mfma_f32_16x16x32_bf16 a[196:199], v[176:179], v[88:91], 0
v_cvt_pk_bf16_f32 v92, v52, v53
v_cvt_pk_bf16_f32 v93, v54, v55
v_mfma_f32_16x16x32_bf16 a[196:199], v[172:175], v[84:87], a[196:199]
v_exp_f32 v56, v56
v_mfma_f32_16x16x32_bf16 a[200:203], v[180:183], v[84:87], 0
ds_read_b128 v[140:143], v2 offset:10240
ds_read_b128 v[144:147], v2 offset:11264
v_mfma_f32_16x16x32_bf16 a[200:203], v[184:187], v[88:91], a[200:203]
v_exp_f32 v57, v57
v_mfma_f32_16x16x32_bf16 a[204:207], v[192:195], v[88:91], 0
buffer_load_dwordx4 v5, s[4:7], s59 offen offset:2048 sc1 lds
v_mfma_f32_16x16x32_bf16 a[204:207], v[188:191], v[84:87], a[204:207]
v_exp_f32 v58, v58
v_mfma_f32_16x16x32_bf16 a[208:211], v[196:199], v[84:87], 0
ds_read_b128 v[148:151], v2 offset:12288
ds_read_b128 v[152:155], v2 offset:13312
v_mfma_f32_16x16x32_bf16 a[208:211], v[200:203], v[88:91], a[208:211]
v_exp_f32 v59, v59
v_mfma_f32_16x16x32_bf16 a[212:215], v[208:211], v[88:91], 0
v_cvt_pk_bf16_f32 v94, v56, v57
v_cvt_pk_bf16_f32 v95, v58, v59
v_mfma_f32_16x16x32_bf16 a[212:215], v[204:207], v[84:87], a[212:215]
v_exp_f32 v60, v60
v_mfma_f32_16x16x32_bf16 a[216:219], v[212:215], v[84:87], 0
ds_read_b128 v[156:159], v2 offset:14336
ds_read_b128 v[160:163], v2 offset:15360
v_mfma_f32_16x16x32_bf16 a[216:219], v[216:219], v[88:91], a[216:219]
v_exp_f32 v61, v61
v_mfma_f32_16x16x32_bf16 a[220:223], v[224:227], v[88:91], 0
buffer_load_dwordx4 v5, s[4:7], s59 offen offset:3072 sc1 lds
v_mfma_f32_16x16x32_bf16 a[220:223], v[220:223], v[84:87], a[220:223]
s_xor_b32 s57, s57, 196608
v_exp_f32 v62, v62
v_mfma_f32_16x16x32_bf16 v[28:31], v[8:11], v[84:87], 0
v_xor_b32 v2, 65536, v2
v_mfma_f32_16x16x32_bf16 v[28:31], v[8:11], v[88:91], v[28:31]
s_waitcnt lgkmcnt(3)
v_exp_f32 v63, v63
v_mfma_f32_16x16x32_bf16 v[36:39], v[100:103], a[0:3], v[12:15]
v_cvt_pk_bf16_f32 v96, v60, v61
v_cvt_pk_bf16_f32 v97, v62, v63
v_mfma_f32_16x16x32_bf16 v[36:39], v[104:107], a[4:7], v[36:39]
v_exp_f32 v64, v64
v_mfma_f32_16x16x32_bf16 v[36:39], v[108:111], a[8:11], v[36:39]
v_mfma_f32_16x16x32_bf16 v[36:39], v[112:115], a[12:15], v[36:39]
v_exp_f32 v65, v65
v_exp_f32 v66, v66
v_exp_f32 v67, v67
v_cvt_pk_bf16_f32 v98, v64, v65
v_cvt_pk_bf16_f32 v99, v66, v67
s_nop 2
v_exp_f32 v36, v36
v_exp_f32 v37, v37
v_exp_f32 v38, v38
s_waitcnt vmcnt(8) lgkmcnt(0)
s_barrier
s_add_u32 m0, s56, 0
v_mfma_f32_16x16x32_bf16 a[224:227], v[164:167], v[92:95], 0
buffer_load_dwordx4 v4, s[4:7], s58 offen offset:0 sc1 lds
v_mfma_f32_16x16x32_bf16 a[224:227], v[168:171], v[96:99], a[224:227]
v_exp_f32 v39, v39
v_mfma_f32_16x16x32_bf16 a[228:231], v[176:179], v[96:99], 0
v_cvt_pk_bf16_f32 v68, v36, v37
v_cvt_pk_bf16_f32 v69, v38, v39
v_mfma_f32_16x16x32_bf16 a[228:231], v[172:175], v[92:95], a[228:231]
v_mfma_f32_16x16x32_bf16 a[232:235], v[180:183], v[92:95], 0
ds_read_b128 v[164:167], v3 offset:0
ds_read_b128 v[168:171], v3 offset:1024
v_mfma_f32_16x16x32_bf16 a[232:235], v[184:187], v[96:99], a[232:235]
v_mfma_f32_16x16x32_bf16 a[236:239], v[192:195], v[96:99], 0
buffer_load_dwordx4 v4, s[4:7], s58 offen offset:1024 sc1 lds
v_mfma_f32_16x16x32_bf16 a[236:239], v[188:191], v[92:95], a[236:239]
v_mfma_f32_16x16x32_bf16 a[240:243], v[196:199], v[92:95], 0
ds_read_b128 v[172:175], v3 offset:2048
ds_read_b128 v[176:179], v3 offset:3072
v_mfma_f32_16x16x32_bf16 a[240:243], v[200:203], v[96:99], a[240:243]
v_mfma_f32_16x16x32_bf16 a[244:247], v[208:211], v[96:99], 0
v_mov_b32 v70, 0
v_mov_b32 v71, 0
v_mfma_f32_16x16x32_bf16 a[244:247], v[204:207], v[92:95], a[244:247]
v_mfma_f32_16x16x32_bf16 a[248:251], v[212:215], v[92:95], 0
ds_read_b128 v[180:183], v3 offset:4096
ds_read_b128 v[184:187], v3 offset:5120
v_mfma_f32_16x16x32_bf16 a[248:251], v[216:219], v[96:99], a[248:251]
v_mfma_f32_16x16x32_bf16 a[252:255], v[224:227], v[96:99], 0
buffer_load_dwordx4 v4, s[4:7], s58 offen offset:2048 sc1 lds
v_mfma_f32_16x16x32_bf16 a[252:255], v[220:223], v[92:95], a[252:255]
v_mfma_f32_16x16x32_bf16 v[32:35], v[8:11], v[92:95], 0
ds_read_b128 v[188:191], v3 offset:6144
ds_read_b128 v[192:195], v3 offset:7168
v_mfma_f32_16x16x32_bf16 v[32:35], v[8:11], v[96:99], v[32:35]
v_mfma_f32_16x16x32_bf16 v[52:55], v[100:103], a[16:19], 0
v_mfma_f32_16x16x32_bf16 v[52:55], v[104:107], a[20:23], v[52:55]
v_mfma_f32_16x16x32_bf16 v[52:55], v[108:111], a[24:27], v[52:55]
ds_read_b128 v[196:199], v3 offset:8192
ds_read_b128 v[200:203], v3 offset:9216
v_mfma_f32_16x16x32_bf16 v[52:55], v[112:115], a[28:31], v[52:55]
v_mfma_f32_16x16x32_bf16 v[56:59], v[128:131], a[28:31], v[16:19]
ds_read_b128 v[204:207], v3 offset:10240
ds_read_b128 v[208:211], v3 offset:11264
v_mfma_f32_16x16x32_bf16 v[56:59], v[124:127], a[24:27], v[56:59]
v_mfma_f32_16x16x32_bf16 v[56:59], v[120:123], a[20:23], v[56:59]
ds_read_b128 v[212:215], v3 offset:12288
ds_read_b128 v[216:219], v3 offset:13312
v_mfma_f32_16x16x32_bf16 v[56:59], v[116:119], a[16:19], v[56:59]
v_exp_f32 v52, v52
ds_read_b128 v[220:223], v3 offset:14336
ds_read_b128 v[224:227], v3 offset:15360
v_exp_f32 v53, v53
buffer_load_dwordx4 v4, s[4:7], s58 offen offset:3072 sc1 lds
s_add_u32 m0, s56, 4096
v_exp_f32 v54, v54
v_xor_b32 v3, 196608, v3
s_branch L_at_x
L_at_f21:
s_lshl_b32 s51, s48, 13
v_add_u32 v228, s51, v1
s_sub_u32 s52, s51, 16384
v_xor_b32 v229, 0, v3
v_add_u32 v229, s52, v229
v_xor_b32 v230, 0, v2
v_and_b32 v230, 0x38000, v230
v_lshrrev_b32 v231, 2, v1
s_lshl_b32 s52, s48, 10
s_add_u32 s52, s52, 4096
v_add3_u32 v231, v230, v231, s52
v_and_b32 v232, 63, v231
v_add3_u32 v230, v230, v232, s52
v_xor_b32 v232, 0x400, v230
ds_write_b32 v231, v20 offset:0
ds_write_b32 v231, v24 offset:256
ds_write_b32 v231, v28 offset:512
ds_write_b32 v231, v32 offset:768
ds_write_b128 v228, a[128:131] offset:0
s_waitcnt vmcnt(0)
v_and_b32 v252, v252, v253
v_and_b32 v254, v254, v255
v_and_b32 v7, v252, v254
v_cmp_ne_u32 vcc, 1, v7
s_and_b32 s63, s2, 7
s_and_b32 s51, s63, 1
s_lshr_b32 s63, s63, 1
s_lshr_b32 s56, s2, 3
s_lshr_b32 s61, s56, 3
s_lshr_b32 s100, s56, 2
ds_write_b128 v228, a[132:135] offset:1024
s_and_b32 s100, s100, 1
s_xor_b32 s100, s100, s61
s_and_b32 s100, s100, 3
s_and_b32 s101, s56, 3
s_mul_i32 s61, s61, 10
s_and_b32 s56, s56, 7
s_lshl_b32 s51, s51, 3
s_add_u32 s60, s51, s56
s_lshl_b32 s60, s60, 3
s_mul_i32 s65, s48, 5120
ds_write_b128 v228, a[136:139] offset:2048
s_and_b32 s51, s63, 1
s_lshl_b32 s51, s51, 2
s_add_u32 s51, s51, s60
s_add_u32 s87, s51, s48
s_mul_i32 s51, s87, 186368
v_add_u32 v18, s51, v1
s_lshr_b32 s51, s63, 1
s_mul_i32 s51, s51, 5
s_add_u32 s3, s51, s61
s_lshl_b32 s51, s3, 10
ds_write_b128 v228, a[140:143] offset:3072
s_mul_i32 s56, s48, 40960
s_add_u32 s51, s51, s56
v_add_u32 v16, s51, v1
v_add_u32 v17, 4096, v16
s_cbranch_vccnz L_slow_hw2
L_slow_hw2_back:
v_add_u32 v7, 28672, v1
v_add_u32 v252, 73728, v7
s_mul_i32 s51, s54, 5120
s_add_u32 s51, s51, 16384
v_add_u32 v5, s51, v1
s_mov_b32 s57, 37748736
buffer_load_dwordx4 v[36:39], v18, s[4:7], s57 offen offset:0 sc1
ds_write_b128 v228, a[144:147] offset:4096
v_add_u32 v6, 73728, v5
s_lshl_b32 s51, s55, 13
s_add_u32 s51, s51, 36864
v_add_u32 v253, s51, v1
v_add_u32 v254, 73728, v253
v_lshlrev_b32 v255, 2, v0
s_lshl_b32 s86, s48, 12
s_lshl_b32 s51, s48, 1
s_add_u32 s51, s51, s60
s_mul_i32 s51, s51, 186368
buffer_load_dwordx4 v[40:43], v18, s[4:7], s57 offen offset:1024 sc1
ds_write_b128 v228, a[148:151] offset:5120
s_lshl_b32 s52, s63, 15
s_add_u32 s51, s51, s52
v_add_u32 v12, s51, v1
v_add_u32 v13, 184320, v12
s_mul_i32 s51, s63, 1310720
s_mul_i32 s52, s55, 40960
s_add_u32 s51, s51, s52
s_mul_i32 s52, s54, 5
s_add_u32 s52, s52, s61
s_lshl_b32 s52, s52, 10
buffer_load_dwordx4 v[44:47], v18, s[4:7], s57 offen offset:2048 sc1
ds_write_b128 v228, a[152:155] offset:6144
s_add_u32 s51, s51, s52
v_add_u32 v14, s51, v1
v_add_u32 v15, 4096, v14
s_lshl_b32 s88, s60, 6
s_lshl_b32 s51, s63, 7
s_add_u32 s88, s88, s51
s_add_u32 s88, s88, 70782976
s_mov_b64 s[12:13], 0xff
s_lshr_b32 s51, s60, 1
s_mul_i32 s52, s61, 6554
buffer_load_dwordx4 v[48:51], v18, s[4:7], s57 offen offset:3072 sc1
ds_write_b128 v228, a[156:159] offset:7168
s_lshr_b32 s52, s52, 16
s_add_u32 s51, s51, s52
s_lshl_b32 s89, s51, 7
s_add_u32 s89, s89, 70791168
s_mul_i32 s51, s51, 163840
s_add_u32 s51, s51, 75497472
s_lshl_b32 s52, s54, 1
s_add_u32 s52, s52, s55
s_lshl_b32 s52, s52, 2
s_add_u32 s52, s52, s63
s_mov_b32 s57, 37752832
buffer_load_dwordx4 v[52:55], v18, s[4:7], s57 offen offset:0 sc1
ds_write_b128 v229, a[160:163] offset:0
s_mul_i32 s52, s52, 10240
s_add_u32 s60, s51, s52
s_mul_i32 s52, s63, 40960
s_add_u32 s61, s51, s52
s_mul_i32 s52, s48, 2560
s_add_u32 s61, s61, s52
v_lshlrev_b32 v19, 3, v0
s_lshl_b32 s51, s54, 1
s_add_u32 s51, s51, s55
s_cmp_eq_u32 s51, s63
buffer_load_dwordx4 v[56:59], v18, s[4:7], s57 offen offset:1024 sc1
ds_write_b128 v229, a[164:167] offset:1024
s_cselect_b32 s60, 2146435072, s60
s_lshl_b32 s51, s64, 3
s_add_u32 s51, s51, 4
s_add_u32 s52, s51, s55
s_sub_u32 s53, s51, s55
s_add_u32 s53, s53, 3
s_mul_i32 s52, s52, 186368
s_mul_i32 s53, s53, 186368
s_lshl_b32 s51, s49, 12
s_add_u32 s51, s51, 37804032
buffer_load_dwordx4 v[60:63], v18, s[4:7], s57 offen offset:2048 sc1
ds_write_b128 v229, a[168:171] offset:2048
s_add_u32 s52, s52, s51
s_add_u32 s53, s53, s51
v_accvgpr_read_b32 v28, a192
v_accvgpr_read_b32 v29, a193
v_accvgpr_read_b32 v30, a194
v_accvgpr_read_b32 v31, a195
v_accvgpr_read_b32 v32, a196
v_accvgpr_read_b32 v33, a197
v_accvgpr_read_b32 v34, a198
v_accvgpr_read_b32 v35, a199
buffer_load_dwordx4 v[64:67], v18, s[4:7], s57 offen offset:3072 sc1
ds_write_b128 v229, a[172:175] offset:3072
v_accvgpr_read_b32 v180, a200
v_accvgpr_read_b32 v181, a201
v_accvgpr_read_b32 v182, a202
v_accvgpr_read_b32 v183, a203
v_accvgpr_read_b32 v184, a204
v_accvgpr_read_b32 v185, a205
v_accvgpr_read_b32 v186, a206
v_accvgpr_read_b32 v187, a207
v_accvgpr_read_b32 v188, a208
v_accvgpr_read_b32 v189, a209
s_mov_b32 s57, 37756928
buffer_load_dwordx4 v[68:71], v18, s[4:7], s57 offen offset:0 sc1
ds_write_b128 v229, a[176:179] offset:4096
v_accvgpr_read_b32 v190, a210
v_accvgpr_read_b32 v191, a211
v_accvgpr_read_b32 v192, a212
v_accvgpr_read_b32 v193, a213
v_accvgpr_read_b32 v194, a214
v_accvgpr_read_b32 v195, a215
v_accvgpr_read_b32 v196, a216
v_accvgpr_read_b32 v197, a217
v_accvgpr_read_b32 v198, a218
v_accvgpr_read_b32 v199, a219
buffer_load_dwordx4 v[72:75], v18, s[4:7], s57 offen offset:1024 sc1
ds_write_b128 v229, a[180:183] offset:5120
v_accvgpr_read_b32 v200, a220
v_accvgpr_read_b32 v201, a221
v_accvgpr_read_b32 v202, a222
v_accvgpr_read_b32 v203, a223
v_accvgpr_read_b32 v204, a224
v_accvgpr_read_b32 v205, a225
v_accvgpr_read_b32 v206, a226
v_accvgpr_read_b32 v207, a227
v_accvgpr_read_b32 v208, a228
v_accvgpr_read_b32 v209, a229
buffer_load_dwordx4 v[76:79], v18, s[4:7], s57 offen offset:2048 sc1
ds_write_b128 v229, a[184:187] offset:6144
v_accvgpr_read_b32 v210, a230
v_accvgpr_read_b32 v211, a231
v_accvgpr_read_b32 v212, a232
v_accvgpr_read_b32 v213, a233
v_accvgpr_read_b32 v214, a234
v_accvgpr_read_b32 v215, a235
v_accvgpr_read_b32 v216, a236
v_accvgpr_read_b32 v217, a237
v_accvgpr_read_b32 v218, a238
v_accvgpr_read_b32 v219, a239
buffer_load_dwordx4 v[80:83], v18, s[4:7], s57 offen offset:3072 sc1
s_mov_b32 s57, 37761024
ds_write_b128 v229, a[188:191] offset:7168
v_accvgpr_read_b32 v220, a240
v_accvgpr_read_b32 v221, a241
v_accvgpr_read_b32 v222, a242
v_accvgpr_read_b32 v223, a243
v_accvgpr_read_b32 v224, a244
v_accvgpr_read_b32 v225, a245
v_accvgpr_read_b32 v226, a246
v_accvgpr_read_b32 v227, a247
buffer_load_dwordx4 v[84:87], v18, s[4:7], s57 offen offset:0 sc1
buffer_load_dwordx4 v[88:91], v18, s[4:7], s57 offen offset:1024 sc1
buffer_load_dwordx4 v[92:95], v18, s[4:7], s57 offen offset:2048 sc1
buffer_load_dwordx4 v[96:99], v18, s[4:7], s57 offen offset:3072 sc1
v_xor_b32 v228, 0x2000, v228
v_xor_b32 v229, 0x2000, v229
s_waitcnt lgkmcnt(0)
s_barrier
ds_read_b32 v233, v230 offset:512
ds_read_b32 v234, v232 offset:512
ds_read_b32 v235, v230 offset:768
ds_read_b32 v236, v232 offset:768
ds_read_b128 v[244:247], v228 offset:0
ds_read_b128 v[248:251], v228 offset:1024
ds_read_b128 v[20:23], v228 offset:2048
ds_read_b128 v[24:27], v228 offset:3072
s_mov_b32 s56, 62914560
s_add_u32 m0, s65, 102400
s_nop 0
buffer_load_dwordx4 v16, s[4:7], s56 offen offset:0 sc1 lds
buffer_load_dwordx4 v16, s[4:7], s56 offen offset:1024 sc1 lds
buffer_load_dwordx4 v16, s[4:7], s56 offen offset:2048 sc1 lds
buffer_load_dwordx4 v16, s[4:7], s56 offen offset:3072 sc1 lds
s_add_u32 m0, s65, 106496
s_nop 0
buffer_load_dwordx4 v17, s[4:7], s56 offen sc1 lds
s_mov_b32 s56, 63078400
s_add_u32 m0, s65, 139264
s_nop 0
buffer_load_dwordx4 v16, s[4:7], s56 offen offset:0 sc1 lds
buffer_load_dwordx4 v16, s[4:7], s56 offen offset:1024 sc1 lds
buffer_load_dwordx4 v16, s[4:7], s56 offen offset:2048 sc1 lds
buffer_load_dwordx4 v16, s[4:7], s56 offen offset:3072 sc1 lds
s_add_u32 m0, s65, 143360
s_nop 0
buffer_load_dwordx4 v17, s[4:7], s56 offen sc1 lds
s_mov_b32 s14, 0x2b800000
s_mov_b32 s15, 0x5d800000
s_waitcnt lgkmcnt(6)
v_add_f32 v233, v233, v234
v_cmp_nle_f32 s[32:33], s14, v233
v_cmp_nge_f32 s[34:35], s15, v233
v_rcp_f32 v234, v233
s_waitcnt lgkmcnt(4)
v_add_f32 v235, v235, v236
v_cmp_nle_f32 s[96:97], s14, v235
v_cmp_nge_f32 s[98:99], s15, v235
v_rcp_f32 v236, v235
s_waitcnt lgkmcnt(1)
v_pk_add_f32 v[28:29], v[28:29], v[244:245]
v_pk_add_f32 v[30:31], v[30:31], v[246:247]
v_pk_add_f32 v[32:33], v[32:33], v[248:249]
v_pk_add_f32 v[34:35], v[34:35], v[250:251]
ds_read_b128 v[244:247], v228 offset:4096
ds_read_b128 v[248:251], v228 offset:5120
v_pk_mul_f32 v[28:29], v[28:29], v[234:235] op_sel_hi:[1,0]
v_pk_mul_f32 v[30:31], v[30:31], v[234:235] op_sel_hi:[1,0]
v_pk_mul_f32 v[32:33], v[32:33], v[234:235] op_sel_hi:[1,0]
v_pk_mul_f32 v[34:35], v[34:35], v[234:235] op_sel_hi:[1,0]
v_cvt_pk_bf16_f32 v28, v28, v29
v_cvt_pk_bf16_f32 v29, v30, v31
v_cvt_pk_bf16_f32 v30, v32, v33
v_cvt_pk_bf16_f32 v31, v34, v35
buffer_store_dwordx4 v[28:31], v1, s[4:7], s52 offen offset:0 sc1
s_nop 0
v_mfma_f32_16x16x32_bf16 v[240:243], v[8:11], v[28:31], 0
v_accvgpr_read_b32 v28, a248
v_accvgpr_read_b32 v29, a249
v_accvgpr_read_b32 v30, a250
v_accvgpr_read_b32 v31, a251
v_accvgpr_read_b32 v32, a252
v_accvgpr_read_b32 v33, a253
v_accvgpr_read_b32 v34, a254
v_accvgpr_read_b32 v35, a255
v_pk_add_f32 v[180:181], v[180:181], v[20:21]
v_pk_add_f32 v[182:183], v[182:183], v[22:23]
s_waitcnt lgkmcnt(2)
v_pk_add_f32 v[184:185], v[184:185], v[24:25]
v_pk_add_f32 v[186:187], v[186:187], v[26:27]
ds_read_b128 v[20:23], v228 offset:6144
ds_read_b128 v[24:27], v228 offset:7168
v_pk_mul_f32 v[180:181], v[180:181], v[234:235] op_sel_hi:[1,0]
v_pk_mul_f32 v[182:183], v[182:183], v[234:235] op_sel_hi:[1,0]
v_pk_mul_f32 v[184:185], v[184:185], v[234:235] op_sel_hi:[1,0]
v_pk_mul_f32 v[186:187], v[186:187], v[234:235] op_sel_hi:[1,0]
v_cvt_pk_bf16_f32 v180, v180, v181
v_cvt_pk_bf16_f32 v181, v182, v183
v_cvt_pk_bf16_f32 v182, v184, v185
v_cvt_pk_bf16_f32 v183, v186, v187
buffer_store_dwordx4 v[180:183], v1, s[4:7], s52 offen offset:1024 sc1
s_nop 0
v_mfma_f32_16x16x32_bf16 v[240:243], v[8:11], v[180:183], v[240:243]
s_waitcnt lgkmcnt(3)
v_pk_add_f32 v[188:189], v[188:189], v[244:245]
v_pk_add_f32 v[190:191], v[190:191], v[246:247]
s_waitcnt lgkmcnt(2)
v_pk_add_f32 v[192:193], v[192:193], v[248:249]
v_pk_add_f32 v[194:195], v[194:195], v[250:251]
ds_read_b128 v[244:247], v229 offset:0
ds_read_b128 v[248:251], v229 offset:1024
v_pk_mul_f32 v[188:189], v[188:189], v[234:235] op_sel_hi:[1,0]
v_pk_mul_f32 v[190:191], v[190:191], v[234:235] op_sel_hi:[1,0]
v_pk_mul_f32 v[192:193], v[192:193], v[234:235] op_sel_hi:[1,0]
v_pk_mul_f32 v[194:195], v[194:195], v[234:235] op_sel_hi:[1,0]
v_cvt_pk_bf16_f32 v188, v188, v189
v_cvt_pk_bf16_f32 v189, v190, v191
v_cvt_pk_bf16_f32 v190, v192, v193
v_cvt_pk_bf16_f32 v191, v194, v195
buffer_store_dwordx4 v[188:191], v1, s[4:7], s52 offen offset:2048 sc1
s_nop 0
v_mfma_f32_16x16x32_bf16 v[240:243], v[8:11], v[188:191], v[240:243]
s_waitcnt lgkmcnt(3)
v_pk_add_f32 v[196:197], v[196:197], v[20:21]
v_pk_add_f32 v[198:199], v[198:199], v[22:23]
s_waitcnt lgkmcnt(2)
v_pk_add_f32 v[200:201], v[200:201], v[24:25]
v_pk_add_f32 v[202:203], v[202:203], v[26:27]
ds_read_b128 v[20:23], v229 offset:2048
ds_read_b128 v[24:27], v229 offset:3072
v_pk_mul_f32 v[196:197], v[196:197], v[234:235] op_sel_hi:[1,0]
v_pk_mul_f32 v[198:199], v[198:199], v[234:235] op_sel_hi:[1,0]
v_pk_mul_f32 v[200:201], v[200:201], v[234:235] op_sel_hi:[1,0]
v_pk_mul_f32 v[202:203], v[202:203], v[234:235] op_sel_hi:[1,0]
v_cvt_pk_bf16_f32 v196, v196, v197
v_cvt_pk_bf16_f32 v197, v198, v199
v_cvt_pk_bf16_f32 v198, v200, v201
v_cvt_pk_bf16_f32 v199, v202, v203
buffer_store_dwordx4 v[196:199], v1, s[4:7], s52 offen offset:3072 sc1
s_nop 0
v_mfma_f32_16x16x32_bf16 v[240:243], v[8:11], v[196:199], v[240:243]
s_waitcnt lgkmcnt(3)
v_pk_add_f32 v[204:205], v[204:205], v[244:245]
v_pk_add_f32 v[206:207], v[206:207], v[246:247]
s_waitcnt lgkmcnt(2)
v_pk_add_f32 v[208:209], v[208:209], v[248:249]
v_pk_add_f32 v[210:211], v[210:211], v[250:251]
ds_read_b128 v[244:247], v229 offset:4096
ds_read_b128 v[248:251], v229 offset:5120
v_pk_mul_f32 v[204:205], v[204:205], v[236:237] op_sel_hi:[1,0]
v_pk_mul_f32 v[206:207], v[206:207], v[236:237] op_sel_hi:[1,0]
v_pk_mul_f32 v[208:209], v[208:209], v[236:237] op_sel_hi:[1,0]
v_pk_mul_f32 v[210:211], v[210:211], v[236:237] op_sel_hi:[1,0]
v_cvt_pk_bf16_f32 v204, v204, v205
v_cvt_pk_bf16_f32 v205, v206, v207
v_cvt_pk_bf16_f32 v206, v208, v209
v_cvt_pk_bf16_f32 v207, v210, v211
buffer_store_dwordx4 v[204:207], v1, s[4:7], s53 offen offset:0 sc1
s_nop 0
v_mfma_f32_16x16x32_bf16 v[240:243], v[8:11], v[204:207], v[240:243]
s_waitcnt lgkmcnt(3)
v_pk_add_f32 v[212:213], v[212:213], v[20:21]
v_pk_add_f32 v[214:215], v[214:215], v[22:23]
s_waitcnt lgkmcnt(2)
v_pk_add_f32 v[216:217], v[216:217], v[24:25]
v_pk_add_f32 v[218:219], v[218:219], v[26:27]
ds_read_b128 v[20:23], v229 offset:6144
ds_read_b128 v[24:27], v229 offset:7168
v_pk_mul_f32 v[212:213], v[212:213], v[236:237] op_sel_hi:[1,0]
v_pk_mul_f32 v[214:215], v[214:215], v[236:237] op_sel_hi:[1,0]
v_pk_mul_f32 v[216:217], v[216:217], v[236:237] op_sel_hi:[1,0]
v_pk_mul_f32 v[218:219], v[218:219], v[236:237] op_sel_hi:[1,0]
v_cvt_pk_bf16_f32 v212, v212, v213
v_cvt_pk_bf16_f32 v213, v214, v215
v_cvt_pk_bf16_f32 v214, v216, v217
v_cvt_pk_bf16_f32 v215, v218, v219
buffer_store_dwordx4 v[212:215], v1, s[4:7], s53 offen offset:1024 sc1
s_nop 0
v_mfma_f32_16x16x32_bf16 v[240:243], v[8:11], v[212:215], v[240:243]
s_waitcnt lgkmcnt(3)
v_pk_add_f32 v[220:221], v[220:221], v[244:245]
v_pk_add_f32 v[222:223], v[222:223], v[246:247]
s_waitcnt lgkmcnt(2)
v_pk_add_f32 v[224:225], v[224:225], v[248:249]
v_pk_add_f32 v[226:227], v[226:227], v[250:251]
v_pk_mul_f32 v[220:221], v[220:221], v[236:237] op_sel_hi:[1,0]
v_pk_mul_f32 v[222:223], v[222:223], v[236:237] op_sel_hi:[1,0]
v_pk_mul_f32 v[224:225], v[224:225], v[236:237] op_sel_hi:[1,0]
v_pk_mul_f32 v[226:227], v[226:227], v[236:237] op_sel_hi:[1,0]
v_cvt_pk_bf16_f32 v220, v220, v221
v_cvt_pk_bf16_f32 v221, v222, v223
v_cvt_pk_bf16_f32 v222, v224, v225
v_cvt_pk_bf16_f32 v223, v226, v227
buffer_store_dwordx4 v[220:223], v1, s[4:7], s53 offen offset:2048 sc1
s_nop 0
v_mfma_f32_16x16x32_bf16 v[240:243], v[8:11], v[220:223], v[240:243]
s_waitcnt lgkmcnt(1)
v_pk_add_f32 v[28:29], v[28:29], v[20:21]
v_pk_add_f32 v[30:31], v[30:31], v[22:23]
s_waitcnt lgkmcnt(0)
v_pk_add_f32 v[32:33], v[32:33], v[24:25]
v_pk_add_f32 v[34:35], v[34:35], v[26:27]
v_pk_mul_f32 v[28:29], v[28:29], v[236:237] op_sel_hi:[1,0]
v_pk_mul_f32 v[30:31], v[30:31], v[236:237] op_sel_hi:[1,0]
v_pk_mul_f32 v[32:33], v[32:33], v[236:237] op_sel_hi:[1,0]
v_pk_mul_f32 v[34:35], v[34:35], v[236:237] op_sel_hi:[1,0]
v_cvt_pk_bf16_f32 v28, v28, v29
v_cvt_pk_bf16_f32 v29, v30, v31
v_cvt_pk_bf16_f32 v30, v32, v33
v_cvt_pk_bf16_f32 v31, v34, v35
buffer_store_dwordx4 v[28:31], v1, s[4:7], s53 offen offset:3072 sc1
s_nop 0
v_mfma_f32_16x16x32_bf16 v[240:243], v[8:11], v[28:31], v[240:243]
s_or_b64 s[66:67], s[66:67], s[32:33]
s_or_b64 s[66:67], s[66:67], s[34:35]
s_or_b64 s[66:67], s[66:67], s[96:97]
s_or_b64 s[66:67], s[66:67], s[98:99]
s_nop 3
v_cmp_u_f32 vcc, v241, v241
s_nop 3
s_or_b64 s[66:67], s[66:67], vcc
L_at_done:

L_pub:
s_cmp_lg_u64 s[66:67], 0
s_cselect_b32 s51, 1, 0
v_mov_b32 v3, s51
s_lshl_b32 s51, s48, 2
s_add_u32 s51, s51, 163824
v_mov_b32 v2, s51
v_mov_b32 v228, 163824
ds_write_b32 v2, v3
s_waitcnt vmcnt(5) lgkmcnt(0)
s_barrier
ds_read_b128 v[232:235], v228
s_waitcnt lgkmcnt(0)
v_or3_b32 v232, v232, v233, v234
v_or_b32 v232, v232, v235
v_cmp_ne_u32 vcc, 0, v232
s_nop 3
s_cbranch_vccnz L_safe
ds_read_b128 a[64:67], v252 offset:0
ds_read_b128 a[68:71], v252 offset:5120
ds_read_b128 a[72:75], v252 offset:10240
ds_read_b128 a[76:79], v252 offset:15360
ds_read_b128 a[80:83], v252 offset:1024
ds_read_b128 a[84:87], v252 offset:6144
ds_read_b128 a[88:91], v252 offset:11264
ds_read_b128 a[92:95], v252 offset:16384
ds_read_b128 a[96:99], v252 offset:2048
ds_read_b128 a[100:103], v252 offset:7168
ds_read_b128 a[104:107], v252 offset:12288
ds_read_b128 a[108:111], v252 offset:17408

s_mov_b32 s56, 63242240
s_add_u32 m0, s65, 28672
s_nop 0
buffer_load_dwordx4 v16, s[4:7], s56 offen offset:0 sc1 lds
s_waitcnt lgkmcnt(11)
v_mfma_f32_16x16x32_bf16 v[212:215], a[64:67], v[36:39], 0
s_waitcnt lgkmcnt(10)
ds_read_b128 a[112:115], v252 offset:3072
ds_read_b128 a[116:119], v252 offset:8192
v_mfma_f32_16x16x32_bf16 v[212:215], a[68:71], v[40:43], v[212:215]
s_waitcnt lgkmcnt(11)
ds_read_b128 a[120:123], v252 offset:13312
ds_read_b128 a[124:127], v252 offset:18432
v_mfma_f32_16x16x32_bf16 v[212:215], a[72:75], v[44:47], v[212:215]
s_waitcnt lgkmcnt(12)
buffer_load_dwordx4 v16, s[4:7], s56 offen offset:1024 sc1 lds
v_mfma_f32_16x16x32_bf16 v[212:215], a[76:79], v[48:51], v[212:215]
s_waitcnt lgkmcnt(8)
buffer_load_dwordx4 v16, s[4:7], s56 offen offset:2048 sc1 lds
v_mfma_f32_16x16x32_bf16 v[216:219], a[92:95], v[48:51], 0
ds_read_b128 a[64:67], v252 offset:4096
ds_read_b128 a[68:71], v252 offset:9216
v_mfma_f32_16x16x32_bf16 v[216:219], a[88:91], v[44:47], v[216:219]
ds_read_b128 a[72:75], v252 offset:14336
ds_read_b128 a[76:79], v252 offset:19456
v_mfma_f32_16x16x32_bf16 v[216:219], a[84:87], v[40:43], v[216:219]
buffer_load_dwordx4 v16, s[4:7], s56 offen offset:3072 sc1 lds
v_mfma_f32_16x16x32_bf16 v[216:219], a[80:83], v[36:39], v[216:219]
s_waitcnt lgkmcnt(9)
s_add_u32 m0, s65, 32768
s_nop 0
buffer_load_dwordx4 v17, s[4:7], s56 offen sc1 lds
v_mfma_f32_16x16x32_bf16 v[220:223], a[96:99], v[36:39], 0
s_mov_b32 s56, 63406080
s_add_u32 m0, s65, 65536
v_mfma_f32_16x16x32_bf16 v[220:223], a[100:103], v[40:43], v[220:223]
s_waitcnt vmcnt(5) lgkmcnt(0)
s_barrier
ds_read_b128 a[80:83], v252 offset:36864
v_mfma_f32_16x16x32_bf16 v[220:223], a[104:107], v[44:47], v[220:223]
ds_read_b128 a[84:87], v252 offset:41984
ds_read_b128 a[88:91], v252 offset:47104
v_mfma_f32_16x16x32_bf16 v[220:223], a[108:111], v[48:51], v[220:223]
ds_read_b128 a[92:95], v252 offset:52224
v_mfma_f32_16x16x32_bf16 v[224:227], a[124:127], v[48:51], 0
ds_read_b128 a[96:99], v252 offset:37888
ds_read_b128 a[100:103], v252 offset:43008
v_mfma_f32_16x16x32_bf16 v[224:227], a[120:123], v[44:47], v[224:227]
ds_read_b128 a[104:107], v252 offset:48128
ds_read_b128 a[108:111], v252 offset:53248
v_mfma_f32_16x16x32_bf16 v[224:227], a[116:119], v[40:43], v[224:227]
buffer_load_dwordx4 v16, s[4:7], s56 offen offset:0 sc1 lds
v_mfma_f32_16x16x32_bf16 v[224:227], a[112:115], v[36:39], v[224:227]
buffer_load_dwordx4 v16, s[4:7], s56 offen offset:1024 sc1 lds
v_mfma_f32_16x16x32_bf16 v[228:231], a[64:67], v[36:39], 0
buffer_load_dwordx4 v16, s[4:7], s56 offen offset:2048 sc1 lds
v_mfma_f32_16x16x32_bf16 v[228:231], a[68:71], v[40:43], v[228:231]
ds_read_b128 a[112:115], v252 offset:38912
ds_read_b128 a[116:119], v252 offset:44032
v_mfma_f32_16x16x32_bf16 v[228:231], a[72:75], v[44:47], v[228:231]
ds_read_b128 a[120:123], v252 offset:49152
ds_read_b128 a[124:127], v252 offset:54272
v_mfma_f32_16x16x32_bf16 v[228:231], a[76:79], v[48:51], v[228:231]
s_waitcnt lgkmcnt(11)
buffer_load_dwordx4 v16, s[4:7], s56 offen offset:3072 sc1 lds
v_mfma_f32_16x16x32_bf16 v[212:215], a[80:83], v[52:55], v[212:215]
s_waitcnt lgkmcnt(8)
s_add_u32 m0, s65, 69632
s_nop 0
buffer_load_dwordx4 v17, s[4:7], s56 offen sc1 lds
v_mfma_f32_16x16x32_bf16 v[212:215], a[84:87], v[56:59], v[212:215]
s_lshr_b32 s52, s49, 3
s_lshl_b32 s52, s52, 7
s_and_b32 s51, s49, 7
v_mfma_f32_16x16x32_bf16 v[212:215], a[88:91], v[60:63], v[212:215]
s_lshl_b32 s51, s51, 2
s_add_u32 s52, s52, s51
s_add_u32 s52, s52, 70782976
s_lshl_b32 s51, s50, 9
s_add_u32 s51, s51, s52
v_mov_b32 v8, 2146435072
v_writelane_b32 v8, s51, 0
s_sub_u32 s51, 15, s50
s_lshl_b32 s51, s51, 9
s_add_u32 s51, s51, s52
s_cmp_eq_u32 s48, 0
v_writelane_b32 v8, s51, 1
s_cselect_b32 s51, 0, 2146435072
v_mov_b32 v9, 1
buffer_store_dword v9, v8, s[4:7], s51 offen sc1
v_mfma_f32_16x16x32_bf16 v[212:215], a[92:95], v[64:67], v[212:215]
ds_read_b128 a[64:67], v252 offset:39936
ds_read_b128 a[68:71], v252 offset:45056
ds_read_b128 a[72:75], v252 offset:50176
ds_read_b128 a[76:79], v252 offset:55296
s_waitcnt lgkmcnt(4)
v_mfma_f32_16x16x32_bf16 v[216:219], a[108:111], v[64:67], v[216:219]
s_mov_b32 s56, 63569920
ds_read_b128 a[80:83], v252 offset:40960
ds_read_b128 a[84:87], v252 offset:46080
v_mfma_f32_16x16x32_bf16 v[216:219], a[104:107], v[60:63], v[216:219]
s_add_u32 m0, s65, 102400
ds_read_b128 a[88:91], v252 offset:51200
ds_read_b128 a[92:95], v252 offset:56320
v_mfma_f32_16x16x32_bf16 v[216:219], a[100:103], v[56:59], v[216:219]
buffer_load_dwordx4 v16, s[4:7], s56 offen offset:0 sc1 lds
v_mfma_f32_16x16x32_bf16 v[216:219], a[96:99], v[52:55], v[216:219]
buffer_load_dwordx4 v16, s[4:7], s56 offen offset:1024 sc1 lds
v_mfma_f32_16x16x32_bf16 v[220:223], a[112:115], v[52:55], v[220:223]
buffer_load_dwordx4 v16, s[4:7], s56 offen offset:2048 sc1 lds
v_mfma_f32_16x16x32_bf16 v[220:223], a[116:119], v[56:59], v[220:223]
s_waitcnt vmcnt(9) lgkmcnt(0)
s_barrier
ds_read_b128 a[96:99], v7 offset:0
v_mfma_f32_16x16x32_bf16 v[220:223], a[120:123], v[60:63], v[220:223]
ds_read_b128 a[100:103], v7 offset:5120
ds_read_b128 a[104:107], v7 offset:10240
v_mfma_f32_16x16x32_bf16 v[220:223], a[124:127], v[64:67], v[220:223]
ds_read_b128 a[108:111], v7 offset:15360
v_mfma_f32_16x16x32_bf16 v[224:227], a[76:79], v[64:67], v[224:227]
ds_read_b128 a[112:115], v7 offset:1024
ds_read_b128 a[116:119], v7 offset:6144
v_mfma_f32_16x16x32_bf16 v[224:227], a[72:75], v[60:63], v[224:227]
ds_read_b128 a[120:123], v7 offset:11264
ds_read_b128 a[124:127], v7 offset:16384
v_mfma_f32_16x16x32_bf16 v[224:227], a[68:71], v[56:59], v[224:227]
buffer_load_dwordx4 v16, s[4:7], s56 offen offset:3072 sc1 lds
v_mfma_f32_16x16x32_bf16 v[224:227], a[64:67], v[52:55], v[224:227]
s_add_u32 m0, s65, 106496
s_nop 0
buffer_load_dwordx4 v17, s[4:7], s56 offen sc1 lds
v_mfma_f32_16x16x32_bf16 v[228:231], a[80:83], v[52:55], v[228:231]
s_mov_b32 s57, 37765120
ds_read_b128 a[64:67], v7 offset:2048
ds_read_b128 a[68:71], v7 offset:7168
v_mfma_f32_16x16x32_bf16 v[228:231], a[84:87], v[56:59], v[228:231]
ds_read_b128 a[72:75], v7 offset:12288
ds_read_b128 a[76:79], v7 offset:17408
v_mfma_f32_16x16x32_bf16 v[228:231], a[88:91], v[60:63], v[228:231]
buffer_load_dwordx4 v[36:39], v18, s[4:7], s57 offen offset:0 sc1
v_mfma_f32_16x16x32_bf16 v[228:231], a[92:95], v[64:67], v[228:231]
s_waitcnt lgkmcnt(9)
buffer_load_dwordx4 v[40:43], v18, s[4:7], s57 offen offset:1024 sc1
v_mfma_f32_16x16x32_bf16 v[212:215], a[96:99], v[68:71], v[212:215]
ds_read_b128 a[80:83], v7 offset:3072
ds_read_b128 a[84:87], v7 offset:8192
v_mfma_f32_16x16x32_bf16 v[212:215], a[100:103], v[72:75], v[212:215]
ds_read_b128 a[88:91], v7 offset:13312
ds_read_b128 a[92:95], v7 offset:18432
v_mfma_f32_16x16x32_bf16 v[212:215], a[104:107], v[76:79], v[212:215]
s_waitcnt lgkmcnt(8)
buffer_load_dwordx4 v[44:47], v18, s[4:7], s57 offen offset:2048 sc1
v_mfma_f32_16x16x32_bf16 v[212:215], a[108:111], v[80:83], v[212:215]
s_mov_b32 s56, 63733760
buffer_load_dwordx4 v[48:51], v18, s[4:7], s57 offen offset:3072 sc1
v_mfma_f32_16x16x32_bf16 v[216:219], a[124:127], v[80:83], v[216:219]
s_add_u32 m0, s65, 139264
ds_read_b128 a[96:99], v7 offset:4096
ds_read_b128 a[100:103], v7 offset:9216
v_mfma_f32_16x16x32_bf16 v[216:219], a[120:123], v[76:79], v[216:219]
ds_read_b128 a[104:107], v7 offset:14336
ds_read_b128 a[108:111], v7 offset:19456
v_mfma_f32_16x16x32_bf16 v[216:219], a[116:119], v[72:75], v[216:219]
buffer_load_dwordx4 v16, s[4:7], s56 offen offset:0 sc1 lds
v_mfma_f32_16x16x32_bf16 v[216:219], a[112:115], v[68:71], v[216:219]
s_waitcnt lgkmcnt(8)
buffer_load_dwordx4 v16, s[4:7], s56 offen offset:1024 sc1 lds
v_mfma_f32_16x16x32_bf16 v[220:223], a[64:67], v[68:71], v[220:223]
buffer_load_dwordx4 v16, s[4:7], s56 offen offset:2048 sc1 lds
v_mfma_f32_16x16x32_bf16 v[220:223], a[68:71], v[72:75], v[220:223]
s_waitcnt vmcnt(13) lgkmcnt(0)
s_barrier
ds_read_b128 a[112:115], v7 offset:36864
v_mfma_f32_16x16x32_bf16 v[220:223], a[72:75], v[76:79], v[220:223]
ds_read_b128 a[116:119], v7 offset:41984
ds_read_b128 a[120:123], v7 offset:47104
v_mfma_f32_16x16x32_bf16 v[220:223], a[76:79], v[80:83], v[220:223]
ds_read_b128 a[124:127], v7 offset:52224
v_mfma_f32_16x16x32_bf16 v[224:227], a[92:95], v[80:83], v[224:227]
ds_read_b128 a[64:67], v7 offset:37888
ds_read_b128 a[68:71], v7 offset:43008
v_mfma_f32_16x16x32_bf16 v[224:227], a[88:91], v[76:79], v[224:227]
ds_read_b128 a[72:75], v7 offset:48128
ds_read_b128 a[76:79], v7 offset:53248
v_mfma_f32_16x16x32_bf16 v[224:227], a[84:87], v[72:75], v[224:227]
buffer_load_dwordx4 v16, s[4:7], s56 offen offset:3072 sc1 lds
v_mfma_f32_16x16x32_bf16 v[224:227], a[80:83], v[68:71], v[224:227]
s_add_u32 m0, s65, 143360
s_nop 0
buffer_load_dwordx4 v17, s[4:7], s56 offen sc1 lds
v_mfma_f32_16x16x32_bf16 v[228:231], a[96:99], v[68:71], v[228:231]
s_mov_b32 s57, 37769216
ds_read_b128 a[80:83], v7 offset:38912
ds_read_b128 a[84:87], v7 offset:44032
v_mfma_f32_16x16x32_bf16 v[228:231], a[100:103], v[72:75], v[228:231]
ds_read_b128 a[88:91], v7 offset:49152
ds_read_b128 a[92:95], v7 offset:54272
v_mfma_f32_16x16x32_bf16 v[228:231], a[104:107], v[76:79], v[228:231]
buffer_load_dwordx4 v[52:55], v18, s[4:7], s57 offen offset:0 sc1
v_mfma_f32_16x16x32_bf16 v[228:231], a[108:111], v[80:83], v[228:231]
s_waitcnt lgkmcnt(9)
buffer_load_dwordx4 v[56:59], v18, s[4:7], s57 offen offset:1024 sc1
v_mfma_f32_16x16x32_bf16 v[212:215], a[112:115], v[84:87], v[212:215]
ds_read_b128 a[96:99], v7 offset:39936
ds_read_b128 a[100:103], v7 offset:45056
v_mfma_f32_16x16x32_bf16 v[212:215], a[116:119], v[88:91], v[212:215]
ds_read_b128 a[104:107], v7 offset:50176
ds_read_b128 a[108:111], v7 offset:55296
v_mfma_f32_16x16x32_bf16 v[212:215], a[120:123], v[92:95], v[212:215]
s_waitcnt lgkmcnt(8)
buffer_load_dwordx4 v[60:63], v18, s[4:7], s57 offen offset:2048 sc1
v_mfma_f32_16x16x32_bf16 v[212:215], a[124:127], v[96:99], v[212:215]
s_mov_b32 s56, 63897600
buffer_load_dwordx4 v[64:67], v18, s[4:7], s57 offen offset:3072 sc1
v_mfma_f32_16x16x32_bf16 v[216:219], a[76:79], v[96:99], v[216:219]
s_add_u32 m0, s65, 28672
ds_read_b128 a[112:115], v7 offset:40960
ds_read_b128 a[116:119], v7 offset:46080
v_mfma_f32_16x16x32_bf16 v[216:219], a[72:75], v[92:95], v[216:219]
ds_read_b128 a[120:123], v7 offset:51200
ds_read_b128 a[124:127], v7 offset:56320
v_mfma_f32_16x16x32_bf16 v[216:219], a[68:71], v[88:91], v[216:219]
buffer_load_dwordx4 v16, s[4:7], s56 offen offset:0 sc1 lds
v_mfma_f32_16x16x32_bf16 v[216:219], a[64:67], v[84:87], v[216:219]
s_waitcnt lgkmcnt(8)
buffer_load_dwordx4 v16, s[4:7], s56 offen offset:1024 sc1 lds
v_mfma_f32_16x16x32_bf16 v[220:223], a[80:83], v[84:87], v[220:223]
buffer_load_dwordx4 v16, s[4:7], s56 offen offset:2048 sc1 lds
v_mfma_f32_16x16x32_bf16 v[220:223], a[84:87], v[88:91], v[220:223]
s_waitcnt vmcnt(16) lgkmcnt(0)
s_barrier
ds_read_b128 a[64:67], v252 offset:0
v_mfma_f32_16x16x32_bf16 v[220:223], a[88:91], v[92:95], v[220:223]
ds_read_b128 a[68:71], v252 offset:5120
ds_read_b128 a[72:75], v252 offset:10240
v_mfma_f32_16x16x32_bf16 v[220:223], a[92:95], v[96:99], v[220:223]
ds_read_b128 a[76:79], v252 offset:15360
v_mfma_f32_16x16x32_bf16 v[224:227], a[108:111], v[96:99], v[224:227]
ds_read_b128 a[80:83], v252 offset:1024
ds_read_b128 a[84:87], v252 offset:6144
v_mfma_f32_16x16x32_bf16 v[224:227], a[104:107], v[92:95], v[224:227]
ds_read_b128 a[88:91], v252 offset:11264
ds_read_b128 a[92:95], v252 offset:16384
v_mfma_f32_16x16x32_bf16 v[224:227], a[100:103], v[88:91], v[224:227]
buffer_load_dwordx4 v16, s[4:7], s56 offen offset:3072 sc1 lds
v_mfma_f32_16x16x32_bf16 v[224:227], a[96:99], v[84:87], v[224:227]
s_add_u32 m0, s65, 32768
s_nop 0
buffer_load_dwordx4 v17, s[4:7], s56 offen sc1 lds
v_mfma_f32_16x16x32_bf16 v[228:231], a[112:115], v[84:87], v[228:231]
s_mov_b32 s57, 37773312
ds_read_b128 a[96:99], v252 offset:2048
ds_read_b128 a[100:103], v252 offset:7168
v_mfma_f32_16x16x32_bf16 v[228:231], a[116:119], v[88:91], v[228:231]
ds_read_b128 a[104:107], v252 offset:12288
ds_read_b128 a[108:111], v252 offset:17408
v_mfma_f32_16x16x32_bf16 v[228:231], a[120:123], v[92:95], v[228:231]
buffer_load_dwordx4 v[68:71], v18, s[4:7], s57 offen offset:0 sc1
v_mfma_f32_16x16x32_bf16 v[228:231], a[124:127], v[96:99], v[228:231]
s_waitcnt vmcnt(18) lgkmcnt(9)
buffer_load_dwordx4 v[72:75], v18, s[4:7], s57 offen offset:1024 sc1
v_mfma_f32_16x16x32_bf16 v[212:215], a[64:67], v[36:39], v[212:215]
s_waitcnt vmcnt(18)
ds_read_b128 a[112:115], v252 offset:3072
ds_read_b128 a[116:119], v252 offset:8192
v_mfma_f32_16x16x32_bf16 v[212:215], a[68:71], v[40:43], v[212:215]
s_waitcnt vmcnt(17)
ds_read_b128 a[120:123], v252 offset:13312
ds_read_b128 a[124:127], v252 offset:18432
v_mfma_f32_16x16x32_bf16 v[212:215], a[72:75], v[44:47], v[212:215]
s_waitcnt vmcnt(16) lgkmcnt(8)
buffer_load_dwordx4 v[76:79], v18, s[4:7], s57 offen offset:2048 sc1
v_mfma_f32_16x16x32_bf16 v[212:215], a[76:79], v[48:51], v[212:215]
s_mov_b32 s56, 64061440
buffer_load_dwordx4 v[80:83], v18, s[4:7], s57 offen offset:3072 sc1
v_mfma_f32_16x16x32_bf16 v[216:219], a[92:95], v[48:51], v[216:219]
s_add_u32 m0, s65, 65536
ds_read_b128 a[64:67], v252 offset:4096
ds_read_b128 a[68:71], v252 offset:9216
v_mfma_f32_16x16x32_bf16 v[216:219], a[88:91], v[44:47], v[216:219]
ds_read_b128 a[72:75], v252 offset:14336
ds_read_b128 a[76:79], v252 offset:19456
v_mfma_f32_16x16x32_bf16 v[216:219], a[84:87], v[40:43], v[216:219]
buffer_load_dwordx4 v16, s[4:7], s56 offen offset:0 sc1 lds
v_mfma_f32_16x16x32_bf16 v[216:219], a[80:83], v[36:39], v[216:219]
s_waitcnt lgkmcnt(8)
buffer_load_dwordx4 v16, s[4:7], s56 offen offset:1024 sc1 lds
v_mfma_f32_16x16x32_bf16 v[220:223], a[96:99], v[36:39], v[220:223]
buffer_load_dwordx4 v16, s[4:7], s56 offen offset:2048 sc1 lds
v_mfma_f32_16x16x32_bf16 v[220:223], a[100:103], v[40:43], v[220:223]
s_waitcnt vmcnt(16) lgkmcnt(0)
s_barrier
ds_read_b128 a[80:83], v252 offset:36864
v_mfma_f32_16x16x32_bf16 v[220:223], a[104:107], v[44:47], v[220:223]
ds_read_b128 a[84:87], v252 offset:41984
ds_read_b128 a[88:91], v252 offset:47104
v_mfma_f32_16x16x32_bf16 v[220:223], a[108:111], v[48:51], v[220:223]
ds_read_b128 a[92:95], v252 offset:52224
v_mfma_f32_16x16x32_bf16 v[224:227], a[124:127], v[48:51], v[224:227]
ds_read_b128 a[96:99], v252 offset:37888
ds_read_b128 a[100:103], v252 offset:43008
v_mfma_f32_16x16x32_bf16 v[224:227], a[120:123], v[44:47], v[224:227]
ds_read_b128 a[104:107], v252 offset:48128
ds_read_b128 a[108:111], v252 offset:53248
v_mfma_f32_16x16x32_bf16 v[224:227], a[116:119], v[40:43], v[224:227]
buffer_load_dwordx4 v16, s[4:7], s56 offen offset:3072 sc1 lds
v_mfma_f32_16x16x32_bf16 v[224:227], a[112:115], v[36:39], v[224:227]
s_add_u32 m0, s65, 69632
s_nop 0
buffer_load_dwordx4 v17, s[4:7], s56 offen sc1 lds
v_mfma_f32_16x16x32_bf16 v[228:231], a[64:67], v[36:39], v[228:231]
s_mov_b32 s57, 37777408
ds_read_b128 a[112:115], v252 offset:38912
ds_read_b128 a[116:119], v252 offset:44032
v_mfma_f32_16x16x32_bf16 v[228:231], a[68:71], v[40:43], v[228:231]
ds_read_b128 a[120:123], v252 offset:49152
ds_read_b128 a[124:127], v252 offset:54272
v_mfma_f32_16x16x32_bf16 v[228:231], a[72:75], v[44:47], v[228:231]
buffer_load_dwordx4 v[84:87], v18, s[4:7], s57 offen offset:0 sc1
v_mfma_f32_16x16x32_bf16 v[228:231], a[76:79], v[48:51], v[228:231]
s_waitcnt vmcnt(18) lgkmcnt(9)
buffer_load_dwordx4 v[88:91], v18, s[4:7], s57 offen offset:1024 sc1
v_mfma_f32_16x16x32_bf16 v[212:215], a[80:83], v[52:55], v[212:215]
s_waitcnt vmcnt(18)
ds_read_b128 a[64:67], v252 offset:39936
ds_read_b128 a[68:71], v252 offset:45056
v_mfma_f32_16x16x32_bf16 v[212:215], a[84:87], v[56:59], v[212:215]
s_waitcnt vmcnt(17)
ds_read_b128 a[72:75], v252 offset:50176
ds_read_b128 a[76:79], v252 offset:55296
v_mfma_f32_16x16x32_bf16 v[212:215], a[88:91], v[60:63], v[212:215]
s_waitcnt vmcnt(16) lgkmcnt(8)
buffer_load_dwordx4 v[92:95], v18, s[4:7], s57 offen offset:2048 sc1
v_mfma_f32_16x16x32_bf16 v[212:215], a[92:95], v[64:67], v[212:215]
s_mov_b32 s56, 64225280
buffer_load_dwordx4 v[96:99], v18, s[4:7], s57 offen offset:3072 sc1
v_mfma_f32_16x16x32_bf16 v[216:219], a[108:111], v[64:67], v[216:219]
s_add_u32 m0, s65, 102400
ds_read_b128 a[80:83], v252 offset:40960
ds_read_b128 a[84:87], v252 offset:46080
v_mfma_f32_16x16x32_bf16 v[216:219], a[104:107], v[60:63], v[216:219]
ds_read_b128 a[88:91], v252 offset:51200
ds_read_b128 a[92:95], v252 offset:56320
v_mfma_f32_16x16x32_bf16 v[216:219], a[100:103], v[56:59], v[216:219]
buffer_load_dwordx4 v16, s[4:7], s56 offen offset:0 sc1 lds
v_mfma_f32_16x16x32_bf16 v[216:219], a[96:99], v[52:55], v[216:219]
s_waitcnt lgkmcnt(8)
buffer_load_dwordx4 v16, s[4:7], s56 offen offset:1024 sc1 lds
v_mfma_f32_16x16x32_bf16 v[220:223], a[112:115], v[52:55], v[220:223]
buffer_load_dwordx4 v16, s[4:7], s56 offen offset:2048 sc1 lds
v_mfma_f32_16x16x32_bf16 v[220:223], a[116:119], v[56:59], v[220:223]
s_waitcnt vmcnt(16) lgkmcnt(0)
s_barrier
ds_read_b128 a[96:99], v7 offset:0
v_mfma_f32_16x16x32_bf16 v[220:223], a[120:123], v[60:63], v[220:223]
ds_read_b128 a[100:103], v7 offset:5120
ds_read_b128 a[104:107], v7 offset:10240
v_mfma_f32_16x16x32_bf16 v[220:223], a[124:127], v[64:67], v[220:223]
ds_read_b128 a[108:111], v7 offset:15360
v_mfma_f32_16x16x32_bf16 v[224:227], a[76:79], v[64:67], v[224:227]
ds_read_b128 a[112:115], v7 offset:1024
ds_read_b128 a[116:119], v7 offset:6144
v_mfma_f32_16x16x32_bf16 v[224:227], a[72:75], v[60:63], v[224:227]
ds_read_b128 a[120:123], v7 offset:11264
ds_read_b128 a[124:127], v7 offset:16384
v_mfma_f32_16x16x32_bf16 v[224:227], a[68:71], v[56:59], v[224:227]
buffer_load_dwordx4 v16, s[4:7], s56 offen offset:3072 sc1 lds
v_mfma_f32_16x16x32_bf16 v[224:227], a[64:67], v[52:55], v[224:227]
s_add_u32 m0, s65, 106496
s_nop 0
buffer_load_dwordx4 v17, s[4:7], s56 offen sc1 lds
v_mfma_f32_16x16x32_bf16 v[228:231], a[80:83], v[52:55], v[228:231]
s_mov_b32 s57, 37781504
ds_read_b128 a[64:67], v7 offset:2048
ds_read_b128 a[68:71], v7 offset:7168
v_mfma_f32_16x16x32_bf16 v[228:231], a[84:87], v[56:59], v[228:231]
ds_read_b128 a[72:75], v7 offset:12288
ds_read_b128 a[76:79], v7 offset:17408
v_mfma_f32_16x16x32_bf16 v[228:231], a[88:91], v[60:63], v[228:231]
buffer_load_dwordx4 v[36:39], v18, s[4:7], s57 offen offset:0 sc1
v_mfma_f32_16x16x32_bf16 v[228:231], a[92:95], v[64:67], v[228:231]
s_waitcnt vmcnt(18) lgkmcnt(9)
buffer_load_dwordx4 v[40:43], v18, s[4:7], s57 offen offset:1024 sc1
v_mfma_f32_16x16x32_bf16 v[212:215], a[96:99], v[68:71], v[212:215]
s_waitcnt vmcnt(18)
ds_read_b128 a[80:83], v7 offset:3072
ds_read_b128 a[84:87], v7 offset:8192
v_mfma_f32_16x16x32_bf16 v[212:215], a[100:103], v[72:75], v[212:215]
s_waitcnt vmcnt(17)
ds_read_b128 a[88:91], v7 offset:13312
ds_read_b128 a[92:95], v7 offset:18432
v_mfma_f32_16x16x32_bf16 v[212:215], a[104:107], v[76:79], v[212:215]
s_waitcnt vmcnt(16) lgkmcnt(8)
buffer_load_dwordx4 v[44:47], v18, s[4:7], s57 offen offset:2048 sc1
v_mfma_f32_16x16x32_bf16 v[212:215], a[108:111], v[80:83], v[212:215]
s_mov_b32 s56, 64389120
buffer_load_dwordx4 v[48:51], v18, s[4:7], s57 offen offset:3072 sc1
v_mfma_f32_16x16x32_bf16 v[216:219], a[124:127], v[80:83], v[216:219]
s_add_u32 m0, s65, 139264
ds_read_b128 a[96:99], v7 offset:4096
ds_read_b128 a[100:103], v7 offset:9216
v_mfma_f32_16x16x32_bf16 v[216:219], a[120:123], v[76:79], v[216:219]
ds_read_b128 a[104:107], v7 offset:14336
ds_read_b128 a[108:111], v7 offset:19456
v_mfma_f32_16x16x32_bf16 v[216:219], a[116:119], v[72:75], v[216:219]
buffer_load_dwordx4 v16, s[4:7], s56 offen offset:0 sc1 lds
v_mfma_f32_16x16x32_bf16 v[216:219], a[112:115], v[68:71], v[216:219]
s_waitcnt lgkmcnt(8)
buffer_load_dwordx4 v16, s[4:7], s56 offen offset:1024 sc1 lds
v_mfma_f32_16x16x32_bf16 v[220:223], a[64:67], v[68:71], v[220:223]
buffer_load_dwordx4 v16, s[4:7], s56 offen offset:2048 sc1 lds
v_mfma_f32_16x16x32_bf16 v[220:223], a[68:71], v[72:75], v[220:223]
s_waitcnt vmcnt(16) lgkmcnt(0)
s_barrier
ds_read_b128 a[112:115], v7 offset:36864
v_mfma_f32_16x16x32_bf16 v[220:223], a[72:75], v[76:79], v[220:223]
ds_read_b128 a[116:119], v7 offset:41984
ds_read_b128 a[120:123], v7 offset:47104
v_mfma_f32_16x16x32_bf16 v[220:223], a[76:79], v[80:83], v[220:223]
ds_read_b128 a[124:127], v7 offset:52224
v_mfma_f32_16x16x32_bf16 v[224:227], a[92:95], v[80:83], v[224:227]
ds_read_b128 a[64:67], v7 offset:37888
ds_read_b128 a[68:71], v7 offset:43008
v_mfma_f32_16x16x32_bf16 v[224:227], a[88:91], v[76:79], v[224:227]
ds_read_b128 a[72:75], v7 offset:48128
ds_read_b128 a[76:79], v7 offset:53248
v_mfma_f32_16x16x32_bf16 v[224:227], a[84:87], v[72:75], v[224:227]
buffer_load_dwordx4 v16, s[4:7], s56 offen offset:3072 sc1 lds
v_mfma_f32_16x16x32_bf16 v[224:227], a[80:83], v[68:71], v[224:227]
s_add_u32 m0, s65, 143360
s_nop 0
buffer_load_dwordx4 v17, s[4:7], s56 offen sc1 lds
v_mfma_f32_16x16x32_bf16 v[228:231], a[96:99], v[68:71], v[228:231]
ds_read_b128 a[80:83], v7 offset:38912
ds_read_b128 a[84:87], v7 offset:44032
v_mfma_f32_16x16x32_bf16 v[228:231], a[100:103], v[72:75], v[228:231]
ds_read_b128 a[88:91], v7 offset:49152
ds_read_b128 a[92:95], v7 offset:54272
v_mfma_f32_16x16x32_bf16 v[228:231], a[104:107], v[76:79], v[228:231]
s_mov_b32 s57, 37785600
buffer_load_dword v2, v255, s[4:7], s88 offen sc1
v_mfma_f32_16x16x32_bf16 v[228:231], a[108:111], v[80:83], v[228:231]
s_waitcnt vmcnt(18) lgkmcnt(9)
buffer_load_dwordx4 v[52:55], v18, s[4:7], s57 offen offset:0 sc1
v_mfma_f32_16x16x32_bf16 v[212:215], a[112:115], v[84:87], v[212:215]
s_waitcnt vmcnt(18)
ds_read_b128 a[96:99], v7 offset:39936
ds_read_b128 a[100:103], v7 offset:45056
v_mfma_f32_16x16x32_bf16 v[212:215], a[116:119], v[88:91], v[212:215]
s_waitcnt vmcnt(17)
ds_read_b128 a[104:107], v7 offset:50176
ds_read_b128 a[108:111], v7 offset:55296
v_mfma_f32_16x16x32_bf16 v[212:215], a[120:123], v[92:95], v[212:215]
s_waitcnt vmcnt(16) lgkmcnt(8)
buffer_load_dwordx4 v[56:59], v18, s[4:7], s57 offen offset:1024 sc1
v_mfma_f32_16x16x32_bf16 v[212:215], a[124:127], v[96:99], v[212:215]
buffer_load_dwordx4 v[60:63], v18, s[4:7], s57 offen offset:2048 sc1
v_mfma_f32_16x16x32_bf16 v[216:219], a[76:79], v[96:99], v[216:219]
ds_read_b128 a[112:115], v7 offset:40960
ds_read_b128 a[116:119], v7 offset:46080
v_mfma_f32_16x16x32_bf16 v[216:219], a[72:75], v[92:95], v[216:219]
ds_read_b128 a[120:123], v7 offset:51200
ds_read_b128 a[124:127], v7 offset:56320
v_mfma_f32_16x16x32_bf16 v[216:219], a[68:71], v[88:91], v[216:219]
buffer_load_dwordx4 v[64:67], v18, s[4:7], s57 offen offset:3072 sc1
v_mfma_f32_16x16x32_bf16 v[216:219], a[64:67], v[84:87], v[216:219]
s_waitcnt lgkmcnt(8)
s_add_u32 s57, s101, 0
s_and_b32 s57, s57, 15
s_xor_b32 s57, s57, s100
v_mfma_f32_16x16x32_bf16 v[220:223], a[80:83], v[84:87], v[220:223]
s_lshl_b32 s57, s57, 11
s_mul_i32 s56, s57, 40
s_add_u32 s56, s56, 65126400
v_mfma_f32_16x16x32_bf16 v[220:223], a[84:87], v[88:91], v[220:223]
s_waitcnt vmcnt(14) lgkmcnt(0)
s_barrier
ds_read_b128 a[64:67], v252 offset:0
v_mfma_f32_16x16x32_bf16 v[220:223], a[88:91], v[92:95], v[220:223]
s_add_u32 s57, s57, 37804032
ds_read_b128 a[68:71], v252 offset:5120
ds_read_b128 a[72:75], v252 offset:10240
v_mfma_f32_16x16x32_bf16 v[220:223], a[92:95], v[96:99], v[220:223]
s_add_u32 m0, s65, 16384
ds_read_b128 a[76:79], v252 offset:15360
v_mfma_f32_16x16x32_bf16 v[224:227], a[108:111], v[96:99], v[224:227]
ds_read_b128 a[80:83], v252 offset:1024
ds_read_b128 a[84:87], v252 offset:6144
v_mfma_f32_16x16x32_bf16 v[224:227], a[104:107], v[92:95], v[224:227]
ds_read_b128 a[88:91], v252 offset:11264
ds_read_b128 a[92:95], v252 offset:16384
v_mfma_f32_16x16x32_bf16 v[224:227], a[100:103], v[88:91], v[224:227]
buffer_load_dwordx4 v14, s[4:7], s56 offen offset:0 sc1 lds
v_mfma_f32_16x16x32_bf16 v[224:227], a[96:99], v[84:87], v[224:227]
buffer_load_dwordx4 v14, s[4:7], s56 offen offset:1024 sc1 lds
v_mfma_f32_16x16x32_bf16 v[228:231], a[112:115], v[84:87], v[228:231]
ds_read_b128 a[96:99], v252 offset:2048
ds_read_b128 a[100:103], v252 offset:7168
v_mfma_f32_16x16x32_bf16 v[228:231], a[116:119], v[88:91], v[228:231]
ds_read_b128 a[104:107], v252 offset:12288
ds_read_b128 a[108:111], v252 offset:17408
v_mfma_f32_16x16x32_bf16 v[228:231], a[120:123], v[92:95], v[228:231]
buffer_load_dwordx4 v14, s[4:7], s56 offen offset:2048 sc1 lds
v_mfma_f32_16x16x32_bf16 v[228:231], a[124:127], v[96:99], v[228:231]
s_waitcnt vmcnt(16) lgkmcnt(11)
buffer_load_dwordx4 v14, s[4:7], s56 offen offset:3072 sc1 lds
v_mfma_f32_16x16x32_bf16 v[212:215], a[64:67], v[36:39], v[212:215]
s_waitcnt vmcnt(16) lgkmcnt(9)
s_add_u32 m0, s65, 20480
ds_read_b128 a[112:115], v252 offset:3072
ds_read_b128 a[116:119], v252 offset:8192
v_mfma_f32_16x16x32_bf16 v[212:215], a[68:71], v[40:43], v[212:215]
s_waitcnt vmcnt(15)
ds_read_b128 a[120:123], v252 offset:13312
ds_read_b128 a[124:127], v252 offset:18432
v_mfma_f32_16x16x32_bf16 v[212:215], a[72:75], v[44:47], v[212:215]
s_waitcnt vmcnt(14) lgkmcnt(9)
buffer_load_dwordx4 v15, s[4:7], s56 offen sc1 lds
v_mfma_f32_16x16x32_bf16 v[212:215], a[76:79], v[48:51], v[212:215]
s_waitcnt vmcnt(9) lgkmcnt(8)
v_cmp_ne_u32 vcc, 1, v2
v_mfma_f32_16x16x32_bf16 v[216:219], a[92:95], v[48:51], v[216:219]
s_nop 2
s_and_b64 vcc, vcc, s[12:13]
ds_read_b128 a[64:67], v252 offset:4096
ds_read_b128 a[68:71], v252 offset:9216
v_mfma_f32_16x16x32_bf16 v[216:219], a[88:91], v[44:47], v[216:219]
ds_read_b128 a[72:75], v252 offset:14336
ds_read_b128 a[76:79], v252 offset:19456
v_mfma_f32_16x16x32_bf16 v[216:219], a[84:87], v[40:43], v[216:219]
s_cbranch_vccnz L_slow_o
L_slow_o_back:
v_mfma_f32_16x16x32_bf16 v[216:219], a[80:83], v[36:39], v[216:219]
s_waitcnt lgkmcnt(8)
s_add_u32 m0, s86, 36864
s_nop 0
buffer_load_dwordx4 v12, s[4:7], s57 offen offset:0 sc1 lds
v_mfma_f32_16x16x32_bf16 v[220:223], a[96:99], v[36:39], v[220:223]
buffer_load_dwordx4 v12, s[4:7], s57 offen offset:1024 sc1 lds
v_mfma_f32_16x16x32_bf16 v[220:223], a[100:103], v[40:43], v[220:223]
s_waitcnt vmcnt(63) lgkmcnt(0)
s_barrier
ds_read_b128 a[80:83], v252 offset:36864
v_mfma_f32_16x16x32_bf16 v[220:223], a[104:107], v[44:47], v[220:223]
ds_read_b128 a[84:87], v252 offset:41984
ds_read_b128 a[88:91], v252 offset:47104
v_mfma_f32_16x16x32_bf16 v[220:223], a[108:111], v[48:51], v[220:223]
ds_read_b128 a[92:95], v252 offset:52224
v_mfma_f32_16x16x32_bf16 v[224:227], a[124:127], v[48:51], v[224:227]
ds_read_b128 a[96:99], v252 offset:37888
ds_read_b128 a[100:103], v252 offset:43008
v_mfma_f32_16x16x32_bf16 v[224:227], a[120:123], v[44:47], v[224:227]
ds_read_b128 a[104:107], v252 offset:48128
ds_read_b128 a[108:111], v252 offset:53248
v_mfma_f32_16x16x32_bf16 v[224:227], a[116:119], v[40:43], v[224:227]
buffer_load_dwordx4 v13, s[4:7], s57 offen offset:2048 sc1 lds
v_mfma_f32_16x16x32_bf16 v[224:227], a[112:115], v[36:39], v[224:227]
buffer_load_dwordx4 v13, s[4:7], s57 offen offset:3072 sc1 lds
v_mfma_f32_16x16x32_bf16 v[228:231], a[64:67], v[36:39], v[228:231]
s_add_u32 s57, s101, 1
ds_read_b128 a[112:115], v252 offset:38912
ds_read_b128 a[116:119], v252 offset:44032
v_mfma_f32_16x16x32_bf16 v[228:231], a[68:71], v[40:43], v[228:231]
s_and_b32 s57, s57, 15
ds_read_b128 a[120:123], v252 offset:49152
ds_read_b128 a[124:127], v252 offset:54272
v_mfma_f32_16x16x32_bf16 v[228:231], a[72:75], v[44:47], v[228:231]
s_xor_b32 s57, s57, s100
s_lshl_b32 s57, s57, 11
s_mul_i32 s56, s57, 40
v_mfma_f32_16x16x32_bf16 v[228:231], a[76:79], v[48:51], v[228:231]
s_waitcnt vmcnt(12) lgkmcnt(9)
s_add_u32 s56, s56, 65126400
s_add_u32 s57, s57, 37804032
s_add_u32 m0, s65, 53248
v_mfma_f32_16x16x32_bf16 v[212:215], a[80:83], v[52:55], v[212:215]
s_waitcnt vmcnt(11)
buffer_load_dwordx4 v14, s[4:7], s56 offen offset:0 sc1 lds
v_mfma_f32_16x16x32_bf16 v[212:215], a[84:87], v[56:59], v[212:215]
s_waitcnt vmcnt(11)
ds_read_b128 a[64:67], v252 offset:39936
ds_read_b128 a[68:71], v252 offset:45056
v_mfma_f32_16x16x32_bf16 v[212:215], a[88:91], v[60:63], v[212:215]
s_waitcnt vmcnt(10) lgkmcnt(6)
ds_read_b128 a[72:75], v252 offset:50176
ds_read_b128 a[76:79], v252 offset:55296
v_mfma_f32_16x16x32_bf16 v[212:215], a[92:95], v[64:67], v[212:215]
buffer_load_dwordx4 v14, s[4:7], s56 offen offset:1024 sc1 lds
v_mfma_f32_16x16x32_bf16 v[216:219], a[108:111], v[64:67], v[216:219]
ds_read_b128 a[80:83], v252 offset:40960
ds_read_b128 a[84:87], v252 offset:46080
v_mfma_f32_16x16x32_bf16 v[216:219], a[104:107], v[60:63], v[216:219]
ds_read_b128 a[88:91], v252 offset:51200
ds_read_b128 a[92:95], v252 offset:56320
v_mfma_f32_16x16x32_bf16 v[216:219], a[100:103], v[56:59], v[216:219]
buffer_load_dwordx4 v14, s[4:7], s56 offen offset:2048 sc1 lds
v_mfma_f32_16x16x32_bf16 v[216:219], a[96:99], v[52:55], v[216:219]
s_waitcnt lgkmcnt(8)
buffer_load_dwordx4 v14, s[4:7], s56 offen offset:3072 sc1 lds
v_mfma_f32_16x16x32_bf16 v[220:223], a[112:115], v[52:55], v[220:223]
s_add_u32 m0, s65, 57344
s_nop 0
buffer_load_dwordx4 v15, s[4:7], s56 offen sc1 lds
v_mfma_f32_16x16x32_bf16 v[220:223], a[116:119], v[56:59], v[220:223]
s_waitcnt vmcnt(5) lgkmcnt(0)
s_barrier
ds_read_b128 a[96:99], v5 offset:0
v_mfma_f32_16x16x32_bf16 v[220:223], a[120:123], v[60:63], v[220:223]
s_add_u32 m0, s86, 73728
ds_read_b128 a[100:103], v5 offset:10240
ds_read_b128 a[0:3], v253 offset:0
v_mfma_f32_16x16x32_bf16 v[220:223], a[124:127], v[64:67], v[220:223]
buffer_load_dwordx4 v12, s[4:7], s57 offen offset:0 sc1 lds
v_mfma_f32_16x16x32_bf16 v[224:227], a[76:79], v[64:67], v[224:227]
ds_read_b128 a[112:115], v5 offset:1024
ds_read_b128 a[116:119], v5 offset:11264
v_mfma_f32_16x16x32_bf16 v[224:227], a[72:75], v[60:63], v[224:227]
buffer_load_dwordx4 v12, s[4:7], s57 offen offset:1024 sc1 lds
v_mfma_f32_16x16x32_bf16 v[224:227], a[68:71], v[56:59], v[224:227]
ds_read_b128 a[4:7], v253 offset:1024
ds_read_b128 a[8:11], v253 offset:2048
v_mfma_f32_16x16x32_bf16 v[224:227], a[64:67], v[52:55], v[224:227]
ds_read_b128 a[12:15], v253 offset:3072
ds_read_b128 a[16:19], v253 offset:4096
v_mfma_f32_16x16x32_bf16 v[228:231], a[80:83], v[52:55], v[228:231]
ds_read_b128 a[20:23], v253 offset:5120
ds_read_b128 a[24:27], v253 offset:6144
v_mfma_f32_16x16x32_bf16 v[228:231], a[84:87], v[56:59], v[228:231]
ds_read_b128 a[28:31], v253 offset:7168
ds_read_b128 a[64:67], v5 offset:2048
v_mfma_f32_16x16x32_bf16 v[228:231], a[88:91], v[60:63], v[228:231]
buffer_load_dwordx4 v13, s[4:7], s57 offen offset:2048 sc1 lds
v_mfma_f32_16x16x32_bf16 v[228:231], a[92:95], v[64:67], v[228:231]
s_waitcnt lgkmcnt(10)
ds_read_b128 a[68:71], v5 offset:12288
v_mfma_f32_16x16x32_bf16 v[100:103], a[96:99], a[0:3], 0
s_waitcnt lgkmcnt(8)
s_mul_i32 s20, s48, 2816
buffer_load_dwordx4 v13, s[4:7], s57 offen offset:3072 sc1 lds
v_mfma_f32_16x16x32_bf16 v[100:103], a[100:103], a[4:7], v[100:103]
s_waitcnt lgkmcnt(6)
s_add_u32 s57, s101, 2
s_and_b32 s57, s57, 15
s_xor_b32 s57, s57, s100
v_mfma_f32_16x16x32_bf16 v[120:123], a[100:103], a[12:15], 0
s_lshl_b32 s57, s57, 11
s_mul_i32 s56, s57, 40
s_add_u32 s56, s56, 65126400
s_add_u32 s57, s57, 37804032
s_add_u32 m0, s65, 90112
s_nop 0
buffer_load_dwordx4 v14, s[4:7], s56 offen offset:0 sc1 lds
v_mfma_f32_16x16x32_bf16 v[120:123], a[96:99], a[8:11], v[120:123]
s_waitcnt lgkmcnt(5)
ds_read_b128 a[80:83], v5 offset:3072
ds_read_b128 a[84:87], v5 offset:13312
v_mfma_f32_16x16x32_bf16 v[140:143], a[96:99], a[16:19], 0
s_waitcnt lgkmcnt(5)
buffer_load_dwordx4 v14, s[4:7], s56 offen offset:1024 sc1 lds
v_mfma_f32_16x16x32_bf16 v[140:143], a[100:103], a[20:23], v[140:143]
s_waitcnt lgkmcnt(3)
buffer_load_dwordx4 v14, s[4:7], s56 offen offset:2048 sc1 lds
v_mfma_f32_16x16x32_bf16 v[160:163], a[100:103], a[28:31], 0
buffer_load_dwordx4 v14, s[4:7], s56 offen offset:3072 sc1 lds
v_mfma_f32_16x16x32_bf16 v[160:163], a[96:99], a[24:27], v[160:163]
s_add_u32 m0, s65, 94208
s_nop 0
buffer_load_dwordx4 v15, s[4:7], s56 offen sc1 lds
v_mfma_f32_16x16x32_bf16 v[104:107], a[112:115], a[0:3], 0
s_add_u32 m0, s86, 110592
ds_read_b128 a[96:99], v5 offset:4096
ds_read_b128 a[100:103], v5 offset:14336
v_mfma_f32_16x16x32_bf16 v[104:107], a[116:119], a[4:7], v[104:107]
buffer_load_dwordx4 v12, s[4:7], s57 offen offset:0 sc1 lds
v_mfma_f32_16x16x32_bf16 v[124:127], a[116:119], a[12:15], 0
buffer_load_dwordx4 v12, s[4:7], s57 offen offset:1024 sc1 lds
v_mfma_f32_16x16x32_bf16 v[124:127], a[112:115], a[8:11], v[124:127]
buffer_load_dwordx4 v13, s[4:7], s57 offen offset:2048 sc1 lds
v_mfma_f32_16x16x32_bf16 v[144:147], a[112:115], a[16:19], 0
buffer_load_dwordx4 v13, s[4:7], s57 offen offset:3072 sc1 lds
v_mfma_f32_16x16x32_bf16 v[144:147], a[116:119], a[20:23], v[144:147]
s_add_u32 s57, s101, 3
s_and_b32 s57, s57, 15
s_xor_b32 s57, s57, s100
v_mfma_f32_16x16x32_bf16 v[164:167], a[116:119], a[28:31], 0
s_lshl_b32 s57, s57, 11
s_mul_i32 s56, s57, 40
s_add_u32 s56, s56, 65126400
v_mfma_f32_16x16x32_bf16 v[164:167], a[112:115], a[24:27], v[164:167]
s_add_u32 s57, s57, 37804032
s_add_u32 m0, s65, 126976
v_and_b32 v200, 15, v0
v_mfma_f32_16x16x32_bf16 v[108:111], a[64:67], a[0:3], 0
s_waitcnt vmcnt(9) lgkmcnt(0)
s_barrier
ds_read_b128 a[112:115], v5 offset:36864
v_mfma_f32_16x16x32_bf16 v[108:111], a[68:71], a[4:7], v[108:111]
ds_read_b128 a[116:119], v5 offset:47104
ds_read_b128 a[32:35], v253 offset:36864
v_mfma_f32_16x16x32_bf16 v[128:131], a[68:71], a[12:15], 0
buffer_load_dwordx4 v14, s[4:7], s56 offen offset:0 sc1 lds
v_mfma_f32_16x16x32_bf16 v[128:131], a[64:67], a[8:11], v[128:131]
buffer_load_dwordx4 v14, s[4:7], s56 offen offset:1024 sc1 lds
v_mfma_f32_16x16x32_bf16 v[148:151], a[64:67], a[16:19], 0
buffer_load_dwordx4 v14, s[4:7], s56 offen offset:2048 sc1 lds
v_mfma_f32_16x16x32_bf16 v[148:151], a[68:71], a[20:23], v[148:151]
buffer_load_dwordx4 v14, s[4:7], s56 offen offset:3072 sc1 lds
v_mfma_f32_16x16x32_bf16 v[168:171], a[68:71], a[28:31], 0
s_add_u32 m0, s65, 131072
ds_read_b128 a[36:39], v253 offset:37888
ds_read_b128 a[40:43], v253 offset:38912
v_mfma_f32_16x16x32_bf16 v[168:171], a[64:67], a[24:27], v[168:171]
ds_read_b128 a[44:47], v253 offset:39936
ds_read_b128 a[48:51], v253 offset:40960
v_mfma_f32_16x16x32_bf16 v[112:115], a[80:83], a[0:3], 0
ds_read_b128 a[64:67], v5 offset:37888
ds_read_b128 a[68:71], v5 offset:48128
v_mfma_f32_16x16x32_bf16 v[112:115], a[84:87], a[4:7], v[112:115]
ds_read_b128 a[52:55], v253 offset:41984
v_lshrrev_b32 v201, 4, v0
v_mfma_f32_16x16x32_bf16 v[132:135], a[84:87], a[12:15], 0
ds_read_b128 a[56:59], v253 offset:43008
v_mul_u32_u24 v200, 176, v200
v_mfma_f32_16x16x32_bf16 v[132:135], a[80:83], a[8:11], v[132:135]
ds_read_b128 a[60:63], v253 offset:44032
v_lshl_add_u32 v200, v201, 3, v200
v_mfma_f32_16x16x32_bf16 v[152:155], a[80:83], a[16:19], 0
buffer_load_dwordx4 v15, s[4:7], s56 offen sc1 lds
v_mfma_f32_16x16x32_bf16 v[152:155], a[84:87], a[20:23], v[152:155]
s_add_u32 m0, s86, 147456
s_nop 0
buffer_load_dwordx4 v12, s[4:7], s57 offen offset:0 sc1 lds
v_mfma_f32_16x16x32_bf16 v[172:175], a[84:87], a[28:31], 0
buffer_load_dwordx4 v12, s[4:7], s57 offen offset:1024 sc1 lds
v_mfma_f32_16x16x32_bf16 v[172:175], a[80:83], a[24:27], v[172:175]
buffer_load_dwordx4 v13, s[4:7], s57 offen offset:2048 sc1 lds
v_mfma_f32_16x16x32_bf16 v[116:119], a[96:99], a[0:3], 0
ds_read_b128 a[80:83], v5 offset:38912
ds_read_b128 a[84:87], v5 offset:49152
v_mfma_f32_16x16x32_bf16 v[116:119], a[100:103], a[4:7], v[116:119]
buffer_load_dwordx4 v13, s[4:7], s57 offen offset:3072 sc1 lds
v_mfma_f32_16x16x32_bf16 v[136:139], a[100:103], a[12:15], 0
s_add_u32 s57, s101, 4
s_and_b32 s57, s57, 15
s_xor_b32 s57, s57, s100
v_mfma_f32_16x16x32_bf16 v[136:139], a[96:99], a[8:11], v[136:139]
s_lshl_b32 s57, s57, 11
s_mul_i32 s56, s57, 40
s_add_u32 s56, s56, 65126400
v_mfma_f32_16x16x32_bf16 v[156:159], a[96:99], a[16:19], 0
s_add_u32 s57, s57, 37804032
s_add_u32 m0, s65, 16384
v_add_u32 v192, s20, v200
v_mfma_f32_16x16x32_bf16 v[156:159], a[100:103], a[20:23], v[156:159]
s_lshl_b32 s21, s87, 4
buffer_load_dwordx4 v14, s[4:7], s56 offen offset:0 sc1 lds
v_mfma_f32_16x16x32_bf16 v[176:179], a[100:103], a[28:31], 0
s_mul_i32 s21, s21, 1280
buffer_load_dwordx4 v14, s[4:7], s56 offen offset:1024 sc1 lds
v_mfma_f32_16x16x32_bf16 v[176:179], a[96:99], a[24:27], v[176:179]
s_waitcnt lgkmcnt(2)
s_lshl_b32 s22, s3, 5
s_add_u32 s21, s21, s22
s_movk_i32 s22, 1280
v_mfma_f32_16x16x32_bf16 v[100:103], a[112:115], a[32:35], v[100:103]
ds_read_b128 a[96:99], v5 offset:39936
ds_read_b128 a[100:103], v5 offset:50176
v_mfma_f32_16x16x32_bf16 v[100:103], a[116:119], a[36:39], v[100:103]
buffer_load_dwordx4 v14, s[4:7], s56 offen offset:2048 sc1 lds
v_mfma_f32_16x16x32_bf16 v[120:123], a[116:119], a[44:47], v[120:123]
v_cmp_gt_u32 s[24:25], 32, v0
v_add_u32 v200, 0, v0
v_mfma_f32_16x16x32_bf16 v[120:123], a[112:115], a[40:43], v[120:123]
v_mul_u32_u24 v201, 6554, v200
v_lshrrev_b32 v201, 16, v201
v_mfma_f32_16x16x32_bf16 v[140:143], a[112:115], a[48:51], v[140:143]
v_mul_u32_u24 v202, 10, v201
v_sub_u32 v202, v200, v202
v_mfma_f32_16x16x32_bf16 v[140:143], a[116:119], a[52:55], v[140:143]
buffer_load_dwordx4 v14, s[4:7], s56 offen offset:3072 sc1 lds
v_mfma_f32_16x16x32_bf16 v[160:163], a[116:119], a[60:63], v[160:163]
v_lshlrev_b32 v202, 4, v202
v_mul_u32_u24 v203, 176, v201
v_mfma_f32_16x16x32_bf16 v[160:163], a[112:115], a[56:59], v[160:163]
v_add3_u32 v193, v203, v202, s20
v_mul_lo_u32 v203, v201, s22
v_mfma_f32_16x16x32_bf16 v[104:107], a[64:67], a[32:35], v[104:107]
ds_read_b128 a[112:115], v5 offset:40960
ds_read_b128 a[116:119], v5 offset:51200
v_mfma_f32_16x16x32_bf16 v[104:107], a[68:71], a[36:39], v[104:107]
s_add_u32 m0, s65, 20480
s_nop 0
buffer_load_dwordx4 v15, s[4:7], s56 offen sc1 lds
v_mfma_f32_16x16x32_bf16 v[124:127], a[68:71], a[44:47], v[124:127]
v_add3_u32 v196, v203, v202, s21
v_add_u32 v200, 64, v0
v_mfma_f32_16x16x32_bf16 v[124:127], a[64:67], a[40:43], v[124:127]
v_mul_u32_u24 v201, 6554, v200
v_lshrrev_b32 v201, 16, v201
v_mfma_f32_16x16x32_bf16 v[144:147], a[64:67], a[48:51], v[144:147]
v_mul_u32_u24 v202, 10, v201
v_sub_u32 v202, v200, v202
v_mfma_f32_16x16x32_bf16 v[144:147], a[68:71], a[52:55], v[144:147]
v_lshlrev_b32 v202, 4, v202
v_mul_u32_u24 v203, 176, v201
v_mfma_f32_16x16x32_bf16 v[164:167], a[68:71], a[60:63], v[164:167]
s_add_u32 m0, s86, 36864
s_nop 0
buffer_load_dwordx4 v12, s[4:7], s57 offen offset:0 sc1 lds
v_mfma_f32_16x16x32_bf16 v[164:167], a[64:67], a[56:59], v[164:167]
s_waitcnt lgkmcnt(2)
v_add3_u32 v194, v203, v202, s20
v_mul_lo_u32 v203, v201, s22
v_mfma_f32_16x16x32_bf16 v[108:111], a[80:83], a[32:35], v[108:111]
s_waitcnt vmcnt(15) lgkmcnt(0)
s_barrier
ds_read_b128 a[64:67], v6 offset:0
v_mfma_f32_16x16x32_bf16 v[108:111], a[84:87], a[36:39], v[108:111]
ds_read_b128 a[68:71], v6 offset:10240
ds_read_b128 a[0:3], v254 offset:0
v_mfma_f32_16x16x32_bf16 v[128:131], a[84:87], a[44:47], v[128:131]
ds_read_b128 a[4:7], v254 offset:1024
v_add3_u32 v197, v203, v202, s21
v_mfma_f32_16x16x32_bf16 v[128:131], a[80:83], a[40:43], v[128:131]
buffer_load_dwordx4 v12, s[4:7], s57 offen offset:1024 sc1 lds
v_mfma_f32_16x16x32_bf16 v[148:151], a[80:83], a[48:51], v[148:151]
ds_read_b128 a[8:11], v254 offset:2048
v_add_u32 v200, 128, v0
v_mfma_f32_16x16x32_bf16 v[148:151], a[84:87], a[52:55], v[148:151]
ds_read_b128 a[12:15], v254 offset:3072
v_mul_u32_u24 v201, 6554, v200
v_mfma_f32_16x16x32_bf16 v[168:171], a[84:87], a[60:63], v[168:171]
buffer_load_dwordx4 v13, s[4:7], s57 offen offset:2048 sc1 lds
v_mfma_f32_16x16x32_bf16 v[168:171], a[80:83], a[56:59], v[168:171]
ds_read_b128 a[16:19], v254 offset:4096
v_lshrrev_b32 v201, 16, v201
v_mfma_f32_16x16x32_bf16 v[112:115], a[96:99], a[32:35], v[112:115]
ds_read_b128 a[80:83], v6 offset:1024
ds_read_b128 a[84:87], v6 offset:11264
v_mfma_f32_16x16x32_bf16 v[112:115], a[100:103], a[36:39], v[112:115]
ds_read_b128 a[20:23], v254 offset:5120
v_mul_u32_u24 v202, 10, v201
v_mfma_f32_16x16x32_bf16 v[132:135], a[100:103], a[44:47], v[132:135]
ds_read_b128 a[24:27], v254 offset:6144
v_sub_u32 v202, v200, v202
v_mfma_f32_16x16x32_bf16 v[132:135], a[96:99], a[40:43], v[132:135]
ds_read_b128 a[28:31], v254 offset:7168
v_lshlrev_b32 v202, 4, v202
v_mfma_f32_16x16x32_bf16 v[152:155], a[96:99], a[48:51], v[152:155]
buffer_load_dwordx4 v13, s[4:7], s57 offen offset:3072 sc1 lds
v_mfma_f32_16x16x32_bf16 v[152:155], a[100:103], a[52:55], v[152:155]
v_mul_u32_u24 v203, 176, v201
v_add3_u32 v195, v203, v202, s20
v_mfma_f32_16x16x32_bf16 v[172:175], a[100:103], a[60:63], v[172:175]
v_mul_lo_u32 v203, v201, s22
v_add3_u32 v198, v203, v202, s21
v_mfma_f32_16x16x32_bf16 v[172:175], a[96:99], a[56:59], v[172:175]
s_add_u32 s57, s101, 5
s_and_b32 s57, s57, 15
s_xor_b32 s57, s57, s100
v_mfma_f32_16x16x32_bf16 v[116:119], a[112:115], a[32:35], v[116:119]
s_lshl_b32 s57, s57, 11
ds_read_b128 a[96:99], v6 offset:2048
ds_read_b128 a[100:103], v6 offset:12288
v_mfma_f32_16x16x32_bf16 v[116:119], a[116:119], a[36:39], v[116:119]
s_mul_i32 s56, s57, 40
s_add_u32 s56, s56, 65126400
s_add_u32 s57, s57, 37804032
v_mfma_f32_16x16x32_bf16 v[136:139], a[116:119], a[44:47], v[136:139]
s_add_u32 m0, s65, 53248
s_nop 0
buffer_load_dwordx4 v14, s[4:7], s56 offen offset:0 sc1 lds
v_mfma_f32_16x16x32_bf16 v[136:139], a[112:115], a[40:43], v[136:139]
v_mov_b32 v200, 2146435072
v_cndmask_b32 v198, v200, v198, s[24:25]
v_mfma_f32_16x16x32_bf16 v[156:159], a[112:115], a[48:51], v[156:159]
buffer_load_dwordx4 v14, s[4:7], s56 offen offset:1024 sc1 lds
v_mfma_f32_16x16x32_bf16 v[156:159], a[116:119], a[52:55], v[156:159]
v_cndmask_b32 v200, v194, v195, s[24:25]
v_mfma_f32_16x16x32_bf16 v[176:179], a[116:119], a[60:63], v[176:179]
v_mfma_f32_16x16x32_bf16 v[176:179], a[112:115], a[56:59], v[176:179]
s_waitcnt lgkmcnt(2)
v_mfma_f32_16x16x32_bf16 v[100:103], a[64:67], a[0:3], v[100:103]
ds_read_b128 a[112:115], v6 offset:3072
ds_read_b128 a[116:119], v6 offset:13312
v_mfma_f32_16x16x32_bf16 v[100:103], a[68:71], a[4:7], v[100:103]
buffer_load_dwordx4 v14, s[4:7], s56 offen offset:2048 sc1 lds
v_mfma_f32_16x16x32_bf16 v[120:123], a[68:71], a[12:15], v[120:123]
v_mfma_f32_16x16x32_bf16 v[120:123], a[64:67], a[8:11], v[120:123]
v_mfma_f32_16x16x32_bf16 v[140:143], a[64:67], a[16:19], v[140:143]
buffer_load_dwordx4 v14, s[4:7], s56 offen offset:3072 sc1 lds
v_mfma_f32_16x16x32_bf16 v[140:143], a[68:71], a[20:23], v[140:143]
v_mfma_f32_16x16x32_bf16 v[160:163], a[68:71], a[28:31], v[160:163]
v_mfma_f32_16x16x32_bf16 v[160:163], a[64:67], a[24:27], v[160:163]
v_mfma_f32_16x16x32_bf16 v[104:107], a[80:83], a[0:3], v[104:107]
ds_read_b128 a[64:67], v6 offset:4096
ds_read_b128 a[68:71], v6 offset:14336
v_mfma_f32_16x16x32_bf16 v[104:107], a[84:87], a[4:7], v[104:107]
s_add_u32 m0, s65, 57344
s_nop 0
buffer_load_dwordx4 v15, s[4:7], s56 offen sc1 lds
v_mfma_f32_16x16x32_bf16 v[124:127], a[84:87], a[12:15], v[124:127]
v_mfma_f32_16x16x32_bf16 v[124:127], a[80:83], a[8:11], v[124:127]
v_mfma_f32_16x16x32_bf16 v[144:147], a[80:83], a[16:19], v[144:147]
v_mfma_f32_16x16x32_bf16 v[144:147], a[84:87], a[20:23], v[144:147]
s_add_u32 m0, s86, 73728
s_nop 0
buffer_load_dwordx4 v12, s[4:7], s57 offen offset:0 sc1 lds
v_mfma_f32_16x16x32_bf16 v[164:167], a[84:87], a[28:31], v[164:167]
v_mfma_f32_16x16x32_bf16 v[164:167], a[80:83], a[24:27], v[164:167]
s_waitcnt lgkmcnt(2)
v_mfma_f32_16x16x32_bf16 v[108:111], a[96:99], a[0:3], v[108:111]
s_waitcnt vmcnt(15) lgkmcnt(0)
s_barrier
ds_read_b128 a[80:83], v6 offset:36864
v_mfma_f32_16x16x32_bf16 v[108:111], a[100:103], a[4:7], v[108:111]
ds_read_b128 a[84:87], v6 offset:47104
ds_read_b128 a[32:35], v254 offset:36864
v_mfma_f32_16x16x32_bf16 v[128:131], a[100:103], a[12:15], v[128:131]
ds_read_b128 a[36:39], v254 offset:37888
v_mfma_f32_16x16x32_bf16 v[128:131], a[96:99], a[8:11], v[128:131]
buffer_load_dwordx4 v12, s[4:7], s57 offen offset:1024 sc1 lds
v_mfma_f32_16x16x32_bf16 v[148:151], a[96:99], a[16:19], v[148:151]
ds_read_b128 a[40:43], v254 offset:38912
v_mfma_f32_16x16x32_bf16 v[148:151], a[100:103], a[20:23], v[148:151]
ds_read_b128 a[44:47], v254 offset:39936
v_mfma_f32_16x16x32_bf16 v[168:171], a[100:103], a[28:31], v[168:171]
buffer_load_dwordx4 v13, s[4:7], s57 offen offset:2048 sc1 lds
v_mfma_f32_16x16x32_bf16 v[168:171], a[96:99], a[24:27], v[168:171]
ds_read_b128 a[48:51], v254 offset:40960
v_mfma_f32_16x16x32_bf16 v[112:115], a[112:115], a[0:3], v[112:115]
ds_read_b128 a[96:99], v6 offset:37888
ds_read_b128 a[100:103], v6 offset:48128
v_mfma_f32_16x16x32_bf16 v[112:115], a[116:119], a[4:7], v[112:115]
ds_read_b128 a[52:55], v254 offset:41984
v_mfma_f32_16x16x32_bf16 v[132:135], a[116:119], a[12:15], v[132:135]
ds_read_b128 a[56:59], v254 offset:43008
v_mfma_f32_16x16x32_bf16 v[132:135], a[112:115], a[8:11], v[132:135]
ds_read_b128 a[60:63], v254 offset:44032
v_mfma_f32_16x16x32_bf16 v[152:155], a[112:115], a[16:19], v[152:155]
buffer_load_dwordx4 v13, s[4:7], s57 offen offset:3072 sc1 lds
v_mfma_f32_16x16x32_bf16 v[152:155], a[116:119], a[20:23], v[152:155]
v_mfma_f32_16x16x32_bf16 v[172:175], a[116:119], a[28:31], v[172:175]
v_mfma_f32_16x16x32_bf16 v[172:175], a[112:115], a[24:27], v[172:175]
s_add_u32 s57, s101, 6
s_and_b32 s57, s57, 15
s_xor_b32 s57, s57, s100
v_mfma_f32_16x16x32_bf16 v[116:119], a[64:67], a[0:3], v[116:119]
s_lshl_b32 s57, s57, 11
ds_read_b128 a[112:115], v6 offset:38912
ds_read_b128 a[116:119], v6 offset:49152
v_mfma_f32_16x16x32_bf16 v[116:119], a[68:71], a[4:7], v[116:119]
s_mul_i32 s56, s57, 40
s_add_u32 s56, s56, 65126400
s_add_u32 s57, s57, 37804032
v_mfma_f32_16x16x32_bf16 v[136:139], a[68:71], a[12:15], v[136:139]
s_add_u32 m0, s65, 90112
s_nop 0
buffer_load_dwordx4 v14, s[4:7], s56 offen offset:0 sc1 lds
v_mfma_f32_16x16x32_bf16 v[136:139], a[64:67], a[8:11], v[136:139]
buffer_load_dwordx4 v14, s[4:7], s56 offen offset:1024 sc1 lds
v_mfma_f32_16x16x32_bf16 v[156:159], a[64:67], a[16:19], v[156:159]
v_mfma_f32_16x16x32_bf16 v[156:159], a[68:71], a[20:23], v[156:159]
v_mfma_f32_16x16x32_bf16 v[176:179], a[68:71], a[28:31], v[176:179]
v_mfma_f32_16x16x32_bf16 v[176:179], a[64:67], a[24:27], v[176:179]
s_waitcnt lgkmcnt(2)
v_mfma_f32_16x16x32_bf16 v[100:103], a[80:83], a[32:35], v[100:103]
ds_read_b128 a[64:67], v6 offset:39936
ds_read_b128 a[68:71], v6 offset:50176
v_mfma_f32_16x16x32_bf16 v[100:103], a[84:87], a[36:39], v[100:103]
buffer_load_dwordx4 v14, s[4:7], s56 offen offset:2048 sc1 lds
v_mfma_f32_16x16x32_bf16 v[120:123], a[84:87], a[44:47], v[120:123]
v_mfma_f32_16x16x32_bf16 v[120:123], a[80:83], a[40:43], v[120:123]
v_mfma_f32_16x16x32_bf16 v[140:143], a[80:83], a[48:51], v[140:143]
buffer_load_dwordx4 v14, s[4:7], s56 offen offset:3072 sc1 lds
v_mfma_f32_16x16x32_bf16 v[140:143], a[84:87], a[52:55], v[140:143]
v_mfma_f32_16x16x32_bf16 v[160:163], a[84:87], a[60:63], v[160:163]
v_mfma_f32_16x16x32_bf16 v[160:163], a[80:83], a[56:59], v[160:163]
v_mfma_f32_16x16x32_bf16 v[104:107], a[96:99], a[32:35], v[104:107]
s_add_u32 m0, s65, 94208
ds_read_b128 a[80:83], v6 offset:40960
ds_read_b128 a[84:87], v6 offset:51200
v_mfma_f32_16x16x32_bf16 v[104:107], a[100:103], a[36:39], v[104:107]
buffer_load_dwordx4 v15, s[4:7], s56 offen sc1 lds
v_mfma_f32_16x16x32_bf16 v[124:127], a[100:103], a[44:47], v[124:127]
v_mfma_f32_16x16x32_bf16 v[124:127], a[96:99], a[40:43], v[124:127]
v_mfma_f32_16x16x32_bf16 v[144:147], a[96:99], a[48:51], v[144:147]
v_mfma_f32_16x16x32_bf16 v[144:147], a[100:103], a[52:55], v[144:147]
s_add_u32 m0, s86, 110592
s_nop 0
buffer_load_dwordx4 v12, s[4:7], s57 offen offset:0 sc1 lds
v_mfma_f32_16x16x32_bf16 v[164:167], a[100:103], a[60:63], v[164:167]
v_mfma_f32_16x16x32_bf16 v[164:167], a[96:99], a[56:59], v[164:167]
s_waitcnt lgkmcnt(2)
v_mfma_f32_16x16x32_bf16 v[108:111], a[112:115], a[32:35], v[108:111]
s_waitcnt vmcnt(15) lgkmcnt(0)
s_barrier
ds_read_b128 a[96:99], v5 offset:0
v_mfma_f32_16x16x32_bf16 v[108:111], a[116:119], a[36:39], v[108:111]
ds_read_b128 a[100:103], v5 offset:10240
ds_read_b128 a[0:3], v253 offset:0
v_mfma_f32_16x16x32_bf16 v[128:131], a[116:119], a[44:47], v[128:131]
ds_read_b128 a[4:7], v253 offset:1024
v_mfma_f32_16x16x32_bf16 v[128:131], a[112:115], a[40:43], v[128:131]
buffer_load_dwordx4 v12, s[4:7], s57 offen offset:1024 sc1 lds
v_mfma_f32_16x16x32_bf16 v[148:151], a[112:115], a[48:51], v[148:151]
ds_read_b128 a[8:11], v253 offset:2048
v_mfma_f32_16x16x32_bf16 v[148:151], a[116:119], a[52:55], v[148:151]
ds_read_b128 a[12:15], v253 offset:3072
v_mfma_f32_16x16x32_bf16 v[168:171], a[116:119], a[60:63], v[168:171]
buffer_load_dwordx4 v13, s[4:7], s57 offen offset:2048 sc1 lds
v_mfma_f32_16x16x32_bf16 v[168:171], a[112:115], a[56:59], v[168:171]
ds_read_b128 a[16:19], v253 offset:4096
v_mfma_f32_16x16x32_bf16 v[112:115], a[64:67], a[32:35], v[112:115]
ds_read_b128 a[112:115], v5 offset:1024
ds_read_b128 a[116:119], v5 offset:11264
v_mfma_f32_16x16x32_bf16 v[112:115], a[68:71], a[36:39], v[112:115]
ds_read_b128 a[20:23], v253 offset:5120
v_mfma_f32_16x16x32_bf16 v[132:135], a[68:71], a[44:47], v[132:135]
ds_read_b128 a[24:27], v253 offset:6144
v_mfma_f32_16x16x32_bf16 v[132:135], a[64:67], a[40:43], v[132:135]
ds_read_b128 a[28:31], v253 offset:7168
v_mfma_f32_16x16x32_bf16 v[152:155], a[64:67], a[48:51], v[152:155]
buffer_load_dwordx4 v13, s[4:7], s57 offen offset:3072 sc1 lds
v_mfma_f32_16x16x32_bf16 v[152:155], a[68:71], a[52:55], v[152:155]
v_mfma_f32_16x16x32_bf16 v[172:175], a[68:71], a[60:63], v[172:175]
s_add_u32 s57, s101, 7
s_and_b32 s57, s57, 15
s_xor_b32 s57, s57, s100
v_mfma_f32_16x16x32_bf16 v[172:175], a[64:67], a[56:59], v[172:175]
s_lshl_b32 s57, s57, 11
s_mul_i32 s56, s57, 40
s_add_u32 s56, s56, 65126400
v_mfma_f32_16x16x32_bf16 v[116:119], a[80:83], a[32:35], v[116:119]
s_add_u32 s57, s57, 37804032
ds_read_b128 a[64:67], v5 offset:2048
ds_read_b128 a[68:71], v5 offset:12288
v_mfma_f32_16x16x32_bf16 v[116:119], a[84:87], a[36:39], v[116:119]
s_add_u32 m0, s65, 126976
s_nop 0
buffer_load_dwordx4 v14, s[4:7], s56 offen offset:0 sc1 lds
v_mfma_f32_16x16x32_bf16 v[136:139], a[84:87], a[44:47], v[136:139]
v_mfma_f32_16x16x32_bf16 v[136:139], a[80:83], a[40:43], v[136:139]
buffer_load_dwordx4 v14, s[4:7], s56 offen offset:1024 sc1 lds
v_mfma_f32_16x16x32_bf16 v[156:159], a[80:83], a[48:51], v[156:159]
v_mfma_f32_16x16x32_bf16 v[156:159], a[84:87], a[52:55], v[156:159]
v_mfma_f32_16x16x32_bf16 v[176:179], a[84:87], a[60:63], v[176:179]
v_mfma_f32_16x16x32_bf16 v[176:179], a[80:83], a[56:59], v[176:179]
s_waitcnt lgkmcnt(2)
buffer_load_dwordx4 v14, s[4:7], s56 offen offset:2048 sc1 lds
v_mfma_f32_16x16x32_bf16 v[100:103], a[96:99], a[0:3], v[100:103]
ds_read_b128 a[80:83], v5 offset:3072
ds_read_b128 a[84:87], v5 offset:13312
v_mfma_f32_16x16x32_bf16 v[100:103], a[100:103], a[4:7], v[100:103]
buffer_load_dwordx4 v[180:183], v196, s[8:11], 0 offen
v_mfma_f32_16x16x32_bf16 v[120:123], a[100:103], a[12:15], v[120:123]
v_mfma_f32_16x16x32_bf16 v[120:123], a[96:99], a[8:11], v[120:123]
v_mfma_f32_16x16x32_bf16 v[140:143], a[96:99], a[16:19], v[140:143]
buffer_load_dwordx4 v14, s[4:7], s56 offen offset:3072 sc1 lds
v_mfma_f32_16x16x32_bf16 v[140:143], a[100:103], a[20:23], v[140:143]
v_mfma_f32_16x16x32_bf16 v[160:163], a[100:103], a[28:31], v[160:163]
buffer_load_dwordx4 v[184:187], v197, s[8:11], 0 offen
v_mfma_f32_16x16x32_bf16 v[160:163], a[96:99], a[24:27], v[160:163]
v_mfma_f32_16x16x32_bf16 v[104:107], a[112:115], a[0:3], v[104:107]
s_add_u32 m0, s65, 131072
ds_read_b128 a[96:99], v5 offset:4096
ds_read_b128 a[100:103], v5 offset:14336
v_mfma_f32_16x16x32_bf16 v[104:107], a[116:119], a[4:7], v[104:107]
buffer_load_dwordx4 v15, s[4:7], s56 offen sc1 lds
v_mfma_f32_16x16x32_bf16 v[124:127], a[116:119], a[12:15], v[124:127]
v_mfma_f32_16x16x32_bf16 v[124:127], a[112:115], a[8:11], v[124:127]
v_mfma_f32_16x16x32_bf16 v[144:147], a[112:115], a[16:19], v[144:147]
s_add_u32 m0, s86, 147456
buffer_load_dwordx4 v[188:191], v198, s[8:11], 0 offen
v_mfma_f32_16x16x32_bf16 v[144:147], a[116:119], a[20:23], v[144:147]
buffer_load_dwordx4 v12, s[4:7], s57 offen offset:0 sc1 lds
v_mfma_f32_16x16x32_bf16 v[164:167], a[116:119], a[28:31], v[164:167]
v_mfma_f32_16x16x32_bf16 v[164:167], a[112:115], a[24:27], v[164:167]
s_waitcnt lgkmcnt(2)
v_mfma_f32_16x16x32_bf16 v[108:111], a[64:67], a[0:3], v[108:111]
s_waitcnt vmcnt(18) lgkmcnt(0)
s_barrier
ds_read_b128 a[112:115], v5 offset:36864
v_mfma_f32_16x16x32_bf16 v[108:111], a[68:71], a[4:7], v[108:111]
ds_read_b128 a[116:119], v5 offset:47104
ds_read_b128 a[32:35], v253 offset:36864
v_mfma_f32_16x16x32_bf16 v[128:131], a[68:71], a[12:15], v[128:131]
ds_read_b128 a[36:39], v253 offset:37888
v_mfma_f32_16x16x32_bf16 v[128:131], a[64:67], a[8:11], v[128:131]
buffer_load_dwordx4 v12, s[4:7], s57 offen offset:1024 sc1 lds
v_mfma_f32_16x16x32_bf16 v[148:151], a[64:67], a[16:19], v[148:151]
ds_read_b128 a[40:43], v253 offset:38912
v_mfma_f32_16x16x32_bf16 v[148:151], a[68:71], a[20:23], v[148:151]
ds_read_b128 a[44:47], v253 offset:39936
v_mfma_f32_16x16x32_bf16 v[168:171], a[68:71], a[28:31], v[168:171]
buffer_load_dwordx4 v13, s[4:7], s57 offen offset:2048 sc1 lds
v_mfma_f32_16x16x32_bf16 v[168:171], a[64:67], a[24:27], v[168:171]
ds_read_b128 a[48:51], v253 offset:40960
v_mfma_f32_16x16x32_bf16 v[112:115], a[80:83], a[0:3], v[112:115]
ds_read_b128 a[64:67], v5 offset:37888
ds_read_b128 a[68:71], v5 offset:48128
v_mfma_f32_16x16x32_bf16 v[112:115], a[84:87], a[4:7], v[112:115]
ds_read_b128 a[52:55], v253 offset:41984
v_mfma_f32_16x16x32_bf16 v[132:135], a[84:87], a[12:15], v[132:135]
ds_read_b128 a[56:59], v253 offset:43008
v_mfma_f32_16x16x32_bf16 v[132:135], a[80:83], a[8:11], v[132:135]
ds_read_b128 a[60:63], v253 offset:44032
v_mfma_f32_16x16x32_bf16 v[152:155], a[80:83], a[16:19], v[152:155]
buffer_load_dwordx4 v13, s[4:7], s57 offen offset:3072 sc1 lds
v_mfma_f32_16x16x32_bf16 v[152:155], a[84:87], a[20:23], v[152:155]
v_mfma_f32_16x16x32_bf16 v[172:175], a[84:87], a[28:31], v[172:175]
s_add_u32 s57, s101, 8
s_and_b32 s57, s57, 15
s_xor_b32 s57, s57, s100
v_mfma_f32_16x16x32_bf16 v[172:175], a[80:83], a[24:27], v[172:175]
s_lshl_b32 s57, s57, 11
s_mul_i32 s56, s57, 40
s_add_u32 s56, s56, 65126400
v_mfma_f32_16x16x32_bf16 v[116:119], a[96:99], a[0:3], v[116:119]
s_add_u32 s57, s57, 37804032
ds_read_b128 a[80:83], v5 offset:38912
ds_read_b128 a[84:87], v5 offset:49152
v_mfma_f32_16x16x32_bf16 v[116:119], a[100:103], a[4:7], v[116:119]
s_add_u32 m0, s65, 16384
s_nop 0
buffer_load_dwordx4 v14, s[4:7], s56 offen offset:0 sc1 lds
v_mfma_f32_16x16x32_bf16 v[136:139], a[100:103], a[12:15], v[136:139]
buffer_load_dwordx4 v14, s[4:7], s56 offen offset:1024 sc1 lds
v_mfma_f32_16x16x32_bf16 v[136:139], a[96:99], a[8:11], v[136:139]
v_mfma_f32_16x16x32_bf16 v[156:159], a[96:99], a[16:19], v[156:159]
v_mfma_f32_16x16x32_bf16 v[156:159], a[100:103], a[20:23], v[156:159]
v_mfma_f32_16x16x32_bf16 v[176:179], a[100:103], a[28:31], v[176:179]
v_mfma_f32_16x16x32_bf16 v[176:179], a[96:99], a[24:27], v[176:179]
s_waitcnt lgkmcnt(2)
buffer_load_dwordx4 v14, s[4:7], s56 offen offset:2048 sc1 lds
v_mfma_f32_16x16x32_bf16 v[100:103], a[112:115], a[32:35], v[100:103]
ds_read_b128 a[96:99], v5 offset:39936
ds_read_b128 a[100:103], v5 offset:50176
v_mfma_f32_16x16x32_bf16 v[100:103], a[116:119], a[36:39], v[100:103]
v_mfma_f32_16x16x32_bf16 v[120:123], a[116:119], a[44:47], v[120:123]
v_mfma_f32_16x16x32_bf16 v[120:123], a[112:115], a[40:43], v[120:123]
buffer_load_dwordx4 v14, s[4:7], s56 offen offset:3072 sc1 lds
v_mfma_f32_16x16x32_bf16 v[140:143], a[112:115], a[48:51], v[140:143]
v_mfma_f32_16x16x32_bf16 v[140:143], a[116:119], a[52:55], v[140:143]
v_mfma_f32_16x16x32_bf16 v[160:163], a[116:119], a[60:63], v[160:163]
v_mfma_f32_16x16x32_bf16 v[160:163], a[112:115], a[56:59], v[160:163]
v_mfma_f32_16x16x32_bf16 v[104:107], a[64:67], a[32:35], v[104:107]
s_add_u32 m0, s65, 20480
ds_read_b128 a[112:115], v5 offset:40960
ds_read_b128 a[116:119], v5 offset:51200
v_mfma_f32_16x16x32_bf16 v[104:107], a[68:71], a[36:39], v[104:107]
buffer_load_dwordx4 v15, s[4:7], s56 offen sc1 lds
v_mfma_f32_16x16x32_bf16 v[124:127], a[68:71], a[44:47], v[124:127]
v_mfma_f32_16x16x32_bf16 v[124:127], a[64:67], a[40:43], v[124:127]
v_mfma_f32_16x16x32_bf16 v[144:147], a[64:67], a[48:51], v[144:147]
s_add_u32 m0, s86, 36864
s_nop 0
buffer_load_dwordx4 v12, s[4:7], s57 offen offset:0 sc1 lds
v_mfma_f32_16x16x32_bf16 v[144:147], a[68:71], a[52:55], v[144:147]
v_mfma_f32_16x16x32_bf16 v[164:167], a[68:71], a[60:63], v[164:167]
v_mfma_f32_16x16x32_bf16 v[164:167], a[64:67], a[56:59], v[164:167]
s_waitcnt lgkmcnt(2)
v_mfma_f32_16x16x32_bf16 v[108:111], a[80:83], a[32:35], v[108:111]
s_waitcnt vmcnt(18) lgkmcnt(0)
s_barrier
ds_read_b128 a[64:67], v6 offset:0
v_mfma_f32_16x16x32_bf16 v[108:111], a[84:87], a[36:39], v[108:111]
ds_read_b128 a[68:71], v6 offset:10240
ds_read_b128 a[0:3], v254 offset:0
v_mfma_f32_16x16x32_bf16 v[128:131], a[84:87], a[44:47], v[128:131]
ds_read_b128 a[4:7], v254 offset:1024
v_mfma_f32_16x16x32_bf16 v[128:131], a[80:83], a[40:43], v[128:131]
buffer_load_dwordx4 v12, s[4:7], s57 offen offset:1024 sc1 lds
v_mfma_f32_16x16x32_bf16 v[148:151], a[80:83], a[48:51], v[148:151]
ds_read_b128 a[8:11], v254 offset:2048
v_mfma_f32_16x16x32_bf16 v[148:151], a[84:87], a[52:55], v[148:151]
ds_read_b128 a[12:15], v254 offset:3072
v_mfma_f32_16x16x32_bf16 v[168:171], a[84:87], a[60:63], v[168:171]
buffer_load_dwordx4 v13, s[4:7], s57 offen offset:2048 sc1 lds
v_mfma_f32_16x16x32_bf16 v[168:171], a[80:83], a[56:59], v[168:171]
ds_read_b128 a[16:19], v254 offset:4096
v_mfma_f32_16x16x32_bf16 v[112:115], a[96:99], a[32:35], v[112:115]
ds_read_b128 a[80:83], v6 offset:1024
ds_read_b128 a[84:87], v6 offset:11264
v_mfma_f32_16x16x32_bf16 v[112:115], a[100:103], a[36:39], v[112:115]
ds_read_b128 a[20:23], v254 offset:5120
v_mfma_f32_16x16x32_bf16 v[132:135], a[100:103], a[44:47], v[132:135]
ds_read_b128 a[24:27], v254 offset:6144
v_mfma_f32_16x16x32_bf16 v[132:135], a[96:99], a[40:43], v[132:135]
ds_read_b128 a[28:31], v254 offset:7168
v_mfma_f32_16x16x32_bf16 v[152:155], a[96:99], a[48:51], v[152:155]
buffer_load_dwordx4 v13, s[4:7], s57 offen offset:3072 sc1 lds
v_mfma_f32_16x16x32_bf16 v[152:155], a[100:103], a[52:55], v[152:155]
v_mfma_f32_16x16x32_bf16 v[172:175], a[100:103], a[60:63], v[172:175]
s_add_u32 s57, s101, 9
s_and_b32 s57, s57, 15
s_xor_b32 s57, s57, s100
v_mfma_f32_16x16x32_bf16 v[172:175], a[96:99], a[56:59], v[172:175]
s_lshl_b32 s57, s57, 11
s_mul_i32 s56, s57, 40
s_add_u32 s56, s56, 65126400
v_mfma_f32_16x16x32_bf16 v[116:119], a[112:115], a[32:35], v[116:119]
s_add_u32 s57, s57, 37804032
ds_read_b128 a[96:99], v6 offset:2048
ds_read_b128 a[100:103], v6 offset:12288
v_mfma_f32_16x16x32_bf16 v[116:119], a[116:119], a[36:39], v[116:119]
s_add_u32 m0, s65, 53248
s_nop 0
buffer_load_dwordx4 v14, s[4:7], s56 offen offset:0 sc1 lds
v_mfma_f32_16x16x32_bf16 v[136:139], a[116:119], a[44:47], v[136:139]
buffer_load_dwordx4 v14, s[4:7], s56 offen offset:1024 sc1 lds
v_mfma_f32_16x16x32_bf16 v[136:139], a[112:115], a[40:43], v[136:139]
v_mfma_f32_16x16x32_bf16 v[156:159], a[112:115], a[48:51], v[156:159]
v_mfma_f32_16x16x32_bf16 v[156:159], a[116:119], a[52:55], v[156:159]
v_mfma_f32_16x16x32_bf16 v[176:179], a[116:119], a[60:63], v[176:179]
buffer_load_dwordx4 v14, s[4:7], s56 offen offset:2048 sc1 lds
v_mfma_f32_16x16x32_bf16 v[176:179], a[112:115], a[56:59], v[176:179]
s_waitcnt lgkmcnt(2)
v_mfma_f32_16x16x32_bf16 v[100:103], a[64:67], a[0:3], v[100:103]
ds_read_b128 a[112:115], v6 offset:3072
ds_read_b128 a[116:119], v6 offset:13312
v_mfma_f32_16x16x32_bf16 v[100:103], a[68:71], a[4:7], v[100:103]
v_mfma_f32_16x16x32_bf16 v[120:123], a[68:71], a[12:15], v[120:123]
v_mfma_f32_16x16x32_bf16 v[120:123], a[64:67], a[8:11], v[120:123]
buffer_load_dwordx4 v14, s[4:7], s56 offen offset:3072 sc1 lds
v_mfma_f32_16x16x32_bf16 v[140:143], a[64:67], a[16:19], v[140:143]
v_mfma_f32_16x16x32_bf16 v[140:143], a[68:71], a[20:23], v[140:143]
v_mfma_f32_16x16x32_bf16 v[160:163], a[68:71], a[28:31], v[160:163]
v_mfma_f32_16x16x32_bf16 v[160:163], a[64:67], a[24:27], v[160:163]
s_add_u32 m0, s65, 57344
s_nop 0
buffer_load_dwordx4 v15, s[4:7], s56 offen sc1 lds
v_mfma_f32_16x16x32_bf16 v[104:107], a[80:83], a[0:3], v[104:107]
ds_read_b128 a[64:67], v6 offset:4096
ds_read_b128 a[68:71], v6 offset:14336
v_mfma_f32_16x16x32_bf16 v[104:107], a[84:87], a[4:7], v[104:107]
v_mfma_f32_16x16x32_bf16 v[124:127], a[84:87], a[12:15], v[124:127]
v_mfma_f32_16x16x32_bf16 v[124:127], a[80:83], a[8:11], v[124:127]
v_mfma_f32_16x16x32_bf16 v[144:147], a[80:83], a[16:19], v[144:147]
s_add_u32 m0, s86, 73728
s_nop 0
buffer_load_dwordx4 v12, s[4:7], s57 offen offset:0 sc1 lds
v_mfma_f32_16x16x32_bf16 v[144:147], a[84:87], a[20:23], v[144:147]
v_mfma_f32_16x16x32_bf16 v[164:167], a[84:87], a[28:31], v[164:167]
v_mfma_f32_16x16x32_bf16 v[164:167], a[80:83], a[24:27], v[164:167]
s_waitcnt lgkmcnt(2)
v_mfma_f32_16x16x32_bf16 v[108:111], a[96:99], a[0:3], v[108:111]
s_waitcnt vmcnt(15) lgkmcnt(0)
s_barrier
ds_read_b128 a[80:83], v6 offset:36864
v_mfma_f32_16x16x32_bf16 v[108:111], a[100:103], a[4:7], v[108:111]
ds_read_b128 a[84:87], v6 offset:47104
ds_read_b128 a[32:35], v254 offset:36864
v_mfma_f32_16x16x32_bf16 v[128:131], a[100:103], a[12:15], v[128:131]
ds_read_b128 a[36:39], v254 offset:37888
v_mfma_f32_16x16x32_bf16 v[128:131], a[96:99], a[8:11], v[128:131]
buffer_load_dwordx4 v12, s[4:7], s57 offen offset:1024 sc1 lds
v_mfma_f32_16x16x32_bf16 v[148:151], a[96:99], a[16:19], v[148:151]
ds_read_b128 a[40:43], v254 offset:38912
v_mfma_f32_16x16x32_bf16 v[148:151], a[100:103], a[20:23], v[148:151]
ds_read_b128 a[44:47], v254 offset:39936
v_mfma_f32_16x16x32_bf16 v[168:171], a[100:103], a[28:31], v[168:171]
buffer_load_dwordx4 v13, s[4:7], s57 offen offset:2048 sc1 lds
v_mfma_f32_16x16x32_bf16 v[168:171], a[96:99], a[24:27], v[168:171]
ds_read_b128 a[48:51], v254 offset:40960
v_mfma_f32_16x16x32_bf16 v[112:115], a[112:115], a[0:3], v[112:115]
ds_read_b128 a[96:99], v6 offset:37888
ds_read_b128 a[100:103], v6 offset:48128
v_mfma_f32_16x16x32_bf16 v[112:115], a[116:119], a[4:7], v[112:115]
ds_read_b128 a[52:55], v254 offset:41984
v_mfma_f32_16x16x32_bf16 v[132:135], a[116:119], a[12:15], v[132:135]
ds_read_b128 a[56:59], v254 offset:43008
v_mfma_f32_16x16x32_bf16 v[132:135], a[112:115], a[8:11], v[132:135]
ds_read_b128 a[60:63], v254 offset:44032
v_mfma_f32_16x16x32_bf16 v[152:155], a[112:115], a[16:19], v[152:155]
buffer_load_dwordx4 v13, s[4:7], s57 offen offset:3072 sc1 lds
v_mfma_f32_16x16x32_bf16 v[152:155], a[116:119], a[20:23], v[152:155]
s_add_u32 s57, s101, 10
s_and_b32 s57, s57, 15
s_xor_b32 s57, s57, s100
v_mfma_f32_16x16x32_bf16 v[172:175], a[116:119], a[28:31], v[172:175]
s_lshl_b32 s57, s57, 11
s_mul_i32 s56, s57, 40
s_add_u32 s56, s56, 65126400
v_mfma_f32_16x16x32_bf16 v[172:175], a[112:115], a[24:27], v[172:175]
s_add_u32 s57, s57, 37804032
s_add_u32 m0, s65, 90112
v_mfma_f32_16x16x32_bf16 v[116:119], a[64:67], a[0:3], v[116:119]
ds_read_b128 a[112:115], v6 offset:38912
ds_read_b128 a[116:119], v6 offset:49152
v_mfma_f32_16x16x32_bf16 v[116:119], a[68:71], a[4:7], v[116:119]
buffer_load_dwordx4 v14, s[4:7], s56 offen offset:0 sc1 lds
v_mfma_f32_16x16x32_bf16 v[136:139], a[68:71], a[12:15], v[136:139]
buffer_load_dwordx4 v14, s[4:7], s56 offen offset:1024 sc1 lds
v_mfma_f32_16x16x32_bf16 v[136:139], a[64:67], a[8:11], v[136:139]
v_mfma_f32_16x16x32_bf16 v[156:159], a[64:67], a[16:19], v[156:159]
v_mfma_f32_16x16x32_bf16 v[156:159], a[68:71], a[20:23], v[156:159]
v_mfma_f32_16x16x32_bf16 v[176:179], a[68:71], a[28:31], v[176:179]
buffer_load_dwordx4 v14, s[4:7], s56 offen offset:2048 sc1 lds
v_mfma_f32_16x16x32_bf16 v[176:179], a[64:67], a[24:27], v[176:179]
s_waitcnt lgkmcnt(2)
v_mfma_f32_16x16x32_bf16 v[100:103], a[80:83], a[32:35], v[100:103]
ds_read_b128 a[64:67], v6 offset:39936
ds_read_b128 a[68:71], v6 offset:50176
v_mfma_f32_16x16x32_bf16 v[100:103], a[84:87], a[36:39], v[100:103]
v_cndmask_b32 v188, v184, v188, s[24:25]
v_cndmask_b32 v189, v185, v189, s[24:25]
v_mfma_f32_16x16x32_bf16 v[120:123], a[84:87], a[44:47], v[120:123]
buffer_load_dwordx4 v14, s[4:7], s56 offen offset:3072 sc1 lds
v_mfma_f32_16x16x32_bf16 v[120:123], a[80:83], a[40:43], v[120:123]
v_cndmask_b32 v190, v186, v190, s[24:25]
v_cndmask_b32 v191, v187, v191, s[24:25]
v_mfma_f32_16x16x32_bf16 v[140:143], a[80:83], a[48:51], v[140:143]
ds_write_b128 v193, v[180:183]
v_mfma_f32_16x16x32_bf16 v[140:143], a[84:87], a[52:55], v[140:143]
ds_write_b128 v194, v[184:187]
v_mfma_f32_16x16x32_bf16 v[160:163], a[84:87], a[60:63], v[160:163]
ds_write_b128 v200, v[188:191]
v_mfma_f32_16x16x32_bf16 v[160:163], a[80:83], a[56:59], v[160:163]
s_add_u32 m0, s65, 94208
s_nop 0
buffer_load_dwordx4 v15, s[4:7], s56 offen sc1 lds
v_mfma_f32_16x16x32_bf16 v[104:107], a[96:99], a[32:35], v[104:107]
ds_read_b128 a[80:83], v6 offset:40960
ds_read_b128 a[84:87], v6 offset:51200
v_mfma_f32_16x16x32_bf16 v[104:107], a[100:103], a[36:39], v[104:107]
ds_read_b64 v[20:21], v192 offset:0
ds_read_b64 v[22:23], v192 offset:32
v_mfma_f32_16x16x32_bf16 v[124:127], a[100:103], a[44:47], v[124:127]
ds_read_b64 v[24:25], v192 offset:64
ds_read_b64 v[26:27], v192 offset:96
v_mfma_f32_16x16x32_bf16 v[124:127], a[96:99], a[40:43], v[124:127]
s_add_u32 m0, s86, 110592
s_nop 0
buffer_load_dwordx4 v12, s[4:7], s57 offen offset:0 sc1 lds
v_mfma_f32_16x16x32_bf16 v[144:147], a[96:99], a[48:51], v[144:147]
ds_read_b64 v[28:29], v192 offset:128
v_mfma_f32_16x16x32_bf16 v[144:147], a[100:103], a[52:55], v[144:147]
v_mfma_f32_16x16x32_bf16 v[164:167], a[100:103], a[60:63], v[164:167]
v_mfma_f32_16x16x32_bf16 v[164:167], a[96:99], a[56:59], v[164:167]
s_waitcnt lgkmcnt(7)
v_mfma_f32_16x16x32_bf16 v[108:111], a[112:115], a[32:35], v[108:111]
s_waitcnt vmcnt(15) lgkmcnt(0)
s_barrier
ds_read_b128 a[96:99], v5 offset:0
v_mfma_f32_16x16x32_bf16 v[108:111], a[116:119], a[36:39], v[108:111]
ds_read_b128 a[100:103], v5 offset:10240
ds_read_b128 a[0:3], v253 offset:0
v_mfma_f32_16x16x32_bf16 v[128:131], a[116:119], a[44:47], v[128:131]
ds_read_b128 a[4:7], v253 offset:1024
v_mfma_f32_16x16x32_bf16 v[128:131], a[112:115], a[40:43], v[128:131]
buffer_load_dwordx4 v12, s[4:7], s57 offen offset:1024 sc1 lds
v_mfma_f32_16x16x32_bf16 v[148:151], a[112:115], a[48:51], v[148:151]
ds_read_b128 a[8:11], v253 offset:2048
v_mfma_f32_16x16x32_bf16 v[148:151], a[116:119], a[52:55], v[148:151]
ds_read_b128 a[12:15], v253 offset:3072
v_mfma_f32_16x16x32_bf16 v[168:171], a[116:119], a[60:63], v[168:171]
buffer_load_dwordx4 v13, s[4:7], s57 offen offset:2048 sc1 lds
v_mfma_f32_16x16x32_bf16 v[168:171], a[112:115], a[56:59], v[168:171]
ds_read_b128 a[16:19], v253 offset:4096
v_mfma_f32_16x16x32_bf16 v[112:115], a[64:67], a[32:35], v[112:115]
ds_read_b128 a[112:115], v5 offset:1024
ds_read_b128 a[116:119], v5 offset:11264
v_mfma_f32_16x16x32_bf16 v[112:115], a[68:71], a[36:39], v[112:115]
ds_read_b128 a[20:23], v253 offset:5120
v_mfma_f32_16x16x32_bf16 v[132:135], a[68:71], a[44:47], v[132:135]
ds_read_b128 a[24:27], v253 offset:6144
v_mfma_f32_16x16x32_bf16 v[132:135], a[64:67], a[40:43], v[132:135]
ds_read_b128 a[28:31], v253 offset:7168
v_mfma_f32_16x16x32_bf16 v[152:155], a[64:67], a[48:51], v[152:155]
buffer_load_dwordx4 v13, s[4:7], s57 offen offset:3072 sc1 lds
v_mfma_f32_16x16x32_bf16 v[152:155], a[68:71], a[52:55], v[152:155]
s_add_u32 s57, s101, 11
s_and_b32 s57, s57, 15
s_xor_b32 s57, s57, s100
v_mfma_f32_16x16x32_bf16 v[172:175], a[68:71], a[60:63], v[172:175]
s_lshl_b32 s57, s57, 11
s_mul_i32 s56, s57, 40
s_add_u32 s56, s56, 65126400
v_mfma_f32_16x16x32_bf16 v[172:175], a[64:67], a[56:59], v[172:175]
s_add_u32 s57, s57, 37804032
s_add_u32 m0, s65, 126976
v_mfma_f32_16x16x32_bf16 v[116:119], a[80:83], a[32:35], v[116:119]
ds_read_b128 a[64:67], v5 offset:2048
ds_read_b128 a[68:71], v5 offset:12288
v_mfma_f32_16x16x32_bf16 v[116:119], a[84:87], a[36:39], v[116:119]
buffer_load_dwordx4 v14, s[4:7], s56 offen offset:0 sc1 lds
v_mfma_f32_16x16x32_bf16 v[136:139], a[84:87], a[44:47], v[136:139]
buffer_load_dwordx4 v14, s[4:7], s56 offen offset:1024 sc1 lds
v_mfma_f32_16x16x32_bf16 v[136:139], a[80:83], a[40:43], v[136:139]
v_mfma_f32_16x16x32_bf16 v[156:159], a[80:83], a[48:51], v[156:159]
v_mfma_f32_16x16x32_bf16 v[156:159], a[84:87], a[52:55], v[156:159]
v_mfma_f32_16x16x32_bf16 v[176:179], a[84:87], a[60:63], v[176:179]
buffer_load_dwordx4 v14, s[4:7], s56 offen offset:2048 sc1 lds
v_mfma_f32_16x16x32_bf16 v[176:179], a[80:83], a[56:59], v[176:179]
s_waitcnt lgkmcnt(2)
v_mfma_f32_16x16x32_bf16 v[100:103], a[96:99], a[0:3], v[100:103]
ds_read_b128 a[80:83], v5 offset:3072
ds_read_b128 a[84:87], v5 offset:13312
v_mfma_f32_16x16x32_bf16 v[100:103], a[100:103], a[4:7], v[100:103]
v_mfma_f32_16x16x32_bf16 v[120:123], a[100:103], a[12:15], v[120:123]
buffer_load_dwordx4 v14, s[4:7], s56 offen offset:3072 sc1 lds
v_mfma_f32_16x16x32_bf16 v[120:123], a[96:99], a[8:11], v[120:123]
v_mfma_f32_16x16x32_bf16 v[140:143], a[96:99], a[16:19], v[140:143]
v_mfma_f32_16x16x32_bf16 v[140:143], a[100:103], a[20:23], v[140:143]
v_mfma_f32_16x16x32_bf16 v[160:163], a[100:103], a[28:31], v[160:163]
s_add_u32 m0, s65, 131072
s_nop 0
buffer_load_dwordx4 v15, s[4:7], s56 offen sc1 lds
v_mfma_f32_16x16x32_bf16 v[160:163], a[96:99], a[24:27], v[160:163]
v_mfma_f32_16x16x32_bf16 v[104:107], a[112:115], a[0:3], v[104:107]
ds_read_b128 a[96:99], v5 offset:4096
ds_read_b128 a[100:103], v5 offset:14336
v_mfma_f32_16x16x32_bf16 v[104:107], a[116:119], a[4:7], v[104:107]
v_mfma_f32_16x16x32_bf16 v[124:127], a[116:119], a[12:15], v[124:127]
v_mfma_f32_16x16x32_bf16 v[124:127], a[112:115], a[8:11], v[124:127]
s_add_u32 m0, s86, 147456
s_nop 0
buffer_load_dwordx4 v12, s[4:7], s57 offen offset:0 sc1 lds
v_mfma_f32_16x16x32_bf16 v[144:147], a[112:115], a[16:19], v[144:147]
v_mfma_f32_16x16x32_bf16 v[144:147], a[116:119], a[20:23], v[144:147]
v_mfma_f32_16x16x32_bf16 v[164:167], a[116:119], a[28:31], v[164:167]
v_mfma_f32_16x16x32_bf16 v[164:167], a[112:115], a[24:27], v[164:167]
s_waitcnt lgkmcnt(2)
buffer_load_dwordx4 v12, s[4:7], s57 offen offset:1024 sc1 lds
v_mfma_f32_16x16x32_bf16 v[108:111], a[64:67], a[0:3], v[108:111]
s_waitcnt vmcnt(16) lgkmcnt(0)
s_barrier
ds_read_b128 a[112:115], v5 offset:36864
v_mfma_f32_16x16x32_bf16 v[108:111], a[68:71], a[4:7], v[108:111]
ds_read_b128 a[116:119], v5 offset:47104
ds_read_b128 a[32:35], v253 offset:36864
v_mfma_f32_16x16x32_bf16 v[128:131], a[68:71], a[12:15], v[128:131]
ds_read_b128 a[36:39], v253 offset:37888
v_mfma_f32_16x16x32_bf16 v[128:131], a[64:67], a[8:11], v[128:131]
v_mfma_f32_16x16x32_bf16 v[148:151], a[64:67], a[16:19], v[148:151]
ds_read_b128 a[40:43], v253 offset:38912
v_mfma_f32_16x16x32_bf16 v[148:151], a[68:71], a[20:23], v[148:151]
ds_read_b128 a[44:47], v253 offset:39936
v_mfma_f32_16x16x32_bf16 v[168:171], a[68:71], a[28:31], v[168:171]
buffer_load_dwordx4 v13, s[4:7], s57 offen offset:2048 sc1 lds
v_mfma_f32_16x16x32_bf16 v[168:171], a[64:67], a[24:27], v[168:171]
ds_read_b128 a[48:51], v253 offset:40960
v_mfma_f32_16x16x32_bf16 v[112:115], a[80:83], a[0:3], v[112:115]
ds_read_b128 a[64:67], v5 offset:37888
ds_read_b128 a[68:71], v5 offset:48128
v_mfma_f32_16x16x32_bf16 v[112:115], a[84:87], a[4:7], v[112:115]
ds_read_b128 a[52:55], v253 offset:41984
v_mfma_f32_16x16x32_bf16 v[132:135], a[84:87], a[12:15], v[132:135]
ds_read_b128 a[56:59], v253 offset:43008
v_mfma_f32_16x16x32_bf16 v[132:135], a[80:83], a[8:11], v[132:135]
ds_read_b128 a[60:63], v253 offset:44032
v_mfma_f32_16x16x32_bf16 v[152:155], a[80:83], a[16:19], v[152:155]
buffer_load_dwordx4 v13, s[4:7], s57 offen offset:3072 sc1 lds
v_mfma_f32_16x16x32_bf16 v[152:155], a[84:87], a[20:23], v[152:155]
s_add_u32 s57, s101, 12
s_and_b32 s57, s57, 15
s_xor_b32 s57, s57, s100
v_mfma_f32_16x16x32_bf16 v[172:175], a[84:87], a[28:31], v[172:175]
s_lshl_b32 s57, s57, 11
s_mul_i32 s56, s57, 40
s_add_u32 s56, s56, 65126400
v_mfma_f32_16x16x32_bf16 v[172:175], a[80:83], a[24:27], v[172:175]
s_add_u32 s57, s57, 37804032
s_add_u32 m0, s65, 16384
v_mfma_f32_16x16x32_bf16 v[116:119], a[96:99], a[0:3], v[116:119]
ds_read_b128 a[80:83], v5 offset:38912
ds_read_b128 a[84:87], v5 offset:49152
v_mfma_f32_16x16x32_bf16 v[116:119], a[100:103], a[4:7], v[116:119]
buffer_load_dwordx4 v14, s[4:7], s56 offen offset:0 sc1 lds
v_mfma_f32_16x16x32_bf16 v[136:139], a[100:103], a[12:15], v[136:139]
buffer_load_dwordx4 v14, s[4:7], s56 offen offset:1024 sc1 lds
v_mfma_f32_16x16x32_bf16 v[136:139], a[96:99], a[8:11], v[136:139]
v_mfma_f32_16x16x32_bf16 v[156:159], a[96:99], a[16:19], v[156:159]
v_mfma_f32_16x16x32_bf16 v[156:159], a[100:103], a[20:23], v[156:159]
buffer_load_dwordx4 v14, s[4:7], s56 offen offset:2048 sc1 lds
v_mfma_f32_16x16x32_bf16 v[176:179], a[100:103], a[28:31], v[176:179]
v_mfma_f32_16x16x32_bf16 v[176:179], a[96:99], a[24:27], v[176:179]
s_waitcnt lgkmcnt(2)
v_mfma_f32_16x16x32_bf16 v[100:103], a[112:115], a[32:35], v[100:103]
ds_read_b128 a[96:99], v5 offset:39936
ds_read_b128 a[100:103], v5 offset:50176
v_mfma_f32_16x16x32_bf16 v[100:103], a[116:119], a[36:39], v[100:103]
v_mfma_f32_16x16x32_bf16 v[120:123], a[116:119], a[44:47], v[120:123]
buffer_load_dwordx4 v14, s[4:7], s56 offen offset:3072 sc1 lds
v_mfma_f32_16x16x32_bf16 v[120:123], a[112:115], a[40:43], v[120:123]
v_mfma_f32_16x16x32_bf16 v[140:143], a[112:115], a[48:51], v[140:143]
v_mfma_f32_16x16x32_bf16 v[140:143], a[116:119], a[52:55], v[140:143]
v_mfma_f32_16x16x32_bf16 v[160:163], a[116:119], a[60:63], v[160:163]
s_add_u32 m0, s65, 20480
s_nop 0
buffer_load_dwordx4 v15, s[4:7], s56 offen sc1 lds
v_mfma_f32_16x16x32_bf16 v[160:163], a[112:115], a[56:59], v[160:163]
v_mfma_f32_16x16x32_bf16 v[104:107], a[64:67], a[32:35], v[104:107]
ds_read_b128 a[112:115], v5 offset:40960
ds_read_b128 a[116:119], v5 offset:51200
v_mfma_f32_16x16x32_bf16 v[104:107], a[68:71], a[36:39], v[104:107]
v_mfma_f32_16x16x32_bf16 v[124:127], a[68:71], a[44:47], v[124:127]
s_add_u32 m0, s86, 36864
s_nop 0
buffer_load_dwordx4 v12, s[4:7], s57 offen offset:0 sc1 lds
v_mfma_f32_16x16x32_bf16 v[124:127], a[64:67], a[40:43], v[124:127]
v_mfma_f32_16x16x32_bf16 v[144:147], a[64:67], a[48:51], v[144:147]
v_mfma_f32_16x16x32_bf16 v[144:147], a[68:71], a[52:55], v[144:147]
v_mfma_f32_16x16x32_bf16 v[164:167], a[68:71], a[60:63], v[164:167]
v_mfma_f32_16x16x32_bf16 v[164:167], a[64:67], a[56:59], v[164:167]
s_waitcnt lgkmcnt(2)
buffer_load_dwordx4 v12, s[4:7], s57 offen offset:1024 sc1 lds
v_mfma_f32_16x16x32_bf16 v[108:111], a[80:83], a[32:35], v[108:111]
s_waitcnt vmcnt(16) lgkmcnt(0)
s_barrier
ds_read_b128 a[64:67], v6 offset:0
v_mfma_f32_16x16x32_bf16 v[108:111], a[84:87], a[36:39], v[108:111]
ds_read_b128 a[68:71], v6 offset:10240
ds_read_b128 a[0:3], v254 offset:0
v_mfma_f32_16x16x32_bf16 v[128:131], a[84:87], a[44:47], v[128:131]
ds_read_b128 a[4:7], v254 offset:1024
v_mfma_f32_16x16x32_bf16 v[128:131], a[80:83], a[40:43], v[128:131]
buffer_load_dwordx4 v13, s[4:7], s57 offen offset:2048 sc1 lds
v_mfma_f32_16x16x32_bf16 v[148:151], a[80:83], a[48:51], v[148:151]
ds_read_b128 a[8:11], v254 offset:2048
v_mfma_f32_16x16x32_bf16 v[148:151], a[84:87], a[52:55], v[148:151]
ds_read_b128 a[12:15], v254 offset:3072
v_mfma_f32_16x16x32_bf16 v[168:171], a[84:87], a[60:63], v[168:171]
v_mfma_f32_16x16x32_bf16 v[168:171], a[80:83], a[56:59], v[168:171]
ds_read_b128 a[16:19], v254 offset:4096
v_mfma_f32_16x16x32_bf16 v[112:115], a[96:99], a[32:35], v[112:115]
ds_read_b128 a[80:83], v6 offset:1024
ds_read_b128 a[84:87], v6 offset:11264
v_mfma_f32_16x16x32_bf16 v[112:115], a[100:103], a[36:39], v[112:115]
ds_read_b128 a[20:23], v254 offset:5120
v_mfma_f32_16x16x32_bf16 v[132:135], a[100:103], a[44:47], v[132:135]
ds_read_b128 a[24:27], v254 offset:6144
v_mfma_f32_16x16x32_bf16 v[132:135], a[96:99], a[40:43], v[132:135]
ds_read_b128 a[28:31], v254 offset:7168
v_mfma_f32_16x16x32_bf16 v[152:155], a[96:99], a[48:51], v[152:155]
buffer_load_dwordx4 v13, s[4:7], s57 offen offset:3072 sc1 lds
v_mfma_f32_16x16x32_bf16 v[152:155], a[100:103], a[52:55], v[152:155]
s_add_u32 s57, s101, 13
s_and_b32 s57, s57, 15
s_xor_b32 s57, s57, s100
v_mfma_f32_16x16x32_bf16 v[172:175], a[100:103], a[60:63], v[172:175]
s_lshl_b32 s57, s57, 11
s_mul_i32 s56, s57, 40
s_add_u32 s56, s56, 65126400
v_mfma_f32_16x16x32_bf16 v[172:175], a[96:99], a[56:59], v[172:175]
s_add_u32 s57, s57, 37804032
s_add_u32 m0, s65, 53248
v_mfma_f32_16x16x32_bf16 v[116:119], a[112:115], a[32:35], v[116:119]
ds_read_b128 a[96:99], v6 offset:2048
ds_read_b128 a[100:103], v6 offset:12288
v_mfma_f32_16x16x32_bf16 v[116:119], a[116:119], a[36:39], v[116:119]
buffer_load_dwordx4 v14, s[4:7], s56 offen offset:0 sc1 lds
v_mfma_f32_16x16x32_bf16 v[136:139], a[116:119], a[44:47], v[136:139]
buffer_load_dwordx4 v14, s[4:7], s56 offen offset:1024 sc1 lds
v_mfma_f32_16x16x32_bf16 v[136:139], a[112:115], a[40:43], v[136:139]
v_mfma_f32_16x16x32_bf16 v[156:159], a[112:115], a[48:51], v[156:159]
v_mfma_f32_16x16x32_bf16 v[156:159], a[116:119], a[52:55], v[156:159]
buffer_load_dwordx4 v14, s[4:7], s56 offen offset:2048 sc1 lds
v_mfma_f32_16x16x32_bf16 v[176:179], a[116:119], a[60:63], v[176:179]
v_mfma_f32_16x16x32_bf16 v[176:179], a[112:115], a[56:59], v[176:179]
s_waitcnt lgkmcnt(2)
v_mfma_f32_16x16x32_bf16 v[100:103], a[64:67], a[0:3], v[100:103]
ds_read_b128 a[112:115], v6 offset:3072
ds_read_b128 a[116:119], v6 offset:13312
v_mfma_f32_16x16x32_bf16 v[100:103], a[68:71], a[4:7], v[100:103]
buffer_load_dwordx4 v14, s[4:7], s56 offen offset:3072 sc1 lds
v_mfma_f32_16x16x32_bf16 v[120:123], a[68:71], a[12:15], v[120:123]
v_mfma_f32_16x16x32_bf16 v[120:123], a[64:67], a[8:11], v[120:123]
v_mfma_f32_16x16x32_bf16 v[140:143], a[64:67], a[16:19], v[140:143]
v_mfma_f32_16x16x32_bf16 v[140:143], a[68:71], a[20:23], v[140:143]
v_mfma_f32_16x16x32_bf16 v[160:163], a[68:71], a[28:31], v[160:163]
s_add_u32 m0, s65, 57344
s_nop 0
buffer_load_dwordx4 v15, s[4:7], s56 offen sc1 lds
v_mfma_f32_16x16x32_bf16 v[160:163], a[64:67], a[24:27], v[160:163]
v_mfma_f32_16x16x32_bf16 v[104:107], a[80:83], a[0:3], v[104:107]
ds_read_b128 a[64:67], v6 offset:4096
ds_read_b128 a[68:71], v6 offset:14336
v_mfma_f32_16x16x32_bf16 v[104:107], a[84:87], a[4:7], v[104:107]
v_mfma_f32_16x16x32_bf16 v[124:127], a[84:87], a[12:15], v[124:127]
s_add_u32 m0, s86, 73728
s_nop 0
buffer_load_dwordx4 v12, s[4:7], s57 offen offset:0 sc1 lds
v_mfma_f32_16x16x32_bf16 v[124:127], a[80:83], a[8:11], v[124:127]
v_mfma_f32_16x16x32_bf16 v[144:147], a[80:83], a[16:19], v[144:147]
v_mfma_f32_16x16x32_bf16 v[144:147], a[84:87], a[20:23], v[144:147]
v_mfma_f32_16x16x32_bf16 v[164:167], a[84:87], a[28:31], v[164:167]
buffer_load_dwordx4 v12, s[4:7], s57 offen offset:1024 sc1 lds
v_mfma_f32_16x16x32_bf16 v[164:167], a[80:83], a[24:27], v[164:167]
s_waitcnt lgkmcnt(2)
v_mfma_f32_16x16x32_bf16 v[108:111], a[96:99], a[0:3], v[108:111]
s_waitcnt vmcnt(16) lgkmcnt(0)
s_barrier
ds_read_b128 a[80:83], v6 offset:36864
v_mfma_f32_16x16x32_bf16 v[108:111], a[100:103], a[4:7], v[108:111]
ds_read_b128 a[84:87], v6 offset:47104
ds_read_b128 a[32:35], v254 offset:36864
v_mfma_f32_16x16x32_bf16 v[128:131], a[100:103], a[12:15], v[128:131]
ds_read_b128 a[36:39], v254 offset:37888
v_mfma_f32_16x16x32_bf16 v[128:131], a[96:99], a[8:11], v[128:131]
buffer_load_dwordx4 v13, s[4:7], s57 offen offset:2048 sc1 lds
v_mfma_f32_16x16x32_bf16 v[148:151], a[96:99], a[16:19], v[148:151]
ds_read_b128 a[40:43], v254 offset:38912
v_mfma_f32_16x16x32_bf16 v[148:151], a[100:103], a[20:23], v[148:151]
ds_read_b128 a[44:47], v254 offset:39936
v_mfma_f32_16x16x32_bf16 v[168:171], a[100:103], a[28:31], v[168:171]
v_mfma_f32_16x16x32_bf16 v[168:171], a[96:99], a[24:27], v[168:171]
ds_read_b128 a[48:51], v254 offset:40960
v_mfma_f32_16x16x32_bf16 v[112:115], a[112:115], a[0:3], v[112:115]
ds_read_b128 a[96:99], v6 offset:37888
ds_read_b128 a[100:103], v6 offset:48128
v_mfma_f32_16x16x32_bf16 v[112:115], a[116:119], a[4:7], v[112:115]
ds_read_b128 a[52:55], v254 offset:41984
v_mfma_f32_16x16x32_bf16 v[132:135], a[116:119], a[12:15], v[132:135]
ds_read_b128 a[56:59], v254 offset:43008
v_mfma_f32_16x16x32_bf16 v[132:135], a[112:115], a[8:11], v[132:135]
ds_read_b128 a[60:63], v254 offset:44032
v_mfma_f32_16x16x32_bf16 v[152:155], a[112:115], a[16:19], v[152:155]
buffer_load_dwordx4 v13, s[4:7], s57 offen offset:3072 sc1 lds
v_mfma_f32_16x16x32_bf16 v[152:155], a[116:119], a[20:23], v[152:155]
s_add_u32 s57, s101, 14
s_and_b32 s57, s57, 15
s_xor_b32 s57, s57, s100
v_mfma_f32_16x16x32_bf16 v[172:175], a[116:119], a[28:31], v[172:175]
s_lshl_b32 s57, s57, 11
s_mul_i32 s56, s57, 40
s_add_u32 s56, s56, 65126400
v_mfma_f32_16x16x32_bf16 v[172:175], a[112:115], a[24:27], v[172:175]
s_add_u32 s57, s57, 37804032
s_add_u32 m0, s65, 90112
v_mfma_f32_16x16x32_bf16 v[116:119], a[64:67], a[0:3], v[116:119]
ds_read_b128 a[112:115], v6 offset:38912
ds_read_b128 a[116:119], v6 offset:49152
v_mfma_f32_16x16x32_bf16 v[116:119], a[68:71], a[4:7], v[116:119]
buffer_load_dwordx4 v14, s[4:7], s56 offen offset:0 sc1 lds
v_mfma_f32_16x16x32_bf16 v[136:139], a[68:71], a[12:15], v[136:139]
buffer_load_dwordx4 v14, s[4:7], s56 offen offset:1024 sc1 lds
v_mfma_f32_16x16x32_bf16 v[136:139], a[64:67], a[8:11], v[136:139]
v_mfma_f32_16x16x32_bf16 v[156:159], a[64:67], a[16:19], v[156:159]
buffer_load_dwordx4 v14, s[4:7], s56 offen offset:2048 sc1 lds
v_mfma_f32_16x16x32_bf16 v[156:159], a[68:71], a[20:23], v[156:159]
v_mfma_f32_16x16x32_bf16 v[176:179], a[68:71], a[28:31], v[176:179]
v_mfma_f32_16x16x32_bf16 v[176:179], a[64:67], a[24:27], v[176:179]
s_waitcnt lgkmcnt(2)
v_mfma_f32_16x16x32_bf16 v[100:103], a[80:83], a[32:35], v[100:103]
ds_read_b128 a[64:67], v6 offset:39936
ds_read_b128 a[68:71], v6 offset:50176
v_mfma_f32_16x16x32_bf16 v[100:103], a[84:87], a[36:39], v[100:103]
buffer_load_dwordx4 v14, s[4:7], s56 offen offset:3072 sc1 lds
v_mfma_f32_16x16x32_bf16 v[120:123], a[84:87], a[44:47], v[120:123]
v_mfma_f32_16x16x32_bf16 v[120:123], a[80:83], a[40:43], v[120:123]
v_mfma_f32_16x16x32_bf16 v[140:143], a[80:83], a[48:51], v[140:143]
v_mfma_f32_16x16x32_bf16 v[140:143], a[84:87], a[52:55], v[140:143]
s_add_u32 m0, s65, 94208
s_nop 0
buffer_load_dwordx4 v15, s[4:7], s56 offen sc1 lds
v_mfma_f32_16x16x32_bf16 v[160:163], a[84:87], a[60:63], v[160:163]
v_mfma_f32_16x16x32_bf16 v[160:163], a[80:83], a[56:59], v[160:163]
v_mfma_f32_16x16x32_bf16 v[104:107], a[96:99], a[32:35], v[104:107]
ds_read_b128 a[80:83], v6 offset:40960
ds_read_b128 a[84:87], v6 offset:51200
v_mfma_f32_16x16x32_bf16 v[104:107], a[100:103], a[36:39], v[104:107]
v_mfma_f32_16x16x32_bf16 v[124:127], a[100:103], a[44:47], v[124:127]
s_add_u32 m0, s86, 110592
s_nop 0
buffer_load_dwordx4 v12, s[4:7], s57 offen offset:0 sc1 lds
v_mfma_f32_16x16x32_bf16 v[124:127], a[96:99], a[40:43], v[124:127]
v_mfma_f32_16x16x32_bf16 v[144:147], a[96:99], a[48:51], v[144:147]
v_mfma_f32_16x16x32_bf16 v[144:147], a[100:103], a[52:55], v[144:147]
v_mfma_f32_16x16x32_bf16 v[164:167], a[100:103], a[60:63], v[164:167]
buffer_load_dwordx4 v12, s[4:7], s57 offen offset:1024 sc1 lds
v_mfma_f32_16x16x32_bf16 v[164:167], a[96:99], a[56:59], v[164:167]
s_waitcnt lgkmcnt(2)
v_mfma_f32_16x16x32_bf16 v[108:111], a[112:115], a[32:35], v[108:111]
s_waitcnt vmcnt(16) lgkmcnt(0)
s_barrier
ds_read_b128 a[96:99], v5 offset:0
v_mfma_f32_16x16x32_bf16 v[108:111], a[116:119], a[36:39], v[108:111]
ds_read_b128 a[100:103], v5 offset:10240
ds_read_b128 a[0:3], v253 offset:0
v_mfma_f32_16x16x32_bf16 v[128:131], a[116:119], a[44:47], v[128:131]
ds_read_b128 a[4:7], v253 offset:1024
v_mfma_f32_16x16x32_bf16 v[128:131], a[112:115], a[40:43], v[128:131]
buffer_load_dwordx4 v13, s[4:7], s57 offen offset:2048 sc1 lds
v_mfma_f32_16x16x32_bf16 v[148:151], a[112:115], a[48:51], v[148:151]
ds_read_b128 a[8:11], v253 offset:2048
v_mfma_f32_16x16x32_bf16 v[148:151], a[116:119], a[52:55], v[148:151]
ds_read_b128 a[12:15], v253 offset:3072
v_mfma_f32_16x16x32_bf16 v[168:171], a[116:119], a[60:63], v[168:171]
v_mfma_f32_16x16x32_bf16 v[168:171], a[112:115], a[56:59], v[168:171]
ds_read_b128 a[16:19], v253 offset:4096
v_mfma_f32_16x16x32_bf16 v[112:115], a[64:67], a[32:35], v[112:115]
ds_read_b128 a[112:115], v5 offset:1024
ds_read_b128 a[116:119], v5 offset:11264
v_mfma_f32_16x16x32_bf16 v[112:115], a[68:71], a[36:39], v[112:115]
ds_read_b128 a[20:23], v253 offset:5120
v_mfma_f32_16x16x32_bf16 v[132:135], a[68:71], a[44:47], v[132:135]
ds_read_b128 a[24:27], v253 offset:6144
v_mfma_f32_16x16x32_bf16 v[132:135], a[64:67], a[40:43], v[132:135]
ds_read_b128 a[28:31], v253 offset:7168
v_mfma_f32_16x16x32_bf16 v[152:155], a[64:67], a[48:51], v[152:155]
buffer_load_dwordx4 v13, s[4:7], s57 offen offset:3072 sc1 lds
v_mfma_f32_16x16x32_bf16 v[152:155], a[68:71], a[52:55], v[152:155]
s_add_u32 s57, s101, 15
s_and_b32 s57, s57, 15
s_xor_b32 s57, s57, s100
v_mfma_f32_16x16x32_bf16 v[172:175], a[68:71], a[60:63], v[172:175]
s_lshl_b32 s57, s57, 11
s_mul_i32 s56, s57, 40
s_add_u32 s56, s56, 65126400
v_mfma_f32_16x16x32_bf16 v[172:175], a[64:67], a[56:59], v[172:175]
s_add_u32 s57, s57, 37804032
s_add_u32 m0, s65, 126976
v_mfma_f32_16x16x32_bf16 v[116:119], a[80:83], a[32:35], v[116:119]
ds_read_b128 a[64:67], v5 offset:2048
ds_read_b128 a[68:71], v5 offset:12288
v_mfma_f32_16x16x32_bf16 v[116:119], a[84:87], a[36:39], v[116:119]
buffer_load_dwordx4 v14, s[4:7], s56 offen offset:0 sc1 lds
v_mfma_f32_16x16x32_bf16 v[136:139], a[84:87], a[44:47], v[136:139]
buffer_load_dwordx4 v14, s[4:7], s56 offen offset:1024 sc1 lds
v_mfma_f32_16x16x32_bf16 v[136:139], a[80:83], a[40:43], v[136:139]
v_mfma_f32_16x16x32_bf16 v[156:159], a[80:83], a[48:51], v[156:159]
buffer_load_dwordx4 v14, s[4:7], s56 offen offset:2048 sc1 lds
v_mfma_f32_16x16x32_bf16 v[156:159], a[84:87], a[52:55], v[156:159]
v_mfma_f32_16x16x32_bf16 v[176:179], a[84:87], a[60:63], v[176:179]
v_mfma_f32_16x16x32_bf16 v[176:179], a[80:83], a[56:59], v[176:179]
s_waitcnt lgkmcnt(2)
v_mfma_f32_16x16x32_bf16 v[100:103], a[96:99], a[0:3], v[100:103]
ds_read_b128 a[80:83], v5 offset:3072
ds_read_b128 a[84:87], v5 offset:13312
v_mfma_f32_16x16x32_bf16 v[100:103], a[100:103], a[4:7], v[100:103]
buffer_load_dwordx4 v14, s[4:7], s56 offen offset:3072 sc1 lds
v_mfma_f32_16x16x32_bf16 v[120:123], a[100:103], a[12:15], v[120:123]
v_mfma_f32_16x16x32_bf16 v[120:123], a[96:99], a[8:11], v[120:123]
v_mfma_f32_16x16x32_bf16 v[140:143], a[96:99], a[16:19], v[140:143]
v_mfma_f32_16x16x32_bf16 v[140:143], a[100:103], a[20:23], v[140:143]
s_add_u32 m0, s65, 131072
s_nop 0
buffer_load_dwordx4 v15, s[4:7], s56 offen sc1 lds
v_mfma_f32_16x16x32_bf16 v[160:163], a[100:103], a[28:31], v[160:163]
v_mfma_f32_16x16x32_bf16 v[160:163], a[96:99], a[24:27], v[160:163]
v_mfma_f32_16x16x32_bf16 v[104:107], a[112:115], a[0:3], v[104:107]
ds_read_b128 a[96:99], v5 offset:4096
ds_read_b128 a[100:103], v5 offset:14336
v_mfma_f32_16x16x32_bf16 v[104:107], a[116:119], a[4:7], v[104:107]
s_add_u32 m0, s86, 147456
s_nop 0
buffer_load_dwordx4 v12, s[4:7], s57 offen offset:0 sc1 lds
v_mfma_f32_16x16x32_bf16 v[124:127], a[116:119], a[12:15], v[124:127]
v_mfma_f32_16x16x32_bf16 v[124:127], a[112:115], a[8:11], v[124:127]
v_mfma_f32_16x16x32_bf16 v[144:147], a[112:115], a[16:19], v[144:147]
v_mfma_f32_16x16x32_bf16 v[144:147], a[116:119], a[20:23], v[144:147]
v_mfma_f32_16x16x32_bf16 v[164:167], a[116:119], a[28:31], v[164:167]
buffer_load_dwordx4 v12, s[4:7], s57 offen offset:1024 sc1 lds
v_mfma_f32_16x16x32_bf16 v[164:167], a[112:115], a[24:27], v[164:167]
s_waitcnt lgkmcnt(2)
v_mfma_f32_16x16x32_bf16 v[108:111], a[64:67], a[0:3], v[108:111]
s_waitcnt vmcnt(16) lgkmcnt(0)
s_barrier
ds_read_b128 a[112:115], v5 offset:36864
v_mfma_f32_16x16x32_bf16 v[108:111], a[68:71], a[4:7], v[108:111]
ds_read_b128 a[116:119], v5 offset:47104
ds_read_b128 a[32:35], v253 offset:36864
v_mfma_f32_16x16x32_bf16 v[128:131], a[68:71], a[12:15], v[128:131]
ds_read_b128 a[36:39], v253 offset:37888
v_mfma_f32_16x16x32_bf16 v[128:131], a[64:67], a[8:11], v[128:131]
buffer_load_dwordx4 v13, s[4:7], s57 offen offset:2048 sc1 lds
v_mfma_f32_16x16x32_bf16 v[148:151], a[64:67], a[16:19], v[148:151]
ds_read_b128 a[40:43], v253 offset:38912
v_mfma_f32_16x16x32_bf16 v[148:151], a[68:71], a[20:23], v[148:151]
ds_read_b128 a[44:47], v253 offset:39936
v_mfma_f32_16x16x32_bf16 v[168:171], a[68:71], a[28:31], v[168:171]
buffer_load_dwordx4 v13, s[4:7], s57 offen offset:3072 sc1 lds
v_mfma_f32_16x16x32_bf16 v[168:171], a[64:67], a[24:27], v[168:171]
ds_read_b128 a[48:51], v253 offset:40960
v_mfma_f32_16x16x32_bf16 v[112:115], a[80:83], a[0:3], v[112:115]
ds_read_b128 a[64:67], v5 offset:37888
ds_read_b128 a[68:71], v5 offset:48128
v_mfma_f32_16x16x32_bf16 v[112:115], a[84:87], a[4:7], v[112:115]
ds_read_b128 a[52:55], v253 offset:41984
v_mfma_f32_16x16x32_bf16 v[132:135], a[84:87], a[12:15], v[132:135]
ds_read_b128 a[56:59], v253 offset:43008
v_mfma_f32_16x16x32_bf16 v[132:135], a[80:83], a[8:11], v[132:135]
s_mov_b32 s56, 64552960
s_add_u32 m0, s65, 28672
ds_read_b128 a[60:63], v253 offset:44032
v_mfma_f32_16x16x32_bf16 v[152:155], a[80:83], a[16:19], v[152:155]
buffer_load_dwordx4 v16, s[4:7], s56 offen offset:0 sc1 lds
v_mfma_f32_16x16x32_bf16 v[152:155], a[84:87], a[20:23], v[152:155]
v_mfma_f32_16x16x32_bf16 v[172:175], a[84:87], a[28:31], v[172:175]
v_mfma_f32_16x16x32_bf16 v[172:175], a[80:83], a[24:27], v[172:175]
buffer_load_dwordx4 v16, s[4:7], s56 offen offset:1024 sc1 lds
v_mfma_f32_16x16x32_bf16 v[116:119], a[96:99], a[0:3], v[116:119]
ds_read_b128 a[80:83], v5 offset:38912
ds_read_b128 a[84:87], v5 offset:49152
v_mfma_f32_16x16x32_bf16 v[116:119], a[100:103], a[4:7], v[116:119]
v_mfma_f32_16x16x32_bf16 v[136:139], a[100:103], a[12:15], v[136:139]
v_mfma_f32_16x16x32_bf16 v[136:139], a[96:99], a[8:11], v[136:139]
v_mfma_f32_16x16x32_bf16 v[156:159], a[96:99], a[16:19], v[156:159]
buffer_load_dwordx4 v16, s[4:7], s56 offen offset:2048 sc1 lds
v_mfma_f32_16x16x32_bf16 v[156:159], a[100:103], a[20:23], v[156:159]
v_mfma_f32_16x16x32_bf16 v[176:179], a[100:103], a[28:31], v[176:179]
v_mfma_f32_16x16x32_bf16 v[176:179], a[96:99], a[24:27], v[176:179]
s_waitcnt lgkmcnt(2)
v_mfma_f32_16x16x32_bf16 v[100:103], a[112:115], a[32:35], v[100:103]
ds_read_b128 a[96:99], v5 offset:39936
ds_read_b128 a[100:103], v5 offset:50176
v_mfma_f32_16x16x32_bf16 v[100:103], a[116:119], a[36:39], v[100:103]
buffer_load_dwordx4 v16, s[4:7], s56 offen offset:3072 sc1 lds
v_mfma_f32_16x16x32_bf16 v[120:123], a[116:119], a[44:47], v[120:123]
v_mfma_f32_16x16x32_bf16 v[120:123], a[112:115], a[40:43], v[120:123]
v_mfma_f32_16x16x32_bf16 v[140:143], a[112:115], a[48:51], v[140:143]
s_add_u32 m0, s65, 32768
s_nop 0
buffer_load_dwordx4 v17, s[4:7], s56 offen sc1 lds
v_mfma_f32_16x16x32_bf16 v[140:143], a[116:119], a[52:55], v[140:143]
v_mfma_f32_16x16x32_bf16 v[160:163], a[116:119], a[60:63], v[160:163]
v_mfma_f32_16x16x32_bf16 v[160:163], a[112:115], a[56:59], v[160:163]
v_mfma_f32_16x16x32_bf16 v[104:107], a[64:67], a[32:35], v[104:107]
ds_read_b128 a[112:115], v5 offset:40960
ds_read_b128 a[116:119], v5 offset:51200
v_mfma_f32_16x16x32_bf16 v[104:107], a[68:71], a[36:39], v[104:107]
s_mov_b32 s57, 37789696
buffer_load_dwordx4 v[68:71], v18, s[4:7], s57 offen offset:0 sc1
v_mfma_f32_16x16x32_bf16 v[124:127], a[68:71], a[44:47], v[124:127]
v_mfma_f32_16x16x32_bf16 v[124:127], a[64:67], a[40:43], v[124:127]
v_mfma_f32_16x16x32_bf16 v[144:147], a[64:67], a[48:51], v[144:147]
v_mfma_f32_16x16x32_bf16 v[144:147], a[68:71], a[52:55], v[144:147]
buffer_load_dwordx4 v[72:75], v18, s[4:7], s57 offen offset:1024 sc1
v_mfma_f32_16x16x32_bf16 v[164:167], a[68:71], a[60:63], v[164:167]
v_mfma_f32_16x16x32_bf16 v[164:167], a[64:67], a[56:59], v[164:167]
s_waitcnt lgkmcnt(2)
v_mfma_f32_16x16x32_bf16 v[108:111], a[80:83], a[32:35], v[108:111]
s_waitcnt vmcnt(16) lgkmcnt(0)
s_barrier
ds_read_b128 a[64:67], v6 offset:0
v_mfma_f32_16x16x32_bf16 v[108:111], a[84:87], a[36:39], v[108:111]
ds_read_b128 a[68:71], v6 offset:10240
ds_read_b128 a[0:3], v254 offset:0
v_mfma_f32_16x16x32_bf16 v[128:131], a[84:87], a[44:47], v[128:131]
ds_read_b128 a[4:7], v254 offset:1024
v_mfma_f32_16x16x32_bf16 v[128:131], a[80:83], a[40:43], v[128:131]
buffer_load_dwordx4 v[76:79], v18, s[4:7], s57 offen offset:2048 sc1
v_mfma_f32_16x16x32_bf16 v[148:151], a[80:83], a[48:51], v[148:151]
ds_read_b128 a[8:11], v254 offset:2048
v_mfma_f32_16x16x32_bf16 v[148:151], a[84:87], a[52:55], v[148:151]
ds_read_b128 a[12:15], v254 offset:3072
v_mfma_f32_16x16x32_bf16 v[168:171], a[84:87], a[60:63], v[168:171]
buffer_load_dwordx4 v[80:83], v18, s[4:7], s57 offen offset:3072 sc1
v_mfma_f32_16x16x32_bf16 v[168:171], a[80:83], a[56:59], v[168:171]
ds_read_b128 a[16:19], v254 offset:4096
v_mfma_f32_16x16x32_bf16 v[112:115], a[96:99], a[32:35], v[112:115]
ds_read_b128 a[80:83], v6 offset:1024
ds_read_b128 a[84:87], v6 offset:11264
v_mfma_f32_16x16x32_bf16 v[112:115], a[100:103], a[36:39], v[112:115]
ds_read_b128 a[20:23], v254 offset:5120
v_mfma_f32_16x16x32_bf16 v[132:135], a[100:103], a[44:47], v[132:135]
s_mov_b32 s56, 64716800
s_add_u32 m0, s65, 65536
ds_read_b128 a[24:27], v254 offset:6144
v_mfma_f32_16x16x32_bf16 v[132:135], a[96:99], a[40:43], v[132:135]
ds_read_b128 a[28:31], v254 offset:7168
v_mfma_f32_16x16x32_bf16 v[152:155], a[96:99], a[48:51], v[152:155]
buffer_load_dwordx4 v16, s[4:7], s56 offen offset:0 sc1 lds
v_mfma_f32_16x16x32_bf16 v[152:155], a[100:103], a[52:55], v[152:155]
v_mfma_f32_16x16x32_bf16 v[172:175], a[100:103], a[60:63], v[172:175]
v_mfma_f32_16x16x32_bf16 v[172:175], a[96:99], a[56:59], v[172:175]
buffer_load_dwordx4 v16, s[4:7], s56 offen offset:1024 sc1 lds
v_mfma_f32_16x16x32_bf16 v[116:119], a[112:115], a[32:35], v[116:119]
ds_read_b128 a[96:99], v6 offset:2048
ds_read_b128 a[100:103], v6 offset:12288
v_mfma_f32_16x16x32_bf16 v[116:119], a[116:119], a[36:39], v[116:119]
v_mfma_f32_16x16x32_bf16 v[136:139], a[116:119], a[44:47], v[136:139]
v_mfma_f32_16x16x32_bf16 v[136:139], a[112:115], a[40:43], v[136:139]
buffer_load_dwordx4 v16, s[4:7], s56 offen offset:2048 sc1 lds
v_mfma_f32_16x16x32_bf16 v[156:159], a[112:115], a[48:51], v[156:159]
v_mfma_f32_16x16x32_bf16 v[156:159], a[116:119], a[52:55], v[156:159]
v_mfma_f32_16x16x32_bf16 v[176:179], a[116:119], a[60:63], v[176:179]
v_mfma_f32_16x16x32_bf16 v[176:179], a[112:115], a[56:59], v[176:179]
s_waitcnt lgkmcnt(2)
v_mfma_f32_16x16x32_bf16 v[100:103], a[64:67], a[0:3], v[100:103]
s_mul_i32 s62, s48, 36864
ds_read_b128 a[112:115], v6 offset:3072
ds_read_b128 a[116:119], v6 offset:13312
v_mfma_f32_16x16x32_bf16 v[100:103], a[68:71], a[4:7], v[100:103]
s_add_u32 s62, s62, 16384
buffer_load_dwordx4 v16, s[4:7], s56 offen offset:3072 sc1 lds
v_mfma_f32_16x16x32_bf16 v[120:123], a[68:71], a[12:15], v[120:123]
v_add_u32 v8, s62, v1
v_add_u32 v9, s62, v19
v_mfma_f32_16x16x32_bf16 v[120:123], a[64:67], a[8:11], v[120:123]
v_mfma_f32_16x16x32_bf16 v[140:143], a[64:67], a[16:19], v[140:143]
s_add_u32 m0, s65, 69632
s_nop 0
buffer_load_dwordx4 v17, s[4:7], s56 offen sc1 lds
v_mfma_f32_16x16x32_bf16 v[140:143], a[68:71], a[20:23], v[140:143]
v_mfma_f32_16x16x32_bf16 v[160:163], a[68:71], a[28:31], v[160:163]
v_mfma_f32_16x16x32_bf16 v[160:163], a[64:67], a[24:27], v[160:163]
v_mfma_f32_16x16x32_bf16 v[104:107], a[80:83], a[0:3], v[104:107]
s_mov_b32 s57, 37793792
ds_read_b128 a[64:67], v6 offset:4096
ds_read_b128 a[68:71], v6 offset:14336
v_mfma_f32_16x16x32_bf16 v[104:107], a[84:87], a[4:7], v[104:107]
buffer_load_dwordx4 v[84:87], v18, s[4:7], s57 offen offset:0 sc1
v_mfma_f32_16x16x32_bf16 v[124:127], a[84:87], a[12:15], v[124:127]
v_mfma_f32_16x16x32_bf16 v[124:127], a[80:83], a[8:11], v[124:127]
v_mfma_f32_16x16x32_bf16 v[144:147], a[80:83], a[16:19], v[144:147]
v_mfma_f32_16x16x32_bf16 v[144:147], a[84:87], a[20:23], v[144:147]
buffer_load_dwordx4 v[88:91], v18, s[4:7], s57 offen offset:1024 sc1
v_mfma_f32_16x16x32_bf16 v[164:167], a[84:87], a[28:31], v[164:167]
v_mfma_f32_16x16x32_bf16 v[164:167], a[80:83], a[24:27], v[164:167]
s_waitcnt lgkmcnt(2)
v_mfma_f32_16x16x32_bf16 v[108:111], a[96:99], a[0:3], v[108:111]
s_waitcnt vmcnt(16) lgkmcnt(0)
s_barrier
ds_read_b128 a[80:83], v6 offset:36864
v_mfma_f32_16x16x32_bf16 v[108:111], a[100:103], a[4:7], v[108:111]
ds_read_b128 a[84:87], v6 offset:47104
ds_read_b128 a[32:35], v254 offset:36864
v_mfma_f32_16x16x32_bf16 v[128:131], a[100:103], a[12:15], v[128:131]
ds_read_b128 a[36:39], v254 offset:37888
v_mfma_f32_16x16x32_bf16 v[128:131], a[96:99], a[8:11], v[128:131]
buffer_load_dwordx4 v[92:95], v18, s[4:7], s57 offen offset:2048 sc1
v_mfma_f32_16x16x32_bf16 v[148:151], a[96:99], a[16:19], v[148:151]
ds_read_b128 a[40:43], v254 offset:38912
v_mfma_f32_16x16x32_bf16 v[148:151], a[100:103], a[20:23], v[148:151]
ds_read_b128 a[44:47], v254 offset:39936
v_mfma_f32_16x16x32_bf16 v[168:171], a[100:103], a[28:31], v[168:171]
buffer_load_dwordx4 v[96:99], v18, s[4:7], s57 offen offset:3072 sc1
v_mfma_f32_16x16x32_bf16 v[168:171], a[96:99], a[24:27], v[168:171]
ds_read_b128 a[48:51], v254 offset:40960
v_mfma_f32_16x16x32_bf16 v[112:115], a[112:115], a[0:3], v[112:115]
ds_read_b128 a[96:99], v6 offset:37888
ds_read_b128 a[100:103], v6 offset:48128
v_mfma_f32_16x16x32_bf16 v[112:115], a[116:119], a[4:7], v[112:115]
ds_read_b128 a[52:55], v254 offset:41984
v_mfma_f32_16x16x32_bf16 v[132:135], a[116:119], a[12:15], v[132:135]
s_mov_b32 s56, 64880640
s_add_u32 m0, s65, 102400
ds_read_b128 a[56:59], v254 offset:43008
v_mfma_f32_16x16x32_bf16 v[132:135], a[112:115], a[8:11], v[132:135]
ds_read_b128 a[60:63], v254 offset:44032
v_mfma_f32_16x16x32_bf16 v[152:155], a[112:115], a[16:19], v[152:155]
buffer_load_dwordx4 v16, s[4:7], s56 offen offset:0 sc1 lds
v_mfma_f32_16x16x32_bf16 v[152:155], a[116:119], a[20:23], v[152:155]
v_mfma_f32_16x16x32_bf16 v[172:175], a[116:119], a[28:31], v[172:175]
buffer_load_dwordx4 v16, s[4:7], s56 offen offset:1024 sc1 lds
v_mfma_f32_16x16x32_bf16 v[172:175], a[112:115], a[24:27], v[172:175]
v_mfma_f32_16x16x32_bf16 v[116:119], a[64:67], a[0:3], v[116:119]
ds_read_b128 a[112:115], v6 offset:38912
ds_read_b128 a[116:119], v6 offset:49152
v_mfma_f32_16x16x32_bf16 v[116:119], a[68:71], a[4:7], v[116:119]
v_mfma_f32_16x16x32_bf16 v[136:139], a[68:71], a[12:15], v[136:139]
v_mfma_f32_16x16x32_bf16 v[136:139], a[64:67], a[8:11], v[136:139]
buffer_load_dwordx4 v16, s[4:7], s56 offen offset:2048 sc1 lds
v_mfma_f32_16x16x32_bf16 v[156:159], a[64:67], a[16:19], v[156:159]
v_mfma_f32_16x16x32_bf16 v[156:159], a[68:71], a[20:23], v[156:159]
v_mfma_f32_16x16x32_bf16 v[176:179], a[68:71], a[28:31], v[176:179]
v_mfma_f32_16x16x32_bf16 v[176:179], a[64:67], a[24:27], v[176:179]
s_waitcnt lgkmcnt(2)
buffer_load_dwordx4 v16, s[4:7], s56 offen offset:3072 sc1 lds
v_mfma_f32_16x16x32_bf16 v[100:103], a[80:83], a[32:35], v[100:103]
ds_read_b128 a[64:67], v6 offset:39936
ds_read_b128 a[68:71], v6 offset:50176
v_mfma_f32_16x16x32_bf16 v[100:103], a[84:87], a[36:39], v[100:103]
v_mfma_f32_16x16x32_bf16 v[120:123], a[84:87], a[44:47], v[120:123]
v_mfma_f32_16x16x32_bf16 v[120:123], a[80:83], a[40:43], v[120:123]
v_mfma_f32_16x16x32_bf16 v[140:143], a[80:83], a[48:51], v[140:143]
s_add_u32 m0, s65, 106496
s_nop 0
buffer_load_dwordx4 v17, s[4:7], s56 offen sc1 lds
v_mfma_f32_16x16x32_bf16 v[140:143], a[84:87], a[52:55], v[140:143]
v_mfma_f32_16x16x32_bf16 v[160:163], a[84:87], a[60:63], v[160:163]
v_mfma_f32_16x16x32_bf16 v[160:163], a[80:83], a[56:59], v[160:163]
v_mfma_f32_16x16x32_bf16 v[104:107], a[96:99], a[32:35], v[104:107]
s_mov_b32 s57, 37797888
ds_read_b128 a[80:83], v6 offset:40960
ds_read_b128 a[84:87], v6 offset:51200
v_mfma_f32_16x16x32_bf16 v[104:107], a[100:103], a[36:39], v[104:107]
buffer_load_dwordx4 v[36:39], v18, s[4:7], s57 offen offset:0 sc1
v_mfma_f32_16x16x32_bf16 v[124:127], a[100:103], a[44:47], v[124:127]
v_mfma_f32_16x16x32_bf16 v[124:127], a[96:99], a[40:43], v[124:127]
v_mfma_f32_16x16x32_bf16 v[144:147], a[96:99], a[48:51], v[144:147]
buffer_load_dwordx4 v[40:43], v18, s[4:7], s57 offen offset:1024 sc1
v_mfma_f32_16x16x32_bf16 v[144:147], a[100:103], a[52:55], v[144:147]
v_mfma_f32_16x16x32_bf16 v[164:167], a[100:103], a[60:63], v[164:167]
v_mfma_f32_16x16x32_bf16 v[164:167], a[96:99], a[56:59], v[164:167]
s_waitcnt lgkmcnt(2)
v_cvt_pk_bf16_f32 v100, v100, v101
v_cvt_pk_bf16_f32 v101, v102, v103
v_mfma_f32_16x16x32_bf16 v[108:111], a[112:115], a[32:35], v[108:111]
s_waitcnt vmcnt(20) lgkmcnt(0)
s_barrier
ds_read_b128 a[96:99], v7 offset:0
v_mfma_f32_16x16x32_bf16 v[108:111], a[116:119], a[36:39], v[108:111]
ds_read_b128 a[100:103], v7 offset:5120
ds_read_b128 a[104:107], v7 offset:10240
v_mfma_f32_16x16x32_bf16 v[128:131], a[116:119], a[44:47], v[128:131]
ds_read_b128 a[108:111], v7 offset:15360
v_cvt_pk_bf16_f32 v102, v104, v105
v_mfma_f32_16x16x32_bf16 v[128:131], a[112:115], a[40:43], v[128:131]
buffer_load_dwordx4 v[44:47], v18, s[4:7], s57 offen offset:2048 sc1
v_mfma_f32_16x16x32_bf16 v[148:151], a[112:115], a[48:51], v[148:151]
s_add_u32 s62, s60, 0
v_cvt_pk_bf16_f32 v103, v106, v107
v_mfma_f32_16x16x32_bf16 v[148:151], a[116:119], a[52:55], v[148:151]
buffer_load_dwordx4 v[48:51], v18, s[4:7], s57 offen offset:3072 sc1
v_mfma_f32_16x16x32_bf16 v[168:171], a[116:119], a[60:63], v[168:171]
buffer_store_dwordx4 v[100:103], v1, s[4:7], s62 offen sc1
v_mfma_f32_16x16x32_bf16 v[168:171], a[112:115], a[56:59], v[168:171]
v_cvt_pk_bf16_f32 v120, v120, v121
v_cvt_pk_bf16_f32 v121, v122, v123
v_mfma_f32_16x16x32_bf16 v[112:115], a[64:67], a[32:35], v[112:115]
ds_read_b128 a[112:115], v7 offset:1024
ds_read_b128 a[116:119], v7 offset:6144
v_mfma_f32_16x16x32_bf16 v[112:115], a[68:71], a[36:39], v[112:115]
ds_read_b128 a[120:123], v7 offset:11264
ds_read_b128 a[124:127], v7 offset:16384
v_mfma_f32_16x16x32_bf16 v[132:135], a[68:71], a[44:47], v[132:135]
s_mov_b32 s56, 65044480
s_add_u32 m0, s65, 139264
s_cmp_lt_u32 s48, 2
v_mfma_f32_16x16x32_bf16 v[132:135], a[64:67], a[40:43], v[132:135]
s_cselect_b32 s56, s56, 2146435072
buffer_load_dwordx4 v16, s[4:7], s56 offen offset:0 sc1 lds
v_mfma_f32_16x16x32_bf16 v[152:155], a[64:67], a[48:51], v[152:155]
s_add_u32 s62, s60, 2560
v_cvt_pk_bf16_f32 v122, v124, v125
v_cvt_pk_bf16_f32 v123, v126, v127
v_mfma_f32_16x16x32_bf16 v[152:155], a[68:71], a[52:55], v[152:155]
buffer_store_dwordx4 v[120:123], v1, s[4:7], s62 offen sc1
v_mfma_f32_16x16x32_bf16 v[172:175], a[68:71], a[60:63], v[172:175]
buffer_load_dwordx4 v16, s[4:7], s56 offen offset:1024 sc1 lds
v_mfma_f32_16x16x32_bf16 v[172:175], a[64:67], a[56:59], v[172:175]
v_cvt_pk_bf16_f32 v140, v140, v141
v_cvt_pk_bf16_f32 v141, v142, v143
v_mfma_f32_16x16x32_bf16 v[116:119], a[80:83], a[32:35], v[116:119]
ds_read_b128 a[64:67], v7 offset:2048
ds_read_b128 a[68:71], v7 offset:7168
v_mfma_f32_16x16x32_bf16 v[116:119], a[84:87], a[36:39], v[116:119]
ds_read_b128 a[72:75], v7 offset:12288
ds_read_b128 a[76:79], v7 offset:17408
v_mfma_f32_16x16x32_bf16 v[136:139], a[84:87], a[44:47], v[136:139]
s_add_u32 s62, s60, 5120
v_cvt_pk_bf16_f32 v142, v144, v145
v_cvt_pk_bf16_f32 v143, v146, v147
v_mfma_f32_16x16x32_bf16 v[136:139], a[80:83], a[40:43], v[136:139]
buffer_store_dwordx4 v[140:143], v1, s[4:7], s62 offen sc1
v_mfma_f32_16x16x32_bf16 v[156:159], a[80:83], a[48:51], v[156:159]
buffer_load_dwordx4 v16, s[4:7], s56 offen offset:2048 sc1 lds
v_mfma_f32_16x16x32_bf16 v[156:159], a[84:87], a[52:55], v[156:159]
v_cvt_pk_bf16_f32 v160, v160, v161
v_cvt_pk_bf16_f32 v161, v162, v163
v_mfma_f32_16x16x32_bf16 v[176:179], a[84:87], a[60:63], v[176:179]
s_add_u32 s62, s60, 7680
v_cvt_pk_bf16_f32 v162, v164, v165
v_cvt_pk_bf16_f32 v163, v166, v167
v_mfma_f32_16x16x32_bf16 v[176:179], a[80:83], a[56:59], v[176:179]
buffer_store_dwordx4 v[160:163], v1, s[4:7], s62 offen sc1
s_waitcnt vmcnt(28) lgkmcnt(4)
v_mfma_f32_16x16x32_bf16 v[212:215], a[96:99], v[68:71], v[212:215]
s_waitcnt vmcnt(27)
ds_read_b128 a[80:83], v7 offset:3072
ds_read_b128 a[84:87], v7 offset:8192
v_mfma_f32_16x16x32_bf16 v[212:215], a[100:103], v[72:75], v[212:215]
s_waitcnt vmcnt(26)
ds_read_b128 a[88:91], v7 offset:13312
ds_read_b128 a[92:95], v7 offset:18432
v_mfma_f32_16x16x32_bf16 v[212:215], a[104:107], v[76:79], v[212:215]
s_waitcnt vmcnt(25)
buffer_load_dwordx4 v16, s[4:7], s56 offen offset:3072 sc1 lds
v_mfma_f32_16x16x32_bf16 v[212:215], a[108:111], v[80:83], v[212:215]
s_add_u32 m0, s65, 143360
s_nop 0
buffer_load_dwordx4 v17, s[4:7], s56 offen sc1 lds
v_mfma_f32_16x16x32_bf16 v[216:219], a[124:127], v[80:83], v[216:219]
s_mov_b32 s57, 37801984
ds_read_b128 a[96:99], v7 offset:4096
ds_read_b128 a[100:103], v7 offset:9216
v_mfma_f32_16x16x32_bf16 v[216:219], a[120:123], v[76:79], v[216:219]
ds_read_b128 a[104:107], v7 offset:14336
ds_read_b128 a[108:111], v7 offset:19456
v_mfma_f32_16x16x32_bf16 v[216:219], a[116:119], v[72:75], v[216:219]
v_cvt_pk_bf16_f32 v108, v108, v109
v_cvt_pk_bf16_f32 v109, v110, v111
v_mfma_f32_16x16x32_bf16 v[216:219], a[112:115], v[68:71], v[216:219]
s_waitcnt lgkmcnt(8)
s_add_u32 s62, s60, 1024
v_cvt_pk_bf16_f32 v110, v112, v113
v_cvt_pk_bf16_f32 v111, v114, v115
v_mfma_f32_16x16x32_bf16 v[220:223], a[64:67], v[68:71], v[220:223]
buffer_store_dwordx4 v[108:111], v1, s[4:7], s62 offen sc1
v_mfma_f32_16x16x32_bf16 v[220:223], a[68:71], v[72:75], v[220:223]
s_waitcnt vmcnt(23) lgkmcnt(0)
s_barrier
ds_read_b128 a[112:115], v7 offset:36864
v_mfma_f32_16x16x32_bf16 v[220:223], a[72:75], v[76:79], v[220:223]
ds_read_b128 a[116:119], v7 offset:41984
ds_read_b128 a[120:123], v7 offset:47104
v_mfma_f32_16x16x32_bf16 v[220:223], a[76:79], v[80:83], v[220:223]
ds_read_b128 a[124:127], v7 offset:52224
v_cvt_pk_bf16_f32 v128, v128, v129
v_mfma_f32_16x16x32_bf16 v[224:227], a[92:95], v[80:83], v[224:227]
ds_read_b128 a[64:67], v7 offset:37888
ds_read_b128 a[68:71], v7 offset:43008
v_mfma_f32_16x16x32_bf16 v[224:227], a[88:91], v[76:79], v[224:227]
ds_read_b128 a[72:75], v7 offset:48128
ds_read_b128 a[76:79], v7 offset:53248
v_mfma_f32_16x16x32_bf16 v[224:227], a[84:87], v[72:75], v[224:227]
v_cvt_pk_bf16_f32 v129, v130, v131
v_cvt_pk_bf16_f32 v130, v132, v133
v_mfma_f32_16x16x32_bf16 v[224:227], a[80:83], v[68:71], v[224:227]
s_add_u32 s62, s60, 3584
v_cvt_pk_bf16_f32 v131, v134, v135
v_mfma_f32_16x16x32_bf16 v[228:231], a[96:99], v[68:71], v[228:231]
ds_read_b128 a[80:83], v7 offset:38912
ds_read_b128 a[84:87], v7 offset:44032
v_mfma_f32_16x16x32_bf16 v[228:231], a[100:103], v[72:75], v[228:231]
ds_read_b128 a[88:91], v7 offset:49152
ds_read_b128 a[92:95], v7 offset:54272
v_mfma_f32_16x16x32_bf16 v[228:231], a[104:107], v[76:79], v[228:231]
buffer_store_dwordx4 v[128:131], v1, s[4:7], s62 offen sc1
v_mfma_f32_16x16x32_bf16 v[228:231], a[108:111], v[80:83], v[228:231]
s_waitcnt vmcnt(23) lgkmcnt(11)
v_cvt_pk_bf16_f32 v148, v148, v149
v_cvt_pk_bf16_f32 v149, v150, v151
v_mfma_f32_16x16x32_bf16 v[212:215], a[112:115], v[84:87], v[212:215]
s_waitcnt vmcnt(22) lgkmcnt(9)
ds_read_b128 a[96:99], v7 offset:39936
ds_read_b128 a[100:103], v7 offset:45056
v_mfma_f32_16x16x32_bf16 v[212:215], a[116:119], v[88:91], v[212:215]
s_waitcnt vmcnt(21)
ds_read_b128 a[104:107], v7 offset:50176
ds_read_b128 a[108:111], v7 offset:55296
v_mfma_f32_16x16x32_bf16 v[212:215], a[120:123], v[92:95], v[212:215]
s_waitcnt vmcnt(20) lgkmcnt(9)
s_add_u32 s62, s60, 6144
v_cvt_pk_bf16_f32 v150, v152, v153
v_cvt_pk_bf16_f32 v151, v154, v155
v_mfma_f32_16x16x32_bf16 v[212:215], a[124:127], v[96:99], v[212:215]
buffer_store_dwordx4 v[148:151], v1, s[4:7], s62 offen sc1
s_waitcnt lgkmcnt(8)
v_mfma_f32_16x16x32_bf16 v[216:219], a[76:79], v[96:99], v[216:219]
v_cvt_pk_bf16_f32 v168, v168, v169
v_cvt_pk_bf16_f32 v169, v170, v171
v_mfma_f32_16x16x32_bf16 v[216:219], a[72:75], v[92:95], v[216:219]
s_add_u32 s62, s60, 8704
v_cvt_pk_bf16_f32 v170, v172, v173
v_cvt_pk_bf16_f32 v171, v174, v175
v_mfma_f32_16x16x32_bf16 v[216:219], a[68:71], v[88:91], v[216:219]
buffer_store_dwordx4 v[168:171], v1, s[4:7], s62 offen sc1
s_add_u32 s62, s60, 2048
v_cvt_pk_bf16_f32 v116, v116, v117
v_cvt_pk_bf16_f32 v117, v118, v119
buffer_store_dwordx2 v[116:117], v19, s[4:7], s62 offen sc1
s_add_u32 s62, s60, 4608
v_cvt_pk_bf16_f32 v136, v136, v137
v_cvt_pk_bf16_f32 v137, v138, v139
buffer_store_dwordx2 v[136:137], v19, s[4:7], s62 offen sc1
s_add_u32 s62, s60, 7168
v_cvt_pk_bf16_f32 v156, v156, v157
v_cvt_pk_bf16_f32 v157, v158, v159
buffer_store_dwordx2 v[156:157], v19, s[4:7], s62 offen sc1
s_add_u32 s62, s60, 9728
v_cvt_pk_bf16_f32 v176, v176, v177
v_cvt_pk_bf16_f32 v177, v178, v179
buffer_store_dwordx2 v[176:177], v19, s[4:7], s62 offen sc1
v_mfma_f32_16x16x32_bf16 v[216:219], a[64:67], v[84:87], v[216:219]
ds_read_b128 a[112:115], v7 offset:40960
ds_read_b128 a[116:119], v7 offset:46080
ds_read_b128 a[120:123], v7 offset:51200
ds_read_b128 a[124:127], v7 offset:56320
buffer_load_dwordx4 v[52:55], v18, s[4:7], s57 offen offset:0 sc1
s_waitcnt lgkmcnt(4)
v_mfma_f32_16x16x32_bf16 v[220:223], a[80:83], v[84:87], v[220:223]
buffer_load_dwordx4 v[56:59], v18, s[4:7], s57 offen offset:1024 sc1
v_mfma_f32_16x16x32_bf16 v[220:223], a[84:87], v[88:91], v[220:223]
s_waitcnt vmcnt(2) lgkmcnt(0)
s_barrier
ds_read_b128 a[64:67], v252 offset:0
v_mfma_f32_16x16x32_bf16 v[220:223], a[88:91], v[92:95], v[220:223]
s_lshl_b32 s51, s63, 2
ds_read_b128 a[68:71], v252 offset:5120
ds_read_b128 a[72:75], v252 offset:10240
v_mfma_f32_16x16x32_bf16 v[220:223], a[92:95], v[96:99], v[220:223]
s_add_u32 s51, s51, s89
s_cmp_eq_u32 s48, 0
ds_read_b128 a[76:79], v252 offset:15360
v_mfma_f32_16x16x32_bf16 v[224:227], a[108:111], v[96:99], v[224:227]
s_cselect_b32 s51, s51, 2146435072
ds_read_b128 a[80:83], v252 offset:1024
ds_read_b128 a[84:87], v252 offset:6144
v_mfma_f32_16x16x32_bf16 v[224:227], a[104:107], v[92:95], v[224:227]
ds_read_b128 a[88:91], v252 offset:11264
ds_read_b128 a[92:95], v252 offset:16384
v_mfma_f32_16x16x32_bf16 v[224:227], a[100:103], v[88:91], v[224:227]
v_mov_b32 v12, 2146435072
v_mov_b32 v13, 1
v_mfma_f32_16x16x32_bf16 v[224:227], a[96:99], v[84:87], v[224:227]
v_writelane_b32 v12, 0, 0
v_mfma_f32_16x16x32_bf16 v[228:231], a[112:115], v[84:87], v[228:231]
ds_read_b128 a[96:99], v252 offset:2048
ds_read_b128 a[100:103], v252 offset:7168
v_mfma_f32_16x16x32_bf16 v[228:231], a[116:119], v[88:91], v[228:231]
ds_read_b128 a[104:107], v252 offset:12288
ds_read_b128 a[108:111], v252 offset:17408
v_mfma_f32_16x16x32_bf16 v[228:231], a[120:123], v[92:95], v[228:231]
buffer_store_dword v13, v12, s[4:7], s51 offen sc1
v_mfma_f32_16x16x32_bf16 v[228:231], a[124:127], v[96:99], v[228:231]
ds_write_b128 v8, v[100:103] offset:0
s_waitcnt lgkmcnt(10)
v_mfma_f32_16x16x32_bf16 v[212:215], a[64:67], v[36:39], v[212:215]
ds_read_b128 a[112:115], v252 offset:3072
ds_read_b128 a[116:119], v252 offset:8192
v_mfma_f32_16x16x32_bf16 v[212:215], a[68:71], v[40:43], v[212:215]
ds_read_b128 a[120:123], v252 offset:13312
ds_read_b128 a[124:127], v252 offset:18432
v_mfma_f32_16x16x32_bf16 v[212:215], a[72:75], v[44:47], v[212:215]
ds_write_b128 v8, v[120:123] offset:2560
s_waitcnt lgkmcnt(12)
v_mfma_f32_16x16x32_bf16 v[212:215], a[76:79], v[48:51], v[212:215]
ds_write_b128 v8, v[140:143] offset:5120
s_waitcnt lgkmcnt(11)
v_mfma_f32_16x16x32_bf16 v[216:219], a[92:95], v[48:51], v[216:219]
ds_write_b128 v8, v[160:163] offset:7680
v_mfma_f32_16x16x32_bf16 v[216:219], a[88:91], v[44:47], v[216:219]
ds_write_b128 v8, v[108:111] offset:1024
v_mfma_f32_16x16x32_bf16 v[216:219], a[84:87], v[40:43], v[216:219]
ds_write_b128 v8, v[128:131] offset:3584
ds_write_b128 v8, v[148:151] offset:6144
ds_write_b128 v8, v[168:171] offset:8704
ds_write_b64 v9, v[116:117] offset:2048
ds_write_b64 v9, v[136:137] offset:4608
ds_write_b64 v9, v[156:157] offset:7168
ds_write_b64 v9, v[176:177] offset:9728
v_mfma_f32_16x16x32_bf16 v[216:219], a[80:83], v[36:39], v[216:219]
ds_read_b128 a[64:67], v252 offset:4096
ds_read_b128 a[68:71], v252 offset:9216
ds_read_b128 a[72:75], v252 offset:14336
ds_read_b128 a[76:79], v252 offset:19456
s_waitcnt lgkmcnt(15)
v_mfma_f32_16x16x32_bf16 v[220:223], a[96:99], v[36:39], v[220:223]
v_mfma_f32_16x16x32_bf16 v[220:223], a[100:103], v[40:43], v[220:223]
s_waitcnt vmcnt(63) lgkmcnt(0)
s_barrier
ds_read_b128 a[80:83], v252 offset:36864
v_mfma_f32_16x16x32_bf16 v[220:223], a[104:107], v[44:47], v[220:223]
ds_read_b128 a[84:87], v252 offset:41984
v_mfma_f32_16x16x32_bf16 v[220:223], a[108:111], v[48:51], v[220:223]
v_mfma_f32_16x16x32_bf16 v[224:227], a[124:127], v[48:51], v[224:227]
ds_read_b128 a[96:99], v252 offset:37888
ds_read_b128 a[100:103], v252 offset:43008
v_mfma_f32_16x16x32_bf16 v[224:227], a[120:123], v[44:47], v[224:227]
v_mfma_f32_16x16x32_bf16 v[224:227], a[116:119], v[40:43], v[224:227]
v_mfma_f32_16x16x32_bf16 v[224:227], a[112:115], v[36:39], v[224:227]
v_mfma_f32_16x16x32_bf16 v[228:231], a[64:67], v[36:39], v[228:231]
ds_read_b128 a[112:115], v252 offset:38912
ds_read_b128 a[116:119], v252 offset:44032
v_mfma_f32_16x16x32_bf16 v[228:231], a[68:71], v[40:43], v[228:231]
v_mfma_f32_16x16x32_bf16 v[228:231], a[72:75], v[44:47], v[228:231]
v_mfma_f32_16x16x32_bf16 v[228:231], a[76:79], v[48:51], v[228:231]
s_waitcnt vmcnt(2) lgkmcnt(5)
v_mfma_f32_16x16x32_bf16 v[212:215], a[80:83], v[52:55], v[212:215]
s_waitcnt vmcnt(1) lgkmcnt(4)
ds_read_b128 a[64:67], v252 offset:39936
ds_read_b128 a[68:71], v252 offset:45056
v_mfma_f32_16x16x32_bf16 v[212:215], a[84:87], v[56:59], v[212:215]
s_waitcnt lgkmcnt(4)
v_mfma_f32_16x16x32_bf16 v[216:219], a[100:103], v[56:59], v[216:219]
ds_read_b128 a[80:83], v252 offset:40960
ds_read_b128 a[84:87], v252 offset:46080
v_mfma_f32_16x16x32_bf16 v[216:219], a[96:99], v[52:55], v[216:219]
s_waitcnt lgkmcnt(5)
v_mfma_f32_16x16x32_bf16 v[220:223], a[112:115], v[52:55], v[220:223]
s_waitcnt lgkmcnt(4)
v_mfma_f32_16x16x32_bf16 v[220:223], a[116:119], v[56:59], v[220:223]
s_waitcnt lgkmcnt(2)
v_mfma_f32_16x16x32_bf16 v[224:227], a[68:71], v[56:59], v[224:227]
v_mfma_f32_16x16x32_bf16 v[224:227], a[64:67], v[52:55], v[224:227]
s_waitcnt lgkmcnt(1)
v_mfma_f32_16x16x32_bf16 v[228:231], a[80:83], v[52:55], v[228:231]
s_waitcnt lgkmcnt(0)
v_mfma_f32_16x16x32_bf16 v[228:231], a[84:87], v[56:59], v[228:231]

s_mov_b64 s[12:13], 15
buffer_load_dword v2, v255, s[4:7], s89 offen sc1
s_and_b32 s51, s63, 1
s_lshl_b32 s51, s51, 1
s_lshr_b32 s52, s63, 1
s_add_u32 s51, s51, s52
s_mul_i32 s51, s51, 36864
s_mul_i32 s52, s48, 2560
s_add_u32 s51, s51, s52
s_add_u32 s51, s51, 16384
v_add_u32 v8, s51, v1
v_add_u32 v9, s51, v19
s_add_u32 s14, s63, 1
s_and_b32 s14, s14, 3
s_mul_i32 s14, s14, 10240
s_add_u32 s14, s14, s61
s_add_u32 s15, s63, 2
s_and_b32 s15, s15, 3
s_mul_i32 s15, s15, 10240
s_add_u32 s15, s15, s61
s_add_u32 s16, s63, 3
s_and_b32 s16, s16, 3
s_mul_i32 s16, s16, 10240
s_add_u32 s16, s16, s61
v_mul_f32 v56, 0xbfb8aa3b, v212
v_mul_f32 v57, 0xbfb8aa3b, v213
v_mul_f32 v58, 0xbfb8aa3b, v214
v_mul_f32 v59, 0xbfb8aa3b, v215
v_exp_f32 v56, v56
v_exp_f32 v57, v57
v_exp_f32 v58, v58
v_exp_f32 v59, v59
v_add_f32 v56, 1.0, v56
v_add_f32 v57, 1.0, v57
v_add_f32 v58, 1.0, v58
v_add_f32 v59, 1.0, v59
v_rcp_f32 v56, v56
v_rcp_f32 v57, v57
v_rcp_f32 v58, v58
v_rcp_f32 v59, v59
v_mul_f32 v212, v212, v56
v_mul_f32 v213, v213, v57
v_mul_f32 v214, v214, v58
v_mul_f32 v215, v215, v59
v_mul_f32 v60, 0xbfb8aa3b, v216
v_mul_f32 v61, 0xbfb8aa3b, v217
v_mul_f32 v62, 0xbfb8aa3b, v218
v_mul_f32 v63, 0xbfb8aa3b, v219
v_exp_f32 v60, v60
v_exp_f32 v61, v61
v_exp_f32 v62, v62
v_exp_f32 v63, v63
v_add_f32 v60, 1.0, v60
v_add_f32 v61, 1.0, v61
v_add_f32 v62, 1.0, v62
v_add_f32 v63, 1.0, v63
v_rcp_f32 v60, v60
v_rcp_f32 v61, v61
v_rcp_f32 v62, v62
v_rcp_f32 v63, v63
v_mul_f32 v216, v216, v60
v_mul_f32 v217, v217, v61
v_mul_f32 v218, v218, v62
v_mul_f32 v219, v219, v63
v_mul_f32 v64, 0xbfb8aa3b, v220
v_mul_f32 v65, 0xbfb8aa3b, v221
v_mul_f32 v66, 0xbfb8aa3b, v222
v_mul_f32 v67, 0xbfb8aa3b, v223
v_exp_f32 v64, v64
v_exp_f32 v65, v65
v_exp_f32 v66, v66
v_exp_f32 v67, v67
v_add_f32 v64, 1.0, v64
v_add_f32 v65, 1.0, v65
v_add_f32 v66, 1.0, v66
v_add_f32 v67, 1.0, v67
v_rcp_f32 v64, v64
v_rcp_f32 v65, v65
v_rcp_f32 v66, v66
v_rcp_f32 v67, v67
v_mul_f32 v220, v220, v64
v_mul_f32 v221, v221, v65
v_mul_f32 v222, v222, v66
v_mul_f32 v223, v223, v67
s_waitcnt vmcnt(0)
v_cmp_ne_u32 vcc, 1, v2
s_nop 3
s_and_b64 vcc, vcc, s[12:13]
s_cbranch_vccnz L_slow_p
L_slow_p_back:
buffer_load_dwordx4 v[112:115], v1, s[4:7], s14 offen offset:0 sc1
buffer_load_dwordx4 v[124:127], v1, s[4:7], s15 offen offset:0 sc1
buffer_load_dwordx4 v[136:139], v1, s[4:7], s16 offen offset:0 sc1
buffer_load_dwordx4 v[116:119], v1, s[4:7], s14 offen offset:1024 sc1
buffer_load_dwordx4 v[128:131], v1, s[4:7], s15 offen offset:1024 sc1
buffer_load_dwordx4 v[140:143], v1, s[4:7], s16 offen offset:1024 sc1
buffer_load_dwordx2 v[120:121], v19, s[4:7], s14 offen offset:2048 sc1
buffer_load_dwordx2 v[132:133], v19, s[4:7], s15 offen offset:2048 sc1
buffer_load_dwordx2 v[144:145], v19, s[4:7], s16 offen offset:2048 sc1
ds_read_b128 v[100:103], v8 offset:0
ds_read_b128 v[104:107], v8 offset:1024
ds_read_b64 v[108:109], v9 offset:2048
v_mul_f32 v68, 0xbfb8aa3b, v224
v_mul_f32 v69, 0xbfb8aa3b, v225
v_mul_f32 v70, 0xbfb8aa3b, v226
v_mul_f32 v71, 0xbfb8aa3b, v227
v_exp_f32 v68, v68
v_exp_f32 v69, v69
v_exp_f32 v70, v70
v_exp_f32 v71, v71
v_add_f32 v68, 1.0, v68
v_add_f32 v69, 1.0, v69
v_add_f32 v70, 1.0, v70
v_add_f32 v71, 1.0, v71
v_rcp_f32 v68, v68
v_rcp_f32 v69, v69
v_rcp_f32 v70, v70
v_rcp_f32 v71, v71
v_mul_f32 v224, v224, v68
v_mul_f32 v225, v225, v69
v_mul_f32 v226, v226, v70
v_mul_f32 v227, v227, v71
v_mul_f32 v72, 0xbfb8aa3b, v228
v_mul_f32 v73, 0xbfb8aa3b, v229
v_mul_f32 v74, 0xbfb8aa3b, v230
v_mul_f32 v75, 0xbfb8aa3b, v231
v_exp_f32 v72, v72
v_exp_f32 v73, v73
v_exp_f32 v74, v74
v_exp_f32 v75, v75
v_add_f32 v72, 1.0, v72
v_add_f32 v73, 1.0, v73
v_add_f32 v74, 1.0, v74
v_add_f32 v75, 1.0, v75
v_rcp_f32 v72, v72
v_rcp_f32 v73, v73
v_rcp_f32 v74, v74
v_rcp_f32 v75, v75
v_mul_f32 v228, v228, v72
v_mul_f32 v229, v229, v73
v_mul_f32 v230, v230, v74
v_mul_f32 v231, v231, v75
v_lshlrev_b32 v36, 16, v20
v_and_b32 v37, 0xffff0000, v20
v_lshlrev_b32 v38, 16, v21
v_and_b32 v39, 0xffff0000, v21
v_lshlrev_b32 v40, 16, v22
v_and_b32 v41, 0xffff0000, v22
v_lshlrev_b32 v42, 16, v23
v_and_b32 v43, 0xffff0000, v23
v_lshlrev_b32 v44, 16, v24
v_and_b32 v45, 0xffff0000, v24
v_lshlrev_b32 v46, 16, v25
v_and_b32 v47, 0xffff0000, v25
v_lshlrev_b32 v48, 16, v26
v_and_b32 v49, 0xffff0000, v26
v_lshlrev_b32 v50, 16, v27
v_and_b32 v51, 0xffff0000, v27
v_lshlrev_b32 v52, 16, v28
v_and_b32 v53, 0xffff0000, v28
v_lshlrev_b32 v54, 16, v29
v_and_b32 v55, 0xffff0000, v29
s_waitcnt lgkmcnt(0)
v_lshlrev_b32 v160, 16, v100
v_and_b32 v161, 0xffff0000, v100
v_lshlrev_b32 v162, 16, v101
v_and_b32 v163, 0xffff0000, v101
s_waitcnt vmcnt(8)
v_lshlrev_b32 v164, 16, v112
v_and_b32 v165, 0xffff0000, v112
v_lshlrev_b32 v166, 16, v113
v_and_b32 v167, 0xffff0000, v113
s_waitcnt vmcnt(7)
v_lshlrev_b32 v168, 16, v124
v_and_b32 v169, 0xffff0000, v124
v_lshlrev_b32 v170, 16, v125
v_and_b32 v171, 0xffff0000, v125
s_waitcnt vmcnt(6)
v_lshlrev_b32 v172, 16, v136
v_and_b32 v173, 0xffff0000, v136
v_lshlrev_b32 v174, 16, v137
v_and_b32 v175, 0xffff0000, v137
v_pk_add_f32 v[160:161], v[160:161], v[164:165]
v_pk_add_f32 v[162:163], v[162:163], v[166:167]
v_pk_add_f32 v[168:169], v[168:169], v[172:173]
v_pk_add_f32 v[170:171], v[170:171], v[174:175]
v_pk_add_f32 v[160:161], v[160:161], v[168:169]
v_pk_add_f32 v[162:163], v[162:163], v[170:171]
v_pk_fma_f32 v[36:37], v[160:161], v[212:213], v[36:37]
v_pk_fma_f32 v[38:39], v[162:163], v[214:215], v[38:39]
v_cvt_pk_bf16_f32 v36, v36, v37
v_cvt_pk_bf16_f32 v37, v38, v39
ds_write_b64 v192, v[36:37] offset:0
v_lshlrev_b32 v160, 16, v102
v_and_b32 v161, 0xffff0000, v102
v_lshlrev_b32 v162, 16, v103
v_and_b32 v163, 0xffff0000, v103
v_lshlrev_b32 v164, 16, v114
v_and_b32 v165, 0xffff0000, v114
v_lshlrev_b32 v166, 16, v115
v_and_b32 v167, 0xffff0000, v115
v_lshlrev_b32 v168, 16, v126
v_and_b32 v169, 0xffff0000, v126
v_lshlrev_b32 v170, 16, v127
v_and_b32 v171, 0xffff0000, v127
v_lshlrev_b32 v172, 16, v138
v_and_b32 v173, 0xffff0000, v138
v_lshlrev_b32 v174, 16, v139
v_and_b32 v175, 0xffff0000, v139
v_pk_add_f32 v[160:161], v[160:161], v[164:165]
v_pk_add_f32 v[162:163], v[162:163], v[166:167]
v_pk_add_f32 v[168:169], v[168:169], v[172:173]
v_pk_add_f32 v[170:171], v[170:171], v[174:175]
v_pk_add_f32 v[160:161], v[160:161], v[168:169]
v_pk_add_f32 v[162:163], v[162:163], v[170:171]
v_pk_fma_f32 v[40:41], v[160:161], v[216:217], v[40:41]
v_pk_fma_f32 v[42:43], v[162:163], v[218:219], v[42:43]
v_cvt_pk_bf16_f32 v40, v40, v41
v_cvt_pk_bf16_f32 v41, v42, v43
ds_write_b64 v192, v[40:41] offset:32
v_lshlrev_b32 v160, 16, v104
v_and_b32 v161, 0xffff0000, v104
v_lshlrev_b32 v162, 16, v105
v_and_b32 v163, 0xffff0000, v105
s_waitcnt vmcnt(5)
v_lshlrev_b32 v164, 16, v116
v_and_b32 v165, 0xffff0000, v116
v_lshlrev_b32 v166, 16, v117
v_and_b32 v167, 0xffff0000, v117
s_waitcnt vmcnt(4)
v_lshlrev_b32 v168, 16, v128
v_and_b32 v169, 0xffff0000, v128
v_lshlrev_b32 v170, 16, v129
v_and_b32 v171, 0xffff0000, v129
s_waitcnt vmcnt(3)
v_lshlrev_b32 v172, 16, v140
v_and_b32 v173, 0xffff0000, v140
v_lshlrev_b32 v174, 16, v141
v_and_b32 v175, 0xffff0000, v141
v_pk_add_f32 v[160:161], v[160:161], v[164:165]
v_pk_add_f32 v[162:163], v[162:163], v[166:167]
v_pk_add_f32 v[168:169], v[168:169], v[172:173]
v_pk_add_f32 v[170:171], v[170:171], v[174:175]
v_pk_add_f32 v[160:161], v[160:161], v[168:169]
v_pk_add_f32 v[162:163], v[162:163], v[170:171]
v_pk_fma_f32 v[44:45], v[160:161], v[220:221], v[44:45]
v_pk_fma_f32 v[46:47], v[162:163], v[222:223], v[46:47]
v_cvt_pk_bf16_f32 v44, v44, v45
v_cvt_pk_bf16_f32 v45, v46, v47
ds_write_b64 v192, v[44:45] offset:64
v_lshlrev_b32 v160, 16, v106
v_and_b32 v161, 0xffff0000, v106
v_lshlrev_b32 v162, 16, v107
v_and_b32 v163, 0xffff0000, v107
v_lshlrev_b32 v164, 16, v118
v_and_b32 v165, 0xffff0000, v118
v_lshlrev_b32 v166, 16, v119
v_and_b32 v167, 0xffff0000, v119
v_lshlrev_b32 v168, 16, v130
v_and_b32 v169, 0xffff0000, v130
v_lshlrev_b32 v170, 16, v131
v_and_b32 v171, 0xffff0000, v131
v_lshlrev_b32 v172, 16, v142
v_and_b32 v173, 0xffff0000, v142
v_lshlrev_b32 v174, 16, v143
v_and_b32 v175, 0xffff0000, v143
v_pk_add_f32 v[160:161], v[160:161], v[164:165]
v_pk_add_f32 v[162:163], v[162:163], v[166:167]
v_pk_add_f32 v[168:169], v[168:169], v[172:173]
v_pk_add_f32 v[170:171], v[170:171], v[174:175]
v_pk_add_f32 v[160:161], v[160:161], v[168:169]
v_pk_add_f32 v[162:163], v[162:163], v[170:171]
v_pk_fma_f32 v[48:49], v[160:161], v[224:225], v[48:49]
v_pk_fma_f32 v[50:51], v[162:163], v[226:227], v[50:51]
v_cvt_pk_bf16_f32 v48, v48, v49
v_cvt_pk_bf16_f32 v49, v50, v51
ds_write_b64 v192, v[48:49] offset:96
v_lshlrev_b32 v160, 16, v108
v_and_b32 v161, 0xffff0000, v108
v_lshlrev_b32 v162, 16, v109
v_and_b32 v163, 0xffff0000, v109
s_waitcnt vmcnt(2)
v_lshlrev_b32 v164, 16, v120
v_and_b32 v165, 0xffff0000, v120
v_lshlrev_b32 v166, 16, v121
v_and_b32 v167, 0xffff0000, v121
s_waitcnt vmcnt(1)
v_lshlrev_b32 v168, 16, v132
v_and_b32 v169, 0xffff0000, v132
v_lshlrev_b32 v170, 16, v133
v_and_b32 v171, 0xffff0000, v133
s_waitcnt vmcnt(0)
v_lshlrev_b32 v172, 16, v144
v_and_b32 v173, 0xffff0000, v144
v_lshlrev_b32 v174, 16, v145
v_and_b32 v175, 0xffff0000, v145
v_pk_add_f32 v[160:161], v[160:161], v[164:165]
v_pk_add_f32 v[162:163], v[162:163], v[166:167]
v_pk_add_f32 v[168:169], v[168:169], v[172:173]
v_pk_add_f32 v[170:171], v[170:171], v[174:175]
v_pk_add_f32 v[160:161], v[160:161], v[168:169]
v_pk_add_f32 v[162:163], v[162:163], v[170:171]
v_pk_fma_f32 v[52:53], v[160:161], v[228:229], v[52:53]
v_pk_fma_f32 v[54:55], v[162:163], v[230:231], v[54:55]
v_cvt_pk_bf16_f32 v52, v52, v53
v_cvt_pk_bf16_f32 v53, v54, v55
ds_write_b64 v192, v[52:53] offset:128
ds_read_b128 v[180:183], v193
ds_read_b128 v[184:187], v194
ds_read_b128 v[188:191], v195
s_waitcnt lgkmcnt(2)
buffer_store_dwordx4 v[180:183], v196, s[40:43], 0 offen sc0 sc1
s_waitcnt lgkmcnt(1)
buffer_store_dwordx4 v[184:187], v197, s[40:43], 0 offen sc0 sc1
s_waitcnt lgkmcnt(0)
buffer_store_dwordx4 v[188:191], v198, s[40:43], 0 offen sc0 sc1

L_end:
s_endpgm
L_slow_xn:
s_mov_b32 s53, 0x40000
L_spin1:
buffer_load_dword v43, v37, s[4:7], 0 offen sc1
s_waitcnt vmcnt(0)
v_cmp_ne_u32 vcc, 1, v43
s_nop 3
s_and_b64 vcc, vcc, s[90:91]
s_cmp_eq_u64 vcc, 0
s_cbranch_scc1 L_spin1_ok
s_sleep 2
s_sub_u32 s53, s53, 1
s_cmp_lg_u32 s53, 0
s_cbranch_scc1 L_spin1
L_spin1_ok:
s_branch L_slow_xn_back
L_slow_z:
s_mov_b32 s53, 0x40000
L_spin2:
buffer_load_dword v43, v36, s[44:47], 0 offen sc1
s_waitcnt vmcnt(0)
v_cmp_ne_u32 vcc, 1, v43
s_nop 3
s_and_b64 vcc, vcc, s[90:91]
s_cmp_eq_u64 vcc, 0
s_cbranch_scc1 L_spin2_ok
s_sleep 2
s_sub_u32 s53, s53, 1
s_cmp_lg_u32 s53, 0
s_cbranch_scc1 L_spin2
L_spin2_ok:
s_branch L_slow_z_back
L_slow_hw1:
s_mov_b32 s53, 0x40000
L_spin3:
buffer_load_dwordx4 v[252:255], v6, s[4:7], 0 offen sc1
s_waitcnt vmcnt(0)
v_and_b32 v252, v252, v253
v_and_b32 v254, v254, v255
v_and_b32 v7, v252, v254
s_waitcnt vmcnt(0)
v_cmp_ne_u32 vcc, 1, v7
s_nop 3
s_and_b64 vcc, vcc, exec
s_cmp_eq_u64 vcc, 0
s_cbranch_scc1 L_spin3_ok
s_sleep 2
s_sub_u32 s53, s53, 1
s_cmp_lg_u32 s53, 0
s_cbranch_scc1 L_spin3
L_spin3_ok:
s_branch L_slow_hw1_back
L_slow_hw2:
s_mov_b32 s53, 0x40000
L_spin4:
buffer_load_dwordx4 v[252:255], v6, s[4:7], 0 offen sc1
s_waitcnt vmcnt(0)
v_and_b32 v252, v252, v253
v_and_b32 v254, v254, v255
v_and_b32 v7, v252, v254
s_waitcnt vmcnt(0)
v_cmp_ne_u32 vcc, 1, v7
s_nop 3
s_and_b64 vcc, vcc, exec
s_cmp_eq_u64 vcc, 0
s_cbranch_scc1 L_spin4_ok
s_sleep 2
s_sub_u32 s53, s53, 1
s_cmp_lg_u32 s53, 0
s_cbranch_scc1 L_spin4
L_spin4_ok:
s_branch L_slow_hw2_back
L_slow_kv0:
s_mov_b32 s53, 0x40000
L_spin5:
buffer_load_dword v35, v34, s[4:7], s57 offen sc1
s_waitcnt vmcnt(0)
v_cmp_ne_u32 vcc, 1, v35
s_nop 3
s_and_b64 vcc, vcc, s[88:89]
s_cmp_eq_u64 vcc, 0
s_cbranch_scc1 L_spin5_ok
s_sleep 2
s_sub_u32 s53, s53, 1
s_cmp_lg_u32 s53, 0
s_cbranch_scc1 L_spin5
L_spin5_ok:
s_branch L_slow_kv0_back
L_slow_kv1:
s_mov_b32 s53, 0x40000
L_spin6:
buffer_load_dword v35, v34, s[4:7], s57 offen sc1
s_waitcnt vmcnt(0)
v_cmp_ne_u32 vcc, 1, v35
s_nop 3
s_and_b64 vcc, vcc, s[88:89]
s_cmp_eq_u64 vcc, 0
s_cbranch_scc1 L_spin6_ok
s_sleep 2
s_sub_u32 s53, s53, 1
s_cmp_lg_u32 s53, 0
s_cbranch_scc1 L_spin6
L_spin6_ok:
s_branch L_slow_kv1_back
L_slow_o:
s_mov_b32 s53, 0x40000
L_spin7:
buffer_load_dword v2, v255, s[4:7], s88 offen sc1
s_waitcnt vmcnt(0)
v_cmp_ne_u32 vcc, 1, v2
s_nop 3
s_and_b64 vcc, vcc, s[12:13]
s_cmp_eq_u64 vcc, 0
s_cbranch_scc1 L_spin7_ok
s_sleep 2
s_sub_u32 s53, s53, 1
s_cmp_lg_u32 s53, 0
s_cbranch_scc1 L_spin7
L_spin7_ok:
s_branch L_slow_o_back
L_slow_p:
s_mov_b32 s53, 0x40000
L_spin8:
buffer_load_dword v2, v255, s[4:7], s89 offen sc1
s_waitcnt vmcnt(0)
v_cmp_ne_u32 vcc, 1, v2
s_nop 3
s_and_b64 vcc, vcc, s[12:13]
s_cmp_eq_u64 vcc, 0
s_cbranch_scc1 L_spin8_ok
s_sleep 2
s_sub_u32 s53, s53, 1
s_cmp_lg_u32 s53, 0
s_cbranch_scc1 L_spin8
L_spin8_ok:
s_branch L_slow_p_back
L_safe:
s_waitcnt vmcnt(0) lgkmcnt(0)
s_lshl_b32 s56, s48, 13
s_lshl_b32 s51, s49, 19
s_add_u32 s51, s51, s56
v_add_u32 v4, s51, v1
v_add_u32 v5, 4096, v4
v_mov_b32 v4, v4
v_mov_b32 v5, v5
s_mov_b32 s60, 2
s_cmp_eq_u32 s50, 0
s_cselect_b32 s58, 0, 0x8000
s_add_u32 s58, s58, 4194304
s_add_u32 s61, s50, 1
s_add_u32 s57, s56, 65536
s_add_u32 s56, s56, 98304
v_and_b32 v6, 15, v0
v_lshrrev_b32 v7, 4, v0
s_lshl_b32 s51, s54, 14
s_add_u32 s51, s51, 98304
v_add_u32 v2, s51, v1
v_cmp_eq_u32 vcc, 0, v6
v_mov_b32 v8, 0x3f803f80
v_lshlrev_b32 v7, 2, v7
v_cndmask_b32 v8, 0, v8, vcc
v_sub_u32 v7, v6, v7
v_mov_b32 v9, v8
v_mov_b32 v10, v8
v_mov_b32 v11, v8
s_sub_i32 s51, s54, s55
s_lshl_b32 s51, s51, 4
s_add_i32 s52, s54, s55
s_sub_i32 s52, s52, 1
s_lshl_b32 s52, s52, 4
v_mov_b32 v6, 0xf149f2ca
v_subrev_u32 v20, s51, v7
v_subrev_u32 v21, s52, v7
v_cmp_le_i32 vcc, 0, v20
v_cmp_le_i32 s[52:53], 0, v21
s_nop 0
v_cndmask_b32 v12, v6, 0, vcc
v_cndmask_b32 v16, v6, 0, s[52:53]
v_cmp_le_i32 vcc, 1, v20
v_cmp_le_i32 s[52:53], 1, v21
s_nop 0
v_cndmask_b32 v13, v6, 0, vcc
v_cndmask_b32 v17, v6, 0, s[52:53]
v_cmp_le_i32 vcc, 2, v20
v_cmp_le_i32 s[52:53], 2, v21
s_nop 0
v_cndmask_b32 v14, v6, 0, vcc
v_cndmask_b32 v18, v6, 0, s[52:53]
v_cmp_le_i32 vcc, 3, v20
v_cmp_le_i32 s[52:53], 3, v21
s_nop 0
v_cndmask_b32 v15, v6, 0, vcc
v_cndmask_b32 v19, v6, 0, s[52:53]
s_lshl_b32 s56, s48, 13
v_add_u32 v3, 32768, v2
s_mov_b32 s63, s50
s_mov_b32 s65, 2
L_safe_blk:
v_mov_b32 v248, 0xff7fffff
v_mov_b32 v249, 0xff7fffff
v_mov_b32 v250, 0xff7fffff
v_mov_b32 v251, 0xff7fffff
s_mov_b32 s58, 4194304
s_mov_b32 s62, s63
s_cmp_eq_u32 s62, 0
s_cbranch_scc1 L_safe_a_d
L_safe_a:
s_waitcnt lgkmcnt(0)
s_barrier
s_add_u32 m0, s56, 98304
s_nop 0
buffer_load_dwordx4 v4, s[4:7], s58 offen offset:0 sc1 lds
buffer_load_dwordx4 v4, s[4:7], s58 offen offset:1024 sc1 lds
buffer_load_dwordx4 v4, s[4:7], s58 offen offset:2048 sc1 lds
buffer_load_dwordx4 v4, s[4:7], s58 offen offset:3072 sc1 lds
s_add_u32 m0, s56, 102400
s_nop 0
buffer_load_dwordx4 v5, s[4:7], s58 offen offset:0 sc1 lds
buffer_load_dwordx4 v5, s[4:7], s58 offen offset:1024 sc1 lds
buffer_load_dwordx4 v5, s[4:7], s58 offen offset:2048 sc1 lds
buffer_load_dwordx4 v5, s[4:7], s58 offen offset:3072 sc1 lds
s_add_u32 s58, s58, 32768
s_waitcnt vmcnt(0)
s_barrier
ds_read_b128 v[100:103], v2 offset:0
ds_read_b128 v[104:107], v2 offset:1024
ds_read_b128 v[108:111], v2 offset:2048
ds_read_b128 v[112:115], v2 offset:3072
ds_read_b128 v[116:119], v2 offset:4096
ds_read_b128 v[120:123], v2 offset:5120
ds_read_b128 v[124:127], v2 offset:6144
ds_read_b128 v[128:131], v2 offset:7168
ds_read_b128 v[132:135], v2 offset:8192
ds_read_b128 v[136:139], v2 offset:9216
ds_read_b128 v[140:143], v2 offset:10240
ds_read_b128 v[144:147], v2 offset:11264
ds_read_b128 v[148:151], v2 offset:12288
ds_read_b128 v[152:155], v2 offset:13312
ds_read_b128 v[156:159], v2 offset:14336
ds_read_b128 v[160:163], v2 offset:15360
s_waitcnt lgkmcnt(15)
v_mfma_f32_16x16x32_bf16 v[36:39], v[100:103], a[0:3], 0
s_waitcnt lgkmcnt(14)
v_mfma_f32_16x16x32_bf16 v[36:39], v[104:107], a[4:7], v[36:39]
s_waitcnt lgkmcnt(13)
v_mfma_f32_16x16x32_bf16 v[36:39], v[108:111], a[8:11], v[36:39]
s_waitcnt lgkmcnt(12)
v_mfma_f32_16x16x32_bf16 v[36:39], v[112:115], a[12:15], v[36:39]
s_waitcnt lgkmcnt(11)
v_mfma_f32_16x16x32_bf16 v[40:43], v[116:119], a[0:3], 0
s_waitcnt lgkmcnt(10)
v_mfma_f32_16x16x32_bf16 v[40:43], v[120:123], a[4:7], v[40:43]
s_waitcnt lgkmcnt(9)
v_mfma_f32_16x16x32_bf16 v[40:43], v[124:127], a[8:11], v[40:43]
s_waitcnt lgkmcnt(8)
v_mfma_f32_16x16x32_bf16 v[40:43], v[128:131], a[12:15], v[40:43]
s_waitcnt lgkmcnt(6)
v_mfma_f32_16x16x32_bf16 v[44:47], v[132:135], a[0:3], 0
v_mfma_f32_16x16x32_bf16 v[44:47], v[136:139], a[4:7], v[44:47]
s_waitcnt lgkmcnt(0)
v_mfma_f32_16x16x32_bf16 v[44:47], v[140:143], a[8:11], v[44:47]
v_mfma_f32_16x16x32_bf16 v[44:47], v[144:147], a[12:15], v[44:47]
v_mfma_f32_16x16x32_bf16 v[48:51], v[148:151], a[0:3], 0
v_mfma_f32_16x16x32_bf16 v[48:51], v[152:155], a[4:7], v[48:51]
v_mfma_f32_16x16x32_bf16 v[48:51], v[156:159], a[8:11], v[48:51]
v_mfma_f32_16x16x32_bf16 v[48:51], v[160:163], a[12:15], v[48:51]
v_max3_f32 v248, v36, v37, v248
v_max3_f32 v248, v38, v39, v248
v_max3_f32 v248, v40, v41, v248
v_max3_f32 v248, v42, v43, v248
v_max3_f32 v248, v44, v45, v248
v_max3_f32 v248, v46, v47, v248
s_nop 1
v_max3_f32 v248, v48, v49, v248
v_max3_f32 v248, v50, v51, v248
v_mfma_f32_16x16x32_bf16 v[52:55], v[100:103], a[16:19], 0
v_mfma_f32_16x16x32_bf16 v[52:55], v[104:107], a[20:23], v[52:55]
v_mfma_f32_16x16x32_bf16 v[52:55], v[108:111], a[24:27], v[52:55]
v_mfma_f32_16x16x32_bf16 v[52:55], v[112:115], a[28:31], v[52:55]
v_mfma_f32_16x16x32_bf16 v[56:59], v[116:119], a[16:19], 0
v_mfma_f32_16x16x32_bf16 v[56:59], v[120:123], a[20:23], v[56:59]
v_mfma_f32_16x16x32_bf16 v[56:59], v[124:127], a[24:27], v[56:59]
v_mfma_f32_16x16x32_bf16 v[56:59], v[128:131], a[28:31], v[56:59]
v_mfma_f32_16x16x32_bf16 v[60:63], v[132:135], a[16:19], 0
v_mfma_f32_16x16x32_bf16 v[60:63], v[136:139], a[20:23], v[60:63]
v_mfma_f32_16x16x32_bf16 v[60:63], v[140:143], a[24:27], v[60:63]
v_mfma_f32_16x16x32_bf16 v[60:63], v[144:147], a[28:31], v[60:63]
v_mfma_f32_16x16x32_bf16 v[64:67], v[148:151], a[16:19], 0
v_mfma_f32_16x16x32_bf16 v[64:67], v[152:155], a[20:23], v[64:67]
v_mfma_f32_16x16x32_bf16 v[64:67], v[156:159], a[24:27], v[64:67]
v_mfma_f32_16x16x32_bf16 v[64:67], v[160:163], a[28:31], v[64:67]
v_max3_f32 v249, v52, v53, v249
v_max3_f32 v249, v54, v55, v249
v_max3_f32 v249, v56, v57, v249
v_max3_f32 v249, v58, v59, v249
v_max3_f32 v249, v60, v61, v249
v_max3_f32 v249, v62, v63, v249
s_nop 1
v_max3_f32 v249, v64, v65, v249
v_max3_f32 v249, v66, v67, v249
v_mfma_f32_16x16x32_bf16 v[36:39], v[100:103], a[32:35], 0
v_mfma_f32_16x16x32_bf16 v[36:39], v[104:107], a[36:39], v[36:39]
v_mfma_f32_16x16x32_bf16 v[36:39], v[108:111], a[40:43], v[36:39]
v_mfma_f32_16x16x32_bf16 v[36:39], v[112:115], a[44:47], v[36:39]
v_mfma_f32_16x16x32_bf16 v[40:43], v[116:119], a[32:35], 0
v_mfma_f32_16x16x32_bf16 v[40:43], v[120:123], a[36:39], v[40:43]
v_mfma_f32_16x16x32_bf16 v[40:43], v[124:127], a[40:43], v[40:43]
v_mfma_f32_16x16x32_bf16 v[40:43], v[128:131], a[44:47], v[40:43]
v_mfma_f32_16x16x32_bf16 v[44:47], v[132:135], a[32:35], 0
v_mfma_f32_16x16x32_bf16 v[44:47], v[136:139], a[36:39], v[44:47]
v_mfma_f32_16x16x32_bf16 v[44:47], v[140:143], a[40:43], v[44:47]
v_mfma_f32_16x16x32_bf16 v[44:47], v[144:147], a[44:47], v[44:47]
v_mfma_f32_16x16x32_bf16 v[48:51], v[148:151], a[32:35], 0
v_mfma_f32_16x16x32_bf16 v[48:51], v[152:155], a[36:39], v[48:51]
v_mfma_f32_16x16x32_bf16 v[48:51], v[156:159], a[40:43], v[48:51]
v_mfma_f32_16x16x32_bf16 v[48:51], v[160:163], a[44:47], v[48:51]
v_max3_f32 v250, v36, v37, v250
v_max3_f32 v250, v38, v39, v250
v_max3_f32 v250, v40, v41, v250
v_max3_f32 v250, v42, v43, v250
v_max3_f32 v250, v44, v45, v250
v_max3_f32 v250, v46, v47, v250
s_nop 1
v_max3_f32 v250, v48, v49, v250
v_max3_f32 v250, v50, v51, v250
v_mfma_f32_16x16x32_bf16 v[52:55], v[100:103], a[48:51], 0
v_mfma_f32_16x16x32_bf16 v[52:55], v[104:107], a[52:55], v[52:55]
v_mfma_f32_16x16x32_bf16 v[52:55], v[108:111], a[56:59], v[52:55]
v_mfma_f32_16x16x32_bf16 v[52:55], v[112:115], a[60:63], v[52:55]
v_mfma_f32_16x16x32_bf16 v[56:59], v[116:119], a[48:51], 0
v_mfma_f32_16x16x32_bf16 v[56:59], v[120:123], a[52:55], v[56:59]
v_mfma_f32_16x16x32_bf16 v[56:59], v[124:127], a[56:59], v[56:59]
v_mfma_f32_16x16x32_bf16 v[56:59], v[128:131], a[60:63], v[56:59]
v_mfma_f32_16x16x32_bf16 v[60:63], v[132:135], a[48:51], 0
v_mfma_f32_16x16x32_bf16 v[60:63], v[136:139], a[52:55], v[60:63]
v_mfma_f32_16x16x32_bf16 v[60:63], v[140:143], a[56:59], v[60:63]
v_mfma_f32_16x16x32_bf16 v[60:63], v[144:147], a[60:63], v[60:63]
v_mfma_f32_16x16x32_bf16 v[64:67], v[148:151], a[48:51], 0
v_mfma_f32_16x16x32_bf16 v[64:67], v[152:155], a[52:55], v[64:67]
v_mfma_f32_16x16x32_bf16 v[64:67], v[156:159], a[56:59], v[64:67]
v_mfma_f32_16x16x32_bf16 v[64:67], v[160:163], a[60:63], v[64:67]
v_max3_f32 v251, v52, v53, v251
v_max3_f32 v251, v54, v55, v251
v_max3_f32 v251, v56, v57, v251
v_max3_f32 v251, v58, v59, v251
v_max3_f32 v251, v60, v61, v251
v_max3_f32 v251, v62, v63, v251
s_nop 1
v_max3_f32 v251, v64, v65, v251
v_max3_f32 v251, v66, v67, v251
s_sub_u32 s62, s62, 1
s_cmp_lg_u32 s62, 0
s_cbranch_scc1 L_safe_a
L_safe_a_d:
s_waitcnt lgkmcnt(0)
s_barrier
s_add_u32 m0, s56, 98304
s_nop 0
buffer_load_dwordx4 v4, s[4:7], s58 offen offset:0 sc1 lds
buffer_load_dwordx4 v4, s[4:7], s58 offen offset:1024 sc1 lds
buffer_load_dwordx4 v4, s[4:7], s58 offen offset:2048 sc1 lds
buffer_load_dwordx4 v4, s[4:7], s58 offen offset:3072 sc1 lds
s_add_u32 m0, s56, 102400
s_nop 0
buffer_load_dwordx4 v5, s[4:7], s58 offen offset:0 sc1 lds
buffer_load_dwordx4 v5, s[4:7], s58 offen offset:1024 sc1 lds
buffer_load_dwordx4 v5, s[4:7], s58 offen offset:2048 sc1 lds
buffer_load_dwordx4 v5, s[4:7], s58 offen offset:3072 sc1 lds
s_add_u32 s58, s58, 32768
s_waitcnt vmcnt(0)
s_barrier
ds_read_b128 v[100:103], v2 offset:0
ds_read_b128 v[104:107], v2 offset:1024
ds_read_b128 v[108:111], v2 offset:2048
ds_read_b128 v[112:115], v2 offset:3072
ds_read_b128 v[116:119], v2 offset:4096
ds_read_b128 v[120:123], v2 offset:5120
ds_read_b128 v[124:127], v2 offset:6144
ds_read_b128 v[128:131], v2 offset:7168
ds_read_b128 v[132:135], v2 offset:8192
ds_read_b128 v[136:139], v2 offset:9216
ds_read_b128 v[140:143], v2 offset:10240
ds_read_b128 v[144:147], v2 offset:11264
ds_read_b128 v[148:151], v2 offset:12288
ds_read_b128 v[152:155], v2 offset:13312
ds_read_b128 v[156:159], v2 offset:14336
ds_read_b128 v[160:163], v2 offset:15360
s_waitcnt lgkmcnt(15)
v_mfma_f32_16x16x32_bf16 v[36:39], v[100:103], a[0:3], v[12:15]
s_waitcnt lgkmcnt(14)
v_mfma_f32_16x16x32_bf16 v[36:39], v[104:107], a[4:7], v[36:39]
s_waitcnt lgkmcnt(13)
v_mfma_f32_16x16x32_bf16 v[36:39], v[108:111], a[8:11], v[36:39]
s_waitcnt lgkmcnt(12)
v_mfma_f32_16x16x32_bf16 v[36:39], v[112:115], a[12:15], v[36:39]
s_nop 7
v_max3_f32 v248, v36, v37, v248
v_max3_f32 v248, v38, v39, v248
v_mfma_f32_16x16x32_bf16 v[52:55], v[100:103], a[16:19], 0
v_mfma_f32_16x16x32_bf16 v[52:55], v[104:107], a[20:23], v[52:55]
v_mfma_f32_16x16x32_bf16 v[52:55], v[108:111], a[24:27], v[52:55]
v_mfma_f32_16x16x32_bf16 v[52:55], v[112:115], a[28:31], v[52:55]
s_waitcnt lgkmcnt(6)
v_mfma_f32_16x16x32_bf16 v[56:59], v[116:119], a[16:19], v[16:19]
v_mfma_f32_16x16x32_bf16 v[56:59], v[120:123], a[20:23], v[56:59]
v_mfma_f32_16x16x32_bf16 v[56:59], v[124:127], a[24:27], v[56:59]
v_mfma_f32_16x16x32_bf16 v[56:59], v[128:131], a[28:31], v[56:59]
s_nop 2
v_max3_f32 v249, v52, v53, v249
v_max3_f32 v249, v54, v55, v249
s_nop 2
v_max3_f32 v249, v56, v57, v249
v_max3_f32 v249, v58, v59, v249
v_mfma_f32_16x16x32_bf16 v[36:39], v[100:103], a[32:35], 0
v_mfma_f32_16x16x32_bf16 v[36:39], v[104:107], a[36:39], v[36:39]
v_mfma_f32_16x16x32_bf16 v[36:39], v[108:111], a[40:43], v[36:39]
v_mfma_f32_16x16x32_bf16 v[36:39], v[112:115], a[44:47], v[36:39]
v_mfma_f32_16x16x32_bf16 v[40:43], v[116:119], a[32:35], 0
v_mfma_f32_16x16x32_bf16 v[40:43], v[120:123], a[36:39], v[40:43]
v_mfma_f32_16x16x32_bf16 v[40:43], v[124:127], a[40:43], v[40:43]
v_mfma_f32_16x16x32_bf16 v[40:43], v[128:131], a[44:47], v[40:43]
v_mfma_f32_16x16x32_bf16 v[44:47], v[132:135], a[32:35], v[12:15]
v_mfma_f32_16x16x32_bf16 v[44:47], v[136:139], a[36:39], v[44:47]
s_waitcnt lgkmcnt(0)
v_mfma_f32_16x16x32_bf16 v[44:47], v[140:143], a[40:43], v[44:47]
v_mfma_f32_16x16x32_bf16 v[44:47], v[144:147], a[44:47], v[44:47]
v_max3_f32 v250, v36, v37, v250
v_max3_f32 v250, v38, v39, v250
s_nop 0
v_max3_f32 v250, v40, v41, v250
v_max3_f32 v250, v42, v43, v250
s_nop 2
v_max3_f32 v250, v44, v45, v250
v_max3_f32 v250, v46, v47, v250
v_mfma_f32_16x16x32_bf16 v[52:55], v[100:103], a[48:51], 0
v_mfma_f32_16x16x32_bf16 v[52:55], v[104:107], a[52:55], v[52:55]
v_mfma_f32_16x16x32_bf16 v[52:55], v[108:111], a[56:59], v[52:55]
v_mfma_f32_16x16x32_bf16 v[52:55], v[112:115], a[60:63], v[52:55]
v_mfma_f32_16x16x32_bf16 v[56:59], v[116:119], a[48:51], 0
v_mfma_f32_16x16x32_bf16 v[56:59], v[120:123], a[52:55], v[56:59]
v_mfma_f32_16x16x32_bf16 v[56:59], v[124:127], a[56:59], v[56:59]
v_mfma_f32_16x16x32_bf16 v[56:59], v[128:131], a[60:63], v[56:59]
v_mfma_f32_16x16x32_bf16 v[60:63], v[132:135], a[48:51], 0
v_mfma_f32_16x16x32_bf16 v[60:63], v[136:139], a[52:55], v[60:63]
v_mfma_f32_16x16x32_bf16 v[60:63], v[140:143], a[56:59], v[60:63]
v_mfma_f32_16x16x32_bf16 v[60:63], v[144:147], a[60:63], v[60:63]
v_mfma_f32_16x16x32_bf16 v[64:67], v[148:151], a[48:51], v[16:19]
v_mfma_f32_16x16x32_bf16 v[64:67], v[152:155], a[52:55], v[64:67]
v_mfma_f32_16x16x32_bf16 v[64:67], v[156:159], a[56:59], v[64:67]
v_mfma_f32_16x16x32_bf16 v[64:67], v[160:163], a[60:63], v[64:67]
v_max3_f32 v251, v52, v53, v251
v_max3_f32 v251, v54, v55, v251
v_max3_f32 v251, v56, v57, v251
v_max3_f32 v251, v58, v59, v251
v_max3_f32 v251, v60, v61, v251
v_max3_f32 v251, v62, v63, v251
s_nop 1
v_max3_f32 v251, v64, v65, v251
v_max3_f32 v251, v66, v67, v251
v_mov_b32 v228, v248
v_mov_b32 v229, v249
v_mov_b32 v230, v250
v_mov_b32 v231, v251
v_permlane16_swap_b32 v248, v228
v_permlane16_swap_b32 v249, v229
v_permlane16_swap_b32 v250, v230
v_permlane16_swap_b32 v251, v231
v_max_f32 v248, v248, v228
v_max_f32 v249, v249, v229
v_max_f32 v250, v250, v230
v_max_f32 v251, v251, v231
v_mov_b32 v228, v248
v_mov_b32 v229, v249
v_mov_b32 v230, v250
v_mov_b32 v231, v251
v_permlane32_swap_b32 v248, v228
v_permlane32_swap_b32 v249, v229
v_permlane32_swap_b32 v250, v230
v_permlane32_swap_b32 v251, v231
v_max_f32 v248, v248, v228
v_max_f32 v249, v249, v229
v_max_f32 v250, v250, v230
v_max_f32 v251, v251, v231
s_lshl_b32 s51, s48, 10
v_add_u32 v244, s51, v1
v_xor_b32 v245, 0x400, v244
ds_write_b128 v244, v[248:251]
s_waitcnt lgkmcnt(0)
s_barrier
ds_read_b128 v[252:255], v245
s_waitcnt lgkmcnt(0)
v_max_f32 v248, v248, v252
v_max_f32 v249, v249, v253
v_max_f32 v250, v250, v254
v_max_f32 v251, v251, v255
v_sub_f32 v228, 0, v248
v_sub_f32 v229, 0, v248
v_sub_f32 v230, 0, v248
v_sub_f32 v231, 0, v248
v_sub_f32 v232, 0, v249
v_sub_f32 v233, 0, v249
v_sub_f32 v234, 0, v249
v_sub_f32 v235, 0, v249
v_sub_f32 v236, 0, v250
v_sub_f32 v237, 0, v250
v_sub_f32 v238, 0, v250
v_sub_f32 v239, 0, v250
v_sub_f32 v240, 0, v251
v_sub_f32 v241, 0, v251
v_sub_f32 v242, 0, v251
v_sub_f32 v243, 0, v251
v_accvgpr_write_b32 a128, 0
v_accvgpr_write_b32 a129, 0
v_accvgpr_write_b32 a130, 0
v_accvgpr_write_b32 a131, 0
v_accvgpr_write_b32 a132, 0
v_accvgpr_write_b32 a133, 0
v_accvgpr_write_b32 a134, 0
v_accvgpr_write_b32 a135, 0
v_accvgpr_write_b32 a136, 0
v_accvgpr_write_b32 a137, 0
v_accvgpr_write_b32 a138, 0
v_accvgpr_write_b32 a139, 0
v_accvgpr_write_b32 a140, 0
v_accvgpr_write_b32 a141, 0
v_accvgpr_write_b32 a142, 0
v_accvgpr_write_b32 a143, 0
v_accvgpr_write_b32 a144, 0
v_accvgpr_write_b32 a145, 0
v_accvgpr_write_b32 a146, 0
v_accvgpr_write_b32 a147, 0
v_accvgpr_write_b32 a148, 0
v_accvgpr_write_b32 a149, 0
v_accvgpr_write_b32 a150, 0
v_accvgpr_write_b32 a151, 0
v_accvgpr_write_b32 a152, 0
v_accvgpr_write_b32 a153, 0
v_accvgpr_write_b32 a154, 0
v_accvgpr_write_b32 a155, 0
v_accvgpr_write_b32 a156, 0
v_accvgpr_write_b32 a157, 0
v_accvgpr_write_b32 a158, 0
v_accvgpr_write_b32 a159, 0
v_accvgpr_write_b32 a160, 0
v_accvgpr_write_b32 a161, 0
v_accvgpr_write_b32 a162, 0
v_accvgpr_write_b32 a163, 0
v_accvgpr_write_b32 a164, 0
v_accvgpr_write_b32 a165, 0
v_accvgpr_write_b32 a166, 0
v_accvgpr_write_b32 a167, 0
v_accvgpr_write_b32 a168, 0
v_accvgpr_write_b32 a169, 0
v_accvgpr_write_b32 a170, 0
v_accvgpr_write_b32 a171, 0
v_accvgpr_write_b32 a172, 0
v_accvgpr_write_b32 a173, 0
v_accvgpr_write_b32 a174, 0
v_accvgpr_write_b32 a175, 0
v_accvgpr_write_b32 a176, 0
v_accvgpr_write_b32 a177, 0
v_accvgpr_write_b32 a178, 0
v_accvgpr_write_b32 a179, 0
v_accvgpr_write_b32 a180, 0
v_accvgpr_write_b32 a181, 0
v_accvgpr_write_b32 a182, 0
v_accvgpr_write_b32 a183, 0
v_accvgpr_write_b32 a184, 0
v_accvgpr_write_b32 a185, 0
v_accvgpr_write_b32 a186, 0
v_accvgpr_write_b32 a187, 0
v_accvgpr_write_b32 a188, 0
v_accvgpr_write_b32 a189, 0
v_accvgpr_write_b32 a190, 0
v_accvgpr_write_b32 a191, 0
v_accvgpr_write_b32 a192, 0
v_accvgpr_write_b32 a193, 0
v_accvgpr_write_b32 a194, 0
v_accvgpr_write_b32 a195, 0
v_accvgpr_write_b32 a196, 0
v_accvgpr_write_b32 a197, 0
v_accvgpr_write_b32 a198, 0
v_accvgpr_write_b32 a199, 0
v_accvgpr_write_b32 a200, 0
v_accvgpr_write_b32 a201, 0
v_accvgpr_write_b32 a202, 0
v_accvgpr_write_b32 a203, 0
v_accvgpr_write_b32 a204, 0
v_accvgpr_write_b32 a205, 0
v_accvgpr_write_b32 a206, 0
v_accvgpr_write_b32 a207, 0
v_accvgpr_write_b32 a208, 0
v_accvgpr_write_b32 a209, 0
v_accvgpr_write_b32 a210, 0
v_accvgpr_write_b32 a211, 0
v_accvgpr_write_b32 a212, 0
v_accvgpr_write_b32 a213, 0
v_accvgpr_write_b32 a214, 0
v_accvgpr_write_b32 a215, 0
v_accvgpr_write_b32 a216, 0
v_accvgpr_write_b32 a217, 0
v_accvgpr_write_b32 a218, 0
v_accvgpr_write_b32 a219, 0
v_accvgpr_write_b32 a220, 0
v_accvgpr_write_b32 a221, 0
v_accvgpr_write_b32 a222, 0
v_accvgpr_write_b32 a223, 0
v_accvgpr_write_b32 a224, 0
v_accvgpr_write_b32 a225, 0
v_accvgpr_write_b32 a226, 0
v_accvgpr_write_b32 a227, 0
v_accvgpr_write_b32 a228, 0
v_accvgpr_write_b32 a229, 0
v_accvgpr_write_b32 a230, 0
v_accvgpr_write_b32 a231, 0
v_accvgpr_write_b32 a232, 0
v_accvgpr_write_b32 a233, 0
v_accvgpr_write_b32 a234, 0
v_accvgpr_write_b32 a235, 0
v_accvgpr_write_b32 a236, 0
v_accvgpr_write_b32 a237, 0
v_accvgpr_write_b32 a238, 0
v_accvgpr_write_b32 a239, 0
v_accvgpr_write_b32 a240, 0
v_accvgpr_write_b32 a241, 0
v_accvgpr_write_b32 a242, 0
v_accvgpr_write_b32 a243, 0
v_accvgpr_write_b32 a244, 0
v_accvgpr_write_b32 a245, 0
v_accvgpr_write_b32 a246, 0
v_accvgpr_write_b32 a247, 0
v_accvgpr_write_b32 a248, 0
v_accvgpr_write_b32 a249, 0
v_accvgpr_write_b32 a250, 0
v_accvgpr_write_b32 a251, 0
v_accvgpr_write_b32 a252, 0
v_accvgpr_write_b32 a253, 0
v_accvgpr_write_b32 a254, 0
v_accvgpr_write_b32 a255, 0
v_mov_b32 v20, 0
v_mov_b32 v21, 0
v_mov_b32 v22, 0
v_mov_b32 v23, 0
v_mov_b32 v24, 0
v_mov_b32 v25, 0
v_mov_b32 v26, 0
v_mov_b32 v27, 0
v_mov_b32 v28, 0
v_mov_b32 v29, 0
v_mov_b32 v30, 0
v_mov_b32 v31, 0
v_mov_b32 v32, 0
v_mov_b32 v33, 0
v_mov_b32 v34, 0
v_mov_b32 v35, 0
s_mov_b32 s58, 4194304
s_mov_b32 s62, s63
s_cmp_eq_u32 s62, 0
s_cbranch_scc1 L_safe_b_d
L_safe_b:
s_waitcnt lgkmcnt(0)
s_barrier
s_add_u32 m0, s56, 98304
s_nop 0
buffer_load_dwordx4 v4, s[4:7], s58 offen offset:0 sc1 lds
buffer_load_dwordx4 v4, s[4:7], s58 offen offset:1024 sc1 lds
buffer_load_dwordx4 v4, s[4:7], s58 offen offset:2048 sc1 lds
buffer_load_dwordx4 v4, s[4:7], s58 offen offset:3072 sc1 lds
s_add_u32 m0, s56, 102400
s_nop 0
buffer_load_dwordx4 v5, s[4:7], s58 offen offset:0 sc1 lds
buffer_load_dwordx4 v5, s[4:7], s58 offen offset:1024 sc1 lds
buffer_load_dwordx4 v5, s[4:7], s58 offen offset:2048 sc1 lds
buffer_load_dwordx4 v5, s[4:7], s58 offen offset:3072 sc1 lds
s_add_u32 s59, s58, 16777216
s_add_u32 m0, s56, 131072
s_nop 0
buffer_load_dwordx4 v4, s[4:7], s59 offen offset:0 sc1 lds
buffer_load_dwordx4 v4, s[4:7], s59 offen offset:1024 sc1 lds
buffer_load_dwordx4 v4, s[4:7], s59 offen offset:2048 sc1 lds
buffer_load_dwordx4 v4, s[4:7], s59 offen offset:3072 sc1 lds
s_add_u32 m0, s56, 135168
s_nop 0
buffer_load_dwordx4 v5, s[4:7], s59 offen offset:0 sc1 lds
buffer_load_dwordx4 v5, s[4:7], s59 offen offset:1024 sc1 lds
buffer_load_dwordx4 v5, s[4:7], s59 offen offset:2048 sc1 lds
buffer_load_dwordx4 v5, s[4:7], s59 offen offset:3072 sc1 lds
s_add_u32 s58, s58, 32768
s_waitcnt vmcnt(0)
s_barrier
ds_read_b128 v[100:103], v2 offset:0
ds_read_b128 v[104:107], v2 offset:1024
ds_read_b128 v[108:111], v2 offset:2048
ds_read_b128 v[112:115], v2 offset:3072
ds_read_b128 v[116:119], v2 offset:4096
ds_read_b128 v[120:123], v2 offset:5120
ds_read_b128 v[124:127], v2 offset:6144
ds_read_b128 v[128:131], v2 offset:7168
ds_read_b128 v[132:135], v2 offset:8192
ds_read_b128 v[136:139], v2 offset:9216
ds_read_b128 v[140:143], v2 offset:10240
ds_read_b128 v[144:147], v2 offset:11264
ds_read_b128 v[148:151], v2 offset:12288
ds_read_b128 v[152:155], v2 offset:13312
ds_read_b128 v[156:159], v2 offset:14336
ds_read_b128 v[160:163], v2 offset:15360
ds_read_b128 v[164:167], v3 offset:0
ds_read_b128 v[168:171], v3 offset:1024
ds_read_b128 v[172:175], v3 offset:2048
ds_read_b128 v[176:179], v3 offset:3072
ds_read_b128 v[180:183], v3 offset:4096
ds_read_b128 v[184:187], v3 offset:5120
ds_read_b128 v[188:191], v3 offset:6144
ds_read_b128 v[192:195], v3 offset:7168
ds_read_b128 v[196:199], v3 offset:8192
ds_read_b128 v[200:203], v3 offset:9216
ds_read_b128 v[204:207], v3 offset:10240
ds_read_b128 v[208:211], v3 offset:11264
ds_read_b128 v[212:215], v3 offset:12288
ds_read_b128 v[216:219], v3 offset:13312
ds_read_b128 v[220:223], v3 offset:14336
ds_read_b128 v[224:227], v3 offset:15360
s_waitcnt lgkmcnt(15)
v_mfma_f32_16x16x32_bf16 v[36:39], v[100:103], a[0:3], v[228:231]
v_mfma_f32_16x16x32_bf16 v[36:39], v[104:107], a[4:7], v[36:39]
v_mfma_f32_16x16x32_bf16 v[36:39], v[108:111], a[8:11], v[36:39]
v_mfma_f32_16x16x32_bf16 v[36:39], v[112:115], a[12:15], v[36:39]
v_mfma_f32_16x16x32_bf16 v[40:43], v[116:119], a[0:3], v[228:231]
v_mfma_f32_16x16x32_bf16 v[40:43], v[120:123], a[4:7], v[40:43]
v_mfma_f32_16x16x32_bf16 v[40:43], v[124:127], a[8:11], v[40:43]
v_mfma_f32_16x16x32_bf16 v[40:43], v[128:131], a[12:15], v[40:43]
v_mfma_f32_16x16x32_bf16 v[44:47], v[132:135], a[0:3], v[228:231]
v_mfma_f32_16x16x32_bf16 v[44:47], v[136:139], a[4:7], v[44:47]
v_mfma_f32_16x16x32_bf16 v[44:47], v[140:143], a[8:11], v[44:47]
v_mfma_f32_16x16x32_bf16 v[44:47], v[144:147], a[12:15], v[44:47]
v_mfma_f32_16x16x32_bf16 v[48:51], v[148:151], a[0:3], v[228:231]
v_mfma_f32_16x16x32_bf16 v[48:51], v[152:155], a[4:7], v[48:51]
v_mfma_f32_16x16x32_bf16 v[48:51], v[156:159], a[8:11], v[48:51]
v_mfma_f32_16x16x32_bf16 v[48:51], v[160:163], a[12:15], v[48:51]
v_exp_f32 v36, v36
v_exp_f32 v37, v37
v_exp_f32 v38, v38
v_exp_f32 v39, v39
v_cvt_pk_bf16_f32 v68, v36, v37
v_cvt_pk_bf16_f32 v69, v38, v39
v_exp_f32 v40, v40
v_exp_f32 v41, v41
v_exp_f32 v42, v42
v_exp_f32 v43, v43
v_cvt_pk_bf16_f32 v70, v40, v41
v_cvt_pk_bf16_f32 v71, v42, v43
v_exp_f32 v44, v44
v_exp_f32 v45, v45
v_exp_f32 v46, v46
v_exp_f32 v47, v47
v_cvt_pk_bf16_f32 v72, v44, v45
v_cvt_pk_bf16_f32 v73, v46, v47
v_exp_f32 v48, v48
v_exp_f32 v49, v49
v_exp_f32 v50, v50
v_exp_f32 v51, v51
v_cvt_pk_bf16_f32 v74, v48, v49
v_cvt_pk_bf16_f32 v75, v50, v51
v_mfma_f32_16x16x32_bf16 v[52:55], v[100:103], a[16:19], v[232:235]
v_mfma_f32_16x16x32_bf16 v[52:55], v[104:107], a[20:23], v[52:55]
v_mfma_f32_16x16x32_bf16 v[52:55], v[108:111], a[24:27], v[52:55]
v_mfma_f32_16x16x32_bf16 v[52:55], v[112:115], a[28:31], v[52:55]
v_mfma_f32_16x16x32_bf16 v[56:59], v[116:119], a[16:19], v[232:235]
v_mfma_f32_16x16x32_bf16 v[56:59], v[120:123], a[20:23], v[56:59]
v_mfma_f32_16x16x32_bf16 v[56:59], v[124:127], a[24:27], v[56:59]
v_mfma_f32_16x16x32_bf16 v[56:59], v[128:131], a[28:31], v[56:59]
v_mfma_f32_16x16x32_bf16 v[60:63], v[132:135], a[16:19], v[232:235]
v_mfma_f32_16x16x32_bf16 v[60:63], v[136:139], a[20:23], v[60:63]
v_mfma_f32_16x16x32_bf16 v[60:63], v[140:143], a[24:27], v[60:63]
v_mfma_f32_16x16x32_bf16 v[60:63], v[144:147], a[28:31], v[60:63]
v_mfma_f32_16x16x32_bf16 v[64:67], v[148:151], a[16:19], v[232:235]
v_mfma_f32_16x16x32_bf16 v[64:67], v[152:155], a[20:23], v[64:67]
v_mfma_f32_16x16x32_bf16 v[64:67], v[156:159], a[24:27], v[64:67]
v_mfma_f32_16x16x32_bf16 v[64:67], v[160:163], a[28:31], v[64:67]
v_exp_f32 v52, v52
v_exp_f32 v53, v53
v_exp_f32 v54, v54
v_exp_f32 v55, v55
v_cvt_pk_bf16_f32 v76, v52, v53
v_cvt_pk_bf16_f32 v77, v54, v55
v_exp_f32 v56, v56
v_exp_f32 v57, v57
v_exp_f32 v58, v58
v_exp_f32 v59, v59
v_cvt_pk_bf16_f32 v78, v56, v57
v_cvt_pk_bf16_f32 v79, v58, v59
v_exp_f32 v60, v60
v_exp_f32 v61, v61
v_exp_f32 v62, v62
v_exp_f32 v63, v63
v_cvt_pk_bf16_f32 v80, v60, v61
v_cvt_pk_bf16_f32 v81, v62, v63
v_exp_f32 v64, v64
v_exp_f32 v65, v65
v_exp_f32 v66, v66
v_exp_f32 v67, v67
v_cvt_pk_bf16_f32 v82, v64, v65
v_cvt_pk_bf16_f32 v83, v66, v67
v_mfma_f32_16x16x32_bf16 v[36:39], v[100:103], a[32:35], v[236:239]
v_mfma_f32_16x16x32_bf16 v[36:39], v[104:107], a[36:39], v[36:39]
v_mfma_f32_16x16x32_bf16 v[36:39], v[108:111], a[40:43], v[36:39]
v_mfma_f32_16x16x32_bf16 v[36:39], v[112:115], a[44:47], v[36:39]
v_mfma_f32_16x16x32_bf16 v[40:43], v[116:119], a[32:35], v[236:239]
v_mfma_f32_16x16x32_bf16 v[40:43], v[120:123], a[36:39], v[40:43]
v_mfma_f32_16x16x32_bf16 v[40:43], v[124:127], a[40:43], v[40:43]
v_mfma_f32_16x16x32_bf16 v[40:43], v[128:131], a[44:47], v[40:43]
v_mfma_f32_16x16x32_bf16 v[44:47], v[132:135], a[32:35], v[236:239]
v_mfma_f32_16x16x32_bf16 v[44:47], v[136:139], a[36:39], v[44:47]
v_mfma_f32_16x16x32_bf16 v[44:47], v[140:143], a[40:43], v[44:47]
v_mfma_f32_16x16x32_bf16 v[44:47], v[144:147], a[44:47], v[44:47]
v_mfma_f32_16x16x32_bf16 v[48:51], v[148:151], a[32:35], v[236:239]
v_mfma_f32_16x16x32_bf16 v[48:51], v[152:155], a[36:39], v[48:51]
v_mfma_f32_16x16x32_bf16 v[48:51], v[156:159], a[40:43], v[48:51]
v_mfma_f32_16x16x32_bf16 v[48:51], v[160:163], a[44:47], v[48:51]
v_exp_f32 v36, v36
v_exp_f32 v37, v37
v_exp_f32 v38, v38
v_exp_f32 v39, v39
v_cvt_pk_bf16_f32 v84, v36, v37
v_cvt_pk_bf16_f32 v85, v38, v39
v_exp_f32 v40, v40
v_exp_f32 v41, v41
v_exp_f32 v42, v42
v_exp_f32 v43, v43
v_cvt_pk_bf16_f32 v86, v40, v41
v_cvt_pk_bf16_f32 v87, v42, v43
v_exp_f32 v44, v44
v_exp_f32 v45, v45
v_exp_f32 v46, v46
v_exp_f32 v47, v47
v_cvt_pk_bf16_f32 v88, v44, v45
v_cvt_pk_bf16_f32 v89, v46, v47
v_exp_f32 v48, v48
v_exp_f32 v49, v49
v_exp_f32 v50, v50
v_exp_f32 v51, v51
v_cvt_pk_bf16_f32 v90, v48, v49
v_cvt_pk_bf16_f32 v91, v50, v51
v_mfma_f32_16x16x32_bf16 v[52:55], v[100:103], a[48:51], v[240:243]
v_mfma_f32_16x16x32_bf16 v[52:55], v[104:107], a[52:55], v[52:55]
v_mfma_f32_16x16x32_bf16 v[52:55], v[108:111], a[56:59], v[52:55]
v_mfma_f32_16x16x32_bf16 v[52:55], v[112:115], a[60:63], v[52:55]
v_mfma_f32_16x16x32_bf16 v[56:59], v[116:119], a[48:51], v[240:243]
v_mfma_f32_16x16x32_bf16 v[56:59], v[120:123], a[52:55], v[56:59]
v_mfma_f32_16x16x32_bf16 v[56:59], v[124:127], a[56:59], v[56:59]
v_mfma_f32_16x16x32_bf16 v[56:59], v[128:131], a[60:63], v[56:59]
v_mfma_f32_16x16x32_bf16 v[60:63], v[132:135], a[48:51], v[240:243]
v_mfma_f32_16x16x32_bf16 v[60:63], v[136:139], a[52:55], v[60:63]
v_mfma_f32_16x16x32_bf16 v[60:63], v[140:143], a[56:59], v[60:63]
v_mfma_f32_16x16x32_bf16 v[60:63], v[144:147], a[60:63], v[60:63]
v_mfma_f32_16x16x32_bf16 v[64:67], v[148:151], a[48:51], v[240:243]
v_mfma_f32_16x16x32_bf16 v[64:67], v[152:155], a[52:55], v[64:67]
v_mfma_f32_16x16x32_bf16 v[64:67], v[156:159], a[56:59], v[64:67]
v_mfma_f32_16x16x32_bf16 v[64:67], v[160:163], a[60:63], v[64:67]
v_exp_f32 v52, v52
v_exp_f32 v53, v53
v_exp_f32 v54, v54
v_exp_f32 v55, v55
v_cvt_pk_bf16_f32 v92, v52, v53
v_cvt_pk_bf16_f32 v93, v54, v55
v_exp_f32 v56, v56
v_exp_f32 v57, v57
v_exp_f32 v58, v58
v_exp_f32 v59, v59
v_cvt_pk_bf16_f32 v94, v56, v57
v_cvt_pk_bf16_f32 v95, v58, v59
v_exp_f32 v60, v60
v_exp_f32 v61, v61
v_exp_f32 v62, v62
v_exp_f32 v63, v63
v_cvt_pk_bf16_f32 v96, v60, v61
v_cvt_pk_bf16_f32 v97, v62, v63
v_exp_f32 v64, v64
v_exp_f32 v65, v65
v_exp_f32 v66, v66
v_exp_f32 v67, v67
v_cvt_pk_bf16_f32 v98, v64, v65
v_cvt_pk_bf16_f32 v99, v66, v67
v_mfma_f32_16x16x32_bf16 a[128:131], v[164:167], v[68:71], a[128:131]
s_waitcnt lgkmcnt(0)
v_mfma_f32_16x16x32_bf16 a[128:131], v[168:171], v[72:75], a[128:131]
v_mfma_f32_16x16x32_bf16 a[132:135], v[172:175], v[68:71], a[132:135]
v_mfma_f32_16x16x32_bf16 a[132:135], v[176:179], v[72:75], a[132:135]
v_mfma_f32_16x16x32_bf16 a[136:139], v[180:183], v[68:71], a[136:139]
v_mfma_f32_16x16x32_bf16 a[136:139], v[184:187], v[72:75], a[136:139]
v_mfma_f32_16x16x32_bf16 a[140:143], v[188:191], v[68:71], a[140:143]
v_mfma_f32_16x16x32_bf16 a[140:143], v[192:195], v[72:75], a[140:143]
v_mfma_f32_16x16x32_bf16 a[144:147], v[196:199], v[68:71], a[144:147]
v_mfma_f32_16x16x32_bf16 a[144:147], v[200:203], v[72:75], a[144:147]
v_mfma_f32_16x16x32_bf16 a[148:151], v[204:207], v[68:71], a[148:151]
v_mfma_f32_16x16x32_bf16 a[148:151], v[208:211], v[72:75], a[148:151]
v_mfma_f32_16x16x32_bf16 a[152:155], v[212:215], v[68:71], a[152:155]
v_mfma_f32_16x16x32_bf16 a[152:155], v[216:219], v[72:75], a[152:155]
v_mfma_f32_16x16x32_bf16 a[156:159], v[220:223], v[68:71], a[156:159]
v_mfma_f32_16x16x32_bf16 a[156:159], v[224:227], v[72:75], a[156:159]
v_mfma_f32_16x16x32_bf16 v[20:23], v[8:11], v[68:71], v[20:23]
v_mfma_f32_16x16x32_bf16 v[20:23], v[8:11], v[72:75], v[20:23]
v_mfma_f32_16x16x32_bf16 a[160:163], v[164:167], v[76:79], a[160:163]
v_mfma_f32_16x16x32_bf16 a[160:163], v[168:171], v[80:83], a[160:163]
v_mfma_f32_16x16x32_bf16 a[164:167], v[172:175], v[76:79], a[164:167]
v_mfma_f32_16x16x32_bf16 a[164:167], v[176:179], v[80:83], a[164:167]
v_mfma_f32_16x16x32_bf16 a[168:171], v[180:183], v[76:79], a[168:171]
v_mfma_f32_16x16x32_bf16 a[168:171], v[184:187], v[80:83], a[168:171]
v_mfma_f32_16x16x32_bf16 a[172:175], v[188:191], v[76:79], a[172:175]
v_mfma_f32_16x16x32_bf16 a[172:175], v[192:195], v[80:83], a[172:175]
v_mfma_f32_16x16x32_bf16 a[176:179], v[196:199], v[76:79], a[176:179]
v_mfma_f32_16x16x32_bf16 a[176:179], v[200:203], v[80:83], a[176:179]
v_mfma_f32_16x16x32_bf16 a[180:183], v[204:207], v[76:79], a[180:183]
v_mfma_f32_16x16x32_bf16 a[180:183], v[208:211], v[80:83], a[180:183]
v_mfma_f32_16x16x32_bf16 a[184:187], v[212:215], v[76:79], a[184:187]
v_mfma_f32_16x16x32_bf16 a[184:187], v[216:219], v[80:83], a[184:187]
v_mfma_f32_16x16x32_bf16 a[188:191], v[220:223], v[76:79], a[188:191]
v_mfma_f32_16x16x32_bf16 a[188:191], v[224:227], v[80:83], a[188:191]
v_mfma_f32_16x16x32_bf16 v[24:27], v[8:11], v[76:79], v[24:27]
v_mfma_f32_16x16x32_bf16 v[24:27], v[8:11], v[80:83], v[24:27]
v_mfma_f32_16x16x32_bf16 a[192:195], v[164:167], v[84:87], a[192:195]
v_mfma_f32_16x16x32_bf16 a[192:195], v[168:171], v[88:91], a[192:195]
v_mfma_f32_16x16x32_bf16 a[196:199], v[172:175], v[84:87], a[196:199]
v_mfma_f32_16x16x32_bf16 a[196:199], v[176:179], v[88:91], a[196:199]
v_mfma_f32_16x16x32_bf16 a[200:203], v[180:183], v[84:87], a[200:203]
v_mfma_f32_16x16x32_bf16 a[200:203], v[184:187], v[88:91], a[200:203]
v_mfma_f32_16x16x32_bf16 a[204:207], v[188:191], v[84:87], a[204:207]
v_mfma_f32_16x16x32_bf16 a[204:207], v[192:195], v[88:91], a[204:207]
v_mfma_f32_16x16x32_bf16 a[208:211], v[196:199], v[84:87], a[208:211]
v_mfma_f32_16x16x32_bf16 a[208:211], v[200:203], v[88:91], a[208:211]
v_mfma_f32_16x16x32_bf16 a[212:215], v[204:207], v[84:87], a[212:215]
v_mfma_f32_16x16x32_bf16 a[212:215], v[208:211], v[88:91], a[212:215]
v_mfma_f32_16x16x32_bf16 a[216:219], v[212:215], v[84:87], a[216:219]
v_mfma_f32_16x16x32_bf16 a[216:219], v[216:219], v[88:91], a[216:219]
v_mfma_f32_16x16x32_bf16 a[220:223], v[220:223], v[84:87], a[220:223]
v_mfma_f32_16x16x32_bf16 a[220:223], v[224:227], v[88:91], a[220:223]
v_mfma_f32_16x16x32_bf16 v[28:31], v[8:11], v[84:87], v[28:31]
v_mfma_f32_16x16x32_bf16 v[28:31], v[8:11], v[88:91], v[28:31]
v_mfma_f32_16x16x32_bf16 a[224:227], v[164:167], v[92:95], a[224:227]
v_mfma_f32_16x16x32_bf16 a[224:227], v[168:171], v[96:99], a[224:227]
v_mfma_f32_16x16x32_bf16 a[228:231], v[172:175], v[92:95], a[228:231]
v_mfma_f32_16x16x32_bf16 a[228:231], v[176:179], v[96:99], a[228:231]
v_mfma_f32_16x16x32_bf16 a[232:235], v[180:183], v[92:95], a[232:235]
v_mfma_f32_16x16x32_bf16 a[232:235], v[184:187], v[96:99], a[232:235]
v_mfma_f32_16x16x32_bf16 a[236:239], v[188:191], v[92:95], a[236:239]
v_mfma_f32_16x16x32_bf16 a[236:239], v[192:195], v[96:99], a[236:239]
v_mfma_f32_16x16x32_bf16 a[240:243], v[196:199], v[92:95], a[240:243]
v_mfma_f32_16x16x32_bf16 a[240:243], v[200:203], v[96:99], a[240:243]
v_mfma_f32_16x16x32_bf16 a[244:247], v[204:207], v[92:95], a[244:247]
v_mfma_f32_16x16x32_bf16 a[244:247], v[208:211], v[96:99], a[244:247]
v_mfma_f32_16x16x32_bf16 a[248:251], v[212:215], v[92:95], a[248:251]
v_mfma_f32_16x16x32_bf16 a[248:251], v[216:219], v[96:99], a[248:251]
v_mfma_f32_16x16x32_bf16 a[252:255], v[220:223], v[92:95], a[252:255]
v_mfma_f32_16x16x32_bf16 a[252:255], v[224:227], v[96:99], a[252:255]
v_mfma_f32_16x16x32_bf16 v[32:35], v[8:11], v[92:95], v[32:35]
v_mfma_f32_16x16x32_bf16 v[32:35], v[8:11], v[96:99], v[32:35]
s_sub_u32 s62, s62, 1
s_cmp_lg_u32 s62, 0
s_cbranch_scc1 L_safe_b
L_safe_b_d:
s_waitcnt lgkmcnt(0)
s_barrier
s_add_u32 m0, s56, 98304
s_nop 0
buffer_load_dwordx4 v4, s[4:7], s58 offen offset:0 sc1 lds
buffer_load_dwordx4 v4, s[4:7], s58 offen offset:1024 sc1 lds
buffer_load_dwordx4 v4, s[4:7], s58 offen offset:2048 sc1 lds
buffer_load_dwordx4 v4, s[4:7], s58 offen offset:3072 sc1 lds
s_add_u32 m0, s56, 102400
s_nop 0
buffer_load_dwordx4 v5, s[4:7], s58 offen offset:0 sc1 lds
buffer_load_dwordx4 v5, s[4:7], s58 offen offset:1024 sc1 lds
buffer_load_dwordx4 v5, s[4:7], s58 offen offset:2048 sc1 lds
buffer_load_dwordx4 v5, s[4:7], s58 offen offset:3072 sc1 lds
s_add_u32 s59, s58, 16777216
s_add_u32 m0, s56, 131072
s_nop 0
buffer_load_dwordx4 v4, s[4:7], s59 offen offset:0 sc1 lds
buffer_load_dwordx4 v4, s[4:7], s59 offen offset:1024 sc1 lds
buffer_load_dwordx4 v4, s[4:7], s59 offen offset:2048 sc1 lds
buffer_load_dwordx4 v4, s[4:7], s59 offen offset:3072 sc1 lds
s_add_u32 m0, s56, 135168
s_nop 0
buffer_load_dwordx4 v5, s[4:7], s59 offen offset:0 sc1 lds
buffer_load_dwordx4 v5, s[4:7], s59 offen offset:1024 sc1 lds
buffer_load_dwordx4 v5, s[4:7], s59 offen offset:2048 sc1 lds
buffer_load_dwordx4 v5, s[4:7], s59 offen offset:3072 sc1 lds
s_add_u32 s58, s58, 32768
s_waitcnt vmcnt(0)
s_barrier
ds_read_b128 v[100:103], v2 offset:0
ds_read_b128 v[104:107], v2 offset:1024
ds_read_b128 v[108:111], v2 offset:2048
ds_read_b128 v[112:115], v2 offset:3072
ds_read_b128 v[116:119], v2 offset:4096
ds_read_b128 v[120:123], v2 offset:5120
ds_read_b128 v[124:127], v2 offset:6144
ds_read_b128 v[128:131], v2 offset:7168
ds_read_b128 v[132:135], v2 offset:8192
ds_read_b128 v[136:139], v2 offset:9216
ds_read_b128 v[140:143], v2 offset:10240
ds_read_b128 v[144:147], v2 offset:11264
ds_read_b128 v[148:151], v2 offset:12288
ds_read_b128 v[152:155], v2 offset:13312
ds_read_b128 v[156:159], v2 offset:14336
ds_read_b128 v[160:163], v2 offset:15360
ds_read_b128 v[164:167], v3 offset:0
ds_read_b128 v[168:171], v3 offset:1024
ds_read_b128 v[172:175], v3 offset:2048
ds_read_b128 v[176:179], v3 offset:3072
ds_read_b128 v[180:183], v3 offset:4096
ds_read_b128 v[184:187], v3 offset:5120
ds_read_b128 v[188:191], v3 offset:6144
ds_read_b128 v[192:195], v3 offset:7168
ds_read_b128 v[196:199], v3 offset:8192
ds_read_b128 v[200:203], v3 offset:9216
ds_read_b128 v[204:207], v3 offset:10240
ds_read_b128 v[208:211], v3 offset:11264
ds_read_b128 v[212:215], v3 offset:12288
ds_read_b128 v[216:219], v3 offset:13312
ds_read_b128 v[220:223], v3 offset:14336
ds_read_b128 v[224:227], v3 offset:15360
v_add_f32 v244, v12, v228
v_add_f32 v245, v13, v229
v_add_f32 v246, v14, v230
v_add_f32 v247, v15, v231
s_waitcnt lgkmcnt(15)
s_nop 0
v_mfma_f32_16x16x32_bf16 v[36:39], v[100:103], a[0:3], v[244:247]
v_mfma_f32_16x16x32_bf16 v[36:39], v[104:107], a[4:7], v[36:39]
v_mfma_f32_16x16x32_bf16 v[36:39], v[108:111], a[8:11], v[36:39]
v_mfma_f32_16x16x32_bf16 v[36:39], v[112:115], a[12:15], v[36:39]
s_nop 7
v_exp_f32 v36, v36
v_exp_f32 v37, v37
v_exp_f32 v38, v38
v_exp_f32 v39, v39
v_cvt_pk_bf16_f32 v68, v36, v37
v_cvt_pk_bf16_f32 v69, v38, v39
v_mov_b32 v70, 0
v_mov_b32 v71, 0
v_mov_b32 v72, 0
v_mov_b32 v73, 0
v_mov_b32 v74, 0
v_mov_b32 v75, 0
v_add_f32 v244, v16, v232
v_add_f32 v245, v17, v233
v_add_f32 v246, v18, v234
v_add_f32 v247, v19, v235
v_mfma_f32_16x16x32_bf16 v[52:55], v[100:103], a[16:19], v[232:235]
v_mfma_f32_16x16x32_bf16 v[52:55], v[104:107], a[20:23], v[52:55]
v_mfma_f32_16x16x32_bf16 v[52:55], v[108:111], a[24:27], v[52:55]
v_mfma_f32_16x16x32_bf16 v[52:55], v[112:115], a[28:31], v[52:55]
v_mfma_f32_16x16x32_bf16 v[56:59], v[116:119], a[16:19], v[244:247]
v_mfma_f32_16x16x32_bf16 v[56:59], v[120:123], a[20:23], v[56:59]
v_mfma_f32_16x16x32_bf16 v[56:59], v[124:127], a[24:27], v[56:59]
v_mfma_f32_16x16x32_bf16 v[56:59], v[128:131], a[28:31], v[56:59]
s_nop 3
v_exp_f32 v52, v52
v_exp_f32 v53, v53
v_exp_f32 v54, v54
v_exp_f32 v55, v55
v_cvt_pk_bf16_f32 v76, v52, v53
v_cvt_pk_bf16_f32 v77, v54, v55
v_exp_f32 v56, v56
v_exp_f32 v57, v57
v_exp_f32 v58, v58
v_exp_f32 v59, v59
v_cvt_pk_bf16_f32 v78, v56, v57
v_cvt_pk_bf16_f32 v79, v58, v59
v_mov_b32 v80, 0
v_mov_b32 v81, 0
v_mov_b32 v82, 0
v_mov_b32 v83, 0
v_add_f32 v244, v12, v236
v_add_f32 v245, v13, v237
v_add_f32 v246, v14, v238
v_add_f32 v247, v15, v239
v_mfma_f32_16x16x32_bf16 v[36:39], v[100:103], a[32:35], v[236:239]
v_mfma_f32_16x16x32_bf16 v[36:39], v[104:107], a[36:39], v[36:39]
v_mfma_f32_16x16x32_bf16 v[36:39], v[108:111], a[40:43], v[36:39]
v_mfma_f32_16x16x32_bf16 v[36:39], v[112:115], a[44:47], v[36:39]
v_mfma_f32_16x16x32_bf16 v[40:43], v[116:119], a[32:35], v[236:239]
v_mfma_f32_16x16x32_bf16 v[40:43], v[120:123], a[36:39], v[40:43]
v_mfma_f32_16x16x32_bf16 v[40:43], v[124:127], a[40:43], v[40:43]
v_mfma_f32_16x16x32_bf16 v[40:43], v[128:131], a[44:47], v[40:43]
v_mfma_f32_16x16x32_bf16 v[44:47], v[132:135], a[32:35], v[244:247]
v_mfma_f32_16x16x32_bf16 v[44:47], v[136:139], a[36:39], v[44:47]
v_mfma_f32_16x16x32_bf16 v[44:47], v[140:143], a[40:43], v[44:47]
v_mfma_f32_16x16x32_bf16 v[44:47], v[144:147], a[44:47], v[44:47]
v_exp_f32 v36, v36
v_exp_f32 v37, v37
v_exp_f32 v38, v38
v_exp_f32 v39, v39
v_cvt_pk_bf16_f32 v84, v36, v37
v_cvt_pk_bf16_f32 v85, v38, v39
v_exp_f32 v40, v40
v_exp_f32 v41, v41
v_exp_f32 v42, v42
v_exp_f32 v43, v43
v_cvt_pk_bf16_f32 v86, v40, v41
v_cvt_pk_bf16_f32 v87, v42, v43
v_exp_f32 v44, v44
v_exp_f32 v45, v45
v_exp_f32 v46, v46
v_exp_f32 v47, v47
v_cvt_pk_bf16_f32 v88, v44, v45
v_cvt_pk_bf16_f32 v89, v46, v47
v_mov_b32 v90, 0
v_mov_b32 v91, 0
v_add_f32 v244, v16, v240
v_add_f32 v245, v17, v241
v_add_f32 v246, v18, v242
v_add_f32 v247, v19, v243
v_mfma_f32_16x16x32_bf16 v[52:55], v[100:103], a[48:51], v[240:243]
v_mfma_f32_16x16x32_bf16 v[52:55], v[104:107], a[52:55], v[52:55]
v_mfma_f32_16x16x32_bf16 v[52:55], v[108:111], a[56:59], v[52:55]
v_mfma_f32_16x16x32_bf16 v[52:55], v[112:115], a[60:63], v[52:55]
v_mfma_f32_16x16x32_bf16 v[56:59], v[116:119], a[48:51], v[240:243]
v_mfma_f32_16x16x32_bf16 v[56:59], v[120:123], a[52:55], v[56:59]
v_mfma_f32_16x16x32_bf16 v[56:59], v[124:127], a[56:59], v[56:59]
v_mfma_f32_16x16x32_bf16 v[56:59], v[128:131], a[60:63], v[56:59]
v_mfma_f32_16x16x32_bf16 v[60:63], v[132:135], a[48:51], v[240:243]
v_mfma_f32_16x16x32_bf16 v[60:63], v[136:139], a[52:55], v[60:63]
v_mfma_f32_16x16x32_bf16 v[60:63], v[140:143], a[56:59], v[60:63]
v_mfma_f32_16x16x32_bf16 v[60:63], v[144:147], a[60:63], v[60:63]
v_mfma_f32_16x16x32_bf16 v[64:67], v[148:151], a[48:51], v[244:247]
v_mfma_f32_16x16x32_bf16 v[64:67], v[152:155], a[52:55], v[64:67]
v_mfma_f32_16x16x32_bf16 v[64:67], v[156:159], a[56:59], v[64:67]
v_mfma_f32_16x16x32_bf16 v[64:67], v[160:163], a[60:63], v[64:67]
v_exp_f32 v52, v52
v_exp_f32 v53, v53
v_exp_f32 v54, v54
v_exp_f32 v55, v55
v_cvt_pk_bf16_f32 v92, v52, v53
v_cvt_pk_bf16_f32 v93, v54, v55
v_exp_f32 v56, v56
v_exp_f32 v57, v57
v_exp_f32 v58, v58
v_exp_f32 v59, v59
v_cvt_pk_bf16_f32 v94, v56, v57
v_cvt_pk_bf16_f32 v95, v58, v59
v_exp_f32 v60, v60
v_exp_f32 v61, v61
v_exp_f32 v62, v62
v_exp_f32 v63, v63
v_cvt_pk_bf16_f32 v96, v60, v61
v_cvt_pk_bf16_f32 v97, v62, v63
v_exp_f32 v64, v64
v_exp_f32 v65, v65
v_exp_f32 v66, v66
v_exp_f32 v67, v67
v_cvt_pk_bf16_f32 v98, v64, v65
v_cvt_pk_bf16_f32 v99, v66, v67
v_mfma_f32_16x16x32_bf16 a[128:131], v[164:167], v[68:71], a[128:131]
s_waitcnt lgkmcnt(0)
v_mfma_f32_16x16x32_bf16 a[128:131], v[168:171], v[72:75], a[128:131]
v_mfma_f32_16x16x32_bf16 a[132:135], v[172:175], v[68:71], a[132:135]
v_mfma_f32_16x16x32_bf16 a[132:135], v[176:179], v[72:75], a[132:135]
v_mfma_f32_16x16x32_bf16 a[136:139], v[180:183], v[68:71], a[136:139]
v_mfma_f32_16x16x32_bf16 a[136:139], v[184:187], v[72:75], a[136:139]
v_mfma_f32_16x16x32_bf16 a[140:143], v[188:191], v[68:71], a[140:143]
v_mfma_f32_16x16x32_bf16 a[140:143], v[192:195], v[72:75], a[140:143]
v_mfma_f32_16x16x32_bf16 a[144:147], v[196:199], v[68:71], a[144:147]
v_mfma_f32_16x16x32_bf16 a[144:147], v[200:203], v[72:75], a[144:147]
v_mfma_f32_16x16x32_bf16 a[148:151], v[204:207], v[68:71], a[148:151]
v_mfma_f32_16x16x32_bf16 a[148:151], v[208:211], v[72:75], a[148:151]
v_mfma_f32_16x16x32_bf16 a[152:155], v[212:215], v[68:71], a[152:155]
v_mfma_f32_16x16x32_bf16 a[152:155], v[216:219], v[72:75], a[152:155]
v_mfma_f32_16x16x32_bf16 a[156:159], v[220:223], v[68:71], a[156:159]
v_mfma_f32_16x16x32_bf16 a[156:159], v[224:227], v[72:75], a[156:159]
v_mfma_f32_16x16x32_bf16 v[20:23], v[8:11], v[68:71], v[20:23]
v_mfma_f32_16x16x32_bf16 v[20:23], v[8:11], v[72:75], v[20:23]
v_mfma_f32_16x16x32_bf16 a[160:163], v[164:167], v[76:79], a[160:163]
v_mfma_f32_16x16x32_bf16 a[160:163], v[168:171], v[80:83], a[160:163]
v_mfma_f32_16x16x32_bf16 a[164:167], v[172:175], v[76:79], a[164:167]
v_mfma_f32_16x16x32_bf16 a[164:167], v[176:179], v[80:83], a[164:167]
v_mfma_f32_16x16x32_bf16 a[168:171], v[180:183], v[76:79], a[168:171]
v_mfma_f32_16x16x32_bf16 a[168:171], v[184:187], v[80:83], a[168:171]
v_mfma_f32_16x16x32_bf16 a[172:175], v[188:191], v[76:79], a[172:175]
v_mfma_f32_16x16x32_bf16 a[172:175], v[192:195], v[80:83], a[172:175]
v_mfma_f32_16x16x32_bf16 a[176:179], v[196:199], v[76:79], a[176:179]
v_mfma_f32_16x16x32_bf16 a[176:179], v[200:203], v[80:83], a[176:179]
v_mfma_f32_16x16x32_bf16 a[180:183], v[204:207], v[76:79], a[180:183]
v_mfma_f32_16x16x32_bf16 a[180:183], v[208:211], v[80:83], a[180:183]
v_mfma_f32_16x16x32_bf16 a[184:187], v[212:215], v[76:79], a[184:187]
v_mfma_f32_16x16x32_bf16 a[184:187], v[216:219], v[80:83], a[184:187]
v_mfma_f32_16x16x32_bf16 a[188:191], v[220:223], v[76:79], a[188:191]
v_mfma_f32_16x16x32_bf16 a[188:191], v[224:227], v[80:83], a[188:191]
v_mfma_f32_16x16x32_bf16 v[24:27], v[8:11], v[76:79], v[24:27]
v_mfma_f32_16x16x32_bf16 v[24:27], v[8:11], v[80:83], v[24:27]
v_mfma_f32_16x16x32_bf16 a[192:195], v[164:167], v[84:87], a[192:195]
v_mfma_f32_16x16x32_bf16 a[192:195], v[168:171], v[88:91], a[192:195]
v_mfma_f32_16x16x32_bf16 a[196:199], v[172:175], v[84:87], a[196:199]
v_mfma_f32_16x16x32_bf16 a[196:199], v[176:179], v[88:91], a[196:199]
v_mfma_f32_16x16x32_bf16 a[200:203], v[180:183], v[84:87], a[200:203]
v_mfma_f32_16x16x32_bf16 a[200:203], v[184:187], v[88:91], a[200:203]
v_mfma_f32_16x16x32_bf16 a[204:207], v[188:191], v[84:87], a[204:207]
v_mfma_f32_16x16x32_bf16 a[204:207], v[192:195], v[88:91], a[204:207]
v_mfma_f32_16x16x32_bf16 a[208:211], v[196:199], v[84:87], a[208:211]
v_mfma_f32_16x16x32_bf16 a[208:211], v[200:203], v[88:91], a[208:211]
v_mfma_f32_16x16x32_bf16 a[212:215], v[204:207], v[84:87], a[212:215]
v_mfma_f32_16x16x32_bf16 a[212:215], v[208:211], v[88:91], a[212:215]
v_mfma_f32_16x16x32_bf16 a[216:219], v[212:215], v[84:87], a[216:219]
v_mfma_f32_16x16x32_bf16 a[216:219], v[216:219], v[88:91], a[216:219]
v_mfma_f32_16x16x32_bf16 a[220:223], v[220:223], v[84:87], a[220:223]
v_mfma_f32_16x16x32_bf16 a[220:223], v[224:227], v[88:91], a[220:223]
v_mfma_f32_16x16x32_bf16 v[28:31], v[8:11], v[84:87], v[28:31]
v_mfma_f32_16x16x32_bf16 v[28:31], v[8:11], v[88:91], v[28:31]
v_mfma_f32_16x16x32_bf16 a[224:227], v[164:167], v[92:95], a[224:227]
v_mfma_f32_16x16x32_bf16 a[224:227], v[168:171], v[96:99], a[224:227]
v_mfma_f32_16x16x32_bf16 a[228:231], v[172:175], v[92:95], a[228:231]
v_mfma_f32_16x16x32_bf16 a[228:231], v[176:179], v[96:99], a[228:231]
v_mfma_f32_16x16x32_bf16 a[232:235], v[180:183], v[92:95], a[232:235]
v_mfma_f32_16x16x32_bf16 a[232:235], v[184:187], v[96:99], a[232:235]
v_mfma_f32_16x16x32_bf16 a[236:239], v[188:191], v[92:95], a[236:239]
v_mfma_f32_16x16x32_bf16 a[236:239], v[192:195], v[96:99], a[236:239]
v_mfma_f32_16x16x32_bf16 a[240:243], v[196:199], v[92:95], a[240:243]
v_mfma_f32_16x16x32_bf16 a[240:243], v[200:203], v[96:99], a[240:243]
v_mfma_f32_16x16x32_bf16 a[244:247], v[204:207], v[92:95], a[244:247]
v_mfma_f32_16x16x32_bf16 a[244:247], v[208:211], v[96:99], a[244:247]
v_mfma_f32_16x16x32_bf16 a[248:251], v[212:215], v[92:95], a[248:251]
v_mfma_f32_16x16x32_bf16 a[248:251], v[216:219], v[96:99], a[248:251]
v_mfma_f32_16x16x32_bf16 a[252:255], v[220:223], v[92:95], a[252:255]
v_mfma_f32_16x16x32_bf16 a[252:255], v[224:227], v[96:99], a[252:255]
v_mfma_f32_16x16x32_bf16 v[32:35], v[8:11], v[92:95], v[32:35]
v_mfma_f32_16x16x32_bf16 v[32:35], v[8:11], v[96:99], v[32:35]
s_cmp_eq_u32 s54, 1
s_cbranch_scc1 L_safe_f1
s_lshl_b32 s51, s48, 13
v_add_u32 v228, s51, v1
s_sub_u32 s52, s51, 0
v_xor_b32 v229, 196608, v3
v_add_u32 v229, s52, v229
v_xor_b32 v230, 65536, v2
v_and_b32 v230, 0x38000, v230
v_lshrrev_b32 v231, 2, v1
s_lshl_b32 s52, s48, 10
s_add_u32 s52, s52, 4096
v_add3_u32 v231, v230, v231, s52
v_and_b32 v232, 63, v231
v_add3_u32 v230, v230, v232, s52
v_xor_b32 v232, 0x400, v230
s_waitcnt lgkmcnt(0)
s_barrier
ds_write_b32 v231, v20 offset:0
ds_write_b32 v231, v24 offset:256
ds_write_b32 v231, v28 offset:512
ds_write_b32 v231, v32 offset:768
ds_write_b128 v228, a[192:195] offset:0
s_lshl_b32 s51, s63, 3
s_add_u32 s51, s51, 0
s_add_u32 s52, s51, s55
s_sub_u32 s53, s51, s55
ds_write_b128 v228, a[196:199] offset:1024
s_add_u32 s53, s53, 3
s_mul_i32 s52, s52, 186368
s_mul_i32 s53, s53, 186368
s_lshl_b32 s51, s49, 12
ds_write_b128 v228, a[200:203] offset:2048
s_add_u32 s51, s51, 37804032
s_add_u32 s52, s52, s51
s_add_u32 s53, s53, s51
v_accvgpr_read_b32 v28, a128
ds_write_b128 v228, a[204:207] offset:3072
v_accvgpr_read_b32 v29, a129
v_accvgpr_read_b32 v30, a130
v_accvgpr_read_b32 v31, a131
v_accvgpr_read_b32 v32, a132
ds_write_b128 v228, a[208:211] offset:4096
v_accvgpr_read_b32 v33, a133
v_accvgpr_read_b32 v34, a134
v_accvgpr_read_b32 v35, a135
v_accvgpr_read_b32 v36, a136
ds_write_b128 v228, a[212:215] offset:5120
v_accvgpr_read_b32 v37, a137
v_accvgpr_read_b32 v38, a138
v_accvgpr_read_b32 v39, a139
v_accvgpr_read_b32 v40, a140
ds_write_b128 v228, a[216:219] offset:6144
v_accvgpr_read_b32 v41, a141
v_accvgpr_read_b32 v42, a142
v_accvgpr_read_b32 v43, a143
v_accvgpr_read_b32 v44, a144
ds_write_b128 v228, a[220:223] offset:7168
v_accvgpr_read_b32 v45, a145
v_accvgpr_read_b32 v46, a146
v_accvgpr_read_b32 v47, a147
v_accvgpr_read_b32 v48, a148
ds_write_b128 v229, a[224:227] offset:0
v_accvgpr_read_b32 v49, a149
v_accvgpr_read_b32 v50, a150
v_accvgpr_read_b32 v51, a151
v_accvgpr_read_b32 v84, a152
ds_write_b128 v229, a[228:231] offset:1024
v_accvgpr_read_b32 v85, a153
v_accvgpr_read_b32 v86, a154
v_accvgpr_read_b32 v87, a155
v_accvgpr_read_b32 v88, a156
ds_write_b128 v229, a[232:235] offset:2048
v_accvgpr_read_b32 v89, a157
v_accvgpr_read_b32 v90, a158
v_accvgpr_read_b32 v91, a159
v_accvgpr_read_b32 v92, a160
ds_write_b128 v229, a[236:239] offset:3072
v_accvgpr_read_b32 v93, a161
v_accvgpr_read_b32 v94, a162
v_accvgpr_read_b32 v95, a163
v_accvgpr_read_b32 v96, a164
ds_write_b128 v229, a[240:243] offset:4096
v_accvgpr_read_b32 v97, a165
v_accvgpr_read_b32 v98, a166
v_accvgpr_read_b32 v99, a167
ds_write_b128 v229, a[244:247] offset:5120
ds_write_b128 v229, a[248:251] offset:6144
ds_write_b128 v229, a[252:255] offset:7168
v_xor_b32 v228, 0x2000, v228
v_xor_b32 v229, 0x2000, v229
s_waitcnt lgkmcnt(0)
s_barrier
ds_read_b32 v233, v230 offset:0
ds_read_b32 v234, v232 offset:0
ds_read_b32 v235, v230 offset:256
ds_read_b32 v236, v232 offset:256
ds_read_b128 v[244:247], v228 offset:0
ds_read_b128 v[248:251], v228 offset:1024
ds_read_b128 v[20:23], v228 offset:2048
ds_read_b128 v[24:27], v228 offset:3072
s_mov_b32 s86, 0x2b800000
s_mov_b32 s87, 0x5d800000
s_waitcnt lgkmcnt(6)
v_add_f32 v233, v233, v234
v_cmp_nle_f32 s[32:33], s86, v233
v_cmp_nge_f32 s[34:35], s87, v233
v_rcp_f32 v234, v233
s_waitcnt lgkmcnt(4)
v_add_f32 v235, v235, v236
v_cmp_nle_f32 s[96:97], s86, v235
v_cmp_nge_f32 s[98:99], s87, v235
v_rcp_f32 v236, v235
s_waitcnt lgkmcnt(3)
v_pk_add_f32 v[28:29], v[28:29], v[244:245]
v_pk_add_f32 v[30:31], v[30:31], v[246:247]
s_waitcnt lgkmcnt(2)
v_pk_add_f32 v[32:33], v[32:33], v[248:249]
v_pk_add_f32 v[34:35], v[34:35], v[250:251]
ds_read_b128 v[244:247], v228 offset:4096
ds_read_b128 v[248:251], v228 offset:5120
v_pk_mul_f32 v[28:29], v[28:29], v[234:235] op_sel_hi:[1,0]
v_pk_mul_f32 v[30:31], v[30:31], v[234:235] op_sel_hi:[1,0]
v_pk_mul_f32 v[32:33], v[32:33], v[234:235] op_sel_hi:[1,0]
v_pk_mul_f32 v[34:35], v[34:35], v[234:235] op_sel_hi:[1,0]
v_cvt_pk_bf16_f32 v28, v28, v29
v_cvt_pk_bf16_f32 v29, v30, v31
v_cvt_pk_bf16_f32 v30, v32, v33
v_cvt_pk_bf16_f32 v31, v34, v35
buffer_store_dwordx4 v[28:31], v1, s[4:7], s52 offen offset:0 sc1
s_nop 0
v_mfma_f32_16x16x32_bf16 v[240:243], v[8:11], v[28:31], 0
v_accvgpr_read_b32 v28, a168
v_accvgpr_read_b32 v29, a169
v_accvgpr_read_b32 v30, a170
v_accvgpr_read_b32 v31, a171
v_accvgpr_read_b32 v32, a172
v_accvgpr_read_b32 v33, a173
v_accvgpr_read_b32 v34, a174
v_accvgpr_read_b32 v35, a175
s_waitcnt lgkmcnt(3)
v_pk_add_f32 v[36:37], v[36:37], v[20:21]
v_pk_add_f32 v[38:39], v[38:39], v[22:23]
s_waitcnt lgkmcnt(2)
v_pk_add_f32 v[40:41], v[40:41], v[24:25]
v_pk_add_f32 v[42:43], v[42:43], v[26:27]
ds_read_b128 v[20:23], v228 offset:6144
ds_read_b128 v[24:27], v228 offset:7168
v_pk_mul_f32 v[36:37], v[36:37], v[234:235] op_sel_hi:[1,0]
v_pk_mul_f32 v[38:39], v[38:39], v[234:235] op_sel_hi:[1,0]
v_pk_mul_f32 v[40:41], v[40:41], v[234:235] op_sel_hi:[1,0]
v_pk_mul_f32 v[42:43], v[42:43], v[234:235] op_sel_hi:[1,0]
v_cvt_pk_bf16_f32 v36, v36, v37
v_cvt_pk_bf16_f32 v37, v38, v39
v_cvt_pk_bf16_f32 v38, v40, v41
v_cvt_pk_bf16_f32 v39, v42, v43
buffer_store_dwordx4 v[36:39], v1, s[4:7], s52 offen offset:1024 sc1
s_nop 0
v_mfma_f32_16x16x32_bf16 v[240:243], v[8:11], v[36:39], v[240:243]
v_accvgpr_read_b32 v36, a176
v_accvgpr_read_b32 v37, a177
v_accvgpr_read_b32 v38, a178
v_accvgpr_read_b32 v39, a179
v_accvgpr_read_b32 v40, a180
v_accvgpr_read_b32 v41, a181
v_accvgpr_read_b32 v42, a182
v_accvgpr_read_b32 v43, a183
s_waitcnt lgkmcnt(2)
v_pk_add_f32 v[44:45], v[44:45], v[244:245]
v_pk_add_f32 v[46:47], v[46:47], v[246:247]
v_pk_add_f32 v[48:49], v[48:49], v[248:249]
v_pk_add_f32 v[50:51], v[50:51], v[250:251]
ds_read_b128 v[244:247], v229 offset:0
ds_read_b128 v[248:251], v229 offset:1024
v_pk_mul_f32 v[44:45], v[44:45], v[234:235] op_sel_hi:[1,0]
v_pk_mul_f32 v[46:47], v[46:47], v[234:235] op_sel_hi:[1,0]
v_pk_mul_f32 v[48:49], v[48:49], v[234:235] op_sel_hi:[1,0]
v_pk_mul_f32 v[50:51], v[50:51], v[234:235] op_sel_hi:[1,0]
v_cvt_pk_bf16_f32 v44, v44, v45
v_cvt_pk_bf16_f32 v45, v46, v47
v_cvt_pk_bf16_f32 v46, v48, v49
v_cvt_pk_bf16_f32 v47, v50, v51
buffer_store_dwordx4 v[44:47], v1, s[4:7], s52 offen offset:2048 sc1
s_nop 0
v_mfma_f32_16x16x32_bf16 v[240:243], v[8:11], v[44:47], v[240:243]
v_accvgpr_read_b32 v44, a184
v_accvgpr_read_b32 v45, a185
v_accvgpr_read_b32 v46, a186
v_accvgpr_read_b32 v47, a187
v_accvgpr_read_b32 v48, a188
v_accvgpr_read_b32 v49, a189
v_accvgpr_read_b32 v50, a190
v_accvgpr_read_b32 v51, a191
s_waitcnt lgkmcnt(2)
v_pk_add_f32 v[84:85], v[84:85], v[20:21]
v_pk_add_f32 v[86:87], v[86:87], v[22:23]
v_pk_add_f32 v[88:89], v[88:89], v[24:25]
v_pk_add_f32 v[90:91], v[90:91], v[26:27]
ds_read_b128 v[20:23], v229 offset:2048
ds_read_b128 v[24:27], v229 offset:3072
v_pk_mul_f32 v[84:85], v[84:85], v[234:235] op_sel_hi:[1,0]
v_pk_mul_f32 v[86:87], v[86:87], v[234:235] op_sel_hi:[1,0]
v_pk_mul_f32 v[88:89], v[88:89], v[234:235] op_sel_hi:[1,0]
v_pk_mul_f32 v[90:91], v[90:91], v[234:235] op_sel_hi:[1,0]
v_cvt_pk_bf16_f32 v84, v84, v85
v_cvt_pk_bf16_f32 v85, v86, v87
v_cvt_pk_bf16_f32 v86, v88, v89
v_cvt_pk_bf16_f32 v87, v90, v91
buffer_store_dwordx4 v[84:87], v1, s[4:7], s52 offen offset:3072 sc1
s_nop 0
v_mfma_f32_16x16x32_bf16 v[240:243], v[8:11], v[84:87], v[240:243]
s_waitcnt lgkmcnt(3)
v_pk_add_f32 v[92:93], v[92:93], v[244:245]
v_pk_add_f32 v[94:95], v[94:95], v[246:247]
s_waitcnt lgkmcnt(2)
v_pk_add_f32 v[96:97], v[96:97], v[248:249]
v_pk_add_f32 v[98:99], v[98:99], v[250:251]
ds_read_b128 v[244:247], v229 offset:4096
ds_read_b128 v[248:251], v229 offset:5120
v_pk_mul_f32 v[92:93], v[92:93], v[236:237] op_sel_hi:[1,0]
v_pk_mul_f32 v[94:95], v[94:95], v[236:237] op_sel_hi:[1,0]
v_pk_mul_f32 v[96:97], v[96:97], v[236:237] op_sel_hi:[1,0]
v_pk_mul_f32 v[98:99], v[98:99], v[236:237] op_sel_hi:[1,0]
v_cvt_pk_bf16_f32 v92, v92, v93
v_cvt_pk_bf16_f32 v93, v94, v95
v_cvt_pk_bf16_f32 v94, v96, v97
v_cvt_pk_bf16_f32 v95, v98, v99
buffer_store_dwordx4 v[92:95], v1, s[4:7], s53 offen offset:0 sc1
s_nop 0
v_mfma_f32_16x16x32_bf16 v[240:243], v[8:11], v[92:95], v[240:243]
s_waitcnt lgkmcnt(3)
v_pk_add_f32 v[28:29], v[28:29], v[20:21]
v_pk_add_f32 v[30:31], v[30:31], v[22:23]
s_waitcnt lgkmcnt(2)
v_pk_add_f32 v[32:33], v[32:33], v[24:25]
v_pk_add_f32 v[34:35], v[34:35], v[26:27]
ds_read_b128 v[20:23], v229 offset:6144
ds_read_b128 v[24:27], v229 offset:7168
v_pk_mul_f32 v[28:29], v[28:29], v[236:237] op_sel_hi:[1,0]
v_pk_mul_f32 v[30:31], v[30:31], v[236:237] op_sel_hi:[1,0]
v_pk_mul_f32 v[32:33], v[32:33], v[236:237] op_sel_hi:[1,0]
v_pk_mul_f32 v[34:35], v[34:35], v[236:237] op_sel_hi:[1,0]
v_cvt_pk_bf16_f32 v28, v28, v29
v_cvt_pk_bf16_f32 v29, v30, v31
v_cvt_pk_bf16_f32 v30, v32, v33
v_cvt_pk_bf16_f32 v31, v34, v35
buffer_store_dwordx4 v[28:31], v1, s[4:7], s53 offen offset:1024 sc1
s_nop 0
v_mfma_f32_16x16x32_bf16 v[240:243], v[8:11], v[28:31], v[240:243]
s_waitcnt lgkmcnt(3)
v_pk_add_f32 v[36:37], v[36:37], v[244:245]
v_pk_add_f32 v[38:39], v[38:39], v[246:247]
s_waitcnt lgkmcnt(2)
v_pk_add_f32 v[40:41], v[40:41], v[248:249]
v_pk_add_f32 v[42:43], v[42:43], v[250:251]
v_pk_mul_f32 v[36:37], v[36:37], v[236:237] op_sel_hi:[1,0]
v_pk_mul_f32 v[38:39], v[38:39], v[236:237] op_sel_hi:[1,0]
v_pk_mul_f32 v[40:41], v[40:41], v[236:237] op_sel_hi:[1,0]
v_pk_mul_f32 v[42:43], v[42:43], v[236:237] op_sel_hi:[1,0]
v_cvt_pk_bf16_f32 v36, v36, v37
v_cvt_pk_bf16_f32 v37, v38, v39
v_cvt_pk_bf16_f32 v38, v40, v41
v_cvt_pk_bf16_f32 v39, v42, v43
buffer_store_dwordx4 v[36:39], v1, s[4:7], s53 offen offset:2048 sc1
s_nop 0
v_mfma_f32_16x16x32_bf16 v[240:243], v[8:11], v[36:39], v[240:243]
s_waitcnt lgkmcnt(1)
v_pk_add_f32 v[44:45], v[44:45], v[20:21]
v_pk_add_f32 v[46:47], v[46:47], v[22:23]
s_waitcnt lgkmcnt(0)
v_pk_add_f32 v[48:49], v[48:49], v[24:25]
v_pk_add_f32 v[50:51], v[50:51], v[26:27]
v_pk_mul_f32 v[44:45], v[44:45], v[236:237] op_sel_hi:[1,0]
v_pk_mul_f32 v[46:47], v[46:47], v[236:237] op_sel_hi:[1,0]
v_pk_mul_f32 v[48:49], v[48:49], v[236:237] op_sel_hi:[1,0]
v_pk_mul_f32 v[50:51], v[50:51], v[236:237] op_sel_hi:[1,0]
v_cvt_pk_bf16_f32 v44, v44, v45
v_cvt_pk_bf16_f32 v45, v46, v47
v_cvt_pk_bf16_f32 v46, v48, v49
v_cvt_pk_bf16_f32 v47, v50, v51
buffer_store_dwordx4 v[44:47], v1, s[4:7], s53 offen offset:3072 sc1
s_nop 0
v_mfma_f32_16x16x32_bf16 v[240:243], v[8:11], v[44:47], v[240:243]
s_or_b64 s[66:67], s[66:67], s[32:33]
s_or_b64 s[66:67], s[66:67], s[34:35]
s_or_b64 s[66:67], s[66:67], s[96:97]
s_or_b64 s[66:67], s[66:67], s[98:99]
s_nop 3
v_cmp_u_f32 vcc, v241, v241
s_nop 3
s_or_b64 s[66:67], s[66:67], vcc
s_branch L_safe_next
L_safe_f1:
s_lshl_b32 s51, s48, 13
v_add_u32 v228, s51, v1
s_sub_u32 s52, s51, 16384
v_xor_b32 v229, 196608, v3
v_add_u32 v229, s52, v229
v_xor_b32 v230, 65536, v2
v_and_b32 v230, 0x38000, v230
v_lshrrev_b32 v231, 2, v1
s_lshl_b32 s52, s48, 10
s_add_u32 s52, s52, 4096
v_add3_u32 v231, v230, v231, s52
v_and_b32 v232, 63, v231
v_add3_u32 v230, v230, v232, s52
v_xor_b32 v232, 0x400, v230
s_waitcnt lgkmcnt(0)
s_barrier
ds_write_b32 v231, v20 offset:0
ds_write_b32 v231, v24 offset:256
ds_write_b32 v231, v28 offset:512
ds_write_b32 v231, v32 offset:768
ds_write_b128 v228, a[128:131] offset:0
s_lshl_b32 s51, s63, 3
s_add_u32 s51, s51, 4
s_add_u32 s52, s51, s55
s_sub_u32 s53, s51, s55
ds_write_b128 v228, a[132:135] offset:1024
s_add_u32 s53, s53, 3
s_mul_i32 s52, s52, 186368
s_mul_i32 s53, s53, 186368
s_lshl_b32 s51, s49, 12
ds_write_b128 v228, a[136:139] offset:2048
s_add_u32 s51, s51, 37804032
s_add_u32 s52, s52, s51
s_add_u32 s53, s53, s51
v_accvgpr_read_b32 v28, a192
ds_write_b128 v228, a[140:143] offset:3072
v_accvgpr_read_b32 v29, a193
v_accvgpr_read_b32 v30, a194
v_accvgpr_read_b32 v31, a195
v_accvgpr_read_b32 v32, a196
ds_write_b128 v228, a[144:147] offset:4096
v_accvgpr_read_b32 v33, a197
v_accvgpr_read_b32 v34, a198
v_accvgpr_read_b32 v35, a199
v_accvgpr_read_b32 v36, a200
ds_write_b128 v228, a[148:151] offset:5120
v_accvgpr_read_b32 v37, a201
v_accvgpr_read_b32 v38, a202
v_accvgpr_read_b32 v39, a203
v_accvgpr_read_b32 v40, a204
ds_write_b128 v228, a[152:155] offset:6144
v_accvgpr_read_b32 v41, a205
v_accvgpr_read_b32 v42, a206
v_accvgpr_read_b32 v43, a207
v_accvgpr_read_b32 v44, a208
ds_write_b128 v228, a[156:159] offset:7168
v_accvgpr_read_b32 v45, a209
v_accvgpr_read_b32 v46, a210
v_accvgpr_read_b32 v47, a211
v_accvgpr_read_b32 v48, a212
ds_write_b128 v229, a[160:163] offset:0
v_accvgpr_read_b32 v49, a213
v_accvgpr_read_b32 v50, a214
v_accvgpr_read_b32 v51, a215
v_accvgpr_read_b32 v84, a216
ds_write_b128 v229, a[164:167] offset:1024
v_accvgpr_read_b32 v85, a217
v_accvgpr_read_b32 v86, a218
v_accvgpr_read_b32 v87, a219
v_accvgpr_read_b32 v88, a220
ds_write_b128 v229, a[168:171] offset:2048
v_accvgpr_read_b32 v89, a221
v_accvgpr_read_b32 v90, a222
v_accvgpr_read_b32 v91, a223
v_accvgpr_read_b32 v92, a224
ds_write_b128 v229, a[172:175] offset:3072
v_accvgpr_read_b32 v93, a225
v_accvgpr_read_b32 v94, a226
v_accvgpr_read_b32 v95, a227
v_accvgpr_read_b32 v96, a228
ds_write_b128 v229, a[176:179] offset:4096
v_accvgpr_read_b32 v97, a229
v_accvgpr_read_b32 v98, a230
v_accvgpr_read_b32 v99, a231
ds_write_b128 v229, a[180:183] offset:5120
ds_write_b128 v229, a[184:187] offset:6144
ds_write_b128 v229, a[188:191] offset:7168
v_xor_b32 v228, 0x2000, v228
v_xor_b32 v229, 0x2000, v229
s_waitcnt lgkmcnt(0)
s_barrier
ds_read_b32 v233, v230 offset:512
ds_read_b32 v234, v232 offset:512
ds_read_b32 v235, v230 offset:768
ds_read_b32 v236, v232 offset:768
ds_read_b128 v[244:247], v228 offset:0
ds_read_b128 v[248:251], v228 offset:1024
ds_read_b128 v[20:23], v228 offset:2048
ds_read_b128 v[24:27], v228 offset:3072
s_mov_b32 s86, 0x2b800000
s_mov_b32 s87, 0x5d800000
s_waitcnt lgkmcnt(6)
v_add_f32 v233, v233, v234
v_cmp_nle_f32 s[32:33], s86, v233
v_cmp_nge_f32 s[34:35], s87, v233
v_rcp_f32 v234, v233
s_waitcnt lgkmcnt(4)
v_add_f32 v235, v235, v236
v_cmp_nle_f32 s[96:97], s86, v235
v_cmp_nge_f32 s[98:99], s87, v235
v_rcp_f32 v236, v235
s_waitcnt lgkmcnt(3)
v_pk_add_f32 v[28:29], v[28:29], v[244:245]
v_pk_add_f32 v[30:31], v[30:31], v[246:247]
s_waitcnt lgkmcnt(2)
v_pk_add_f32 v[32:33], v[32:33], v[248:249]
v_pk_add_f32 v[34:35], v[34:35], v[250:251]
ds_read_b128 v[244:247], v228 offset:4096
ds_read_b128 v[248:251], v228 offset:5120
v_pk_mul_f32 v[28:29], v[28:29], v[234:235] op_sel_hi:[1,0]
v_pk_mul_f32 v[30:31], v[30:31], v[234:235] op_sel_hi:[1,0]
v_pk_mul_f32 v[32:33], v[32:33], v[234:235] op_sel_hi:[1,0]
v_pk_mul_f32 v[34:35], v[34:35], v[234:235] op_sel_hi:[1,0]
v_cvt_pk_bf16_f32 v28, v28, v29
v_cvt_pk_bf16_f32 v29, v30, v31
v_cvt_pk_bf16_f32 v30, v32, v33
v_cvt_pk_bf16_f32 v31, v34, v35
buffer_store_dwordx4 v[28:31], v1, s[4:7], s52 offen offset:0 sc1
s_nop 0
v_mfma_f32_16x16x32_bf16 v[240:243], v[8:11], v[28:31], 0
v_accvgpr_read_b32 v28, a232
v_accvgpr_read_b32 v29, a233
v_accvgpr_read_b32 v30, a234
v_accvgpr_read_b32 v31, a235
v_accvgpr_read_b32 v32, a236
v_accvgpr_read_b32 v33, a237
v_accvgpr_read_b32 v34, a238
v_accvgpr_read_b32 v35, a239
s_waitcnt lgkmcnt(3)
v_pk_add_f32 v[36:37], v[36:37], v[20:21]
v_pk_add_f32 v[38:39], v[38:39], v[22:23]
s_waitcnt lgkmcnt(2)
v_pk_add_f32 v[40:41], v[40:41], v[24:25]
v_pk_add_f32 v[42:43], v[42:43], v[26:27]
ds_read_b128 v[20:23], v228 offset:6144
ds_read_b128 v[24:27], v228 offset:7168
v_pk_mul_f32 v[36:37], v[36:37], v[234:235] op_sel_hi:[1,0]
v_pk_mul_f32 v[38:39], v[38:39], v[234:235] op_sel_hi:[1,0]
v_pk_mul_f32 v[40:41], v[40:41], v[234:235] op_sel_hi:[1,0]
v_pk_mul_f32 v[42:43], v[42:43], v[234:235] op_sel_hi:[1,0]
v_cvt_pk_bf16_f32 v36, v36, v37
v_cvt_pk_bf16_f32 v37, v38, v39
v_cvt_pk_bf16_f32 v38, v40, v41
v_cvt_pk_bf16_f32 v39, v42, v43
buffer_store_dwordx4 v[36:39], v1, s[4:7], s52 offen offset:1024 sc1
s_nop 0
v_mfma_f32_16x16x32_bf16 v[240:243], v[8:11], v[36:39], v[240:243]
v_accvgpr_read_b32 v36, a240
v_accvgpr_read_b32 v37, a241
v_accvgpr_read_b32 v38, a242
v_accvgpr_read_b32 v39, a243
v_accvgpr_read_b32 v40, a244
v_accvgpr_read_b32 v41, a245
v_accvgpr_read_b32 v42, a246
v_accvgpr_read_b32 v43, a247
s_waitcnt lgkmcnt(2)
v_pk_add_f32 v[44:45], v[44:45], v[244:245]
v_pk_add_f32 v[46:47], v[46:47], v[246:247]
v_pk_add_f32 v[48:49], v[48:49], v[248:249]
v_pk_add_f32 v[50:51], v[50:51], v[250:251]
ds_read_b128 v[244:247], v229 offset:0
ds_read_b128 v[248:251], v229 offset:1024
v_pk_mul_f32 v[44:45], v[44:45], v[234:235] op_sel_hi:[1,0]
v_pk_mul_f32 v[46:47], v[46:47], v[234:235] op_sel_hi:[1,0]
v_pk_mul_f32 v[48:49], v[48:49], v[234:235] op_sel_hi:[1,0]
v_pk_mul_f32 v[50:51], v[50:51], v[234:235] op_sel_hi:[1,0]
v_cvt_pk_bf16_f32 v44, v44, v45
v_cvt_pk_bf16_f32 v45, v46, v47
v_cvt_pk_bf16_f32 v46, v48, v49
v_cvt_pk_bf16_f32 v47, v50, v51
buffer_store_dwordx4 v[44:47], v1, s[4:7], s52 offen offset:2048 sc1
s_nop 0
v_mfma_f32_16x16x32_bf16 v[240:243], v[8:11], v[44:47], v[240:243]
v_accvgpr_read_b32 v44, a248
v_accvgpr_read_b32 v45, a249
v_accvgpr_read_b32 v46, a250
v_accvgpr_read_b32 v47, a251
v_accvgpr_read_b32 v48, a252
v_accvgpr_read_b32 v49, a253
v_accvgpr_read_b32 v50, a254
v_accvgpr_read_b32 v51, a255
s_waitcnt lgkmcnt(2)
v_pk_add_f32 v[84:85], v[84:85], v[20:21]
v_pk_add_f32 v[86:87], v[86:87], v[22:23]
v_pk_add_f32 v[88:89], v[88:89], v[24:25]
v_pk_add_f32 v[90:91], v[90:91], v[26:27]
ds_read_b128 v[20:23], v229 offset:2048
ds_read_b128 v[24:27], v229 offset:3072
v_pk_mul_f32 v[84:85], v[84:85], v[234:235] op_sel_hi:[1,0]
v_pk_mul_f32 v[86:87], v[86:87], v[234:235] op_sel_hi:[1,0]
v_pk_mul_f32 v[88:89], v[88:89], v[234:235] op_sel_hi:[1,0]
v_pk_mul_f32 v[90:91], v[90:91], v[234:235] op_sel_hi:[1,0]
v_cvt_pk_bf16_f32 v84, v84, v85
v_cvt_pk_bf16_f32 v85, v86, v87
v_cvt_pk_bf16_f32 v86, v88, v89
v_cvt_pk_bf16_f32 v87, v90, v91
buffer_store_dwordx4 v[84:87], v1, s[4:7], s52 offen offset:3072 sc1
s_nop 0
v_mfma_f32_16x16x32_bf16 v[240:243], v[8:11], v[84:87], v[240:243]
s_waitcnt lgkmcnt(3)
v_pk_add_f32 v[92:93], v[92:93], v[244:245]
v_pk_add_f32 v[94:95], v[94:95], v[246:247]
s_waitcnt lgkmcnt(2)
v_pk_add_f32 v[96:97], v[96:97], v[248:249]
v_pk_add_f32 v[98:99], v[98:99], v[250:251]
ds_read_b128 v[244:247], v229 offset:4096
ds_read_b128 v[248:251], v229 offset:5120
v_pk_mul_f32 v[92:93], v[92:93], v[236:237] op_sel_hi:[1,0]
v_pk_mul_f32 v[94:95], v[94:95], v[236:237] op_sel_hi:[1,0]
v_pk_mul_f32 v[96:97], v[96:97], v[236:237] op_sel_hi:[1,0]
v_pk_mul_f32 v[98:99], v[98:99], v[236:237] op_sel_hi:[1,0]
v_cvt_pk_bf16_f32 v92, v92, v93
v_cvt_pk_bf16_f32 v93, v94, v95
v_cvt_pk_bf16_f32 v94, v96, v97
v_cvt_pk_bf16_f32 v95, v98, v99
buffer_store_dwordx4 v[92:95], v1, s[4:7], s53 offen offset:0 sc1
s_nop 0
v_mfma_f32_16x16x32_bf16 v[240:243], v[8:11], v[92:95], v[240:243]
s_waitcnt lgkmcnt(3)
v_pk_add_f32 v[28:29], v[28:29], v[20:21]
v_pk_add_f32 v[30:31], v[30:31], v[22:23]
s_waitcnt lgkmcnt(2)
v_pk_add_f32 v[32:33], v[32:33], v[24:25]
v_pk_add_f32 v[34:35], v[34:35], v[26:27]
ds_read_b128 v[20:23], v229 offset:6144
ds_read_b128 v[24:27], v229 offset:7168
v_pk_mul_f32 v[28:29], v[28:29], v[236:237] op_sel_hi:[1,0]
v_pk_mul_f32 v[30:31], v[30:31], v[236:237] op_sel_hi:[1,0]
v_pk_mul_f32 v[32:33], v[32:33], v[236:237] op_sel_hi:[1,0]
v_pk_mul_f32 v[34:35], v[34:35], v[236:237] op_sel_hi:[1,0]
v_cvt_pk_bf16_f32 v28, v28, v29
v_cvt_pk_bf16_f32 v29, v30, v31
v_cvt_pk_bf16_f32 v30, v32, v33
v_cvt_pk_bf16_f32 v31, v34, v35
buffer_store_dwordx4 v[28:31], v1, s[4:7], s53 offen offset:1024 sc1
s_nop 0
v_mfma_f32_16x16x32_bf16 v[240:243], v[8:11], v[28:31], v[240:243]
s_waitcnt lgkmcnt(3)
v_pk_add_f32 v[36:37], v[36:37], v[244:245]
v_pk_add_f32 v[38:39], v[38:39], v[246:247]
s_waitcnt lgkmcnt(2)
v_pk_add_f32 v[40:41], v[40:41], v[248:249]
v_pk_add_f32 v[42:43], v[42:43], v[250:251]
v_pk_mul_f32 v[36:37], v[36:37], v[236:237] op_sel_hi:[1,0]
v_pk_mul_f32 v[38:39], v[38:39], v[236:237] op_sel_hi:[1,0]
v_pk_mul_f32 v[40:41], v[40:41], v[236:237] op_sel_hi:[1,0]
v_pk_mul_f32 v[42:43], v[42:43], v[236:237] op_sel_hi:[1,0]
v_cvt_pk_bf16_f32 v36, v36, v37
v_cvt_pk_bf16_f32 v37, v38, v39
v_cvt_pk_bf16_f32 v38, v40, v41
v_cvt_pk_bf16_f32 v39, v42, v43
buffer_store_dwordx4 v[36:39], v1, s[4:7], s53 offen offset:2048 sc1
s_nop 0
v_mfma_f32_16x16x32_bf16 v[240:243], v[8:11], v[36:39], v[240:243]
s_waitcnt lgkmcnt(1)
v_pk_add_f32 v[44:45], v[44:45], v[20:21]
v_pk_add_f32 v[46:47], v[46:47], v[22:23]
s_waitcnt lgkmcnt(0)
v_pk_add_f32 v[48:49], v[48:49], v[24:25]
v_pk_add_f32 v[50:51], v[50:51], v[26:27]
v_pk_mul_f32 v[44:45], v[44:45], v[236:237] op_sel_hi:[1,0]
v_pk_mul_f32 v[46:47], v[46:47], v[236:237] op_sel_hi:[1,0]
v_pk_mul_f32 v[48:49], v[48:49], v[236:237] op_sel_hi:[1,0]
v_pk_mul_f32 v[50:51], v[50:51], v[236:237] op_sel_hi:[1,0]
v_cvt_pk_bf16_f32 v44, v44, v45
v_cvt_pk_bf16_f32 v45, v46, v47
v_cvt_pk_bf16_f32 v46, v48, v49
v_cvt_pk_bf16_f32 v47, v50, v51
buffer_store_dwordx4 v[44:47], v1, s[4:7], s53 offen offset:3072 sc1
s_nop 0
v_mfma_f32_16x16x32_bf16 v[240:243], v[8:11], v[44:47], v[240:243]
s_or_b64 s[66:67], s[66:67], s[32:33]
s_or_b64 s[66:67], s[66:67], s[34:35]
s_or_b64 s[66:67], s[66:67], s[96:97]
s_or_b64 s[66:67], s[66:67], s[98:99]
s_nop 3
v_cmp_u_f32 vcc, v241, v241
s_nop 3
s_or_b64 s[66:67], s[66:67], vcc
L_safe_next:
v_accvgpr_mov_b32 a0, a64
v_accvgpr_mov_b32 a1, a65
v_accvgpr_mov_b32 a2, a66
v_accvgpr_mov_b32 a3, a67
v_accvgpr_mov_b32 a4, a68
v_accvgpr_mov_b32 a5, a69
v_accvgpr_mov_b32 a6, a70
v_accvgpr_mov_b32 a7, a71
v_accvgpr_mov_b32 a8, a72
v_accvgpr_mov_b32 a9, a73
v_accvgpr_mov_b32 a10, a74
v_accvgpr_mov_b32 a11, a75
v_accvgpr_mov_b32 a12, a76
v_accvgpr_mov_b32 a13, a77
v_accvgpr_mov_b32 a14, a78
v_accvgpr_mov_b32 a15, a79
v_accvgpr_mov_b32 a16, a80
v_accvgpr_mov_b32 a17, a81
v_accvgpr_mov_b32 a18, a82
v_accvgpr_mov_b32 a19, a83
v_accvgpr_mov_b32 a20, a84
v_accvgpr_mov_b32 a21, a85
v_accvgpr_mov_b32 a22, a86
v_accvgpr_mov_b32 a23, a87
v_accvgpr_mov_b32 a24, a88
v_accvgpr_mov_b32 a25, a89
v_accvgpr_mov_b32 a26, a90
v_accvgpr_mov_b32 a27, a91
v_accvgpr_mov_b32 a28, a92
v_accvgpr_mov_b32 a29, a93
v_accvgpr_mov_b32 a30, a94
v_accvgpr_mov_b32 a31, a95
v_accvgpr_mov_b32 a32, a96
v_accvgpr_mov_b32 a33, a97
v_accvgpr_mov_b32 a34, a98
v_accvgpr_mov_b32 a35, a99
v_accvgpr_mov_b32 a36, a100
v_accvgpr_mov_b32 a37, a101
v_accvgpr_mov_b32 a38, a102
v_accvgpr_mov_b32 a39, a103
v_accvgpr_mov_b32 a40, a104
v_accvgpr_mov_b32 a41, a105
v_accvgpr_mov_b32 a42, a106
v_accvgpr_mov_b32 a43, a107
v_accvgpr_mov_b32 a44, a108
v_accvgpr_mov_b32 a45, a109
v_accvgpr_mov_b32 a46, a110
v_accvgpr_mov_b32 a47, a111
v_accvgpr_mov_b32 a48, a112
v_accvgpr_mov_b32 a49, a113
v_accvgpr_mov_b32 a50, a114
v_accvgpr_mov_b32 a51, a115
v_accvgpr_mov_b32 a52, a116
v_accvgpr_mov_b32 a53, a117
v_accvgpr_mov_b32 a54, a118
v_accvgpr_mov_b32 a55, a119
v_accvgpr_mov_b32 a56, a120
v_accvgpr_mov_b32 a57, a121
v_accvgpr_mov_b32 a58, a122
v_accvgpr_mov_b32 a59, a123
v_accvgpr_mov_b32 a60, a124
v_accvgpr_mov_b32 a61, a125
v_accvgpr_mov_b32 a62, a126
v_accvgpr_mov_b32 a63, a127
s_mov_b32 s63, s64
s_sub_u32 s65, s65, 1
s_cmp_lg_u32 s65, 0
s_cbranch_scc1 L_safe_blk
s_mov_b64 s[66:67], 0
s_mov_b64 s[90:91], 0
s_waitcnt lgkmcnt(0)
s_barrier
s_and_b32 s63, s2, 7
s_and_b32 s51, s63, 1
s_lshr_b32 s63, s63, 1
s_lshr_b32 s56, s2, 3
s_lshr_b32 s61, s56, 3
s_lshr_b32 s100, s56, 2
s_and_b32 s100, s100, 1
s_xor_b32 s100, s100, s61
s_and_b32 s100, s100, 3
s_and_b32 s101, s56, 3
s_mul_i32 s61, s61, 10
s_and_b32 s56, s56, 7
s_lshl_b32 s51, s51, 3
s_add_u32 s60, s51, s56
s_lshl_b32 s60, s60, 3
s_mul_i32 s65, s48, 5120
s_and_b32 s51, s63, 1
s_lshl_b32 s51, s51, 2
s_add_u32 s51, s51, s60
s_add_u32 s87, s51, s48
s_mul_i32 s51, s87, 186368
v_add_u32 v18, s51, v1
s_lshr_b32 s51, s63, 1
s_mul_i32 s51, s51, 5
s_add_u32 s3, s51, s61
s_lshl_b32 s51, s3, 10
s_mul_i32 s56, s48, 40960
s_add_u32 s51, s51, s56
v_add_u32 v16, s51, v1
v_add_u32 v17, 4096, v16
v_add_u32 v7, 28672, v1
v_add_u32 v252, 73728, v7
s_mul_i32 s51, s54, 5120
s_add_u32 s51, s51, 16384
v_add_u32 v5, s51, v1
v_add_u32 v6, 73728, v5
s_lshl_b32 s51, s55, 13
s_add_u32 s51, s51, 36864
v_add_u32 v253, s51, v1
v_add_u32 v254, 73728, v253
v_lshlrev_b32 v255, 2, v0
s_lshl_b32 s86, s48, 12
s_lshl_b32 s51, s48, 1
s_add_u32 s51, s51, s60
s_mul_i32 s51, s51, 186368
s_lshl_b32 s52, s63, 15
s_add_u32 s51, s51, s52
v_add_u32 v12, s51, v1
v_add_u32 v13, 184320, v12
s_mul_i32 s51, s63, 1310720
s_mul_i32 s52, s55, 40960
s_add_u32 s51, s51, s52
s_mul_i32 s52, s54, 5
s_add_u32 s52, s52, s61
s_lshl_b32 s52, s52, 10
s_add_u32 s51, s51, s52
v_add_u32 v14, s51, v1
v_add_u32 v15, 4096, v14
s_lshl_b32 s88, s60, 6
s_lshl_b32 s51, s63, 7
s_add_u32 s88, s88, s51
s_add_u32 s88, s88, 70782976
s_mov_b64 s[12:13], 0xff
s_lshr_b32 s51, s60, 1
s_mul_i32 s52, s61, 6554
s_lshr_b32 s52, s52, 16
s_add_u32 s51, s51, s52
s_lshl_b32 s89, s51, 7
s_add_u32 s89, s89, 70791168
s_mul_i32 s51, s51, 163840
s_add_u32 s51, s51, 75497472
s_lshl_b32 s52, s54, 1
s_add_u32 s52, s52, s55
s_lshl_b32 s52, s52, 2
s_add_u32 s52, s52, s63
s_mul_i32 s52, s52, 10240
s_add_u32 s60, s51, s52
s_mul_i32 s52, s63, 40960
s_add_u32 s61, s51, s52
s_mul_i32 s52, s48, 2560
s_add_u32 s61, s61, s52
v_lshlrev_b32 v19, 3, v0
s_lshl_b32 s51, s54, 1
s_add_u32 s51, s51, s55
s_cmp_eq_u32 s51, s63
s_cselect_b32 s60, 2146435072, s60
s_mov_b32 s57, 37748736
buffer_load_dwordx4 v[36:39], v18, s[4:7], s57 offen offset:0 sc1
buffer_load_dwordx4 v[40:43], v18, s[4:7], s57 offen offset:1024 sc1
buffer_load_dwordx4 v[44:47], v18, s[4:7], s57 offen offset:2048 sc1
buffer_load_dwordx4 v[48:51], v18, s[4:7], s57 offen offset:3072 sc1
s_mov_b32 s57, 37752832
buffer_load_dwordx4 v[52:55], v18, s[4:7], s57 offen offset:0 sc1
buffer_load_dwordx4 v[56:59], v18, s[4:7], s57 offen offset:1024 sc1
buffer_load_dwordx4 v[60:63], v18, s[4:7], s57 offen offset:2048 sc1
buffer_load_dwordx4 v[64:67], v18, s[4:7], s57 offen offset:3072 sc1
s_mov_b32 s57, 37756928
buffer_load_dwordx4 v[68:71], v18, s[4:7], s57 offen offset:0 sc1
buffer_load_dwordx4 v[72:75], v18, s[4:7], s57 offen offset:1024 sc1
buffer_load_dwordx4 v[76:79], v18, s[4:7], s57 offen offset:2048 sc1
buffer_load_dwordx4 v[80:83], v18, s[4:7], s57 offen offset:3072 sc1
s_mov_b32 s57, 37761024
buffer_load_dwordx4 v[84:87], v18, s[4:7], s57 offen offset:0 sc1
buffer_load_dwordx4 v[88:91], v18, s[4:7], s57 offen offset:1024 sc1
buffer_load_dwordx4 v[92:95], v18, s[4:7], s57 offen offset:2048 sc1
buffer_load_dwordx4 v[96:99], v18, s[4:7], s57 offen offset:3072 sc1
s_mov_b32 s56, 62914560
s_add_u32 m0, s65, 102400
s_nop 0
buffer_load_dwordx4 v16, s[4:7], s56 offen offset:0 sc1 lds
buffer_load_dwordx4 v16, s[4:7], s56 offen offset:1024 sc1 lds
buffer_load_dwordx4 v16, s[4:7], s56 offen offset:2048 sc1 lds
buffer_load_dwordx4 v16, s[4:7], s56 offen offset:3072 sc1 lds
s_add_u32 m0, s65, 106496
s_nop 0
buffer_load_dwordx4 v17, s[4:7], s56 offen sc1 lds
s_mov_b32 s56, 63078400
s_add_u32 m0, s65, 139264
s_nop 0
buffer_load_dwordx4 v16, s[4:7], s56 offen offset:0 sc1 lds
buffer_load_dwordx4 v16, s[4:7], s56 offen offset:1024 sc1 lds
buffer_load_dwordx4 v16, s[4:7], s56 offen offset:2048 sc1 lds
buffer_load_dwordx4 v16, s[4:7], s56 offen offset:3072 sc1 lds
s_add_u32 m0, s65, 143360
s_nop 0
buffer_load_dwordx4 v17, s[4:7], s56 offen sc1 lds
s_branch L_pub
L_code_end:
.section .rodata,"a"
.p2align 6
.amdhsa_kernel recurrent_scan__compressed_kv_cla__dense_activation_silu__prompt_kernel
  .amdhsa_next_free_vgpr 512
  .amdhsa_next_free_sgpr 102
  .amdhsa_accum_offset 256
  .amdhsa_group_segment_fixed_size 0
  .amdhsa_kernarg_size 96
  .amdhsa_user_sgpr_count 2
  .amdhsa_user_sgpr_kernarg_segment_ptr 1
  .amdhsa_system_sgpr_workgroup_id_x 1
.end_amdhsa_kernel
```
